```python
import torch

def _softmax(x, axis=-1):
    return torch.softmax(x, dim=axis)
def _gelu(x):
    return torch.nn.functional.gelu(x, approximate="tanh")
def _silu(x):
    return torch.nn.functional.silu(x)
def _sigmoid(x):
    return torch.sigmoid(x)
def _layernorm(x, axis=-1, eps=1e-5):
    m = x.mean(dim=axis, keepdim=True)
    v = x.var(dim=axis, keepdim=True, unbiased=False)
    return (x - m) / torch.sqrt(v + eps)
def _scatter_add(tgt, idx, src, axis=0):
    return tgt.clone().index_add_(axis, idx, src)
def _segment_sum(src, seg, n):
    out = torch.zeros((n,) + src.shape[1:], dtype=src.dtype)
    return out.index_add_(0, seg, src)
def _pad(x, pw):
    flat = tuple(v for pair in reversed(pw) for v in pair)
    return torch.nn.functional.pad(x, flat)

kernel_name = 'recurrent_scan__sliding_block__glu_gated_bilinear__prompt'

def setup_inputs():

    _w = (lambda a: (lambda t: t.to(torch.bfloat16) if t.is_floating_point() else t)(torch.as_tensor(a)))
    def _A_setup():
        B, S, D = 1, 2048, 1024
        return {
            "x": _w((lambda *s: torch.randn(*s, dtype=torch.bfloat16) * 0.05)(B, S, D)),
            "wqkv": _w((lambda *s: torch.randn(*s, dtype=torch.bfloat16) * 0.2)(D, 3 * D)),
            "wo": _w((lambda *s: torch.randn(*s, dtype=torch.bfloat16) * 0.2)(D, D)),
        }
    _A_in = _A_setup()

    def _B_setup():
        B, S, D, F = 1, 2048, 1024, 3584
        return {
            "x": _w((lambda *s: torch.randn(*s, dtype=torch.bfloat16) * 0.05)(B, S, D)),
            "w_gate": _w((lambda *s: torch.randn(*s, dtype=torch.bfloat16) * 0.1)(D, F) * (D ** -0.5)),
            "w_up": _w((lambda *s: torch.randn(*s, dtype=torch.bfloat16) * 0.1)(D, F) * (D ** -0.5)),
            "w_down": _w((lambda *s: torch.randn(*s, dtype=torch.bfloat16) * 0.1)(F, D) * (F ** -0.5)),
        }
    _B_in = _B_setup()

    return {
        "A_x": _A_in["x"],
        "A_wqkv": _A_in["wqkv"],
        "A_wo": _A_in["wo"],
        "B_x": _B_in["x"],
        "B_w_gate": _B_in["w_gate"],
        "B_w_up": _B_in["w_up"],
        "B_w_down": _B_in["w_down"],
    }

def reference(A_x, A_wqkv, A_wo, B_x, B_w_gate, B_w_up, B_w_down):
    def _A_ref(x, wqkv, wo):
        B, S, D = x.shape
        H = 32; Dh = D // H; W = 256
        qkv = (lambda x, *d: x.permute(*d))((x @ wqkv).reshape(B, S, 3, H, Dh), 2, 0, 3, 1, 4)
        q, k, v = qkv[0], qkv[1], qkv[2]
        scores = torch.einsum("bhqd,bhkd->bhqk", q, k) * (Dh ** -0.5)
        idx = torch.arange(S)
        mask = (idx[:, None] - idx[None, :] >= 0) & (idx[:, None] - idx[None, :] < W)
        scores = torch.where(mask[None, None], scores, -1e9)
        p = _softmax(scores, axis=-1)
        o = torch.einsum("bhqk,bhkd->bhqd", p, v)
        return (lambda x, *d: x.permute(*d))(o, 0, 2, 1, 3).reshape(B, S, D) @ wo

    def _B_ref(x, w_gate, w_up, w_down):
        g = torch.einsum("bsd,df->bsf", x, w_gate)
        u = torch.einsum("bsd,df->bsf", x, w_up)
        h = g * u
        return torch.einsum("bsf,fd->bsd", h, w_down)

    x = A_x
    xn = _layernorm(x, axis=-1)
    s = _A_ref(xn, A_wqkv, A_wo)
    g = _silu(_B_ref(xn, B_w_gate, B_w_up, B_w_down))
    return x + s * g
```

```asm
; @launch grid=(256,1,1) block=(256,1,1) lds=163840
.amdgcn_target "amdgcn-amd-amdhsa--gfx950"
.text
.globl recurrent_scan__sliding_block__glu_gated_bilinear__prompt_kernel
.p2align 8
.type recurrent_scan__sliding_block__glu_gated_bilinear__prompt_kernel,@function
recurrent_scan__sliding_block__glu_gated_bilinear__prompt_kernel:
  s_cmp_lt_u32 s2, 256
  s_cbranch_scc1 fz_start
  s_endpgm
fz_start:
  s_load_dwordx2 s[72:73], s[0:1], 0
  s_load_dwordx2 s[6:7], s[0:1], 72
  s_load_dwordx2 s[4:5], s[0:1], 8
  s_load_dwordx4 s[8:11], s[0:1], 32
  v_lshrrev_b32 v14, 6, v0
  v_and_b32 v0, 63, v0
  v_readfirstlane_b32 s40, v14
  v_lshlrev_b32 v1, 4, v0
  s_and_b32 s79, s2, 7
  s_lshr_b32 s57, s2, 3
  s_and_b32 s56, s57, 1
  s_lshl_b32 s56, s56, 4
  s_bfe_u32 s58, s57, 0x20001
  s_lshl_b32 s58, s58, 2
  s_lshr_b32 s57, s57, 3
  s_or_b32 s57, s57, s58
  s_or_b32 s57, s57, s56
  s_and_b32 s43, s79, 1
  s_lshl_b32 s43, s43, 2
  s_and_b32 s56, s57, 3
  s_add_u32 s43, s43, s56
  s_lshr_b32 s57, s57, 2
  s_lshr_b32 s3, s57, 2
  s_and_b32 s57, s57, 3
  s_lshr_b32 s44, s79, 1
  s_lshl_b32 s44, s44, 2
  s_add_u32 s44, s44, s57
  s_lshr_b32 s78, s44, 1
  s_lshl_b32 s78, s78, 1
  s_add_u32 s78, s78, s3
  s_lshl_b32 s78, s78, 1
  s_and_b32 s56, s44, 1
  s_add_u32 s78, s78, s56
  s_lshr_b32 s41, s40, 1
  s_and_b32 s42, s40, 1
  v_and_b32 v64, 7, v0
  v_bfe_u32 v65, v0, 3, 1
  v_lshrrev_b32 v66, 4, v0
  v_lshlrev_b32 v67, 11, v64
  v_lshlrev_b32 v68, 6, v65
  v_add_u32 v67, v67, v68
  v_lshlrev_b32 v68, 3, v66
  v_add_u32 v67, v67, v68
  s_lshl_b32 s56, s40, 9
  v_add_u32 v67, s56, v67
  s_lshl_b32 s56, s43, 5
  s_add_u32 s56, s56, s78
  s_lshl_b32 s56, s56, 14
  s_waitcnt lgkmcnt(0)
  s_add_u32 s32, s72, s56
  s_addc_u32 s33, s73, 0
  s_mov_b32 s34, 16384
  s_mov_b32 s35, 0x20000
  buffer_load_dwordx2 v[32:33], v67, s[32:35], 0 offen offset:0
  buffer_load_dwordx2 v[34:35], v67, s[32:35], 0 offen offset:32
  buffer_load_dwordx2 v[36:37], v67, s[32:35], 0 offen offset:128
  buffer_load_dwordx2 v[38:39], v67, s[32:35], 0 offen offset:160
  buffer_load_dwordx2 v[40:41], v67, s[32:35], 0 offen offset:256
  buffer_load_dwordx2 v[42:43], v67, s[32:35], 0 offen offset:288
  buffer_load_dwordx2 v[44:45], v67, s[32:35], 0 offen offset:384
  buffer_load_dwordx2 v[46:47], v67, s[32:35], 0 offen offset:416
  s_getpc_b64 s[58:59]
pfc_1:
  s_sub_u32 s58, s58, pfc_1-fz_start
  s_subb_u32 s59, s59, 0
  s_lshl_b32 s60, s3, 2
  s_and_b32 s61, s44, 3
  s_add_u32 s60, s60, s61
  s_lshl_b32 s60, s60, 2
  s_and_b32 s61, s43, 3
  s_add_u32 s60, s60, s61
  s_lshl_b32 s60, s60, 2
  s_add_u32 s60, s60, s40
  s_lshl_b32 s60, s60, 10
  v_and_b32 v12, 7, v0
  v_lshlrev_b32 v12, 7, v12
  v_add_u32 v12, s60, v12
  s_mov_b32 s60, fz_end-fz_start-4
  v_min_u32 v12, s60, v12
  v_mov_b32 v13, s59
  v_add_co_u32 v12, vcc, s58, v12
  s_nop 1
  v_addc_co_u32 v13, vcc, 0, v13, vcc
  global_load_dword v191, v[12:13], off
  s_add_u32 s56, s6, 62914560
  s_addc_u32 s57, s7, 0
  s_load_dwordx2 s[76:77], s[56:57], 0
  v_lshrrev_b32 v14, 3, v0
  v_and_b32 v15, 6, v14
  v_and_b32 v16, 7, v0
  v_xor_b32 v15, v15, v16
  s_lshl_b32 s56, s40, 3
  v_add_u32 v14, s56, v14
  s_lshl_b32 s52, s40, 12
  v_add_u32 v188, s52, v1
  s_lshl_b32 s56, s40, 10
  s_add_u32 s53, s56, 65536
  s_add_u32 s54, s56, 131072
  s_cmp_eq_u32 s3, 1
  s_cbranch_scc1 g1_set_glu
  s_lshl_b32 s64, s44, 7
  s_add_u32 s56, s64, 2048
  s_add_u32 s57, s64, 4096
  s_add_u32 s58, s64, 5120
  s_mov_b32 s59, s58
  s_mov_b32 s68, s4
  s_mov_b32 s69, s5
  s_mov_b32 s70, s4
  s_mov_b32 s71, s5
  s_mov_b32 s72, s8
  s_mov_b32 s73, s9
  s_mov_b32 s74, s10
  s_mov_b32 s75, s11
  s_add_u32 s60, s4, s64
  s_addc_u32 s61, s5, 0
  s_add_u32 s62, s60, 64
  s_addc_u32 s63, s61, 0
  s_mov_b32 s65, 6144
  s_mov_b32 s67, 6144
  s_branch g1_set_done
g1_set_glu:
  s_lshl_b32 s56, s44, 7
  s_mov_b32 s57, s56
  s_mul_i32 s66, s44, 192
  s_add_u32 s66, s66, 2048
  s_and_b32 s65, s44, 1
  s_lshl_b32 s67, s65, 6
  s_add_u32 s58, s66, s67
  s_mov_b32 s59, s58
  s_cmp_eq_u32 s65, 0
  s_cselect_b32 s67, 128, 0
  s_add_u32 s64, s66, s67
  s_mov_b32 s68, s8
  s_mov_b32 s69, s9
  s_mov_b32 s70, s10
  s_mov_b32 s71, s11
  s_mov_b32 s72, s8
  s_mov_b32 s73, s9
  s_mov_b32 s74, s10
  s_mov_b32 s75, s11
  s_add_u32 s60, s8, s64
  s_addc_u32 s61, s9, 0
  s_add_u32 s62, s10, s64
  s_addc_u32 s63, s11, 0
  s_mov_b32 s65, 7168
  s_mov_b32 s67, 7168
g1_set_done:
  s_mov_b32 s64, 32
  s_mov_b32 s66, 7168
  s_add_u32 s16, s68, s56
  s_addc_u32 s17, s69, 0
  s_lshl_b32 s18, s65, 10
  s_sub_u32 s18, s18, s56
  s_mov_b32 s19, 0x20000
  s_add_u32 s20, s70, s57
  s_addc_u32 s21, s71, 0
  s_lshl_b32 s22, s65, 10
  s_sub_u32 s22, s22, s57
  s_mov_b32 s23, 0x20000
  s_add_u32 s24, s72, s58
  s_addc_u32 s25, s73, 0
  s_lshl_b32 s26, s66, 10
  s_sub_u32 s26, s26, s58
  s_mov_b32 s27, 0x20000
  s_add_u32 s28, s74, s59
  s_addc_u32 s29, s75, 0
  s_lshl_b32 s30, s66, 10
  s_sub_u32 s30, s30, s59
  s_mov_b32 s31, 0x20000
  s_lshl_b32 s48, s65, 5
  s_lshl_b32 s49, s66, 5
  s_lshl_b32 s50, s67, 5
  s_mov_b32 s51, 0
  s_mov_b32 s45, 0
  s_mov_b32 s46, 0
  s_mov_b32 s47, 0
  v_lshlrev_b32 v16, 4, v15
  v_mul_lo_u32 v2, v14, s65
  v_add_u32 v2, v2, v16
  v_mul_lo_u32 v3, v14, s66
  v_add_u32 v3, v3, v16
  v_mul_lo_u32 v14, v14, s67
  v_and_b32 v16, 1, v15
  v_lshlrev_b32 v16, 4, v16
  v_add_u32 v14, v14, v16
  v_bfe_u32 v16, v15, 1, 1
  v_mul_lo_u32 v16, v16, s64
  v_add_u32 v14, v14, v16
  v_cmp_gt_u32 vcc, 4, v15
  v_mov_b32 v4, s62
  v_mov_b32 v16, s60
  v_cndmask_b32 v4, v4, v16, vcc
  v_mov_b32 v5, s63
  v_mov_b32 v16, s61
  v_cndmask_b32 v5, v5, v16, vcc
  v_add_co_u32 v4, vcc, v4, v14
  s_nop 1
  v_addc_co_u32 v5, vcc, 0, v5, vcc
  s_add_u32 m0, s53, 0
  s_nop 0
  buffer_load_dwordx4 v2, s[16:19], s46 offen lds
  s_add_u32 m0, s53, 4096
  s_nop 0
  buffer_load_dwordx4 v2, s[20:23], s46 offen lds
  s_add_u32 m0, s53, 8192
  s_nop 0
  buffer_load_dwordx4 v3, s[24:27], s47 offen lds
  s_add_u32 m0, s53, 12288
  s_nop 0
  buffer_load_dwordx4 v3, s[28:31], s47 offen lds
  s_add_u32 m0, s54, 0
  s_nop 0
  global_load_lds_dwordx4 v[4:5], off
  s_add_u32 s46, s46, s48
  s_add_u32 s47, s47, s49
  v_lshl_add_u64 v[4:5], s[50:51], 0, v[4:5]
  s_add_u32 m0, s53, 16384
  s_nop 0
  buffer_load_dwordx4 v2, s[16:19], s46 offen lds
  s_add_u32 m0, s53, 20480
  s_nop 0
  buffer_load_dwordx4 v2, s[20:23], s46 offen lds
  s_add_u32 m0, s53, 24576
  s_nop 0
  buffer_load_dwordx4 v3, s[24:27], s47 offen lds
  s_add_u32 m0, s53, 28672
  s_nop 0
  buffer_load_dwordx4 v3, s[28:31], s47 offen lds
  s_add_u32 m0, s54, 4096
  s_nop 0
  global_load_lds_dwordx4 v[4:5], off
  s_add_u32 s46, s46, s48
  s_add_u32 s47, s47, s49
  v_lshl_add_u64 v[4:5], s[50:51], 0, v[4:5]
  s_add_u32 m0, s53, 32768
  s_nop 0
  buffer_load_dwordx4 v2, s[16:19], s46 offen lds
  s_add_u32 m0, s53, 36864
  s_nop 0
  buffer_load_dwordx4 v2, s[20:23], s46 offen lds
  s_add_u32 m0, s53, 40960
  s_nop 0
  buffer_load_dwordx4 v3, s[24:27], s47 offen lds
  s_add_u32 m0, s53, 45056
  s_nop 0
  buffer_load_dwordx4 v3, s[28:31], s47 offen lds
  s_add_u32 m0, s54, 8192
  s_nop 0
  global_load_lds_dwordx4 v[4:5], off
  s_add_u32 s46, s46, s48
  s_add_u32 s47, s47, s49
  v_lshl_add_u64 v[4:5], s[50:51], 0, v[4:5]
  s_add_u32 m0, s53, 49152
  s_nop 0
  buffer_load_dwordx4 v2, s[16:19], s46 offen lds
  s_add_u32 m0, s53, 53248
  s_nop 0
  buffer_load_dwordx4 v2, s[20:23], s46 offen lds
  s_add_u32 m0, s53, 57344
  s_nop 0
  buffer_load_dwordx4 v3, s[24:27], s47 offen lds
  s_add_u32 m0, s53, 61440
  s_nop 0
  buffer_load_dwordx4 v3, s[28:31], s47 offen lds
  s_add_u32 m0, s54, 12288
  s_nop 0
  global_load_lds_dwordx4 v[4:5], off
  s_add_u32 s46, s46, s48
  s_add_u32 s47, s47, s49
  v_lshl_add_u64 v[4:5], s[50:51], 0, v[4:5]
  s_lshl_b32 s56, s2, 2
  s_add_u32 s56, s56, s40
  s_mov_b32 s36, s4
  s_mov_b32 s37, s5
  s_mov_b32 s38, 6291456
  s_mov_b32 s57, 3932160
  s_cmp_lt_u32 s56, 288
  s_cbranch_scc1 g1_pft_done
  s_sub_u32 s56, s56, 288
  s_mov_b32 s36, s8
  s_mov_b32 s37, s9
  s_mov_b32 s38, 7340032
  s_mov_b32 s57, 4587520
  s_cmp_lt_u32 s56, 336
  s_cbranch_scc1 g1_pft_done
  s_sub_u32 s56, s56, 336
  s_mov_b32 s36, s10
  s_mov_b32 s37, s11
g1_pft_done:
  s_mov_b32 s39, 0x20000
  s_lshl_b32 s56, s56, 13
  s_add_u32 s57, s57, s56
  v_and_b32 v187, 15, v0
  v_lshlrev_b32 v187, 7, v187
  v_add_u32 v187, s57, v187
  s_mov_b32 s56, 3670016
  s_cmp_eq_u32 s38, 6291456
  s_cselect_b32 s56, 3145728, s56
  s_sub_u32 s57, s57, s56
  v_lshlrev_b32 v13, 7, v0
  v_add_u32 v13, s57, v13
  s_cmp_eq_u32 s3, 0
  s_cselect_b32 s56, 16, 48
  s_load_dwordx2 s[4:5], s[0:1], s56
  s_load_dwordx2 s[8:9], s[0:1], 0
  s_load_dwordx2 s[10:11], s[0:1], 56
  s_load_dwordx2 s[68:69], s[0:1], 48
  s_load_dwordx2 s[70:71], s[0:1], 16
  s_lshl_b32 s56, s43, 19
  s_add_u32 s12, s6, s56
  s_addc_u32 s13, s7, 0
  s_mov_b32 s14, 524288
  s_mov_b32 s15, 0x20000
  s_add_u32 s72, s6, 62914560
  s_addc_u32 s73, s7, 0
  s_mov_b32 s74, 167936
  s_mov_b32 s75, 0x20000
  s_lshl_b32 s56, s41, 13
  v_add_u32 v6, s56, v1
  v_lshrrev_b32 v16, 2, v0
  v_and_b32 v17, 6, v16
  v_lshlrev_b32 v16, 7, v16
  v_bfe_u32 v18, v0, 1, 1
  v_lshlrev_b32 v18, 4, v18
  v_add_u32 v16, v16, v18
  v_and_b32 v18, 1, v0
  v_lshlrev_b32 v18, 3, v18
  v_add_u32 v16, v16, v18
  s_lshl_b32 s56, s42, 1
  s_add_u32 s56, s56, 0
  s_add_u32 s57, s42, 0
  s_cmp_eq_u32 s3, 0
  s_cselect_b32 s57, s56, s57
  s_lshl_b32 s56, s56, 1
  s_lshl_b32 s57, s57, 1
  v_xor_b32 v18, s56, v17
  v_lshlrev_b32 v18, 4, v18
  v_add_u32 v18, v18, v16
  v_add_u32 v7, 65536, v18
  v_xor_b32 v18, s57, v17
  v_lshlrev_b32 v18, 4, v18
  v_add_u32 v18, v18, v16
  v_add_u32 v9, 131072, v18
  s_lshl_b32 s56, s42, 1
  s_add_u32 s56, s56, 1
  s_add_u32 s57, s42, 2
  s_cmp_eq_u32 s3, 0
  s_cselect_b32 s57, s56, s57
  s_lshl_b32 s56, s56, 1
  s_lshl_b32 s57, s57, 1
  v_xor_b32 v18, s56, v17
  v_lshlrev_b32 v18, 4, v18
  v_add_u32 v18, v18, v16
  v_add_u32 v8, 65536, v18
  v_xor_b32 v18, s57, v17
  v_lshlrev_b32 v18, 4, v18
  v_add_u32 v18, v18, v16
  v_add_u32 v10, 131072, v18
  s_and_b32 s56, s78, 1
  s_lshl_b32 s56, s56, 3
  v_add_u32 v68, s56, v64
  v_lshlrev_b32 v68, 4, v68
  v_lshlrev_b32 v69, 8, v66
  v_add_u32 v68, v68, v69
  v_lshlrev_b32 v69, 14, v65
  v_add_u32 v68, v68, v69
  v_lshlrev_b32 v70, 2, v64
  v_add_u32 v70, 147456, v70
  s_lshl_b32 s56, s40, 5
  v_add_u32 v71, s56, v70
  s_lshl_b32 s60, s43, 5
  s_lshl_b32 s56, s40, 3
  s_add_u32 s60, s60, s56
  s_lshl_b32 s60, s60, 14
  s_lshr_b32 s56, s78, 1
  s_lshl_b32 s56, s56, 10
  s_add_u32 s60, s60, s56
  s_add_u32 s32, s6, 46137344
  s_addc_u32 s33, s7, 0
  s_mov_b32 s34, 4194304
  s_mov_b32 s35, 0x20000
  s_waitcnt vmcnt(21)
  s_add_u32 s32, s6, 0
  s_addc_u32 s33, s7, 0
  s_mov_b32 s34, 4194304
  s_mov_b32 s35, 0x20000
  v_lshlrev_b32 v80, 16, v32
  v_and_b32 v81, 0xffff0000, v32
  v_lshlrev_b32 v82, 16, v33
  v_and_b32 v83, 0xffff0000, v33
  v_lshlrev_b32 v84, 16, v34
  v_and_b32 v85, 0xffff0000, v34
  v_lshlrev_b32 v86, 16, v35
  v_and_b32 v87, 0xffff0000, v35
  v_lshlrev_b32 v88, 16, v36
  v_and_b32 v89, 0xffff0000, v36
  v_lshlrev_b32 v90, 16, v37
  v_and_b32 v91, 0xffff0000, v37
  v_lshlrev_b32 v92, 16, v38
  v_and_b32 v93, 0xffff0000, v38
  v_lshlrev_b32 v94, 16, v39
  v_and_b32 v95, 0xffff0000, v39
  v_lshlrev_b32 v96, 16, v40
  v_and_b32 v97, 0xffff0000, v40
  v_lshlrev_b32 v98, 16, v41
  v_and_b32 v99, 0xffff0000, v41
  v_lshlrev_b32 v100, 16, v42
  v_and_b32 v101, 0xffff0000, v42
  v_lshlrev_b32 v102, 16, v43
  v_and_b32 v103, 0xffff0000, v43
  v_lshlrev_b32 v104, 16, v44
  v_and_b32 v105, 0xffff0000, v44
  v_lshlrev_b32 v106, 16, v45
  v_and_b32 v107, 0xffff0000, v45
  v_lshlrev_b32 v108, 16, v46
  v_and_b32 v109, 0xffff0000, v46
  v_lshlrev_b32 v110, 16, v47
  v_and_b32 v111, 0xffff0000, v47
  v_add_f32 v72, v80, v84
  v_add_f32 v73, v81, v85
  v_add_f32 v74, v82, v86
  v_add_f32 v75, v83, v87
  v_add_f32 v72, v72, v88
  v_add_f32 v73, v73, v89
  v_add_f32 v74, v74, v90
  v_add_f32 v75, v75, v91
  v_add_f32 v72, v72, v92
  v_add_f32 v73, v73, v93
  v_add_f32 v74, v74, v94
  v_add_f32 v75, v75, v95
  v_add_f32 v72, v72, v96
  v_add_f32 v73, v73, v97
  v_add_f32 v74, v74, v98
  v_add_f32 v75, v75, v99
  v_add_f32 v72, v72, v100
  v_add_f32 v73, v73, v101
  v_add_f32 v74, v74, v102
  v_add_f32 v75, v75, v103
  v_add_f32 v72, v72, v104
  v_add_f32 v73, v73, v105
  v_add_f32 v74, v74, v106
  v_add_f32 v75, v75, v107
  v_add_f32 v72, v72, v108
  v_add_f32 v73, v73, v109
  v_add_f32 v74, v74, v110
  v_add_f32 v75, v75, v111
  v_add_f32 v72, v72, v73
  v_add_f32 v74, v74, v75
  v_add_f32 v72, v72, v74
  s_nop 1
  v_add_f32_dpp v72, v72, v72 row_ror:8 row_mask:0xf bank_mask:0xf
  v_mov_b32 v76, v72
  s_nop 1
  v_permlane32_swap_b32 v72, v76
  s_nop 0
  v_add_f32 v72, v72, v76
  v_mov_b32 v76, v72
  s_nop 1
  v_permlane16_swap_b32 v72, v76
  s_nop 0
  v_add_f32 v72, v72, v76
  ds_write_b32 v71, v72 offset:0
  s_waitcnt lgkmcnt(0)
  s_barrier
  ds_read_b32 v72, v70 offset:0
  ds_read_b32 v73, v70 offset:32
  ds_read_b32 v74, v70 offset:64
  ds_read_b32 v75, v70 offset:96
  s_waitcnt lgkmcnt(0)
  v_add_f32 v72, v72, v73
  v_add_f32 v74, v74, v75
  v_add_f32 v72, v72, v74
  v_mul_f32 v77, 0x3a800000, v72
  v_sub_f32 v78, v80, v77
  v_mul_f32 v72, v78, v78
  v_sub_f32 v78, v81, v77
  v_mul_f32 v73, v78, v78
  v_sub_f32 v78, v82, v77
  v_mul_f32 v74, v78, v78
  v_sub_f32 v78, v83, v77
  v_mul_f32 v75, v78, v78
  v_sub_f32 v78, v84, v77
  v_fmac_f32 v72, v78, v78
  v_sub_f32 v79, v85, v77
  v_fmac_f32 v73, v79, v79
  v_sub_f32 v78, v86, v77
  v_fmac_f32 v74, v78, v78
  v_sub_f32 v79, v87, v77
  v_fmac_f32 v75, v79, v79
  v_sub_f32 v78, v88, v77
  v_fmac_f32 v72, v78, v78
  v_sub_f32 v79, v89, v77
  v_fmac_f32 v73, v79, v79
  v_sub_f32 v78, v90, v77
  v_fmac_f32 v74, v78, v78
  v_sub_f32 v79, v91, v77
  v_fmac_f32 v75, v79, v79
  v_sub_f32 v78, v92, v77
  v_fmac_f32 v72, v78, v78
  v_sub_f32 v79, v93, v77
  v_fmac_f32 v73, v79, v79
  v_sub_f32 v78, v94, v77
  v_fmac_f32 v74, v78, v78
  v_sub_f32 v79, v95, v77
  v_fmac_f32 v75, v79, v79
  v_sub_f32 v78, v96, v77
  v_fmac_f32 v72, v78, v78
  v_sub_f32 v79, v97, v77
  v_fmac_f32 v73, v79, v79
  v_sub_f32 v78, v98, v77
  v_fmac_f32 v74, v78, v78
  v_sub_f32 v79, v99, v77
  v_fmac_f32 v75, v79, v79
  v_sub_f32 v78, v100, v77
  v_fmac_f32 v72, v78, v78
  v_sub_f32 v79, v101, v77
  v_fmac_f32 v73, v79, v79
  v_sub_f32 v78, v102, v77
  v_fmac_f32 v74, v78, v78
  v_sub_f32 v79, v103, v77
  v_fmac_f32 v75, v79, v79
  v_sub_f32 v78, v104, v77
  v_fmac_f32 v72, v78, v78
  v_sub_f32 v79, v105, v77
  v_fmac_f32 v73, v79, v79
  v_sub_f32 v78, v106, v77
  v_fmac_f32 v74, v78, v78
  v_sub_f32 v79, v107, v77
  v_fmac_f32 v75, v79, v79
  v_sub_f32 v78, v108, v77
  v_fmac_f32 v72, v78, v78
  v_sub_f32 v79, v109, v77
  v_fmac_f32 v73, v79, v79
  v_sub_f32 v78, v110, v77
  v_fmac_f32 v74, v78, v78
  v_sub_f32 v79, v111, v77
  v_fmac_f32 v75, v79, v79
  v_add_f32 v72, v72, v73
  v_add_f32 v74, v74, v75
  v_add_f32 v72, v72, v74
  s_nop 1
  v_add_f32_dpp v72, v72, v72 row_ror:8 row_mask:0xf bank_mask:0xf
  v_mov_b32 v76, v72
  s_nop 1
  v_permlane32_swap_b32 v72, v76
  s_nop 0
  v_add_f32 v72, v72, v76
  v_mov_b32 v76, v72
  s_nop 1
  v_permlane16_swap_b32 v72, v76
  s_nop 0
  v_add_f32 v72, v72, v76
  ds_write_b32 v71, v72 offset:128
  s_waitcnt lgkmcnt(0)
  s_barrier
  ds_read_b32 v72, v70 offset:128
  ds_read_b32 v73, v70 offset:160
  ds_read_b32 v74, v70 offset:192
  ds_read_b32 v75, v70 offset:224
  s_waitcnt lgkmcnt(0)
  v_add_f32 v72, v72, v73
  v_add_f32 v74, v74, v75
  v_add_f32 v72, v72, v74
  v_mul_f32 v72, 0x3a800000, v72
  v_cvt_pk_bf16_f32 v72, v72, v77
  v_and_b32 v77, 0xffff0000, v72
  v_lshlrev_b32 v72, 16, v72
  v_add_f32 v72, 0x3727c5ac, v72
  v_cvt_pk_bf16_f32 v72, v72, v72
  v_lshlrev_b32 v72, 16, v72
  v_sqrt_f32 v72, v72
  s_nop 0
  v_cvt_pk_bf16_f32 v72, v72, v72
  v_lshlrev_b32 v72, 16, v72
  v_rcp_f32 v78, v72
  v_sub_f32 v80, v80, v77
  v_sub_f32 v81, v81, v77
  v_cvt_pk_bf16_f32 v79, v80, v81
  v_lshlrev_b32 v80, 16, v79
  v_and_b32 v81, 0xffff0000, v79
  v_mul_f32 v80, v80, v78
  v_mul_f32 v81, v81, v78
  v_cvt_pk_bf16_f32 v112, v80, v81
  v_sub_f32 v82, v82, v77
  v_sub_f32 v83, v83, v77
  v_cvt_pk_bf16_f32 v79, v82, v83
  v_lshlrev_b32 v82, 16, v79
  v_and_b32 v83, 0xffff0000, v79
  v_mul_f32 v82, v82, v78
  v_mul_f32 v83, v83, v78
  v_cvt_pk_bf16_f32 v113, v82, v83
  v_sub_f32 v84, v84, v77
  v_sub_f32 v85, v85, v77
  v_cvt_pk_bf16_f32 v79, v84, v85
  v_lshlrev_b32 v84, 16, v79
  v_and_b32 v85, 0xffff0000, v79
  v_mul_f32 v84, v84, v78
  v_mul_f32 v85, v85, v78
  v_cvt_pk_bf16_f32 v114, v84, v85
  v_sub_f32 v86, v86, v77
  v_sub_f32 v87, v87, v77
  v_cvt_pk_bf16_f32 v79, v86, v87
  v_lshlrev_b32 v86, 16, v79
  v_and_b32 v87, 0xffff0000, v79
  v_mul_f32 v86, v86, v78
  v_mul_f32 v87, v87, v78
  v_cvt_pk_bf16_f32 v115, v86, v87
  s_add_u32 s61, s60, 0
  buffer_store_dwordx4 v[112:115], v68, s[32:35], s61 offen sc1
  v_sub_f32 v88, v88, v77
  v_sub_f32 v89, v89, v77
  v_cvt_pk_bf16_f32 v79, v88, v89
  v_lshlrev_b32 v88, 16, v79
  v_and_b32 v89, 0xffff0000, v79
  v_mul_f32 v88, v88, v78
  v_mul_f32 v89, v89, v78
  v_cvt_pk_bf16_f32 v116, v88, v89
  v_sub_f32 v90, v90, v77
  v_sub_f32 v91, v91, v77
  v_cvt_pk_bf16_f32 v79, v90, v91
  v_lshlrev_b32 v90, 16, v79
  v_and_b32 v91, 0xffff0000, v79
  v_mul_f32 v90, v90, v78
  v_mul_f32 v91, v91, v78
  v_cvt_pk_bf16_f32 v117, v90, v91
  v_sub_f32 v92, v92, v77
  v_sub_f32 v93, v93, v77
  v_cvt_pk_bf16_f32 v79, v92, v93
  v_lshlrev_b32 v92, 16, v79
  v_and_b32 v93, 0xffff0000, v79
  v_mul_f32 v92, v92, v78
  v_mul_f32 v93, v93, v78
  v_cvt_pk_bf16_f32 v118, v92, v93
  v_sub_f32 v94, v94, v77
  v_sub_f32 v95, v95, v77
  v_cvt_pk_bf16_f32 v79, v94, v95
  v_lshlrev_b32 v94, 16, v79
  v_and_b32 v95, 0xffff0000, v79
  v_mul_f32 v94, v94, v78
  v_mul_f32 v95, v95, v78
  v_cvt_pk_bf16_f32 v119, v94, v95
  s_add_u32 s61, s60, 32768
  buffer_store_dwordx4 v[116:119], v68, s[32:35], s61 offen sc1
  v_sub_f32 v96, v96, v77
  v_sub_f32 v97, v97, v77
  v_cvt_pk_bf16_f32 v79, v96, v97
  v_lshlrev_b32 v96, 16, v79
  v_and_b32 v97, 0xffff0000, v79
  v_mul_f32 v96, v96, v78
  v_mul_f32 v97, v97, v78
  v_cvt_pk_bf16_f32 v120, v96, v97
  v_sub_f32 v98, v98, v77
  v_sub_f32 v99, v99, v77
  v_cvt_pk_bf16_f32 v79, v98, v99
  v_lshlrev_b32 v98, 16, v79
  v_and_b32 v99, 0xffff0000, v79
  v_mul_f32 v98, v98, v78
  v_mul_f32 v99, v99, v78
  v_cvt_pk_bf16_f32 v121, v98, v99
  v_sub_f32 v100, v100, v77
  v_sub_f32 v101, v101, v77
  v_cvt_pk_bf16_f32 v79, v100, v101
  v_lshlrev_b32 v100, 16, v79
  v_and_b32 v101, 0xffff0000, v79
  v_mul_f32 v100, v100, v78
  v_mul_f32 v101, v101, v78
  v_cvt_pk_bf16_f32 v122, v100, v101
  v_sub_f32 v102, v102, v77
  v_sub_f32 v103, v103, v77
  v_cvt_pk_bf16_f32 v79, v102, v103
  v_lshlrev_b32 v102, 16, v79
  v_and_b32 v103, 0xffff0000, v79
  v_mul_f32 v102, v102, v78
  v_mul_f32 v103, v103, v78
  v_cvt_pk_bf16_f32 v123, v102, v103
  s_add_u32 s61, s60, 65536
  buffer_store_dwordx4 v[120:123], v68, s[32:35], s61 offen sc1
  v_sub_f32 v104, v104, v77
  v_sub_f32 v105, v105, v77
  v_cvt_pk_bf16_f32 v79, v104, v105
  v_lshlrev_b32 v104, 16, v79
  v_and_b32 v105, 0xffff0000, v79
  v_mul_f32 v104, v104, v78
  v_mul_f32 v105, v105, v78
  v_cvt_pk_bf16_f32 v124, v104, v105
  v_sub_f32 v106, v106, v77
  v_sub_f32 v107, v107, v77
  v_cvt_pk_bf16_f32 v79, v106, v107
  v_lshlrev_b32 v106, 16, v79
  v_and_b32 v107, 0xffff0000, v79
  v_mul_f32 v106, v106, v78
  v_mul_f32 v107, v107, v78
  v_cvt_pk_bf16_f32 v125, v106, v107
  v_sub_f32 v108, v108, v77
  v_sub_f32 v109, v109, v77
  v_cvt_pk_bf16_f32 v79, v108, v109
  v_lshlrev_b32 v108, 16, v79
  v_and_b32 v109, 0xffff0000, v79
  v_mul_f32 v108, v108, v78
  v_mul_f32 v109, v109, v78
  v_cvt_pk_bf16_f32 v126, v108, v109
  v_sub_f32 v110, v110, v77
  v_sub_f32 v111, v111, v77
  v_cvt_pk_bf16_f32 v79, v110, v111
  v_lshlrev_b32 v110, 16, v79
  v_and_b32 v111, 0xffff0000, v79
  v_mul_f32 v110, v110, v78
  v_mul_f32 v111, v111, v78
  v_cvt_pk_bf16_f32 v127, v110, v111
  s_add_u32 s61, s60, 98304
  buffer_store_dwordx4 v[124:127], v68, s[32:35], s61 offen sc1
  s_add_u32 s76, s76, 1
  s_waitcnt vmcnt(0)
  s_barrier
  s_cmp_eq_u32 s40, 0
  s_cbranch_scc0 sig_2
  s_lshl_b32 s56, s43, 5
  s_add_u32 s56, s56, s78
  s_add_u32 s56, s56, 0
  s_lshl_b32 s56, s56, 7
  s_add_u32 s56, s56, 4096
  v_mov_b32 v16, s76
  v_mov_b32 v17, s77
  v_mov_b32 v18, 0
  s_mov_b64 exec, 1
  buffer_store_dwordx2 v[16:17], v18, s[72:75], s56 offen sc1
  s_mov_b64 exec, -1
sig_2:
  s_mul_i32 s56, s2, 28672
  s_add_u32 s32, s68, s56
  s_addc_u32 s33, s69, 0
  s_mov_b32 s34, 28672
  s_mov_b32 s35, 0x20000
  s_lshl_b32 s56, s2, 13
  s_add_u32 s68, s70, s56
  s_addc_u32 s69, s71, 0
  s_lshl_b32 s56, s40, 13
  v_and_b32 v190, 15, v0
  v_lshlrev_b32 v190, 7, v190
  v_add_u32 v190, s56, v190
  s_lshl_b32 s56, s40, 11
  v_and_b32 v15, 15, v0
  v_lshlrev_b32 v15, 7, v15
  v_add_u32 v15, s56, v15
  s_cmp_eq_u32 s40, 0
  s_cbranch_scc0 poll_3_done
  s_lshl_b32 s56, s43, 5
  s_add_u32 s56, s56, 0
  s_lshl_b32 s56, s56, 7
  s_add_u32 s56, s56, 4096
  v_and_b32 v18, 31, v0
  v_lshlrev_b32 v18, 7, v18
  s_mov_b32 s57, 0
  buffer_load_dwordx2 v[160:161], v18, s[72:75], s56 offen sc1
poll_3:
  buffer_load_dwordx2 v[162:163], v18, s[72:75], s56 offen sc1
  s_add_u32 s57, s57, 1
  s_waitcnt vmcnt(1)
  v_cmp_eq_u32 vcc, s76, v160
  v_cmp_eq_u32 s[58:59], s77, v161
  s_nop 1
  s_and_b64 vcc, vcc, s[58:59]
  s_cmp_eq_u64 vcc, exec
  s_cbranch_scc1 poll_3_ok
  buffer_load_dwordx2 v[160:161], v18, s[72:75], s56 offen sc1
  s_add_u32 s57, s57, 1
  s_waitcnt vmcnt(1)
  v_cmp_eq_u32 vcc, s76, v162
  v_cmp_eq_u32 s[58:59], s77, v163
  s_nop 1
  s_and_b64 vcc, vcc, s[58:59]
  s_cmp_eq_u64 vcc, exec
  s_cbranch_scc1 poll_3_ok
  s_cmp_lt_u32 s57, 0x80000
  s_cbranch_scc1 poll_3
poll_3_ok:
poll_3_done:
  s_barrier
  s_add_u32 m0, s52, 0
  s_nop 0
  buffer_load_dwordx4 v188, s[12:15], s45 offen offset:0 sc1 lds
  buffer_load_dwordx4 v188, s[12:15], s45 offen offset:1024 sc1 lds
  buffer_load_dwordx4 v188, s[12:15], s45 offen offset:2048 sc1 lds
  buffer_load_dwordx4 v188, s[12:15], s45 offen offset:3072 sc1 lds
  s_add_u32 s45, s45, 16384
  s_add_u32 m0, s52, 16384
  s_nop 0
  buffer_load_dwordx4 v188, s[12:15], s45 offen offset:0 sc1 lds
  buffer_load_dwordx4 v188, s[12:15], s45 offen offset:1024 sc1 lds
  buffer_load_dwordx4 v188, s[12:15], s45 offen offset:2048 sc1 lds
  buffer_load_dwordx4 v188, s[12:15], s45 offen offset:3072 sc1 lds
  s_add_u32 s45, s45, 16384
  s_add_u32 m0, s52, 32768
  s_nop 0
  buffer_load_dwordx4 v188, s[12:15], s45 offen offset:0 sc1 lds
  buffer_load_dwordx4 v188, s[12:15], s45 offen offset:1024 sc1 lds
  buffer_load_dwordx4 v188, s[12:15], s45 offen offset:2048 sc1 lds
  buffer_load_dwordx4 v188, s[12:15], s45 offen offset:3072 sc1 lds
  s_add_u32 s45, s45, 16384
  s_add_u32 m0, s52, 49152
  s_nop 0
  buffer_load_dwordx4 v188, s[12:15], s45 offen offset:0 sc1 lds
  buffer_load_dwordx4 v188, s[12:15], s45 offen offset:1024 sc1 lds
  buffer_load_dwordx4 v188, s[12:15], s45 offen offset:2048 sc1 lds
  buffer_load_dwordx4 v188, s[12:15], s45 offen offset:3072 sc1 lds
  s_add_u32 s45, s45, 16384
  s_cmp_eq_u32 s3, 1
  s_cbranch_scc1 fz_g_path
  s_waitcnt vmcnt(12)
  s_barrier
  ds_read_b128 v[16:19], v6 offset:0
  ds_read_b128 v[20:23], v6 offset:1024
  ds_read_b128 v[24:27], v6 offset:2048
  ds_read_b128 v[28:31], v6 offset:3072
  ds_read_b128 v[32:35], v6 offset:4096
  ds_read_b128 v[36:39], v6 offset:5120
  ds_read_b128 v[40:43], v6 offset:6144
  ds_read_b128 v[44:47], v6 offset:7168
  ds_read_b64_tr_b16 v[80:81], v7 offset:0
  ds_read_b64_tr_b16 v[82:83], v7 offset:2048
  ds_read_b64_tr_b16 v[84:85], v8 offset:0
  ds_read_b64_tr_b16 v[86:87], v8 offset:2048
  ds_read_b64_tr_b16 v[88:89], v7 offset:4096
  ds_read_b64_tr_b16 v[90:91], v7 offset:6144
  ds_read_b64_tr_b16 v[92:93], v8 offset:4096
  ds_read_b64_tr_b16 v[94:95], v8 offset:6144
  ds_read_b64_tr_b16 v[96:97], v7 offset:8192
  ds_read_b64_tr_b16 v[98:99], v7 offset:10240
  ds_read_b64_tr_b16 v[100:101], v8 offset:8192
  ds_read_b64_tr_b16 v[102:103], v8 offset:10240
  ds_read_b64_tr_b16 v[104:105], v7 offset:12288
  ds_read_b64_tr_b16 v[106:107], v7 offset:14336
  ds_read_b64_tr_b16 v[108:109], v8 offset:12288
  ds_read_b64_tr_b16 v[110:111], v8 offset:14336
  ds_read_b64_tr_b16 v[112:113], v9 offset:0
  ds_read_b64_tr_b16 v[114:115], v9 offset:2048
  ds_read_b64_tr_b16 v[116:117], v10 offset:0
  ds_read_b64_tr_b16 v[118:119], v10 offset:2048
  s_waitcnt vmcnt(8) lgkmcnt(0)
  s_barrier
  v_mfma_f32_16x16x32_bf16 a[0:3], v[80:83], v[16:19], 0
  ds_read_b128 v[48:51], v6 offset:16384
  s_add_u32 m0, s52, 0
  v_mfma_f32_16x16x32_bf16 a[4:7], v[80:83], v[20:23], 0
  s_mov_b32 s70, 0
  v_mfma_f32_16x16x32_bf16 a[8:11], v[80:83], v[24:27], 0
  ds_read_b64_tr_b16 v[120:121], v7 offset:16384
  v_mfma_f32_16x16x32_bf16 a[12:15], v[80:83], v[28:31], 0
  v_mfma_f32_16x16x32_bf16 a[16:19], v[80:83], v[32:35], 0
  buffer_load_dwordx4 v188, s[12:15], s45 offen offset:0 sc1 lds
  v_mfma_f32_16x16x32_bf16 a[20:23], v[80:83], v[36:39], 0
  ds_read_b64_tr_b16 v[122:123], v7 offset:18432
  v_mfma_f32_16x16x32_bf16 a[24:27], v[80:83], v[40:43], 0
  v_mfma_f32_16x16x32_bf16 a[28:31], v[80:83], v[44:47], 0
  ds_read_b128 v[52:55], v6 offset:17408
  v_mfma_f32_16x16x32_bf16 a[32:35], v[84:87], v[16:19], 0
  buffer_load_dwordx4 v188, s[12:15], s45 offen offset:1024 sc1 lds
  v_mfma_f32_16x16x32_bf16 a[36:39], v[84:87], v[20:23], 0
  v_mfma_f32_16x16x32_bf16 a[40:43], v[84:87], v[24:27], 0
  ds_read_b64_tr_b16 v[124:125], v8 offset:16384
  v_mfma_f32_16x16x32_bf16 a[44:47], v[84:87], v[28:31], 0
  v_mfma_f32_16x16x32_bf16 a[48:51], v[84:87], v[32:35], 0
  ds_read_b64_tr_b16 v[126:127], v8 offset:18432
  v_mfma_f32_16x16x32_bf16 a[52:55], v[84:87], v[36:39], 0
  buffer_load_dwordx4 v188, s[12:15], s45 offen offset:2048 sc1 lds
  v_mfma_f32_16x16x32_bf16 a[56:59], v[84:87], v[40:43], 0
  v_mfma_f32_16x16x32_bf16 a[60:63], v[84:87], v[44:47], 0
  ds_read_b64_tr_b16 v[128:129], v7 offset:20480
  v_mfma_f32_16x16x32_bf16 a[64:67], v[16:19], v[88:91], 0
  buffer_load_dwordx4 v188, s[12:15], s45 offen offset:3072 sc1 lds
  v_mfma_f32_16x16x32_bf16 a[68:71], v[20:23], v[88:91], 0
  v_mfma_f32_16x16x32_bf16 a[72:75], v[24:27], v[88:91], 0
  ds_read_b128 v[56:59], v6 offset:18432
  v_mfma_f32_16x16x32_bf16 a[76:79], v[28:31], v[88:91], 0
  v_mfma_f32_16x16x32_bf16 a[80:83], v[32:35], v[88:91], 0
  ds_read_b64_tr_b16 v[130:131], v7 offset:22528
  s_add_u32 s45, s45, 16384
  v_mfma_f32_16x16x32_bf16 a[84:87], v[36:39], v[88:91], 0
  v_mfma_f32_16x16x32_bf16 a[88:91], v[40:43], v[88:91], 0
  v_mfma_f32_16x16x32_bf16 a[92:95], v[44:47], v[88:91], 0
  ds_read_b64_tr_b16 v[132:133], v8 offset:20480
  v_mfma_f32_16x16x32_bf16 a[96:99], v[16:19], v[92:95], 0
  s_add_u32 m0, s53, 0
  v_mfma_f32_16x16x32_bf16 a[100:103], v[20:23], v[92:95], 0
  ds_read_b128 v[60:63], v6 offset:19456
  v_mfma_f32_16x16x32_bf16 a[104:107], v[24:27], v[92:95], 0
  v_mfma_f32_16x16x32_bf16 a[108:111], v[28:31], v[92:95], 0
  v_mfma_f32_16x16x32_bf16 a[112:115], v[32:35], v[92:95], 0
  ds_read_b64_tr_b16 v[134:135], v8 offset:22528
  v_mfma_f32_16x16x32_bf16 a[116:119], v[36:39], v[92:95], 0
  buffer_load_dwordx4 v2, s[16:19], s46 offen lds
  v_mfma_f32_16x16x32_bf16 a[120:123], v[40:43], v[92:95], 0
  ds_read_b64_tr_b16 v[136:137], v7 offset:24576
  v_mfma_f32_16x16x32_bf16 a[124:127], v[44:47], v[92:95], 0
  v_mfma_f32_16x16x32_bf16 a[128:131], v[96:99], v[16:19], 0
  s_add_u32 m0, s53, 4096
  v_mfma_f32_16x16x32_bf16 a[132:135], v[96:99], v[20:23], 0
  ds_read_b64_tr_b16 v[138:139], v7 offset:26624
  v_mfma_f32_16x16x32_bf16 a[136:139], v[96:99], v[24:27], 0
  v_mfma_f32_16x16x32_bf16 a[140:143], v[96:99], v[28:31], 0
  v_mfma_f32_16x16x32_bf16 a[144:147], v[96:99], v[32:35], 0
  ds_read_b128 v[64:67], v6 offset:20480
  v_mfma_f32_16x16x32_bf16 a[148:151], v[96:99], v[36:39], 0
  buffer_load_dwordx4 v2, s[20:23], s46 offen lds
  v_mfma_f32_16x16x32_bf16 a[152:155], v[96:99], v[40:43], 0
  ds_read_b64_tr_b16 v[140:141], v8 offset:24576
  v_mfma_f32_16x16x32_bf16 a[156:159], v[96:99], v[44:47], 0
  v_mfma_f32_16x16x32_bf16 a[160:163], v[100:103], v[16:19], 0
  buffer_load_dword v191, v187, s[36:39], s70 offen
  v_mfma_f32_16x16x32_bf16 a[164:167], v[100:103], v[20:23], 0
  ds_read_b64_tr_b16 v[142:143], v8 offset:26624
  s_add_u32 m0, s53, 8192
  v_mfma_f32_16x16x32_bf16 a[168:171], v[100:103], v[24:27], 0
  v_mfma_f32_16x16x32_bf16 a[172:175], v[100:103], v[28:31], 0
  ds_read_b128 v[68:71], v6 offset:21504
  v_mfma_f32_16x16x32_bf16 a[176:179], v[100:103], v[32:35], 0
  v_mfma_f32_16x16x32_bf16 a[180:183], v[100:103], v[36:39], 0
  buffer_load_dwordx4 v3, s[24:27], s47 offen lds
  v_mfma_f32_16x16x32_bf16 a[184:187], v[100:103], v[40:43], 0
  ds_read_b64_tr_b16 v[144:145], v7 offset:28672
  v_mfma_f32_16x16x32_bf16 a[188:191], v[100:103], v[44:47], 0
  v_mfma_f32_16x16x32_bf16 a[192:195], v[104:107], v[16:19], 0
  ds_read_b64_tr_b16 v[146:147], v7 offset:30720
  v_mfma_f32_16x16x32_bf16 a[196:199], v[104:107], v[20:23], 0
  s_add_u32 m0, s53, 12288
  v_mfma_f32_16x16x32_bf16 a[200:203], v[104:107], v[24:27], 0
  v_mfma_f32_16x16x32_bf16 a[204:207], v[104:107], v[28:31], 0
  ds_read_b64_tr_b16 v[148:149], v8 offset:28672
  v_mfma_f32_16x16x32_bf16 a[208:211], v[104:107], v[32:35], 0
  v_mfma_f32_16x16x32_bf16 a[212:215], v[104:107], v[36:39], 0
  buffer_load_dwordx4 v3, s[28:31], s47 offen lds
  v_mfma_f32_16x16x32_bf16 a[216:219], v[104:107], v[40:43], 0
  ds_read_b128 v[72:75], v6 offset:22528
  v_mfma_f32_16x16x32_bf16 a[220:223], v[104:107], v[44:47], 0
  v_mfma_f32_16x16x32_bf16 a[224:227], v[108:111], v[16:19], 0
  ds_read_b64_tr_b16 v[150:151], v8 offset:30720
  v_mfma_f32_16x16x32_bf16 a[228:231], v[108:111], v[20:23], 0
  s_add_u32 m0, s54, 0
  v_mfma_f32_16x16x32_bf16 a[232:235], v[108:111], v[24:27], 0
  v_mfma_f32_16x16x32_bf16 a[236:239], v[108:111], v[28:31], 0
  ds_read_b64_tr_b16 v[152:153], v9 offset:4096
  v_mfma_f32_16x16x32_bf16 a[240:243], v[108:111], v[32:35], 0
  v_mfma_f32_16x16x32_bf16 a[244:247], v[108:111], v[36:39], 0
  ds_read_b128 v[76:79], v6 offset:23552
  v_mfma_f32_16x16x32_bf16 a[248:251], v[108:111], v[40:43], 0
  global_load_lds_dwordx4 v[4:5], off
  v_mfma_f32_16x16x32_bf16 a[252:255], v[108:111], v[44:47], 0
  v_mfma_f32_16x16x32_bf16 v[192:195], v[112:115], v[16:19], 0
  ds_read_b64_tr_b16 v[154:155], v9 offset:6144
  v_mfma_f32_16x16x32_bf16 v[196:199], v[112:115], v[20:23], 0
  s_add_u32 s46, s46, s48
  v_mfma_f32_16x16x32_bf16 v[200:203], v[112:115], v[24:27], 0
  ds_read_b64_tr_b16 v[156:157], v10 offset:4096
  v_mfma_f32_16x16x32_bf16 v[204:207], v[112:115], v[28:31], 0
  v_mfma_f32_16x16x32_bf16 v[208:211], v[112:115], v[32:35], 0
  v_mfma_f32_16x16x32_bf16 v[212:215], v[112:115], v[36:39], 0
  ds_read_b64_tr_b16 v[158:159], v10 offset:6144
  s_add_u32 s47, s47, s49
  v_mfma_f32_16x16x32_bf16 v[216:219], v[112:115], v[40:43], 0
  v_mfma_f32_16x16x32_bf16 v[220:223], v[112:115], v[44:47], 0
  v_mfma_f32_16x16x32_bf16 v[224:227], v[116:119], v[16:19], 0
  v_mfma_f32_16x16x32_bf16 v[228:231], v[116:119], v[20:23], 0
  v_lshl_add_u64 v[4:5], s[50:51], 0, v[4:5]
  v_mfma_f32_16x16x32_bf16 v[232:235], v[116:119], v[24:27], 0
  v_mfma_f32_16x16x32_bf16 v[236:239], v[116:119], v[28:31], 0
  v_mfma_f32_16x16x32_bf16 v[240:243], v[116:119], v[32:35], 0
  v_mfma_f32_16x16x32_bf16 v[244:247], v[116:119], v[36:39], 0
  v_mfma_f32_16x16x32_bf16 v[248:251], v[116:119], v[40:43], 0
  v_mfma_f32_16x16x32_bf16 v[252:255], v[116:119], v[44:47], 0
  s_waitcnt vmcnt(14) lgkmcnt(0)
  s_barrier
  v_mfma_f32_16x16x32_bf16 a[0:3], v[120:123], v[48:51], a[0:3]
  ds_read_b128 v[16:19], v6 offset:32768
  s_add_u32 m0, s52, 16384
  v_mfma_f32_16x16x32_bf16 a[4:7], v[120:123], v[52:55], a[4:7]
  s_mov_b32 s70, 2048
  v_mfma_f32_16x16x32_bf16 a[8:11], v[120:123], v[56:59], a[8:11]
  ds_read_b64_tr_b16 v[80:81], v7 offset:32768
  v_mfma_f32_16x16x32_bf16 a[12:15], v[120:123], v[60:63], a[12:15]
  v_mfma_f32_16x16x32_bf16 a[16:19], v[120:123], v[64:67], a[16:19]
  buffer_load_dwordx4 v188, s[12:15], s45 offen offset:0 sc1 lds
  v_mfma_f32_16x16x32_bf16 a[20:23], v[120:123], v[68:71], a[20:23]
  ds_read_b64_tr_b16 v[82:83], v7 offset:34816
  v_mfma_f32_16x16x32_bf16 a[24:27], v[120:123], v[72:75], a[24:27]
  v_mfma_f32_16x16x32_bf16 a[28:31], v[120:123], v[76:79], a[28:31]
  ds_read_b128 v[20:23], v6 offset:33792
  v_mfma_f32_16x16x32_bf16 a[32:35], v[124:127], v[48:51], a[32:35]
  buffer_load_dwordx4 v188, s[12:15], s45 offen offset:1024 sc1 lds
  v_mfma_f32_16x16x32_bf16 a[36:39], v[124:127], v[52:55], a[36:39]
  v_mfma_f32_16x16x32_bf16 a[40:43], v[124:127], v[56:59], a[40:43]
  ds_read_b64_tr_b16 v[84:85], v8 offset:32768
  v_mfma_f32_16x16x32_bf16 a[44:47], v[124:127], v[60:63], a[44:47]
  v_mfma_f32_16x16x32_bf16 a[48:51], v[124:127], v[64:67], a[48:51]
  ds_read_b64_tr_b16 v[86:87], v8 offset:34816
  v_mfma_f32_16x16x32_bf16 a[52:55], v[124:127], v[68:71], a[52:55]
  buffer_load_dwordx4 v188, s[12:15], s45 offen offset:2048 sc1 lds
  v_mfma_f32_16x16x32_bf16 a[56:59], v[124:127], v[72:75], a[56:59]
  v_mfma_f32_16x16x32_bf16 a[60:63], v[124:127], v[76:79], a[60:63]
  ds_read_b64_tr_b16 v[88:89], v7 offset:36864
  v_mfma_f32_16x16x32_bf16 a[64:67], v[48:51], v[128:131], a[64:67]
  buffer_load_dwordx4 v188, s[12:15], s45 offen offset:3072 sc1 lds
  v_mfma_f32_16x16x32_bf16 a[68:71], v[52:55], v[128:131], a[68:71]
  v_mfma_f32_16x16x32_bf16 a[72:75], v[56:59], v[128:131], a[72:75]
  ds_read_b128 v[24:27], v6 offset:34816
  v_mfma_f32_16x16x32_bf16 a[76:79], v[60:63], v[128:131], a[76:79]
  v_mfma_f32_16x16x32_bf16 a[80:83], v[64:67], v[128:131], a[80:83]
  ds_read_b64_tr_b16 v[90:91], v7 offset:38912
  s_add_u32 s45, s45, 16384
  v_mfma_f32_16x16x32_bf16 a[84:87], v[68:71], v[128:131], a[84:87]
  v_mfma_f32_16x16x32_bf16 a[88:91], v[72:75], v[128:131], a[88:91]
  v_mfma_f32_16x16x32_bf16 a[92:95], v[76:79], v[128:131], a[92:95]
  ds_read_b64_tr_b16 v[92:93], v8 offset:36864
  v_mfma_f32_16x16x32_bf16 a[96:99], v[48:51], v[132:135], a[96:99]
  s_add_u32 m0, s53, 16384
  v_mfma_f32_16x16x32_bf16 a[100:103], v[52:55], v[132:135], a[100:103]
  ds_read_b128 v[28:31], v6 offset:35840
  v_mfma_f32_16x16x32_bf16 a[104:107], v[56:59], v[132:135], a[104:107]
  v_mfma_f32_16x16x32_bf16 a[108:111], v[60:63], v[132:135], a[108:111]
  v_mfma_f32_16x16x32_bf16 a[112:115], v[64:67], v[132:135], a[112:115]
  ds_read_b64_tr_b16 v[94:95], v8 offset:38912
  v_mfma_f32_16x16x32_bf16 a[116:119], v[68:71], v[132:135], a[116:119]
  buffer_load_dwordx4 v2, s[16:19], s46 offen lds
  v_mfma_f32_16x16x32_bf16 a[120:123], v[72:75], v[132:135], a[120:123]
  ds_read_b64_tr_b16 v[96:97], v7 offset:40960
  v_mfma_f32_16x16x32_bf16 a[124:127], v[76:79], v[132:135], a[124:127]
  v_mfma_f32_16x16x32_bf16 a[128:131], v[136:139], v[48:51], a[128:131]
  s_add_u32 m0, s53, 20480
  v_mfma_f32_16x16x32_bf16 a[132:135], v[136:139], v[52:55], a[132:135]
  ds_read_b64_tr_b16 v[98:99], v7 offset:43008
  v_mfma_f32_16x16x32_bf16 a[136:139], v[136:139], v[56:59], a[136:139]
  v_mfma_f32_16x16x32_bf16 a[140:143], v[136:139], v[60:63], a[140:143]
  v_mfma_f32_16x16x32_bf16 a[144:147], v[136:139], v[64:67], a[144:147]
  ds_read_b128 v[32:35], v6 offset:36864
  v_mfma_f32_16x16x32_bf16 a[148:151], v[136:139], v[68:71], a[148:151]
  buffer_load_dwordx4 v2, s[20:23], s46 offen lds
  v_mfma_f32_16x16x32_bf16 a[152:155], v[136:139], v[72:75], a[152:155]
  ds_read_b64_tr_b16 v[100:101], v8 offset:40960
  v_mfma_f32_16x16x32_bf16 a[156:159], v[136:139], v[76:79], a[156:159]
  v_mfma_f32_16x16x32_bf16 a[160:163], v[140:143], v[48:51], a[160:163]
  buffer_load_dword v191, v187, s[36:39], s70 offen
  v_mfma_f32_16x16x32_bf16 a[164:167], v[140:143], v[52:55], a[164:167]
  ds_read_b64_tr_b16 v[102:103], v8 offset:43008
  s_add_u32 m0, s53, 24576
  v_mfma_f32_16x16x32_bf16 a[168:171], v[140:143], v[56:59], a[168:171]
  v_mfma_f32_16x16x32_bf16 a[172:175], v[140:143], v[60:63], a[172:175]
  ds_read_b128 v[36:39], v6 offset:37888
  v_mfma_f32_16x16x32_bf16 a[176:179], v[140:143], v[64:67], a[176:179]
  v_mfma_f32_16x16x32_bf16 a[180:183], v[140:143], v[68:71], a[180:183]
  buffer_load_dwordx4 v3, s[24:27], s47 offen lds
  v_mfma_f32_16x16x32_bf16 a[184:187], v[140:143], v[72:75], a[184:187]
  ds_read_b64_tr_b16 v[104:105], v7 offset:45056
  v_mfma_f32_16x16x32_bf16 a[188:191], v[140:143], v[76:79], a[188:191]
  v_mfma_f32_16x16x32_bf16 a[192:195], v[144:147], v[48:51], a[192:195]
  ds_read_b64_tr_b16 v[106:107], v7 offset:47104
  v_mfma_f32_16x16x32_bf16 a[196:199], v[144:147], v[52:55], a[196:199]
  s_add_u32 m0, s53, 28672
  v_mfma_f32_16x16x32_bf16 a[200:203], v[144:147], v[56:59], a[200:203]
  v_mfma_f32_16x16x32_bf16 a[204:207], v[144:147], v[60:63], a[204:207]
  ds_read_b64_tr_b16 v[108:109], v8 offset:45056
  v_mfma_f32_16x16x32_bf16 a[208:211], v[144:147], v[64:67], a[208:211]
  v_mfma_f32_16x16x32_bf16 a[212:215], v[144:147], v[68:71], a[212:215]
  buffer_load_dwordx4 v3, s[28:31], s47 offen lds
  v_mfma_f32_16x16x32_bf16 a[216:219], v[144:147], v[72:75], a[216:219]
  ds_read_b128 v[40:43], v6 offset:38912
  v_mfma_f32_16x16x32_bf16 a[220:223], v[144:147], v[76:79], a[220:223]
  v_mfma_f32_16x16x32_bf16 a[224:227], v[148:151], v[48:51], a[224:227]
  ds_read_b64_tr_b16 v[110:111], v8 offset:47104
  v_mfma_f32_16x16x32_bf16 a[228:231], v[148:151], v[52:55], a[228:231]
  s_add_u32 m0, s54, 4096
  v_mfma_f32_16x16x32_bf16 a[232:235], v[148:151], v[56:59], a[232:235]
  v_mfma_f32_16x16x32_bf16 a[236:239], v[148:151], v[60:63], a[236:239]
  ds_read_b64_tr_b16 v[112:113], v9 offset:8192
  v_mfma_f32_16x16x32_bf16 a[240:243], v[148:151], v[64:67], a[240:243]
  v_mfma_f32_16x16x32_bf16 a[244:247], v[148:151], v[68:71], a[244:247]
  ds_read_b128 v[44:47], v6 offset:39936
  v_mfma_f32_16x16x32_bf16 a[248:251], v[148:151], v[72:75], a[248:251]
  global_load_lds_dwordx4 v[4:5], off
  v_mfma_f32_16x16x32_bf16 a[252:255], v[148:151], v[76:79], a[252:255]
  v_mfma_f32_16x16x32_bf16 v[192:195], v[152:155], v[48:51], v[192:195]
  ds_read_b64_tr_b16 v[114:115], v9 offset:10240
  v_mfma_f32_16x16x32_bf16 v[196:199], v[152:155], v[52:55], v[196:199]
  s_add_u32 s46, s46, s48
  v_mfma_f32_16x16x32_bf16 v[200:203], v[152:155], v[56:59], v[200:203]
  ds_read_b64_tr_b16 v[116:117], v10 offset:8192
  v_mfma_f32_16x16x32_bf16 v[204:207], v[152:155], v[60:63], v[204:207]
  v_mfma_f32_16x16x32_bf16 v[208:211], v[152:155], v[64:67], v[208:211]
  v_mfma_f32_16x16x32_bf16 v[212:215], v[152:155], v[68:71], v[212:215]
  ds_read_b64_tr_b16 v[118:119], v10 offset:10240
  s_add_u32 s47, s47, s49
  v_mfma_f32_16x16x32_bf16 v[216:219], v[152:155], v[72:75], v[216:219]
  v_mfma_f32_16x16x32_bf16 v[220:223], v[152:155], v[76:79], v[220:223]
  v_mfma_f32_16x16x32_bf16 v[224:227], v[156:159], v[48:51], v[224:227]
  v_mfma_f32_16x16x32_bf16 v[228:231], v[156:159], v[52:55], v[228:231]
  v_lshl_add_u64 v[4:5], s[50:51], 0, v[4:5]
  v_mfma_f32_16x16x32_bf16 v[232:235], v[156:159], v[56:59], v[232:235]
  v_mfma_f32_16x16x32_bf16 v[236:239], v[156:159], v[60:63], v[236:239]
  v_mfma_f32_16x16x32_bf16 v[240:243], v[156:159], v[64:67], v[240:243]
  v_mfma_f32_16x16x32_bf16 v[244:247], v[156:159], v[68:71], v[244:247]
  v_mfma_f32_16x16x32_bf16 v[248:251], v[156:159], v[72:75], v[248:251]
  v_mfma_f32_16x16x32_bf16 v[252:255], v[156:159], v[76:79], v[252:255]
  s_waitcnt vmcnt(20) lgkmcnt(0)
  s_barrier
  v_mfma_f32_16x16x32_bf16 a[0:3], v[80:83], v[16:19], a[0:3]
  ds_read_b128 v[48:51], v6 offset:49152
  s_add_u32 m0, s52, 32768
  v_mfma_f32_16x16x32_bf16 a[4:7], v[80:83], v[20:23], a[4:7]
  s_mov_b32 s70, 4096
  v_mfma_f32_16x16x32_bf16 a[8:11], v[80:83], v[24:27], a[8:11]
  ds_read_b64_tr_b16 v[120:121], v7 offset:49152
  v_mfma_f32_16x16x32_bf16 a[12:15], v[80:83], v[28:31], a[12:15]
  v_mfma_f32_16x16x32_bf16 a[16:19], v[80:83], v[32:35], a[16:19]
  buffer_load_dwordx4 v188, s[12:15], s45 offen offset:0 sc1 lds
  v_mfma_f32_16x16x32_bf16 a[20:23], v[80:83], v[36:39], a[20:23]
  ds_read_b64_tr_b16 v[122:123], v7 offset:51200
  v_mfma_f32_16x16x32_bf16 a[24:27], v[80:83], v[40:43], a[24:27]
  v_mfma_f32_16x16x32_bf16 a[28:31], v[80:83], v[44:47], a[28:31]
  ds_read_b128 v[52:55], v6 offset:50176
  v_mfma_f32_16x16x32_bf16 a[32:35], v[84:87], v[16:19], a[32:35]
  buffer_load_dwordx4 v188, s[12:15], s45 offen offset:1024 sc1 lds
  v_mfma_f32_16x16x32_bf16 a[36:39], v[84:87], v[20:23], a[36:39]
  v_mfma_f32_16x16x32_bf16 a[40:43], v[84:87], v[24:27], a[40:43]
  ds_read_b64_tr_b16 v[124:125], v8 offset:49152
  v_mfma_f32_16x16x32_bf16 a[44:47], v[84:87], v[28:31], a[44:47]
  v_mfma_f32_16x16x32_bf16 a[48:51], v[84:87], v[32:35], a[48:51]
  ds_read_b64_tr_b16 v[126:127], v8 offset:51200
  v_mfma_f32_16x16x32_bf16 a[52:55], v[84:87], v[36:39], a[52:55]
  buffer_load_dwordx4 v188, s[12:15], s45 offen offset:2048 sc1 lds
  v_mfma_f32_16x16x32_bf16 a[56:59], v[84:87], v[40:43], a[56:59]
  v_mfma_f32_16x16x32_bf16 a[60:63], v[84:87], v[44:47], a[60:63]
  ds_read_b64_tr_b16 v[128:129], v7 offset:53248
  v_mfma_f32_16x16x32_bf16 a[64:67], v[16:19], v[88:91], a[64:67]
  buffer_load_dwordx4 v188, s[12:15], s45 offen offset:3072 sc1 lds
  v_mfma_f32_16x16x32_bf16 a[68:71], v[20:23], v[88:91], a[68:71]
  v_mfma_f32_16x16x32_bf16 a[72:75], v[24:27], v[88:91], a[72:75]
  ds_read_b128 v[56:59], v6 offset:51200
  v_mfma_f32_16x16x32_bf16 a[76:79], v[28:31], v[88:91], a[76:79]
  v_mfma_f32_16x16x32_bf16 a[80:83], v[32:35], v[88:91], a[80:83]
  ds_read_b64_tr_b16 v[130:131], v7 offset:55296
  s_add_u32 s45, s45, 16384
  v_mfma_f32_16x16x32_bf16 a[84:87], v[36:39], v[88:91], a[84:87]
  v_mfma_f32_16x16x32_bf16 a[88:91], v[40:43], v[88:91], a[88:91]
  v_mfma_f32_16x16x32_bf16 a[92:95], v[44:47], v[88:91], a[92:95]
  ds_read_b64_tr_b16 v[132:133], v8 offset:53248
  v_mfma_f32_16x16x32_bf16 a[96:99], v[16:19], v[92:95], a[96:99]
  s_add_u32 m0, s53, 32768
  v_mfma_f32_16x16x32_bf16 a[100:103], v[20:23], v[92:95], a[100:103]
  ds_read_b128 v[60:63], v6 offset:52224
  v_mfma_f32_16x16x32_bf16 a[104:107], v[24:27], v[92:95], a[104:107]
  v_mfma_f32_16x16x32_bf16 a[108:111], v[28:31], v[92:95], a[108:111]
  v_mfma_f32_16x16x32_bf16 a[112:115], v[32:35], v[92:95], a[112:115]
  ds_read_b64_tr_b16 v[134:135], v8 offset:55296
  v_mfma_f32_16x16x32_bf16 a[116:119], v[36:39], v[92:95], a[116:119]
  buffer_load_dwordx4 v2, s[16:19], s46 offen lds
  v_mfma_f32_16x16x32_bf16 a[120:123], v[40:43], v[92:95], a[120:123]
  ds_read_b64_tr_b16 v[136:137], v7 offset:57344
  v_mfma_f32_16x16x32_bf16 a[124:127], v[44:47], v[92:95], a[124:127]
  v_mfma_f32_16x16x32_bf16 a[128:131], v[96:99], v[16:19], a[128:131]
  s_add_u32 m0, s53, 36864
  v_mfma_f32_16x16x32_bf16 a[132:135], v[96:99], v[20:23], a[132:135]
  ds_read_b64_tr_b16 v[138:139], v7 offset:59392
  v_mfma_f32_16x16x32_bf16 a[136:139], v[96:99], v[24:27], a[136:139]
  v_mfma_f32_16x16x32_bf16 a[140:143], v[96:99], v[28:31], a[140:143]
  v_mfma_f32_16x16x32_bf16 a[144:147], v[96:99], v[32:35], a[144:147]
  ds_read_b128 v[64:67], v6 offset:53248
  v_mfma_f32_16x16x32_bf16 a[148:151], v[96:99], v[36:39], a[148:151]
  buffer_load_dwordx4 v2, s[20:23], s46 offen lds
  v_mfma_f32_16x16x32_bf16 a[152:155], v[96:99], v[40:43], a[152:155]
  ds_read_b64_tr_b16 v[140:141], v8 offset:57344
  v_mfma_f32_16x16x32_bf16 a[156:159], v[96:99], v[44:47], a[156:159]
  v_mfma_f32_16x16x32_bf16 a[160:163], v[100:103], v[16:19], a[160:163]
  buffer_load_dword v191, v187, s[36:39], s70 offen
  v_mfma_f32_16x16x32_bf16 a[164:167], v[100:103], v[20:23], a[164:167]
  ds_read_b64_tr_b16 v[142:143], v8 offset:59392
  s_add_u32 m0, s53, 40960
  v_mfma_f32_16x16x32_bf16 a[168:171], v[100:103], v[24:27], a[168:171]
  v_mfma_f32_16x16x32_bf16 a[172:175], v[100:103], v[28:31], a[172:175]
  ds_read_b128 v[68:71], v6 offset:54272
  v_mfma_f32_16x16x32_bf16 a[176:179], v[100:103], v[32:35], a[176:179]
  v_mfma_f32_16x16x32_bf16 a[180:183], v[100:103], v[36:39], a[180:183]
  buffer_load_dwordx4 v3, s[24:27], s47 offen lds
  v_mfma_f32_16x16x32_bf16 a[184:187], v[100:103], v[40:43], a[184:187]
  ds_read_b64_tr_b16 v[144:145], v7 offset:61440
  v_mfma_f32_16x16x32_bf16 a[188:191], v[100:103], v[44:47], a[188:191]
  v_mfma_f32_16x16x32_bf16 a[192:195], v[104:107], v[16:19], a[192:195]
  ds_read_b64_tr_b16 v[146:147], v7 offset:63488
  v_mfma_f32_16x16x32_bf16 a[196:199], v[104:107], v[20:23], a[196:199]
  s_add_u32 m0, s53, 45056
  v_mfma_f32_16x16x32_bf16 a[200:203], v[104:107], v[24:27], a[200:203]
  v_mfma_f32_16x16x32_bf16 a[204:207], v[104:107], v[28:31], a[204:207]
  ds_read_b64_tr_b16 v[148:149], v8 offset:61440
  v_mfma_f32_16x16x32_bf16 a[208:211], v[104:107], v[32:35], a[208:211]
  v_mfma_f32_16x16x32_bf16 a[212:215], v[104:107], v[36:39], a[212:215]
  buffer_load_dwordx4 v3, s[28:31], s47 offen lds
  v_mfma_f32_16x16x32_bf16 a[216:219], v[104:107], v[40:43], a[216:219]
  ds_read_b128 v[72:75], v6 offset:55296
  v_mfma_f32_16x16x32_bf16 a[220:223], v[104:107], v[44:47], a[220:223]
  v_mfma_f32_16x16x32_bf16 a[224:227], v[108:111], v[16:19], a[224:227]
  ds_read_b64_tr_b16 v[150:151], v8 offset:63488
  v_mfma_f32_16x16x32_bf16 a[228:231], v[108:111], v[20:23], a[228:231]
  s_add_u32 m0, s54, 8192
  v_mfma_f32_16x16x32_bf16 a[232:235], v[108:111], v[24:27], a[232:235]
  v_mfma_f32_16x16x32_bf16 a[236:239], v[108:111], v[28:31], a[236:239]
  ds_read_b64_tr_b16 v[152:153], v9 offset:12288
  v_mfma_f32_16x16x32_bf16 a[240:243], v[108:111], v[32:35], a[240:243]
  v_mfma_f32_16x16x32_bf16 a[244:247], v[108:111], v[36:39], a[244:247]
  ds_read_b128 v[76:79], v6 offset:56320
  v_mfma_f32_16x16x32_bf16 a[248:251], v[108:111], v[40:43], a[248:251]
  global_load_lds_dwordx4 v[4:5], off
  v_mfma_f32_16x16x32_bf16 a[252:255], v[108:111], v[44:47], a[252:255]
  v_mfma_f32_16x16x32_bf16 v[192:195], v[112:115], v[16:19], v[192:195]
  ds_read_b64_tr_b16 v[154:155], v9 offset:14336
  v_mfma_f32_16x16x32_bf16 v[196:199], v[112:115], v[20:23], v[196:199]
  s_add_u32 s46, s46, s48
  v_mfma_f32_16x16x32_bf16 v[200:203], v[112:115], v[24:27], v[200:203]
  ds_read_b64_tr_b16 v[156:157], v10 offset:12288
  v_mfma_f32_16x16x32_bf16 v[204:207], v[112:115], v[28:31], v[204:207]
  v_mfma_f32_16x16x32_bf16 v[208:211], v[112:115], v[32:35], v[208:211]
  v_mfma_f32_16x16x32_bf16 v[212:215], v[112:115], v[36:39], v[212:215]
  ds_read_b64_tr_b16 v[158:159], v10 offset:14336
  s_add_u32 s47, s47, s49
  v_mfma_f32_16x16x32_bf16 v[216:219], v[112:115], v[40:43], v[216:219]
  v_mfma_f32_16x16x32_bf16 v[220:223], v[112:115], v[44:47], v[220:223]
  v_mfma_f32_16x16x32_bf16 v[224:227], v[116:119], v[16:19], v[224:227]
  v_mfma_f32_16x16x32_bf16 v[228:231], v[116:119], v[20:23], v[228:231]
  v_lshl_add_u64 v[4:5], s[50:51], 0, v[4:5]
  v_mfma_f32_16x16x32_bf16 v[232:235], v[116:119], v[24:27], v[232:235]
  v_mfma_f32_16x16x32_bf16 v[236:239], v[116:119], v[28:31], v[236:239]
  v_mfma_f32_16x16x32_bf16 v[240:243], v[116:119], v[32:35], v[240:243]
  v_mfma_f32_16x16x32_bf16 v[244:247], v[116:119], v[36:39], v[244:247]
  v_mfma_f32_16x16x32_bf16 v[248:251], v[116:119], v[40:43], v[248:251]
  v_mfma_f32_16x16x32_bf16 v[252:255], v[116:119], v[44:47], v[252:255]
  s_waitcnt vmcnt(20) lgkmcnt(0)
  s_barrier
  v_mfma_f32_16x16x32_bf16 a[0:3], v[120:123], v[48:51], a[0:3]
  ds_read_b128 v[16:19], v6 offset:0
  s_add_u32 m0, s52, 49152
  v_mfma_f32_16x16x32_bf16 a[4:7], v[120:123], v[52:55], a[4:7]
  s_mov_b32 s70, 6144
  v_mfma_f32_16x16x32_bf16 a[8:11], v[120:123], v[56:59], a[8:11]
  ds_read_b64_tr_b16 v[80:81], v7 offset:0
  v_mfma_f32_16x16x32_bf16 a[12:15], v[120:123], v[60:63], a[12:15]
  v_mfma_f32_16x16x32_bf16 a[16:19], v[120:123], v[64:67], a[16:19]
  buffer_load_dwordx4 v188, s[12:15], s45 offen offset:0 sc1 lds
  v_mfma_f32_16x16x32_bf16 a[20:23], v[120:123], v[68:71], a[20:23]
  ds_read_b64_tr_b16 v[82:83], v7 offset:2048
  v_mfma_f32_16x16x32_bf16 a[24:27], v[120:123], v[72:75], a[24:27]
  v_mfma_f32_16x16x32_bf16 a[28:31], v[120:123], v[76:79], a[28:31]
  ds_read_b128 v[20:23], v6 offset:1024
  v_mfma_f32_16x16x32_bf16 a[32:35], v[124:127], v[48:51], a[32:35]
  buffer_load_dwordx4 v188, s[12:15], s45 offen offset:1024 sc1 lds
  v_mfma_f32_16x16x32_bf16 a[36:39], v[124:127], v[52:55], a[36:39]
  v_mfma_f32_16x16x32_bf16 a[40:43], v[124:127], v[56:59], a[40:43]
  ds_read_b64_tr_b16 v[84:85], v8 offset:0
  v_mfma_f32_16x16x32_bf16 a[44:47], v[124:127], v[60:63], a[44:47]
  v_mfma_f32_16x16x32_bf16 a[48:51], v[124:127], v[64:67], a[48:51]
  ds_read_b64_tr_b16 v[86:87], v8 offset:2048
  v_mfma_f32_16x16x32_bf16 a[52:55], v[124:127], v[68:71], a[52:55]
  buffer_load_dwordx4 v188, s[12:15], s45 offen offset:2048 sc1 lds
  v_mfma_f32_16x16x32_bf16 a[56:59], v[124:127], v[72:75], a[56:59]
  v_mfma_f32_16x16x32_bf16 a[60:63], v[124:127], v[76:79], a[60:63]
  ds_read_b64_tr_b16 v[88:89], v7 offset:4096
  v_mfma_f32_16x16x32_bf16 a[64:67], v[48:51], v[128:131], a[64:67]
  buffer_load_dwordx4 v188, s[12:15], s45 offen offset:3072 sc1 lds
  v_mfma_f32_16x16x32_bf16 a[68:71], v[52:55], v[128:131], a[68:71]
  v_mfma_f32_16x16x32_bf16 a[72:75], v[56:59], v[128:131], a[72:75]
  ds_read_b128 v[24:27], v6 offset:2048
  v_mfma_f32_16x16x32_bf16 a[76:79], v[60:63], v[128:131], a[76:79]
  v_mfma_f32_16x16x32_bf16 a[80:83], v[64:67], v[128:131], a[80:83]
  ds_read_b64_tr_b16 v[90:91], v7 offset:6144
  s_add_u32 s45, s45, 16384
  v_mfma_f32_16x16x32_bf16 a[84:87], v[68:71], v[128:131], a[84:87]
  v_mfma_f32_16x16x32_bf16 a[88:91], v[72:75], v[128:131], a[88:91]
  v_mfma_f32_16x16x32_bf16 a[92:95], v[76:79], v[128:131], a[92:95]
  ds_read_b64_tr_b16 v[92:93], v8 offset:4096
  v_mfma_f32_16x16x32_bf16 a[96:99], v[48:51], v[132:135], a[96:99]
  s_add_u32 m0, s53, 49152
  v_mfma_f32_16x16x32_bf16 a[100:103], v[52:55], v[132:135], a[100:103]
  ds_read_b128 v[28:31], v6 offset:3072
  v_mfma_f32_16x16x32_bf16 a[104:107], v[56:59], v[132:135], a[104:107]
  v_mfma_f32_16x16x32_bf16 a[108:111], v[60:63], v[132:135], a[108:111]
  v_mfma_f32_16x16x32_bf16 a[112:115], v[64:67], v[132:135], a[112:115]
  ds_read_b64_tr_b16 v[94:95], v8 offset:6144
  v_mfma_f32_16x16x32_bf16 a[116:119], v[68:71], v[132:135], a[116:119]
  buffer_load_dwordx4 v2, s[16:19], s46 offen lds
  v_mfma_f32_16x16x32_bf16 a[120:123], v[72:75], v[132:135], a[120:123]
  ds_read_b64_tr_b16 v[96:97], v7 offset:8192
  v_mfma_f32_16x16x32_bf16 a[124:127], v[76:79], v[132:135], a[124:127]
  v_mfma_f32_16x16x32_bf16 a[128:131], v[136:139], v[48:51], a[128:131]
  s_add_u32 m0, s53, 53248
  v_mfma_f32_16x16x32_bf16 a[132:135], v[136:139], v[52:55], a[132:135]
  ds_read_b64_tr_b16 v[98:99], v7 offset:10240
  v_mfma_f32_16x16x32_bf16 a[136:139], v[136:139], v[56:59], a[136:139]
  v_mfma_f32_16x16x32_bf16 a[140:143], v[136:139], v[60:63], a[140:143]
  v_mfma_f32_16x16x32_bf16 a[144:147], v[136:139], v[64:67], a[144:147]
  ds_read_b128 v[32:35], v6 offset:4096
  v_mfma_f32_16x16x32_bf16 a[148:151], v[136:139], v[68:71], a[148:151]
  buffer_load_dwordx4 v2, s[20:23], s46 offen lds
  v_mfma_f32_16x16x32_bf16 a[152:155], v[136:139], v[72:75], a[152:155]
  ds_read_b64_tr_b16 v[100:101], v8 offset:8192
  v_mfma_f32_16x16x32_bf16 a[156:159], v[136:139], v[76:79], a[156:159]
  v_mfma_f32_16x16x32_bf16 a[160:163], v[140:143], v[48:51], a[160:163]
  buffer_load_dword v191, v187, s[36:39], s70 offen
  v_mfma_f32_16x16x32_bf16 a[164:167], v[140:143], v[52:55], a[164:167]
  ds_read_b64_tr_b16 v[102:103], v8 offset:10240
  s_add_u32 m0, s53, 57344
  v_mfma_f32_16x16x32_bf16 a[168:171], v[140:143], v[56:59], a[168:171]
  v_mfma_f32_16x16x32_bf16 a[172:175], v[140:143], v[60:63], a[172:175]
  ds_read_b128 v[36:39], v6 offset:5120
  v_mfma_f32_16x16x32_bf16 a[176:179], v[140:143], v[64:67], a[176:179]
  v_mfma_f32_16x16x32_bf16 a[180:183], v[140:143], v[68:71], a[180:183]
  buffer_load_dwordx4 v3, s[24:27], s47 offen lds
  v_mfma_f32_16x16x32_bf16 a[184:187], v[140:143], v[72:75], a[184:187]
  ds_read_b64_tr_b16 v[104:105], v7 offset:12288
  v_mfma_f32_16x16x32_bf16 a[188:191], v[140:143], v[76:79], a[188:191]
  v_mfma_f32_16x16x32_bf16 a[192:195], v[144:147], v[48:51], a[192:195]
  ds_read_b64_tr_b16 v[106:107], v7 offset:14336
  v_mfma_f32_16x16x32_bf16 a[196:199], v[144:147], v[52:55], a[196:199]
  s_add_u32 m0, s53, 61440
  v_mfma_f32_16x16x32_bf16 a[200:203], v[144:147], v[56:59], a[200:203]
  v_mfma_f32_16x16x32_bf16 a[204:207], v[144:147], v[60:63], a[204:207]
  ds_read_b64_tr_b16 v[108:109], v8 offset:12288
  v_mfma_f32_16x16x32_bf16 a[208:211], v[144:147], v[64:67], a[208:211]
  v_mfma_f32_16x16x32_bf16 a[212:215], v[144:147], v[68:71], a[212:215]
  buffer_load_dwordx4 v3, s[28:31], s47 offen lds
  v_mfma_f32_16x16x32_bf16 a[216:219], v[144:147], v[72:75], a[216:219]
  ds_read_b128 v[40:43], v6 offset:6144
  v_mfma_f32_16x16x32_bf16 a[220:223], v[144:147], v[76:79], a[220:223]
  v_mfma_f32_16x16x32_bf16 a[224:227], v[148:151], v[48:51], a[224:227]
  ds_read_b64_tr_b16 v[110:111], v8 offset:14336
  v_mfma_f32_16x16x32_bf16 a[228:231], v[148:151], v[52:55], a[228:231]
  s_add_u32 m0, s54, 12288
  v_mfma_f32_16x16x32_bf16 a[232:235], v[148:151], v[56:59], a[232:235]
  v_mfma_f32_16x16x32_bf16 a[236:239], v[148:151], v[60:63], a[236:239]
  ds_read_b64_tr_b16 v[112:113], v9 offset:0
  v_mfma_f32_16x16x32_bf16 a[240:243], v[148:151], v[64:67], a[240:243]
  v_mfma_f32_16x16x32_bf16 a[244:247], v[148:151], v[68:71], a[244:247]
  ds_read_b128 v[44:47], v6 offset:7168
  v_mfma_f32_16x16x32_bf16 a[248:251], v[148:151], v[72:75], a[248:251]
  global_load_lds_dwordx4 v[4:5], off
  v_mfma_f32_16x16x32_bf16 a[252:255], v[148:151], v[76:79], a[252:255]
  v_mfma_f32_16x16x32_bf16 v[192:195], v[152:155], v[48:51], v[192:195]
  ds_read_b64_tr_b16 v[114:115], v9 offset:2048
  v_mfma_f32_16x16x32_bf16 v[196:199], v[152:155], v[52:55], v[196:199]
  s_add_u32 s46, s46, s48
  v_mfma_f32_16x16x32_bf16 v[200:203], v[152:155], v[56:59], v[200:203]
  ds_read_b64_tr_b16 v[116:117], v10 offset:0
  v_mfma_f32_16x16x32_bf16 v[204:207], v[152:155], v[60:63], v[204:207]
  v_mfma_f32_16x16x32_bf16 v[208:211], v[152:155], v[64:67], v[208:211]
  v_mfma_f32_16x16x32_bf16 v[212:215], v[152:155], v[68:71], v[212:215]
  ds_read_b64_tr_b16 v[118:119], v10 offset:2048
  s_add_u32 s47, s47, s49
  v_mfma_f32_16x16x32_bf16 v[216:219], v[152:155], v[72:75], v[216:219]
  v_mfma_f32_16x16x32_bf16 v[220:223], v[152:155], v[76:79], v[220:223]
  v_mfma_f32_16x16x32_bf16 v[224:227], v[156:159], v[48:51], v[224:227]
  v_mfma_f32_16x16x32_bf16 v[228:231], v[156:159], v[52:55], v[228:231]
  v_lshl_add_u64 v[4:5], s[50:51], 0, v[4:5]
  v_mfma_f32_16x16x32_bf16 v[232:235], v[156:159], v[56:59], v[232:235]
  v_mfma_f32_16x16x32_bf16 v[236:239], v[156:159], v[60:63], v[236:239]
  v_mfma_f32_16x16x32_bf16 v[240:243], v[156:159], v[64:67], v[240:243]
  v_mfma_f32_16x16x32_bf16 v[244:247], v[156:159], v[68:71], v[244:247]
  v_mfma_f32_16x16x32_bf16 v[248:251], v[156:159], v[72:75], v[248:251]
  v_mfma_f32_16x16x32_bf16 v[252:255], v[156:159], v[76:79], v[252:255]
  s_waitcnt vmcnt(20) lgkmcnt(0)
  s_barrier
  s_mov_b32 s71, 0
g1_loop_Q:
  v_mfma_f32_16x16x32_bf16 a[0:3], v[80:83], v[16:19], a[0:3]
  ds_read_b128 v[48:51], v6 offset:16384
  s_add_u32 m0, s52, 0
  v_mfma_f32_16x16x32_bf16 a[4:7], v[80:83], v[20:23], a[4:7]
  v_mfma_f32_16x16x32_bf16 a[8:11], v[80:83], v[24:27], a[8:11]
  ds_read_b64_tr_b16 v[120:121], v7 offset:16384
  v_mfma_f32_16x16x32_bf16 a[12:15], v[80:83], v[28:31], a[12:15]
  v_mfma_f32_16x16x32_bf16 a[16:19], v[80:83], v[32:35], a[16:19]
  buffer_load_dwordx4 v188, s[12:15], s45 offen offset:0 sc1 lds
  v_mfma_f32_16x16x32_bf16 a[20:23], v[80:83], v[36:39], a[20:23]
  ds_read_b64_tr_b16 v[122:123], v7 offset:18432
  v_mfma_f32_16x16x32_bf16 a[24:27], v[80:83], v[40:43], a[24:27]
  v_mfma_f32_16x16x32_bf16 a[28:31], v[80:83], v[44:47], a[28:31]
  ds_read_b128 v[52:55], v6 offset:17408
  v_mfma_f32_16x16x32_bf16 a[32:35], v[84:87], v[16:19], a[32:35]
  buffer_load_dwordx4 v188, s[12:15], s45 offen offset:1024 sc1 lds
  v_mfma_f32_16x16x32_bf16 a[36:39], v[84:87], v[20:23], a[36:39]
  v_mfma_f32_16x16x32_bf16 a[40:43], v[84:87], v[24:27], a[40:43]
  ds_read_b64_tr_b16 v[124:125], v8 offset:16384
  v_mfma_f32_16x16x32_bf16 a[44:47], v[84:87], v[28:31], a[44:47]
  v_mfma_f32_16x16x32_bf16 a[48:51], v[84:87], v[32:35], a[48:51]
  ds_read_b64_tr_b16 v[126:127], v8 offset:18432
  v_mfma_f32_16x16x32_bf16 a[52:55], v[84:87], v[36:39], a[52:55]
  buffer_load_dwordx4 v188, s[12:15], s45 offen offset:2048 sc1 lds
  v_mfma_f32_16x16x32_bf16 a[56:59], v[84:87], v[40:43], a[56:59]
  v_mfma_f32_16x16x32_bf16 a[60:63], v[84:87], v[44:47], a[60:63]
  ds_read_b64_tr_b16 v[128:129], v7 offset:20480
  v_mfma_f32_16x16x32_bf16 a[64:67], v[16:19], v[88:91], a[64:67]
  buffer_load_dwordx4 v188, s[12:15], s45 offen offset:3072 sc1 lds
  v_mfma_f32_16x16x32_bf16 a[68:71], v[20:23], v[88:91], a[68:71]
  v_mfma_f32_16x16x32_bf16 a[72:75], v[24:27], v[88:91], a[72:75]
  ds_read_b128 v[56:59], v6 offset:18432
  v_mfma_f32_16x16x32_bf16 a[76:79], v[28:31], v[88:91], a[76:79]
  v_mfma_f32_16x16x32_bf16 a[80:83], v[32:35], v[88:91], a[80:83]
  ds_read_b64_tr_b16 v[130:131], v7 offset:22528
  s_add_u32 s45, s45, 16384
  v_mfma_f32_16x16x32_bf16 a[84:87], v[36:39], v[88:91], a[84:87]
  v_mfma_f32_16x16x32_bf16 a[88:91], v[40:43], v[88:91], a[88:91]
  v_mfma_f32_16x16x32_bf16 a[92:95], v[44:47], v[88:91], a[92:95]
  ds_read_b64_tr_b16 v[132:133], v8 offset:20480
  v_mfma_f32_16x16x32_bf16 a[96:99], v[16:19], v[92:95], a[96:99]
  s_add_u32 m0, s53, 0
  v_mfma_f32_16x16x32_bf16 a[100:103], v[20:23], v[92:95], a[100:103]
  ds_read_b128 v[60:63], v6 offset:19456
  v_mfma_f32_16x16x32_bf16 a[104:107], v[24:27], v[92:95], a[104:107]
  v_mfma_f32_16x16x32_bf16 a[108:111], v[28:31], v[92:95], a[108:111]
  v_mfma_f32_16x16x32_bf16 a[112:115], v[32:35], v[92:95], a[112:115]
  ds_read_b64_tr_b16 v[134:135], v8 offset:22528
  v_mfma_f32_16x16x32_bf16 a[116:119], v[36:39], v[92:95], a[116:119]
  buffer_load_dwordx4 v2, s[16:19], s46 offen lds
  v_mfma_f32_16x16x32_bf16 a[120:123], v[40:43], v[92:95], a[120:123]
  ds_read_b64_tr_b16 v[136:137], v7 offset:24576
  v_mfma_f32_16x16x32_bf16 a[124:127], v[44:47], v[92:95], a[124:127]
  v_mfma_f32_16x16x32_bf16 a[128:131], v[96:99], v[16:19], a[128:131]
  s_add_u32 m0, s53, 4096
  v_mfma_f32_16x16x32_bf16 a[132:135], v[96:99], v[20:23], a[132:135]
  ds_read_b64_tr_b16 v[138:139], v7 offset:26624
  v_mfma_f32_16x16x32_bf16 a[136:139], v[96:99], v[24:27], a[136:139]
  v_mfma_f32_16x16x32_bf16 a[140:143], v[96:99], v[28:31], a[140:143]
  v_mfma_f32_16x16x32_bf16 a[144:147], v[96:99], v[32:35], a[144:147]
  ds_read_b128 v[64:67], v6 offset:20480
  v_mfma_f32_16x16x32_bf16 a[148:151], v[96:99], v[36:39], a[148:151]
  buffer_load_dwordx4 v2, s[20:23], s46 offen lds
  v_mfma_f32_16x16x32_bf16 a[152:155], v[96:99], v[40:43], a[152:155]
  ds_read_b64_tr_b16 v[140:141], v8 offset:24576
  v_mfma_f32_16x16x32_bf16 a[156:159], v[96:99], v[44:47], a[156:159]
  v_mfma_f32_16x16x32_bf16 a[160:163], v[100:103], v[16:19], a[160:163]
  v_mfma_f32_16x16x32_bf16 a[164:167], v[100:103], v[20:23], a[164:167]
  ds_read_b64_tr_b16 v[142:143], v8 offset:26624
  s_add_u32 m0, s53, 8192
  v_mfma_f32_16x16x32_bf16 a[168:171], v[100:103], v[24:27], a[168:171]
  v_mfma_f32_16x16x32_bf16 a[172:175], v[100:103], v[28:31], a[172:175]
  ds_read_b128 v[68:71], v6 offset:21504
  v_mfma_f32_16x16x32_bf16 a[176:179], v[100:103], v[32:35], a[176:179]
  v_mfma_f32_16x16x32_bf16 a[180:183], v[100:103], v[36:39], a[180:183]
  buffer_load_dwordx4 v3, s[24:27], s47 offen lds
  v_mfma_f32_16x16x32_bf16 a[184:187], v[100:103], v[40:43], a[184:187]
  ds_read_b64_tr_b16 v[144:145], v7 offset:28672
  v_mfma_f32_16x16x32_bf16 a[188:191], v[100:103], v[44:47], a[188:191]
  v_mfma_f32_16x16x32_bf16 a[192:195], v[104:107], v[16:19], a[192:195]
  ds_read_b64_tr_b16 v[146:147], v7 offset:30720
  v_mfma_f32_16x16x32_bf16 a[196:199], v[104:107], v[20:23], a[196:199]
  s_add_u32 m0, s53, 12288
  v_mfma_f32_16x16x32_bf16 a[200:203], v[104:107], v[24:27], a[200:203]
  v_mfma_f32_16x16x32_bf16 a[204:207], v[104:107], v[28:31], a[204:207]
  ds_read_b64_tr_b16 v[148:149], v8 offset:28672
  v_mfma_f32_16x16x32_bf16 a[208:211], v[104:107], v[32:35], a[208:211]
  v_mfma_f32_16x16x32_bf16 a[212:215], v[104:107], v[36:39], a[212:215]
  buffer_load_dwordx4 v3, s[28:31], s47 offen lds
  v_mfma_f32_16x16x32_bf16 a[216:219], v[104:107], v[40:43], a[216:219]
  ds_read_b128 v[72:75], v6 offset:22528
  v_mfma_f32_16x16x32_bf16 a[220:223], v[104:107], v[44:47], a[220:223]
  v_mfma_f32_16x16x32_bf16 a[224:227], v[108:111], v[16:19], a[224:227]
  ds_read_b64_tr_b16 v[150:151], v8 offset:30720
  v_mfma_f32_16x16x32_bf16 a[228:231], v[108:111], v[20:23], a[228:231]
  s_add_u32 m0, s54, 0
  v_mfma_f32_16x16x32_bf16 a[232:235], v[108:111], v[24:27], a[232:235]
  v_mfma_f32_16x16x32_bf16 a[236:239], v[108:111], v[28:31], a[236:239]
  ds_read_b64_tr_b16 v[152:153], v9 offset:4096
  v_mfma_f32_16x16x32_bf16 a[240:243], v[108:111], v[32:35], a[240:243]
  v_mfma_f32_16x16x32_bf16 a[244:247], v[108:111], v[36:39], a[244:247]
  ds_read_b128 v[76:79], v6 offset:23552
  v_mfma_f32_16x16x32_bf16 a[248:251], v[108:111], v[40:43], a[248:251]
  global_load_lds_dwordx4 v[4:5], off
  v_mfma_f32_16x16x32_bf16 a[252:255], v[108:111], v[44:47], a[252:255]
  v_mfma_f32_16x16x32_bf16 v[192:195], v[112:115], v[16:19], v[192:195]
  ds_read_b64_tr_b16 v[154:155], v9 offset:6144
  v_mfma_f32_16x16x32_bf16 v[196:199], v[112:115], v[20:23], v[196:199]
  s_add_u32 s46, s46, s48
  v_mfma_f32_16x16x32_bf16 v[200:203], v[112:115], v[24:27], v[200:203]
  ds_read_b64_tr_b16 v[156:157], v10 offset:4096
  v_mfma_f32_16x16x32_bf16 v[204:207], v[112:115], v[28:31], v[204:207]
  v_mfma_f32_16x16x32_bf16 v[208:211], v[112:115], v[32:35], v[208:211]
  v_mfma_f32_16x16x32_bf16 v[212:215], v[112:115], v[36:39], v[212:215]
  ds_read_b64_tr_b16 v[158:159], v10 offset:6144
  s_add_u32 s47, s47, s49
  v_mfma_f32_16x16x32_bf16 v[216:219], v[112:115], v[40:43], v[216:219]
  v_mfma_f32_16x16x32_bf16 v[220:223], v[112:115], v[44:47], v[220:223]
  v_mfma_f32_16x16x32_bf16 v[224:227], v[116:119], v[16:19], v[224:227]
  v_mfma_f32_16x16x32_bf16 v[228:231], v[116:119], v[20:23], v[228:231]
  v_lshl_add_u64 v[4:5], s[50:51], 0, v[4:5]
  v_mfma_f32_16x16x32_bf16 v[232:235], v[116:119], v[24:27], v[232:235]
  v_mfma_f32_16x16x32_bf16 v[236:239], v[116:119], v[28:31], v[236:239]
  v_mfma_f32_16x16x32_bf16 v[240:243], v[116:119], v[32:35], v[240:243]
  v_mfma_f32_16x16x32_bf16 v[244:247], v[116:119], v[36:39], v[244:247]
  v_mfma_f32_16x16x32_bf16 v[248:251], v[116:119], v[40:43], v[248:251]
  v_mfma_f32_16x16x32_bf16 v[252:255], v[116:119], v[44:47], v[252:255]
  s_waitcnt vmcnt(18) lgkmcnt(0)
  s_barrier
  v_mfma_f32_16x16x32_bf16 a[0:3], v[120:123], v[48:51], a[0:3]
  ds_read_b128 v[16:19], v6 offset:32768
  s_add_u32 m0, s52, 16384
  v_mfma_f32_16x16x32_bf16 a[4:7], v[120:123], v[52:55], a[4:7]
  v_mfma_f32_16x16x32_bf16 a[8:11], v[120:123], v[56:59], a[8:11]
  ds_read_b64_tr_b16 v[80:81], v7 offset:32768
  v_mfma_f32_16x16x32_bf16 a[12:15], v[120:123], v[60:63], a[12:15]
  v_mfma_f32_16x16x32_bf16 a[16:19], v[120:123], v[64:67], a[16:19]
  buffer_load_dwordx4 v188, s[12:15], s45 offen offset:0 sc1 lds
  v_mfma_f32_16x16x32_bf16 a[20:23], v[120:123], v[68:71], a[20:23]
  ds_read_b64_tr_b16 v[82:83], v7 offset:34816
  v_mfma_f32_16x16x32_bf16 a[24:27], v[120:123], v[72:75], a[24:27]
  v_mfma_f32_16x16x32_bf16 a[28:31], v[120:123], v[76:79], a[28:31]
  ds_read_b128 v[20:23], v6 offset:33792
  v_mfma_f32_16x16x32_bf16 a[32:35], v[124:127], v[48:51], a[32:35]
  buffer_load_dwordx4 v188, s[12:15], s45 offen offset:1024 sc1 lds
  v_mfma_f32_16x16x32_bf16 a[36:39], v[124:127], v[52:55], a[36:39]
  v_mfma_f32_16x16x32_bf16 a[40:43], v[124:127], v[56:59], a[40:43]
  ds_read_b64_tr_b16 v[84:85], v8 offset:32768
  v_mfma_f32_16x16x32_bf16 a[44:47], v[124:127], v[60:63], a[44:47]
  v_mfma_f32_16x16x32_bf16 a[48:51], v[124:127], v[64:67], a[48:51]
  ds_read_b64_tr_b16 v[86:87], v8 offset:34816
  v_mfma_f32_16x16x32_bf16 a[52:55], v[124:127], v[68:71], a[52:55]
  buffer_load_dwordx4 v188, s[12:15], s45 offen offset:2048 sc1 lds
  v_mfma_f32_16x16x32_bf16 a[56:59], v[124:127], v[72:75], a[56:59]
  v_mfma_f32_16x16x32_bf16 a[60:63], v[124:127], v[76:79], a[60:63]
  ds_read_b64_tr_b16 v[88:89], v7 offset:36864
  v_mfma_f32_16x16x32_bf16 a[64:67], v[48:51], v[128:131], a[64:67]
  buffer_load_dwordx4 v188, s[12:15], s45 offen offset:3072 sc1 lds
  v_mfma_f32_16x16x32_bf16 a[68:71], v[52:55], v[128:131], a[68:71]
  v_mfma_f32_16x16x32_bf16 a[72:75], v[56:59], v[128:131], a[72:75]
  ds_read_b128 v[24:27], v6 offset:34816
  v_mfma_f32_16x16x32_bf16 a[76:79], v[60:63], v[128:131], a[76:79]
  v_mfma_f32_16x16x32_bf16 a[80:83], v[64:67], v[128:131], a[80:83]
  ds_read_b64_tr_b16 v[90:91], v7 offset:38912
  s_add_u32 s45, s45, 16384
  v_mfma_f32_16x16x32_bf16 a[84:87], v[68:71], v[128:131], a[84:87]
  v_mfma_f32_16x16x32_bf16 a[88:91], v[72:75], v[128:131], a[88:91]
  v_mfma_f32_16x16x32_bf16 a[92:95], v[76:79], v[128:131], a[92:95]
  ds_read_b64_tr_b16 v[92:93], v8 offset:36864
  v_mfma_f32_16x16x32_bf16 a[96:99], v[48:51], v[132:135], a[96:99]
  s_add_u32 m0, s53, 16384
  v_mfma_f32_16x16x32_bf16 a[100:103], v[52:55], v[132:135], a[100:103]
  ds_read_b128 v[28:31], v6 offset:35840
  v_mfma_f32_16x16x32_bf16 a[104:107], v[56:59], v[132:135], a[104:107]
  v_mfma_f32_16x16x32_bf16 a[108:111], v[60:63], v[132:135], a[108:111]
  v_mfma_f32_16x16x32_bf16 a[112:115], v[64:67], v[132:135], a[112:115]
  ds_read_b64_tr_b16 v[94:95], v8 offset:38912
  v_mfma_f32_16x16x32_bf16 a[116:119], v[68:71], v[132:135], a[116:119]
  buffer_load_dwordx4 v2, s[16:19], s46 offen lds
  v_mfma_f32_16x16x32_bf16 a[120:123], v[72:75], v[132:135], a[120:123]
  ds_read_b64_tr_b16 v[96:97], v7 offset:40960
  v_mfma_f32_16x16x32_bf16 a[124:127], v[76:79], v[132:135], a[124:127]
  v_mfma_f32_16x16x32_bf16 a[128:131], v[136:139], v[48:51], a[128:131]
  s_add_u32 m0, s53, 20480
  v_mfma_f32_16x16x32_bf16 a[132:135], v[136:139], v[52:55], a[132:135]
  ds_read_b64_tr_b16 v[98:99], v7 offset:43008
  v_mfma_f32_16x16x32_bf16 a[136:139], v[136:139], v[56:59], a[136:139]
  v_mfma_f32_16x16x32_bf16 a[140:143], v[136:139], v[60:63], a[140:143]
  v_mfma_f32_16x16x32_bf16 a[144:147], v[136:139], v[64:67], a[144:147]
  ds_read_b128 v[32:35], v6 offset:36864
  v_mfma_f32_16x16x32_bf16 a[148:151], v[136:139], v[68:71], a[148:151]
  buffer_load_dwordx4 v2, s[20:23], s46 offen lds
  v_mfma_f32_16x16x32_bf16 a[152:155], v[136:139], v[72:75], a[152:155]
  ds_read_b64_tr_b16 v[100:101], v8 offset:40960
  v_mfma_f32_16x16x32_bf16 a[156:159], v[136:139], v[76:79], a[156:159]
  v_mfma_f32_16x16x32_bf16 a[160:163], v[140:143], v[48:51], a[160:163]
  v_mfma_f32_16x16x32_bf16 a[164:167], v[140:143], v[52:55], a[164:167]
  ds_read_b64_tr_b16 v[102:103], v8 offset:43008
  s_add_u32 m0, s53, 24576
  v_mfma_f32_16x16x32_bf16 a[168:171], v[140:143], v[56:59], a[168:171]
  v_mfma_f32_16x16x32_bf16 a[172:175], v[140:143], v[60:63], a[172:175]
  ds_read_b128 v[36:39], v6 offset:37888
  v_mfma_f32_16x16x32_bf16 a[176:179], v[140:143], v[64:67], a[176:179]
  v_mfma_f32_16x16x32_bf16 a[180:183], v[140:143], v[68:71], a[180:183]
  buffer_load_dwordx4 v3, s[24:27], s47 offen lds
  v_mfma_f32_16x16x32_bf16 a[184:187], v[140:143], v[72:75], a[184:187]
  ds_read_b64_tr_b16 v[104:105], v7 offset:45056
  v_mfma_f32_16x16x32_bf16 a[188:191], v[140:143], v[76:79], a[188:191]
  v_mfma_f32_16x16x32_bf16 a[192:195], v[144:147], v[48:51], a[192:195]
  ds_read_b64_tr_b16 v[106:107], v7 offset:47104
  v_mfma_f32_16x16x32_bf16 a[196:199], v[144:147], v[52:55], a[196:199]
  s_add_u32 m0, s53, 28672
  v_mfma_f32_16x16x32_bf16 a[200:203], v[144:147], v[56:59], a[200:203]
  v_mfma_f32_16x16x32_bf16 a[204:207], v[144:147], v[60:63], a[204:207]
  ds_read_b64_tr_b16 v[108:109], v8 offset:45056
  v_mfma_f32_16x16x32_bf16 a[208:211], v[144:147], v[64:67], a[208:211]
  v_mfma_f32_16x16x32_bf16 a[212:215], v[144:147], v[68:71], a[212:215]
  buffer_load_dwordx4 v3, s[28:31], s47 offen lds
  v_mfma_f32_16x16x32_bf16 a[216:219], v[144:147], v[72:75], a[216:219]
  ds_read_b128 v[40:43], v6 offset:38912
  v_mfma_f32_16x16x32_bf16 a[220:223], v[144:147], v[76:79], a[220:223]
  v_mfma_f32_16x16x32_bf16 a[224:227], v[148:151], v[48:51], a[224:227]
  ds_read_b64_tr_b16 v[110:111], v8 offset:47104
  v_mfma_f32_16x16x32_bf16 a[228:231], v[148:151], v[52:55], a[228:231]
  s_add_u32 m0, s54, 4096
  v_mfma_f32_16x16x32_bf16 a[232:235], v[148:151], v[56:59], a[232:235]
  v_mfma_f32_16x16x32_bf16 a[236:239], v[148:151], v[60:63], a[236:239]
  ds_read_b64_tr_b16 v[112:113], v9 offset:8192
  v_mfma_f32_16x16x32_bf16 a[240:243], v[148:151], v[64:67], a[240:243]
  v_mfma_f32_16x16x32_bf16 a[244:247], v[148:151], v[68:71], a[244:247]
  ds_read_b128 v[44:47], v6 offset:39936
  v_mfma_f32_16x16x32_bf16 a[248:251], v[148:151], v[72:75], a[248:251]
  global_load_lds_dwordx4 v[4:5], off
  v_mfma_f32_16x16x32_bf16 a[252:255], v[148:151], v[76:79], a[252:255]
  v_mfma_f32_16x16x32_bf16 v[192:195], v[152:155], v[48:51], v[192:195]
  ds_read_b64_tr_b16 v[114:115], v9 offset:10240
  v_mfma_f32_16x16x32_bf16 v[196:199], v[152:155], v[52:55], v[196:199]
  s_add_u32 s46, s46, s48
  v_mfma_f32_16x16x32_bf16 v[200:203], v[152:155], v[56:59], v[200:203]
  ds_read_b64_tr_b16 v[116:117], v10 offset:8192
  v_mfma_f32_16x16x32_bf16 v[204:207], v[152:155], v[60:63], v[204:207]
  v_mfma_f32_16x16x32_bf16 v[208:211], v[152:155], v[64:67], v[208:211]
  v_mfma_f32_16x16x32_bf16 v[212:215], v[152:155], v[68:71], v[212:215]
  ds_read_b64_tr_b16 v[118:119], v10 offset:10240
  s_add_u32 s47, s47, s49
  v_mfma_f32_16x16x32_bf16 v[216:219], v[152:155], v[72:75], v[216:219]
  v_mfma_f32_16x16x32_bf16 v[220:223], v[152:155], v[76:79], v[220:223]
  v_mfma_f32_16x16x32_bf16 v[224:227], v[156:159], v[48:51], v[224:227]
  v_mfma_f32_16x16x32_bf16 v[228:231], v[156:159], v[52:55], v[228:231]
  v_lshl_add_u64 v[4:5], s[50:51], 0, v[4:5]
  v_mfma_f32_16x16x32_bf16 v[232:235], v[156:159], v[56:59], v[232:235]
  v_mfma_f32_16x16x32_bf16 v[236:239], v[156:159], v[60:63], v[236:239]
  v_mfma_f32_16x16x32_bf16 v[240:243], v[156:159], v[64:67], v[240:243]
  v_mfma_f32_16x16x32_bf16 v[244:247], v[156:159], v[68:71], v[244:247]
  v_mfma_f32_16x16x32_bf16 v[248:251], v[156:159], v[72:75], v[248:251]
  v_mfma_f32_16x16x32_bf16 v[252:255], v[156:159], v[76:79], v[252:255]
  s_waitcnt vmcnt(18) lgkmcnt(0)
  s_barrier
  v_mfma_f32_16x16x32_bf16 a[0:3], v[80:83], v[16:19], a[0:3]
  ds_read_b128 v[48:51], v6 offset:49152
  s_add_u32 m0, s52, 32768
  v_mfma_f32_16x16x32_bf16 a[4:7], v[80:83], v[20:23], a[4:7]
  v_mfma_f32_16x16x32_bf16 a[8:11], v[80:83], v[24:27], a[8:11]
  ds_read_b64_tr_b16 v[120:121], v7 offset:49152
  v_mfma_f32_16x16x32_bf16 a[12:15], v[80:83], v[28:31], a[12:15]
  v_mfma_f32_16x16x32_bf16 a[16:19], v[80:83], v[32:35], a[16:19]
  buffer_load_dwordx4 v188, s[12:15], s45 offen offset:0 sc1 lds
  v_mfma_f32_16x16x32_bf16 a[20:23], v[80:83], v[36:39], a[20:23]
  ds_read_b64_tr_b16 v[122:123], v7 offset:51200
  v_mfma_f32_16x16x32_bf16 a[24:27], v[80:83], v[40:43], a[24:27]
  v_mfma_f32_16x16x32_bf16 a[28:31], v[80:83], v[44:47], a[28:31]
  ds_read_b128 v[52:55], v6 offset:50176
  v_mfma_f32_16x16x32_bf16 a[32:35], v[84:87], v[16:19], a[32:35]
  buffer_load_dwordx4 v188, s[12:15], s45 offen offset:1024 sc1 lds
  v_mfma_f32_16x16x32_bf16 a[36:39], v[84:87], v[20:23], a[36:39]
  v_mfma_f32_16x16x32_bf16 a[40:43], v[84:87], v[24:27], a[40:43]
  ds_read_b64_tr_b16 v[124:125], v8 offset:49152
  v_mfma_f32_16x16x32_bf16 a[44:47], v[84:87], v[28:31], a[44:47]
  v_mfma_f32_16x16x32_bf16 a[48:51], v[84:87], v[32:35], a[48:51]
  ds_read_b64_tr_b16 v[126:127], v8 offset:51200
  v_mfma_f32_16x16x32_bf16 a[52:55], v[84:87], v[36:39], a[52:55]
  buffer_load_dwordx4 v188, s[12:15], s45 offen offset:2048 sc1 lds
  v_mfma_f32_16x16x32_bf16 a[56:59], v[84:87], v[40:43], a[56:59]
  v_mfma_f32_16x16x32_bf16 a[60:63], v[84:87], v[44:47], a[60:63]
  ds_read_b64_tr_b16 v[128:129], v7 offset:53248
  v_mfma_f32_16x16x32_bf16 a[64:67], v[16:19], v[88:91], a[64:67]
  buffer_load_dwordx4 v188, s[12:15], s45 offen offset:3072 sc1 lds
  v_mfma_f32_16x16x32_bf16 a[68:71], v[20:23], v[88:91], a[68:71]
  v_mfma_f32_16x16x32_bf16 a[72:75], v[24:27], v[88:91], a[72:75]
  ds_read_b128 v[56:59], v6 offset:51200
  v_mfma_f32_16x16x32_bf16 a[76:79], v[28:31], v[88:91], a[76:79]
  v_mfma_f32_16x16x32_bf16 a[80:83], v[32:35], v[88:91], a[80:83]
  ds_read_b64_tr_b16 v[130:131], v7 offset:55296
  s_add_u32 s45, s45, 16384
  v_mfma_f32_16x16x32_bf16 a[84:87], v[36:39], v[88:91], a[84:87]
  v_mfma_f32_16x16x32_bf16 a[88:91], v[40:43], v[88:91], a[88:91]
  v_mfma_f32_16x16x32_bf16 a[92:95], v[44:47], v[88:91], a[92:95]
  ds_read_b64_tr_b16 v[132:133], v8 offset:53248
  v_mfma_f32_16x16x32_bf16 a[96:99], v[16:19], v[92:95], a[96:99]
  s_add_u32 m0, s53, 32768
  v_mfma_f32_16x16x32_bf16 a[100:103], v[20:23], v[92:95], a[100:103]
  ds_read_b128 v[60:63], v6 offset:52224
  v_mfma_f32_16x16x32_bf16 a[104:107], v[24:27], v[92:95], a[104:107]
  v_mfma_f32_16x16x32_bf16 a[108:111], v[28:31], v[92:95], a[108:111]
  v_mfma_f32_16x16x32_bf16 a[112:115], v[32:35], v[92:95], a[112:115]
  ds_read_b64_tr_b16 v[134:135], v8 offset:55296
  v_mfma_f32_16x16x32_bf16 a[116:119], v[36:39], v[92:95], a[116:119]
  buffer_load_dwordx4 v2, s[16:19], s46 offen lds
  v_mfma_f32_16x16x32_bf16 a[120:123], v[40:43], v[92:95], a[120:123]
  ds_read_b64_tr_b16 v[136:137], v7 offset:57344
  v_mfma_f32_16x16x32_bf16 a[124:127], v[44:47], v[92:95], a[124:127]
  v_mfma_f32_16x16x32_bf16 a[128:131], v[96:99], v[16:19], a[128:131]
  s_add_u32 m0, s53, 36864
  v_mfma_f32_16x16x32_bf16 a[132:135], v[96:99], v[20:23], a[132:135]
  ds_read_b64_tr_b16 v[138:139], v7 offset:59392
  v_mfma_f32_16x16x32_bf16 a[136:139], v[96:99], v[24:27], a[136:139]
  v_mfma_f32_16x16x32_bf16 a[140:143], v[96:99], v[28:31], a[140:143]
  v_mfma_f32_16x16x32_bf16 a[144:147], v[96:99], v[32:35], a[144:147]
  ds_read_b128 v[64:67], v6 offset:53248
  v_mfma_f32_16x16x32_bf16 a[148:151], v[96:99], v[36:39], a[148:151]
  buffer_load_dwordx4 v2, s[20:23], s46 offen lds
  v_mfma_f32_16x16x32_bf16 a[152:155], v[96:99], v[40:43], a[152:155]
  ds_read_b64_tr_b16 v[140:141], v8 offset:57344
  v_mfma_f32_16x16x32_bf16 a[156:159], v[96:99], v[44:47], a[156:159]
  v_mfma_f32_16x16x32_bf16 a[160:163], v[100:103], v[16:19], a[160:163]
  v_mfma_f32_16x16x32_bf16 a[164:167], v[100:103], v[20:23], a[164:167]
  ds_read_b64_tr_b16 v[142:143], v8 offset:59392
  s_add_u32 m0, s53, 40960
  v_mfma_f32_16x16x32_bf16 a[168:171], v[100:103], v[24:27], a[168:171]
  v_mfma_f32_16x16x32_bf16 a[172:175], v[100:103], v[28:31], a[172:175]
  ds_read_b128 v[68:71], v6 offset:54272
  v_mfma_f32_16x16x32_bf16 a[176:179], v[100:103], v[32:35], a[176:179]
  v_mfma_f32_16x16x32_bf16 a[180:183], v[100:103], v[36:39], a[180:183]
  buffer_load_dwordx4 v3, s[24:27], s47 offen lds
  v_mfma_f32_16x16x32_bf16 a[184:187], v[100:103], v[40:43], a[184:187]
  ds_read_b64_tr_b16 v[144:145], v7 offset:61440
  v_mfma_f32_16x16x32_bf16 a[188:191], v[100:103], v[44:47], a[188:191]
  v_mfma_f32_16x16x32_bf16 a[192:195], v[104:107], v[16:19], a[192:195]
  ds_read_b64_tr_b16 v[146:147], v7 offset:63488
  v_mfma_f32_16x16x32_bf16 a[196:199], v[104:107], v[20:23], a[196:199]
  s_add_u32 m0, s53, 45056
  v_mfma_f32_16x16x32_bf16 a[200:203], v[104:107], v[24:27], a[200:203]
  v_mfma_f32_16x16x32_bf16 a[204:207], v[104:107], v[28:31], a[204:207]
  ds_read_b64_tr_b16 v[148:149], v8 offset:61440
  v_mfma_f32_16x16x32_bf16 a[208:211], v[104:107], v[32:35], a[208:211]
  v_mfma_f32_16x16x32_bf16 a[212:215], v[104:107], v[36:39], a[212:215]
  buffer_load_dwordx4 v3, s[28:31], s47 offen lds
  v_mfma_f32_16x16x32_bf16 a[216:219], v[104:107], v[40:43], a[216:219]
  ds_read_b128 v[72:75], v6 offset:55296
  v_mfma_f32_16x16x32_bf16 a[220:223], v[104:107], v[44:47], a[220:223]
  v_mfma_f32_16x16x32_bf16 a[224:227], v[108:111], v[16:19], a[224:227]
  ds_read_b64_tr_b16 v[150:151], v8 offset:63488
  v_mfma_f32_16x16x32_bf16 a[228:231], v[108:111], v[20:23], a[228:231]
  s_add_u32 m0, s54, 8192
  v_mfma_f32_16x16x32_bf16 a[232:235], v[108:111], v[24:27], a[232:235]
  v_mfma_f32_16x16x32_bf16 a[236:239], v[108:111], v[28:31], a[236:239]
  ds_read_b64_tr_b16 v[152:153], v9 offset:12288
  v_mfma_f32_16x16x32_bf16 a[240:243], v[108:111], v[32:35], a[240:243]
  v_mfma_f32_16x16x32_bf16 a[244:247], v[108:111], v[36:39], a[244:247]
  ds_read_b128 v[76:79], v6 offset:56320
  v_mfma_f32_16x16x32_bf16 a[248:251], v[108:111], v[40:43], a[248:251]
  global_load_lds_dwordx4 v[4:5], off
  v_mfma_f32_16x16x32_bf16 a[252:255], v[108:111], v[44:47], a[252:255]
  v_mfma_f32_16x16x32_bf16 v[192:195], v[112:115], v[16:19], v[192:195]
  ds_read_b64_tr_b16 v[154:155], v9 offset:14336
  v_mfma_f32_16x16x32_bf16 v[196:199], v[112:115], v[20:23], v[196:199]
  s_add_u32 s46, s46, s48
  v_mfma_f32_16x16x32_bf16 v[200:203], v[112:115], v[24:27], v[200:203]
  ds_read_b64_tr_b16 v[156:157], v10 offset:12288
  v_mfma_f32_16x16x32_bf16 v[204:207], v[112:115], v[28:31], v[204:207]
  v_mfma_f32_16x16x32_bf16 v[208:211], v[112:115], v[32:35], v[208:211]
  v_mfma_f32_16x16x32_bf16 v[212:215], v[112:115], v[36:39], v[212:215]
  ds_read_b64_tr_b16 v[158:159], v10 offset:14336
  s_add_u32 s47, s47, s49
  v_mfma_f32_16x16x32_bf16 v[216:219], v[112:115], v[40:43], v[216:219]
  v_mfma_f32_16x16x32_bf16 v[220:223], v[112:115], v[44:47], v[220:223]
  v_mfma_f32_16x16x32_bf16 v[224:227], v[116:119], v[16:19], v[224:227]
  v_mfma_f32_16x16x32_bf16 v[228:231], v[116:119], v[20:23], v[228:231]
  v_lshl_add_u64 v[4:5], s[50:51], 0, v[4:5]
  v_mfma_f32_16x16x32_bf16 v[232:235], v[116:119], v[24:27], v[232:235]
  v_mfma_f32_16x16x32_bf16 v[236:239], v[116:119], v[28:31], v[236:239]
  v_mfma_f32_16x16x32_bf16 v[240:243], v[116:119], v[32:35], v[240:243]
  v_mfma_f32_16x16x32_bf16 v[244:247], v[116:119], v[36:39], v[244:247]
  v_mfma_f32_16x16x32_bf16 v[248:251], v[116:119], v[40:43], v[248:251]
  v_mfma_f32_16x16x32_bf16 v[252:255], v[116:119], v[44:47], v[252:255]
  s_waitcnt vmcnt(18) lgkmcnt(0)
  s_barrier
  v_mfma_f32_16x16x32_bf16 a[0:3], v[120:123], v[48:51], a[0:3]
  ds_read_b128 v[16:19], v6 offset:0
  s_add_u32 m0, s52, 49152
  v_mfma_f32_16x16x32_bf16 a[4:7], v[120:123], v[52:55], a[4:7]
  v_mfma_f32_16x16x32_bf16 a[8:11], v[120:123], v[56:59], a[8:11]
  ds_read_b64_tr_b16 v[80:81], v7 offset:0
  v_mfma_f32_16x16x32_bf16 a[12:15], v[120:123], v[60:63], a[12:15]
  v_mfma_f32_16x16x32_bf16 a[16:19], v[120:123], v[64:67], a[16:19]
  buffer_load_dwordx4 v188, s[12:15], s45 offen offset:0 sc1 lds
  v_mfma_f32_16x16x32_bf16 a[20:23], v[120:123], v[68:71], a[20:23]
  ds_read_b64_tr_b16 v[82:83], v7 offset:2048
  v_mfma_f32_16x16x32_bf16 a[24:27], v[120:123], v[72:75], a[24:27]
  v_mfma_f32_16x16x32_bf16 a[28:31], v[120:123], v[76:79], a[28:31]
  ds_read_b128 v[20:23], v6 offset:1024
  v_mfma_f32_16x16x32_bf16 a[32:35], v[124:127], v[48:51], a[32:35]
  buffer_load_dwordx4 v188, s[12:15], s45 offen offset:1024 sc1 lds
  v_mfma_f32_16x16x32_bf16 a[36:39], v[124:127], v[52:55], a[36:39]
  v_mfma_f32_16x16x32_bf16 a[40:43], v[124:127], v[56:59], a[40:43]
  ds_read_b64_tr_b16 v[84:85], v8 offset:0
  v_mfma_f32_16x16x32_bf16 a[44:47], v[124:127], v[60:63], a[44:47]
  v_mfma_f32_16x16x32_bf16 a[48:51], v[124:127], v[64:67], a[48:51]
  ds_read_b64_tr_b16 v[86:87], v8 offset:2048
  v_mfma_f32_16x16x32_bf16 a[52:55], v[124:127], v[68:71], a[52:55]
  buffer_load_dwordx4 v188, s[12:15], s45 offen offset:2048 sc1 lds
  v_mfma_f32_16x16x32_bf16 a[56:59], v[124:127], v[72:75], a[56:59]
  v_mfma_f32_16x16x32_bf16 a[60:63], v[124:127], v[76:79], a[60:63]
  ds_read_b64_tr_b16 v[88:89], v7 offset:4096
  v_mfma_f32_16x16x32_bf16 a[64:67], v[48:51], v[128:131], a[64:67]
  buffer_load_dwordx4 v188, s[12:15], s45 offen offset:3072 sc1 lds
  v_mfma_f32_16x16x32_bf16 a[68:71], v[52:55], v[128:131], a[68:71]
  v_mfma_f32_16x16x32_bf16 a[72:75], v[56:59], v[128:131], a[72:75]
  ds_read_b128 v[24:27], v6 offset:2048
  v_mfma_f32_16x16x32_bf16 a[76:79], v[60:63], v[128:131], a[76:79]
  v_mfma_f32_16x16x32_bf16 a[80:83], v[64:67], v[128:131], a[80:83]
  ds_read_b64_tr_b16 v[90:91], v7 offset:6144
  s_add_u32 s45, s45, 16384
  v_mfma_f32_16x16x32_bf16 a[84:87], v[68:71], v[128:131], a[84:87]
  v_mfma_f32_16x16x32_bf16 a[88:91], v[72:75], v[128:131], a[88:91]
  v_mfma_f32_16x16x32_bf16 a[92:95], v[76:79], v[128:131], a[92:95]
  ds_read_b64_tr_b16 v[92:93], v8 offset:4096
  v_mfma_f32_16x16x32_bf16 a[96:99], v[48:51], v[132:135], a[96:99]
  s_add_u32 m0, s53, 49152
  v_mfma_f32_16x16x32_bf16 a[100:103], v[52:55], v[132:135], a[100:103]
  ds_read_b128 v[28:31], v6 offset:3072
  v_mfma_f32_16x16x32_bf16 a[104:107], v[56:59], v[132:135], a[104:107]
  v_mfma_f32_16x16x32_bf16 a[108:111], v[60:63], v[132:135], a[108:111]
  v_mfma_f32_16x16x32_bf16 a[112:115], v[64:67], v[132:135], a[112:115]
  ds_read_b64_tr_b16 v[94:95], v8 offset:6144
  v_mfma_f32_16x16x32_bf16 a[116:119], v[68:71], v[132:135], a[116:119]
  buffer_load_dwordx4 v2, s[16:19], s46 offen lds
  v_mfma_f32_16x16x32_bf16 a[120:123], v[72:75], v[132:135], a[120:123]
  ds_read_b64_tr_b16 v[96:97], v7 offset:8192
  v_mfma_f32_16x16x32_bf16 a[124:127], v[76:79], v[132:135], a[124:127]
  v_mfma_f32_16x16x32_bf16 a[128:131], v[136:139], v[48:51], a[128:131]
  s_add_u32 m0, s53, 53248
  v_mfma_f32_16x16x32_bf16 a[132:135], v[136:139], v[52:55], a[132:135]
  ds_read_b64_tr_b16 v[98:99], v7 offset:10240
  v_mfma_f32_16x16x32_bf16 a[136:139], v[136:139], v[56:59], a[136:139]
  v_mfma_f32_16x16x32_bf16 a[140:143], v[136:139], v[60:63], a[140:143]
  v_mfma_f32_16x16x32_bf16 a[144:147], v[136:139], v[64:67], a[144:147]
  ds_read_b128 v[32:35], v6 offset:4096
  v_mfma_f32_16x16x32_bf16 a[148:151], v[136:139], v[68:71], a[148:151]
  buffer_load_dwordx4 v2, s[20:23], s46 offen lds
  v_mfma_f32_16x16x32_bf16 a[152:155], v[136:139], v[72:75], a[152:155]
  ds_read_b64_tr_b16 v[100:101], v8 offset:8192
  v_mfma_f32_16x16x32_bf16 a[156:159], v[136:139], v[76:79], a[156:159]
  v_mfma_f32_16x16x32_bf16 a[160:163], v[140:143], v[48:51], a[160:163]
  v_mfma_f32_16x16x32_bf16 a[164:167], v[140:143], v[52:55], a[164:167]
  ds_read_b64_tr_b16 v[102:103], v8 offset:10240
  s_add_u32 m0, s53, 57344
  v_mfma_f32_16x16x32_bf16 a[168:171], v[140:143], v[56:59], a[168:171]
  v_mfma_f32_16x16x32_bf16 a[172:175], v[140:143], v[60:63], a[172:175]
  ds_read_b128 v[36:39], v6 offset:5120
  v_mfma_f32_16x16x32_bf16 a[176:179], v[140:143], v[64:67], a[176:179]
  v_mfma_f32_16x16x32_bf16 a[180:183], v[140:143], v[68:71], a[180:183]
  buffer_load_dwordx4 v3, s[24:27], s47 offen lds
  v_mfma_f32_16x16x32_bf16 a[184:187], v[140:143], v[72:75], a[184:187]
  ds_read_b64_tr_b16 v[104:105], v7 offset:12288
  v_mfma_f32_16x16x32_bf16 a[188:191], v[140:143], v[76:79], a[188:191]
  v_mfma_f32_16x16x32_bf16 a[192:195], v[144:147], v[48:51], a[192:195]
  ds_read_b64_tr_b16 v[106:107], v7 offset:14336
  v_mfma_f32_16x16x32_bf16 a[196:199], v[144:147], v[52:55], a[196:199]
  s_add_u32 m0, s53, 61440
  v_mfma_f32_16x16x32_bf16 a[200:203], v[144:147], v[56:59], a[200:203]
  v_mfma_f32_16x16x32_bf16 a[204:207], v[144:147], v[60:63], a[204:207]
  ds_read_b64_tr_b16 v[108:109], v8 offset:12288
  v_mfma_f32_16x16x32_bf16 a[208:211], v[144:147], v[64:67], a[208:211]
  v_mfma_f32_16x16x32_bf16 a[212:215], v[144:147], v[68:71], a[212:215]
  buffer_load_dwordx4 v3, s[28:31], s47 offen lds
  v_mfma_f32_16x16x32_bf16 a[216:219], v[144:147], v[72:75], a[216:219]
  ds_read_b128 v[40:43], v6 offset:6144
  v_mfma_f32_16x16x32_bf16 a[220:223], v[144:147], v[76:79], a[220:223]
  v_mfma_f32_16x16x32_bf16 a[224:227], v[148:151], v[48:51], a[224:227]
  ds_read_b64_tr_b16 v[110:111], v8 offset:14336
  v_mfma_f32_16x16x32_bf16 a[228:231], v[148:151], v[52:55], a[228:231]
  s_add_u32 m0, s54, 12288
  v_mfma_f32_16x16x32_bf16 a[232:235], v[148:151], v[56:59], a[232:235]
  v_mfma_f32_16x16x32_bf16 a[236:239], v[148:151], v[60:63], a[236:239]
  ds_read_b64_tr_b16 v[112:113], v9 offset:0
  v_mfma_f32_16x16x32_bf16 a[240:243], v[148:151], v[64:67], a[240:243]
  v_mfma_f32_16x16x32_bf16 a[244:247], v[148:151], v[68:71], a[244:247]
  ds_read_b128 v[44:47], v6 offset:7168
  v_mfma_f32_16x16x32_bf16 a[248:251], v[148:151], v[72:75], a[248:251]
  global_load_lds_dwordx4 v[4:5], off
  v_mfma_f32_16x16x32_bf16 a[252:255], v[148:151], v[76:79], a[252:255]
  v_mfma_f32_16x16x32_bf16 v[192:195], v[152:155], v[48:51], v[192:195]
  ds_read_b64_tr_b16 v[114:115], v9 offset:2048
  v_mfma_f32_16x16x32_bf16 v[196:199], v[152:155], v[52:55], v[196:199]
  s_add_u32 s46, s46, s48
  v_mfma_f32_16x16x32_bf16 v[200:203], v[152:155], v[56:59], v[200:203]
  ds_read_b64_tr_b16 v[116:117], v10 offset:0
  v_mfma_f32_16x16x32_bf16 v[204:207], v[152:155], v[60:63], v[204:207]
  v_mfma_f32_16x16x32_bf16 v[208:211], v[152:155], v[64:67], v[208:211]
  v_mfma_f32_16x16x32_bf16 v[212:215], v[152:155], v[68:71], v[212:215]
  ds_read_b64_tr_b16 v[118:119], v10 offset:2048
  s_add_u32 s47, s47, s49
  v_mfma_f32_16x16x32_bf16 v[216:219], v[152:155], v[72:75], v[216:219]
  v_mfma_f32_16x16x32_bf16 v[220:223], v[152:155], v[76:79], v[220:223]
  v_mfma_f32_16x16x32_bf16 v[224:227], v[156:159], v[48:51], v[224:227]
  v_mfma_f32_16x16x32_bf16 v[228:231], v[156:159], v[52:55], v[228:231]
  v_lshl_add_u64 v[4:5], s[50:51], 0, v[4:5]
  v_mfma_f32_16x16x32_bf16 v[232:235], v[156:159], v[56:59], v[232:235]
  v_mfma_f32_16x16x32_bf16 v[236:239], v[156:159], v[60:63], v[236:239]
  v_mfma_f32_16x16x32_bf16 v[240:243], v[156:159], v[64:67], v[240:243]
  v_mfma_f32_16x16x32_bf16 v[244:247], v[156:159], v[68:71], v[244:247]
  v_mfma_f32_16x16x32_bf16 v[248:251], v[156:159], v[72:75], v[248:251]
  v_mfma_f32_16x16x32_bf16 v[252:255], v[156:159], v[76:79], v[252:255]
  s_waitcnt vmcnt(18) lgkmcnt(0)
  s_barrier
  s_add_u32 s71, s71, 1
  s_cmp_lt_u32 s71, 3
  s_cbranch_scc1 g1_loop_Q
  v_mfma_f32_16x16x32_bf16 a[0:3], v[80:83], v[16:19], a[0:3]
  ds_read_b128 v[48:51], v6 offset:16384
  s_add_u32 m0, s52, 0
  v_mfma_f32_16x16x32_bf16 a[4:7], v[80:83], v[20:23], a[4:7]
  s_mov_b32 s70, 0
  v_mfma_f32_16x16x32_bf16 a[8:11], v[80:83], v[24:27], a[8:11]
  ds_read_b64_tr_b16 v[120:121], v7 offset:16384
  v_mfma_f32_16x16x32_bf16 a[12:15], v[80:83], v[28:31], a[12:15]
  v_mfma_f32_16x16x32_bf16 a[16:19], v[80:83], v[32:35], a[16:19]
  v_mfma_f32_16x16x32_bf16 a[20:23], v[80:83], v[36:39], a[20:23]
  ds_read_b64_tr_b16 v[122:123], v7 offset:18432
  v_mfma_f32_16x16x32_bf16 a[24:27], v[80:83], v[40:43], a[24:27]
  v_mfma_f32_16x16x32_bf16 a[28:31], v[80:83], v[44:47], a[28:31]
  ds_read_b128 v[52:55], v6 offset:17408
  v_mfma_f32_16x16x32_bf16 a[32:35], v[84:87], v[16:19], a[32:35]
  buffer_load_dwordx4 v188, s[12:15], s45 offen offset:0 sc1 lds
  v_mfma_f32_16x16x32_bf16 a[36:39], v[84:87], v[20:23], a[36:39]
  v_mfma_f32_16x16x32_bf16 a[40:43], v[84:87], v[24:27], a[40:43]
  ds_read_b64_tr_b16 v[124:125], v8 offset:16384
  v_mfma_f32_16x16x32_bf16 a[44:47], v[84:87], v[28:31], a[44:47]
  v_mfma_f32_16x16x32_bf16 a[48:51], v[84:87], v[32:35], a[48:51]
  ds_read_b64_tr_b16 v[126:127], v8 offset:18432
  v_mfma_f32_16x16x32_bf16 a[52:55], v[84:87], v[36:39], a[52:55]
  v_mfma_f32_16x16x32_bf16 a[56:59], v[84:87], v[40:43], a[56:59]
  buffer_load_dwordx4 v188, s[12:15], s45 offen offset:1024 sc1 lds
  v_mfma_f32_16x16x32_bf16 a[60:63], v[84:87], v[44:47], a[60:63]
  ds_read_b64_tr_b16 v[128:129], v7 offset:20480
  v_mfma_f32_16x16x32_bf16 a[64:67], v[16:19], v[88:91], a[64:67]
  v_mfma_f32_16x16x32_bf16 a[68:71], v[20:23], v[88:91], a[68:71]
  v_mfma_f32_16x16x32_bf16 a[72:75], v[24:27], v[88:91], a[72:75]
  ds_read_b128 v[56:59], v6 offset:18432
  v_mfma_f32_16x16x32_bf16 a[76:79], v[28:31], v[88:91], a[76:79]
  v_mfma_f32_16x16x32_bf16 a[80:83], v[32:35], v[88:91], a[80:83]
  ds_read_b64_tr_b16 v[130:131], v7 offset:22528
  v_mfma_f32_16x16x32_bf16 a[84:87], v[36:39], v[88:91], a[84:87]
  buffer_load_dwordx4 v188, s[12:15], s45 offen offset:2048 sc1 lds
  v_mfma_f32_16x16x32_bf16 a[88:91], v[40:43], v[88:91], a[88:91]
  v_mfma_f32_16x16x32_bf16 a[92:95], v[44:47], v[88:91], a[92:95]
  ds_read_b64_tr_b16 v[132:133], v8 offset:20480
  v_mfma_f32_16x16x32_bf16 a[96:99], v[16:19], v[92:95], a[96:99]
  v_mfma_f32_16x16x32_bf16 a[100:103], v[20:23], v[92:95], a[100:103]
  ds_read_b128 v[60:63], v6 offset:19456
  v_mfma_f32_16x16x32_bf16 a[104:107], v[24:27], v[92:95], a[104:107]
  v_mfma_f32_16x16x32_bf16 a[108:111], v[28:31], v[92:95], a[108:111]
  v_mfma_f32_16x16x32_bf16 a[112:115], v[32:35], v[92:95], a[112:115]
  ds_read_b64_tr_b16 v[134:135], v8 offset:22528
  v_mfma_f32_16x16x32_bf16 a[116:119], v[36:39], v[92:95], a[116:119]
  buffer_load_dwordx4 v188, s[12:15], s45 offen offset:3072 sc1 lds
  v_mfma_f32_16x16x32_bf16 a[120:123], v[40:43], v[92:95], a[120:123]
  ds_read_b64_tr_b16 v[136:137], v7 offset:24576
  v_mfma_f32_16x16x32_bf16 a[124:127], v[44:47], v[92:95], a[124:127]
  v_mfma_f32_16x16x32_bf16 a[128:131], v[96:99], v[16:19], a[128:131]
  v_mfma_f32_16x16x32_bf16 a[132:135], v[96:99], v[20:23], a[132:135]
  ds_read_b64_tr_b16 v[138:139], v7 offset:26624
  v_mfma_f32_16x16x32_bf16 a[136:139], v[96:99], v[24:27], a[136:139]
  v_mfma_f32_16x16x32_bf16 a[140:143], v[96:99], v[28:31], a[140:143]
  s_add_u32 s45, s45, 16384
  v_mfma_f32_16x16x32_bf16 a[144:147], v[96:99], v[32:35], a[144:147]
  ds_read_b128 v[64:67], v6 offset:20480
  v_mfma_f32_16x16x32_bf16 a[148:151], v[96:99], v[36:39], a[148:151]
  v_mfma_f32_16x16x32_bf16 a[152:155], v[96:99], v[40:43], a[152:155]
  ds_read_b64_tr_b16 v[140:141], v8 offset:24576
  v_mfma_f32_16x16x32_bf16 a[156:159], v[96:99], v[44:47], a[156:159]
  v_mfma_f32_16x16x32_bf16 a[160:163], v[100:103], v[16:19], a[160:163]
  buffer_load_dword v191, v190, s[32:35], s70 offen
  v_mfma_f32_16x16x32_bf16 a[164:167], v[100:103], v[20:23], a[164:167]
  ds_read_b64_tr_b16 v[142:143], v8 offset:26624
  v_mfma_f32_16x16x32_bf16 a[168:171], v[100:103], v[24:27], a[168:171]
  s_add_u32 m0, s53, 0
  v_mfma_f32_16x16x32_bf16 a[172:175], v[100:103], v[28:31], a[172:175]
  ds_read_b128 v[68:71], v6 offset:21504
  v_mfma_f32_16x16x32_bf16 a[176:179], v[100:103], v[32:35], a[176:179]
  v_mfma_f32_16x16x32_bf16 a[180:183], v[100:103], v[36:39], a[180:183]
  v_mfma_f32_16x16x32_bf16 a[184:187], v[100:103], v[40:43], a[184:187]
  ds_read_b64_tr_b16 v[144:145], v7 offset:28672
  v_mfma_f32_16x16x32_bf16 a[188:191], v[100:103], v[44:47], a[188:191]
  v_mfma_f32_16x16x32_bf16 a[192:195], v[104:107], v[16:19], a[192:195]
  ds_read_b64_tr_b16 v[146:147], v7 offset:30720
  v_mfma_f32_16x16x32_bf16 a[196:199], v[104:107], v[20:23], a[196:199]
  buffer_load_dwordx4 v2, s[16:19], s46 offen lds
  v_mfma_f32_16x16x32_bf16 a[200:203], v[104:107], v[24:27], a[200:203]
  v_mfma_f32_16x16x32_bf16 a[204:207], v[104:107], v[28:31], a[204:207]
  ds_read_b64_tr_b16 v[148:149], v8 offset:28672
  v_mfma_f32_16x16x32_bf16 a[208:211], v[104:107], v[32:35], a[208:211]
  v_mfma_f32_16x16x32_bf16 a[212:215], v[104:107], v[36:39], a[212:215]
  v_mfma_f32_16x16x32_bf16 a[216:219], v[104:107], v[40:43], a[216:219]
  ds_read_b128 v[72:75], v6 offset:22528
  v_mfma_f32_16x16x32_bf16 a[220:223], v[104:107], v[44:47], a[220:223]
  v_mfma_f32_16x16x32_bf16 a[224:227], v[108:111], v[16:19], a[224:227]
  ds_read_b64_tr_b16 v[150:151], v8 offset:30720
  s_add_u32 m0, s53, 4096
  v_mfma_f32_16x16x32_bf16 a[228:231], v[108:111], v[20:23], a[228:231]
  v_mfma_f32_16x16x32_bf16 a[232:235], v[108:111], v[24:27], a[232:235]
  v_mfma_f32_16x16x32_bf16 a[236:239], v[108:111], v[28:31], a[236:239]
  ds_read_b64_tr_b16 v[152:153], v9 offset:4096
  v_mfma_f32_16x16x32_bf16 a[240:243], v[108:111], v[32:35], a[240:243]
  v_mfma_f32_16x16x32_bf16 a[244:247], v[108:111], v[36:39], a[244:247]
  ds_read_b128 v[76:79], v6 offset:23552
  v_mfma_f32_16x16x32_bf16 a[248:251], v[108:111], v[40:43], a[248:251]
  v_mfma_f32_16x16x32_bf16 a[252:255], v[108:111], v[44:47], a[252:255]
  buffer_load_dwordx4 v2, s[20:23], s46 offen lds
  v_mfma_f32_16x16x32_bf16 v[192:195], v[112:115], v[16:19], v[192:195]
  ds_read_b64_tr_b16 v[154:155], v9 offset:6144
  v_mfma_f32_16x16x32_bf16 v[196:199], v[112:115], v[20:23], v[196:199]
  v_mfma_f32_16x16x32_bf16 v[200:203], v[112:115], v[24:27], v[200:203]
  ds_read_b64_tr_b16 v[156:157], v10 offset:4096
  v_mfma_f32_16x16x32_bf16 v[204:207], v[112:115], v[28:31], v[204:207]
  v_mfma_f32_16x16x32_bf16 v[208:211], v[112:115], v[32:35], v[208:211]
  v_mfma_f32_16x16x32_bf16 v[212:215], v[112:115], v[36:39], v[212:215]
  ds_read_b64_tr_b16 v[158:159], v10 offset:6144
  v_mfma_f32_16x16x32_bf16 v[216:219], v[112:115], v[40:43], v[216:219]
  s_add_u32 s46, s46, s48
  v_mfma_f32_16x16x32_bf16 v[220:223], v[112:115], v[44:47], v[220:223]
  v_mfma_f32_16x16x32_bf16 v[224:227], v[116:119], v[16:19], v[224:227]
  v_mfma_f32_16x16x32_bf16 v[228:231], v[116:119], v[20:23], v[228:231]
  v_mfma_f32_16x16x32_bf16 v[232:235], v[116:119], v[24:27], v[232:235]
  v_mfma_f32_16x16x32_bf16 v[236:239], v[116:119], v[28:31], v[236:239]
  v_mfma_f32_16x16x32_bf16 v[240:243], v[116:119], v[32:35], v[240:243]
  v_mfma_f32_16x16x32_bf16 v[244:247], v[116:119], v[36:39], v[244:247]
  v_mfma_f32_16x16x32_bf16 v[248:251], v[116:119], v[40:43], v[248:251]
  v_mfma_f32_16x16x32_bf16 v[252:255], v[116:119], v[44:47], v[252:255]
  s_waitcnt vmcnt(16) lgkmcnt(0)
  s_barrier
  v_mfma_f32_16x16x32_bf16 a[0:3], v[120:123], v[48:51], a[0:3]
  ds_read_b128 v[16:19], v6 offset:32768
  s_add_u32 m0, s52, 16384
  v_mfma_f32_16x16x32_bf16 a[4:7], v[120:123], v[52:55], a[4:7]
  s_mov_b32 s70, 2048
  v_mfma_f32_16x16x32_bf16 a[8:11], v[120:123], v[56:59], a[8:11]
  ds_read_b64_tr_b16 v[80:81], v7 offset:32768
  v_mfma_f32_16x16x32_bf16 a[12:15], v[120:123], v[60:63], a[12:15]
  v_mfma_f32_16x16x32_bf16 a[16:19], v[120:123], v[64:67], a[16:19]
  v_mfma_f32_16x16x32_bf16 a[20:23], v[120:123], v[68:71], a[20:23]
  ds_read_b64_tr_b16 v[82:83], v7 offset:34816
  v_mfma_f32_16x16x32_bf16 a[24:27], v[120:123], v[72:75], a[24:27]
  v_mfma_f32_16x16x32_bf16 a[28:31], v[120:123], v[76:79], a[28:31]
  ds_read_b128 v[20:23], v6 offset:33792
  v_mfma_f32_16x16x32_bf16 a[32:35], v[124:127], v[48:51], a[32:35]
  buffer_load_dwordx4 v188, s[12:15], s45 offen offset:0 sc1 lds
  v_mfma_f32_16x16x32_bf16 a[36:39], v[124:127], v[52:55], a[36:39]
  v_mfma_f32_16x16x32_bf16 a[40:43], v[124:127], v[56:59], a[40:43]
  ds_read_b64_tr_b16 v[84:85], v8 offset:32768
  v_mfma_f32_16x16x32_bf16 a[44:47], v[124:127], v[60:63], a[44:47]
  v_mfma_f32_16x16x32_bf16 a[48:51], v[124:127], v[64:67], a[48:51]
  ds_read_b64_tr_b16 v[86:87], v8 offset:34816
  v_mfma_f32_16x16x32_bf16 a[52:55], v[124:127], v[68:71], a[52:55]
  v_mfma_f32_16x16x32_bf16 a[56:59], v[124:127], v[72:75], a[56:59]
  buffer_load_dwordx4 v188, s[12:15], s45 offen offset:1024 sc1 lds
  v_mfma_f32_16x16x32_bf16 a[60:63], v[124:127], v[76:79], a[60:63]
  ds_read_b64_tr_b16 v[88:89], v7 offset:36864
  v_mfma_f32_16x16x32_bf16 a[64:67], v[48:51], v[128:131], a[64:67]
  v_mfma_f32_16x16x32_bf16 a[68:71], v[52:55], v[128:131], a[68:71]
  v_mfma_f32_16x16x32_bf16 a[72:75], v[56:59], v[128:131], a[72:75]
  ds_read_b128 v[24:27], v6 offset:34816
  v_mfma_f32_16x16x32_bf16 a[76:79], v[60:63], v[128:131], a[76:79]
  v_mfma_f32_16x16x32_bf16 a[80:83], v[64:67], v[128:131], a[80:83]
  ds_read_b64_tr_b16 v[90:91], v7 offset:38912
  v_mfma_f32_16x16x32_bf16 a[84:87], v[68:71], v[128:131], a[84:87]
  buffer_load_dwordx4 v188, s[12:15], s45 offen offset:2048 sc1 lds
  v_mfma_f32_16x16x32_bf16 a[88:91], v[72:75], v[128:131], a[88:91]
  v_mfma_f32_16x16x32_bf16 a[92:95], v[76:79], v[128:131], a[92:95]
  ds_read_b64_tr_b16 v[92:93], v8 offset:36864
  v_mfma_f32_16x16x32_bf16 a[96:99], v[48:51], v[132:135], a[96:99]
  v_mfma_f32_16x16x32_bf16 a[100:103], v[52:55], v[132:135], a[100:103]
  ds_read_b128 v[28:31], v6 offset:35840
  v_mfma_f32_16x16x32_bf16 a[104:107], v[56:59], v[132:135], a[104:107]
  v_mfma_f32_16x16x32_bf16 a[108:111], v[60:63], v[132:135], a[108:111]
  v_mfma_f32_16x16x32_bf16 a[112:115], v[64:67], v[132:135], a[112:115]
  ds_read_b64_tr_b16 v[94:95], v8 offset:38912
  v_mfma_f32_16x16x32_bf16 a[116:119], v[68:71], v[132:135], a[116:119]
  buffer_load_dwordx4 v188, s[12:15], s45 offen offset:3072 sc1 lds
  v_mfma_f32_16x16x32_bf16 a[120:123], v[72:75], v[132:135], a[120:123]
  ds_read_b64_tr_b16 v[96:97], v7 offset:40960
  v_mfma_f32_16x16x32_bf16 a[124:127], v[76:79], v[132:135], a[124:127]
  v_mfma_f32_16x16x32_bf16 a[128:131], v[136:139], v[48:51], a[128:131]
  v_mfma_f32_16x16x32_bf16 a[132:135], v[136:139], v[52:55], a[132:135]
  ds_read_b64_tr_b16 v[98:99], v7 offset:43008
  v_mfma_f32_16x16x32_bf16 a[136:139], v[136:139], v[56:59], a[136:139]
  v_mfma_f32_16x16x32_bf16 a[140:143], v[136:139], v[60:63], a[140:143]
  s_add_u32 s45, s45, 16384
  v_mfma_f32_16x16x32_bf16 a[144:147], v[136:139], v[64:67], a[144:147]
  ds_read_b128 v[32:35], v6 offset:36864
  v_mfma_f32_16x16x32_bf16 a[148:151], v[136:139], v[68:71], a[148:151]
  v_mfma_f32_16x16x32_bf16 a[152:155], v[136:139], v[72:75], a[152:155]
  ds_read_b64_tr_b16 v[100:101], v8 offset:40960
  v_mfma_f32_16x16x32_bf16 a[156:159], v[136:139], v[76:79], a[156:159]
  v_mfma_f32_16x16x32_bf16 a[160:163], v[140:143], v[48:51], a[160:163]
  buffer_load_dword v191, v190, s[32:35], s70 offen
  v_mfma_f32_16x16x32_bf16 a[164:167], v[140:143], v[52:55], a[164:167]
  ds_read_b64_tr_b16 v[102:103], v8 offset:43008
  v_mfma_f32_16x16x32_bf16 a[168:171], v[140:143], v[56:59], a[168:171]
  s_add_u32 m0, s53, 16384
  v_mfma_f32_16x16x32_bf16 a[172:175], v[140:143], v[60:63], a[172:175]
  ds_read_b128 v[36:39], v6 offset:37888
  v_mfma_f32_16x16x32_bf16 a[176:179], v[140:143], v[64:67], a[176:179]
  v_mfma_f32_16x16x32_bf16 a[180:183], v[140:143], v[68:71], a[180:183]
  v_mfma_f32_16x16x32_bf16 a[184:187], v[140:143], v[72:75], a[184:187]
  ds_read_b64_tr_b16 v[104:105], v7 offset:45056
  v_mfma_f32_16x16x32_bf16 a[188:191], v[140:143], v[76:79], a[188:191]
  v_mfma_f32_16x16x32_bf16 a[192:195], v[144:147], v[48:51], a[192:195]
  ds_read_b64_tr_b16 v[106:107], v7 offset:47104
  v_mfma_f32_16x16x32_bf16 a[196:199], v[144:147], v[52:55], a[196:199]
  buffer_load_dwordx4 v2, s[16:19], s46 offen lds
  v_mfma_f32_16x16x32_bf16 a[200:203], v[144:147], v[56:59], a[200:203]
  v_mfma_f32_16x16x32_bf16 a[204:207], v[144:147], v[60:63], a[204:207]
  ds_read_b64_tr_b16 v[108:109], v8 offset:45056
  v_mfma_f32_16x16x32_bf16 a[208:211], v[144:147], v[64:67], a[208:211]
  v_mfma_f32_16x16x32_bf16 a[212:215], v[144:147], v[68:71], a[212:215]
  v_mfma_f32_16x16x32_bf16 a[216:219], v[144:147], v[72:75], a[216:219]
  ds_read_b128 v[40:43], v6 offset:38912
  v_mfma_f32_16x16x32_bf16 a[220:223], v[144:147], v[76:79], a[220:223]
  v_mfma_f32_16x16x32_bf16 a[224:227], v[148:151], v[48:51], a[224:227]
  ds_read_b64_tr_b16 v[110:111], v8 offset:47104
  s_add_u32 m0, s53, 20480
  v_mfma_f32_16x16x32_bf16 a[228:231], v[148:151], v[52:55], a[228:231]
  v_mfma_f32_16x16x32_bf16 a[232:235], v[148:151], v[56:59], a[232:235]
  v_mfma_f32_16x16x32_bf16 a[236:239], v[148:151], v[60:63], a[236:239]
  ds_read_b64_tr_b16 v[112:113], v9 offset:8192
  v_mfma_f32_16x16x32_bf16 a[240:243], v[148:151], v[64:67], a[240:243]
  v_mfma_f32_16x16x32_bf16 a[244:247], v[148:151], v[68:71], a[244:247]
  ds_read_b128 v[44:47], v6 offset:39936
  v_mfma_f32_16x16x32_bf16 a[248:251], v[148:151], v[72:75], a[248:251]
  v_mfma_f32_16x16x32_bf16 a[252:255], v[148:151], v[76:79], a[252:255]
  buffer_load_dwordx4 v2, s[20:23], s46 offen lds
  v_mfma_f32_16x16x32_bf16 v[192:195], v[152:155], v[48:51], v[192:195]
  ds_read_b64_tr_b16 v[114:115], v9 offset:10240
  v_mfma_f32_16x16x32_bf16 v[196:199], v[152:155], v[52:55], v[196:199]
  v_mfma_f32_16x16x32_bf16 v[200:203], v[152:155], v[56:59], v[200:203]
  ds_read_b64_tr_b16 v[116:117], v10 offset:8192
  v_mfma_f32_16x16x32_bf16 v[204:207], v[152:155], v[60:63], v[204:207]
  v_mfma_f32_16x16x32_bf16 v[208:211], v[152:155], v[64:67], v[208:211]
  v_mfma_f32_16x16x32_bf16 v[212:215], v[152:155], v[68:71], v[212:215]
  ds_read_b64_tr_b16 v[118:119], v10 offset:10240
  v_mfma_f32_16x16x32_bf16 v[216:219], v[152:155], v[72:75], v[216:219]
  s_add_u32 s46, s46, s48
  v_mfma_f32_16x16x32_bf16 v[220:223], v[152:155], v[76:79], v[220:223]
  v_mfma_f32_16x16x32_bf16 v[224:227], v[156:159], v[48:51], v[224:227]
  v_mfma_f32_16x16x32_bf16 v[228:231], v[156:159], v[52:55], v[228:231]
  v_mfma_f32_16x16x32_bf16 v[232:235], v[156:159], v[56:59], v[232:235]
  v_mfma_f32_16x16x32_bf16 v[236:239], v[156:159], v[60:63], v[236:239]
  v_mfma_f32_16x16x32_bf16 v[240:243], v[156:159], v[64:67], v[240:243]
  v_mfma_f32_16x16x32_bf16 v[244:247], v[156:159], v[68:71], v[244:247]
  v_mfma_f32_16x16x32_bf16 v[248:251], v[156:159], v[72:75], v[248:251]
  v_mfma_f32_16x16x32_bf16 v[252:255], v[156:159], v[76:79], v[252:255]
  s_waitcnt vmcnt(14) lgkmcnt(0)
  s_barrier
  v_mfma_f32_16x16x32_bf16 a[0:3], v[80:83], v[16:19], a[0:3]
  ds_read_b128 v[48:51], v6 offset:49152
  s_add_u32 m0, s52, 32768
  v_mfma_f32_16x16x32_bf16 a[4:7], v[80:83], v[20:23], a[4:7]
  s_mov_b32 s70, 4096
  v_mfma_f32_16x16x32_bf16 a[8:11], v[80:83], v[24:27], a[8:11]
  ds_read_b64_tr_b16 v[120:121], v7 offset:49152
  v_mfma_f32_16x16x32_bf16 a[12:15], v[80:83], v[28:31], a[12:15]
  v_mfma_f32_16x16x32_bf16 a[16:19], v[80:83], v[32:35], a[16:19]
  v_mfma_f32_16x16x32_bf16 a[20:23], v[80:83], v[36:39], a[20:23]
  ds_read_b64_tr_b16 v[122:123], v7 offset:51200
  v_mfma_f32_16x16x32_bf16 a[24:27], v[80:83], v[40:43], a[24:27]
  v_mfma_f32_16x16x32_bf16 a[28:31], v[80:83], v[44:47], a[28:31]
  ds_read_b128 v[52:55], v6 offset:50176
  v_mfma_f32_16x16x32_bf16 a[32:35], v[84:87], v[16:19], a[32:35]
  buffer_load_dwordx4 v188, s[12:15], s45 offen offset:0 sc1 lds
  v_mfma_f32_16x16x32_bf16 a[36:39], v[84:87], v[20:23], a[36:39]
  v_mfma_f32_16x16x32_bf16 a[40:43], v[84:87], v[24:27], a[40:43]
  ds_read_b64_tr_b16 v[124:125], v8 offset:49152
  v_mfma_f32_16x16x32_bf16 a[44:47], v[84:87], v[28:31], a[44:47]
  v_mfma_f32_16x16x32_bf16 a[48:51], v[84:87], v[32:35], a[48:51]
  ds_read_b64_tr_b16 v[126:127], v8 offset:51200
  v_mfma_f32_16x16x32_bf16 a[52:55], v[84:87], v[36:39], a[52:55]
  v_mfma_f32_16x16x32_bf16 a[56:59], v[84:87], v[40:43], a[56:59]
  buffer_load_dwordx4 v188, s[12:15], s45 offen offset:1024 sc1 lds
  v_mfma_f32_16x16x32_bf16 a[60:63], v[84:87], v[44:47], a[60:63]
  ds_read_b64_tr_b16 v[128:129], v7 offset:53248
  v_mfma_f32_16x16x32_bf16 a[64:67], v[16:19], v[88:91], a[64:67]
  v_mfma_f32_16x16x32_bf16 a[68:71], v[20:23], v[88:91], a[68:71]
  v_mfma_f32_16x16x32_bf16 a[72:75], v[24:27], v[88:91], a[72:75]
  ds_read_b128 v[56:59], v6 offset:51200
  v_mfma_f32_16x16x32_bf16 a[76:79], v[28:31], v[88:91], a[76:79]
  v_mfma_f32_16x16x32_bf16 a[80:83], v[32:35], v[88:91], a[80:83]
  ds_read_b64_tr_b16 v[130:131], v7 offset:55296
  v_mfma_f32_16x16x32_bf16 a[84:87], v[36:39], v[88:91], a[84:87]
  buffer_load_dwordx4 v188, s[12:15], s45 offen offset:2048 sc1 lds
  v_mfma_f32_16x16x32_bf16 a[88:91], v[40:43], v[88:91], a[88:91]
  v_mfma_f32_16x16x32_bf16 a[92:95], v[44:47], v[88:91], a[92:95]
  ds_read_b64_tr_b16 v[132:133], v8 offset:53248
  v_mfma_f32_16x16x32_bf16 a[96:99], v[16:19], v[92:95], a[96:99]
  v_mfma_f32_16x16x32_bf16 a[100:103], v[20:23], v[92:95], a[100:103]
  ds_read_b128 v[60:63], v6 offset:52224
  v_mfma_f32_16x16x32_bf16 a[104:107], v[24:27], v[92:95], a[104:107]
  v_mfma_f32_16x16x32_bf16 a[108:111], v[28:31], v[92:95], a[108:111]
  v_mfma_f32_16x16x32_bf16 a[112:115], v[32:35], v[92:95], a[112:115]
  ds_read_b64_tr_b16 v[134:135], v8 offset:55296
  v_mfma_f32_16x16x32_bf16 a[116:119], v[36:39], v[92:95], a[116:119]
  buffer_load_dwordx4 v188, s[12:15], s45 offen offset:3072 sc1 lds
  v_mfma_f32_16x16x32_bf16 a[120:123], v[40:43], v[92:95], a[120:123]
  ds_read_b64_tr_b16 v[136:137], v7 offset:57344
  v_mfma_f32_16x16x32_bf16 a[124:127], v[44:47], v[92:95], a[124:127]
  v_mfma_f32_16x16x32_bf16 a[128:131], v[96:99], v[16:19], a[128:131]
  v_mfma_f32_16x16x32_bf16 a[132:135], v[96:99], v[20:23], a[132:135]
  ds_read_b64_tr_b16 v[138:139], v7 offset:59392
  v_mfma_f32_16x16x32_bf16 a[136:139], v[96:99], v[24:27], a[136:139]
  v_mfma_f32_16x16x32_bf16 a[140:143], v[96:99], v[28:31], a[140:143]
  s_add_u32 s45, s45, 16384
  v_mfma_f32_16x16x32_bf16 a[144:147], v[96:99], v[32:35], a[144:147]
  ds_read_b128 v[64:67], v6 offset:53248
  v_mfma_f32_16x16x32_bf16 a[148:151], v[96:99], v[36:39], a[148:151]
  v_mfma_f32_16x16x32_bf16 a[152:155], v[96:99], v[40:43], a[152:155]
  ds_read_b64_tr_b16 v[140:141], v8 offset:57344
  v_mfma_f32_16x16x32_bf16 a[156:159], v[96:99], v[44:47], a[156:159]
  v_mfma_f32_16x16x32_bf16 a[160:163], v[100:103], v[16:19], a[160:163]
  buffer_load_dword v191, v190, s[32:35], s70 offen
  v_mfma_f32_16x16x32_bf16 a[164:167], v[100:103], v[20:23], a[164:167]
  ds_read_b64_tr_b16 v[142:143], v8 offset:59392
  v_mfma_f32_16x16x32_bf16 a[168:171], v[100:103], v[24:27], a[168:171]
  s_add_u32 m0, s53, 32768
  v_mfma_f32_16x16x32_bf16 a[172:175], v[100:103], v[28:31], a[172:175]
  ds_read_b128 v[68:71], v6 offset:54272
  v_mfma_f32_16x16x32_bf16 a[176:179], v[100:103], v[32:35], a[176:179]
  v_mfma_f32_16x16x32_bf16 a[180:183], v[100:103], v[36:39], a[180:183]
  v_mfma_f32_16x16x32_bf16 a[184:187], v[100:103], v[40:43], a[184:187]
  ds_read_b64_tr_b16 v[144:145], v7 offset:61440
  v_mfma_f32_16x16x32_bf16 a[188:191], v[100:103], v[44:47], a[188:191]
  v_mfma_f32_16x16x32_bf16 a[192:195], v[104:107], v[16:19], a[192:195]
  ds_read_b64_tr_b16 v[146:147], v7 offset:63488
  v_mfma_f32_16x16x32_bf16 a[196:199], v[104:107], v[20:23], a[196:199]
  buffer_load_dwordx4 v2, s[16:19], s46 offen lds
  v_mfma_f32_16x16x32_bf16 a[200:203], v[104:107], v[24:27], a[200:203]
  v_mfma_f32_16x16x32_bf16 a[204:207], v[104:107], v[28:31], a[204:207]
  ds_read_b64_tr_b16 v[148:149], v8 offset:61440
  v_mfma_f32_16x16x32_bf16 a[208:211], v[104:107], v[32:35], a[208:211]
  v_mfma_f32_16x16x32_bf16 a[212:215], v[104:107], v[36:39], a[212:215]
  v_mfma_f32_16x16x32_bf16 a[216:219], v[104:107], v[40:43], a[216:219]
  ds_read_b128 v[72:75], v6 offset:55296
  v_mfma_f32_16x16x32_bf16 a[220:223], v[104:107], v[44:47], a[220:223]
  v_mfma_f32_16x16x32_bf16 a[224:227], v[108:111], v[16:19], a[224:227]
  ds_read_b64_tr_b16 v[150:151], v8 offset:63488
  s_add_u32 m0, s53, 36864
  v_mfma_f32_16x16x32_bf16 a[228:231], v[108:111], v[20:23], a[228:231]
  v_mfma_f32_16x16x32_bf16 a[232:235], v[108:111], v[24:27], a[232:235]
  v_mfma_f32_16x16x32_bf16 a[236:239], v[108:111], v[28:31], a[236:239]
  ds_read_b64_tr_b16 v[152:153], v9 offset:12288
  v_mfma_f32_16x16x32_bf16 a[240:243], v[108:111], v[32:35], a[240:243]
  v_mfma_f32_16x16x32_bf16 a[244:247], v[108:111], v[36:39], a[244:247]
  ds_read_b128 v[76:79], v6 offset:56320
  v_mfma_f32_16x16x32_bf16 a[248:251], v[108:111], v[40:43], a[248:251]
  v_mfma_f32_16x16x32_bf16 a[252:255], v[108:111], v[44:47], a[252:255]
  buffer_load_dwordx4 v2, s[20:23], s46 offen lds
  v_mfma_f32_16x16x32_bf16 v[192:195], v[112:115], v[16:19], v[192:195]
  ds_read_b64_tr_b16 v[154:155], v9 offset:14336
  v_mfma_f32_16x16x32_bf16 v[196:199], v[112:115], v[20:23], v[196:199]
  v_mfma_f32_16x16x32_bf16 v[200:203], v[112:115], v[24:27], v[200:203]
  ds_read_b64_tr_b16 v[156:157], v10 offset:12288
  v_mfma_f32_16x16x32_bf16 v[204:207], v[112:115], v[28:31], v[204:207]
  v_mfma_f32_16x16x32_bf16 v[208:211], v[112:115], v[32:35], v[208:211]
  v_mfma_f32_16x16x32_bf16 v[212:215], v[112:115], v[36:39], v[212:215]
  ds_read_b64_tr_b16 v[158:159], v10 offset:14336
  v_mfma_f32_16x16x32_bf16 v[216:219], v[112:115], v[40:43], v[216:219]
  s_add_u32 s46, s46, s48
  v_mfma_f32_16x16x32_bf16 v[220:223], v[112:115], v[44:47], v[220:223]
  v_mfma_f32_16x16x32_bf16 v[224:227], v[116:119], v[16:19], v[224:227]
  v_mfma_f32_16x16x32_bf16 v[228:231], v[116:119], v[20:23], v[228:231]
  v_mfma_f32_16x16x32_bf16 v[232:235], v[116:119], v[24:27], v[232:235]
  v_mfma_f32_16x16x32_bf16 v[236:239], v[116:119], v[28:31], v[236:239]
  v_mfma_f32_16x16x32_bf16 v[240:243], v[116:119], v[32:35], v[240:243]
  v_mfma_f32_16x16x32_bf16 v[244:247], v[116:119], v[36:39], v[244:247]
  v_mfma_f32_16x16x32_bf16 v[248:251], v[116:119], v[40:43], v[248:251]
  v_mfma_f32_16x16x32_bf16 v[252:255], v[116:119], v[44:47], v[252:255]
  s_waitcnt vmcnt(14) lgkmcnt(0)
  s_barrier
  v_mfma_f32_16x16x32_bf16 a[0:3], v[120:123], v[48:51], a[0:3]
  ds_read_b128 v[16:19], v6 offset:0
  s_add_u32 m0, s52, 49152
  v_mfma_f32_16x16x32_bf16 a[4:7], v[120:123], v[52:55], a[4:7]
  s_mov_b32 s70, 6144
  v_mfma_f32_16x16x32_bf16 a[8:11], v[120:123], v[56:59], a[8:11]
  v_mfma_f32_16x16x32_bf16 a[12:15], v[120:123], v[60:63], a[12:15]
  v_mfma_f32_16x16x32_bf16 a[16:19], v[120:123], v[64:67], a[16:19]
  ds_read_b64_tr_b16 v[80:81], v7 offset:0
  v_mfma_f32_16x16x32_bf16 a[20:23], v[120:123], v[68:71], a[20:23]
  v_mfma_f32_16x16x32_bf16 a[24:27], v[120:123], v[72:75], a[24:27]
  v_mfma_f32_16x16x32_bf16 a[28:31], v[120:123], v[76:79], a[28:31]
  buffer_load_dwordx4 v188, s[12:15], s45 offen offset:0 sc1 lds
  v_mfma_f32_16x16x32_bf16 a[32:35], v[124:127], v[48:51], a[32:35]
  v_mfma_f32_16x16x32_bf16 a[36:39], v[124:127], v[52:55], a[36:39]
  ds_read_b128 v[20:23], v6 offset:1024
  v_mfma_f32_16x16x32_bf16 a[40:43], v[124:127], v[56:59], a[40:43]
  v_mfma_f32_16x16x32_bf16 a[44:47], v[124:127], v[60:63], a[44:47]
  v_mfma_f32_16x16x32_bf16 a[48:51], v[124:127], v[64:67], a[48:51]
  v_mfma_f32_16x16x32_bf16 a[52:55], v[124:127], v[68:71], a[52:55]
  ds_read_b64_tr_b16 v[82:83], v7 offset:2048
  v_mfma_f32_16x16x32_bf16 a[56:59], v[124:127], v[72:75], a[56:59]
  buffer_load_dwordx4 v188, s[12:15], s45 offen offset:1024 sc1 lds
  v_mfma_f32_16x16x32_bf16 a[60:63], v[124:127], v[76:79], a[60:63]
  v_mfma_f32_16x16x32_bf16 a[64:67], v[48:51], v[128:131], a[64:67]
  v_mfma_f32_16x16x32_bf16 a[68:71], v[52:55], v[128:131], a[68:71]
  v_mfma_f32_16x16x32_bf16 a[72:75], v[56:59], v[128:131], a[72:75]
  ds_read_b128 v[24:27], v6 offset:2048
  v_mfma_f32_16x16x32_bf16 a[76:79], v[60:63], v[128:131], a[76:79]
  v_mfma_f32_16x16x32_bf16 a[80:83], v[64:67], v[128:131], a[80:83]
  v_mfma_f32_16x16x32_bf16 a[84:87], v[68:71], v[128:131], a[84:87]
  buffer_load_dwordx4 v188, s[12:15], s45 offen offset:2048 sc1 lds
  v_mfma_f32_16x16x32_bf16 a[88:91], v[72:75], v[128:131], a[88:91]
  ds_read_b64_tr_b16 v[84:85], v8 offset:0
  v_mfma_f32_16x16x32_bf16 a[92:95], v[76:79], v[128:131], a[92:95]
  v_mfma_f32_16x16x32_bf16 a[96:99], v[48:51], v[132:135], a[96:99]
  v_mfma_f32_16x16x32_bf16 a[100:103], v[52:55], v[132:135], a[100:103]
  v_mfma_f32_16x16x32_bf16 a[104:107], v[56:59], v[132:135], a[104:107]
  v_mfma_f32_16x16x32_bf16 a[108:111], v[60:63], v[132:135], a[108:111]
  ds_read_b128 v[28:31], v6 offset:3072
  v_mfma_f32_16x16x32_bf16 a[112:115], v[64:67], v[132:135], a[112:115]
  buffer_load_dwordx4 v188, s[12:15], s45 offen offset:3072 sc1 lds
  v_mfma_f32_16x16x32_bf16 a[116:119], v[68:71], v[132:135], a[116:119]
  v_mfma_f32_16x16x32_bf16 a[120:123], v[72:75], v[132:135], a[120:123]
  v_mfma_f32_16x16x32_bf16 a[124:127], v[76:79], v[132:135], a[124:127]
  ds_read_b64_tr_b16 v[86:87], v8 offset:2048
  v_mfma_f32_16x16x32_bf16 a[128:131], v[136:139], v[48:51], a[128:131]
  v_mfma_f32_16x16x32_bf16 a[132:135], v[136:139], v[52:55], a[132:135]
  v_mfma_f32_16x16x32_bf16 a[136:139], v[136:139], v[56:59], a[136:139]
  v_mfma_f32_16x16x32_bf16 a[140:143], v[136:139], v[60:63], a[140:143]
  s_add_u32 s45, s45, 16384
  v_mfma_f32_16x16x32_bf16 a[144:147], v[136:139], v[64:67], a[144:147]
  ds_read_b128 v[32:35], v6 offset:4096
  v_mfma_f32_16x16x32_bf16 a[148:151], v[136:139], v[68:71], a[148:151]
  v_mfma_f32_16x16x32_bf16 a[152:155], v[136:139], v[72:75], a[152:155]
  v_mfma_f32_16x16x32_bf16 a[156:159], v[136:139], v[76:79], a[156:159]
  v_mfma_f32_16x16x32_bf16 a[160:163], v[140:143], v[48:51], a[160:163]
  ds_read_b64_tr_b16 v[88:89], v7 offset:4096
  v_mfma_f32_16x16x32_bf16 a[164:167], v[140:143], v[52:55], a[164:167]
  buffer_load_dword v191, v190, s[32:35], s70 offen
  v_mfma_f32_16x16x32_bf16 a[168:171], v[140:143], v[56:59], a[168:171]
  s_add_u32 m0, s53, 49152
  v_mfma_f32_16x16x32_bf16 a[172:175], v[140:143], v[60:63], a[172:175]
  v_mfma_f32_16x16x32_bf16 a[176:179], v[140:143], v[64:67], a[176:179]
  v_mfma_f32_16x16x32_bf16 a[180:183], v[140:143], v[68:71], a[180:183]
  ds_read_b128 v[36:39], v6 offset:5120
  v_mfma_f32_16x16x32_bf16 a[184:187], v[140:143], v[72:75], a[184:187]
  v_mfma_f32_16x16x32_bf16 a[188:191], v[140:143], v[76:79], a[188:191]
  v_mfma_f32_16x16x32_bf16 a[192:195], v[144:147], v[48:51], a[192:195]
  v_mfma_f32_16x16x32_bf16 a[196:199], v[144:147], v[52:55], a[196:199]
  ds_read_b64_tr_b16 v[90:91], v7 offset:6144
  v_mfma_f32_16x16x32_bf16 a[200:203], v[144:147], v[56:59], a[200:203]
  buffer_load_dwordx4 v2, s[16:19], s46 offen lds
  v_mfma_f32_16x16x32_bf16 a[204:207], v[144:147], v[60:63], a[204:207]
  v_mfma_f32_16x16x32_bf16 a[208:211], v[144:147], v[64:67], a[208:211]
  v_mfma_f32_16x16x32_bf16 a[212:215], v[144:147], v[68:71], a[212:215]
  v_mfma_f32_16x16x32_bf16 a[216:219], v[144:147], v[72:75], a[216:219]
  ds_read_b128 v[40:43], v6 offset:6144
  v_mfma_f32_16x16x32_bf16 a[220:223], v[144:147], v[76:79], a[220:223]
  v_mfma_f32_16x16x32_bf16 a[224:227], v[148:151], v[48:51], a[224:227]
  s_add_u32 m0, s53, 53248
  v_mfma_f32_16x16x32_bf16 a[228:231], v[148:151], v[52:55], a[228:231]
  v_mfma_f32_16x16x32_bf16 a[232:235], v[148:151], v[56:59], a[232:235]
  ds_read_b64_tr_b16 v[92:93], v8 offset:4096
  v_mfma_f32_16x16x32_bf16 a[236:239], v[148:151], v[60:63], a[236:239]
  v_mfma_f32_16x16x32_bf16 a[240:243], v[148:151], v[64:67], a[240:243]
  v_mfma_f32_16x16x32_bf16 a[244:247], v[148:151], v[68:71], a[244:247]
  v_mfma_f32_16x16x32_bf16 a[248:251], v[148:151], v[72:75], a[248:251]
  v_mfma_f32_16x16x32_bf16 a[252:255], v[148:151], v[76:79], a[252:255]
  ds_read_b128 v[44:47], v6 offset:7168
  v_mfma_f32_16x16x32_bf16 v[192:195], v[152:155], v[48:51], v[192:195]
  buffer_load_dwordx4 v2, s[20:23], s46 offen lds
  v_mfma_f32_16x16x32_bf16 v[196:199], v[152:155], v[52:55], v[196:199]
  v_mfma_f32_16x16x32_bf16 v[200:203], v[152:155], v[56:59], v[200:203]
  v_mfma_f32_16x16x32_bf16 v[204:207], v[152:155], v[60:63], v[204:207]
  ds_read_b64_tr_b16 v[94:95], v8 offset:6144
  v_mfma_f32_16x16x32_bf16 v[208:211], v[152:155], v[64:67], v[208:211]
  v_mfma_f32_16x16x32_bf16 v[212:215], v[152:155], v[68:71], v[212:215]
  v_mfma_f32_16x16x32_bf16 v[216:219], v[152:155], v[72:75], v[216:219]
  s_add_u32 s46, s46, s48
  v_mfma_f32_16x16x32_bf16 v[220:223], v[152:155], v[76:79], v[220:223]
  v_mfma_f32_16x16x32_bf16 v[224:227], v[156:159], v[48:51], v[224:227]
  v_mfma_f32_16x16x32_bf16 v[228:231], v[156:159], v[52:55], v[228:231]
  v_mfma_f32_16x16x32_bf16 v[232:235], v[156:159], v[56:59], v[232:235]
  v_mfma_f32_16x16x32_bf16 v[236:239], v[156:159], v[60:63], v[236:239]
  v_mfma_f32_16x16x32_bf16 v[240:243], v[156:159], v[64:67], v[240:243]
  v_mfma_f32_16x16x32_bf16 v[244:247], v[156:159], v[68:71], v[244:247]
  v_mfma_f32_16x16x32_bf16 v[248:251], v[156:159], v[72:75], v[248:251]
  v_mfma_f32_16x16x32_bf16 v[252:255], v[156:159], v[76:79], v[252:255]
  s_waitcnt vmcnt(14) lgkmcnt(0)
  s_barrier
  v_mfma_f32_16x16x32_bf16 a[0:3], v[80:83], v[16:19], a[0:3]
  ds_read_b128 v[48:51], v6 offset:16384
  s_add_u32 m0, s52, 0
  v_mfma_f32_16x16x32_bf16 a[4:7], v[80:83], v[20:23], a[4:7]
  ds_read_b64_tr_b16 v[120:121], v7 offset:16384
  v_mfma_f32_16x16x32_bf16 a[8:11], v[80:83], v[24:27], a[8:11]
  s_mov_b32 s36, s68
  s_mov_b32 s37, s69
  s_mov_b32 s38, 8192
  s_mov_b32 s39, 0x20000
  v_mfma_f32_16x16x32_bf16 a[12:15], v[80:83], v[28:31], a[12:15]
  buffer_load_dwordx4 v188, s[12:15], s45 offen offset:0 sc1 lds
  v_mfma_f32_16x16x32_bf16 a[16:19], v[80:83], v[32:35], a[16:19]
  ds_read_b128 v[52:55], v6 offset:17408
  ds_read_b64_tr_b16 v[122:123], v7 offset:18432
  v_mfma_f32_16x16x32_bf16 a[20:23], v[80:83], v[36:39], a[20:23]
  buffer_load_dwordx4 v188, s[12:15], s45 offen offset:1024 sc1 lds
  v_mfma_f32_16x16x32_bf16 a[24:27], v[80:83], v[40:43], a[24:27]
  ds_read_b128 v[56:59], v6 offset:18432
  v_mfma_f32_16x16x32_bf16 a[28:31], v[80:83], v[44:47], a[28:31]
  ds_read_b64_tr_b16 v[124:125], v8 offset:16384
  v_mfma_f32_16x16x32_bf16 a[32:35], v[84:87], v[16:19], a[32:35]
  buffer_load_dwordx4 v188, s[12:15], s45 offen offset:2048 sc1 lds
  v_mfma_f32_16x16x32_bf16 a[36:39], v[84:87], v[20:23], a[36:39]
  ds_read_b128 v[60:63], v6 offset:19456
  v_mfma_f32_16x16x32_bf16 a[40:43], v[84:87], v[24:27], a[40:43]
  ds_read_b64_tr_b16 v[126:127], v8 offset:18432
  v_mfma_f32_16x16x32_bf16 a[44:47], v[84:87], v[28:31], a[44:47]
  buffer_load_dwordx4 v188, s[12:15], s45 offen offset:3072 sc1 lds
  v_mfma_f32_16x16x32_bf16 a[48:51], v[84:87], v[32:35], a[48:51]
  ds_read_b128 v[64:67], v6 offset:20480
  v_mfma_f32_16x16x32_bf16 a[52:55], v[84:87], v[36:39], a[52:55]
  ds_read_b64_tr_b16 v[128:129], v7 offset:20480
  s_add_u32 s45, s45, 16384
  v_mfma_f32_16x16x32_bf16 a[56:59], v[84:87], v[40:43], a[56:59]
  v_mfma_f32_16x16x32_bf16 a[60:63], v[84:87], v[44:47], a[60:63]
  ds_read_b128 v[68:71], v6 offset:21504
  v_mfma_f32_16x16x32_bf16 a[64:67], v[16:19], v[88:91], a[64:67]
  ds_read_b64_tr_b16 v[130:131], v7 offset:22528
  s_add_u32 m0, s53, 0
  v_mfma_f32_16x16x32_bf16 a[68:71], v[20:23], v[88:91], a[68:71]
  buffer_load_dword v191, v15, s[36:39], 0 offen
  v_mfma_f32_16x16x32_bf16 a[72:75], v[24:27], v[88:91], a[72:75]
  ds_read_b128 v[72:75], v6 offset:22528
  v_mfma_f32_16x16x32_bf16 a[76:79], v[28:31], v[88:91], a[76:79]
  ds_read_b64_tr_b16 v[132:133], v8 offset:20480
  v_mfma_f32_16x16x32_bf16 a[80:83], v[32:35], v[88:91], a[80:83]
  buffer_load_dwordx4 v2, s[16:19], s46 offen lds
  v_mfma_f32_16x16x32_bf16 a[84:87], v[36:39], v[88:91], a[84:87]
  ds_read_b128 v[76:79], v6 offset:23552
  s_add_u32 m0, s53, 4096
  v_mfma_f32_16x16x32_bf16 a[88:91], v[40:43], v[88:91], a[88:91]
  ds_read_b64_tr_b16 v[134:135], v8 offset:22528
  v_mfma_f32_16x16x32_bf16 a[92:95], v[44:47], v[88:91], a[92:95]
  v_mfma_f32_16x16x32_bf16 a[96:99], v[16:19], v[92:95], a[96:99]
  buffer_load_dwordx4 v2, s[20:23], s46 offen lds
  v_mfma_f32_16x16x32_bf16 a[100:103], v[20:23], v[92:95], a[100:103]
  v_mfma_f32_16x16x32_bf16 a[104:107], v[24:27], v[92:95], a[104:107]
  v_mfma_f32_16x16x32_bf16 a[108:111], v[28:31], v[92:95], a[108:111]
  s_add_u32 s46, s46, s48
  v_mfma_f32_16x16x32_bf16 a[112:115], v[32:35], v[92:95], a[112:115]
  v_mfma_f32_16x16x32_bf16 a[116:119], v[36:39], v[92:95], a[116:119]
  v_mfma_f32_16x16x32_bf16 a[120:123], v[40:43], v[92:95], a[120:123]
  v_mfma_f32_16x16x32_bf16 a[124:127], v[44:47], v[92:95], a[124:127]
  s_waitcnt vmcnt(14) lgkmcnt(0)
  s_barrier
  v_mfma_f32_16x16x32_bf16 a[0:3], v[120:123], v[48:51], a[0:3]
  ds_read_b128 v[16:19], v6 offset:32768
  s_add_u32 m0, s52, 16384
  v_mfma_f32_16x16x32_bf16 a[4:7], v[120:123], v[52:55], a[4:7]
  ds_read_b64_tr_b16 v[80:81], v7 offset:32768
  v_mfma_f32_16x16x32_bf16 a[8:11], v[120:123], v[56:59], a[8:11]
  buffer_load_dwordx4 v188, s[12:15], s45 offen offset:0 sc1 lds
  v_mfma_f32_16x16x32_bf16 a[12:15], v[120:123], v[60:63], a[12:15]
  ds_read_b128 v[20:23], v6 offset:33792
  v_mfma_f32_16x16x32_bf16 a[16:19], v[120:123], v[64:67], a[16:19]
  ds_read_b64_tr_b16 v[82:83], v7 offset:34816
  v_mfma_f32_16x16x32_bf16 a[20:23], v[120:123], v[68:71], a[20:23]
  buffer_load_dwordx4 v188, s[12:15], s45 offen offset:1024 sc1 lds
  v_mfma_f32_16x16x32_bf16 a[24:27], v[120:123], v[72:75], a[24:27]
  ds_read_b128 v[24:27], v6 offset:34816
  v_mfma_f32_16x16x32_bf16 a[28:31], v[120:123], v[76:79], a[28:31]
  ds_read_b64_tr_b16 v[84:85], v8 offset:32768
  v_mfma_f32_16x16x32_bf16 a[32:35], v[124:127], v[48:51], a[32:35]
  buffer_load_dwordx4 v188, s[12:15], s45 offen offset:2048 sc1 lds
  v_mfma_f32_16x16x32_bf16 a[36:39], v[124:127], v[52:55], a[36:39]
  ds_read_b128 v[28:31], v6 offset:35840
  v_mfma_f32_16x16x32_bf16 a[40:43], v[124:127], v[56:59], a[40:43]
  ds_read_b64_tr_b16 v[86:87], v8 offset:34816
  v_mfma_f32_16x16x32_bf16 a[44:47], v[124:127], v[60:63], a[44:47]
  buffer_load_dwordx4 v188, s[12:15], s45 offen offset:3072 sc1 lds
  v_mfma_f32_16x16x32_bf16 a[48:51], v[124:127], v[64:67], a[48:51]
  ds_read_b128 v[32:35], v6 offset:36864
  v_mfma_f32_16x16x32_bf16 a[52:55], v[124:127], v[68:71], a[52:55]
  ds_read_b64_tr_b16 v[88:89], v7 offset:36864
  s_add_u32 s45, s45, 16384
  v_mfma_f32_16x16x32_bf16 a[56:59], v[124:127], v[72:75], a[56:59]
  v_mfma_f32_16x16x32_bf16 a[60:63], v[124:127], v[76:79], a[60:63]
  ds_read_b128 v[36:39], v6 offset:37888
  v_mfma_f32_16x16x32_bf16 a[64:67], v[48:51], v[128:131], a[64:67]
  ds_read_b64_tr_b16 v[90:91], v7 offset:38912
  s_add_u32 m0, s53, 16384
  v_mfma_f32_16x16x32_bf16 a[68:71], v[52:55], v[128:131], a[68:71]
  v_mfma_f32_16x16x32_bf16 a[72:75], v[56:59], v[128:131], a[72:75]
  ds_read_b128 v[40:43], v6 offset:38912
  v_mfma_f32_16x16x32_bf16 a[76:79], v[60:63], v[128:131], a[76:79]
  ds_read_b64_tr_b16 v[92:93], v8 offset:36864
  v_mfma_f32_16x16x32_bf16 a[80:83], v[64:67], v[128:131], a[80:83]
  buffer_load_dwordx4 v2, s[16:19], s46 offen lds
  v_mfma_f32_16x16x32_bf16 a[84:87], v[68:71], v[128:131], a[84:87]
  ds_read_b128 v[44:47], v6 offset:39936
  s_add_u32 m0, s53, 20480
  v_mfma_f32_16x16x32_bf16 a[88:91], v[72:75], v[128:131], a[88:91]
  ds_read_b64_tr_b16 v[94:95], v8 offset:38912
  v_mfma_f32_16x16x32_bf16 a[92:95], v[76:79], v[128:131], a[92:95]
  v_mfma_f32_16x16x32_bf16 a[96:99], v[48:51], v[132:135], a[96:99]
  buffer_load_dwordx4 v2, s[20:23], s46 offen lds
  v_mfma_f32_16x16x32_bf16 a[100:103], v[52:55], v[132:135], a[100:103]
  v_mfma_f32_16x16x32_bf16 a[104:107], v[56:59], v[132:135], a[104:107]
  v_mfma_f32_16x16x32_bf16 a[108:111], v[60:63], v[132:135], a[108:111]
  s_add_u32 s46, s46, s48
  v_mfma_f32_16x16x32_bf16 a[112:115], v[64:67], v[132:135], a[112:115]
  v_mfma_f32_16x16x32_bf16 a[116:119], v[68:71], v[132:135], a[116:119]
  v_mfma_f32_16x16x32_bf16 a[120:123], v[72:75], v[132:135], a[120:123]
  v_mfma_f32_16x16x32_bf16 a[124:127], v[76:79], v[132:135], a[124:127]
  s_waitcnt vmcnt(13) lgkmcnt(0)
  s_barrier
  v_mfma_f32_16x16x32_bf16 a[0:3], v[80:83], v[16:19], a[0:3]
  ds_read_b128 v[48:51], v6 offset:49152
  s_add_u32 m0, s52, 32768
  v_mfma_f32_16x16x32_bf16 a[4:7], v[80:83], v[20:23], a[4:7]
  ds_read_b64_tr_b16 v[120:121], v7 offset:49152
  v_mfma_f32_16x16x32_bf16 a[8:11], v[80:83], v[24:27], a[8:11]
  buffer_load_dwordx4 v188, s[12:15], s45 offen offset:0 sc1 lds
  v_mfma_f32_16x16x32_bf16 a[12:15], v[80:83], v[28:31], a[12:15]
  ds_read_b128 v[52:55], v6 offset:50176
  v_mfma_f32_16x16x32_bf16 a[16:19], v[80:83], v[32:35], a[16:19]
  ds_read_b64_tr_b16 v[122:123], v7 offset:51200
  v_mfma_f32_16x16x32_bf16 a[20:23], v[80:83], v[36:39], a[20:23]
  buffer_load_dwordx4 v188, s[12:15], s45 offen offset:1024 sc1 lds
  v_mfma_f32_16x16x32_bf16 a[24:27], v[80:83], v[40:43], a[24:27]
  ds_read_b128 v[56:59], v6 offset:51200
  v_mfma_f32_16x16x32_bf16 a[28:31], v[80:83], v[44:47], a[28:31]
  ds_read_b64_tr_b16 v[124:125], v8 offset:49152
  v_mfma_f32_16x16x32_bf16 a[32:35], v[84:87], v[16:19], a[32:35]
  buffer_load_dwordx4 v188, s[12:15], s45 offen offset:2048 sc1 lds
  v_mfma_f32_16x16x32_bf16 a[36:39], v[84:87], v[20:23], a[36:39]
  ds_read_b128 v[60:63], v6 offset:52224
  v_mfma_f32_16x16x32_bf16 a[40:43], v[84:87], v[24:27], a[40:43]
  ds_read_b64_tr_b16 v[126:127], v8 offset:51200
  v_mfma_f32_16x16x32_bf16 a[44:47], v[84:87], v[28:31], a[44:47]
  buffer_load_dwordx4 v188, s[12:15], s45 offen offset:3072 sc1 lds
  v_mfma_f32_16x16x32_bf16 a[48:51], v[84:87], v[32:35], a[48:51]
  ds_read_b128 v[64:67], v6 offset:53248
  v_mfma_f32_16x16x32_bf16 a[52:55], v[84:87], v[36:39], a[52:55]
  ds_read_b64_tr_b16 v[128:129], v7 offset:53248
  s_add_u32 s45, s45, 16384
  v_mfma_f32_16x16x32_bf16 a[56:59], v[84:87], v[40:43], a[56:59]
  v_mfma_f32_16x16x32_bf16 a[60:63], v[84:87], v[44:47], a[60:63]
  ds_read_b128 v[68:71], v6 offset:54272
  v_mfma_f32_16x16x32_bf16 a[64:67], v[16:19], v[88:91], a[64:67]
  ds_read_b64_tr_b16 v[130:131], v7 offset:55296
  s_add_u32 m0, s53, 32768
  v_mfma_f32_16x16x32_bf16 a[68:71], v[20:23], v[88:91], a[68:71]
  v_mfma_f32_16x16x32_bf16 a[72:75], v[24:27], v[88:91], a[72:75]
  ds_read_b128 v[72:75], v6 offset:55296
  v_mfma_f32_16x16x32_bf16 a[76:79], v[28:31], v[88:91], a[76:79]
  ds_read_b64_tr_b16 v[132:133], v8 offset:53248
  v_mfma_f32_16x16x32_bf16 a[80:83], v[32:35], v[88:91], a[80:83]
  buffer_load_dwordx4 v2, s[16:19], s46 offen lds
  v_mfma_f32_16x16x32_bf16 a[84:87], v[36:39], v[88:91], a[84:87]
  ds_read_b128 v[76:79], v6 offset:56320
  s_add_u32 m0, s53, 36864
  v_mfma_f32_16x16x32_bf16 a[88:91], v[40:43], v[88:91], a[88:91]
  ds_read_b64_tr_b16 v[134:135], v8 offset:55296
  v_mfma_f32_16x16x32_bf16 a[92:95], v[44:47], v[88:91], a[92:95]
  v_mfma_f32_16x16x32_bf16 a[96:99], v[16:19], v[92:95], a[96:99]
  buffer_load_dwordx4 v2, s[20:23], s46 offen lds
  v_mfma_f32_16x16x32_bf16 a[100:103], v[20:23], v[92:95], a[100:103]
  v_mfma_f32_16x16x32_bf16 a[104:107], v[24:27], v[92:95], a[104:107]
  v_mfma_f32_16x16x32_bf16 a[108:111], v[28:31], v[92:95], a[108:111]
  s_add_u32 s46, s46, s48
  v_mfma_f32_16x16x32_bf16 a[112:115], v[32:35], v[92:95], a[112:115]
  v_mfma_f32_16x16x32_bf16 a[116:119], v[36:39], v[92:95], a[116:119]
  v_mfma_f32_16x16x32_bf16 a[120:123], v[40:43], v[92:95], a[120:123]
  v_mfma_f32_16x16x32_bf16 a[124:127], v[44:47], v[92:95], a[124:127]
  s_waitcnt vmcnt(12) lgkmcnt(0)
  s_barrier
  v_mfma_f32_16x16x32_bf16 a[0:3], v[120:123], v[48:51], a[0:3]
  ds_read_b128 v[16:19], v6 offset:0
  s_add_u32 m0, s52, 49152
  v_mfma_f32_16x16x32_bf16 a[4:7], v[120:123], v[52:55], a[4:7]
  ds_read_b64_tr_b16 v[80:81], v7 offset:0
  v_mfma_f32_16x16x32_bf16 a[8:11], v[120:123], v[56:59], a[8:11]
  buffer_load_dwordx4 v188, s[12:15], s45 offen offset:0 sc1 lds
  v_mfma_f32_16x16x32_bf16 a[12:15], v[120:123], v[60:63], a[12:15]
  ds_read_b128 v[20:23], v6 offset:1024
  v_mfma_f32_16x16x32_bf16 a[16:19], v[120:123], v[64:67], a[16:19]
  ds_read_b64_tr_b16 v[82:83], v7 offset:2048
  v_mfma_f32_16x16x32_bf16 a[20:23], v[120:123], v[68:71], a[20:23]
  buffer_load_dwordx4 v188, s[12:15], s45 offen offset:1024 sc1 lds
  v_mfma_f32_16x16x32_bf16 a[24:27], v[120:123], v[72:75], a[24:27]
  ds_read_b128 v[24:27], v6 offset:2048
  v_mfma_f32_16x16x32_bf16 a[28:31], v[120:123], v[76:79], a[28:31]
  ds_read_b64_tr_b16 v[84:85], v8 offset:0
  v_mfma_f32_16x16x32_bf16 a[32:35], v[124:127], v[48:51], a[32:35]
  buffer_load_dwordx4 v188, s[12:15], s45 offen offset:2048 sc1 lds
  v_mfma_f32_16x16x32_bf16 a[36:39], v[124:127], v[52:55], a[36:39]
  ds_read_b128 v[28:31], v6 offset:3072
  v_mfma_f32_16x16x32_bf16 a[40:43], v[124:127], v[56:59], a[40:43]
  ds_read_b64_tr_b16 v[86:87], v8 offset:2048
  v_mfma_f32_16x16x32_bf16 a[44:47], v[124:127], v[60:63], a[44:47]
  buffer_load_dwordx4 v188, s[12:15], s45 offen offset:3072 sc1 lds
  v_mfma_f32_16x16x32_bf16 a[48:51], v[124:127], v[64:67], a[48:51]
  ds_read_b128 v[32:35], v6 offset:4096
  v_mfma_f32_16x16x32_bf16 a[52:55], v[124:127], v[68:71], a[52:55]
  ds_read_b64_tr_b16 v[88:89], v7 offset:4096
  s_add_u32 s45, s45, 16384
  v_mfma_f32_16x16x32_bf16 a[56:59], v[124:127], v[72:75], a[56:59]
  v_mfma_f32_16x16x32_bf16 a[60:63], v[124:127], v[76:79], a[60:63]
  ds_read_b128 v[36:39], v6 offset:5120
  v_mfma_f32_16x16x32_bf16 a[64:67], v[48:51], v[128:131], a[64:67]
  ds_read_b64_tr_b16 v[90:91], v7 offset:6144
  s_add_u32 m0, s53, 49152
  v_mfma_f32_16x16x32_bf16 a[68:71], v[52:55], v[128:131], a[68:71]
  v_mfma_f32_16x16x32_bf16 a[72:75], v[56:59], v[128:131], a[72:75]
  ds_read_b128 v[40:43], v6 offset:6144
  v_mfma_f32_16x16x32_bf16 a[76:79], v[60:63], v[128:131], a[76:79]
  ds_read_b64_tr_b16 v[92:93], v8 offset:4096
  v_mfma_f32_16x16x32_bf16 a[80:83], v[64:67], v[128:131], a[80:83]
  buffer_load_dwordx4 v2, s[16:19], s46 offen lds
  v_mfma_f32_16x16x32_bf16 a[84:87], v[68:71], v[128:131], a[84:87]
  ds_read_b128 v[44:47], v6 offset:7168
  s_add_u32 m0, s53, 53248
  v_mfma_f32_16x16x32_bf16 a[88:91], v[72:75], v[128:131], a[88:91]
  ds_read_b64_tr_b16 v[94:95], v8 offset:6144
  v_mfma_f32_16x16x32_bf16 a[92:95], v[76:79], v[128:131], a[92:95]
  v_mfma_f32_16x16x32_bf16 a[96:99], v[48:51], v[132:135], a[96:99]
  buffer_load_dwordx4 v2, s[20:23], s46 offen lds
  v_mfma_f32_16x16x32_bf16 a[100:103], v[52:55], v[132:135], a[100:103]
  v_mfma_f32_16x16x32_bf16 a[104:107], v[56:59], v[132:135], a[104:107]
  v_mfma_f32_16x16x32_bf16 a[108:111], v[60:63], v[132:135], a[108:111]
  s_add_u32 s46, s46, s48
  v_mfma_f32_16x16x32_bf16 a[112:115], v[64:67], v[132:135], a[112:115]
  v_mfma_f32_16x16x32_bf16 a[116:119], v[68:71], v[132:135], a[116:119]
  v_mfma_f32_16x16x32_bf16 a[120:123], v[72:75], v[132:135], a[120:123]
  v_mfma_f32_16x16x32_bf16 a[124:127], v[76:79], v[132:135], a[124:127]
  s_waitcnt vmcnt(12) lgkmcnt(0)
  s_barrier
  v_mfma_f32_16x16x32_bf16 a[0:3], v[80:83], v[16:19], a[0:3]
  ds_read_b128 v[48:51], v6 offset:16384
  s_add_u32 m0, s52, 0
  v_mfma_f32_16x16x32_bf16 a[4:7], v[80:83], v[20:23], a[4:7]
  ds_read_b64_tr_b16 v[120:121], v7 offset:16384
  v_mfma_f32_16x16x32_bf16 a[8:11], v[80:83], v[24:27], a[8:11]
  buffer_load_dwordx4 v188, s[12:15], s45 offen offset:0 sc1 lds
  v_mfma_f32_16x16x32_bf16 a[12:15], v[80:83], v[28:31], a[12:15]
  ds_read_b128 v[52:55], v6 offset:17408
  v_mfma_f32_16x16x32_bf16 a[16:19], v[80:83], v[32:35], a[16:19]
  ds_read_b64_tr_b16 v[122:123], v7 offset:18432
  v_mfma_f32_16x16x32_bf16 a[20:23], v[80:83], v[36:39], a[20:23]
  buffer_load_dwordx4 v188, s[12:15], s45 offen offset:1024 sc1 lds
  v_mfma_f32_16x16x32_bf16 a[24:27], v[80:83], v[40:43], a[24:27]
  ds_read_b128 v[56:59], v6 offset:18432
  v_mfma_f32_16x16x32_bf16 a[28:31], v[80:83], v[44:47], a[28:31]
  ds_read_b64_tr_b16 v[124:125], v8 offset:16384
  v_mfma_f32_16x16x32_bf16 a[32:35], v[84:87], v[16:19], a[32:35]
  buffer_load_dwordx4 v188, s[12:15], s45 offen offset:2048 sc1 lds
  v_mfma_f32_16x16x32_bf16 a[36:39], v[84:87], v[20:23], a[36:39]
  ds_read_b128 v[60:63], v6 offset:19456
  v_mfma_f32_16x16x32_bf16 a[40:43], v[84:87], v[24:27], a[40:43]
  ds_read_b64_tr_b16 v[126:127], v8 offset:18432
  v_mfma_f32_16x16x32_bf16 a[44:47], v[84:87], v[28:31], a[44:47]
  buffer_load_dwordx4 v188, s[12:15], s45 offen offset:3072 sc1 lds
  v_mfma_f32_16x16x32_bf16 a[48:51], v[84:87], v[32:35], a[48:51]
  ds_read_b128 v[64:67], v6 offset:20480
  v_mfma_f32_16x16x32_bf16 a[52:55], v[84:87], v[36:39], a[52:55]
  ds_read_b64_tr_b16 v[128:129], v7 offset:20480
  s_add_u32 s45, s45, 16384
  v_mfma_f32_16x16x32_bf16 a[56:59], v[84:87], v[40:43], a[56:59]
  v_mfma_f32_16x16x32_bf16 a[60:63], v[84:87], v[44:47], a[60:63]
  ds_read_b128 v[68:71], v6 offset:21504
  v_mfma_f32_16x16x32_bf16 a[64:67], v[16:19], v[88:91], a[64:67]
  ds_read_b64_tr_b16 v[130:131], v7 offset:22528
  s_add_u32 m0, s53, 0
  v_mfma_f32_16x16x32_bf16 a[68:71], v[20:23], v[88:91], a[68:71]
  v_mfma_f32_16x16x32_bf16 a[72:75], v[24:27], v[88:91], a[72:75]
  ds_read_b128 v[72:75], v6 offset:22528
  v_mfma_f32_16x16x32_bf16 a[76:79], v[28:31], v[88:91], a[76:79]
  ds_read_b64_tr_b16 v[132:133], v8 offset:20480
  v_mfma_f32_16x16x32_bf16 a[80:83], v[32:35], v[88:91], a[80:83]
  buffer_load_dwordx4 v2, s[16:19], s46 offen lds
  v_mfma_f32_16x16x32_bf16 a[84:87], v[36:39], v[88:91], a[84:87]
  ds_read_b128 v[76:79], v6 offset:23552
  s_add_u32 m0, s53, 4096
  v_mfma_f32_16x16x32_bf16 a[88:91], v[40:43], v[88:91], a[88:91]
  ds_read_b64_tr_b16 v[134:135], v8 offset:22528
  v_mfma_f32_16x16x32_bf16 a[92:95], v[44:47], v[88:91], a[92:95]
  v_mfma_f32_16x16x32_bf16 a[96:99], v[16:19], v[92:95], a[96:99]
  buffer_load_dwordx4 v2, s[20:23], s46 offen lds
  v_mfma_f32_16x16x32_bf16 a[100:103], v[20:23], v[92:95], a[100:103]
  v_mfma_f32_16x16x32_bf16 a[104:107], v[24:27], v[92:95], a[104:107]
  v_mfma_f32_16x16x32_bf16 a[108:111], v[28:31], v[92:95], a[108:111]
  s_add_u32 s46, s46, s48
  v_mfma_f32_16x16x32_bf16 a[112:115], v[32:35], v[92:95], a[112:115]
  v_mfma_f32_16x16x32_bf16 a[116:119], v[36:39], v[92:95], a[116:119]
  v_mfma_f32_16x16x32_bf16 a[120:123], v[40:43], v[92:95], a[120:123]
  v_mfma_f32_16x16x32_bf16 a[124:127], v[44:47], v[92:95], a[124:127]
  s_waitcnt vmcnt(12) lgkmcnt(0)
  s_barrier
  v_mfma_f32_16x16x32_bf16 a[0:3], v[120:123], v[48:51], a[0:3]
  ds_read_b128 v[16:19], v6 offset:32768
  s_add_u32 m0, s52, 16384
  v_mfma_f32_16x16x32_bf16 a[4:7], v[120:123], v[52:55], a[4:7]
  ds_read_b64_tr_b16 v[80:81], v7 offset:32768
  v_mfma_f32_16x16x32_bf16 a[8:11], v[120:123], v[56:59], a[8:11]
  buffer_load_dwordx4 v188, s[12:15], s45 offen offset:0 sc1 lds
  v_mfma_f32_16x16x32_bf16 a[12:15], v[120:123], v[60:63], a[12:15]
  ds_read_b128 v[20:23], v6 offset:33792
  v_mfma_f32_16x16x32_bf16 a[16:19], v[120:123], v[64:67], a[16:19]
  ds_read_b64_tr_b16 v[82:83], v7 offset:34816
  v_mfma_f32_16x16x32_bf16 a[20:23], v[120:123], v[68:71], a[20:23]
  buffer_load_dwordx4 v188, s[12:15], s45 offen offset:1024 sc1 lds
  v_mfma_f32_16x16x32_bf16 a[24:27], v[120:123], v[72:75], a[24:27]
  ds_read_b128 v[24:27], v6 offset:34816
  v_mfma_f32_16x16x32_bf16 a[28:31], v[120:123], v[76:79], a[28:31]
  ds_read_b64_tr_b16 v[84:85], v8 offset:32768
  v_mfma_f32_16x16x32_bf16 a[32:35], v[124:127], v[48:51], a[32:35]
  buffer_load_dwordx4 v188, s[12:15], s45 offen offset:2048 sc1 lds
  v_mfma_f32_16x16x32_bf16 a[36:39], v[124:127], v[52:55], a[36:39]
  ds_read_b128 v[28:31], v6 offset:35840
  v_mfma_f32_16x16x32_bf16 a[40:43], v[124:127], v[56:59], a[40:43]
  ds_read_b64_tr_b16 v[86:87], v8 offset:34816
  v_mfma_f32_16x16x32_bf16 a[44:47], v[124:127], v[60:63], a[44:47]
  buffer_load_dwordx4 v188, s[12:15], s45 offen offset:3072 sc1 lds
  v_mfma_f32_16x16x32_bf16 a[48:51], v[124:127], v[64:67], a[48:51]
  ds_read_b128 v[32:35], v6 offset:36864
  v_mfma_f32_16x16x32_bf16 a[52:55], v[124:127], v[68:71], a[52:55]
  ds_read_b64_tr_b16 v[88:89], v7 offset:36864
  s_add_u32 s45, s45, 16384
  v_mfma_f32_16x16x32_bf16 a[56:59], v[124:127], v[72:75], a[56:59]
  v_mfma_f32_16x16x32_bf16 a[60:63], v[124:127], v[76:79], a[60:63]
  ds_read_b128 v[36:39], v6 offset:37888
  v_mfma_f32_16x16x32_bf16 a[64:67], v[48:51], v[128:131], a[64:67]
  ds_read_b64_tr_b16 v[90:91], v7 offset:38912
  s_add_u32 m0, s53, 16384
  v_mfma_f32_16x16x32_bf16 a[68:71], v[52:55], v[128:131], a[68:71]
  v_mfma_f32_16x16x32_bf16 a[72:75], v[56:59], v[128:131], a[72:75]
  ds_read_b128 v[40:43], v6 offset:38912
  v_mfma_f32_16x16x32_bf16 a[76:79], v[60:63], v[128:131], a[76:79]
  ds_read_b64_tr_b16 v[92:93], v8 offset:36864
  v_mfma_f32_16x16x32_bf16 a[80:83], v[64:67], v[128:131], a[80:83]
  buffer_load_dwordx4 v2, s[16:19], s46 offen lds
  v_mfma_f32_16x16x32_bf16 a[84:87], v[68:71], v[128:131], a[84:87]
  ds_read_b128 v[44:47], v6 offset:39936
  s_add_u32 m0, s53, 20480
  v_mfma_f32_16x16x32_bf16 a[88:91], v[72:75], v[128:131], a[88:91]
  ds_read_b64_tr_b16 v[94:95], v8 offset:38912
  v_mfma_f32_16x16x32_bf16 a[92:95], v[76:79], v[128:131], a[92:95]
  v_mfma_f32_16x16x32_bf16 a[96:99], v[48:51], v[132:135], a[96:99]
  buffer_load_dwordx4 v2, s[20:23], s46 offen lds
  v_mfma_f32_16x16x32_bf16 a[100:103], v[52:55], v[132:135], a[100:103]
  v_mfma_f32_16x16x32_bf16 a[104:107], v[56:59], v[132:135], a[104:107]
  v_mfma_f32_16x16x32_bf16 a[108:111], v[60:63], v[132:135], a[108:111]
  s_add_u32 s46, s46, s48
  v_mfma_f32_16x16x32_bf16 a[112:115], v[64:67], v[132:135], a[112:115]
  v_mfma_f32_16x16x32_bf16 a[116:119], v[68:71], v[132:135], a[116:119]
  v_mfma_f32_16x16x32_bf16 a[120:123], v[72:75], v[132:135], a[120:123]
  v_mfma_f32_16x16x32_bf16 a[124:127], v[76:79], v[132:135], a[124:127]
  s_waitcnt vmcnt(12) lgkmcnt(0)
  s_barrier
  v_mfma_f32_16x16x32_bf16 a[0:3], v[80:83], v[16:19], a[0:3]
  ds_read_b128 v[48:51], v6 offset:49152
  s_add_u32 m0, s52, 32768
  v_mfma_f32_16x16x32_bf16 a[4:7], v[80:83], v[20:23], a[4:7]
  ds_read_b64_tr_b16 v[120:121], v7 offset:49152
  v_mfma_f32_16x16x32_bf16 a[8:11], v[80:83], v[24:27], a[8:11]
  buffer_load_dwordx4 v188, s[12:15], s45 offen offset:0 sc1 lds
  v_mfma_f32_16x16x32_bf16 a[12:15], v[80:83], v[28:31], a[12:15]
  ds_read_b128 v[52:55], v6 offset:50176
  v_mfma_f32_16x16x32_bf16 a[16:19], v[80:83], v[32:35], a[16:19]
  ds_read_b64_tr_b16 v[122:123], v7 offset:51200
  v_mfma_f32_16x16x32_bf16 a[20:23], v[80:83], v[36:39], a[20:23]
  buffer_load_dwordx4 v188, s[12:15], s45 offen offset:1024 sc1 lds
  v_mfma_f32_16x16x32_bf16 a[24:27], v[80:83], v[40:43], a[24:27]
  ds_read_b128 v[56:59], v6 offset:51200
  v_mfma_f32_16x16x32_bf16 a[28:31], v[80:83], v[44:47], a[28:31]
  ds_read_b64_tr_b16 v[124:125], v8 offset:49152
  v_mfma_f32_16x16x32_bf16 a[32:35], v[84:87], v[16:19], a[32:35]
  buffer_load_dwordx4 v188, s[12:15], s45 offen offset:2048 sc1 lds
  v_mfma_f32_16x16x32_bf16 a[36:39], v[84:87], v[20:23], a[36:39]
  ds_read_b128 v[60:63], v6 offset:52224
  v_mfma_f32_16x16x32_bf16 a[40:43], v[84:87], v[24:27], a[40:43]
  ds_read_b64_tr_b16 v[126:127], v8 offset:51200
  v_mfma_f32_16x16x32_bf16 a[44:47], v[84:87], v[28:31], a[44:47]
  buffer_load_dwordx4 v188, s[12:15], s45 offen offset:3072 sc1 lds
  v_mfma_f32_16x16x32_bf16 a[48:51], v[84:87], v[32:35], a[48:51]
  ds_read_b128 v[64:67], v6 offset:53248
  v_mfma_f32_16x16x32_bf16 a[52:55], v[84:87], v[36:39], a[52:55]
  ds_read_b64_tr_b16 v[128:129], v7 offset:53248
  s_add_u32 s45, s45, 16384
  v_mfma_f32_16x16x32_bf16 a[56:59], v[84:87], v[40:43], a[56:59]
  v_mfma_f32_16x16x32_bf16 a[60:63], v[84:87], v[44:47], a[60:63]
  ds_read_b128 v[68:71], v6 offset:54272
  v_mfma_f32_16x16x32_bf16 a[64:67], v[16:19], v[88:91], a[64:67]
  ds_read_b64_tr_b16 v[130:131], v7 offset:55296
  s_add_u32 m0, s53, 32768
  v_mfma_f32_16x16x32_bf16 a[68:71], v[20:23], v[88:91], a[68:71]
  v_mfma_f32_16x16x32_bf16 a[72:75], v[24:27], v[88:91], a[72:75]
  ds_read_b128 v[72:75], v6 offset:55296
  v_mfma_f32_16x16x32_bf16 a[76:79], v[28:31], v[88:91], a[76:79]
  ds_read_b64_tr_b16 v[132:133], v8 offset:53248
  v_mfma_f32_16x16x32_bf16 a[80:83], v[32:35], v[88:91], a[80:83]
  buffer_load_dwordx4 v2, s[16:19], s46 offen lds
  v_mfma_f32_16x16x32_bf16 a[84:87], v[36:39], v[88:91], a[84:87]
  ds_read_b128 v[76:79], v6 offset:56320
  s_add_u32 m0, s53, 36864
  v_mfma_f32_16x16x32_bf16 a[88:91], v[40:43], v[88:91], a[88:91]
  ds_read_b64_tr_b16 v[134:135], v8 offset:55296
  v_mfma_f32_16x16x32_bf16 a[92:95], v[44:47], v[88:91], a[92:95]
  v_mfma_f32_16x16x32_bf16 a[96:99], v[16:19], v[92:95], a[96:99]
  buffer_load_dwordx4 v2, s[20:23], s46 offen lds
  v_mfma_f32_16x16x32_bf16 a[100:103], v[20:23], v[92:95], a[100:103]
  v_mfma_f32_16x16x32_bf16 a[104:107], v[24:27], v[92:95], a[104:107]
  v_mfma_f32_16x16x32_bf16 a[108:111], v[28:31], v[92:95], a[108:111]
  s_add_u32 s46, s46, s48
  v_mfma_f32_16x16x32_bf16 a[112:115], v[32:35], v[92:95], a[112:115]
  v_mfma_f32_16x16x32_bf16 a[116:119], v[36:39], v[92:95], a[116:119]
  v_mfma_f32_16x16x32_bf16 a[120:123], v[40:43], v[92:95], a[120:123]
  v_mfma_f32_16x16x32_bf16 a[124:127], v[44:47], v[92:95], a[124:127]
  s_waitcnt vmcnt(12) lgkmcnt(0)
  s_barrier
  v_mfma_f32_16x16x32_bf16 a[0:3], v[120:123], v[48:51], a[0:3]
  ds_read_b128 v[16:19], v6 offset:0
  s_add_u32 m0, s52, 49152
  v_mfma_f32_16x16x32_bf16 a[4:7], v[120:123], v[52:55], a[4:7]
  ds_read_b64_tr_b16 v[80:81], v7 offset:0
  v_mfma_f32_16x16x32_bf16 a[8:11], v[120:123], v[56:59], a[8:11]
  buffer_load_dwordx4 v188, s[12:15], s45 offen offset:0 sc1 lds
  v_mfma_f32_16x16x32_bf16 a[12:15], v[120:123], v[60:63], a[12:15]
  ds_read_b128 v[20:23], v6 offset:1024
  v_mfma_f32_16x16x32_bf16 a[16:19], v[120:123], v[64:67], a[16:19]
  ds_read_b64_tr_b16 v[82:83], v7 offset:2048
  v_mfma_f32_16x16x32_bf16 a[20:23], v[120:123], v[68:71], a[20:23]
  buffer_load_dwordx4 v188, s[12:15], s45 offen offset:1024 sc1 lds
  v_mfma_f32_16x16x32_bf16 a[24:27], v[120:123], v[72:75], a[24:27]
  ds_read_b128 v[24:27], v6 offset:2048
  v_mfma_f32_16x16x32_bf16 a[28:31], v[120:123], v[76:79], a[28:31]
  ds_read_b64_tr_b16 v[84:85], v8 offset:0
  v_mfma_f32_16x16x32_bf16 a[32:35], v[124:127], v[48:51], a[32:35]
  buffer_load_dwordx4 v188, s[12:15], s45 offen offset:2048 sc1 lds
  v_mfma_f32_16x16x32_bf16 a[36:39], v[124:127], v[52:55], a[36:39]
  ds_read_b128 v[28:31], v6 offset:3072
  v_mfma_f32_16x16x32_bf16 a[40:43], v[124:127], v[56:59], a[40:43]
  ds_read_b64_tr_b16 v[86:87], v8 offset:2048
  v_mfma_f32_16x16x32_bf16 a[44:47], v[124:127], v[60:63], a[44:47]
  buffer_load_dwordx4 v188, s[12:15], s45 offen offset:3072 sc1 lds
  v_mfma_f32_16x16x32_bf16 a[48:51], v[124:127], v[64:67], a[48:51]
  ds_read_b128 v[32:35], v6 offset:4096
  v_mfma_f32_16x16x32_bf16 a[52:55], v[124:127], v[68:71], a[52:55]
  ds_read_b64_tr_b16 v[88:89], v7 offset:4096
  s_add_u32 s45, s45, 16384
  v_mfma_f32_16x16x32_bf16 a[56:59], v[124:127], v[72:75], a[56:59]
  v_mfma_f32_16x16x32_bf16 a[60:63], v[124:127], v[76:79], a[60:63]
  ds_read_b128 v[36:39], v6 offset:5120
  v_mfma_f32_16x16x32_bf16 a[64:67], v[48:51], v[128:131], a[64:67]
  ds_read_b64_tr_b16 v[90:91], v7 offset:6144
  s_add_u32 m0, s53, 49152
  v_mfma_f32_16x16x32_bf16 a[68:71], v[52:55], v[128:131], a[68:71]
  v_mfma_f32_16x16x32_bf16 a[72:75], v[56:59], v[128:131], a[72:75]
  ds_read_b128 v[40:43], v6 offset:6144
  v_mfma_f32_16x16x32_bf16 a[76:79], v[60:63], v[128:131], a[76:79]
  ds_read_b64_tr_b16 v[92:93], v8 offset:4096
  v_mfma_f32_16x16x32_bf16 a[80:83], v[64:67], v[128:131], a[80:83]
  buffer_load_dwordx4 v2, s[16:19], s46 offen lds
  v_mfma_f32_16x16x32_bf16 a[84:87], v[68:71], v[128:131], a[84:87]
  ds_read_b128 v[44:47], v6 offset:7168
  s_add_u32 m0, s53, 53248
  v_mfma_f32_16x16x32_bf16 a[88:91], v[72:75], v[128:131], a[88:91]
  ds_read_b64_tr_b16 v[94:95], v8 offset:6144
  v_mfma_f32_16x16x32_bf16 a[92:95], v[76:79], v[128:131], a[92:95]
  v_mfma_f32_16x16x32_bf16 a[96:99], v[48:51], v[132:135], a[96:99]
  buffer_load_dwordx4 v2, s[20:23], s46 offen lds
  v_mfma_f32_16x16x32_bf16 a[100:103], v[52:55], v[132:135], a[100:103]
  v_mfma_f32_16x16x32_bf16 a[104:107], v[56:59], v[132:135], a[104:107]
  v_mfma_f32_16x16x32_bf16 a[108:111], v[60:63], v[132:135], a[108:111]
  s_add_u32 s46, s46, s48
  v_mfma_f32_16x16x32_bf16 a[112:115], v[64:67], v[132:135], a[112:115]
  v_mfma_f32_16x16x32_bf16 a[116:119], v[68:71], v[132:135], a[116:119]
  v_mfma_f32_16x16x32_bf16 a[120:123], v[72:75], v[132:135], a[120:123]
  v_mfma_f32_16x16x32_bf16 a[124:127], v[76:79], v[132:135], a[124:127]
  s_waitcnt vmcnt(12) lgkmcnt(0)
  s_barrier
  v_mfma_f32_16x16x32_bf16 a[0:3], v[80:83], v[16:19], a[0:3]
  ds_read_b128 v[48:51], v6 offset:16384
  s_mov_b32 s45, 327680
  v_mfma_f32_16x16x32_bf16 a[4:7], v[80:83], v[20:23], a[4:7]
  ds_read_b64_tr_b16 v[120:121], v7 offset:16384
  v_mfma_f32_16x16x32_bf16 a[8:11], v[80:83], v[24:27], a[8:11]
  s_add_u32 m0, s52, 0
  v_mfma_f32_16x16x32_bf16 a[12:15], v[80:83], v[28:31], a[12:15]
  ds_read_b128 v[52:55], v6 offset:17408
  v_mfma_f32_16x16x32_bf16 a[16:19], v[80:83], v[32:35], a[16:19]
  ds_read_b64_tr_b16 v[122:123], v7 offset:18432
  v_mfma_f32_16x16x32_bf16 a[20:23], v[80:83], v[36:39], a[20:23]
  buffer_load_dwordx4 v188, s[12:15], s45 offen offset:0 sc1 lds
  v_mfma_f32_16x16x32_bf16 a[24:27], v[80:83], v[40:43], a[24:27]
  ds_read_b128 v[56:59], v6 offset:18432
  v_mfma_f32_16x16x32_bf16 a[28:31], v[80:83], v[44:47], a[28:31]
  buffer_load_dwordx4 v188, s[12:15], s45 offen offset:1024 sc1 lds
  v_mfma_f32_16x16x32_bf16 a[32:35], v[84:87], v[16:19], a[32:35]
  ds_read_b64_tr_b16 v[124:125], v8 offset:16384
  v_mfma_f32_16x16x32_bf16 a[36:39], v[84:87], v[20:23], a[36:39]
  buffer_load_dwordx4 v188, s[12:15], s45 offen offset:2048 sc1 lds
  v_mfma_f32_16x16x32_bf16 a[40:43], v[84:87], v[24:27], a[40:43]
  ds_read_b128 v[60:63], v6 offset:19456
  ds_read_b64_tr_b16 v[126:127], v8 offset:18432
  v_mfma_f32_16x16x32_bf16 a[44:47], v[84:87], v[28:31], a[44:47]
  buffer_load_dwordx4 v188, s[12:15], s45 offen offset:3072 sc1 lds
  v_mfma_f32_16x16x32_bf16 a[48:51], v[84:87], v[32:35], a[48:51]
  ds_read_b128 v[64:67], v6 offset:20480
  s_add_u32 s45, s45, 16384
  v_mfma_f32_16x16x32_bf16 a[52:55], v[84:87], v[36:39], a[52:55]
  ds_read_b64_tr_b16 v[128:129], v7 offset:20480
  v_mfma_f32_16x16x32_bf16 a[56:59], v[84:87], v[40:43], a[56:59]
  s_add_u32 m0, s53, 8192
  v_mfma_f32_16x16x32_bf16 a[60:63], v[84:87], v[44:47], a[60:63]
  ds_read_b128 v[68:71], v6 offset:21504
  v_mfma_f32_16x16x32_bf16 a[64:67], v[16:19], v[88:91], a[64:67]
  ds_read_b64_tr_b16 v[130:131], v7 offset:22528
  v_mfma_f32_16x16x32_bf16 a[68:71], v[20:23], v[88:91], a[68:71]
  buffer_load_dwordx4 v3, s[24:27], s47 offen lds
  v_mfma_f32_16x16x32_bf16 a[72:75], v[24:27], v[88:91], a[72:75]
  ds_read_b128 v[72:75], v6 offset:22528
  s_add_u32 m0, s53, 12288
  v_mfma_f32_16x16x32_bf16 a[76:79], v[28:31], v[88:91], a[76:79]
  ds_read_b64_tr_b16 v[132:133], v8 offset:20480
  v_mfma_f32_16x16x32_bf16 a[80:83], v[32:35], v[88:91], a[80:83]
  buffer_load_dwordx4 v3, s[28:31], s47 offen lds
  v_mfma_f32_16x16x32_bf16 a[84:87], v[36:39], v[88:91], a[84:87]
  ds_read_b128 v[76:79], v6 offset:23552
  v_mfma_f32_16x16x32_bf16 a[88:91], v[40:43], v[88:91], a[88:91]
  ds_read_b64_tr_b16 v[134:135], v8 offset:22528
  s_add_u32 m0, s54, 0
  v_mfma_f32_16x16x32_bf16 a[92:95], v[44:47], v[88:91], a[92:95]
  v_mfma_f32_16x16x32_bf16 a[96:99], v[16:19], v[92:95], a[96:99]
  global_load_lds_dwordx4 v[4:5], off
  v_mfma_f32_16x16x32_bf16 a[100:103], v[20:23], v[92:95], a[100:103]
  v_mfma_f32_16x16x32_bf16 a[104:107], v[24:27], v[92:95], a[104:107]
  s_add_u32 s47, s47, s49
  v_mfma_f32_16x16x32_bf16 a[108:111], v[28:31], v[92:95], a[108:111]
  v_mfma_f32_16x16x32_bf16 a[112:115], v[32:35], v[92:95], a[112:115]
  v_lshl_add_u64 v[4:5], s[50:51], 0, v[4:5]
  v_mfma_f32_16x16x32_bf16 a[116:119], v[36:39], v[92:95], a[116:119]
  v_mfma_f32_16x16x32_bf16 a[120:123], v[40:43], v[92:95], a[120:123]
  v_mfma_f32_16x16x32_bf16 a[124:127], v[44:47], v[92:95], a[124:127]
  s_waitcnt vmcnt(13) lgkmcnt(0)
  s_barrier
  v_mfma_f32_16x16x32_bf16 a[0:3], v[120:123], v[48:51], a[0:3]
  ds_read_b128 v[16:19], v6 offset:32768
  s_add_u32 m0, s52, 16384
  v_mfma_f32_16x16x32_bf16 a[4:7], v[120:123], v[52:55], a[4:7]
  ds_read_b64_tr_b16 v[80:81], v7 offset:32768
  v_mfma_f32_16x16x32_bf16 a[8:11], v[120:123], v[56:59], a[8:11]
  buffer_load_dwordx4 v188, s[12:15], s45 offen offset:0 sc1 lds
  v_mfma_f32_16x16x32_bf16 a[12:15], v[120:123], v[60:63], a[12:15]
  ds_read_b128 v[20:23], v6 offset:33792
  v_mfma_f32_16x16x32_bf16 a[16:19], v[120:123], v[64:67], a[16:19]
  ds_read_b64_tr_b16 v[82:83], v7 offset:34816
  v_mfma_f32_16x16x32_bf16 a[20:23], v[120:123], v[68:71], a[20:23]
  buffer_load_dwordx4 v188, s[12:15], s45 offen offset:1024 sc1 lds
  v_mfma_f32_16x16x32_bf16 a[24:27], v[120:123], v[72:75], a[24:27]
  ds_read_b128 v[24:27], v6 offset:34816
  v_mfma_f32_16x16x32_bf16 a[28:31], v[120:123], v[76:79], a[28:31]
  buffer_load_dwordx4 v188, s[12:15], s45 offen offset:2048 sc1 lds
  v_mfma_f32_16x16x32_bf16 a[32:35], v[124:127], v[48:51], a[32:35]
  ds_read_b64_tr_b16 v[84:85], v8 offset:32768
  v_mfma_f32_16x16x32_bf16 a[36:39], v[124:127], v[52:55], a[36:39]
  buffer_load_dwordx4 v188, s[12:15], s45 offen offset:3072 sc1 lds
  v_mfma_f32_16x16x32_bf16 a[40:43], v[124:127], v[56:59], a[40:43]
  ds_read_b128 v[28:31], v6 offset:35840
  ds_read_b64_tr_b16 v[86:87], v8 offset:34816
  v_mfma_f32_16x16x32_bf16 a[44:47], v[124:127], v[60:63], a[44:47]
  s_add_u32 s45, s45, 16384
  v_mfma_f32_16x16x32_bf16 a[48:51], v[124:127], v[64:67], a[48:51]
  ds_read_b128 v[32:35], v6 offset:36864
  s_add_u32 m0, s53, 24576
  v_mfma_f32_16x16x32_bf16 a[52:55], v[124:127], v[68:71], a[52:55]
  ds_read_b64_tr_b16 v[88:89], v7 offset:36864
  v_mfma_f32_16x16x32_bf16 a[56:59], v[124:127], v[72:75], a[56:59]
  v_mfma_f32_16x16x32_bf16 a[60:63], v[124:127], v[76:79], a[60:63]
  ds_read_b128 v[36:39], v6 offset:37888
  v_mfma_f32_16x16x32_bf16 a[64:67], v[48:51], v[128:131], a[64:67]
  buffer_load_dwordx4 v3, s[24:27], s47 offen lds
  v_mfma_f32_16x16x32_bf16 a[68:71], v[52:55], v[128:131], a[68:71]
  ds_read_b64_tr_b16 v[90:91], v7 offset:38912
  s_add_u32 m0, s53, 28672
  v_mfma_f32_16x16x32_bf16 a[72:75], v[56:59], v[128:131], a[72:75]
  ds_read_b128 v[40:43], v6 offset:38912
  v_mfma_f32_16x16x32_bf16 a[76:79], v[60:63], v[128:131], a[76:79]
  ds_read_b64_tr_b16 v[92:93], v8 offset:36864
  v_mfma_f32_16x16x32_bf16 a[80:83], v[64:67], v[128:131], a[80:83]
  buffer_load_dwordx4 v3, s[28:31], s47 offen lds
  v_mfma_f32_16x16x32_bf16 a[84:87], v[68:71], v[128:131], a[84:87]
  ds_read_b128 v[44:47], v6 offset:39936
  s_add_u32 m0, s54, 4096
  v_mfma_f32_16x16x32_bf16 a[88:91], v[72:75], v[128:131], a[88:91]
  ds_read_b64_tr_b16 v[94:95], v8 offset:38912
  v_mfma_f32_16x16x32_bf16 a[92:95], v[76:79], v[128:131], a[92:95]
  global_load_lds_dwordx4 v[4:5], off
  v_mfma_f32_16x16x32_bf16 a[96:99], v[48:51], v[132:135], a[96:99]
  v_mfma_f32_16x16x32_bf16 a[100:103], v[52:55], v[132:135], a[100:103]
  s_add_u32 s47, s47, s49
  v_mfma_f32_16x16x32_bf16 a[104:107], v[56:59], v[132:135], a[104:107]
  v_mfma_f32_16x16x32_bf16 a[108:111], v[60:63], v[132:135], a[108:111]
  v_lshl_add_u64 v[4:5], s[50:51], 0, v[4:5]
  v_mfma_f32_16x16x32_bf16 a[112:115], v[64:67], v[132:135], a[112:115]
  v_mfma_f32_16x16x32_bf16 a[116:119], v[68:71], v[132:135], a[116:119]
  v_mfma_f32_16x16x32_bf16 a[120:123], v[72:75], v[132:135], a[120:123]
  v_mfma_f32_16x16x32_bf16 a[124:127], v[76:79], v[132:135], a[124:127]
  s_waitcnt vmcnt(14) lgkmcnt(0)
  s_barrier
  v_mfma_f32_16x16x32_bf16 a[0:3], v[80:83], v[16:19], a[0:3]
  ds_read_b128 v[48:51], v6 offset:49152
  s_add_u32 m0, s52, 32768
  v_mfma_f32_16x16x32_bf16 a[4:7], v[80:83], v[20:23], a[4:7]
  ds_read_b64_tr_b16 v[120:121], v7 offset:49152
  v_mfma_f32_16x16x32_bf16 a[8:11], v[80:83], v[24:27], a[8:11]
  s_getpc_b64 s[58:59]
pfc_4:
  s_sub_u32 s58, s58, pfc_4-fz_start
  s_subb_u32 s59, s59, 0
  v_mfma_f32_16x16x32_bf16 a[12:15], v[80:83], v[28:31], a[12:15]
  buffer_load_dwordx4 v188, s[12:15], s45 offen offset:0 sc1 lds
  v_mfma_f32_16x16x32_bf16 a[16:19], v[80:83], v[32:35], a[16:19]
  s_lshl_b32 s60, s3, 2
  ds_read_b128 v[52:55], v6 offset:50176
  v_mfma_f32_16x16x32_bf16 a[20:23], v[80:83], v[36:39], a[20:23]
  ds_read_b64_tr_b16 v[122:123], v7 offset:51200
  s_and_b32 s61, s44, 3
  v_mfma_f32_16x16x32_bf16 a[24:27], v[80:83], v[40:43], a[24:27]
  buffer_load_dwordx4 v188, s[12:15], s45 offen offset:1024 sc1 lds
  v_mfma_f32_16x16x32_bf16 a[28:31], v[80:83], v[44:47], a[28:31]
  ds_read_b128 v[56:59], v6 offset:51200
  s_add_u32 s60, s60, s61
  v_mfma_f32_16x16x32_bf16 a[32:35], v[84:87], v[16:19], a[32:35]
  buffer_load_dwordx4 v188, s[12:15], s45 offen offset:2048 sc1 lds
  v_mfma_f32_16x16x32_bf16 a[36:39], v[84:87], v[20:23], a[36:39]
  ds_read_b64_tr_b16 v[124:125], v8 offset:49152
  s_lshl_b32 s60, s60, 2
  v_mfma_f32_16x16x32_bf16 a[40:43], v[84:87], v[24:27], a[40:43]
  buffer_load_dwordx4 v188, s[12:15], s45 offen offset:3072 sc1 lds
  v_mfma_f32_16x16x32_bf16 a[44:47], v[84:87], v[28:31], a[44:47]
  ds_read_b128 v[60:63], v6 offset:52224
  s_and_b32 s61, s43, 3
  v_mfma_f32_16x16x32_bf16 a[48:51], v[84:87], v[32:35], a[48:51]
  ds_read_b64_tr_b16 v[126:127], v8 offset:51200
  s_add_u32 s45, s45, 16384
  v_mfma_f32_16x16x32_bf16 a[52:55], v[84:87], v[36:39], a[52:55]
  s_add_u32 s60, s60, s61
  ds_read_b128 v[64:67], v6 offset:53248
  v_mfma_f32_16x16x32_bf16 a[56:59], v[84:87], v[40:43], a[56:59]
  s_add_u32 m0, s53, 40960
  ds_read_b64_tr_b16 v[128:129], v7 offset:53248
  v_mfma_f32_16x16x32_bf16 a[60:63], v[84:87], v[44:47], a[60:63]
  s_lshl_b32 s60, s60, 2
  s_add_u32 s60, s60, s40
  v_mfma_f32_16x16x32_bf16 a[64:67], v[16:19], v[88:91], a[64:67]
  ds_read_b128 v[68:71], v6 offset:54272
  ds_read_b64_tr_b16 v[130:131], v7 offset:55296
  v_mfma_f32_16x16x32_bf16 a[68:71], v[20:23], v[88:91], a[68:71]
  buffer_load_dwordx4 v3, s[24:27], s47 offen lds
  v_mfma_f32_16x16x32_bf16 a[72:75], v[24:27], v[88:91], a[72:75]
  s_lshl_b32 s60, s60, 10
  s_add_u32 m0, s53, 45056
  v_mfma_f32_16x16x32_bf16 a[76:79], v[28:31], v[88:91], a[76:79]
  ds_read_b128 v[72:75], v6 offset:55296
  v_and_b32 v12, 7, v0
  v_mfma_f32_16x16x32_bf16 a[80:83], v[32:35], v[88:91], a[80:83]
  ds_read_b64_tr_b16 v[132:133], v8 offset:53248
  v_lshlrev_b32 v12, 7, v12
  v_mfma_f32_16x16x32_bf16 a[84:87], v[36:39], v[88:91], a[84:87]
  buffer_load_dwordx4 v3, s[28:31], s47 offen lds
  v_mfma_f32_16x16x32_bf16 a[88:91], v[40:43], v[88:91], a[88:91]
  ds_read_b128 v[76:79], v6 offset:56320
  s_add_u32 m0, s54, 8192
  v_mfma_f32_16x16x32_bf16 a[92:95], v[44:47], v[88:91], a[92:95]
  ds_read_b64_tr_b16 v[134:135], v8 offset:55296
  v_add_u32 v12, s60, v12
  v_mfma_f32_16x16x32_bf16 a[96:99], v[16:19], v[92:95], a[96:99]
  global_load_lds_dwordx4 v[4:5], off
  v_mfma_f32_16x16x32_bf16 a[100:103], v[20:23], v[92:95], a[100:103]
  s_mov_b32 s60, fz_end-fz_start-4
  s_add_u32 s47, s47, s49
  v_mfma_f32_16x16x32_bf16 a[104:107], v[24:27], v[92:95], a[104:107]
  v_min_u32 v12, s60, v12
  v_mov_b32 v13, s59
  v_mfma_f32_16x16x32_bf16 a[108:111], v[28:31], v[92:95], a[108:111]
  v_lshl_add_u64 v[4:5], s[50:51], 0, v[4:5]
  v_mfma_f32_16x16x32_bf16 a[112:115], v[32:35], v[92:95], a[112:115]
  v_add_co_u32 v12, vcc, s58, v12
  s_nop 1
  v_addc_co_u32 v13, vcc, 0, v13, vcc
  v_mfma_f32_16x16x32_bf16 a[116:119], v[36:39], v[92:95], a[116:119]
  v_mfma_f32_16x16x32_bf16 a[120:123], v[40:43], v[92:95], a[120:123]
  global_load_dword v191, v[12:13], off
  v_mfma_f32_16x16x32_bf16 a[124:127], v[44:47], v[92:95], a[124:127]
  s_waitcnt vmcnt(15) lgkmcnt(0)
  s_barrier
  v_mfma_f32_16x16x32_bf16 a[0:3], v[120:123], v[48:51], a[0:3]
  ds_read_b128 v[16:19], v6 offset:0
  s_add_u32 m0, s52, 49152
  v_mfma_f32_16x16x32_bf16 a[4:7], v[120:123], v[52:55], a[4:7]
  ds_read_b64_tr_b16 v[96:97], v7 offset:8192
  v_mfma_f32_16x16x32_bf16 a[8:11], v[120:123], v[56:59], a[8:11]
  ds_read_b128 v[20:23], v6 offset:1024
  v_mfma_f32_16x16x32_bf16 a[12:15], v[120:123], v[60:63], a[12:15]
  buffer_load_dwordx4 v188, s[12:15], s45 offen offset:0 sc1 lds
  v_mfma_f32_16x16x32_bf16 a[16:19], v[120:123], v[64:67], a[16:19]
  ds_read_b64_tr_b16 v[98:99], v7 offset:10240
  ds_read_b64_tr_b16 v[100:101], v8 offset:8192
  v_mfma_f32_16x16x32_bf16 a[20:23], v[120:123], v[68:71], a[20:23]
  buffer_load_dwordx4 v188, s[12:15], s45 offen offset:1024 sc1 lds
  v_mfma_f32_16x16x32_bf16 a[24:27], v[120:123], v[72:75], a[24:27]
  ds_read_b128 v[24:27], v6 offset:2048
  v_mfma_f32_16x16x32_bf16 a[28:31], v[120:123], v[76:79], a[28:31]
  buffer_load_dwordx4 v188, s[12:15], s45 offen offset:2048 sc1 lds
  v_mfma_f32_16x16x32_bf16 a[32:35], v[124:127], v[48:51], a[32:35]
  ds_read_b64_tr_b16 v[102:103], v8 offset:10240
  ds_read_b128 v[28:31], v6 offset:3072
  v_mfma_f32_16x16x32_bf16 a[36:39], v[124:127], v[52:55], a[36:39]
  buffer_load_dwordx4 v188, s[12:15], s45 offen offset:3072 sc1 lds
  v_mfma_f32_16x16x32_bf16 a[40:43], v[124:127], v[56:59], a[40:43]
  ds_read_b64_tr_b16 v[104:105], v7 offset:12288
  ds_read_b64_tr_b16 v[106:107], v7 offset:14336
  v_mfma_f32_16x16x32_bf16 a[44:47], v[124:127], v[60:63], a[44:47]
  s_add_u32 s45, s45, 16384
  v_mfma_f32_16x16x32_bf16 a[48:51], v[124:127], v[64:67], a[48:51]
  ds_read_b128 v[32:35], v6 offset:4096
  s_add_u32 m0, s53, 57344
  v_mfma_f32_16x16x32_bf16 a[52:55], v[124:127], v[68:71], a[52:55]
  ds_read_b64_tr_b16 v[108:109], v8 offset:12288
  v_mfma_f32_16x16x32_bf16 a[56:59], v[124:127], v[72:75], a[56:59]
  ds_read_b128 v[36:39], v6 offset:5120
  v_mfma_f32_16x16x32_bf16 a[60:63], v[124:127], v[76:79], a[60:63]
  ds_read_b64_tr_b16 v[110:111], v8 offset:14336
  v_mfma_f32_16x16x32_bf16 a[64:67], v[48:51], v[128:131], a[64:67]
  buffer_load_dwordx4 v3, s[24:27], s47 offen lds
  v_mfma_f32_16x16x32_bf16 a[68:71], v[52:55], v[128:131], a[68:71]
  ds_read_b64_tr_b16 v[112:113], v9 offset:0
  s_add_u32 m0, s53, 61440
  v_mfma_f32_16x16x32_bf16 a[72:75], v[56:59], v[128:131], a[72:75]
  ds_read_b128 v[40:43], v6 offset:6144
  v_mfma_f32_16x16x32_bf16 a[76:79], v[60:63], v[128:131], a[76:79]
  ds_read_b64_tr_b16 v[114:115], v9 offset:2048
  v_mfma_f32_16x16x32_bf16 a[80:83], v[64:67], v[128:131], a[80:83]
  buffer_load_dwordx4 v3, s[28:31], s47 offen lds
  v_mfma_f32_16x16x32_bf16 a[84:87], v[68:71], v[128:131], a[84:87]
  ds_read_b128 v[44:47], v6 offset:7168
  ds_read_b64_tr_b16 v[116:117], v10 offset:0
  v_mfma_f32_16x16x32_bf16 a[88:91], v[72:75], v[128:131], a[88:91]
  s_add_u32 m0, s54, 12288
  ds_read_b64_tr_b16 v[118:119], v10 offset:2048
  v_mfma_f32_16x16x32_bf16 a[92:95], v[76:79], v[128:131], a[92:95]
  global_load_lds_dwordx4 v[4:5], off
  v_mfma_f32_16x16x32_bf16 a[96:99], v[48:51], v[132:135], a[96:99]
  v_mfma_f32_16x16x32_bf16 a[100:103], v[52:55], v[132:135], a[100:103]
  s_add_u32 s47, s47, s49
  v_mfma_f32_16x16x32_bf16 a[104:107], v[56:59], v[132:135], a[104:107]
  v_mfma_f32_16x16x32_bf16 a[108:111], v[60:63], v[132:135], a[108:111]
  v_lshl_add_u64 v[4:5], s[50:51], 0, v[4:5]
  v_mfma_f32_16x16x32_bf16 a[112:115], v[64:67], v[132:135], a[112:115]
  v_mfma_f32_16x16x32_bf16 a[116:119], v[68:71], v[132:135], a[116:119]
  v_mfma_f32_16x16x32_bf16 a[120:123], v[72:75], v[132:135], a[120:123]
  v_mfma_f32_16x16x32_bf16 a[124:127], v[76:79], v[132:135], a[124:127]
  s_waitcnt vmcnt(15) lgkmcnt(0)
  s_barrier
  v_mfma_f32_16x16x32_bf16 a[128:131], v[96:99], v[16:19], a[128:131]
  ds_read_b128 v[48:51], v6 offset:16384
  s_add_u32 m0, s52, 0
  v_mfma_f32_16x16x32_bf16 a[132:135], v[96:99], v[20:23], a[132:135]
  s_lshl_b32 s60, s43, 4
  s_lshl_b32 s61, s41, 3
  v_mfma_f32_16x16x32_bf16 a[136:139], v[96:99], v[24:27], a[136:139]
  ds_read_b64_tr_b16 v[136:137], v7 offset:24576
  s_add_u32 s60, s60, s61
  v_mfma_f32_16x16x32_bf16 a[140:143], v[96:99], v[28:31], a[140:143]
  buffer_load_dwordx4 v188, s[12:15], s45 offen offset:0 sc1 lds
  v_mfma_f32_16x16x32_bf16 a[144:147], v[96:99], v[32:35], a[144:147]
  s_lshl_b32 s62, s44, 1
  ds_read_b128 v[52:55], v6 offset:17408
  v_mfma_f32_16x16x32_bf16 a[148:151], v[96:99], v[36:39], a[148:151]
  s_add_u32 s62, s62, s42
  v_mfma_f32_16x16x32_bf16 a[152:155], v[96:99], v[40:43], a[152:155]
  s_add_u32 s32, s6, 4194304
  s_addc_u32 s33, s7, 0
  s_mov_b32 s34, 8388608
  s_mov_b32 s35, 0x20000
  v_mfma_f32_16x16x32_bf16 a[156:159], v[96:99], v[44:47], a[156:159]
  ds_read_b64_tr_b16 v[138:139], v7 offset:26624
  v_mfma_f32_16x16x32_bf16 a[160:163], v[100:103], v[16:19], a[160:163]
  buffer_load_dwordx4 v188, s[12:15], s45 offen offset:1024 sc1 lds
  v_mfma_f32_16x16x32_bf16 a[164:167], v[100:103], v[20:23], a[164:167]
  s_add_u32 s36, s6, 12582912
  s_addc_u32 s37, s7, 0
  s_mov_b32 s38, 4194304
  s_mov_b32 s39, 0x20000
  v_mfma_f32_16x16x32_bf16 a[168:171], v[100:103], v[24:27], a[168:171]
  s_lshl_b32 s56, s62, 17
  s_lshl_b32 s61, s60, 10
  v_mfma_f32_16x16x32_bf16 a[172:175], v[100:103], v[28:31], a[172:175]
  ds_read_b64_tr_b16 v[140:141], v8 offset:24576
  s_add_u32 s56, s56, s61
  v_mfma_f32_16x16x32_bf16 a[176:179], v[100:103], v[32:35], a[176:179]
  buffer_load_dwordx4 v188, s[12:15], s45 offen offset:2048 sc1 lds
  v_mfma_f32_16x16x32_bf16 a[180:183], v[100:103], v[36:39], a[180:183]
  s_add_u32 s56, s56, 4194304
  ds_read_b128 v[56:59], v6 offset:18432
  v_mfma_f32_16x16x32_bf16 a[184:187], v[100:103], v[40:43], a[184:187]
  s_add_u32 s57, s56, 4096
  v_accvgpr_read_b32 v164, a0
  v_mfma_f32_16x16x32_bf16 a[188:191], v[100:103], v[44:47], a[188:191]
  ds_read_b64_tr_b16 v[142:143], v8 offset:26624
  v_accvgpr_read_b32 v165, a1
  v_mfma_f32_16x16x32_bf16 a[192:195], v[104:107], v[16:19], a[192:195]
  buffer_load_dwordx4 v188, s[12:15], s45 offen offset:3072 sc1 lds
  v_mfma_f32_16x16x32_bf16 a[196:199], v[104:107], v[20:23], a[196:199]
  v_accvgpr_read_b32 v166, a2
  ds_read_b128 v[60:63], v6 offset:19456
  v_mfma_f32_16x16x32_bf16 a[200:203], v[104:107], v[24:27], a[200:203]
  v_accvgpr_read_b32 v167, a3
  v_accvgpr_read_b32 v168, a32
  v_mfma_f32_16x16x32_bf16 a[204:207], v[104:107], v[28:31], a[204:207]
  v_accvgpr_read_b32 v169, a33
  ds_read_b64_tr_b16 v[144:145], v7 offset:28672
  v_mfma_f32_16x16x32_bf16 a[208:211], v[104:107], v[32:35], a[208:211]
  s_add_u32 s45, s45, 16384
  v_accvgpr_read_b32 v170, a34
  v_mfma_f32_16x16x32_bf16 a[212:215], v[104:107], v[36:39], a[212:215]
  v_accvgpr_read_b32 v171, a35
  ds_read_b64_tr_b16 v[146:147], v7 offset:30720
  v_mfma_f32_16x16x32_bf16 a[216:219], v[104:107], v[40:43], a[216:219]
  v_cvt_pk_bf16_f32 v160, v164, v165
  s_add_u32 m0, s53, 8192
  v_mfma_f32_16x16x32_bf16 a[220:223], v[104:107], v[44:47], a[220:223]
  v_cvt_pk_bf16_f32 v161, v166, v167
  ds_read_b128 v[64:67], v6 offset:20480
  v_mfma_f32_16x16x32_bf16 a[224:227], v[108:111], v[16:19], a[224:227]
  v_cvt_pk_bf16_f32 v162, v168, v169
  v_cvt_pk_bf16_f32 v163, v170, v171
  v_mfma_f32_16x16x32_bf16 a[228:231], v[108:111], v[20:23], a[228:231]
  buffer_store_dwordx4 v[160:163], v1, s[32:35], s56 offen offset:0 sc1
  v_mfma_f32_16x16x32_bf16 a[232:235], v[108:111], v[24:27], a[232:235]
  ds_read_b64_tr_b16 v[148:149], v8 offset:28672
  v_accvgpr_read_b32 v176, a4
  v_mfma_f32_16x16x32_bf16 a[236:239], v[108:111], v[28:31], a[236:239]
  buffer_load_dwordx4 v3, s[24:27], s47 offen lds
  v_mfma_f32_16x16x32_bf16 a[240:243], v[108:111], v[32:35], a[240:243]
  v_accvgpr_read_b32 v177, a5
  ds_read_b128 v[68:71], v6 offset:21504
  v_mfma_f32_16x16x32_bf16 a[244:247], v[108:111], v[36:39], a[244:247]
  v_accvgpr_read_b32 v178, a6
  v_accvgpr_read_b32 v179, a7
  v_mfma_f32_16x16x32_bf16 a[248:251], v[108:111], v[40:43], a[248:251]
  ds_read_b64_tr_b16 v[150:151], v8 offset:30720
  s_add_u32 m0, s53, 12288
  v_mfma_f32_16x16x32_bf16 a[252:255], v[108:111], v[44:47], a[252:255]
  v_accvgpr_read_b32 v180, a36
  v_accvgpr_read_b32 v181, a37
  v_mfma_f32_16x16x32_bf16 v[192:195], v[112:115], v[16:19], v[192:195]
  v_accvgpr_read_b32 v182, a38
  ds_read_b64_tr_b16 v[152:153], v9 offset:4096
  v_mfma_f32_16x16x32_bf16 v[196:199], v[112:115], v[20:23], v[196:199]
  v_accvgpr_read_b32 v183, a39
  v_cvt_pk_bf16_f32 v172, v176, v177
  v_mfma_f32_16x16x32_bf16 v[200:203], v[112:115], v[24:27], v[200:203]
  buffer_load_dwordx4 v3, s[28:31], s47 offen lds
  v_mfma_f32_16x16x32_bf16 v[204:207], v[112:115], v[28:31], v[204:207]
  ds_read_b128 v[72:75], v6 offset:22528
  v_cvt_pk_bf16_f32 v173, v178, v179
  v_mfma_f32_16x16x32_bf16 v[208:211], v[112:115], v[32:35], v[208:211]
  v_cvt_pk_bf16_f32 v174, v180, v181
  ds_read_b64_tr_b16 v[154:155], v9 offset:6144
  v_mfma_f32_16x16x32_bf16 v[212:215], v[112:115], v[36:39], v[212:215]
  s_add_u32 m0, s54, 0
  v_cvt_pk_bf16_f32 v175, v182, v183
  v_mfma_f32_16x16x32_bf16 v[216:219], v[112:115], v[40:43], v[216:219]
  ds_read_b128 v[76:79], v6 offset:23552
  ds_read_b64_tr_b16 v[156:157], v10 offset:4096
  v_mfma_f32_16x16x32_bf16 v[220:223], v[112:115], v[44:47], v[220:223]
  buffer_store_dwordx4 v[172:175], v1, s[32:35], s56 offen offset:1024 sc1
  ds_read_b64_tr_b16 v[158:159], v10 offset:6144
  v_mfma_f32_16x16x32_bf16 v[224:227], v[116:119], v[16:19], v[224:227]
  v_accvgpr_read_b32 v164, a8
  v_accvgpr_read_b32 v165, a9
  v_mfma_f32_16x16x32_bf16 v[228:231], v[116:119], v[20:23], v[228:231]
  v_accvgpr_read_b32 v166, a10
  v_accvgpr_read_b32 v167, a11
  v_mfma_f32_16x16x32_bf16 v[232:235], v[116:119], v[24:27], v[232:235]
  v_accvgpr_read_b32 v168, a40
  v_accvgpr_read_b32 v169, a41
  v_mfma_f32_16x16x32_bf16 v[236:239], v[116:119], v[28:31], v[236:239]
  v_accvgpr_read_b32 v170, a42
  v_accvgpr_read_b32 v171, a43
  v_mfma_f32_16x16x32_bf16 v[240:243], v[116:119], v[32:35], v[240:243]
  global_load_lds_dwordx4 v[4:5], off
  v_mfma_f32_16x16x32_bf16 v[244:247], v[116:119], v[36:39], v[244:247]
  s_add_u32 s47, s47, s49
  v_cvt_pk_bf16_f32 v160, v164, v165
  v_lshl_add_u64 v[4:5], s[50:51], 0, v[4:5]
  v_mfma_f32_16x16x32_bf16 v[248:251], v[116:119], v[40:43], v[248:251]
  v_cvt_pk_bf16_f32 v161, v166, v167
  v_cvt_pk_bf16_f32 v162, v168, v169
  v_mfma_f32_16x16x32_bf16 v[252:255], v[116:119], v[44:47], v[252:255]
  v_cvt_pk_bf16_f32 v163, v170, v171
  buffer_store_dwordx4 v[160:163], v1, s[32:35], s56 offen offset:2048 sc1
  v_accvgpr_read_b32 v176, a12
  v_accvgpr_read_b32 v177, a13
  v_accvgpr_read_b32 v178, a14
  s_waitcnt vmcnt(18) lgkmcnt(0)
  s_barrier
  v_mfma_f32_16x16x32_bf16 a[128:131], v[136:139], v[48:51], a[128:131]
  ds_read_b128 v[16:19], v6 offset:32768
  s_add_u32 m0, s52, 16384
  v_mfma_f32_16x16x32_bf16 a[132:135], v[136:139], v[52:55], a[132:135]
  v_accvgpr_read_b32 v179, a15
  v_accvgpr_read_b32 v180, a44
  v_mfma_f32_16x16x32_bf16 a[136:139], v[136:139], v[56:59], a[136:139]
  ds_read_b64_tr_b16 v[96:97], v7 offset:40960
  v_accvgpr_read_b32 v181, a45
  v_mfma_f32_16x16x32_bf16 a[140:143], v[136:139], v[60:63], a[140:143]
  buffer_load_dwordx4 v188, s[12:15], s45 offen offset:0 sc1 lds
  v_mfma_f32_16x16x32_bf16 a[144:147], v[136:139], v[64:67], a[144:147]
  v_accvgpr_read_b32 v182, a46
  ds_read_b128 v[20:23], v6 offset:33792
  v_mfma_f32_16x16x32_bf16 a[148:151], v[136:139], v[68:71], a[148:151]
  v_accvgpr_read_b32 v183, a47
  v_cvt_pk_bf16_f32 v172, v176, v177
  v_mfma_f32_16x16x32_bf16 a[152:155], v[136:139], v[72:75], a[152:155]
  v_cvt_pk_bf16_f32 v173, v178, v179
  ds_read_b64_tr_b16 v[98:99], v7 offset:43008
  v_mfma_f32_16x16x32_bf16 a[156:159], v[136:139], v[76:79], a[156:159]
  buffer_load_dwordx4 v188, s[12:15], s45 offen offset:1024 sc1 lds
  v_mfma_f32_16x16x32_bf16 a[160:163], v[140:143], v[48:51], a[160:163]
  v_cvt_pk_bf16_f32 v174, v180, v181
  v_cvt_pk_bf16_f32 v175, v182, v183
  v_mfma_f32_16x16x32_bf16 a[164:167], v[140:143], v[52:55], a[164:167]
  ds_read_b64_tr_b16 v[100:101], v8 offset:40960
  v_mfma_f32_16x16x32_bf16 a[168:171], v[140:143], v[56:59], a[168:171]
  buffer_store_dwordx4 v[172:175], v1, s[32:35], s56 offen offset:3072 sc1
  v_mfma_f32_16x16x32_bf16 a[172:175], v[140:143], v[60:63], a[172:175]
  v_accvgpr_read_b32 v164, a16
  v_accvgpr_read_b32 v165, a17
  v_mfma_f32_16x16x32_bf16 a[176:179], v[140:143], v[64:67], a[176:179]
  buffer_load_dwordx4 v188, s[12:15], s45 offen offset:2048 sc1 lds
  v_mfma_f32_16x16x32_bf16 a[180:183], v[140:143], v[68:71], a[180:183]
  ds_read_b128 v[24:27], v6 offset:34816
  v_accvgpr_read_b32 v166, a18
  v_mfma_f32_16x16x32_bf16 a[184:187], v[140:143], v[72:75], a[184:187]
  v_accvgpr_read_b32 v167, a19
  ds_read_b64_tr_b16 v[102:103], v8 offset:43008
  v_mfma_f32_16x16x32_bf16 a[188:191], v[140:143], v[76:79], a[188:191]
  v_accvgpr_read_b32 v168, a48
  v_accvgpr_read_b32 v169, a49
  v_mfma_f32_16x16x32_bf16 a[192:195], v[144:147], v[48:51], a[192:195]
  buffer_load_dwordx4 v188, s[12:15], s45 offen offset:3072 sc1 lds
  v_mfma_f32_16x16x32_bf16 a[196:199], v[144:147], v[52:55], a[196:199]
  v_accvgpr_read_b32 v170, a50
  ds_read_b128 v[28:31], v6 offset:35840
  v_mfma_f32_16x16x32_bf16 a[200:203], v[144:147], v[56:59], a[200:203]
  v_accvgpr_read_b32 v171, a51
  v_cvt_pk_bf16_f32 v160, v164, v165
  v_mfma_f32_16x16x32_bf16 a[204:207], v[144:147], v[60:63], a[204:207]
  ds_read_b64_tr_b16 v[104:105], v7 offset:45056
  s_add_u32 s45, s45, 16384
  v_mfma_f32_16x16x32_bf16 a[208:211], v[144:147], v[64:67], a[208:211]
  v_cvt_pk_bf16_f32 v161, v166, v167
  v_cvt_pk_bf16_f32 v162, v168, v169
  v_mfma_f32_16x16x32_bf16 a[212:215], v[144:147], v[68:71], a[212:215]
  v_cvt_pk_bf16_f32 v163, v170, v171
  ds_read_b64_tr_b16 v[106:107], v7 offset:47104
  v_mfma_f32_16x16x32_bf16 a[216:219], v[144:147], v[72:75], a[216:219]
  buffer_store_dwordx4 v[160:163], v1, s[32:35], s57 offen offset:0 sc1
  v_mfma_f32_16x16x32_bf16 a[220:223], v[144:147], v[76:79], a[220:223]
  s_add_u32 m0, s53, 24576
  v_accvgpr_read_b32 v176, a20
  v_mfma_f32_16x16x32_bf16 a[224:227], v[148:151], v[48:51], a[224:227]
  ds_read_b128 v[32:35], v6 offset:36864
  v_accvgpr_read_b32 v177, a21
  v_mfma_f32_16x16x32_bf16 a[228:231], v[148:151], v[52:55], a[228:231]
  v_accvgpr_read_b32 v178, a22
  v_accvgpr_read_b32 v179, a23
  v_mfma_f32_16x16x32_bf16 a[232:235], v[148:151], v[56:59], a[232:235]
  ds_read_b64_tr_b16 v[108:109], v8 offset:45056
  v_accvgpr_read_b32 v180, a52
  v_mfma_f32_16x16x32_bf16 a[236:239], v[148:151], v[60:63], a[236:239]
  buffer_load_dwordx4 v3, s[24:27], s47 offen lds
  v_mfma_f32_16x16x32_bf16 a[240:243], v[148:151], v[64:67], a[240:243]
  v_accvgpr_read_b32 v181, a53
  ds_read_b128 v[36:39], v6 offset:37888
  v_mfma_f32_16x16x32_bf16 a[244:247], v[148:151], v[68:71], a[244:247]
  v_accvgpr_read_b32 v182, a54
  v_accvgpr_read_b32 v183, a55
  v_mfma_f32_16x16x32_bf16 a[248:251], v[148:151], v[72:75], a[248:251]
  v_cvt_pk_bf16_f32 v172, v176, v177
  ds_read_b64_tr_b16 v[110:111], v8 offset:47104
  v_mfma_f32_16x16x32_bf16 a[252:255], v[148:151], v[76:79], a[252:255]
  s_add_u32 m0, s53, 28672
  v_cvt_pk_bf16_f32 v173, v178, v179
  v_mfma_f32_16x16x32_bf16 v[192:195], v[152:155], v[48:51], v[192:195]
  v_cvt_pk_bf16_f32 v174, v180, v181
  ds_read_b64_tr_b16 v[112:113], v9 offset:8192
  v_mfma_f32_16x16x32_bf16 v[196:199], v[152:155], v[52:55], v[196:199]
  v_cvt_pk_bf16_f32 v175, v182, v183
  ds_read_b128 v[40:43], v6 offset:38912
  v_mfma_f32_16x16x32_bf16 v[200:203], v[152:155], v[56:59], v[200:203]
  buffer_store_dwordx4 v[172:175], v1, s[32:35], s57 offen offset:1024 sc1
  v_mfma_f32_16x16x32_bf16 v[204:207], v[152:155], v[60:63], v[204:207]
  buffer_load_dwordx4 v3, s[28:31], s47 offen lds
  v_mfma_f32_16x16x32_bf16 v[208:211], v[152:155], v[64:67], v[208:211]
  v_accvgpr_read_b32 v164, a24
  v_accvgpr_read_b32 v165, a25
  v_mfma_f32_16x16x32_bf16 v[212:215], v[152:155], v[68:71], v[212:215]
  v_accvgpr_read_b32 v166, a26
  ds_read_b64_tr_b16 v[114:115], v9 offset:10240
  v_mfma_f32_16x16x32_bf16 v[216:219], v[152:155], v[72:75], v[216:219]
  v_accvgpr_read_b32 v167, a27
  v_accvgpr_read_b32 v168, a56
  v_mfma_f32_16x16x32_bf16 v[220:223], v[152:155], v[76:79], v[220:223]
  v_accvgpr_read_b32 v169, a57
  ds_read_b128 v[44:47], v6 offset:39936
  ds_read_b64_tr_b16 v[116:117], v10 offset:8192
  ds_read_b64_tr_b16 v[118:119], v10 offset:10240
  v_mfma_f32_16x16x32_bf16 v[224:227], v[156:159], v[48:51], v[224:227]
  v_accvgpr_read_b32 v170, a58
  v_accvgpr_read_b32 v171, a59
  v_mfma_f32_16x16x32_bf16 v[228:231], v[156:159], v[52:55], v[228:231]
  v_cvt_pk_bf16_f32 v160, v164, v165
  v_cvt_pk_bf16_f32 v161, v166, v167
  v_mfma_f32_16x16x32_bf16 v[232:235], v[156:159], v[56:59], v[232:235]
  v_cvt_pk_bf16_f32 v162, v168, v169
  v_cvt_pk_bf16_f32 v163, v170, v171
  v_mfma_f32_16x16x32_bf16 v[236:239], v[156:159], v[60:63], v[236:239]
  buffer_store_dwordx4 v[160:163], v1, s[32:35], s57 offen offset:2048 sc1
  v_mfma_f32_16x16x32_bf16 v[240:243], v[156:159], v[64:67], v[240:243]
  s_add_u32 m0, s54, 4096
  v_accvgpr_read_b32 v176, a28
  v_mfma_f32_16x16x32_bf16 v[244:247], v[156:159], v[68:71], v[244:247]
  global_load_lds_dwordx4 v[4:5], off
  s_add_u32 s47, s47, s49
  v_lshl_add_u64 v[4:5], s[50:51], 0, v[4:5]
  v_mfma_f32_16x16x32_bf16 v[248:251], v[156:159], v[72:75], v[248:251]
  v_accvgpr_read_b32 v177, a29
  v_accvgpr_read_b32 v178, a30
  v_mfma_f32_16x16x32_bf16 v[252:255], v[156:159], v[76:79], v[252:255]
  v_accvgpr_read_b32 v179, a31
  v_accvgpr_read_b32 v180, a60
  v_accvgpr_read_b32 v181, a61
  v_accvgpr_read_b32 v182, a62
  v_accvgpr_read_b32 v183, a63
  v_cvt_pk_bf16_f32 v172, v176, v177
  v_cvt_pk_bf16_f32 v173, v178, v179
  s_waitcnt vmcnt(21) lgkmcnt(0)
  s_barrier
  v_mfma_f32_16x16x32_bf16 a[128:131], v[96:99], v[16:19], a[128:131]
  ds_read_b128 v[48:51], v6 offset:49152
  s_add_u32 m0, s52, 32768
  v_mfma_f32_16x16x32_bf16 a[132:135], v[96:99], v[20:23], a[132:135]
  v_cvt_pk_bf16_f32 v174, v180, v181
  v_cvt_pk_bf16_f32 v175, v182, v183
  v_mfma_f32_16x16x32_bf16 a[136:139], v[96:99], v[24:27], a[136:139]
  ds_read_b64_tr_b16 v[136:137], v7 offset:57344
  v_mfma_f32_16x16x32_bf16 a[140:143], v[96:99], v[28:31], a[140:143]
  buffer_store_dwordx4 v[172:175], v1, s[32:35], s57 offen offset:3072 sc1
  v_mfma_f32_16x16x32_bf16 a[144:147], v[96:99], v[32:35], a[144:147]
  buffer_load_dwordx4 v188, s[12:15], s45 offen offset:0 sc1 lds
  v_mfma_f32_16x16x32_bf16 a[148:151], v[96:99], v[36:39], a[148:151]
  s_lshl_b32 s56, s62, 17
  ds_read_b128 v[52:55], v6 offset:50176
  v_mfma_f32_16x16x32_bf16 a[152:155], v[96:99], v[40:43], a[152:155]
  s_lshl_b32 s61, s60, 10
  s_add_u32 s56, s56, s61
  v_mfma_f32_16x16x32_bf16 a[156:159], v[96:99], v[44:47], a[156:159]
  s_add_u32 s57, s56, 4096
  ds_read_b64_tr_b16 v[138:139], v7 offset:59392
  v_mfma_f32_16x16x32_bf16 a[160:163], v[100:103], v[16:19], a[160:163]
  buffer_load_dwordx4 v188, s[12:15], s45 offen offset:1024 sc1 lds
  v_mfma_f32_16x16x32_bf16 a[164:167], v[100:103], v[20:23], a[164:167]
  v_accvgpr_read_b32 v164, a64
  v_accvgpr_read_b32 v165, a65
  v_mfma_f32_16x16x32_bf16 a[168:171], v[100:103], v[24:27], a[168:171]
  ds_read_b64_tr_b16 v[140:141], v8 offset:57344
  v_accvgpr_read_b32 v166, a66
  v_mfma_f32_16x16x32_bf16 a[172:175], v[100:103], v[28:31], a[172:175]
  v_accvgpr_read_b32 v167, a67
  v_accvgpr_read_b32 v168, a68
  v_mfma_f32_16x16x32_bf16 a[176:179], v[100:103], v[32:35], a[176:179]
  buffer_load_dwordx4 v188, s[12:15], s45 offen offset:2048 sc1 lds
  v_mfma_f32_16x16x32_bf16 a[180:183], v[100:103], v[36:39], a[180:183]
  ds_read_b128 v[56:59], v6 offset:51200
  v_accvgpr_read_b32 v169, a69
  v_mfma_f32_16x16x32_bf16 a[184:187], v[100:103], v[40:43], a[184:187]
  v_accvgpr_read_b32 v170, a70
  ds_read_b64_tr_b16 v[142:143], v8 offset:59392
  v_mfma_f32_16x16x32_bf16 a[188:191], v[100:103], v[44:47], a[188:191]
  v_accvgpr_read_b32 v171, a71
  v_cvt_pk_bf16_f32 v160, v164, v165
  v_mfma_f32_16x16x32_bf16 a[192:195], v[104:107], v[16:19], a[192:195]
  buffer_load_dwordx4 v188, s[12:15], s45 offen offset:3072 sc1 lds
  v_mfma_f32_16x16x32_bf16 a[196:199], v[104:107], v[20:23], a[196:199]
  v_cvt_pk_bf16_f32 v161, v166, v167
  ds_read_b128 v[60:63], v6 offset:52224
  v_mfma_f32_16x16x32_bf16 a[200:203], v[104:107], v[24:27], a[200:203]
  v_cvt_pk_bf16_f32 v162, v168, v169
  v_cvt_pk_bf16_f32 v163, v170, v171
  v_mfma_f32_16x16x32_bf16 a[204:207], v[104:107], v[28:31], a[204:207]
  ds_read_b64_tr_b16 v[144:145], v7 offset:61440
  s_add_u32 s45, s45, 16384
  v_mfma_f32_16x16x32_bf16 a[208:211], v[104:107], v[32:35], a[208:211]
  buffer_store_dwordx4 v[160:163], v1, s[36:39], s56 offen offset:0 sc1
  v_mfma_f32_16x16x32_bf16 a[212:215], v[104:107], v[36:39], a[212:215]
  v_accvgpr_read_b32 v176, a72
  v_accvgpr_read_b32 v177, a73
  v_mfma_f32_16x16x32_bf16 a[216:219], v[104:107], v[40:43], a[216:219]
  ds_read_b64_tr_b16 v[146:147], v7 offset:63488
  v_accvgpr_read_b32 v178, a74
  v_mfma_f32_16x16x32_bf16 a[220:223], v[104:107], v[44:47], a[220:223]
  s_add_u32 m0, s53, 40960
  v_accvgpr_read_b32 v179, a75
  v_mfma_f32_16x16x32_bf16 a[224:227], v[108:111], v[16:19], a[224:227]
  ds_read_b128 v[64:67], v6 offset:53248
  v_accvgpr_read_b32 v180, a76
  v_mfma_f32_16x16x32_bf16 a[228:231], v[108:111], v[20:23], a[228:231]
  v_accvgpr_read_b32 v181, a77
  v_accvgpr_read_b32 v182, a78
  v_mfma_f32_16x16x32_bf16 a[232:235], v[108:111], v[24:27], a[232:235]
  ds_read_b64_tr_b16 v[148:149], v8 offset:61440
  v_accvgpr_read_b32 v183, a79
  v_mfma_f32_16x16x32_bf16 a[236:239], v[108:111], v[28:31], a[236:239]
  buffer_load_dwordx4 v3, s[24:27], s47 offen lds
  v_mfma_f32_16x16x32_bf16 a[240:243], v[108:111], v[32:35], a[240:243]
  v_cvt_pk_bf16_f32 v172, v176, v177
  ds_read_b128 v[68:71], v6 offset:54272
  v_mfma_f32_16x16x32_bf16 a[244:247], v[108:111], v[36:39], a[244:247]
  v_cvt_pk_bf16_f32 v173, v178, v179
  v_cvt_pk_bf16_f32 v174, v180, v181
  v_mfma_f32_16x16x32_bf16 a[248:251], v[108:111], v[40:43], a[248:251]
  v_cvt_pk_bf16_f32 v175, v182, v183
  ds_read_b64_tr_b16 v[150:151], v8 offset:63488
  v_mfma_f32_16x16x32_bf16 a[252:255], v[108:111], v[44:47], a[252:255]
  s_add_u32 m0, s53, 45056
  ds_read_b64_tr_b16 v[152:153], v9 offset:12288
  v_mfma_f32_16x16x32_bf16 v[192:195], v[112:115], v[16:19], v[192:195]
  buffer_store_dwordx4 v[172:175], v1, s[36:39], s56 offen offset:2048 sc1
  v_mfma_f32_16x16x32_bf16 v[196:199], v[112:115], v[20:23], v[196:199]
  v_accvgpr_read_b32 v164, a80
  v_accvgpr_read_b32 v165, a81
  v_mfma_f32_16x16x32_bf16 v[200:203], v[112:115], v[24:27], v[200:203]
  v_accvgpr_read_b32 v166, a82
  v_accvgpr_read_b32 v167, a83
  v_mfma_f32_16x16x32_bf16 v[204:207], v[112:115], v[28:31], v[204:207]
  buffer_load_dwordx4 v3, s[28:31], s47 offen lds
  v_mfma_f32_16x16x32_bf16 v[208:211], v[112:115], v[32:35], v[208:211]
  ds_read_b128 v[72:75], v6 offset:55296
  v_accvgpr_read_b32 v168, a84
  v_mfma_f32_16x16x32_bf16 v[212:215], v[112:115], v[36:39], v[212:215]
  v_accvgpr_read_b32 v169, a85
  ds_read_b64_tr_b16 v[154:155], v9 offset:14336
  v_mfma_f32_16x16x32_bf16 v[216:219], v[112:115], v[40:43], v[216:219]
  v_accvgpr_read_b32 v170, a86
  v_accvgpr_read_b32 v171, a87
  v_mfma_f32_16x16x32_bf16 v[220:223], v[112:115], v[44:47], v[220:223]
  v_cvt_pk_bf16_f32 v160, v164, v165
  ds_read_b128 v[76:79], v6 offset:56320
  ds_read_b64_tr_b16 v[156:157], v10 offset:12288
  ds_read_b64_tr_b16 v[158:159], v10 offset:14336
  v_mfma_f32_16x16x32_bf16 v[224:227], v[116:119], v[16:19], v[224:227]
  v_cvt_pk_bf16_f32 v161, v166, v167
  v_cvt_pk_bf16_f32 v162, v168, v169
  v_mfma_f32_16x16x32_bf16 v[228:231], v[116:119], v[20:23], v[228:231]
  v_cvt_pk_bf16_f32 v163, v170, v171
  s_add_u32 m0, s54, 8192
  v_mfma_f32_16x16x32_bf16 v[232:235], v[116:119], v[24:27], v[232:235]
  buffer_store_dwordx4 v[160:163], v1, s[36:39], s57 offen offset:0 sc1
  v_mfma_f32_16x16x32_bf16 v[236:239], v[116:119], v[28:31], v[236:239]
  v_accvgpr_read_b32 v176, a88
  v_accvgpr_read_b32 v177, a89
  v_mfma_f32_16x16x32_bf16 v[240:243], v[116:119], v[32:35], v[240:243]
  global_load_lds_dwordx4 v[4:5], off
  v_mfma_f32_16x16x32_bf16 v[244:247], v[116:119], v[36:39], v[244:247]
  s_add_u32 s47, s47, s49
  v_accvgpr_read_b32 v178, a90
  v_lshl_add_u64 v[4:5], s[50:51], 0, v[4:5]
  v_mfma_f32_16x16x32_bf16 v[248:251], v[116:119], v[40:43], v[248:251]
  v_accvgpr_read_b32 v179, a91
  v_accvgpr_read_b32 v180, a92
  v_mfma_f32_16x16x32_bf16 v[252:255], v[116:119], v[44:47], v[252:255]
  v_accvgpr_read_b32 v181, a93
  v_accvgpr_read_b32 v182, a94
  v_accvgpr_read_b32 v183, a95
  v_cvt_pk_bf16_f32 v172, v176, v177
  v_cvt_pk_bf16_f32 v173, v178, v179
  v_cvt_pk_bf16_f32 v174, v180, v181
  v_cvt_pk_bf16_f32 v175, v182, v183
  buffer_store_dwordx4 v[172:175], v1, s[36:39], s57 offen offset:2048 sc1
  s_waitcnt vmcnt(24) lgkmcnt(0)
  s_barrier
  v_mfma_f32_16x16x32_bf16 a[128:131], v[136:139], v[48:51], a[128:131]
  ds_read_b128 v[16:19], v6 offset:0
  s_add_u32 m0, s52, 49152
  v_mfma_f32_16x16x32_bf16 a[132:135], v[136:139], v[52:55], a[132:135]
  s_lshl_b32 s56, s62, 17
  s_lshl_b32 s61, s60, 10
  v_mfma_f32_16x16x32_bf16 a[136:139], v[136:139], v[56:59], a[136:139]
  ds_read_b64_tr_b16 v[96:97], v7 offset:8192
  s_add_u32 s56, s56, s61
  v_mfma_f32_16x16x32_bf16 a[140:143], v[136:139], v[60:63], a[140:143]
  buffer_load_dwordx4 v188, s[12:15], s45 offen offset:0 sc1 lds
  v_mfma_f32_16x16x32_bf16 a[144:147], v[136:139], v[64:67], a[144:147]
  s_add_u32 s56, s56, 1024
  ds_read_b128 v[20:23], v6 offset:1024
  v_mfma_f32_16x16x32_bf16 a[148:151], v[136:139], v[68:71], a[148:151]
  s_add_u32 s57, s56, 4096
  v_accvgpr_read_b32 v164, a96
  v_mfma_f32_16x16x32_bf16 a[152:155], v[136:139], v[72:75], a[152:155]
  v_accvgpr_read_b32 v165, a97
  ds_read_b64_tr_b16 v[98:99], v7 offset:10240
  v_mfma_f32_16x16x32_bf16 a[156:159], v[136:139], v[76:79], a[156:159]
  buffer_load_dwordx4 v188, s[12:15], s45 offen offset:1024 sc1 lds
  v_mfma_f32_16x16x32_bf16 a[160:163], v[140:143], v[48:51], a[160:163]
  v_accvgpr_read_b32 v166, a98
  v_accvgpr_read_b32 v167, a99
  v_mfma_f32_16x16x32_bf16 a[164:167], v[140:143], v[52:55], a[164:167]
  ds_read_b64_tr_b16 v[100:101], v8 offset:8192
  v_accvgpr_read_b32 v168, a100
  v_mfma_f32_16x16x32_bf16 a[168:171], v[140:143], v[56:59], a[168:171]
  buffer_load_dwordx4 v188, s[12:15], s45 offen offset:2048 sc1 lds
  v_mfma_f32_16x16x32_bf16 a[172:175], v[140:143], v[60:63], a[172:175]
  v_accvgpr_read_b32 v169, a101
  ds_read_b128 v[24:27], v6 offset:2048
  v_mfma_f32_16x16x32_bf16 a[176:179], v[140:143], v[64:67], a[176:179]
  v_accvgpr_read_b32 v170, a102
  v_accvgpr_read_b32 v171, a103
  v_mfma_f32_16x16x32_bf16 a[180:183], v[140:143], v[68:71], a[180:183]
  v_cvt_pk_bf16_f32 v160, v164, v165
  ds_read_b64_tr_b16 v[102:103], v8 offset:10240
  v_mfma_f32_16x16x32_bf16 a[184:187], v[140:143], v[72:75], a[184:187]
  v_cvt_pk_bf16_f32 v161, v166, v167
  v_cvt_pk_bf16_f32 v162, v168, v169
  v_mfma_f32_16x16x32_bf16 a[188:191], v[140:143], v[76:79], a[188:191]
  buffer_load_dwordx4 v188, s[12:15], s45 offen offset:3072 sc1 lds
  v_mfma_f32_16x16x32_bf16 a[192:195], v[144:147], v[48:51], a[192:195]
  ds_read_b128 v[28:31], v6 offset:3072
  v_cvt_pk_bf16_f32 v163, v170, v171
  v_mfma_f32_16x16x32_bf16 a[196:199], v[144:147], v[52:55], a[196:199]
  buffer_store_dwordx4 v[160:163], v1, s[36:39], s56 offen offset:0 sc1
  v_mfma_f32_16x16x32_bf16 a[200:203], v[144:147], v[56:59], a[200:203]
  v_accvgpr_read_b32 v176, a104
  ds_read_b64_tr_b16 v[104:105], v7 offset:12288
  v_mfma_f32_16x16x32_bf16 a[204:207], v[144:147], v[60:63], a[204:207]
  s_add_u32 s45, s45, 16384
  v_accvgpr_read_b32 v177, a105
  v_mfma_f32_16x16x32_bf16 a[208:211], v[144:147], v[64:67], a[208:211]
  v_accvgpr_read_b32 v178, a106
  ds_read_b64_tr_b16 v[106:107], v7 offset:14336
  v_mfma_f32_16x16x32_bf16 a[212:215], v[144:147], v[68:71], a[212:215]
  v_accvgpr_read_b32 v179, a107
  s_add_u32 m0, s53, 57344
  v_mfma_f32_16x16x32_bf16 a[216:219], v[144:147], v[72:75], a[216:219]
  v_accvgpr_read_b32 v180, a108
  v_accvgpr_read_b32 v181, a109
  v_mfma_f32_16x16x32_bf16 a[220:223], v[144:147], v[76:79], a[220:223]
  ds_read_b128 v[32:35], v6 offset:4096
  v_accvgpr_read_b32 v182, a110
  v_mfma_f32_16x16x32_bf16 a[224:227], v[148:151], v[48:51], a[224:227]
  v_accvgpr_read_b32 v183, a111
  ds_read_b64_tr_b16 v[108:109], v8 offset:12288
  v_mfma_f32_16x16x32_bf16 a[228:231], v[148:151], v[52:55], a[228:231]
  v_cvt_pk_bf16_f32 v172, v176, v177
  v_cvt_pk_bf16_f32 v173, v178, v179
  v_mfma_f32_16x16x32_bf16 a[232:235], v[148:151], v[56:59], a[232:235]
  buffer_load_dwordx4 v3, s[24:27], s47 offen lds
  v_mfma_f32_16x16x32_bf16 a[236:239], v[148:151], v[60:63], a[236:239]
  ds_read_b128 v[36:39], v6 offset:5120
  v_cvt_pk_bf16_f32 v174, v180, v181
  v_mfma_f32_16x16x32_bf16 a[240:243], v[148:151], v[64:67], a[240:243]
  v_cvt_pk_bf16_f32 v175, v182, v183
  ds_read_b64_tr_b16 v[110:111], v8 offset:14336
  v_mfma_f32_16x16x32_bf16 a[244:247], v[148:151], v[68:71], a[244:247]
  buffer_store_dwordx4 v[172:175], v1, s[36:39], s56 offen offset:2048 sc1
  v_mfma_f32_16x16x32_bf16 a[248:251], v[148:151], v[72:75], a[248:251]
  s_add_u32 m0, s53, 61440
  v_accvgpr_read_b32 v164, a112
  v_mfma_f32_16x16x32_bf16 a[252:255], v[148:151], v[76:79], a[252:255]
  v_accvgpr_read_b32 v165, a113
  ds_read_b64_tr_b16 v[112:113], v9 offset:0
  v_mfma_f32_16x16x32_bf16 v[192:195], v[152:155], v[48:51], v[192:195]
  v_accvgpr_read_b32 v166, a114
  v_accvgpr_read_b32 v167, a115
  v_mfma_f32_16x16x32_bf16 v[196:199], v[152:155], v[52:55], v[196:199]
  buffer_load_dwordx4 v3, s[28:31], s47 offen lds
  v_mfma_f32_16x16x32_bf16 v[200:203], v[152:155], v[56:59], v[200:203]
  v_accvgpr_read_b32 v168, a116
  ds_read_b128 v[40:43], v6 offset:6144
  v_mfma_f32_16x16x32_bf16 v[204:207], v[152:155], v[60:63], v[204:207]
  v_accvgpr_read_b32 v169, a117
  v_accvgpr_read_b32 v170, a118
  v_mfma_f32_16x16x32_bf16 v[208:211], v[152:155], v[64:67], v[208:211]
  ds_read_b64_tr_b16 v[114:115], v9 offset:2048
  s_add_u32 m0, s54, 12288
  v_mfma_f32_16x16x32_bf16 v[212:215], v[152:155], v[68:71], v[212:215]
  v_accvgpr_read_b32 v171, a119
  v_cvt_pk_bf16_f32 v160, v164, v165
  v_mfma_f32_16x16x32_bf16 v[216:219], v[152:155], v[72:75], v[216:219]
  ds_read_b128 v[44:47], v6 offset:7168
  v_cvt_pk_bf16_f32 v161, v166, v167
  v_mfma_f32_16x16x32_bf16 v[220:223], v[152:155], v[76:79], v[220:223]
  ds_read_b64_tr_b16 v[116:117], v10 offset:0
  ds_read_b64_tr_b16 v[118:119], v10 offset:2048
  v_mfma_f32_16x16x32_bf16 v[224:227], v[156:159], v[48:51], v[224:227]
  v_cvt_pk_bf16_f32 v162, v168, v169
  v_cvt_pk_bf16_f32 v163, v170, v171
  v_mfma_f32_16x16x32_bf16 v[228:231], v[156:159], v[52:55], v[228:231]
  buffer_store_dwordx4 v[160:163], v1, s[36:39], s57 offen offset:0 sc1
  v_mfma_f32_16x16x32_bf16 v[232:235], v[156:159], v[56:59], v[232:235]
  v_accvgpr_read_b32 v176, a120
  v_accvgpr_read_b32 v177, a121
  v_mfma_f32_16x16x32_bf16 v[236:239], v[156:159], v[60:63], v[236:239]
  v_accvgpr_read_b32 v178, a122
  v_accvgpr_read_b32 v179, a123
  v_mfma_f32_16x16x32_bf16 v[240:243], v[156:159], v[64:67], v[240:243]
  global_load_lds_dwordx4 v[4:5], off
  v_mfma_f32_16x16x32_bf16 v[244:247], v[156:159], v[68:71], v[244:247]
  s_add_u32 s47, s47, s49
  v_accvgpr_read_b32 v180, a124
  v_lshl_add_u64 v[4:5], s[50:51], 0, v[4:5]
  v_mfma_f32_16x16x32_bf16 v[248:251], v[156:159], v[72:75], v[248:251]
  v_accvgpr_read_b32 v181, a125
  v_accvgpr_read_b32 v182, a126
  v_mfma_f32_16x16x32_bf16 v[252:255], v[156:159], v[76:79], v[252:255]
  v_accvgpr_read_b32 v183, a127
  v_cvt_pk_bf16_f32 v172, v176, v177
  v_cvt_pk_bf16_f32 v173, v178, v179
  v_cvt_pk_bf16_f32 v174, v180, v181
  v_cvt_pk_bf16_f32 v175, v182, v183
  buffer_store_dwordx4 v[172:175], v1, s[36:39], s57 offen offset:2048 sc1
  s_waitcnt vmcnt(23) lgkmcnt(0)
  s_barrier
  v_mfma_f32_16x16x32_bf16 a[128:131], v[96:99], v[16:19], a[128:131]
  ds_read_b128 v[48:51], v6 offset:16384
  s_add_u32 m0, s52, 0
  v_mfma_f32_16x16x32_bf16 a[132:135], v[96:99], v[20:23], a[132:135]
  v_mfma_f32_16x16x32_bf16 a[136:139], v[96:99], v[24:27], a[136:139]
  ds_read_b64_tr_b16 v[136:137], v7 offset:24576
  v_mfma_f32_16x16x32_bf16 a[140:143], v[96:99], v[28:31], a[140:143]
  buffer_load_dwordx4 v188, s[12:15], s45 offen offset:0 sc1 lds
  v_mfma_f32_16x16x32_bf16 a[144:147], v[96:99], v[32:35], a[144:147]
  ds_read_b128 v[52:55], v6 offset:17408
  v_mfma_f32_16x16x32_bf16 a[148:151], v[96:99], v[36:39], a[148:151]
  v_mfma_f32_16x16x32_bf16 a[152:155], v[96:99], v[40:43], a[152:155]
  ds_read_b64_tr_b16 v[138:139], v7 offset:26624
  v_mfma_f32_16x16x32_bf16 a[156:159], v[96:99], v[44:47], a[156:159]
  buffer_load_dwordx4 v188, s[12:15], s45 offen offset:1024 sc1 lds
  v_mfma_f32_16x16x32_bf16 a[160:163], v[100:103], v[16:19], a[160:163]
  ds_read_b64_tr_b16 v[140:141], v8 offset:24576
  v_mfma_f32_16x16x32_bf16 a[164:167], v[100:103], v[20:23], a[164:167]
  buffer_load_dwordx4 v188, s[12:15], s45 offen offset:2048 sc1 lds
  v_mfma_f32_16x16x32_bf16 a[168:171], v[100:103], v[24:27], a[168:171]
  ds_read_b128 v[56:59], v6 offset:18432
  v_mfma_f32_16x16x32_bf16 a[172:175], v[100:103], v[28:31], a[172:175]
  v_mfma_f32_16x16x32_bf16 a[176:179], v[100:103], v[32:35], a[176:179]
  ds_read_b64_tr_b16 v[142:143], v8 offset:26624
  v_mfma_f32_16x16x32_bf16 a[180:183], v[100:103], v[36:39], a[180:183]
  buffer_load_dwordx4 v188, s[12:15], s45 offen offset:3072 sc1 lds
  v_mfma_f32_16x16x32_bf16 a[184:187], v[100:103], v[40:43], a[184:187]
  ds_read_b128 v[60:63], v6 offset:19456
  v_mfma_f32_16x16x32_bf16 a[188:191], v[100:103], v[44:47], a[188:191]
  v_mfma_f32_16x16x32_bf16 a[192:195], v[104:107], v[16:19], a[192:195]
  ds_read_b64_tr_b16 v[144:145], v7 offset:28672
  s_add_u32 s45, s45, 16384
  v_mfma_f32_16x16x32_bf16 a[196:199], v[104:107], v[20:23], a[196:199]
  v_mfma_f32_16x16x32_bf16 a[200:203], v[104:107], v[24:27], a[200:203]
  ds_read_b64_tr_b16 v[146:147], v7 offset:30720
  v_mfma_f32_16x16x32_bf16 a[204:207], v[104:107], v[28:31], a[204:207]
  s_add_u32 m0, s53, 8192
  v_mfma_f32_16x16x32_bf16 a[208:211], v[104:107], v[32:35], a[208:211]
  ds_read_b128 v[64:67], v6 offset:20480
  v_mfma_f32_16x16x32_bf16 a[212:215], v[104:107], v[36:39], a[212:215]
  v_mfma_f32_16x16x32_bf16 a[216:219], v[104:107], v[40:43], a[216:219]
  ds_read_b64_tr_b16 v[148:149], v8 offset:28672
  v_mfma_f32_16x16x32_bf16 a[220:223], v[104:107], v[44:47], a[220:223]
  buffer_load_dwordx4 v3, s[24:27], s47 offen lds
  v_mfma_f32_16x16x32_bf16 a[224:227], v[108:111], v[16:19], a[224:227]
  ds_read_b128 v[68:71], v6 offset:21504
  v_mfma_f32_16x16x32_bf16 a[228:231], v[108:111], v[20:23], a[228:231]
  v_mfma_f32_16x16x32_bf16 a[232:235], v[108:111], v[24:27], a[232:235]
  ds_read_b64_tr_b16 v[150:151], v8 offset:30720
  s_add_u32 m0, s53, 12288
  v_mfma_f32_16x16x32_bf16 a[236:239], v[108:111], v[28:31], a[236:239]
  v_mfma_f32_16x16x32_bf16 a[240:243], v[108:111], v[32:35], a[240:243]
  ds_read_b64_tr_b16 v[152:153], v9 offset:4096
  v_mfma_f32_16x16x32_bf16 a[244:247], v[108:111], v[36:39], a[244:247]
  buffer_load_dwordx4 v3, s[28:31], s47 offen lds
  v_mfma_f32_16x16x32_bf16 a[248:251], v[108:111], v[40:43], a[248:251]
  ds_read_b128 v[72:75], v6 offset:22528
  v_mfma_f32_16x16x32_bf16 a[252:255], v[108:111], v[44:47], a[252:255]
  v_mfma_f32_16x16x32_bf16 v[192:195], v[112:115], v[16:19], v[192:195]
  ds_read_b64_tr_b16 v[154:155], v9 offset:6144
  s_add_u32 m0, s54, 0
  v_mfma_f32_16x16x32_bf16 v[196:199], v[112:115], v[20:23], v[196:199]
  v_mfma_f32_16x16x32_bf16 v[200:203], v[112:115], v[24:27], v[200:203]
  ds_read_b128 v[76:79], v6 offset:23552
  v_mfma_f32_16x16x32_bf16 v[204:207], v[112:115], v[28:31], v[204:207]
  v_mfma_f32_16x16x32_bf16 v[208:211], v[112:115], v[32:35], v[208:211]
  ds_read_b64_tr_b16 v[156:157], v10 offset:4096
  v_mfma_f32_16x16x32_bf16 v[212:215], v[112:115], v[36:39], v[212:215]
  global_load_lds_dwordx4 v[4:5], off
  v_mfma_f32_16x16x32_bf16 v[216:219], v[112:115], v[40:43], v[216:219]
  ds_read_b64_tr_b16 v[158:159], v10 offset:6144
  v_mfma_f32_16x16x32_bf16 v[220:223], v[112:115], v[44:47], v[220:223]
  s_add_u32 s47, s47, s49
  v_mfma_f32_16x16x32_bf16 v[224:227], v[116:119], v[16:19], v[224:227]
  v_mfma_f32_16x16x32_bf16 v[228:231], v[116:119], v[20:23], v[228:231]
  v_mfma_f32_16x16x32_bf16 v[232:235], v[116:119], v[24:27], v[232:235]
  v_lshl_add_u64 v[4:5], s[50:51], 0, v[4:5]
  v_mfma_f32_16x16x32_bf16 v[236:239], v[116:119], v[28:31], v[236:239]
  v_mfma_f32_16x16x32_bf16 v[240:243], v[116:119], v[32:35], v[240:243]
  v_mfma_f32_16x16x32_bf16 v[244:247], v[116:119], v[36:39], v[244:247]
  v_mfma_f32_16x16x32_bf16 v[248:251], v[116:119], v[40:43], v[248:251]
  v_mfma_f32_16x16x32_bf16 v[252:255], v[116:119], v[44:47], v[252:255]
  s_waitcnt vmcnt(19) lgkmcnt(0)
  s_barrier
  v_mfma_f32_16x16x32_bf16 a[128:131], v[136:139], v[48:51], a[128:131]
  ds_read_b128 v[16:19], v6 offset:32768
  s_add_u32 m0, s52, 16384
  v_mfma_f32_16x16x32_bf16 a[132:135], v[136:139], v[52:55], a[132:135]
  v_mfma_f32_16x16x32_bf16 a[136:139], v[136:139], v[56:59], a[136:139]
  ds_read_b64_tr_b16 v[96:97], v7 offset:40960
  v_mfma_f32_16x16x32_bf16 a[140:143], v[136:139], v[60:63], a[140:143]
  buffer_load_dwordx4 v188, s[12:15], s45 offen offset:0 sc1 lds
  v_mfma_f32_16x16x32_bf16 a[144:147], v[136:139], v[64:67], a[144:147]
  ds_read_b128 v[20:23], v6 offset:33792
  v_mfma_f32_16x16x32_bf16 a[148:151], v[136:139], v[68:71], a[148:151]
  v_mfma_f32_16x16x32_bf16 a[152:155], v[136:139], v[72:75], a[152:155]
  ds_read_b64_tr_b16 v[98:99], v7 offset:43008
  v_mfma_f32_16x16x32_bf16 a[156:159], v[136:139], v[76:79], a[156:159]
  buffer_load_dwordx4 v188, s[12:15], s45 offen offset:1024 sc1 lds
  v_mfma_f32_16x16x32_bf16 a[160:163], v[140:143], v[48:51], a[160:163]
  ds_read_b64_tr_b16 v[100:101], v8 offset:40960
  v_mfma_f32_16x16x32_bf16 a[164:167], v[140:143], v[52:55], a[164:167]
  buffer_load_dwordx4 v188, s[12:15], s45 offen offset:2048 sc1 lds
  v_mfma_f32_16x16x32_bf16 a[168:171], v[140:143], v[56:59], a[168:171]
  ds_read_b128 v[24:27], v6 offset:34816
  v_mfma_f32_16x16x32_bf16 a[172:175], v[140:143], v[60:63], a[172:175]
  v_mfma_f32_16x16x32_bf16 a[176:179], v[140:143], v[64:67], a[176:179]
  ds_read_b64_tr_b16 v[102:103], v8 offset:43008
  v_mfma_f32_16x16x32_bf16 a[180:183], v[140:143], v[68:71], a[180:183]
  buffer_load_dwordx4 v188, s[12:15], s45 offen offset:3072 sc1 lds
  v_mfma_f32_16x16x32_bf16 a[184:187], v[140:143], v[72:75], a[184:187]
  ds_read_b128 v[28:31], v6 offset:35840
  v_mfma_f32_16x16x32_bf16 a[188:191], v[140:143], v[76:79], a[188:191]
  v_mfma_f32_16x16x32_bf16 a[192:195], v[144:147], v[48:51], a[192:195]
  ds_read_b64_tr_b16 v[104:105], v7 offset:45056
  s_add_u32 s45, s45, 16384
  v_mfma_f32_16x16x32_bf16 a[196:199], v[144:147], v[52:55], a[196:199]
  v_mfma_f32_16x16x32_bf16 a[200:203], v[144:147], v[56:59], a[200:203]
  ds_read_b64_tr_b16 v[106:107], v7 offset:47104
  v_mfma_f32_16x16x32_bf16 a[204:207], v[144:147], v[60:63], a[204:207]
  s_add_u32 m0, s53, 24576
  v_mfma_f32_16x16x32_bf16 a[208:211], v[144:147], v[64:67], a[208:211]
  ds_read_b128 v[32:35], v6 offset:36864
  v_mfma_f32_16x16x32_bf16 a[212:215], v[144:147], v[68:71], a[212:215]
  v_mfma_f32_16x16x32_bf16 a[216:219], v[144:147], v[72:75], a[216:219]
  ds_read_b64_tr_b16 v[108:109], v8 offset:45056
  v_mfma_f32_16x16x32_bf16 a[220:223], v[144:147], v[76:79], a[220:223]
  buffer_load_dwordx4 v3, s[24:27], s47 offen lds
  v_mfma_f32_16x16x32_bf16 a[224:227], v[148:151], v[48:51], a[224:227]
  ds_read_b128 v[36:39], v6 offset:37888
  v_mfma_f32_16x16x32_bf16 a[228:231], v[148:151], v[52:55], a[228:231]
  v_mfma_f32_16x16x32_bf16 a[232:235], v[148:151], v[56:59], a[232:235]
  ds_read_b64_tr_b16 v[110:111], v8 offset:47104
  s_add_u32 m0, s53, 28672
  v_mfma_f32_16x16x32_bf16 a[236:239], v[148:151], v[60:63], a[236:239]
  v_mfma_f32_16x16x32_bf16 a[240:243], v[148:151], v[64:67], a[240:243]
  ds_read_b64_tr_b16 v[112:113], v9 offset:8192
  v_mfma_f32_16x16x32_bf16 a[244:247], v[148:151], v[68:71], a[244:247]
  buffer_load_dwordx4 v3, s[28:31], s47 offen lds
  v_mfma_f32_16x16x32_bf16 a[248:251], v[148:151], v[72:75], a[248:251]
  ds_read_b128 v[40:43], v6 offset:38912
  v_mfma_f32_16x16x32_bf16 a[252:255], v[148:151], v[76:79], a[252:255]
  v_mfma_f32_16x16x32_bf16 v[192:195], v[152:155], v[48:51], v[192:195]
  ds_read_b64_tr_b16 v[114:115], v9 offset:10240
  s_add_u32 m0, s54, 4096
  v_mfma_f32_16x16x32_bf16 v[196:199], v[152:155], v[52:55], v[196:199]
  v_mfma_f32_16x16x32_bf16 v[200:203], v[152:155], v[56:59], v[200:203]
  ds_read_b128 v[44:47], v6 offset:39936
  v_mfma_f32_16x16x32_bf16 v[204:207], v[152:155], v[60:63], v[204:207]
  v_mfma_f32_16x16x32_bf16 v[208:211], v[152:155], v[64:67], v[208:211]
  ds_read_b64_tr_b16 v[116:117], v10 offset:8192
  v_mfma_f32_16x16x32_bf16 v[212:215], v[152:155], v[68:71], v[212:215]
  global_load_lds_dwordx4 v[4:5], off
  v_mfma_f32_16x16x32_bf16 v[216:219], v[152:155], v[72:75], v[216:219]
  ds_read_b64_tr_b16 v[118:119], v10 offset:10240
  v_mfma_f32_16x16x32_bf16 v[220:223], v[152:155], v[76:79], v[220:223]
  s_add_u32 s47, s47, s49
  v_mfma_f32_16x16x32_bf16 v[224:227], v[156:159], v[48:51], v[224:227]
  v_mfma_f32_16x16x32_bf16 v[228:231], v[156:159], v[52:55], v[228:231]
  v_mfma_f32_16x16x32_bf16 v[232:235], v[156:159], v[56:59], v[232:235]
  v_lshl_add_u64 v[4:5], s[50:51], 0, v[4:5]
  v_mfma_f32_16x16x32_bf16 v[236:239], v[156:159], v[60:63], v[236:239]
  v_mfma_f32_16x16x32_bf16 v[240:243], v[156:159], v[64:67], v[240:243]
  v_mfma_f32_16x16x32_bf16 v[244:247], v[156:159], v[68:71], v[244:247]
  v_mfma_f32_16x16x32_bf16 v[248:251], v[156:159], v[72:75], v[248:251]
  v_mfma_f32_16x16x32_bf16 v[252:255], v[156:159], v[76:79], v[252:255]
  s_waitcnt vmcnt(14) lgkmcnt(0)
  s_barrier
  s_cmp_eq_u32 s40, 0
  s_cbranch_scc0 sig_5
  s_lshl_b32 s66, s43, 5
  s_add_u32 s66, s66, s78
  s_add_u32 s66, s66, 256
  s_lshl_b32 s66, s66, 7
  s_add_u32 s66, s66, 4096
  v_mov_b32 v12, s76
  v_mov_b32 v13, s77
  v_mov_b32 v14, 0
  s_mov_b64 exec, 1
  buffer_store_dwordx2 v[12:13], v14, s[72:75], s66 offen sc1
  s_mov_b64 exec, -1
sig_5:
  v_mfma_f32_16x16x32_bf16 a[128:131], v[96:99], v[16:19], a[128:131]
  ds_read_b128 v[48:51], v6 offset:49152
  s_add_u32 m0, s52, 32768
  v_mfma_f32_16x16x32_bf16 a[132:135], v[96:99], v[20:23], a[132:135]
  v_mfma_f32_16x16x32_bf16 a[136:139], v[96:99], v[24:27], a[136:139]
  ds_read_b64_tr_b16 v[136:137], v7 offset:57344
  v_mfma_f32_16x16x32_bf16 a[140:143], v[96:99], v[28:31], a[140:143]
  buffer_load_dwordx4 v188, s[12:15], s45 offen offset:0 sc1 lds
  v_mfma_f32_16x16x32_bf16 a[144:147], v[96:99], v[32:35], a[144:147]
  ds_read_b128 v[52:55], v6 offset:50176
  v_mfma_f32_16x16x32_bf16 a[148:151], v[96:99], v[36:39], a[148:151]
  v_mfma_f32_16x16x32_bf16 a[152:155], v[96:99], v[40:43], a[152:155]
  ds_read_b64_tr_b16 v[138:139], v7 offset:59392
  v_mfma_f32_16x16x32_bf16 a[156:159], v[96:99], v[44:47], a[156:159]
  buffer_load_dwordx4 v188, s[12:15], s45 offen offset:1024 sc1 lds
  v_mfma_f32_16x16x32_bf16 a[160:163], v[100:103], v[16:19], a[160:163]
  ds_read_b64_tr_b16 v[140:141], v8 offset:57344
  v_mfma_f32_16x16x32_bf16 a[164:167], v[100:103], v[20:23], a[164:167]
  buffer_load_dwordx4 v188, s[12:15], s45 offen offset:2048 sc1 lds
  v_mfma_f32_16x16x32_bf16 a[168:171], v[100:103], v[24:27], a[168:171]
  ds_read_b128 v[56:59], v6 offset:51200
  v_mfma_f32_16x16x32_bf16 a[172:175], v[100:103], v[28:31], a[172:175]
  v_mfma_f32_16x16x32_bf16 a[176:179], v[100:103], v[32:35], a[176:179]
  ds_read_b64_tr_b16 v[142:143], v8 offset:59392
  v_mfma_f32_16x16x32_bf16 a[180:183], v[100:103], v[36:39], a[180:183]
  buffer_load_dwordx4 v188, s[12:15], s45 offen offset:3072 sc1 lds
  v_mfma_f32_16x16x32_bf16 a[184:187], v[100:103], v[40:43], a[184:187]
  ds_read_b128 v[60:63], v6 offset:52224
  v_mfma_f32_16x16x32_bf16 a[188:191], v[100:103], v[44:47], a[188:191]
  v_mfma_f32_16x16x32_bf16 a[192:195], v[104:107], v[16:19], a[192:195]
  ds_read_b64_tr_b16 v[144:145], v7 offset:61440
  s_add_u32 s45, s45, 16384
  v_mfma_f32_16x16x32_bf16 a[196:199], v[104:107], v[20:23], a[196:199]
  v_mfma_f32_16x16x32_bf16 a[200:203], v[104:107], v[24:27], a[200:203]
  ds_read_b64_tr_b16 v[146:147], v7 offset:63488
  v_mfma_f32_16x16x32_bf16 a[204:207], v[104:107], v[28:31], a[204:207]
  s_add_u32 m0, s53, 40960
  v_mfma_f32_16x16x32_bf16 a[208:211], v[104:107], v[32:35], a[208:211]
  ds_read_b128 v[64:67], v6 offset:53248
  v_mfma_f32_16x16x32_bf16 a[212:215], v[104:107], v[36:39], a[212:215]
  v_mfma_f32_16x16x32_bf16 a[216:219], v[104:107], v[40:43], a[216:219]
  ds_read_b64_tr_b16 v[148:149], v8 offset:61440
  v_mfma_f32_16x16x32_bf16 a[220:223], v[104:107], v[44:47], a[220:223]
  buffer_load_dwordx4 v3, s[24:27], s47 offen lds
  v_mfma_f32_16x16x32_bf16 a[224:227], v[108:111], v[16:19], a[224:227]
  ds_read_b128 v[68:71], v6 offset:54272
  v_mfma_f32_16x16x32_bf16 a[228:231], v[108:111], v[20:23], a[228:231]
  v_mfma_f32_16x16x32_bf16 a[232:235], v[108:111], v[24:27], a[232:235]
  ds_read_b64_tr_b16 v[150:151], v8 offset:63488
  s_add_u32 m0, s53, 45056
  v_mfma_f32_16x16x32_bf16 a[236:239], v[108:111], v[28:31], a[236:239]
  v_mfma_f32_16x16x32_bf16 a[240:243], v[108:111], v[32:35], a[240:243]
  ds_read_b64_tr_b16 v[152:153], v9 offset:12288
  v_mfma_f32_16x16x32_bf16 a[244:247], v[108:111], v[36:39], a[244:247]
  buffer_load_dwordx4 v3, s[28:31], s47 offen lds
  v_mfma_f32_16x16x32_bf16 a[248:251], v[108:111], v[40:43], a[248:251]
  ds_read_b128 v[72:75], v6 offset:55296
  v_mfma_f32_16x16x32_bf16 a[252:255], v[108:111], v[44:47], a[252:255]
  v_mfma_f32_16x16x32_bf16 v[192:195], v[112:115], v[16:19], v[192:195]
  ds_read_b64_tr_b16 v[154:155], v9 offset:14336
  s_add_u32 m0, s54, 8192
  v_mfma_f32_16x16x32_bf16 v[196:199], v[112:115], v[20:23], v[196:199]
  v_mfma_f32_16x16x32_bf16 v[200:203], v[112:115], v[24:27], v[200:203]
  ds_read_b128 v[76:79], v6 offset:56320
  v_mfma_f32_16x16x32_bf16 v[204:207], v[112:115], v[28:31], v[204:207]
  v_mfma_f32_16x16x32_bf16 v[208:211], v[112:115], v[32:35], v[208:211]
  ds_read_b64_tr_b16 v[156:157], v10 offset:12288
  v_mfma_f32_16x16x32_bf16 v[212:215], v[112:115], v[36:39], v[212:215]
  global_load_lds_dwordx4 v[4:5], off
  v_mfma_f32_16x16x32_bf16 v[216:219], v[112:115], v[40:43], v[216:219]
  ds_read_b64_tr_b16 v[158:159], v10 offset:14336
  v_mfma_f32_16x16x32_bf16 v[220:223], v[112:115], v[44:47], v[220:223]
  s_add_u32 s47, s47, s49
  v_mfma_f32_16x16x32_bf16 v[224:227], v[116:119], v[16:19], v[224:227]
  v_mfma_f32_16x16x32_bf16 v[228:231], v[116:119], v[20:23], v[228:231]
  v_mfma_f32_16x16x32_bf16 v[232:235], v[116:119], v[24:27], v[232:235]
  v_lshl_add_u64 v[4:5], s[50:51], 0, v[4:5]
  v_mfma_f32_16x16x32_bf16 v[236:239], v[116:119], v[28:31], v[236:239]
  v_mfma_f32_16x16x32_bf16 v[240:243], v[116:119], v[32:35], v[240:243]
  v_mfma_f32_16x16x32_bf16 v[244:247], v[116:119], v[36:39], v[244:247]
  v_mfma_f32_16x16x32_bf16 v[248:251], v[116:119], v[40:43], v[248:251]
  v_mfma_f32_16x16x32_bf16 v[252:255], v[116:119], v[44:47], v[252:255]
  s_waitcnt vmcnt(14) lgkmcnt(0)
  s_barrier
  v_mfma_f32_16x16x32_bf16 a[128:131], v[136:139], v[48:51], a[128:131]
  ds_read_b128 v[16:19], v6 offset:0
  s_add_u32 m0, s52, 49152
  v_mfma_f32_16x16x32_bf16 a[132:135], v[136:139], v[52:55], a[132:135]
  s_sub_u32 s66, s43, 1
  v_mfma_f32_16x16x32_bf16 a[136:139], v[136:139], v[56:59], a[136:139]
  ds_read_b64_tr_b16 v[96:97], v7 offset:8192
  v_mfma_f32_16x16x32_bf16 a[140:143], v[136:139], v[60:63], a[140:143]
  buffer_load_dwordx4 v188, s[12:15], s45 offen offset:0 sc1 lds
  v_mfma_f32_16x16x32_bf16 a[144:147], v[136:139], v[64:67], a[144:147]
  ds_read_b128 v[20:23], v6 offset:1024
  v_mfma_f32_16x16x32_bf16 a[148:151], v[136:139], v[68:71], a[148:151]
  s_max_i32 s66, s66, 0
  v_mfma_f32_16x16x32_bf16 a[152:155], v[136:139], v[72:75], a[152:155]
  ds_read_b64_tr_b16 v[98:99], v7 offset:10240
  v_mfma_f32_16x16x32_bf16 a[156:159], v[136:139], v[76:79], a[156:159]
  buffer_load_dwordx4 v188, s[12:15], s45 offen offset:1024 sc1 lds
  v_mfma_f32_16x16x32_bf16 a[160:163], v[140:143], v[48:51], a[160:163]
  ds_read_b64_tr_b16 v[100:101], v8 offset:8192
  v_mfma_f32_16x16x32_bf16 a[164:167], v[140:143], v[52:55], a[164:167]
  buffer_load_dwordx4 v188, s[12:15], s45 offen offset:2048 sc1 lds
  v_mfma_f32_16x16x32_bf16 a[168:171], v[140:143], v[56:59], a[168:171]
  s_lshl_b32 s66, s66, 5
  ds_read_b128 v[24:27], v6 offset:2048
  v_mfma_f32_16x16x32_bf16 a[172:175], v[140:143], v[60:63], a[172:175]
  v_mfma_f32_16x16x32_bf16 a[176:179], v[140:143], v[64:67], a[176:179]
  ds_read_b64_tr_b16 v[102:103], v8 offset:10240
  v_mfma_f32_16x16x32_bf16 a[180:183], v[140:143], v[68:71], a[180:183]
  buffer_load_dwordx4 v188, s[12:15], s45 offen offset:3072 sc1 lds
  v_mfma_f32_16x16x32_bf16 a[184:187], v[140:143], v[72:75], a[184:187]
  s_add_u32 s66, s66, s78
  ds_read_b128 v[28:31], v6 offset:3072
  v_mfma_f32_16x16x32_bf16 a[188:191], v[140:143], v[76:79], a[188:191]
  v_mfma_f32_16x16x32_bf16 a[192:195], v[144:147], v[48:51], a[192:195]
  ds_read_b64_tr_b16 v[104:105], v7 offset:12288
  s_add_u32 s45, s45, 16384
  v_mfma_f32_16x16x32_bf16 a[196:199], v[144:147], v[52:55], a[196:199]
  v_mfma_f32_16x16x32_bf16 a[200:203], v[144:147], v[56:59], a[200:203]
  ds_read_b64_tr_b16 v[106:107], v7 offset:14336
  s_add_u32 s66, s66, 256
  v_mfma_f32_16x16x32_bf16 a[204:207], v[144:147], v[60:63], a[204:207]
  s_add_u32 m0, s53, 57344
  v_mfma_f32_16x16x32_bf16 a[208:211], v[144:147], v[64:67], a[208:211]
  ds_read_b128 v[32:35], v6 offset:4096
  v_mfma_f32_16x16x32_bf16 a[212:215], v[144:147], v[68:71], a[212:215]
  v_mfma_f32_16x16x32_bf16 a[216:219], v[144:147], v[72:75], a[216:219]
  ds_read_b64_tr_b16 v[108:109], v8 offset:12288
  s_lshl_b32 s66, s66, 7
  v_mfma_f32_16x16x32_bf16 a[220:223], v[144:147], v[76:79], a[220:223]
  buffer_load_dwordx4 v3, s[24:27], s47 offen lds
  v_mfma_f32_16x16x32_bf16 a[224:227], v[148:151], v[48:51], a[224:227]
  ds_read_b128 v[36:39], v6 offset:5120
  v_mfma_f32_16x16x32_bf16 a[228:231], v[148:151], v[52:55], a[228:231]
  v_mfma_f32_16x16x32_bf16 a[232:235], v[148:151], v[56:59], a[232:235]
  ds_read_b64_tr_b16 v[110:111], v8 offset:14336
  s_add_u32 m0, s53, 61440
  v_mfma_f32_16x16x32_bf16 a[236:239], v[148:151], v[60:63], a[236:239]
  s_add_u32 s66, s66, 4096
  v_mfma_f32_16x16x32_bf16 a[240:243], v[148:151], v[64:67], a[240:243]
  ds_read_b64_tr_b16 v[112:113], v9 offset:0
  v_mfma_f32_16x16x32_bf16 a[244:247], v[148:151], v[68:71], a[244:247]
  buffer_load_dwordx4 v3, s[28:31], s47 offen lds
  v_mfma_f32_16x16x32_bf16 a[248:251], v[148:151], v[72:75], a[248:251]
  ds_read_b128 v[40:43], v6 offset:6144
  v_mov_b32 v186, 0
  v_mfma_f32_16x16x32_bf16 a[252:255], v[148:151], v[76:79], a[252:255]
  v_mfma_f32_16x16x32_bf16 v[192:195], v[152:155], v[48:51], v[192:195]
  ds_read_b64_tr_b16 v[114:115], v9 offset:2048
  s_add_u32 m0, s54, 12288
  v_mfma_f32_16x16x32_bf16 v[196:199], v[152:155], v[52:55], v[196:199]
  v_mfma_f32_16x16x32_bf16 v[200:203], v[152:155], v[56:59], v[200:203]
  ds_read_b128 v[44:47], v6 offset:7168
  v_mfma_f32_16x16x32_bf16 v[204:207], v[152:155], v[60:63], v[204:207]
  v_lshlrev_b32 v186, 7, v186
  v_mfma_f32_16x16x32_bf16 v[208:211], v[152:155], v[64:67], v[208:211]
  ds_read_b64_tr_b16 v[116:117], v10 offset:0
  v_mfma_f32_16x16x32_bf16 v[212:215], v[152:155], v[68:71], v[212:215]
  global_load_lds_dwordx4 v[4:5], off
  v_mfma_f32_16x16x32_bf16 v[216:219], v[152:155], v[72:75], v[216:219]
  ds_read_b64_tr_b16 v[118:119], v10 offset:2048
  v_mfma_f32_16x16x32_bf16 v[220:223], v[152:155], v[76:79], v[220:223]
  s_add_u32 s47, s47, s49
  v_add_u32 v186, s66, v186
  v_mfma_f32_16x16x32_bf16 v[224:227], v[156:159], v[48:51], v[224:227]
  v_mfma_f32_16x16x32_bf16 v[228:231], v[156:159], v[52:55], v[228:231]
  v_mfma_f32_16x16x32_bf16 v[232:235], v[156:159], v[56:59], v[232:235]
  v_lshl_add_u64 v[4:5], s[50:51], 0, v[4:5]
  v_mfma_f32_16x16x32_bf16 v[236:239], v[156:159], v[60:63], v[236:239]
  buffer_load_dwordx2 v[184:185], v186, s[72:75], 0 offen sc1
  v_mfma_f32_16x16x32_bf16 v[240:243], v[156:159], v[64:67], v[240:243]
  v_mfma_f32_16x16x32_bf16 v[244:247], v[156:159], v[68:71], v[244:247]
  v_mfma_f32_16x16x32_bf16 v[248:251], v[156:159], v[72:75], v[248:251]
  v_mfma_f32_16x16x32_bf16 v[252:255], v[156:159], v[76:79], v[252:255]
  s_waitcnt vmcnt(15) lgkmcnt(0)
  s_barrier
  v_mfma_f32_16x16x32_bf16 a[128:131], v[96:99], v[16:19], a[128:131]
  ds_read_b128 v[48:51], v6 offset:16384
  v_mfma_f32_16x16x32_bf16 a[132:135], v[96:99], v[20:23], a[132:135]
  s_mov_b32 s45, s44
  v_mfma_f32_16x16x32_bf16 a[136:139], v[96:99], v[24:27], a[136:139]
  ds_read_b64_tr_b16 v[136:137], v7 offset:24576
  s_mov_b32 s46, s43
  v_mfma_f32_16x16x32_bf16 a[140:143], v[96:99], v[28:31], a[140:143]
  v_mfma_f32_16x16x32_bf16 a[144:147], v[96:99], v[32:35], a[144:147]
  ds_read_b128 v[52:55], v6 offset:17408
  s_lshl_b32 s47, s45, 3
  v_mfma_f32_16x16x32_bf16 a[148:151], v[96:99], v[36:39], a[148:151]
  s_add_u32 s47, s47, s46
  v_mfma_f32_16x16x32_bf16 a[152:155], v[96:99], v[40:43], a[152:155]
  ds_read_b64_tr_b16 v[138:139], v7 offset:26624
  v_mfma_f32_16x16x32_bf16 a[156:159], v[96:99], v[44:47], a[156:159]
  s_lshl_b32 s56, s40, 11
  v_mfma_f32_16x16x32_bf16 a[160:163], v[100:103], v[16:19], a[160:163]
  ds_read_b64_tr_b16 v[140:141], v8 offset:24576
  s_add_u32 s52, s56, 81920
  v_mfma_f32_16x16x32_bf16 a[164:167], v[100:103], v[20:23], a[164:167]
  v_mfma_f32_16x16x32_bf16 a[168:171], v[100:103], v[24:27], a[168:171]
  ds_read_b128 v[56:59], v6 offset:18432
  v_lshrrev_b32 v14, 3, v0
  v_mfma_f32_16x16x32_bf16 a[172:175], v[100:103], v[28:31], a[172:175]
  v_and_b32 v15, 6, v14
  v_mfma_f32_16x16x32_bf16 a[176:179], v[100:103], v[32:35], a[176:179]
  ds_read_b64_tr_b16 v[142:143], v8 offset:26624
  v_mfma_f32_16x16x32_bf16 a[180:183], v[100:103], v[36:39], a[180:183]
  v_and_b32 v187, 7, v0
  v_mfma_f32_16x16x32_bf16 a[184:187], v[100:103], v[40:43], a[184:187]
  ds_read_b128 v[60:63], v6 offset:19456
  v_mfma_f32_16x16x32_bf16 a[188:191], v[100:103], v[44:47], a[188:191]
  v_xor_b32 v15, v15, v187
  v_mfma_f32_16x16x32_bf16 a[192:195], v[104:107], v[16:19], a[192:195]
  ds_read_b64_tr_b16 v[144:145], v7 offset:28672
  s_lshl_b32 s56, s40, 4
  v_mfma_f32_16x16x32_bf16 a[196:199], v[104:107], v[20:23], a[196:199]
  v_mfma_f32_16x16x32_bf16 a[200:203], v[104:107], v[24:27], a[200:203]
  ds_read_b64_tr_b16 v[146:147], v7 offset:30720
  v_add_u32 v14, s56, v14
  v_mfma_f32_16x16x32_bf16 a[204:207], v[104:107], v[28:31], a[204:207]
  v_lshlrev_b32 v14, 11, v14
  v_mfma_f32_16x16x32_bf16 a[208:211], v[104:107], v[32:35], a[208:211]
  ds_read_b128 v[64:67], v6 offset:20480
  v_mfma_f32_16x16x32_bf16 a[212:215], v[104:107], v[36:39], a[212:215]
  v_lshlrev_b32 v15, 4, v15
  v_mfma_f32_16x16x32_bf16 a[216:219], v[104:107], v[40:43], a[216:219]
  ds_read_b64_tr_b16 v[148:149], v8 offset:28672
  v_add_u32 v3, v14, v15
  v_mfma_f32_16x16x32_bf16 a[220:223], v[104:107], v[44:47], a[220:223]
  v_mfma_f32_16x16x32_bf16 a[224:227], v[108:111], v[16:19], a[224:227]
  ds_read_b128 v[68:71], v6 offset:21504
  s_mov_b32 s49, 0
  v_mfma_f32_16x16x32_bf16 a[228:231], v[108:111], v[20:23], a[228:231]
  v_mfma_f32_16x16x32_bf16 a[232:235], v[108:111], v[24:27], a[232:235]
  ds_read_b64_tr_b16 v[150:151], v8 offset:30720
  s_mov_b32 s50, 16384
  v_mfma_f32_16x16x32_bf16 a[236:239], v[108:111], v[28:31], a[236:239]
  s_lshl_b32 s58, s46, 8
  v_mfma_f32_16x16x32_bf16 a[240:243], v[108:111], v[32:35], a[240:243]
  ds_read_b64_tr_b16 v[152:153], v9 offset:4096
  v_mfma_f32_16x16x32_bf16 a[244:247], v[108:111], v[36:39], a[244:247]
  s_add_u32 s16, s4, s58
  s_addc_u32 s17, s5, 0
  s_sub_u32 s18, 2097152, s58
  s_mov_b32 s19, 0x20000
  v_mfma_f32_16x16x32_bf16 a[248:251], v[108:111], v[40:43], a[248:251]
  ds_read_b128 v[72:75], v6 offset:22528
  v_mfma_f32_16x16x32_bf16 a[252:255], v[108:111], v[44:47], a[252:255]
  s_add_u32 s20, s16, 128
  s_addc_u32 s21, s17, 0
  s_sub_u32 s22, s18, 128
  s_mov_b32 s23, 0x20000
  v_mfma_f32_16x16x32_bf16 v[192:195], v[112:115], v[16:19], v[192:195]
  ds_read_b64_tr_b16 v[154:155], v9 offset:6144
  s_add_u32 m0, s52, 65536
  v_mfma_f32_16x16x32_bf16 v[196:199], v[112:115], v[20:23], v[196:199]
  buffer_load_dwordx4 v3, s[16:19], s49 offen lds
  v_mfma_f32_16x16x32_bf16 v[200:203], v[112:115], v[24:27], v[200:203]
  ds_read_b128 v[76:79], v6 offset:23552
  v_mfma_f32_16x16x32_bf16 v[204:207], v[112:115], v[28:31], v[204:207]
  s_add_u32 m0, s52, 66560
  v_mfma_f32_16x16x32_bf16 v[208:211], v[112:115], v[32:35], v[208:211]
  ds_read_b64_tr_b16 v[156:157], v10 offset:4096
  v_mfma_f32_16x16x32_bf16 v[212:215], v[112:115], v[36:39], v[212:215]
  buffer_load_dwordx4 v3, s[16:19], s50 offen lds
  v_mfma_f32_16x16x32_bf16 v[216:219], v[112:115], v[40:43], v[216:219]
  ds_read_b64_tr_b16 v[158:159], v10 offset:6144
  s_add_u32 m0, s52, 73728
  v_mfma_f32_16x16x32_bf16 v[220:223], v[112:115], v[44:47], v[220:223]
  v_mfma_f32_16x16x32_bf16 v[224:227], v[116:119], v[16:19], v[224:227]
  buffer_load_dwordx4 v3, s[20:23], s49 offen lds
  v_mfma_f32_16x16x32_bf16 v[228:231], v[116:119], v[20:23], v[228:231]
  s_add_u32 m0, s52, 74752
  v_mfma_f32_16x16x32_bf16 v[232:235], v[116:119], v[24:27], v[232:235]
  v_mfma_f32_16x16x32_bf16 v[236:239], v[116:119], v[28:31], v[236:239]
  buffer_load_dwordx4 v3, s[20:23], s50 offen lds
  v_mfma_f32_16x16x32_bf16 v[240:243], v[116:119], v[32:35], v[240:243]
  s_add_u32 s49, s49, 131072
  v_mfma_f32_16x16x32_bf16 v[244:247], v[116:119], v[36:39], v[244:247]
  v_mfma_f32_16x16x32_bf16 v[248:251], v[116:119], v[40:43], v[248:251]
  s_add_u32 s50, s50, 131072
  v_mfma_f32_16x16x32_bf16 v[252:255], v[116:119], v[44:47], v[252:255]
  s_waitcnt vmcnt(12) lgkmcnt(0)
  s_barrier
  v_mfma_f32_16x16x32_bf16 a[128:131], v[136:139], v[48:51], a[128:131]
  ds_read_b128 v[16:19], v6 offset:32768
  v_mfma_f32_16x16x32_bf16 a[132:135], v[136:139], v[52:55], a[132:135]
  s_add_u32 m0, s52, 0
  v_mfma_f32_16x16x32_bf16 a[136:139], v[136:139], v[56:59], a[136:139]
  ds_read_b64_tr_b16 v[96:97], v7 offset:40960
  v_mfma_f32_16x16x32_bf16 a[140:143], v[136:139], v[60:63], a[140:143]
  v_mfma_f32_16x16x32_bf16 a[144:147], v[136:139], v[64:67], a[144:147]
  ds_read_b128 v[20:23], v6 offset:33792
  v_mfma_f32_16x16x32_bf16 a[148:151], v[136:139], v[68:71], a[148:151]
  buffer_load_dwordx4 v3, s[16:19], s49 offen lds
  v_mfma_f32_16x16x32_bf16 a[152:155], v[136:139], v[72:75], a[152:155]
  ds_read_b64_tr_b16 v[98:99], v7 offset:43008
  v_mfma_f32_16x16x32_bf16 a[156:159], v[136:139], v[76:79], a[156:159]
  v_mfma_f32_16x16x32_bf16 a[160:163], v[140:143], v[48:51], a[160:163]
  ds_read_b64_tr_b16 v[100:101], v8 offset:40960
  v_mfma_f32_16x16x32_bf16 a[164:167], v[140:143], v[52:55], a[164:167]
  v_mfma_f32_16x16x32_bf16 a[168:171], v[140:143], v[56:59], a[168:171]
  ds_read_b128 v[24:27], v6 offset:34816
  s_add_u32 m0, s52, 1024
  v_mfma_f32_16x16x32_bf16 a[172:175], v[140:143], v[60:63], a[172:175]
  v_mfma_f32_16x16x32_bf16 a[176:179], v[140:143], v[64:67], a[176:179]
  ds_read_b64_tr_b16 v[102:103], v8 offset:43008
  v_mfma_f32_16x16x32_bf16 a[180:183], v[140:143], v[68:71], a[180:183]
  v_mfma_f32_16x16x32_bf16 a[184:187], v[140:143], v[72:75], a[184:187]
  ds_read_b128 v[28:31], v6 offset:35840
  v_mfma_f32_16x16x32_bf16 a[188:191], v[140:143], v[76:79], a[188:191]
  buffer_load_dwordx4 v3, s[16:19], s50 offen lds
  v_mfma_f32_16x16x32_bf16 a[192:195], v[144:147], v[48:51], a[192:195]
  ds_read_b64_tr_b16 v[104:105], v7 offset:45056
  v_mfma_f32_16x16x32_bf16 a[196:199], v[144:147], v[52:55], a[196:199]
  v_mfma_f32_16x16x32_bf16 a[200:203], v[144:147], v[56:59], a[200:203]
  ds_read_b64_tr_b16 v[106:107], v7 offset:47104
  v_mfma_f32_16x16x32_bf16 a[204:207], v[144:147], v[60:63], a[204:207]
  s_add_u32 m0, s52, 8192
  v_mfma_f32_16x16x32_bf16 a[208:211], v[144:147], v[64:67], a[208:211]
  ds_read_b128 v[32:35], v6 offset:36864
  v_mfma_f32_16x16x32_bf16 a[212:215], v[144:147], v[68:71], a[212:215]
  v_mfma_f32_16x16x32_bf16 a[216:219], v[144:147], v[72:75], a[216:219]
  ds_read_b64_tr_b16 v[108:109], v8 offset:45056
  v_mfma_f32_16x16x32_bf16 a[220:223], v[144:147], v[76:79], a[220:223]
  v_mfma_f32_16x16x32_bf16 a[224:227], v[148:151], v[48:51], a[224:227]
  ds_read_b128 v[36:39], v6 offset:37888
  v_mfma_f32_16x16x32_bf16 a[228:231], v[148:151], v[52:55], a[228:231]
  buffer_load_dwordx4 v3, s[20:23], s49 offen lds
  v_mfma_f32_16x16x32_bf16 a[232:235], v[148:151], v[56:59], a[232:235]
  ds_read_b64_tr_b16 v[110:111], v8 offset:47104
  v_mfma_f32_16x16x32_bf16 a[236:239], v[148:151], v[60:63], a[236:239]
  v_mfma_f32_16x16x32_bf16 a[240:243], v[148:151], v[64:67], a[240:243]
  ds_read_b64_tr_b16 v[112:113], v9 offset:8192
  v_mfma_f32_16x16x32_bf16 a[244:247], v[148:151], v[68:71], a[244:247]
  s_add_u32 m0, s52, 9216
  v_mfma_f32_16x16x32_bf16 a[248:251], v[148:151], v[72:75], a[248:251]
  ds_read_b128 v[40:43], v6 offset:38912
  v_mfma_f32_16x16x32_bf16 a[252:255], v[148:151], v[76:79], a[252:255]
  v_mfma_f32_16x16x32_bf16 v[192:195], v[152:155], v[48:51], v[192:195]
  ds_read_b64_tr_b16 v[114:115], v9 offset:10240
  v_mfma_f32_16x16x32_bf16 v[196:199], v[152:155], v[52:55], v[196:199]
  buffer_load_dwordx4 v3, s[20:23], s50 offen lds
  v_mfma_f32_16x16x32_bf16 v[200:203], v[152:155], v[56:59], v[200:203]
  ds_read_b128 v[44:47], v6 offset:39936
  v_mfma_f32_16x16x32_bf16 v[204:207], v[152:155], v[60:63], v[204:207]
  v_mfma_f32_16x16x32_bf16 v[208:211], v[152:155], v[64:67], v[208:211]
  ds_read_b64_tr_b16 v[116:117], v10 offset:8192
  v_mfma_f32_16x16x32_bf16 v[212:215], v[152:155], v[68:71], v[212:215]
  v_mfma_f32_16x16x32_bf16 v[216:219], v[152:155], v[72:75], v[216:219]
  ds_read_b64_tr_b16 v[118:119], v10 offset:10240
  s_add_u32 s49, s49, 131072
  v_mfma_f32_16x16x32_bf16 v[220:223], v[152:155], v[76:79], v[220:223]
  v_mfma_f32_16x16x32_bf16 v[224:227], v[156:159], v[48:51], v[224:227]
  v_mfma_f32_16x16x32_bf16 v[228:231], v[156:159], v[52:55], v[228:231]
  v_mfma_f32_16x16x32_bf16 v[232:235], v[156:159], v[56:59], v[232:235]
  v_mfma_f32_16x16x32_bf16 v[236:239], v[156:159], v[60:63], v[236:239]
  s_add_u32 s50, s50, 131072
  v_mfma_f32_16x16x32_bf16 v[240:243], v[156:159], v[64:67], v[240:243]
  v_mfma_f32_16x16x32_bf16 v[244:247], v[156:159], v[68:71], v[244:247]
  v_mfma_f32_16x16x32_bf16 v[248:251], v[156:159], v[72:75], v[248:251]
  v_mfma_f32_16x16x32_bf16 v[252:255], v[156:159], v[76:79], v[252:255]
  s_waitcnt vmcnt(8) lgkmcnt(0)
  s_barrier
  s_cmp_eq_u32 s43, 0
  s_cbranch_scc1 norb_6
  s_mov_b32 s67, 0
chk_7:
  v_cmp_eq_u32 vcc, s76, v184
  v_cmp_eq_u32 s[68:69], s77, v185
  s_nop 1
  s_and_b64 vcc, vcc, s[68:69]
  s_cmp_eq_u64 vcc, exec
  s_cbranch_scc1 chk_7_ok
  s_add_u32 s67, s67, 1
  s_cmp_ge_u32 s67, 0x40000
  s_cbranch_scc1 chk_7_ok
  s_sleep 1
  buffer_load_dwordx2 v[184:185], v186, s[72:75], 0 offen sc1
  s_waitcnt vmcnt(0)
  s_branch chk_7
chk_7_ok:
norb_6:
  v_mfma_f32_16x16x32_bf16 a[128:131], v[96:99], v[16:19], a[128:131]
  ds_read_b128 v[48:51], v6 offset:49152
  v_mfma_f32_16x16x32_bf16 a[132:135], v[96:99], v[20:23], a[132:135]
  s_add_u32 m0, s52, 16384
  s_lshl_b32 s56, s44, 1
  v_mfma_f32_16x16x32_bf16 a[136:139], v[96:99], v[24:27], a[136:139]
  ds_read_b64_tr_b16 v[136:137], v7 offset:57344
  s_add_u32 s56, s56, s42
  v_mfma_f32_16x16x32_bf16 a[140:143], v[96:99], v[28:31], a[140:143]
  s_lshl_b32 s56, s56, 17
  v_mfma_f32_16x16x32_bf16 a[144:147], v[96:99], v[32:35], a[144:147]
  ds_read_b128 v[52:55], v6 offset:50176
  s_lshl_b32 s57, s43, 4
  v_mfma_f32_16x16x32_bf16 a[148:151], v[96:99], v[36:39], a[148:151]
  buffer_load_dwordx4 v3, s[16:19], s49 offen lds
  v_mfma_f32_16x16x32_bf16 a[152:155], v[96:99], v[40:43], a[152:155]
  s_lshl_b32 s64, s41, 3
  ds_read_b64_tr_b16 v[138:139], v7 offset:59392
  v_mfma_f32_16x16x32_bf16 a[156:159], v[96:99], v[44:47], a[156:159]
  s_add_u32 s57, s57, s64
  s_add_i32 s53, s57, -16
  v_mfma_f32_16x16x32_bf16 a[160:163], v[100:103], v[16:19], a[160:163]
  ds_read_b64_tr_b16 v[140:141], v8 offset:57344
  s_max_i32 s53, s53, 0
  v_mfma_f32_16x16x32_bf16 a[164:167], v[100:103], v[20:23], a[164:167]
  s_lshl_b32 s53, s53, 10
  v_mfma_f32_16x16x32_bf16 a[168:171], v[100:103], v[24:27], a[168:171]
  ds_read_b128 v[56:59], v6 offset:51200
  s_add_u32 m0, s52, 17408
  v_mfma_f32_16x16x32_bf16 a[172:175], v[100:103], v[28:31], a[172:175]
  s_add_u32 s53, s53, s56
  s_add_i32 s54, s57, -12
  v_mfma_f32_16x16x32_bf16 a[176:179], v[100:103], v[32:35], a[176:179]
  ds_read_b64_tr_b16 v[142:143], v8 offset:59392
  s_max_i32 s54, s54, 0
  v_mfma_f32_16x16x32_bf16 a[180:183], v[100:103], v[36:39], a[180:183]
  s_lshl_b32 s54, s54, 10
  v_mfma_f32_16x16x32_bf16 a[184:187], v[100:103], v[40:43], a[184:187]
  ds_read_b128 v[60:63], v6 offset:52224
  s_add_u32 s54, s54, s56
  v_mfma_f32_16x16x32_bf16 a[188:191], v[100:103], v[44:47], a[188:191]
  buffer_load_dwordx4 v3, s[16:19], s50 offen lds
  v_mfma_f32_16x16x32_bf16 a[192:195], v[104:107], v[16:19], a[192:195]
  s_add_i32 s55, s57, -8
  ds_read_b64_tr_b16 v[144:145], v7 offset:61440
  v_mfma_f32_16x16x32_bf16 a[196:199], v[104:107], v[20:23], a[196:199]
  s_max_i32 s55, s55, 0
  s_lshl_b32 s55, s55, 10
  v_mfma_f32_16x16x32_bf16 a[200:203], v[104:107], v[24:27], a[200:203]
  ds_read_b64_tr_b16 v[146:147], v7 offset:63488
  s_add_u32 s55, s55, s56
  v_mfma_f32_16x16x32_bf16 a[204:207], v[104:107], v[28:31], a[204:207]
  s_add_u32 m0, s52, 24576
  s_add_i32 s68, s57, -4
  v_mfma_f32_16x16x32_bf16 a[208:211], v[104:107], v[32:35], a[208:211]
  ds_read_b128 v[64:67], v6 offset:53248
  s_max_i32 s68, s68, 0
  v_mfma_f32_16x16x32_bf16 a[212:215], v[104:107], v[36:39], a[212:215]
  s_lshl_b32 s68, s68, 10
  v_mfma_f32_16x16x32_bf16 a[216:219], v[104:107], v[40:43], a[216:219]
  ds_read_b64_tr_b16 v[148:149], v8 offset:61440
  s_add_u32 s68, s68, s56
  v_mfma_f32_16x16x32_bf16 a[220:223], v[104:107], v[44:47], a[220:223]
  s_add_i32 s69, s57, 0
  v_mfma_f32_16x16x32_bf16 a[224:227], v[108:111], v[16:19], a[224:227]
  ds_read_b128 v[68:71], v6 offset:54272
  v_mfma_f32_16x16x32_bf16 a[228:231], v[108:111], v[20:23], a[228:231]
  buffer_load_dwordx4 v3, s[20:23], s49 offen lds
  v_mfma_f32_16x16x32_bf16 a[232:235], v[108:111], v[24:27], a[232:235]
  s_max_i32 s69, s69, 0
  ds_read_b64_tr_b16 v[150:151], v8 offset:63488
  v_mfma_f32_16x16x32_bf16 a[236:239], v[108:111], v[28:31], a[236:239]
  s_lshl_b32 s69, s69, 10
  s_add_u32 s69, s69, s56
  v_mfma_f32_16x16x32_bf16 a[240:243], v[108:111], v[32:35], a[240:243]
  ds_read_b64_tr_b16 v[152:153], v9 offset:12288
  s_add_i32 s70, s57, 4
  v_mfma_f32_16x16x32_bf16 a[244:247], v[108:111], v[36:39], a[244:247]
  s_add_u32 m0, s52, 25600
  s_max_i32 s70, s70, 0
  v_mfma_f32_16x16x32_bf16 a[248:251], v[108:111], v[40:43], a[248:251]
  ds_read_b128 v[72:75], v6 offset:55296
  s_lshl_b32 s70, s70, 10
  v_mfma_f32_16x16x32_bf16 a[252:255], v[108:111], v[44:47], a[252:255]
  s_add_u32 s70, s70, s56
  v_mfma_f32_16x16x32_bf16 v[192:195], v[112:115], v[16:19], v[192:195]
  ds_read_b64_tr_b16 v[154:155], v9 offset:14336
  s_add_u32 s64, s53, 4194304
  v_mfma_f32_16x16x32_bf16 v[196:199], v[112:115], v[20:23], v[196:199]
  buffer_load_dwordx4 v3, s[20:23], s50 offen lds
  v_mfma_f32_16x16x32_bf16 v[200:203], v[112:115], v[24:27], v[200:203]
  buffer_load_dwordx4 a[0:3], v1, s[32:35], s64 offen offset:0 sc1
  v_mfma_f32_16x16x32_bf16 v[204:207], v[112:115], v[28:31], v[204:207]
  ds_read_b128 v[76:79], v6 offset:56320
  v_mfma_f32_16x16x32_bf16 v[208:211], v[112:115], v[32:35], v[208:211]
  buffer_load_dwordx4 a[4:7], v1, s[32:35], s64 offen offset:1024 sc1
  v_mfma_f32_16x16x32_bf16 v[212:215], v[112:115], v[36:39], v[212:215]
  buffer_load_dwordx4 a[8:11], v1, s[32:35], s64 offen offset:2048 sc1
  v_mfma_f32_16x16x32_bf16 v[216:219], v[112:115], v[40:43], v[216:219]
  ds_read_b64_tr_b16 v[156:157], v10 offset:12288
  ds_read_b64_tr_b16 v[158:159], v10 offset:14336
  v_mfma_f32_16x16x32_bf16 v[220:223], v[112:115], v[44:47], v[220:223]
  buffer_load_dwordx4 a[12:15], v1, s[32:35], s64 offen offset:3072 sc1
  v_mfma_f32_16x16x32_bf16 v[224:227], v[116:119], v[16:19], v[224:227]
  s_add_u32 s64, s54, 4194304
  s_add_u32 s49, s49, 131072
  v_mfma_f32_16x16x32_bf16 v[228:231], v[116:119], v[20:23], v[228:231]
  buffer_load_dwordx4 a[16:19], v1, s[32:35], s64 offen offset:0 sc1
  v_mfma_f32_16x16x32_bf16 v[232:235], v[116:119], v[24:27], v[232:235]
  buffer_load_dwordx4 a[20:23], v1, s[32:35], s64 offen offset:1024 sc1
  v_mfma_f32_16x16x32_bf16 v[236:239], v[116:119], v[28:31], v[236:239]
  buffer_load_dwordx4 a[24:27], v1, s[32:35], s64 offen offset:2048 sc1
  v_mfma_f32_16x16x32_bf16 v[240:243], v[116:119], v[32:35], v[240:243]
  buffer_load_dwordx4 a[28:31], v1, s[32:35], s64 offen offset:3072 sc1
  v_mfma_f32_16x16x32_bf16 v[244:247], v[116:119], v[36:39], v[244:247]
  s_add_u32 s64, s55, 4194304
  s_add_u32 s50, s50, 131072
  v_mfma_f32_16x16x32_bf16 v[248:251], v[116:119], v[40:43], v[248:251]
  buffer_load_dwordx4 a[32:35], v1, s[32:35], s64 offen offset:0 sc1
  v_mfma_f32_16x16x32_bf16 v[252:255], v[116:119], v[44:47], v[252:255]
  buffer_load_dwordx4 a[36:39], v1, s[32:35], s64 offen offset:1024 sc1
  buffer_load_dwordx4 a[40:43], v1, s[32:35], s64 offen offset:2048 sc1
  buffer_load_dwordx4 a[44:47], v1, s[32:35], s64 offen offset:3072 sc1
  s_waitcnt lgkmcnt(0)
  s_barrier
  v_mfma_f32_16x16x32_bf16 a[128:131], v[136:139], v[48:51], a[128:131]
  v_mfma_f32_16x16x32_bf16 a[132:135], v[136:139], v[52:55], a[132:135]
  s_add_u32 s64, s68, 4194304
  s_lshl_b32 s51, s40, 12
  v_mfma_f32_16x16x32_bf16 a[136:139], v[136:139], v[56:59], a[136:139]
  v_add_u32 v2, s51, v1
  s_mov_b32 s48, 0
  v_mfma_f32_16x16x32_bf16 a[140:143], v[136:139], v[60:63], a[140:143]
  s_lshl_b32 s56, s41, 12
  v_mfma_f32_16x16x32_bf16 a[144:147], v[136:139], v[64:67], a[144:147]
  buffer_load_dwordx4 a[48:51], v1, s[32:35], s64 offen offset:0 sc1
  v_mfma_f32_16x16x32_bf16 a[148:151], v[136:139], v[68:71], a[148:151]
  v_add_u32 v4, s56, v1
  v_add_u32 v5, 0x10000, v4
  v_mfma_f32_16x16x32_bf16 a[152:155], v[136:139], v[72:75], a[152:155]
  v_lshrrev_b32 v14, 2, v0
  v_and_b32 v15, 6, v14
  v_mfma_f32_16x16x32_bf16 a[156:159], v[136:139], v[76:79], a[156:159]
  buffer_load_dwordx4 a[52:55], v1, s[32:35], s64 offen offset:1024 sc1
  v_mfma_f32_16x16x32_bf16 a[160:163], v[140:143], v[48:51], a[160:163]
  v_lshlrev_b32 v14, 7, v14
  v_bfe_u32 v187, v0, 1, 1
  v_mfma_f32_16x16x32_bf16 a[164:167], v[140:143], v[52:55], a[164:167]
  v_lshlrev_b32 v187, 4, v187
  v_mfma_f32_16x16x32_bf16 a[168:171], v[140:143], v[56:59], a[168:171]
  buffer_load_dwordx4 a[56:59], v1, s[32:35], s64 offen offset:2048 sc1
  v_mfma_f32_16x16x32_bf16 a[172:175], v[140:143], v[60:63], a[172:175]
  v_add_u32 v14, v14, v187
  v_and_b32 v187, 1, v0
  v_mfma_f32_16x16x32_bf16 a[176:179], v[140:143], v[64:67], a[176:179]
  v_lshlrev_b32 v187, 3, v187
  v_add_u32 v14, v14, v187
  v_mfma_f32_16x16x32_bf16 a[180:183], v[140:143], v[68:71], a[180:183]
  buffer_load_dwordx4 a[60:63], v1, s[32:35], s64 offen offset:3072 sc1
  v_mfma_f32_16x16x32_bf16 a[184:187], v[140:143], v[72:75], a[184:187]
  s_lshl_b32 s56, s42, 13
  s_add_u32 s56, s56, 81920
  v_mfma_f32_16x16x32_bf16 a[188:191], v[140:143], v[76:79], a[188:191]
  v_xor_b32 v187, 0, v15
  v_lshlrev_b32 v187, 4, v187
  v_mfma_f32_16x16x32_bf16 a[192:195], v[144:147], v[48:51], a[192:195]
  s_add_u32 s64, s69, 4194304
  v_add_u32 v187, v187, v14
  v_mfma_f32_16x16x32_bf16 a[196:199], v[144:147], v[52:55], a[196:199]
  v_add_u32 v6, s56, v187
  v_mfma_f32_16x16x32_bf16 a[200:203], v[144:147], v[56:59], a[200:203]
  v_add_u32 v10, 0x10000, v6
  v_mfma_f32_16x16x32_bf16 a[204:207], v[144:147], v[60:63], a[204:207]
  buffer_load_dwordx4 a[64:67], v1, s[32:35], s64 offen offset:0 sc1
  v_mfma_f32_16x16x32_bf16 a[208:211], v[144:147], v[64:67], a[208:211]
  v_xor_b32 v187, 2, v15
  v_lshlrev_b32 v187, 4, v187
  v_mfma_f32_16x16x32_bf16 a[212:215], v[144:147], v[68:71], a[212:215]
  v_add_u32 v187, v187, v14
  v_add_u32 v7, s56, v187
  v_mfma_f32_16x16x32_bf16 a[216:219], v[144:147], v[72:75], a[216:219]
  buffer_load_dwordx4 a[68:71], v1, s[32:35], s64 offen offset:1024 sc1
  v_mfma_f32_16x16x32_bf16 a[220:223], v[144:147], v[76:79], a[220:223]
  v_add_u32 v11, 0x10000, v7
  v_xor_b32 v187, 4, v15
  v_mfma_f32_16x16x32_bf16 a[224:227], v[148:151], v[48:51], a[224:227]
  v_lshlrev_b32 v187, 4, v187
  v_add_u32 v187, v187, v14
  v_mfma_f32_16x16x32_bf16 a[228:231], v[148:151], v[52:55], a[228:231]
  v_add_u32 v8, s56, v187
  v_mfma_f32_16x16x32_bf16 a[232:235], v[148:151], v[56:59], a[232:235]
  buffer_load_dwordx4 a[72:75], v1, s[32:35], s64 offen offset:2048 sc1
  v_mfma_f32_16x16x32_bf16 a[236:239], v[148:151], v[60:63], a[236:239]
  v_add_u32 v12, 0x10000, v8
  v_xor_b32 v187, 6, v15
  v_mfma_f32_16x16x32_bf16 a[240:243], v[148:151], v[64:67], a[240:243]
  v_lshlrev_b32 v187, 4, v187
  v_mfma_f32_16x16x32_bf16 a[244:247], v[148:151], v[68:71], a[244:247]
  buffer_load_dwordx4 a[76:79], v1, s[32:35], s64 offen offset:3072 sc1
  v_mfma_f32_16x16x32_bf16 a[248:251], v[148:151], v[72:75], a[248:251]
  v_add_u32 v187, v187, v14
  v_add_u32 v9, s56, v187
  v_mfma_f32_16x16x32_bf16 a[252:255], v[148:151], v[76:79], a[252:255]
  v_add_u32 v13, 0x10000, v9
  s_add_u32 m0, s52, 32768
  v_mfma_f32_16x16x32_bf16 v[192:195], v[152:155], v[48:51], v[192:195]
  s_add_u32 s64, s70, 4194304
  v_mfma_f32_16x16x32_bf16 v[196:199], v[152:155], v[52:55], v[196:199]
  buffer_load_dwordx4 v3, s[16:19], s49 offen lds
  v_mfma_f32_16x16x32_bf16 v[200:203], v[152:155], v[56:59], v[200:203]
  s_add_u32 m0, s52, 33792
  v_mfma_f32_16x16x32_bf16 v[204:207], v[152:155], v[60:63], v[204:207]
  buffer_load_dwordx4 v3, s[16:19], s50 offen lds
  v_mfma_f32_16x16x32_bf16 v[208:211], v[152:155], v[64:67], v[208:211]
  s_add_u32 m0, s52, 40960
  v_mfma_f32_16x16x32_bf16 v[212:215], v[152:155], v[68:71], v[212:215]
  buffer_load_dwordx4 a[80:83], v1, s[32:35], s64 offen offset:0 sc1
  v_mfma_f32_16x16x32_bf16 v[216:219], v[152:155], v[72:75], v[216:219]
  buffer_load_dwordx4 v3, s[20:23], s49 offen lds
  v_mfma_f32_16x16x32_bf16 v[220:223], v[152:155], v[76:79], v[220:223]
  s_add_u32 m0, s52, 41984
  v_mfma_f32_16x16x32_bf16 v[224:227], v[156:159], v[48:51], v[224:227]
  buffer_load_dwordx4 v3, s[20:23], s50 offen lds
  v_mfma_f32_16x16x32_bf16 v[228:231], v[156:159], v[52:55], v[228:231]
  buffer_load_dwordx4 a[84:87], v1, s[32:35], s64 offen offset:1024 sc1
  v_mfma_f32_16x16x32_bf16 v[232:235], v[156:159], v[56:59], v[232:235]
  s_add_u32 s49, s49, 131072
  s_add_u32 s50, s50, 131072
  v_mfma_f32_16x16x32_bf16 v[236:239], v[156:159], v[60:63], v[236:239]
  s_add_u32 m0, s52, 49152
  v_mfma_f32_16x16x32_bf16 v[240:243], v[156:159], v[64:67], v[240:243]
  buffer_load_dwordx4 v3, s[16:19], s49 offen lds
  v_mfma_f32_16x16x32_bf16 v[244:247], v[156:159], v[68:71], v[244:247]
  s_add_u32 m0, s52, 50176
  v_mfma_f32_16x16x32_bf16 v[248:251], v[156:159], v[72:75], v[248:251]
  buffer_load_dwordx4 v3, s[16:19], s50 offen lds
  v_mfma_f32_16x16x32_bf16 v[252:255], v[156:159], v[76:79], v[252:255]
  buffer_load_dwordx4 a[88:91], v1, s[32:35], s64 offen offset:2048 sc1
  s_add_u32 m0, s52, 57344
  s_nop 0
  buffer_load_dwordx4 v3, s[20:23], s49 offen lds
  buffer_load_dwordx4 a[92:95], v1, s[32:35], s64 offen offset:3072 sc1
  s_add_u32 m0, s52, 58368
  s_nop 0
  buffer_load_dwordx4 v3, s[20:23], s50 offen lds
  s_add_u32 s49, s49, 131072
  s_add_u32 s50, s50, 131072
  s_nop 7
  v_accvgpr_read_b32 v164, a128
  v_accvgpr_read_b32 v168, a192
  v_accvgpr_read_b32 v165, a129
  v_accvgpr_read_b32 v169, a193
  v_accvgpr_read_b32 v166, a130
  v_accvgpr_read_b32 v170, a194
  v_accvgpr_read_b32 v167, a131
  v_accvgpr_read_b32 v171, a195
  v_mul_f32 v164, v164, v168
  v_mul_f32 v165, v165, v169
  v_mul_f32 v166, v166, v170
  v_mul_f32 v167, v167, v171
  v_cvt_pk_bf16_f32 v16, v164, v165
  v_cvt_pk_bf16_f32 v17, v166, v167
  v_accvgpr_read_b32 v164, a160
  v_accvgpr_read_b32 v168, a224
  v_accvgpr_read_b32 v165, a161
  v_accvgpr_read_b32 v169, a225
  v_accvgpr_read_b32 v166, a162
  v_accvgpr_read_b32 v170, a226
  v_accvgpr_read_b32 v167, a163
  v_accvgpr_read_b32 v171, a227
  v_mul_f32 v164, v164, v168
  v_mul_f32 v165, v165, v169
  v_mul_f32 v166, v166, v170
  v_mul_f32 v167, v167, v171
  v_cvt_pk_bf16_f32 v18, v164, v165
  v_cvt_pk_bf16_f32 v19, v166, v167
  v_accvgpr_read_b32 v176, a132
  v_accvgpr_read_b32 v180, a196
  v_accvgpr_read_b32 v177, a133
  v_accvgpr_read_b32 v181, a197
  v_accvgpr_read_b32 v178, a134
  v_accvgpr_read_b32 v182, a198
  v_accvgpr_read_b32 v179, a135
  v_accvgpr_read_b32 v183, a199
  v_mul_f32 v176, v176, v180
  v_mul_f32 v177, v177, v181
  v_mul_f32 v178, v178, v182
  v_mul_f32 v179, v179, v183
  v_cvt_pk_bf16_f32 v20, v176, v177
  v_cvt_pk_bf16_f32 v21, v178, v179
  v_accvgpr_read_b32 v176, a164
  v_accvgpr_read_b32 v180, a228
  v_accvgpr_read_b32 v177, a165
  v_accvgpr_read_b32 v181, a229
  v_accvgpr_read_b32 v178, a166
  v_accvgpr_read_b32 v182, a230
  v_accvgpr_read_b32 v179, a167
  v_accvgpr_read_b32 v183, a231
  v_mul_f32 v176, v176, v180
  v_mul_f32 v177, v177, v181
  v_mul_f32 v178, v178, v182
  v_mul_f32 v179, v179, v183
  v_cvt_pk_bf16_f32 v22, v176, v177
  v_cvt_pk_bf16_f32 v23, v178, v179
  v_accvgpr_read_b32 v164, a136
  v_accvgpr_read_b32 v168, a200
  v_accvgpr_read_b32 v165, a137
  v_accvgpr_read_b32 v169, a201
  v_accvgpr_read_b32 v166, a138
  v_accvgpr_read_b32 v170, a202
  v_accvgpr_read_b32 v167, a139
  v_accvgpr_read_b32 v171, a203
  v_mul_f32 v164, v164, v168
  v_mul_f32 v165, v165, v169
  v_mul_f32 v166, v166, v170
  v_mul_f32 v167, v167, v171
  v_cvt_pk_bf16_f32 v24, v164, v165
  v_cvt_pk_bf16_f32 v25, v166, v167
  v_accvgpr_read_b32 v164, a168
  v_accvgpr_read_b32 v168, a232
  v_accvgpr_read_b32 v165, a169
  v_accvgpr_read_b32 v169, a233
  v_accvgpr_read_b32 v166, a170
  v_accvgpr_read_b32 v170, a234
  v_accvgpr_read_b32 v167, a171
  v_accvgpr_read_b32 v171, a235
  v_mul_f32 v164, v164, v168
  v_mul_f32 v165, v165, v169
  v_mul_f32 v166, v166, v170
  v_mul_f32 v167, v167, v171
  v_cvt_pk_bf16_f32 v26, v164, v165
  v_cvt_pk_bf16_f32 v27, v166, v167
  v_accvgpr_read_b32 v176, a140
  v_accvgpr_read_b32 v180, a204
  v_accvgpr_read_b32 v177, a141
  v_accvgpr_read_b32 v181, a205
  v_accvgpr_read_b32 v178, a142
  v_accvgpr_read_b32 v182, a206
  v_accvgpr_read_b32 v179, a143
  v_accvgpr_read_b32 v183, a207
  v_mul_f32 v176, v176, v180
  v_mul_f32 v177, v177, v181
  v_mul_f32 v178, v178, v182
  v_mul_f32 v179, v179, v183
  v_cvt_pk_bf16_f32 v28, v176, v177
  v_cvt_pk_bf16_f32 v29, v178, v179
  v_accvgpr_read_b32 v176, a172
  v_accvgpr_read_b32 v180, a236
  v_accvgpr_read_b32 v177, a173
  v_accvgpr_read_b32 v181, a237
  v_accvgpr_read_b32 v178, a174
  v_accvgpr_read_b32 v182, a238
  v_accvgpr_read_b32 v179, a175
  v_accvgpr_read_b32 v183, a239
  v_mul_f32 v176, v176, v180
  v_mul_f32 v177, v177, v181
  v_mul_f32 v178, v178, v182
  v_mul_f32 v179, v179, v183
  v_cvt_pk_bf16_f32 v30, v176, v177
  v_cvt_pk_bf16_f32 v31, v178, v179
  v_accvgpr_read_b32 v164, a144
  v_accvgpr_read_b32 v168, a208
  v_accvgpr_read_b32 v165, a145
  v_accvgpr_read_b32 v169, a209
  v_accvgpr_read_b32 v166, a146
  v_accvgpr_read_b32 v170, a210
  v_accvgpr_read_b32 v167, a147
  v_accvgpr_read_b32 v171, a211
  v_mul_f32 v164, v164, v168
  v_mul_f32 v165, v165, v169
  v_mul_f32 v166, v166, v170
  v_mul_f32 v167, v167, v171
  v_cvt_pk_bf16_f32 v32, v164, v165
  v_cvt_pk_bf16_f32 v33, v166, v167
  v_accvgpr_read_b32 v164, a176
  v_accvgpr_read_b32 v168, a240
  v_accvgpr_read_b32 v165, a177
  v_accvgpr_read_b32 v169, a241
  v_accvgpr_read_b32 v166, a178
  v_accvgpr_read_b32 v170, a242
  v_accvgpr_read_b32 v167, a179
  v_accvgpr_read_b32 v171, a243
  v_mul_f32 v164, v164, v168
  v_mul_f32 v165, v165, v169
  v_mul_f32 v166, v166, v170
  v_mul_f32 v167, v167, v171
  v_cvt_pk_bf16_f32 v34, v164, v165
  v_cvt_pk_bf16_f32 v35, v166, v167
  v_accvgpr_read_b32 v176, a148
  v_accvgpr_read_b32 v180, a212
  v_accvgpr_read_b32 v177, a149
  v_accvgpr_read_b32 v181, a213
  v_accvgpr_read_b32 v178, a150
  v_accvgpr_read_b32 v182, a214
  v_accvgpr_read_b32 v179, a151
  v_accvgpr_read_b32 v183, a215
  v_mul_f32 v176, v176, v180
  v_mul_f32 v177, v177, v181
  v_mul_f32 v178, v178, v182
  v_mul_f32 v179, v179, v183
  v_cvt_pk_bf16_f32 v36, v176, v177
  v_cvt_pk_bf16_f32 v37, v178, v179
  v_accvgpr_read_b32 v176, a180
  v_accvgpr_read_b32 v180, a244
  v_accvgpr_read_b32 v177, a181
  v_accvgpr_read_b32 v181, a245
  v_accvgpr_read_b32 v178, a182
  v_accvgpr_read_b32 v182, a246
  v_accvgpr_read_b32 v179, a183
  v_accvgpr_read_b32 v183, a247
  v_mul_f32 v176, v176, v180
  v_mul_f32 v177, v177, v181
  v_mul_f32 v178, v178, v182
  v_mul_f32 v179, v179, v183
  v_cvt_pk_bf16_f32 v38, v176, v177
  v_cvt_pk_bf16_f32 v39, v178, v179
  v_accvgpr_read_b32 v164, a152
  v_accvgpr_read_b32 v168, a216
  v_accvgpr_read_b32 v165, a153
  v_accvgpr_read_b32 v169, a217
  v_accvgpr_read_b32 v166, a154
  v_accvgpr_read_b32 v170, a218
  v_accvgpr_read_b32 v167, a155
  v_accvgpr_read_b32 v171, a219
  v_mul_f32 v164, v164, v168
  v_mul_f32 v165, v165, v169
  v_mul_f32 v166, v166, v170
  v_mul_f32 v167, v167, v171
  v_cvt_pk_bf16_f32 v40, v164, v165
  v_cvt_pk_bf16_f32 v41, v166, v167
  v_accvgpr_read_b32 v164, a184
  v_accvgpr_read_b32 v168, a248
  v_accvgpr_read_b32 v165, a185
  v_accvgpr_read_b32 v169, a249
  v_accvgpr_read_b32 v166, a186
  v_accvgpr_read_b32 v170, a250
  v_accvgpr_read_b32 v167, a187
  v_accvgpr_read_b32 v171, a251
  v_mul_f32 v164, v164, v168
  v_mul_f32 v165, v165, v169
  v_mul_f32 v166, v166, v170
  v_mul_f32 v167, v167, v171
  v_cvt_pk_bf16_f32 v42, v164, v165
  v_cvt_pk_bf16_f32 v43, v166, v167
  v_accvgpr_read_b32 v176, a156
  v_accvgpr_read_b32 v180, a220
  v_accvgpr_read_b32 v177, a157
  v_accvgpr_read_b32 v181, a221
  v_accvgpr_read_b32 v178, a158
  v_accvgpr_read_b32 v182, a222
  v_accvgpr_read_b32 v179, a159
  v_accvgpr_read_b32 v183, a223
  v_mul_f32 v176, v176, v180
  v_mul_f32 v177, v177, v181
  v_mul_f32 v178, v178, v182
  v_mul_f32 v179, v179, v183
  v_cvt_pk_bf16_f32 v44, v176, v177
  v_cvt_pk_bf16_f32 v45, v178, v179
  v_accvgpr_read_b32 v176, a188
  v_accvgpr_read_b32 v180, a252
  v_accvgpr_read_b32 v177, a189
  v_accvgpr_read_b32 v181, a253
  v_accvgpr_read_b32 v178, a190
  v_accvgpr_read_b32 v182, a254
  v_accvgpr_read_b32 v179, a191
  v_accvgpr_read_b32 v183, a255
  v_mul_f32 v176, v176, v180
  v_mul_f32 v177, v177, v181
  v_mul_f32 v178, v178, v182
  v_mul_f32 v179, v179, v183
  v_cvt_pk_bf16_f32 v46, v176, v177
  v_cvt_pk_bf16_f32 v47, v178, v179
  buffer_load_dwordx4 a[96:99], v1, s[36:39], s53 offen offset:0 sc1
  buffer_load_dwordx4 a[100:103], v1, s[36:39], s53 offen offset:1024 sc1
  buffer_load_dwordx4 a[104:107], v1, s[36:39], s53 offen offset:2048 sc1
  buffer_load_dwordx4 a[108:111], v1, s[36:39], s53 offen offset:3072 sc1
  buffer_load_dwordx4 a[112:115], v1, s[36:39], s54 offen offset:0 sc1
  buffer_load_dwordx4 a[116:119], v1, s[36:39], s54 offen offset:1024 sc1
  buffer_load_dwordx4 a[120:123], v1, s[36:39], s54 offen offset:2048 sc1
  buffer_load_dwordx4 a[124:127], v1, s[36:39], s54 offen offset:3072 sc1
  buffer_load_dwordx4 a[128:131], v1, s[36:39], s55 offen offset:0 sc1
  buffer_load_dwordx4 a[132:135], v1, s[36:39], s55 offen offset:1024 sc1
  buffer_load_dwordx4 a[136:139], v1, s[36:39], s55 offen offset:2048 sc1
  buffer_load_dwordx4 a[140:143], v1, s[36:39], s55 offen offset:3072 sc1
  buffer_load_dwordx4 a[144:147], v1, s[36:39], s68 offen offset:0 sc1
  buffer_load_dwordx4 a[148:151], v1, s[36:39], s68 offen offset:1024 sc1
  buffer_load_dwordx4 a[152:155], v1, s[36:39], s68 offen offset:2048 sc1
  buffer_load_dwordx4 a[156:159], v1, s[36:39], s68 offen offset:3072 sc1
  buffer_load_dwordx4 a[160:163], v1, s[36:39], s69 offen offset:0 sc1
  buffer_load_dwordx4 a[164:167], v1, s[36:39], s69 offen offset:1024 sc1
  buffer_load_dwordx4 a[168:171], v1, s[36:39], s69 offen offset:2048 sc1
  buffer_load_dwordx4 a[172:175], v1, s[36:39], s69 offen offset:3072 sc1
  buffer_load_dwordx4 a[176:179], v1, s[36:39], s70 offen offset:0 sc1
  buffer_load_dwordx4 a[180:183], v1, s[36:39], s70 offen offset:1024 sc1
  buffer_load_dwordx4 a[184:187], v1, s[36:39], s70 offen offset:2048 sc1
  buffer_load_dwordx4 a[188:191], v1, s[36:39], s70 offen offset:3072 sc1
  s_lshl_b32 s60, s43, 4
  s_lshl_b32 s61, s41, 3
  s_add_u32 s60, s60, s61
  s_add_u32 s32, s6, 16777216
  s_addc_u32 s33, s7, 0
  s_mov_b32 s34, 14680064
  s_mov_b32 s35, 0x20000
  s_lshl_b32 s62, s44, 1
  s_add_u32 s62, s62, s42
  s_add_u32 s62, s62, 80
  s_lshr_b32 s56, s60, 3
  s_mul_i32 s56, s56, 112
  s_add_u32 s56, s56, s62
  s_lshl_b32 s56, s56, 13
  s_add_u32 s57, s56, 4096
  buffer_store_dwordx4 v[16:19], v1, s[32:35], s56 offen offset:0 sc1
  buffer_store_dwordx4 v[20:23], v1, s[32:35], s56 offen offset:1024 sc1
  buffer_store_dwordx4 v[24:27], v1, s[32:35], s56 offen offset:2048 sc1
  buffer_store_dwordx4 v[28:31], v1, s[32:35], s56 offen offset:3072 sc1
  buffer_store_dwordx4 v[32:35], v1, s[32:35], s57 offen offset:0 sc1
  buffer_store_dwordx4 v[36:39], v1, s[32:35], s57 offen offset:1024 sc1
  buffer_store_dwordx4 v[40:43], v1, s[32:35], s57 offen offset:2048 sc1
  buffer_store_dwordx4 v[44:47], v1, s[32:35], s57 offen offset:3072 sc1
  v_mul_f32 v164, 0x3e8293ee, v192
  v_mul_f32 v165, 0x3e8293ee, v193
  v_mul_f32 v166, 0x3e8293ee, v194
  v_mul_f32 v167, 0x3e8293ee, v195
  v_mul_f32 v168, 0x3e8293ee, v224
  v_mul_f32 v169, 0x3e8293ee, v225
  v_mul_f32 v170, 0x3e8293ee, v226
  v_mul_f32 v171, 0x3e8293ee, v227
  v_cvt_pk_bf16_f32 v160, v164, v165
  v_cvt_pk_bf16_f32 v161, v166, v167
  v_cvt_pk_bf16_f32 v162, v168, v169
  v_cvt_pk_bf16_f32 v163, v170, v171
  v_accvgpr_write_b32 a192, v160
  v_accvgpr_write_b32 a193, v161
  v_accvgpr_write_b32 a194, v162
  v_accvgpr_write_b32 a195, v163
  v_mul_f32 v176, 0x3e8293ee, v196
  v_mul_f32 v177, 0x3e8293ee, v197
  v_mul_f32 v178, 0x3e8293ee, v198
  v_mul_f32 v179, 0x3e8293ee, v199
  v_mul_f32 v180, 0x3e8293ee, v228
  v_mul_f32 v181, 0x3e8293ee, v229
  v_mul_f32 v182, 0x3e8293ee, v230
  v_mul_f32 v183, 0x3e8293ee, v231
  v_cvt_pk_bf16_f32 v172, v176, v177
  v_cvt_pk_bf16_f32 v173, v178, v179
  v_cvt_pk_bf16_f32 v174, v180, v181
  v_cvt_pk_bf16_f32 v175, v182, v183
  v_accvgpr_write_b32 a196, v172
  v_accvgpr_write_b32 a197, v173
  v_accvgpr_write_b32 a198, v174
  v_accvgpr_write_b32 a199, v175
  v_mul_f32 v164, 0x3e8293ee, v200
  v_mul_f32 v165, 0x3e8293ee, v201
  v_mul_f32 v166, 0x3e8293ee, v202
  v_mul_f32 v167, 0x3e8293ee, v203
  v_mul_f32 v168, 0x3e8293ee, v232
  v_mul_f32 v169, 0x3e8293ee, v233
  v_mul_f32 v170, 0x3e8293ee, v234
  v_mul_f32 v171, 0x3e8293ee, v235
  v_cvt_pk_bf16_f32 v160, v164, v165
  v_cvt_pk_bf16_f32 v161, v166, v167
  v_cvt_pk_bf16_f32 v162, v168, v169
  v_cvt_pk_bf16_f32 v163, v170, v171
  v_accvgpr_write_b32 a200, v160
  v_accvgpr_write_b32 a201, v161
  v_accvgpr_write_b32 a202, v162
  v_accvgpr_write_b32 a203, v163
  v_mul_f32 v176, 0x3e8293ee, v204
  v_mul_f32 v177, 0x3e8293ee, v205
  v_mul_f32 v178, 0x3e8293ee, v206
  v_mul_f32 v179, 0x3e8293ee, v207
  v_mul_f32 v180, 0x3e8293ee, v236
  v_mul_f32 v181, 0x3e8293ee, v237
  v_mul_f32 v182, 0x3e8293ee, v238
  v_mul_f32 v183, 0x3e8293ee, v239
  v_cvt_pk_bf16_f32 v172, v176, v177
  v_cvt_pk_bf16_f32 v173, v178, v179
  v_cvt_pk_bf16_f32 v174, v180, v181
  v_cvt_pk_bf16_f32 v175, v182, v183
  v_accvgpr_write_b32 a204, v172
  v_accvgpr_write_b32 a205, v173
  v_accvgpr_write_b32 a206, v174
  v_accvgpr_write_b32 a207, v175
  v_mul_f32 v164, 0x3e8293ee, v208
  v_mul_f32 v165, 0x3e8293ee, v209
  v_mul_f32 v166, 0x3e8293ee, v210
  v_mul_f32 v167, 0x3e8293ee, v211
  v_mul_f32 v168, 0x3e8293ee, v240
  v_mul_f32 v169, 0x3e8293ee, v241
  v_mul_f32 v170, 0x3e8293ee, v242
  v_mul_f32 v171, 0x3e8293ee, v243
  v_cvt_pk_bf16_f32 v160, v164, v165
  v_cvt_pk_bf16_f32 v161, v166, v167
  v_cvt_pk_bf16_f32 v162, v168, v169
  v_cvt_pk_bf16_f32 v163, v170, v171
  v_accvgpr_write_b32 a208, v160
  v_accvgpr_write_b32 a209, v161
  v_accvgpr_write_b32 a210, v162
  v_accvgpr_write_b32 a211, v163
  v_mul_f32 v176, 0x3e8293ee, v212
  v_mul_f32 v177, 0x3e8293ee, v213
  v_mul_f32 v178, 0x3e8293ee, v214
  v_mul_f32 v179, 0x3e8293ee, v215
  v_mul_f32 v180, 0x3e8293ee, v244
  v_mul_f32 v181, 0x3e8293ee, v245
  v_mul_f32 v182, 0x3e8293ee, v246
  v_mul_f32 v183, 0x3e8293ee, v247
  v_cvt_pk_bf16_f32 v172, v176, v177
  v_cvt_pk_bf16_f32 v173, v178, v179
  v_cvt_pk_bf16_f32 v174, v180, v181
  v_cvt_pk_bf16_f32 v175, v182, v183
  v_accvgpr_write_b32 a212, v172
  v_accvgpr_write_b32 a213, v173
  v_accvgpr_write_b32 a214, v174
  v_accvgpr_write_b32 a215, v175
  v_mul_f32 v164, 0x3e8293ee, v216
  v_mul_f32 v165, 0x3e8293ee, v217
  v_mul_f32 v166, 0x3e8293ee, v218
  v_mul_f32 v167, 0x3e8293ee, v219
  v_mul_f32 v168, 0x3e8293ee, v248
  v_mul_f32 v169, 0x3e8293ee, v249
  v_mul_f32 v170, 0x3e8293ee, v250
  v_mul_f32 v171, 0x3e8293ee, v251
  v_cvt_pk_bf16_f32 v160, v164, v165
  v_cvt_pk_bf16_f32 v161, v166, v167
  v_cvt_pk_bf16_f32 v162, v168, v169
  v_cvt_pk_bf16_f32 v163, v170, v171
  v_accvgpr_write_b32 a216, v160
  v_accvgpr_write_b32 a217, v161
  v_accvgpr_write_b32 a218, v162
  v_accvgpr_write_b32 a219, v163
  v_mul_f32 v176, 0x3e8293ee, v220
  v_mul_f32 v177, 0x3e8293ee, v221
  v_mul_f32 v178, 0x3e8293ee, v222
  v_mul_f32 v179, 0x3e8293ee, v223
  v_mul_f32 v180, 0x3e8293ee, v252
  v_mul_f32 v181, 0x3e8293ee, v253
  v_mul_f32 v182, 0x3e8293ee, v254
  v_mul_f32 v183, 0x3e8293ee, v255
  v_cvt_pk_bf16_f32 v172, v176, v177
  v_cvt_pk_bf16_f32 v173, v178, v179
  v_cvt_pk_bf16_f32 v174, v180, v181
  v_cvt_pk_bf16_f32 v175, v182, v183
  v_accvgpr_write_b32 a220, v172
  v_accvgpr_write_b32 a221, v173
  v_accvgpr_write_b32 a222, v174
  v_accvgpr_write_b32 a223, v175
  s_waitcnt vmcnt(0)
  s_barrier
  s_cmp_eq_u32 s40, 0
  s_cbranch_scc0 sig_8
  s_lshl_b32 s66, s43, 5
  s_add_u32 s66, s66, s78
  s_add_u32 s66, s66, 1024
  s_lshl_b32 s66, s66, 7
  s_add_u32 s66, s66, 4096
  v_mov_b32 v252, s76
  v_mov_b32 v253, s77
  v_mov_b32 v254, 0
  s_mov_b64 exec, 1
  buffer_store_dwordx2 v[252:253], v254, s[72:75], s66 offen sc1
  s_mov_b64 exec, -1
sig_8:
  s_lshl_b32 s56, s44, 1
  s_add_u32 s56, s56, s42
  s_lshl_b32 s57, s43, 4
  s_lshl_b32 s58, s41, 3
  s_add_u32 s57, s57, s58
  s_lshr_b32 s60, s57, 3
  s_lshl_b32 s60, s60, 5
  s_add_u32 s60, s60, s56
  s_lshl_b32 s60, s60, 13
  s_add_u32 s61, s60, 4096
  s_cmp_lt_u32 s57, 16
  s_cselect_b32 s62, 0xf149f2ca, 0
  s_cmp_lt_u32 s57, 8
  s_cselect_b32 s63, 0xf149f2ca, 0
  v_and_b32 v246, 15, v0
  v_lshrrev_b32 v247, 4, v0
  v_lshlrev_b32 v247, 2, v247
  v_mov_b32 v250, 0xf149f2ca
  v_mov_b32 v251, s62
  v_mov_b32 v244, 0
  s_add_u32 s32, s6, 33554432
  s_addc_u32 s33, s7, 0
  s_mov_b32 s34, 4194304
  s_mov_b32 s35, 0x20000
  v_mov_b32 v224, s62
  v_mov_b32 v228, s63
  v_add_u32 v245, 0, v247
  v_cmp_gt_u32 vcc, v245, v246
  v_mov_b32 v240, 0x3f803f80
  s_nop 0
  v_cndmask_b32 v232, v250, v251, vcc
  v_cndmask_b32 v236, v244, v250, vcc
  v_mov_b32 v225, s62
  v_mov_b32 v229, s63
  v_add_u32 v245, 1, v247
  v_cmp_gt_u32 vcc, v245, v246
  v_mov_b32 v241, 0x3f803f80
  s_nop 0
  v_cndmask_b32 v233, v250, v251, vcc
  v_cndmask_b32 v237, v244, v250, vcc
  v_mov_b32 v226, s62
  v_mov_b32 v230, s63
  v_add_u32 v245, 2, v247
  v_cmp_gt_u32 vcc, v245, v246
  v_mov_b32 v242, 0x3f803f80
  s_nop 0
  v_cndmask_b32 v234, v250, v251, vcc
  v_cndmask_b32 v238, v244, v250, vcc
  v_mov_b32 v227, s62
  v_mov_b32 v231, s63
  v_add_u32 v245, 3, v247
  v_cmp_gt_u32 vcc, v245, v246
  v_mov_b32 v243, 0x3f803f80
  s_nop 0
  v_cndmask_b32 v235, v250, v251, vcc
  v_cndmask_b32 v239, v244, v250, vcc
  s_nop 1
  v_mfma_f32_16x16x32_bf16 v[16:19], a[0:3], a[192:195], v[232:235]
  v_mfma_f32_16x16x32_bf16 v[20:23], a[4:7], a[192:195], v[224:227]
  v_mfma_f32_16x16x32_bf16 v[24:27], a[8:11], a[192:195], v[224:227]
  v_mfma_f32_16x16x32_bf16 v[28:31], a[12:15], a[192:195], v[224:227]
  v_mfma_f32_16x16x32_bf16 v[32:35], a[16:19], a[192:195], v[224:227]
  v_mfma_f32_16x16x32_bf16 v[36:39], a[20:23], a[192:195], v[224:227]
  v_mfma_f32_16x16x32_bf16 v[40:43], a[24:27], a[192:195], v[224:227]
  v_mfma_f32_16x16x32_bf16 v[44:47], a[28:31], a[192:195], v[224:227]
  v_mfma_f32_16x16x32_bf16 v[48:51], a[32:35], a[192:195], v[228:231]
  v_mfma_f32_16x16x32_bf16 v[52:55], a[36:39], a[192:195], v[228:231]
  v_mfma_f32_16x16x32_bf16 v[56:59], a[40:43], a[192:195], v[228:231]
  v_mfma_f32_16x16x32_bf16 v[60:63], a[44:47], a[192:195], v[228:231]
  v_mfma_f32_16x16x32_bf16 v[64:67], a[48:51], a[192:195], v[228:231]
  v_mfma_f32_16x16x32_bf16 v[68:71], a[52:55], a[192:195], v[228:231]
  v_mfma_f32_16x16x32_bf16 v[72:75], a[56:59], a[192:195], v[228:231]
  v_mfma_f32_16x16x32_bf16 v[76:79], a[60:63], a[192:195], v[228:231]
  v_mfma_f32_16x16x32_bf16 v[80:83], a[64:67], a[192:195], v[236:239]
  s_nop 7
  v_max3_f32 v200, v16, v17, v18
  v_mfma_f32_16x16x32_bf16 v[84:87], a[4:7], a[196:199], v[232:235]
  v_max3_f32 v201, v50, v51, v52
  v_max3_f32 v200, v200, v19, v20
  v_max3_f32 v201, v201, v53, v54
  v_max3_f32 v200, v200, v21, v22
  v_max3_f32 v201, v201, v55, v56
  v_max3_f32 v200, v200, v23, v24
  v_max3_f32 v201, v201, v57, v58
  v_max3_f32 v200, v200, v25, v26
  v_max3_f32 v201, v201, v59, v60
  v_mfma_f32_16x16x32_bf16 v[88:91], a[8:11], a[196:199], v[224:227]
  v_max3_f32 v200, v200, v27, v28
  v_max3_f32 v201, v201, v61, v62
  v_max3_f32 v200, v200, v29, v30
  v_max3_f32 v201, v201, v63, v64
  v_max3_f32 v200, v200, v31, v32
  v_max3_f32 v201, v201, v65, v66
  v_max3_f32 v200, v200, v33, v34
  v_max3_f32 v201, v201, v67, v68
  v_max3_f32 v200, v200, v35, v36
  v_max3_f32 v201, v201, v69, v70
  v_mfma_f32_16x16x32_bf16 v[92:95], a[12:15], a[196:199], v[224:227]
  v_max3_f32 v200, v200, v37, v38
  v_max3_f32 v201, v201, v71, v72
  v_max3_f32 v200, v200, v39, v40
  v_max3_f32 v201, v201, v73, v74
  v_max3_f32 v200, v200, v41, v42
  v_max3_f32 v201, v201, v75, v76
  v_max3_f32 v200, v200, v43, v44
  v_max3_f32 v201, v201, v77, v78
  v_max3_f32 v200, v200, v45, v46
  v_max3_f32 v201, v201, v79, v80
  v_mfma_f32_16x16x32_bf16 v[96:99], a[16:19], a[196:199], v[224:227]
  v_max3_f32 v200, v200, v47, v48
  v_max3_f32 v201, v201, v81, v82
  v_max3_f32 v200, v200, v49, v83
  v_max_f32 v200, v200, v201
  v_mov_b32 v202, v200
  s_nop 1
  v_permlane32_swap_b32 v200, v202
  s_nop 0
  v_max_f32 v200, v200, v202
  v_mov_b32 v202, v200
  v_mfma_f32_16x16x32_bf16 v[100:103], a[20:23], a[196:199], v[224:227]
  s_nop 1
  v_permlane16_swap_b32 v200, v202
  s_nop 0
  v_max_f32 v200, v200, v202
  v_sub_f32 v16, v16, v200
  v_sub_f32 v17, v17, v200
  v_sub_f32 v18, v18, v200
  v_sub_f32 v19, v19, v200
  v_exp_f32 v16, v16
  v_exp_f32 v17, v17
  v_mfma_f32_16x16x32_bf16 v[104:107], a[24:27], a[196:199], v[224:227]
  v_exp_f32 v18, v18
  v_exp_f32 v19, v19
  v_sub_f32 v20, v20, v200
  v_sub_f32 v21, v21, v200
  v_sub_f32 v22, v22, v200
  v_sub_f32 v23, v23, v200
  v_exp_f32 v20, v20
  v_exp_f32 v21, v21
  v_exp_f32 v22, v22
  v_exp_f32 v23, v23
  v_mfma_f32_16x16x32_bf16 v[108:111], a[28:31], a[196:199], v[224:227]
  v_sub_f32 v24, v24, v200
  v_sub_f32 v25, v25, v200
  v_sub_f32 v26, v26, v200
  v_sub_f32 v27, v27, v200
  v_exp_f32 v24, v24
  v_exp_f32 v25, v25
  v_exp_f32 v26, v26
  v_exp_f32 v27, v27
  v_sub_f32 v28, v28, v200
  v_sub_f32 v29, v29, v200
  v_mfma_f32_16x16x32_bf16 v[112:115], a[32:35], a[196:199], v[228:231]
  v_sub_f32 v30, v30, v200
  v_sub_f32 v31, v31, v200
  v_exp_f32 v28, v28
  v_exp_f32 v29, v29
  v_exp_f32 v30, v30
  v_exp_f32 v31, v31
  v_sub_f32 v32, v32, v200
  v_sub_f32 v33, v33, v200
  v_sub_f32 v34, v34, v200
  v_sub_f32 v35, v35, v200
  v_mfma_f32_16x16x32_bf16 v[116:119], a[36:39], a[196:199], v[228:231]
  v_exp_f32 v32, v32
  v_exp_f32 v33, v33
  v_exp_f32 v34, v34
  v_exp_f32 v35, v35
  v_sub_f32 v36, v36, v200
  v_sub_f32 v37, v37, v200
  v_sub_f32 v38, v38, v200
  v_sub_f32 v39, v39, v200
  v_exp_f32 v36, v36
  v_mfma_f32_16x16x32_bf16 v[120:123], a[40:43], a[196:199], v[228:231]
  v_exp_f32 v37, v37
  v_exp_f32 v38, v38
  v_exp_f32 v39, v39
  v_sub_f32 v40, v40, v200
  v_sub_f32 v41, v41, v200
  v_sub_f32 v42, v42, v200
  v_sub_f32 v43, v43, v200
  v_exp_f32 v40, v40
  v_exp_f32 v41, v41
  v_exp_f32 v42, v42
  v_mfma_f32_16x16x32_bf16 v[124:127], a[44:47], a[196:199], v[228:231]
  v_exp_f32 v43, v43
  v_sub_f32 v44, v44, v200
  v_sub_f32 v45, v45, v200
  v_sub_f32 v46, v46, v200
  v_sub_f32 v47, v47, v200
  v_exp_f32 v44, v44
  v_exp_f32 v45, v45
  v_exp_f32 v46, v46
  v_exp_f32 v47, v47
  v_sub_f32 v48, v48, v200
  v_mfma_f32_16x16x32_bf16 v[128:131], a[48:51], a[196:199], v[228:231]
  v_sub_f32 v49, v49, v200
  v_sub_f32 v50, v50, v200
  v_sub_f32 v51, v51, v200
  v_exp_f32 v48, v48
  v_exp_f32 v49, v49
  v_exp_f32 v50, v50
  v_exp_f32 v51, v51
  v_sub_f32 v52, v52, v200
  v_sub_f32 v53, v53, v200
  v_sub_f32 v54, v54, v200
  v_mfma_f32_16x16x32_bf16 v[132:135], a[52:55], a[196:199], v[228:231]
  v_sub_f32 v55, v55, v200
  v_exp_f32 v52, v52
  v_exp_f32 v53, v53
  v_exp_f32 v54, v54
  v_exp_f32 v55, v55
  v_sub_f32 v56, v56, v200
  v_sub_f32 v57, v57, v200
  v_sub_f32 v58, v58, v200
  v_sub_f32 v59, v59, v200
  v_exp_f32 v56, v56
  v_mfma_f32_16x16x32_bf16 v[136:139], a[56:59], a[196:199], v[228:231]
  v_exp_f32 v57, v57
  v_exp_f32 v58, v58
  v_exp_f32 v59, v59
  v_sub_f32 v60, v60, v200
  v_sub_f32 v61, v61, v200
  v_sub_f32 v62, v62, v200
  v_sub_f32 v63, v63, v200
  v_exp_f32 v60, v60
  v_exp_f32 v61, v61
  v_exp_f32 v62, v62
  v_mfma_f32_16x16x32_bf16 v[140:143], a[60:63], a[196:199], v[228:231]
  v_exp_f32 v63, v63
  v_sub_f32 v64, v64, v200
  v_sub_f32 v65, v65, v200
  v_sub_f32 v66, v66, v200
  v_sub_f32 v67, v67, v200
  v_exp_f32 v64, v64
  v_exp_f32 v65, v65
  v_exp_f32 v66, v66
  v_exp_f32 v67, v67
  v_sub_f32 v68, v68, v200
  v_mfma_f32_16x16x32_bf16 v[144:147], a[64:67], a[196:199], 0
  v_sub_f32 v69, v69, v200
  v_sub_f32 v70, v70, v200
  v_sub_f32 v71, v71, v200
  v_exp_f32 v68, v68
  v_exp_f32 v69, v69
  v_exp_f32 v70, v70
  v_exp_f32 v71, v71
  v_sub_f32 v72, v72, v200
  v_sub_f32 v73, v73, v200
  v_sub_f32 v74, v74, v200
  v_mfma_f32_16x16x32_bf16 v[148:151], a[68:71], a[196:199], v[236:239]
  v_sub_f32 v75, v75, v200
  v_exp_f32 v72, v72
  v_exp_f32 v73, v73
  v_exp_f32 v74, v74
  v_exp_f32 v75, v75
  v_sub_f32 v76, v76, v200
  v_sub_f32 v77, v77, v200
  v_sub_f32 v78, v78, v200
  v_sub_f32 v79, v79, v200
  v_exp_f32 v76, v76
  v_exp_f32 v77, v77
  v_exp_f32 v78, v78
  v_exp_f32 v79, v79
  v_sub_f32 v80, v80, v200
  v_sub_f32 v81, v81, v200
  v_sub_f32 v82, v82, v200
  v_sub_f32 v83, v83, v200
  v_exp_f32 v80, v80
  v_exp_f32 v81, v81
  v_exp_f32 v82, v82
  v_exp_f32 v83, v83
  v_mov_b32 v186, 0
  v_mov_b32 v187, 0
  v_cvt_pk_bf16_f32 v152, v16, v17
  v_cvt_pk_bf16_f32 v153, v18, v19
  v_cvt_pk_bf16_f32 v154, v20, v21
  v_cvt_pk_bf16_f32 v155, v22, v23
  v_cvt_pk_bf16_f32 v156, v24, v25
  v_cvt_pk_bf16_f32 v157, v26, v27
  v_cvt_pk_bf16_f32 v158, v28, v29
  v_cvt_pk_bf16_f32 v159, v30, v31
  v_cvt_pk_bf16_f32 v160, v32, v33
  v_cvt_pk_bf16_f32 v161, v34, v35
  v_cvt_pk_bf16_f32 v162, v36, v37
  v_cvt_pk_bf16_f32 v163, v38, v39
  v_cvt_pk_bf16_f32 v164, v40, v41
  v_cvt_pk_bf16_f32 v165, v42, v43
  v_cvt_pk_bf16_f32 v166, v44, v45
  v_cvt_pk_bf16_f32 v167, v46, v47
  v_cvt_pk_bf16_f32 v168, v48, v49
  v_cvt_pk_bf16_f32 v169, v50, v51
  v_cvt_pk_bf16_f32 v170, v52, v53
  v_cvt_pk_bf16_f32 v171, v54, v55
  v_cvt_pk_bf16_f32 v172, v56, v57
  v_cvt_pk_bf16_f32 v173, v58, v59
  v_cvt_pk_bf16_f32 v174, v60, v61
  v_cvt_pk_bf16_f32 v175, v62, v63
  v_cvt_pk_bf16_f32 v176, v64, v65
  v_cvt_pk_bf16_f32 v177, v66, v67
  v_cvt_pk_bf16_f32 v178, v68, v69
  v_cvt_pk_bf16_f32 v179, v70, v71
  v_cvt_pk_bf16_f32 v180, v72, v73
  v_cvt_pk_bf16_f32 v181, v74, v75
  v_cvt_pk_bf16_f32 v182, v76, v77
  v_cvt_pk_bf16_f32 v183, v78, v79
  v_cvt_pk_bf16_f32 v184, v80, v81
  v_cvt_pk_bf16_f32 v185, v82, v83
  v_max3_f32 v200, v84, v85, v86
  v_mfma_f32_16x16x32_bf16 v[188:191], a[96:99], v[152:155], 0
  v_max3_f32 v201, v118, v119, v120
  v_max3_f32 v200, v200, v87, v88
  v_max3_f32 v201, v201, v121, v122
  v_mfma_f32_16x16x32_bf16 v[192:195], a[100:103], v[152:155], 0
  v_max3_f32 v200, v200, v89, v90
  v_max3_f32 v201, v201, v123, v124
  v_max3_f32 v200, v200, v91, v92
  v_max3_f32 v201, v201, v125, v126
  v_mfma_f32_16x16x32_bf16 v[196:199], v[240:243], v[152:155], 0
  v_max3_f32 v200, v200, v93, v94
  v_max3_f32 v201, v201, v127, v128
  v_max3_f32 v200, v200, v95, v96
  v_max3_f32 v201, v201, v129, v130
  v_mfma_f32_16x16x32_bf16 v[188:191], a[104:107], v[156:159], v[188:191]
  v_max3_f32 v200, v200, v97, v98
  v_max3_f32 v201, v201, v131, v132
  v_max3_f32 v200, v200, v99, v100
  v_max3_f32 v201, v201, v133, v134
  v_mfma_f32_16x16x32_bf16 v[192:195], a[108:111], v[156:159], v[192:195]
  v_max3_f32 v200, v200, v101, v102
  v_max3_f32 v201, v201, v135, v136
  v_max3_f32 v200, v200, v103, v104
  v_max3_f32 v201, v201, v137, v138
  v_mfma_f32_16x16x32_bf16 v[196:199], v[240:243], v[156:159], v[196:199]
  v_max3_f32 v200, v200, v105, v106
  v_max3_f32 v201, v201, v139, v140
  v_max3_f32 v200, v200, v107, v108
  v_mfma_f32_16x16x32_bf16 v[188:191], a[112:115], v[160:163], v[188:191]
  v_max3_f32 v201, v201, v141, v142
  v_max3_f32 v200, v200, v109, v110
  v_max3_f32 v201, v201, v143, v144
  v_max3_f32 v200, v200, v111, v112
  v_mfma_f32_16x16x32_bf16 v[192:195], a[116:119], v[160:163], v[192:195]
  v_max3_f32 v201, v201, v145, v146
  v_max3_f32 v200, v200, v113, v114
  v_max3_f32 v201, v201, v147, v148
  v_max3_f32 v200, v200, v115, v116
  v_mfma_f32_16x16x32_bf16 v[196:199], v[240:243], v[160:163], v[196:199]
  v_max3_f32 v201, v201, v149, v150
  v_max3_f32 v200, v200, v117, v151
  v_max_f32 v200, v200, v201
  v_mov_b32 v202, v200
  v_mfma_f32_16x16x32_bf16 v[188:191], a[120:123], v[164:167], v[188:191]
  s_nop 1
  v_permlane32_swap_b32 v200, v202
  s_nop 0
  v_max_f32 v200, v200, v202
  v_mfma_f32_16x16x32_bf16 v[192:195], a[124:127], v[164:167], v[192:195]
  v_mov_b32 v202, v200
  s_nop 1
  v_permlane16_swap_b32 v200, v202
  s_nop 0
  v_mfma_f32_16x16x32_bf16 v[196:199], v[240:243], v[164:167], v[196:199]
  v_max_f32 v200, v200, v202
  v_sub_f32 v84, v84, v200
  v_sub_f32 v85, v85, v200
  v_mfma_f32_16x16x32_bf16 v[188:191], a[128:131], v[168:171], v[188:191]
  v_sub_f32 v86, v86, v200
  v_sub_f32 v87, v87, v200
  v_exp_f32 v84, v84
  v_exp_f32 v85, v85
  v_mfma_f32_16x16x32_bf16 v[192:195], a[132:135], v[168:171], v[192:195]
  v_exp_f32 v86, v86
  v_exp_f32 v87, v87
  v_sub_f32 v88, v88, v200
  v_sub_f32 v89, v89, v200
  v_mfma_f32_16x16x32_bf16 v[196:199], v[240:243], v[168:171], v[196:199]
  v_sub_f32 v90, v90, v200
  v_sub_f32 v91, v91, v200
  v_exp_f32 v88, v88
  v_exp_f32 v89, v89
  v_mfma_f32_16x16x32_bf16 v[188:191], a[136:139], v[172:175], v[188:191]
  v_exp_f32 v90, v90
  v_exp_f32 v91, v91
  v_sub_f32 v92, v92, v200
  v_sub_f32 v93, v93, v200
  v_mfma_f32_16x16x32_bf16 v[192:195], a[140:143], v[172:175], v[192:195]
  v_sub_f32 v94, v94, v200
  v_sub_f32 v95, v95, v200
  v_exp_f32 v92, v92
  v_mfma_f32_16x16x32_bf16 v[196:199], v[240:243], v[172:175], v[196:199]
  v_exp_f32 v93, v93
  v_exp_f32 v94, v94
  v_exp_f32 v95, v95
  v_sub_f32 v96, v96, v200
  v_mfma_f32_16x16x32_bf16 v[188:191], a[144:147], v[176:179], v[188:191]
  v_sub_f32 v97, v97, v200
  v_sub_f32 v98, v98, v200
  v_sub_f32 v99, v99, v200
  v_exp_f32 v96, v96
  v_mfma_f32_16x16x32_bf16 v[192:195], a[148:151], v[176:179], v[192:195]
  v_exp_f32 v97, v97
  v_exp_f32 v98, v98
  v_exp_f32 v99, v99
  v_sub_f32 v100, v100, v200
  v_mfma_f32_16x16x32_bf16 v[196:199], v[240:243], v[176:179], v[196:199]
  v_sub_f32 v101, v101, v200
  v_sub_f32 v102, v102, v200
  v_sub_f32 v103, v103, v200
  v_exp_f32 v100, v100
  v_mfma_f32_16x16x32_bf16 v[188:191], a[152:155], v[180:183], v[188:191]
  v_exp_f32 v101, v101
  v_exp_f32 v102, v102
  v_exp_f32 v103, v103
  v_sub_f32 v104, v104, v200
  v_mfma_f32_16x16x32_bf16 v[192:195], a[156:159], v[180:183], v[192:195]
  v_sub_f32 v105, v105, v200
  v_sub_f32 v106, v106, v200
  v_sub_f32 v107, v107, v200
  v_mfma_f32_16x16x32_bf16 v[196:199], v[240:243], v[180:183], v[196:199]
  v_exp_f32 v104, v104
  v_exp_f32 v105, v105
  v_exp_f32 v106, v106
  v_exp_f32 v107, v107
  v_mfma_f32_16x16x32_bf16 v[188:191], a[160:163], v[184:187], v[188:191]
  v_sub_f32 v108, v108, v200
  v_sub_f32 v109, v109, v200
  v_sub_f32 v110, v110, v200
  v_sub_f32 v111, v111, v200
  v_mfma_f32_16x16x32_bf16 v[192:195], a[164:167], v[184:187], v[192:195]
  v_exp_f32 v108, v108
  v_exp_f32 v109, v109
  v_exp_f32 v110, v110
  v_exp_f32 v111, v111
  v_mfma_f32_16x16x32_bf16 v[196:199], v[240:243], v[184:187], v[196:199]
  v_sub_f32 v112, v112, v200
  v_sub_f32 v113, v113, v200
  v_sub_f32 v114, v114, v200
  v_sub_f32 v115, v115, v200
  v_mfma_f32_16x16x32_bf16 v[16:19], a[8:11], a[200:203], v[232:235]
  v_exp_f32 v112, v112
  v_exp_f32 v113, v113
  v_exp_f32 v114, v114
  v_mfma_f32_16x16x32_bf16 v[20:23], a[12:15], a[200:203], v[224:227]
  v_exp_f32 v115, v115
  v_sub_f32 v116, v116, v200
  v_sub_f32 v117, v117, v200
  v_sub_f32 v118, v118, v200
  v_mfma_f32_16x16x32_bf16 v[24:27], a[16:19], a[200:203], v[224:227]
  v_sub_f32 v119, v119, v200
  v_exp_f32 v116, v116
  v_exp_f32 v117, v117
  v_exp_f32 v118, v118
  v_mfma_f32_16x16x32_bf16 v[28:31], a[20:23], a[200:203], v[224:227]
  v_exp_f32 v119, v119
  v_sub_f32 v120, v120, v200
  v_sub_f32 v121, v121, v200
  v_sub_f32 v122, v122, v200
  v_mfma_f32_16x16x32_bf16 v[32:35], a[24:27], a[200:203], v[224:227]
  v_sub_f32 v123, v123, v200
  v_exp_f32 v120, v120
  v_exp_f32 v121, v121
  v_exp_f32 v122, v122
  v_mfma_f32_16x16x32_bf16 v[36:39], a[28:31], a[200:203], v[224:227]
  v_exp_f32 v123, v123
  v_sub_f32 v124, v124, v200
  v_sub_f32 v125, v125, v200
  v_sub_f32 v126, v126, v200
  v_mfma_f32_16x16x32_bf16 v[40:43], a[32:35], a[200:203], v[228:231]
  v_sub_f32 v127, v127, v200
  v_exp_f32 v124, v124
  v_exp_f32 v125, v125
  v_mfma_f32_16x16x32_bf16 v[44:47], a[36:39], a[200:203], v[228:231]
  v_exp_f32 v126, v126
  v_exp_f32 v127, v127
  v_sub_f32 v128, v128, v200
  v_sub_f32 v129, v129, v200
  v_mfma_f32_16x16x32_bf16 v[48:51], a[40:43], a[200:203], v[228:231]
  v_sub_f32 v130, v130, v200
  v_sub_f32 v131, v131, v200
  v_exp_f32 v128, v128
  v_exp_f32 v129, v129
  v_mfma_f32_16x16x32_bf16 v[52:55], a[44:47], a[200:203], v[228:231]
  v_exp_f32 v130, v130
  v_exp_f32 v131, v131
  v_sub_f32 v132, v132, v200
  v_sub_f32 v133, v133, v200
  v_mfma_f32_16x16x32_bf16 v[56:59], a[48:51], a[200:203], v[228:231]
  v_sub_f32 v134, v134, v200
  v_sub_f32 v135, v135, v200
  v_exp_f32 v132, v132
  v_exp_f32 v133, v133
  v_mfma_f32_16x16x32_bf16 v[60:63], a[52:55], a[200:203], v[228:231]
  v_exp_f32 v134, v134
  v_exp_f32 v135, v135
  v_sub_f32 v136, v136, v200
  v_mfma_f32_16x16x32_bf16 v[64:67], a[56:59], a[200:203], v[228:231]
  v_sub_f32 v137, v137, v200
  v_sub_f32 v138, v138, v200
  v_sub_f32 v139, v139, v200
  v_exp_f32 v136, v136
  v_mfma_f32_16x16x32_bf16 v[68:71], a[60:63], a[200:203], v[228:231]
  v_exp_f32 v137, v137
  v_exp_f32 v138, v138
  v_exp_f32 v139, v139
  v_sub_f32 v140, v140, v200
  v_mfma_f32_16x16x32_bf16 v[72:75], a[64:67], a[200:203], 0
  v_sub_f32 v141, v141, v200
  v_sub_f32 v142, v142, v200
  v_sub_f32 v143, v143, v200
  v_exp_f32 v140, v140
  v_mfma_f32_16x16x32_bf16 v[76:79], a[68:71], a[200:203], 0
  v_exp_f32 v141, v141
  v_exp_f32 v142, v142
  v_exp_f32 v143, v143
  v_sub_f32 v144, v144, v200
  v_mfma_f32_16x16x32_bf16 v[80:83], a[72:75], a[200:203], v[236:239]
  v_sub_f32 v145, v145, v200
  v_sub_f32 v146, v146, v200
  v_sub_f32 v147, v147, v200
  v_exp_f32 v144, v144
  v_exp_f32 v145, v145
  v_exp_f32 v146, v146
  v_exp_f32 v147, v147
  v_sub_f32 v148, v148, v200
  v_sub_f32 v149, v149, v200
  v_sub_f32 v150, v150, v200
  v_sub_f32 v151, v151, v200
  v_exp_f32 v148, v148
  v_exp_f32 v149, v149
  v_exp_f32 v150, v150
  v_exp_f32 v151, v151
  v_rcp_f32 v204, v196
  s_nop 0
  v_mul_f32 v206, v188, v204
  v_mul_f32 v207, v189, v204
  v_mul_f32 v208, v190, v204
  v_mul_f32 v209, v191, v204
  v_mul_f32 v210, v192, v204
  v_mul_f32 v211, v193, v204
  v_mul_f32 v212, v194, v204
  v_mul_f32 v213, v195, v204
  v_cvt_pk_bf16_f32 v216, v206, v207
  v_cvt_pk_bf16_f32 v217, v208, v209
  v_cvt_pk_bf16_f32 v218, v210, v211
  v_cvt_pk_bf16_f32 v219, v212, v213
  buffer_store_dwordx4 v[216:219], v1, s[32:35], s60 offen offset:0 sc1
  v_mov_b32 v152, 0
  v_mov_b32 v153, 0
  v_cvt_pk_bf16_f32 v154, v84, v85
  v_cvt_pk_bf16_f32 v155, v86, v87
  v_cvt_pk_bf16_f32 v156, v88, v89
  v_cvt_pk_bf16_f32 v157, v90, v91
  v_cvt_pk_bf16_f32 v158, v92, v93
  v_cvt_pk_bf16_f32 v159, v94, v95
  v_cvt_pk_bf16_f32 v160, v96, v97
  v_cvt_pk_bf16_f32 v161, v98, v99
  v_cvt_pk_bf16_f32 v162, v100, v101
  v_cvt_pk_bf16_f32 v163, v102, v103
  v_cvt_pk_bf16_f32 v164, v104, v105
  v_cvt_pk_bf16_f32 v165, v106, v107
  v_cvt_pk_bf16_f32 v166, v108, v109
  v_cvt_pk_bf16_f32 v167, v110, v111
  v_cvt_pk_bf16_f32 v168, v112, v113
  v_cvt_pk_bf16_f32 v169, v114, v115
  v_cvt_pk_bf16_f32 v170, v116, v117
  v_cvt_pk_bf16_f32 v171, v118, v119
  v_cvt_pk_bf16_f32 v172, v120, v121
  v_cvt_pk_bf16_f32 v173, v122, v123
  v_cvt_pk_bf16_f32 v174, v124, v125
  v_cvt_pk_bf16_f32 v175, v126, v127
  v_cvt_pk_bf16_f32 v176, v128, v129
  v_cvt_pk_bf16_f32 v177, v130, v131
  v_cvt_pk_bf16_f32 v178, v132, v133
  v_cvt_pk_bf16_f32 v179, v134, v135
  v_cvt_pk_bf16_f32 v180, v136, v137
  v_cvt_pk_bf16_f32 v181, v138, v139
  v_cvt_pk_bf16_f32 v182, v140, v141
  v_cvt_pk_bf16_f32 v183, v142, v143
  v_cvt_pk_bf16_f32 v184, v144, v145
  v_cvt_pk_bf16_f32 v185, v146, v147
  v_cvt_pk_bf16_f32 v186, v148, v149
  v_cvt_pk_bf16_f32 v187, v150, v151
  v_max3_f32 v200, v16, v17, v18
  v_mfma_f32_16x16x32_bf16 v[188:191], a[96:99], v[152:155], 0
  v_max3_f32 v201, v50, v51, v52
  v_max3_f32 v200, v200, v19, v20
  v_max3_f32 v201, v201, v53, v54
  v_mfma_f32_16x16x32_bf16 v[192:195], a[100:103], v[152:155], 0
  v_max3_f32 v200, v200, v21, v22
  v_max3_f32 v201, v201, v55, v56
  v_max3_f32 v200, v200, v23, v24
  v_max3_f32 v201, v201, v57, v58
  v_mfma_f32_16x16x32_bf16 v[196:199], v[240:243], v[152:155], 0
  v_max3_f32 v200, v200, v25, v26
  v_max3_f32 v201, v201, v59, v60
  v_max3_f32 v200, v200, v27, v28
  v_max3_f32 v201, v201, v61, v62
  v_mfma_f32_16x16x32_bf16 v[188:191], a[104:107], v[156:159], v[188:191]
  v_max3_f32 v200, v200, v29, v30
  v_max3_f32 v201, v201, v63, v64
  v_max3_f32 v200, v200, v31, v32
  v_max3_f32 v201, v201, v65, v66
  v_mfma_f32_16x16x32_bf16 v[192:195], a[108:111], v[156:159], v[192:195]
  v_max3_f32 v200, v200, v33, v34
  v_max3_f32 v201, v201, v67, v68
  v_max3_f32 v200, v200, v35, v36
  v_max3_f32 v201, v201, v69, v70
  v_mfma_f32_16x16x32_bf16 v[196:199], v[240:243], v[156:159], v[196:199]
  v_max3_f32 v200, v200, v37, v38
  v_max3_f32 v201, v201, v71, v72
  v_max3_f32 v200, v200, v39, v40
  v_mfma_f32_16x16x32_bf16 v[188:191], a[112:115], v[160:163], v[188:191]
  v_max3_f32 v201, v201, v73, v74
  v_max3_f32 v200, v200, v41, v42
  v_max3_f32 v201, v201, v75, v76
  v_max3_f32 v200, v200, v43, v44
  v_mfma_f32_16x16x32_bf16 v[192:195], a[116:119], v[160:163], v[192:195]
  v_max3_f32 v201, v201, v77, v78
  v_max3_f32 v200, v200, v45, v46
  v_max3_f32 v201, v201, v79, v80
  v_max3_f32 v200, v200, v47, v48
  v_mfma_f32_16x16x32_bf16 v[196:199], v[240:243], v[160:163], v[196:199]
  v_max3_f32 v201, v201, v81, v82
  v_max3_f32 v200, v200, v49, v83
  v_max_f32 v200, v200, v201
  v_mov_b32 v202, v200
  v_mfma_f32_16x16x32_bf16 v[188:191], a[120:123], v[164:167], v[188:191]
  s_nop 1
  v_permlane32_swap_b32 v200, v202
  s_nop 0
  v_max_f32 v200, v200, v202
  v_mfma_f32_16x16x32_bf16 v[192:195], a[124:127], v[164:167], v[192:195]
  v_mov_b32 v202, v200
  s_nop 1
  v_permlane16_swap_b32 v200, v202
  s_nop 0
  v_mfma_f32_16x16x32_bf16 v[196:199], v[240:243], v[164:167], v[196:199]
  v_max_f32 v200, v200, v202
  v_sub_f32 v16, v16, v200
  v_sub_f32 v17, v17, v200
  v_mfma_f32_16x16x32_bf16 v[188:191], a[128:131], v[168:171], v[188:191]
  v_sub_f32 v18, v18, v200
  v_sub_f32 v19, v19, v200
  v_exp_f32 v16, v16
  v_exp_f32 v17, v17
  v_mfma_f32_16x16x32_bf16 v[192:195], a[132:135], v[168:171], v[192:195]
  v_exp_f32 v18, v18
  v_exp_f32 v19, v19
  v_sub_f32 v20, v20, v200
  v_sub_f32 v21, v21, v200
  v_mfma_f32_16x16x32_bf16 v[196:199], v[240:243], v[168:171], v[196:199]
  v_sub_f32 v22, v22, v200
  v_sub_f32 v23, v23, v200
  v_exp_f32 v20, v20
  v_exp_f32 v21, v21
  v_mfma_f32_16x16x32_bf16 v[188:191], a[136:139], v[172:175], v[188:191]
  v_exp_f32 v22, v22
  v_exp_f32 v23, v23
  v_sub_f32 v24, v24, v200
  v_sub_f32 v25, v25, v200
  v_mfma_f32_16x16x32_bf16 v[192:195], a[140:143], v[172:175], v[192:195]
  v_sub_f32 v26, v26, v200
  v_sub_f32 v27, v27, v200
  v_exp_f32 v24, v24
  v_mfma_f32_16x16x32_bf16 v[196:199], v[240:243], v[172:175], v[196:199]
  v_exp_f32 v25, v25
  v_exp_f32 v26, v26
  v_exp_f32 v27, v27
  v_sub_f32 v28, v28, v200
  v_mfma_f32_16x16x32_bf16 v[188:191], a[144:147], v[176:179], v[188:191]
  v_sub_f32 v29, v29, v200
  v_sub_f32 v30, v30, v200
  v_sub_f32 v31, v31, v200
  v_exp_f32 v28, v28
  v_mfma_f32_16x16x32_bf16 v[192:195], a[148:151], v[176:179], v[192:195]
  v_exp_f32 v29, v29
  v_exp_f32 v30, v30
  v_exp_f32 v31, v31
  v_sub_f32 v32, v32, v200
  v_mfma_f32_16x16x32_bf16 v[196:199], v[240:243], v[176:179], v[196:199]
  v_sub_f32 v33, v33, v200
  v_sub_f32 v34, v34, v200
  v_sub_f32 v35, v35, v200
  v_exp_f32 v32, v32
  v_mfma_f32_16x16x32_bf16 v[188:191], a[152:155], v[180:183], v[188:191]
  v_exp_f32 v33, v33
  v_exp_f32 v34, v34
  v_exp_f32 v35, v35
  v_sub_f32 v36, v36, v200
  v_mfma_f32_16x16x32_bf16 v[192:195], a[156:159], v[180:183], v[192:195]
  v_sub_f32 v37, v37, v200
  v_sub_f32 v38, v38, v200
  v_sub_f32 v39, v39, v200
  v_mfma_f32_16x16x32_bf16 v[196:199], v[240:243], v[180:183], v[196:199]
  v_exp_f32 v36, v36
  v_exp_f32 v37, v37
  v_exp_f32 v38, v38
  v_exp_f32 v39, v39
  v_mfma_f32_16x16x32_bf16 v[188:191], a[160:163], v[184:187], v[188:191]
  v_sub_f32 v40, v40, v200
  v_sub_f32 v41, v41, v200
  v_sub_f32 v42, v42, v200
  v_sub_f32 v43, v43, v200
  v_mfma_f32_16x16x32_bf16 v[192:195], a[164:167], v[184:187], v[192:195]
  v_exp_f32 v40, v40
  v_exp_f32 v41, v41
  v_exp_f32 v42, v42
  v_exp_f32 v43, v43
  v_mfma_f32_16x16x32_bf16 v[196:199], v[240:243], v[184:187], v[196:199]
  v_sub_f32 v44, v44, v200
  v_sub_f32 v45, v45, v200
  v_sub_f32 v46, v46, v200
  v_sub_f32 v47, v47, v200
  v_mfma_f32_16x16x32_bf16 v[84:87], a[12:15], a[204:207], v[232:235]
  v_exp_f32 v44, v44
  v_exp_f32 v45, v45
  v_exp_f32 v46, v46
  v_mfma_f32_16x16x32_bf16 v[88:91], a[16:19], a[204:207], v[224:227]
  v_exp_f32 v47, v47
  v_sub_f32 v48, v48, v200
  v_sub_f32 v49, v49, v200
  v_sub_f32 v50, v50, v200
  v_mfma_f32_16x16x32_bf16 v[92:95], a[20:23], a[204:207], v[224:227]
  v_sub_f32 v51, v51, v200
  v_exp_f32 v48, v48
  v_exp_f32 v49, v49
  v_exp_f32 v50, v50
  v_mfma_f32_16x16x32_bf16 v[96:99], a[24:27], a[204:207], v[224:227]
  v_exp_f32 v51, v51
  v_sub_f32 v52, v52, v200
  v_sub_f32 v53, v53, v200
  v_sub_f32 v54, v54, v200
  v_mfma_f32_16x16x32_bf16 v[100:103], a[28:31], a[204:207], v[224:227]
  v_sub_f32 v55, v55, v200
  v_exp_f32 v52, v52
  v_exp_f32 v53, v53
  v_exp_f32 v54, v54
  v_mfma_f32_16x16x32_bf16 v[104:107], a[32:35], a[204:207], v[228:231]
  v_exp_f32 v55, v55
  v_sub_f32 v56, v56, v200
  v_sub_f32 v57, v57, v200
  v_sub_f32 v58, v58, v200
  v_mfma_f32_16x16x32_bf16 v[108:111], a[36:39], a[204:207], v[228:231]
  v_sub_f32 v59, v59, v200
  v_exp_f32 v56, v56
  v_exp_f32 v57, v57
  v_mfma_f32_16x16x32_bf16 v[112:115], a[40:43], a[204:207], v[228:231]
  v_exp_f32 v58, v58
  v_exp_f32 v59, v59
  v_sub_f32 v60, v60, v200
  v_sub_f32 v61, v61, v200
  v_mfma_f32_16x16x32_bf16 v[116:119], a[44:47], a[204:207], v[228:231]
  v_sub_f32 v62, v62, v200
  v_sub_f32 v63, v63, v200
  v_exp_f32 v60, v60
  v_exp_f32 v61, v61
  v_mfma_f32_16x16x32_bf16 v[120:123], a[48:51], a[204:207], v[228:231]
  v_exp_f32 v62, v62
  v_exp_f32 v63, v63
  v_sub_f32 v64, v64, v200
  v_sub_f32 v65, v65, v200
  v_mfma_f32_16x16x32_bf16 v[124:127], a[52:55], a[204:207], v[228:231]
  v_sub_f32 v66, v66, v200
  v_sub_f32 v67, v67, v200
  v_exp_f32 v64, v64
  v_exp_f32 v65, v65
  v_mfma_f32_16x16x32_bf16 v[128:131], a[56:59], a[204:207], v[228:231]
  v_exp_f32 v66, v66
  v_exp_f32 v67, v67
  v_sub_f32 v68, v68, v200
  v_mfma_f32_16x16x32_bf16 v[132:135], a[60:63], a[204:207], v[228:231]
  v_sub_f32 v69, v69, v200
  v_sub_f32 v70, v70, v200
  v_sub_f32 v71, v71, v200
  v_exp_f32 v68, v68
  v_mfma_f32_16x16x32_bf16 v[136:139], a[64:67], a[204:207], 0
  v_exp_f32 v69, v69
  v_exp_f32 v70, v70
  v_exp_f32 v71, v71
  v_sub_f32 v72, v72, v200
  v_mfma_f32_16x16x32_bf16 v[140:143], a[68:71], a[204:207], 0
  v_sub_f32 v73, v73, v200
  v_sub_f32 v74, v74, v200
  v_sub_f32 v75, v75, v200
  v_exp_f32 v72, v72
  v_mfma_f32_16x16x32_bf16 v[144:147], a[72:75], a[204:207], 0
  v_exp_f32 v73, v73
  v_exp_f32 v74, v74
  v_exp_f32 v75, v75
  v_sub_f32 v76, v76, v200
  v_mfma_f32_16x16x32_bf16 v[148:151], a[76:79], a[204:207], v[236:239]
  v_sub_f32 v77, v77, v200
  v_sub_f32 v78, v78, v200
  v_sub_f32 v79, v79, v200
  v_exp_f32 v76, v76
  v_exp_f32 v77, v77
  v_exp_f32 v78, v78
  v_exp_f32 v79, v79
  v_sub_f32 v80, v80, v200
  v_sub_f32 v81, v81, v200
  v_sub_f32 v82, v82, v200
  v_sub_f32 v83, v83, v200
  v_exp_f32 v80, v80
  v_exp_f32 v81, v81
  v_exp_f32 v82, v82
  v_exp_f32 v83, v83
  v_rcp_f32 v204, v196
  s_nop 0
  v_mul_f32 v206, v188, v204
  v_mul_f32 v207, v189, v204
  v_mul_f32 v208, v190, v204
  v_mul_f32 v209, v191, v204
  v_mul_f32 v210, v192, v204
  v_mul_f32 v211, v193, v204
  v_mul_f32 v212, v194, v204
  v_mul_f32 v213, v195, v204
  v_cvt_pk_bf16_f32 v220, v206, v207
  v_cvt_pk_bf16_f32 v221, v208, v209
  v_cvt_pk_bf16_f32 v222, v210, v211
  v_cvt_pk_bf16_f32 v223, v212, v213
  buffer_store_dwordx4 v[220:223], v1, s[32:35], s60 offen offset:1024 sc1
  v_mov_b32 v186, 0
  v_mov_b32 v187, 0
  v_cvt_pk_bf16_f32 v152, v16, v17
  v_cvt_pk_bf16_f32 v153, v18, v19
  v_cvt_pk_bf16_f32 v154, v20, v21
  v_cvt_pk_bf16_f32 v155, v22, v23
  v_cvt_pk_bf16_f32 v156, v24, v25
  v_cvt_pk_bf16_f32 v157, v26, v27
  v_cvt_pk_bf16_f32 v158, v28, v29
  v_cvt_pk_bf16_f32 v159, v30, v31
  v_cvt_pk_bf16_f32 v160, v32, v33
  v_cvt_pk_bf16_f32 v161, v34, v35
  v_cvt_pk_bf16_f32 v162, v36, v37
  v_cvt_pk_bf16_f32 v163, v38, v39
  v_cvt_pk_bf16_f32 v164, v40, v41
  v_cvt_pk_bf16_f32 v165, v42, v43
  v_cvt_pk_bf16_f32 v166, v44, v45
  v_cvt_pk_bf16_f32 v167, v46, v47
  v_cvt_pk_bf16_f32 v168, v48, v49
  v_cvt_pk_bf16_f32 v169, v50, v51
  v_cvt_pk_bf16_f32 v170, v52, v53
  v_cvt_pk_bf16_f32 v171, v54, v55
  v_cvt_pk_bf16_f32 v172, v56, v57
  v_cvt_pk_bf16_f32 v173, v58, v59
  v_cvt_pk_bf16_f32 v174, v60, v61
  v_cvt_pk_bf16_f32 v175, v62, v63
  v_cvt_pk_bf16_f32 v176, v64, v65
  v_cvt_pk_bf16_f32 v177, v66, v67
  v_cvt_pk_bf16_f32 v178, v68, v69
  v_cvt_pk_bf16_f32 v179, v70, v71
  v_cvt_pk_bf16_f32 v180, v72, v73
  v_cvt_pk_bf16_f32 v181, v74, v75
  v_cvt_pk_bf16_f32 v182, v76, v77
  v_cvt_pk_bf16_f32 v183, v78, v79
  v_cvt_pk_bf16_f32 v184, v80, v81
  v_cvt_pk_bf16_f32 v185, v82, v83
  v_max3_f32 v200, v84, v85, v86
  v_mfma_f32_16x16x32_bf16 v[188:191], a[104:107], v[152:155], 0
  v_max3_f32 v201, v118, v119, v120
  v_max3_f32 v200, v200, v87, v88
  v_max3_f32 v201, v201, v121, v122
  v_mfma_f32_16x16x32_bf16 v[192:195], a[108:111], v[152:155], 0
  v_max3_f32 v200, v200, v89, v90
  v_max3_f32 v201, v201, v123, v124
  v_max3_f32 v200, v200, v91, v92
  v_max3_f32 v201, v201, v125, v126
  v_mfma_f32_16x16x32_bf16 v[196:199], v[240:243], v[152:155], 0
  v_max3_f32 v200, v200, v93, v94
  v_max3_f32 v201, v201, v127, v128
  v_max3_f32 v200, v200, v95, v96
  v_max3_f32 v201, v201, v129, v130
  v_mfma_f32_16x16x32_bf16 v[188:191], a[112:115], v[156:159], v[188:191]
  v_max3_f32 v200, v200, v97, v98
  v_max3_f32 v201, v201, v131, v132
  v_max3_f32 v200, v200, v99, v100
  v_max3_f32 v201, v201, v133, v134
  v_mfma_f32_16x16x32_bf16 v[192:195], a[116:119], v[156:159], v[192:195]
  v_max3_f32 v200, v200, v101, v102
  v_max3_f32 v201, v201, v135, v136
  v_max3_f32 v200, v200, v103, v104
  v_max3_f32 v201, v201, v137, v138
  v_mfma_f32_16x16x32_bf16 v[196:199], v[240:243], v[156:159], v[196:199]
  v_max3_f32 v200, v200, v105, v106
  v_max3_f32 v201, v201, v139, v140
  v_max3_f32 v200, v200, v107, v108
  v_mfma_f32_16x16x32_bf16 v[188:191], a[120:123], v[160:163], v[188:191]
  v_max3_f32 v201, v201, v141, v142
  v_max3_f32 v200, v200, v109, v110
  v_max3_f32 v201, v201, v143, v144
  v_max3_f32 v200, v200, v111, v112
  v_mfma_f32_16x16x32_bf16 v[192:195], a[124:127], v[160:163], v[192:195]
  v_max3_f32 v201, v201, v145, v146
  v_max3_f32 v200, v200, v113, v114
  v_max3_f32 v201, v201, v147, v148
  v_max3_f32 v200, v200, v115, v116
  v_mfma_f32_16x16x32_bf16 v[196:199], v[240:243], v[160:163], v[196:199]
  v_max3_f32 v201, v201, v149, v150
  v_max3_f32 v200, v200, v117, v151
  v_max_f32 v200, v200, v201
  v_mov_b32 v202, v200
  v_mfma_f32_16x16x32_bf16 v[188:191], a[128:131], v[164:167], v[188:191]
  s_nop 1
  v_permlane32_swap_b32 v200, v202
  s_nop 0
  v_max_f32 v200, v200, v202
  v_mfma_f32_16x16x32_bf16 v[192:195], a[132:135], v[164:167], v[192:195]
  v_mov_b32 v202, v200
  s_nop 1
  v_permlane16_swap_b32 v200, v202
  s_nop 0
  v_mfma_f32_16x16x32_bf16 v[196:199], v[240:243], v[164:167], v[196:199]
  v_max_f32 v200, v200, v202
  v_sub_f32 v84, v84, v200
  v_sub_f32 v85, v85, v200
  v_mfma_f32_16x16x32_bf16 v[188:191], a[136:139], v[168:171], v[188:191]
  v_sub_f32 v86, v86, v200
  v_sub_f32 v87, v87, v200
  v_exp_f32 v84, v84
  v_exp_f32 v85, v85
  v_mfma_f32_16x16x32_bf16 v[192:195], a[140:143], v[168:171], v[192:195]
  v_exp_f32 v86, v86
  v_exp_f32 v87, v87
  v_sub_f32 v88, v88, v200
  v_sub_f32 v89, v89, v200
  v_mfma_f32_16x16x32_bf16 v[196:199], v[240:243], v[168:171], v[196:199]
  v_sub_f32 v90, v90, v200
  v_sub_f32 v91, v91, v200
  v_exp_f32 v88, v88
  v_exp_f32 v89, v89
  v_mfma_f32_16x16x32_bf16 v[188:191], a[144:147], v[172:175], v[188:191]
  v_exp_f32 v90, v90
  v_exp_f32 v91, v91
  v_sub_f32 v92, v92, v200
  v_sub_f32 v93, v93, v200
  v_mfma_f32_16x16x32_bf16 v[192:195], a[148:151], v[172:175], v[192:195]
  v_sub_f32 v94, v94, v200
  v_sub_f32 v95, v95, v200
  v_exp_f32 v92, v92
  v_mfma_f32_16x16x32_bf16 v[196:199], v[240:243], v[172:175], v[196:199]
  v_exp_f32 v93, v93
  v_exp_f32 v94, v94
  v_exp_f32 v95, v95
  v_sub_f32 v96, v96, v200
  v_mfma_f32_16x16x32_bf16 v[188:191], a[152:155], v[176:179], v[188:191]
  v_sub_f32 v97, v97, v200
  v_sub_f32 v98, v98, v200
  v_sub_f32 v99, v99, v200
  v_exp_f32 v96, v96
  v_mfma_f32_16x16x32_bf16 v[192:195], a[156:159], v[176:179], v[192:195]
  v_exp_f32 v97, v97
  v_exp_f32 v98, v98
  v_exp_f32 v99, v99
  v_sub_f32 v100, v100, v200
  v_mfma_f32_16x16x32_bf16 v[196:199], v[240:243], v[176:179], v[196:199]
  v_sub_f32 v101, v101, v200
  v_sub_f32 v102, v102, v200
  v_sub_f32 v103, v103, v200
  v_exp_f32 v100, v100
  v_mfma_f32_16x16x32_bf16 v[188:191], a[160:163], v[180:183], v[188:191]
  v_exp_f32 v101, v101
  v_exp_f32 v102, v102
  v_exp_f32 v103, v103
  v_sub_f32 v104, v104, v200
  v_mfma_f32_16x16x32_bf16 v[192:195], a[164:167], v[180:183], v[192:195]
  v_sub_f32 v105, v105, v200
  v_sub_f32 v106, v106, v200
  v_sub_f32 v107, v107, v200
  v_mfma_f32_16x16x32_bf16 v[196:199], v[240:243], v[180:183], v[196:199]
  v_exp_f32 v104, v104
  v_exp_f32 v105, v105
  v_exp_f32 v106, v106
  v_exp_f32 v107, v107
  v_mfma_f32_16x16x32_bf16 v[188:191], a[168:171], v[184:187], v[188:191]
  v_sub_f32 v108, v108, v200
  v_sub_f32 v109, v109, v200
  v_sub_f32 v110, v110, v200
  v_sub_f32 v111, v111, v200
  v_mfma_f32_16x16x32_bf16 v[192:195], a[172:175], v[184:187], v[192:195]
  v_exp_f32 v108, v108
  v_exp_f32 v109, v109
  v_exp_f32 v110, v110
  v_exp_f32 v111, v111
  v_mfma_f32_16x16x32_bf16 v[196:199], v[240:243], v[184:187], v[196:199]
  v_sub_f32 v112, v112, v200
  v_sub_f32 v113, v113, v200
  v_sub_f32 v114, v114, v200
  v_sub_f32 v115, v115, v200
  v_mfma_f32_16x16x32_bf16 v[16:19], a[16:19], a[208:211], v[232:235]
  v_exp_f32 v112, v112
  v_exp_f32 v113, v113
  v_exp_f32 v114, v114
  v_mfma_f32_16x16x32_bf16 v[20:23], a[20:23], a[208:211], v[224:227]
  v_exp_f32 v115, v115
  v_sub_f32 v116, v116, v200
  v_sub_f32 v117, v117, v200
  v_sub_f32 v118, v118, v200
  v_mfma_f32_16x16x32_bf16 v[24:27], a[24:27], a[208:211], v[224:227]
  v_sub_f32 v119, v119, v200
  v_exp_f32 v116, v116
  v_exp_f32 v117, v117
  v_exp_f32 v118, v118
  v_mfma_f32_16x16x32_bf16 v[28:31], a[28:31], a[208:211], v[224:227]
  v_exp_f32 v119, v119
  v_sub_f32 v120, v120, v200
  v_sub_f32 v121, v121, v200
  v_sub_f32 v122, v122, v200
  v_mfma_f32_16x16x32_bf16 v[32:35], a[32:35], a[208:211], v[228:231]
  v_sub_f32 v123, v123, v200
  v_exp_f32 v120, v120
  v_exp_f32 v121, v121
  v_exp_f32 v122, v122
  v_mfma_f32_16x16x32_bf16 v[36:39], a[36:39], a[208:211], v[228:231]
  v_exp_f32 v123, v123
  v_sub_f32 v124, v124, v200
  v_sub_f32 v125, v125, v200
  v_sub_f32 v126, v126, v200
  v_mfma_f32_16x16x32_bf16 v[40:43], a[40:43], a[208:211], v[228:231]
  v_sub_f32 v127, v127, v200
  v_exp_f32 v124, v124
  v_exp_f32 v125, v125
  v_mfma_f32_16x16x32_bf16 v[44:47], a[44:47], a[208:211], v[228:231]
  v_exp_f32 v126, v126
  v_exp_f32 v127, v127
  v_sub_f32 v128, v128, v200
  v_sub_f32 v129, v129, v200
  v_mfma_f32_16x16x32_bf16 v[48:51], a[48:51], a[208:211], v[228:231]
  v_sub_f32 v130, v130, v200
  v_sub_f32 v131, v131, v200
  v_exp_f32 v128, v128
  v_exp_f32 v129, v129
  v_mfma_f32_16x16x32_bf16 v[52:55], a[52:55], a[208:211], v[228:231]
  v_exp_f32 v130, v130
  v_exp_f32 v131, v131
  v_sub_f32 v132, v132, v200
  v_sub_f32 v133, v133, v200
  v_mfma_f32_16x16x32_bf16 v[56:59], a[56:59], a[208:211], v[228:231]
  v_sub_f32 v134, v134, v200
  v_sub_f32 v135, v135, v200
  v_exp_f32 v132, v132
  v_exp_f32 v133, v133
  v_mfma_f32_16x16x32_bf16 v[60:63], a[60:63], a[208:211], v[228:231]
  v_exp_f32 v134, v134
  v_exp_f32 v135, v135
  v_sub_f32 v136, v136, v200
  v_mfma_f32_16x16x32_bf16 v[64:67], a[64:67], a[208:211], 0
  v_sub_f32 v137, v137, v200
  v_sub_f32 v138, v138, v200
  v_sub_f32 v139, v139, v200
  v_exp_f32 v136, v136
  v_mfma_f32_16x16x32_bf16 v[68:71], a[68:71], a[208:211], 0
  v_exp_f32 v137, v137
  v_exp_f32 v138, v138
  v_exp_f32 v139, v139
  v_sub_f32 v140, v140, v200
  v_mfma_f32_16x16x32_bf16 v[72:75], a[72:75], a[208:211], 0
  v_sub_f32 v141, v141, v200
  v_sub_f32 v142, v142, v200
  v_sub_f32 v143, v143, v200
  v_exp_f32 v140, v140
  v_mfma_f32_16x16x32_bf16 v[76:79], a[76:79], a[208:211], 0
  v_exp_f32 v141, v141
  v_exp_f32 v142, v142
  v_exp_f32 v143, v143
  v_sub_f32 v144, v144, v200
  v_mfma_f32_16x16x32_bf16 v[80:83], a[80:83], a[208:211], v[236:239]
  v_sub_f32 v145, v145, v200
  v_sub_f32 v146, v146, v200
  v_sub_f32 v147, v147, v200
  v_exp_f32 v144, v144
  v_exp_f32 v145, v145
  v_exp_f32 v146, v146
  v_exp_f32 v147, v147
  v_sub_f32 v148, v148, v200
  v_sub_f32 v149, v149, v200
  v_sub_f32 v150, v150, v200
  v_sub_f32 v151, v151, v200
  v_exp_f32 v148, v148
  v_exp_f32 v149, v149
  v_exp_f32 v150, v150
  v_exp_f32 v151, v151
  v_rcp_f32 v204, v196
  s_nop 0
  v_mul_f32 v206, v188, v204
  v_mul_f32 v207, v189, v204
  v_mul_f32 v208, v190, v204
  v_mul_f32 v209, v191, v204
  v_mul_f32 v210, v192, v204
  v_mul_f32 v211, v193, v204
  v_mul_f32 v212, v194, v204
  v_mul_f32 v213, v195, v204
  v_cvt_pk_bf16_f32 v216, v206, v207
  v_cvt_pk_bf16_f32 v217, v208, v209
  v_cvt_pk_bf16_f32 v218, v210, v211
  v_cvt_pk_bf16_f32 v219, v212, v213
  buffer_store_dwordx4 v[216:219], v1, s[32:35], s60 offen offset:2048 sc1
  v_mov_b32 v152, 0
  v_mov_b32 v153, 0
  v_cvt_pk_bf16_f32 v154, v84, v85
  v_cvt_pk_bf16_f32 v155, v86, v87
  v_cvt_pk_bf16_f32 v156, v88, v89
  v_cvt_pk_bf16_f32 v157, v90, v91
  v_cvt_pk_bf16_f32 v158, v92, v93
  v_cvt_pk_bf16_f32 v159, v94, v95
  v_cvt_pk_bf16_f32 v160, v96, v97
  v_cvt_pk_bf16_f32 v161, v98, v99
  v_cvt_pk_bf16_f32 v162, v100, v101
  v_cvt_pk_bf16_f32 v163, v102, v103
  v_cvt_pk_bf16_f32 v164, v104, v105
  v_cvt_pk_bf16_f32 v165, v106, v107
  v_cvt_pk_bf16_f32 v166, v108, v109
  v_cvt_pk_bf16_f32 v167, v110, v111
  v_cvt_pk_bf16_f32 v168, v112, v113
  v_cvt_pk_bf16_f32 v169, v114, v115
  v_cvt_pk_bf16_f32 v170, v116, v117
  v_cvt_pk_bf16_f32 v171, v118, v119
  v_cvt_pk_bf16_f32 v172, v120, v121
  v_cvt_pk_bf16_f32 v173, v122, v123
  v_cvt_pk_bf16_f32 v174, v124, v125
  v_cvt_pk_bf16_f32 v175, v126, v127
  v_cvt_pk_bf16_f32 v176, v128, v129
  v_cvt_pk_bf16_f32 v177, v130, v131
  v_cvt_pk_bf16_f32 v178, v132, v133
  v_cvt_pk_bf16_f32 v179, v134, v135
  v_cvt_pk_bf16_f32 v180, v136, v137
  v_cvt_pk_bf16_f32 v181, v138, v139
  v_cvt_pk_bf16_f32 v182, v140, v141
  v_cvt_pk_bf16_f32 v183, v142, v143
  v_cvt_pk_bf16_f32 v184, v144, v145
  v_cvt_pk_bf16_f32 v185, v146, v147
  v_cvt_pk_bf16_f32 v186, v148, v149
  v_cvt_pk_bf16_f32 v187, v150, v151
  v_max3_f32 v200, v16, v17, v18
  v_mfma_f32_16x16x32_bf16 v[188:191], a[104:107], v[152:155], 0
  v_max3_f32 v201, v50, v51, v52
  v_max3_f32 v200, v200, v19, v20
  v_max3_f32 v201, v201, v53, v54
  v_mfma_f32_16x16x32_bf16 v[192:195], a[108:111], v[152:155], 0
  v_max3_f32 v200, v200, v21, v22
  v_max3_f32 v201, v201, v55, v56
  v_max3_f32 v200, v200, v23, v24
  v_max3_f32 v201, v201, v57, v58
  v_mfma_f32_16x16x32_bf16 v[196:199], v[240:243], v[152:155], 0
  v_max3_f32 v200, v200, v25, v26
  v_max3_f32 v201, v201, v59, v60
  v_max3_f32 v200, v200, v27, v28
  v_max3_f32 v201, v201, v61, v62
  v_mfma_f32_16x16x32_bf16 v[188:191], a[112:115], v[156:159], v[188:191]
  v_max3_f32 v200, v200, v29, v30
  v_max3_f32 v201, v201, v63, v64
  v_max3_f32 v200, v200, v31, v32
  v_max3_f32 v201, v201, v65, v66
  v_mfma_f32_16x16x32_bf16 v[192:195], a[116:119], v[156:159], v[192:195]
  v_max3_f32 v200, v200, v33, v34
  v_max3_f32 v201, v201, v67, v68
  v_max3_f32 v200, v200, v35, v36
  v_max3_f32 v201, v201, v69, v70
  v_mfma_f32_16x16x32_bf16 v[196:199], v[240:243], v[156:159], v[196:199]
  v_max3_f32 v200, v200, v37, v38
  v_max3_f32 v201, v201, v71, v72
  v_max3_f32 v200, v200, v39, v40
  v_mfma_f32_16x16x32_bf16 v[188:191], a[120:123], v[160:163], v[188:191]
  v_max3_f32 v201, v201, v73, v74
  v_max3_f32 v200, v200, v41, v42
  v_max3_f32 v201, v201, v75, v76
  v_max3_f32 v200, v200, v43, v44
  v_mfma_f32_16x16x32_bf16 v[192:195], a[124:127], v[160:163], v[192:195]
  v_max3_f32 v201, v201, v77, v78
  v_max3_f32 v200, v200, v45, v46
  v_max3_f32 v201, v201, v79, v80
  v_max3_f32 v200, v200, v47, v48
  v_mfma_f32_16x16x32_bf16 v[196:199], v[240:243], v[160:163], v[196:199]
  v_max3_f32 v201, v201, v81, v82
  v_max3_f32 v200, v200, v49, v83
  v_max_f32 v200, v200, v201
  v_mov_b32 v202, v200
  v_mfma_f32_16x16x32_bf16 v[188:191], a[128:131], v[164:167], v[188:191]
  s_nop 1
  v_permlane32_swap_b32 v200, v202
  s_nop 0
  v_max_f32 v200, v200, v202
  v_mfma_f32_16x16x32_bf16 v[192:195], a[132:135], v[164:167], v[192:195]
  v_mov_b32 v202, v200
  s_nop 1
  v_permlane16_swap_b32 v200, v202
  s_nop 0
  v_mfma_f32_16x16x32_bf16 v[196:199], v[240:243], v[164:167], v[196:199]
  v_max_f32 v200, v200, v202
  v_sub_f32 v16, v16, v200
  v_sub_f32 v17, v17, v200
  v_mfma_f32_16x16x32_bf16 v[188:191], a[136:139], v[168:171], v[188:191]
  v_sub_f32 v18, v18, v200
  v_sub_f32 v19, v19, v200
  v_exp_f32 v16, v16
  v_exp_f32 v17, v17
  v_mfma_f32_16x16x32_bf16 v[192:195], a[140:143], v[168:171], v[192:195]
  v_exp_f32 v18, v18
  v_exp_f32 v19, v19
  v_sub_f32 v20, v20, v200
  v_sub_f32 v21, v21, v200
  v_mfma_f32_16x16x32_bf16 v[196:199], v[240:243], v[168:171], v[196:199]
  v_sub_f32 v22, v22, v200
  v_sub_f32 v23, v23, v200
  v_exp_f32 v20, v20
  v_exp_f32 v21, v21
  v_mfma_f32_16x16x32_bf16 v[188:191], a[144:147], v[172:175], v[188:191]
  v_exp_f32 v22, v22
  v_exp_f32 v23, v23
  v_sub_f32 v24, v24, v200
  v_sub_f32 v25, v25, v200
  v_mfma_f32_16x16x32_bf16 v[192:195], a[148:151], v[172:175], v[192:195]
  v_sub_f32 v26, v26, v200
  v_sub_f32 v27, v27, v200
  v_exp_f32 v24, v24
  v_mfma_f32_16x16x32_bf16 v[196:199], v[240:243], v[172:175], v[196:199]
  v_exp_f32 v25, v25
  v_exp_f32 v26, v26
  v_exp_f32 v27, v27
  v_sub_f32 v28, v28, v200
  v_mfma_f32_16x16x32_bf16 v[188:191], a[152:155], v[176:179], v[188:191]
  v_sub_f32 v29, v29, v200
  v_sub_f32 v30, v30, v200
  v_sub_f32 v31, v31, v200
  v_exp_f32 v28, v28
  v_mfma_f32_16x16x32_bf16 v[192:195], a[156:159], v[176:179], v[192:195]
  v_exp_f32 v29, v29
  v_exp_f32 v30, v30
  v_exp_f32 v31, v31
  v_sub_f32 v32, v32, v200
  v_mfma_f32_16x16x32_bf16 v[196:199], v[240:243], v[176:179], v[196:199]
  v_sub_f32 v33, v33, v200
  v_sub_f32 v34, v34, v200
  v_sub_f32 v35, v35, v200
  v_exp_f32 v32, v32
  v_mfma_f32_16x16x32_bf16 v[188:191], a[160:163], v[180:183], v[188:191]
  v_exp_f32 v33, v33
  v_exp_f32 v34, v34
  v_exp_f32 v35, v35
  v_sub_f32 v36, v36, v200
  v_mfma_f32_16x16x32_bf16 v[192:195], a[164:167], v[180:183], v[192:195]
  v_sub_f32 v37, v37, v200
  v_sub_f32 v38, v38, v200
  v_sub_f32 v39, v39, v200
  v_mfma_f32_16x16x32_bf16 v[196:199], v[240:243], v[180:183], v[196:199]
  v_exp_f32 v36, v36
  v_exp_f32 v37, v37
  v_exp_f32 v38, v38
  v_exp_f32 v39, v39
  v_mfma_f32_16x16x32_bf16 v[188:191], a[168:171], v[184:187], v[188:191]
  v_sub_f32 v40, v40, v200
  v_sub_f32 v41, v41, v200
  v_sub_f32 v42, v42, v200
  v_sub_f32 v43, v43, v200
  v_mfma_f32_16x16x32_bf16 v[192:195], a[172:175], v[184:187], v[192:195]
  v_exp_f32 v40, v40
  v_exp_f32 v41, v41
  v_exp_f32 v42, v42
  v_exp_f32 v43, v43
  v_mfma_f32_16x16x32_bf16 v[196:199], v[240:243], v[184:187], v[196:199]
  v_sub_f32 v44, v44, v200
  v_sub_f32 v45, v45, v200
  v_sub_f32 v46, v46, v200
  v_sub_f32 v47, v47, v200
  v_mfma_f32_16x16x32_bf16 v[84:87], a[20:23], a[212:215], v[232:235]
  v_exp_f32 v44, v44
  v_exp_f32 v45, v45
  v_exp_f32 v46, v46
  v_mfma_f32_16x16x32_bf16 v[88:91], a[24:27], a[212:215], v[224:227]
  v_exp_f32 v47, v47
  v_sub_f32 v48, v48, v200
  v_sub_f32 v49, v49, v200
  v_sub_f32 v50, v50, v200
  v_mfma_f32_16x16x32_bf16 v[92:95], a[28:31], a[212:215], v[224:227]
  v_sub_f32 v51, v51, v200
  v_exp_f32 v48, v48
  v_exp_f32 v49, v49
  v_exp_f32 v50, v50
  v_mfma_f32_16x16x32_bf16 v[96:99], a[32:35], a[212:215], v[228:231]
  v_exp_f32 v51, v51
  v_sub_f32 v52, v52, v200
  v_sub_f32 v53, v53, v200
  v_sub_f32 v54, v54, v200
  v_mfma_f32_16x16x32_bf16 v[100:103], a[36:39], a[212:215], v[228:231]
  v_sub_f32 v55, v55, v200
  v_exp_f32 v52, v52
  v_exp_f32 v53, v53
  v_exp_f32 v54, v54
  v_mfma_f32_16x16x32_bf16 v[104:107], a[40:43], a[212:215], v[228:231]
  v_exp_f32 v55, v55
  v_sub_f32 v56, v56, v200
  v_sub_f32 v57, v57, v200
  v_sub_f32 v58, v58, v200
  v_mfma_f32_16x16x32_bf16 v[108:111], a[44:47], a[212:215], v[228:231]
  v_sub_f32 v59, v59, v200
  v_exp_f32 v56, v56
  v_exp_f32 v57, v57
  v_mfma_f32_16x16x32_bf16 v[112:115], a[48:51], a[212:215], v[228:231]
  v_exp_f32 v58, v58
  v_exp_f32 v59, v59
  v_sub_f32 v60, v60, v200
  v_sub_f32 v61, v61, v200
  v_mfma_f32_16x16x32_bf16 v[116:119], a[52:55], a[212:215], v[228:231]
  v_sub_f32 v62, v62, v200
  v_sub_f32 v63, v63, v200
  v_exp_f32 v60, v60
  v_exp_f32 v61, v61
  v_mfma_f32_16x16x32_bf16 v[120:123], a[56:59], a[212:215], v[228:231]
  v_exp_f32 v62, v62
  v_exp_f32 v63, v63
  v_sub_f32 v64, v64, v200
  v_sub_f32 v65, v65, v200
  v_mfma_f32_16x16x32_bf16 v[124:127], a[60:63], a[212:215], v[228:231]
  v_sub_f32 v66, v66, v200
  v_sub_f32 v67, v67, v200
  v_exp_f32 v64, v64
  v_exp_f32 v65, v65
  v_mfma_f32_16x16x32_bf16 v[128:131], a[64:67], a[212:215], 0
  v_exp_f32 v66, v66
  v_exp_f32 v67, v67
  v_sub_f32 v68, v68, v200
  v_mfma_f32_16x16x32_bf16 v[132:135], a[68:71], a[212:215], 0
  v_sub_f32 v69, v69, v200
  v_sub_f32 v70, v70, v200
  v_sub_f32 v71, v71, v200
  v_exp_f32 v68, v68
  v_mfma_f32_16x16x32_bf16 v[136:139], a[72:75], a[212:215], 0
  v_exp_f32 v69, v69
  v_exp_f32 v70, v70
  v_exp_f32 v71, v71
  v_sub_f32 v72, v72, v200
  v_mfma_f32_16x16x32_bf16 v[140:143], a[76:79], a[212:215], 0
  v_sub_f32 v73, v73, v200
  v_sub_f32 v74, v74, v200
  v_sub_f32 v75, v75, v200
  v_exp_f32 v72, v72
  v_mfma_f32_16x16x32_bf16 v[144:147], a[80:83], a[212:215], 0
  v_exp_f32 v73, v73
  v_exp_f32 v74, v74
  v_exp_f32 v75, v75
  v_sub_f32 v76, v76, v200
  v_mfma_f32_16x16x32_bf16 v[148:151], a[84:87], a[212:215], v[236:239]
  v_sub_f32 v77, v77, v200
  v_sub_f32 v78, v78, v200
  v_sub_f32 v79, v79, v200
  v_exp_f32 v76, v76
  v_exp_f32 v77, v77
  v_exp_f32 v78, v78
  v_exp_f32 v79, v79
  v_sub_f32 v80, v80, v200
  v_sub_f32 v81, v81, v200
  v_sub_f32 v82, v82, v200
  v_sub_f32 v83, v83, v200
  v_exp_f32 v80, v80
  v_exp_f32 v81, v81
  v_exp_f32 v82, v82
  v_exp_f32 v83, v83
  v_rcp_f32 v204, v196
  s_nop 0
  v_mul_f32 v206, v188, v204
  v_mul_f32 v207, v189, v204
  v_mul_f32 v208, v190, v204
  v_mul_f32 v209, v191, v204
  v_mul_f32 v210, v192, v204
  v_mul_f32 v211, v193, v204
  v_mul_f32 v212, v194, v204
  v_mul_f32 v213, v195, v204
  v_cvt_pk_bf16_f32 v220, v206, v207
  v_cvt_pk_bf16_f32 v221, v208, v209
  v_cvt_pk_bf16_f32 v222, v210, v211
  v_cvt_pk_bf16_f32 v223, v212, v213
  buffer_store_dwordx4 v[220:223], v1, s[32:35], s60 offen offset:3072 sc1
  v_mov_b32 v186, 0
  v_mov_b32 v187, 0
  v_cvt_pk_bf16_f32 v152, v16, v17
  v_cvt_pk_bf16_f32 v153, v18, v19
  v_cvt_pk_bf16_f32 v154, v20, v21
  v_cvt_pk_bf16_f32 v155, v22, v23
  v_cvt_pk_bf16_f32 v156, v24, v25
  v_cvt_pk_bf16_f32 v157, v26, v27
  v_cvt_pk_bf16_f32 v158, v28, v29
  v_cvt_pk_bf16_f32 v159, v30, v31
  v_cvt_pk_bf16_f32 v160, v32, v33
  v_cvt_pk_bf16_f32 v161, v34, v35
  v_cvt_pk_bf16_f32 v162, v36, v37
  v_cvt_pk_bf16_f32 v163, v38, v39
  v_cvt_pk_bf16_f32 v164, v40, v41
  v_cvt_pk_bf16_f32 v165, v42, v43
  v_cvt_pk_bf16_f32 v166, v44, v45
  v_cvt_pk_bf16_f32 v167, v46, v47
  v_cvt_pk_bf16_f32 v168, v48, v49
  v_cvt_pk_bf16_f32 v169, v50, v51
  v_cvt_pk_bf16_f32 v170, v52, v53
  v_cvt_pk_bf16_f32 v171, v54, v55
  v_cvt_pk_bf16_f32 v172, v56, v57
  v_cvt_pk_bf16_f32 v173, v58, v59
  v_cvt_pk_bf16_f32 v174, v60, v61
  v_cvt_pk_bf16_f32 v175, v62, v63
  v_cvt_pk_bf16_f32 v176, v64, v65
  v_cvt_pk_bf16_f32 v177, v66, v67
  v_cvt_pk_bf16_f32 v178, v68, v69
  v_cvt_pk_bf16_f32 v179, v70, v71
  v_cvt_pk_bf16_f32 v180, v72, v73
  v_cvt_pk_bf16_f32 v181, v74, v75
  v_cvt_pk_bf16_f32 v182, v76, v77
  v_cvt_pk_bf16_f32 v183, v78, v79
  v_cvt_pk_bf16_f32 v184, v80, v81
  v_cvt_pk_bf16_f32 v185, v82, v83
  v_max3_f32 v200, v84, v85, v86
  v_mfma_f32_16x16x32_bf16 v[188:191], a[112:115], v[152:155], 0
  v_max3_f32 v201, v118, v119, v120
  v_max3_f32 v200, v200, v87, v88
  v_max3_f32 v201, v201, v121, v122
  v_mfma_f32_16x16x32_bf16 v[192:195], a[116:119], v[152:155], 0
  v_max3_f32 v200, v200, v89, v90
  v_max3_f32 v201, v201, v123, v124
  v_max3_f32 v200, v200, v91, v92
  v_max3_f32 v201, v201, v125, v126
  v_mfma_f32_16x16x32_bf16 v[196:199], v[240:243], v[152:155], 0
  v_max3_f32 v200, v200, v93, v94
  v_max3_f32 v201, v201, v127, v128
  v_max3_f32 v200, v200, v95, v96
  v_max3_f32 v201, v201, v129, v130
  v_mfma_f32_16x16x32_bf16 v[188:191], a[120:123], v[156:159], v[188:191]
  v_max3_f32 v200, v200, v97, v98
  v_max3_f32 v201, v201, v131, v132
  v_max3_f32 v200, v200, v99, v100
  v_max3_f32 v201, v201, v133, v134
  v_mfma_f32_16x16x32_bf16 v[192:195], a[124:127], v[156:159], v[192:195]
  v_max3_f32 v200, v200, v101, v102
  v_max3_f32 v201, v201, v135, v136
  v_max3_f32 v200, v200, v103, v104
  v_max3_f32 v201, v201, v137, v138
  v_mfma_f32_16x16x32_bf16 v[196:199], v[240:243], v[156:159], v[196:199]
  v_max3_f32 v200, v200, v105, v106
  v_max3_f32 v201, v201, v139, v140
  v_max3_f32 v200, v200, v107, v108
  v_mfma_f32_16x16x32_bf16 v[188:191], a[128:131], v[160:163], v[188:191]
  v_max3_f32 v201, v201, v141, v142
  v_max3_f32 v200, v200, v109, v110
  v_max3_f32 v201, v201, v143, v144
  v_max3_f32 v200, v200, v111, v112
  v_mfma_f32_16x16x32_bf16 v[192:195], a[132:135], v[160:163], v[192:195]
  v_max3_f32 v201, v201, v145, v146
  v_max3_f32 v200, v200, v113, v114
  v_max3_f32 v201, v201, v147, v148
  v_max3_f32 v200, v200, v115, v116
  v_mfma_f32_16x16x32_bf16 v[196:199], v[240:243], v[160:163], v[196:199]
  v_max3_f32 v201, v201, v149, v150
  v_max3_f32 v200, v200, v117, v151
  v_max_f32 v200, v200, v201
  v_mov_b32 v202, v200
  v_mfma_f32_16x16x32_bf16 v[188:191], a[136:139], v[164:167], v[188:191]
  s_nop 1
  v_permlane32_swap_b32 v200, v202
  s_nop 0
  v_max_f32 v200, v200, v202
  v_mfma_f32_16x16x32_bf16 v[192:195], a[140:143], v[164:167], v[192:195]
  v_mov_b32 v202, v200
  s_nop 1
  v_permlane16_swap_b32 v200, v202
  s_nop 0
  v_mfma_f32_16x16x32_bf16 v[196:199], v[240:243], v[164:167], v[196:199]
  v_max_f32 v200, v200, v202
  v_sub_f32 v84, v84, v200
  v_sub_f32 v85, v85, v200
  v_mfma_f32_16x16x32_bf16 v[188:191], a[144:147], v[168:171], v[188:191]
  v_sub_f32 v86, v86, v200
  v_sub_f32 v87, v87, v200
  v_exp_f32 v84, v84
  v_exp_f32 v85, v85
  v_mfma_f32_16x16x32_bf16 v[192:195], a[148:151], v[168:171], v[192:195]
  v_exp_f32 v86, v86
  v_exp_f32 v87, v87
  v_sub_f32 v88, v88, v200
  v_sub_f32 v89, v89, v200
  v_mfma_f32_16x16x32_bf16 v[196:199], v[240:243], v[168:171], v[196:199]
  v_sub_f32 v90, v90, v200
  v_sub_f32 v91, v91, v200
  v_exp_f32 v88, v88
  v_exp_f32 v89, v89
  v_mfma_f32_16x16x32_bf16 v[188:191], a[152:155], v[172:175], v[188:191]
  v_exp_f32 v90, v90
  v_exp_f32 v91, v91
  v_sub_f32 v92, v92, v200
  v_sub_f32 v93, v93, v200
  v_mfma_f32_16x16x32_bf16 v[192:195], a[156:159], v[172:175], v[192:195]
  v_sub_f32 v94, v94, v200
  v_sub_f32 v95, v95, v200
  v_exp_f32 v92, v92
  v_mfma_f32_16x16x32_bf16 v[196:199], v[240:243], v[172:175], v[196:199]
  v_exp_f32 v93, v93
  v_exp_f32 v94, v94
  v_exp_f32 v95, v95
  v_sub_f32 v96, v96, v200
  v_mfma_f32_16x16x32_bf16 v[188:191], a[160:163], v[176:179], v[188:191]
  v_sub_f32 v97, v97, v200
  v_sub_f32 v98, v98, v200
  v_sub_f32 v99, v99, v200
  v_exp_f32 v96, v96
  v_mfma_f32_16x16x32_bf16 v[192:195], a[164:167], v[176:179], v[192:195]
  v_exp_f32 v97, v97
  v_exp_f32 v98, v98
  v_exp_f32 v99, v99
  v_sub_f32 v100, v100, v200
  v_mfma_f32_16x16x32_bf16 v[196:199], v[240:243], v[176:179], v[196:199]
  v_sub_f32 v101, v101, v200
  v_sub_f32 v102, v102, v200
  v_sub_f32 v103, v103, v200
  v_exp_f32 v100, v100
  v_mfma_f32_16x16x32_bf16 v[188:191], a[168:171], v[180:183], v[188:191]
  v_exp_f32 v101, v101
  v_exp_f32 v102, v102
  v_exp_f32 v103, v103
  v_sub_f32 v104, v104, v200
  v_mfma_f32_16x16x32_bf16 v[192:195], a[172:175], v[180:183], v[192:195]
  v_sub_f32 v105, v105, v200
  v_sub_f32 v106, v106, v200
  v_sub_f32 v107, v107, v200
  v_mfma_f32_16x16x32_bf16 v[196:199], v[240:243], v[180:183], v[196:199]
  v_exp_f32 v104, v104
  v_exp_f32 v105, v105
  v_exp_f32 v106, v106
  v_exp_f32 v107, v107
  v_mfma_f32_16x16x32_bf16 v[188:191], a[176:179], v[184:187], v[188:191]
  v_sub_f32 v108, v108, v200
  v_sub_f32 v109, v109, v200
  v_sub_f32 v110, v110, v200
  v_sub_f32 v111, v111, v200
  v_mfma_f32_16x16x32_bf16 v[192:195], a[180:183], v[184:187], v[192:195]
  v_exp_f32 v108, v108
  v_exp_f32 v109, v109
  v_exp_f32 v110, v110
  v_exp_f32 v111, v111
  v_mfma_f32_16x16x32_bf16 v[196:199], v[240:243], v[184:187], v[196:199]
  v_sub_f32 v112, v112, v200
  v_sub_f32 v113, v113, v200
  v_sub_f32 v114, v114, v200
  v_sub_f32 v115, v115, v200
  v_mfma_f32_16x16x32_bf16 v[16:19], a[24:27], a[216:219], v[232:235]
  v_exp_f32 v112, v112
  v_exp_f32 v113, v113
  v_exp_f32 v114, v114
  v_mfma_f32_16x16x32_bf16 v[20:23], a[28:31], a[216:219], v[224:227]
  v_exp_f32 v115, v115
  v_sub_f32 v116, v116, v200
  v_sub_f32 v117, v117, v200
  v_sub_f32 v118, v118, v200
  v_mfma_f32_16x16x32_bf16 v[24:27], a[32:35], a[216:219], v[228:231]
  v_sub_f32 v119, v119, v200
  v_exp_f32 v116, v116
  v_exp_f32 v117, v117
  v_exp_f32 v118, v118
  v_mfma_f32_16x16x32_bf16 v[28:31], a[36:39], a[216:219], v[228:231]
  v_exp_f32 v119, v119
  v_sub_f32 v120, v120, v200
  v_sub_f32 v121, v121, v200
  v_sub_f32 v122, v122, v200
  v_mfma_f32_16x16x32_bf16 v[32:35], a[40:43], a[216:219], v[228:231]
  v_sub_f32 v123, v123, v200
  v_exp_f32 v120, v120
  v_exp_f32 v121, v121
  v_exp_f32 v122, v122
  v_mfma_f32_16x16x32_bf16 v[36:39], a[44:47], a[216:219], v[228:231]
  v_exp_f32 v123, v123
  v_sub_f32 v124, v124, v200
  v_sub_f32 v125, v125, v200
  v_sub_f32 v126, v126, v200
  v_mfma_f32_16x16x32_bf16 v[40:43], a[48:51], a[216:219], v[228:231]
  v_sub_f32 v127, v127, v200
  v_exp_f32 v124, v124
  v_exp_f32 v125, v125
  v_mfma_f32_16x16x32_bf16 v[44:47], a[52:55], a[216:219], v[228:231]
  v_exp_f32 v126, v126
  v_exp_f32 v127, v127
  v_sub_f32 v128, v128, v200
  v_sub_f32 v129, v129, v200
  v_mfma_f32_16x16x32_bf16 v[48:51], a[56:59], a[216:219], v[228:231]
  v_sub_f32 v130, v130, v200
  v_sub_f32 v131, v131, v200
  v_exp_f32 v128, v128
  v_exp_f32 v129, v129
  v_mfma_f32_16x16x32_bf16 v[52:55], a[60:63], a[216:219], v[228:231]
  v_exp_f32 v130, v130
  v_exp_f32 v131, v131
  v_sub_f32 v132, v132, v200
  v_sub_f32 v133, v133, v200
  v_mfma_f32_16x16x32_bf16 v[56:59], a[64:67], a[216:219], 0
  v_sub_f32 v134, v134, v200
  v_sub_f32 v135, v135, v200
  v_exp_f32 v132, v132
  v_exp_f32 v133, v133
  v_mfma_f32_16x16x32_bf16 v[60:63], a[68:71], a[216:219], 0
  v_exp_f32 v134, v134
  v_exp_f32 v135, v135
  v_sub_f32 v136, v136, v200
  v_mfma_f32_16x16x32_bf16 v[64:67], a[72:75], a[216:219], 0
  v_sub_f32 v137, v137, v200
  v_sub_f32 v138, v138, v200
  v_sub_f32 v139, v139, v200
  v_exp_f32 v136, v136
  v_mfma_f32_16x16x32_bf16 v[68:71], a[76:79], a[216:219], 0
  v_exp_f32 v137, v137
  v_exp_f32 v138, v138
  v_exp_f32 v139, v139
  v_sub_f32 v140, v140, v200
  v_mfma_f32_16x16x32_bf16 v[72:75], a[80:83], a[216:219], 0
  v_sub_f32 v141, v141, v200
  v_sub_f32 v142, v142, v200
  v_sub_f32 v143, v143, v200
  v_exp_f32 v140, v140
  v_mfma_f32_16x16x32_bf16 v[76:79], a[84:87], a[216:219], 0
  v_exp_f32 v141, v141
  v_exp_f32 v142, v142
  v_exp_f32 v143, v143
  v_sub_f32 v144, v144, v200
  v_mfma_f32_16x16x32_bf16 v[80:83], a[88:91], a[216:219], v[236:239]
  v_sub_f32 v145, v145, v200
  v_sub_f32 v146, v146, v200
  v_sub_f32 v147, v147, v200
  v_exp_f32 v144, v144
  v_exp_f32 v145, v145
  v_exp_f32 v146, v146
  v_exp_f32 v147, v147
  v_sub_f32 v148, v148, v200
  v_sub_f32 v149, v149, v200
  v_sub_f32 v150, v150, v200
  v_sub_f32 v151, v151, v200
  v_exp_f32 v148, v148
  v_exp_f32 v149, v149
  v_exp_f32 v150, v150
  v_exp_f32 v151, v151
  v_rcp_f32 v204, v196
  s_nop 0
  v_mul_f32 v206, v188, v204
  v_mul_f32 v207, v189, v204
  v_mul_f32 v208, v190, v204
  v_mul_f32 v209, v191, v204
  v_mul_f32 v210, v192, v204
  v_mul_f32 v211, v193, v204
  v_mul_f32 v212, v194, v204
  v_mul_f32 v213, v195, v204
  v_cvt_pk_bf16_f32 v216, v206, v207
  v_cvt_pk_bf16_f32 v217, v208, v209
  v_cvt_pk_bf16_f32 v218, v210, v211
  v_cvt_pk_bf16_f32 v219, v212, v213
  buffer_store_dwordx4 v[216:219], v1, s[32:35], s61 offen offset:0 sc1
  v_mov_b32 v152, 0
  v_mov_b32 v153, 0
  v_cvt_pk_bf16_f32 v154, v84, v85
  v_cvt_pk_bf16_f32 v155, v86, v87
  v_cvt_pk_bf16_f32 v156, v88, v89
  v_cvt_pk_bf16_f32 v157, v90, v91
  v_cvt_pk_bf16_f32 v158, v92, v93
  v_cvt_pk_bf16_f32 v159, v94, v95
  v_cvt_pk_bf16_f32 v160, v96, v97
  v_cvt_pk_bf16_f32 v161, v98, v99
  v_cvt_pk_bf16_f32 v162, v100, v101
  v_cvt_pk_bf16_f32 v163, v102, v103
  v_cvt_pk_bf16_f32 v164, v104, v105
  v_cvt_pk_bf16_f32 v165, v106, v107
  v_cvt_pk_bf16_f32 v166, v108, v109
  v_cvt_pk_bf16_f32 v167, v110, v111
  v_cvt_pk_bf16_f32 v168, v112, v113
  v_cvt_pk_bf16_f32 v169, v114, v115
  v_cvt_pk_bf16_f32 v170, v116, v117
  v_cvt_pk_bf16_f32 v171, v118, v119
  v_cvt_pk_bf16_f32 v172, v120, v121
  v_cvt_pk_bf16_f32 v173, v122, v123
  v_cvt_pk_bf16_f32 v174, v124, v125
  v_cvt_pk_bf16_f32 v175, v126, v127
  v_cvt_pk_bf16_f32 v176, v128, v129
  v_cvt_pk_bf16_f32 v177, v130, v131
  v_cvt_pk_bf16_f32 v178, v132, v133
  v_cvt_pk_bf16_f32 v179, v134, v135
  v_cvt_pk_bf16_f32 v180, v136, v137
  v_cvt_pk_bf16_f32 v181, v138, v139
  v_cvt_pk_bf16_f32 v182, v140, v141
  v_cvt_pk_bf16_f32 v183, v142, v143
  v_cvt_pk_bf16_f32 v184, v144, v145
  v_cvt_pk_bf16_f32 v185, v146, v147
  v_cvt_pk_bf16_f32 v186, v148, v149
  v_cvt_pk_bf16_f32 v187, v150, v151
  v_max3_f32 v200, v16, v17, v18
  v_mfma_f32_16x16x32_bf16 v[188:191], a[112:115], v[152:155], 0
  v_max3_f32 v201, v50, v51, v52
  v_max3_f32 v200, v200, v19, v20
  v_max3_f32 v201, v201, v53, v54
  v_mfma_f32_16x16x32_bf16 v[192:195], a[116:119], v[152:155], 0
  v_max3_f32 v200, v200, v21, v22
  v_max3_f32 v201, v201, v55, v56
  v_max3_f32 v200, v200, v23, v24
  v_max3_f32 v201, v201, v57, v58
  v_mfma_f32_16x16x32_bf16 v[196:199], v[240:243], v[152:155], 0
  v_max3_f32 v200, v200, v25, v26
  v_max3_f32 v201, v201, v59, v60
  v_max3_f32 v200, v200, v27, v28
  v_max3_f32 v201, v201, v61, v62
  v_mfma_f32_16x16x32_bf16 v[188:191], a[120:123], v[156:159], v[188:191]
  v_max3_f32 v200, v200, v29, v30
  v_max3_f32 v201, v201, v63, v64
  v_max3_f32 v200, v200, v31, v32
  v_max3_f32 v201, v201, v65, v66
  v_mfma_f32_16x16x32_bf16 v[192:195], a[124:127], v[156:159], v[192:195]
  v_max3_f32 v200, v200, v33, v34
  v_max3_f32 v201, v201, v67, v68
  v_max3_f32 v200, v200, v35, v36
  v_max3_f32 v201, v201, v69, v70
  v_mfma_f32_16x16x32_bf16 v[196:199], v[240:243], v[156:159], v[196:199]
  v_max3_f32 v200, v200, v37, v38
  v_max3_f32 v201, v201, v71, v72
  v_max3_f32 v200, v200, v39, v40
  v_mfma_f32_16x16x32_bf16 v[188:191], a[128:131], v[160:163], v[188:191]
  v_max3_f32 v201, v201, v73, v74
  v_max3_f32 v200, v200, v41, v42
  v_max3_f32 v201, v201, v75, v76
  v_max3_f32 v200, v200, v43, v44
  v_mfma_f32_16x16x32_bf16 v[192:195], a[132:135], v[160:163], v[192:195]
  v_max3_f32 v201, v201, v77, v78
  v_max3_f32 v200, v200, v45, v46
  v_max3_f32 v201, v201, v79, v80
  v_max3_f32 v200, v200, v47, v48
  v_mfma_f32_16x16x32_bf16 v[196:199], v[240:243], v[160:163], v[196:199]
  v_max3_f32 v201, v201, v81, v82
  v_max3_f32 v200, v200, v49, v83
  v_max_f32 v200, v200, v201
  v_mov_b32 v202, v200
  v_mfma_f32_16x16x32_bf16 v[188:191], a[136:139], v[164:167], v[188:191]
  s_nop 1
  v_permlane32_swap_b32 v200, v202
  s_nop 0
  v_max_f32 v200, v200, v202
  v_mfma_f32_16x16x32_bf16 v[192:195], a[140:143], v[164:167], v[192:195]
  v_mov_b32 v202, v200
  s_nop 1
  v_permlane16_swap_b32 v200, v202
  s_nop 0
  v_mfma_f32_16x16x32_bf16 v[196:199], v[240:243], v[164:167], v[196:199]
  v_max_f32 v200, v200, v202
  v_sub_f32 v16, v16, v200
  v_sub_f32 v17, v17, v200
  v_mfma_f32_16x16x32_bf16 v[188:191], a[144:147], v[168:171], v[188:191]
  v_sub_f32 v18, v18, v200
  v_sub_f32 v19, v19, v200
  v_exp_f32 v16, v16
  v_exp_f32 v17, v17
  v_mfma_f32_16x16x32_bf16 v[192:195], a[148:151], v[168:171], v[192:195]
  v_exp_f32 v18, v18
  v_exp_f32 v19, v19
  v_sub_f32 v20, v20, v200
  v_sub_f32 v21, v21, v200
  v_mfma_f32_16x16x32_bf16 v[196:199], v[240:243], v[168:171], v[196:199]
  v_sub_f32 v22, v22, v200
  v_sub_f32 v23, v23, v200
  v_exp_f32 v20, v20
  v_exp_f32 v21, v21
  v_mfma_f32_16x16x32_bf16 v[188:191], a[152:155], v[172:175], v[188:191]
  v_exp_f32 v22, v22
  v_exp_f32 v23, v23
  v_sub_f32 v24, v24, v200
  v_sub_f32 v25, v25, v200
  v_mfma_f32_16x16x32_bf16 v[192:195], a[156:159], v[172:175], v[192:195]
  v_sub_f32 v26, v26, v200
  v_sub_f32 v27, v27, v200
  v_exp_f32 v24, v24
  v_mfma_f32_16x16x32_bf16 v[196:199], v[240:243], v[172:175], v[196:199]
  v_exp_f32 v25, v25
  v_exp_f32 v26, v26
  v_exp_f32 v27, v27
  v_sub_f32 v28, v28, v200
  v_mfma_f32_16x16x32_bf16 v[188:191], a[160:163], v[176:179], v[188:191]
  v_sub_f32 v29, v29, v200
  v_sub_f32 v30, v30, v200
  v_sub_f32 v31, v31, v200
  v_exp_f32 v28, v28
  v_mfma_f32_16x16x32_bf16 v[192:195], a[164:167], v[176:179], v[192:195]
  v_exp_f32 v29, v29
  v_exp_f32 v30, v30
  v_exp_f32 v31, v31
  v_sub_f32 v32, v32, v200
  v_mfma_f32_16x16x32_bf16 v[196:199], v[240:243], v[176:179], v[196:199]
  v_sub_f32 v33, v33, v200
  v_sub_f32 v34, v34, v200
  v_sub_f32 v35, v35, v200
  v_exp_f32 v32, v32
  v_mfma_f32_16x16x32_bf16 v[188:191], a[168:171], v[180:183], v[188:191]
  v_exp_f32 v33, v33
  v_exp_f32 v34, v34
  v_exp_f32 v35, v35
  v_sub_f32 v36, v36, v200
  v_mfma_f32_16x16x32_bf16 v[192:195], a[172:175], v[180:183], v[192:195]
  v_sub_f32 v37, v37, v200
  v_sub_f32 v38, v38, v200
  v_sub_f32 v39, v39, v200
  v_mfma_f32_16x16x32_bf16 v[196:199], v[240:243], v[180:183], v[196:199]
  v_exp_f32 v36, v36
  v_exp_f32 v37, v37
  v_exp_f32 v38, v38
  v_exp_f32 v39, v39
  v_mfma_f32_16x16x32_bf16 v[188:191], a[176:179], v[184:187], v[188:191]
  v_sub_f32 v40, v40, v200
  v_sub_f32 v41, v41, v200
  v_sub_f32 v42, v42, v200
  v_sub_f32 v43, v43, v200
  v_mfma_f32_16x16x32_bf16 v[192:195], a[180:183], v[184:187], v[192:195]
  v_exp_f32 v40, v40
  v_exp_f32 v41, v41
  v_exp_f32 v42, v42
  v_exp_f32 v43, v43
  v_mfma_f32_16x16x32_bf16 v[196:199], v[240:243], v[184:187], v[196:199]
  v_sub_f32 v44, v44, v200
  v_sub_f32 v45, v45, v200
  v_sub_f32 v46, v46, v200
  v_sub_f32 v47, v47, v200
  v_mfma_f32_16x16x32_bf16 v[84:87], a[28:31], a[220:223], v[232:235]
  v_exp_f32 v44, v44
  v_exp_f32 v45, v45
  v_exp_f32 v46, v46
  v_mfma_f32_16x16x32_bf16 v[88:91], a[32:35], a[220:223], v[228:231]
  v_exp_f32 v47, v47
  v_sub_f32 v48, v48, v200
  v_sub_f32 v49, v49, v200
  v_sub_f32 v50, v50, v200
  v_mfma_f32_16x16x32_bf16 v[92:95], a[36:39], a[220:223], v[228:231]
  v_sub_f32 v51, v51, v200
  v_exp_f32 v48, v48
  v_exp_f32 v49, v49
  v_exp_f32 v50, v50
  v_mfma_f32_16x16x32_bf16 v[96:99], a[40:43], a[220:223], v[228:231]
  v_exp_f32 v51, v51
  v_sub_f32 v52, v52, v200
  v_sub_f32 v53, v53, v200
  v_sub_f32 v54, v54, v200
  v_mfma_f32_16x16x32_bf16 v[100:103], a[44:47], a[220:223], v[228:231]
  v_sub_f32 v55, v55, v200
  v_exp_f32 v52, v52
  v_exp_f32 v53, v53
  v_exp_f32 v54, v54
  v_mfma_f32_16x16x32_bf16 v[104:107], a[48:51], a[220:223], v[228:231]
  v_exp_f32 v55, v55
  v_sub_f32 v56, v56, v200
  v_sub_f32 v57, v57, v200
  v_sub_f32 v58, v58, v200
  v_mfma_f32_16x16x32_bf16 v[108:111], a[52:55], a[220:223], v[228:231]
  v_sub_f32 v59, v59, v200
  v_exp_f32 v56, v56
  v_exp_f32 v57, v57
  v_mfma_f32_16x16x32_bf16 v[112:115], a[56:59], a[220:223], v[228:231]
  v_exp_f32 v58, v58
  v_exp_f32 v59, v59
  v_sub_f32 v60, v60, v200
  v_sub_f32 v61, v61, v200
  v_mfma_f32_16x16x32_bf16 v[116:119], a[60:63], a[220:223], v[228:231]
  v_sub_f32 v62, v62, v200
  v_sub_f32 v63, v63, v200
  v_exp_f32 v60, v60
  v_exp_f32 v61, v61
  v_mfma_f32_16x16x32_bf16 v[120:123], a[64:67], a[220:223], 0
  v_exp_f32 v62, v62
  v_exp_f32 v63, v63
  v_sub_f32 v64, v64, v200
  v_sub_f32 v65, v65, v200
  v_mfma_f32_16x16x32_bf16 v[124:127], a[68:71], a[220:223], 0
  v_sub_f32 v66, v66, v200
  v_sub_f32 v67, v67, v200
  v_exp_f32 v64, v64
  v_exp_f32 v65, v65
  v_mfma_f32_16x16x32_bf16 v[128:131], a[72:75], a[220:223], 0
  v_exp_f32 v66, v66
  v_exp_f32 v67, v67
  v_sub_f32 v68, v68, v200
  v_mfma_f32_16x16x32_bf16 v[132:135], a[76:79], a[220:223], 0
  v_sub_f32 v69, v69, v200
  v_sub_f32 v70, v70, v200
  v_sub_f32 v71, v71, v200
  v_exp_f32 v68, v68
  v_mfma_f32_16x16x32_bf16 v[136:139], a[80:83], a[220:223], 0
  v_exp_f32 v69, v69
  v_exp_f32 v70, v70
  v_exp_f32 v71, v71
  v_sub_f32 v72, v72, v200
  v_mfma_f32_16x16x32_bf16 v[140:143], a[84:87], a[220:223], 0
  v_sub_f32 v73, v73, v200
  v_sub_f32 v74, v74, v200
  v_sub_f32 v75, v75, v200
  v_exp_f32 v72, v72
  v_mfma_f32_16x16x32_bf16 v[144:147], a[88:91], a[220:223], 0
  v_exp_f32 v73, v73
  v_exp_f32 v74, v74
  v_exp_f32 v75, v75
  v_sub_f32 v76, v76, v200
  v_mfma_f32_16x16x32_bf16 v[148:151], a[92:95], a[220:223], v[236:239]
  v_sub_f32 v77, v77, v200
  v_sub_f32 v78, v78, v200
  v_sub_f32 v79, v79, v200
  v_exp_f32 v76, v76
  v_exp_f32 v77, v77
  v_exp_f32 v78, v78
  v_exp_f32 v79, v79
  v_sub_f32 v80, v80, v200
  v_sub_f32 v81, v81, v200
  v_sub_f32 v82, v82, v200
  v_sub_f32 v83, v83, v200
  v_exp_f32 v80, v80
  v_exp_f32 v81, v81
  v_exp_f32 v82, v82
  v_exp_f32 v83, v83
  v_rcp_f32 v204, v196
  s_nop 0
  v_mul_f32 v206, v188, v204
  v_mul_f32 v207, v189, v204
  v_mul_f32 v208, v190, v204
  v_mul_f32 v209, v191, v204
  v_mul_f32 v210, v192, v204
  v_mul_f32 v211, v193, v204
  v_mul_f32 v212, v194, v204
  v_mul_f32 v213, v195, v204
  v_cvt_pk_bf16_f32 v220, v206, v207
  v_cvt_pk_bf16_f32 v221, v208, v209
  v_cvt_pk_bf16_f32 v222, v210, v211
  v_cvt_pk_bf16_f32 v223, v212, v213
  buffer_store_dwordx4 v[220:223], v1, s[32:35], s61 offen offset:1024 sc1
  v_mov_b32 v186, 0
  v_mov_b32 v187, 0
  v_cvt_pk_bf16_f32 v152, v16, v17
  v_cvt_pk_bf16_f32 v153, v18, v19
  v_cvt_pk_bf16_f32 v154, v20, v21
  v_cvt_pk_bf16_f32 v155, v22, v23
  v_cvt_pk_bf16_f32 v156, v24, v25
  v_cvt_pk_bf16_f32 v157, v26, v27
  v_cvt_pk_bf16_f32 v158, v28, v29
  v_cvt_pk_bf16_f32 v159, v30, v31
  v_cvt_pk_bf16_f32 v160, v32, v33
  v_cvt_pk_bf16_f32 v161, v34, v35
  v_cvt_pk_bf16_f32 v162, v36, v37
  v_cvt_pk_bf16_f32 v163, v38, v39
  v_cvt_pk_bf16_f32 v164, v40, v41
  v_cvt_pk_bf16_f32 v165, v42, v43
  v_cvt_pk_bf16_f32 v166, v44, v45
  v_cvt_pk_bf16_f32 v167, v46, v47
  v_cvt_pk_bf16_f32 v168, v48, v49
  v_cvt_pk_bf16_f32 v169, v50, v51
  v_cvt_pk_bf16_f32 v170, v52, v53
  v_cvt_pk_bf16_f32 v171, v54, v55
  v_cvt_pk_bf16_f32 v172, v56, v57
  v_cvt_pk_bf16_f32 v173, v58, v59
  v_cvt_pk_bf16_f32 v174, v60, v61
  v_cvt_pk_bf16_f32 v175, v62, v63
  v_cvt_pk_bf16_f32 v176, v64, v65
  v_cvt_pk_bf16_f32 v177, v66, v67
  v_cvt_pk_bf16_f32 v178, v68, v69
  v_cvt_pk_bf16_f32 v179, v70, v71
  v_cvt_pk_bf16_f32 v180, v72, v73
  v_cvt_pk_bf16_f32 v181, v74, v75
  v_cvt_pk_bf16_f32 v182, v76, v77
  v_cvt_pk_bf16_f32 v183, v78, v79
  v_cvt_pk_bf16_f32 v184, v80, v81
  v_cvt_pk_bf16_f32 v185, v82, v83
  v_max3_f32 v200, v84, v85, v86
  v_mfma_f32_16x16x32_bf16 v[188:191], a[120:123], v[152:155], 0
  v_max3_f32 v201, v118, v119, v120
  v_max3_f32 v200, v200, v87, v88
  v_max3_f32 v201, v201, v121, v122
  v_max3_f32 v200, v200, v89, v90
  v_max3_f32 v201, v201, v123, v124
  v_max3_f32 v200, v200, v91, v92
  v_mfma_f32_16x16x32_bf16 v[192:195], a[124:127], v[152:155], 0
  v_max3_f32 v201, v201, v125, v126
  v_max3_f32 v200, v200, v93, v94
  v_max3_f32 v201, v201, v127, v128
  v_max3_f32 v200, v200, v95, v96
  v_max3_f32 v201, v201, v129, v130
  v_max3_f32 v200, v200, v97, v98
  v_mfma_f32_16x16x32_bf16 v[196:199], v[240:243], v[152:155], 0
  v_max3_f32 v201, v201, v131, v132
  v_max3_f32 v200, v200, v99, v100
  v_max3_f32 v201, v201, v133, v134
  v_max3_f32 v200, v200, v101, v102
  v_max3_f32 v201, v201, v135, v136
  v_max3_f32 v200, v200, v103, v104
  v_mfma_f32_16x16x32_bf16 v[188:191], a[128:131], v[156:159], v[188:191]
  v_max3_f32 v201, v201, v137, v138
  v_max3_f32 v200, v200, v105, v106
  v_max3_f32 v201, v201, v139, v140
  v_max3_f32 v200, v200, v107, v108
  v_max3_f32 v201, v201, v141, v142
  v_max3_f32 v200, v200, v109, v110
  v_mfma_f32_16x16x32_bf16 v[192:195], a[132:135], v[156:159], v[192:195]
  v_max3_f32 v201, v201, v143, v144
  v_max3_f32 v200, v200, v111, v112
  v_max3_f32 v201, v201, v145, v146
  v_max3_f32 v200, v200, v113, v114
  v_max3_f32 v201, v201, v147, v148
  v_max3_f32 v200, v200, v115, v116
  v_max3_f32 v201, v201, v149, v150
  v_mfma_f32_16x16x32_bf16 v[196:199], v[240:243], v[156:159], v[196:199]
  v_max3_f32 v200, v200, v117, v151
  v_max_f32 v200, v200, v201
  v_mov_b32 v202, v200
  s_nop 1
  v_permlane32_swap_b32 v200, v202
  s_nop 0
  v_mfma_f32_16x16x32_bf16 v[188:191], a[136:139], v[160:163], v[188:191]
  v_max_f32 v200, v200, v202
  v_mov_b32 v202, v200
  s_nop 1
  v_permlane16_swap_b32 v200, v202
  s_nop 0
  v_max_f32 v200, v200, v202
  v_mfma_f32_16x16x32_bf16 v[192:195], a[140:143], v[160:163], v[192:195]
  v_sub_f32 v84, v84, v200
  v_sub_f32 v85, v85, v200
  v_sub_f32 v86, v86, v200
  v_sub_f32 v87, v87, v200
  v_exp_f32 v84, v84
  v_exp_f32 v85, v85
  v_mfma_f32_16x16x32_bf16 v[196:199], v[240:243], v[160:163], v[196:199]
  v_exp_f32 v86, v86
  v_exp_f32 v87, v87
  v_sub_f32 v88, v88, v200
  v_sub_f32 v89, v89, v200
  v_sub_f32 v90, v90, v200
  v_sub_f32 v91, v91, v200
  v_exp_f32 v88, v88
  v_mfma_f32_16x16x32_bf16 v[188:191], a[144:147], v[164:167], v[188:191]
  v_exp_f32 v89, v89
  v_exp_f32 v90, v90
  v_exp_f32 v91, v91
  v_sub_f32 v92, v92, v200
  v_sub_f32 v93, v93, v200
  v_sub_f32 v94, v94, v200
  v_mfma_f32_16x16x32_bf16 v[192:195], a[148:151], v[164:167], v[192:195]
  v_sub_f32 v95, v95, v200
  v_exp_f32 v92, v92
  v_exp_f32 v93, v93
  v_exp_f32 v94, v94
  v_exp_f32 v95, v95
  v_sub_f32 v96, v96, v200
  v_mfma_f32_16x16x32_bf16 v[196:199], v[240:243], v[164:167], v[196:199]
  v_sub_f32 v97, v97, v200
  v_sub_f32 v98, v98, v200
  v_sub_f32 v99, v99, v200
  v_exp_f32 v96, v96
  v_exp_f32 v97, v97
  v_exp_f32 v98, v98
  v_mfma_f32_16x16x32_bf16 v[188:191], a[152:155], v[168:171], v[188:191]
  v_exp_f32 v99, v99
  v_sub_f32 v100, v100, v200
  v_sub_f32 v101, v101, v200
  v_sub_f32 v102, v102, v200
  v_sub_f32 v103, v103, v200
  v_exp_f32 v100, v100
  v_mfma_f32_16x16x32_bf16 v[192:195], a[156:159], v[168:171], v[192:195]
  v_exp_f32 v101, v101
  v_exp_f32 v102, v102
  v_exp_f32 v103, v103
  v_sub_f32 v104, v104, v200
  v_sub_f32 v105, v105, v200
  v_sub_f32 v106, v106, v200
  v_sub_f32 v107, v107, v200
  v_mfma_f32_16x16x32_bf16 v[196:199], v[240:243], v[168:171], v[196:199]
  v_exp_f32 v104, v104
  v_exp_f32 v105, v105
  v_exp_f32 v106, v106
  v_exp_f32 v107, v107
  v_sub_f32 v108, v108, v200
  v_sub_f32 v109, v109, v200
  v_mfma_f32_16x16x32_bf16 v[188:191], a[160:163], v[172:175], v[188:191]
  v_sub_f32 v110, v110, v200
  v_sub_f32 v111, v111, v200
  v_exp_f32 v108, v108
  v_exp_f32 v109, v109
  v_exp_f32 v110, v110
  v_exp_f32 v111, v111
  v_mfma_f32_16x16x32_bf16 v[192:195], a[164:167], v[172:175], v[192:195]
  v_sub_f32 v112, v112, v200
  v_sub_f32 v113, v113, v200
  v_sub_f32 v114, v114, v200
  v_sub_f32 v115, v115, v200
  v_exp_f32 v112, v112
  v_exp_f32 v113, v113
  v_mfma_f32_16x16x32_bf16 v[196:199], v[240:243], v[172:175], v[196:199]
  v_exp_f32 v114, v114
  v_exp_f32 v115, v115
  v_sub_f32 v116, v116, v200
  v_sub_f32 v117, v117, v200
  v_sub_f32 v118, v118, v200
  v_sub_f32 v119, v119, v200
  v_exp_f32 v116, v116
  v_mfma_f32_16x16x32_bf16 v[188:191], a[168:171], v[176:179], v[188:191]
  v_exp_f32 v117, v117
  v_exp_f32 v118, v118
  v_exp_f32 v119, v119
  v_sub_f32 v120, v120, v200
  v_sub_f32 v121, v121, v200
  v_sub_f32 v122, v122, v200
  v_mfma_f32_16x16x32_bf16 v[192:195], a[172:175], v[176:179], v[192:195]
  v_sub_f32 v123, v123, v200
  v_exp_f32 v120, v120
  v_exp_f32 v121, v121
  v_exp_f32 v122, v122
  v_exp_f32 v123, v123
  v_sub_f32 v124, v124, v200
  v_mfma_f32_16x16x32_bf16 v[196:199], v[240:243], v[176:179], v[196:199]
  v_sub_f32 v125, v125, v200
  v_sub_f32 v126, v126, v200
  v_sub_f32 v127, v127, v200
  v_exp_f32 v124, v124
  v_exp_f32 v125, v125
  v_exp_f32 v126, v126
  v_mfma_f32_16x16x32_bf16 v[188:191], a[176:179], v[180:183], v[188:191]
  v_exp_f32 v127, v127
  v_sub_f32 v128, v128, v200
  v_sub_f32 v129, v129, v200
  v_sub_f32 v130, v130, v200
  v_sub_f32 v131, v131, v200
  v_exp_f32 v128, v128
  v_mfma_f32_16x16x32_bf16 v[192:195], a[180:183], v[180:183], v[192:195]
  v_exp_f32 v129, v129
  v_exp_f32 v130, v130
  v_exp_f32 v131, v131
  v_sub_f32 v132, v132, v200
  v_sub_f32 v133, v133, v200
  v_sub_f32 v134, v134, v200
  v_sub_f32 v135, v135, v200
  v_mfma_f32_16x16x32_bf16 v[196:199], v[240:243], v[180:183], v[196:199]
  v_exp_f32 v132, v132
  v_exp_f32 v133, v133
  v_exp_f32 v134, v134
  v_exp_f32 v135, v135
  v_sub_f32 v136, v136, v200
  v_sub_f32 v137, v137, v200
  v_mfma_f32_16x16x32_bf16 v[188:191], a[184:187], v[184:187], v[188:191]
  v_sub_f32 v138, v138, v200
  v_sub_f32 v139, v139, v200
  v_exp_f32 v136, v136
  v_exp_f32 v137, v137
  v_exp_f32 v138, v138
  v_exp_f32 v139, v139
  v_mfma_f32_16x16x32_bf16 v[192:195], a[188:191], v[184:187], v[192:195]
  v_sub_f32 v140, v140, v200
  v_sub_f32 v141, v141, v200
  v_sub_f32 v142, v142, v200
  v_sub_f32 v143, v143, v200
  v_exp_f32 v140, v140
  v_exp_f32 v141, v141
  v_mfma_f32_16x16x32_bf16 v[196:199], v[240:243], v[184:187], v[196:199]
  v_exp_f32 v142, v142
  v_exp_f32 v143, v143
  v_sub_f32 v144, v144, v200
  v_sub_f32 v145, v145, v200
  v_sub_f32 v146, v146, v200
  v_sub_f32 v147, v147, v200
  v_exp_f32 v144, v144
  v_exp_f32 v145, v145
  v_exp_f32 v146, v146
  v_exp_f32 v147, v147
  v_sub_f32 v148, v148, v200
  v_sub_f32 v149, v149, v200
  v_sub_f32 v150, v150, v200
  v_sub_f32 v151, v151, v200
  v_exp_f32 v148, v148
  v_exp_f32 v149, v149
  v_exp_f32 v150, v150
  v_exp_f32 v151, v151
  v_rcp_f32 v204, v196
  s_nop 0
  v_mul_f32 v206, v188, v204
  v_mul_f32 v207, v189, v204
  v_mul_f32 v208, v190, v204
  v_mul_f32 v209, v191, v204
  v_mul_f32 v210, v192, v204
  v_mul_f32 v211, v193, v204
  v_mul_f32 v212, v194, v204
  v_mul_f32 v213, v195, v204
  v_cvt_pk_bf16_f32 v216, v206, v207
  v_cvt_pk_bf16_f32 v217, v208, v209
  v_cvt_pk_bf16_f32 v218, v210, v211
  v_cvt_pk_bf16_f32 v219, v212, v213
  buffer_store_dwordx4 v[216:219], v1, s[32:35], s61 offen offset:2048 sc1
  v_mov_b32 v152, 0
  v_mov_b32 v153, 0
  v_cvt_pk_bf16_f32 v154, v84, v85
  v_cvt_pk_bf16_f32 v155, v86, v87
  v_cvt_pk_bf16_f32 v156, v88, v89
  v_cvt_pk_bf16_f32 v157, v90, v91
  v_cvt_pk_bf16_f32 v158, v92, v93
  v_cvt_pk_bf16_f32 v159, v94, v95
  v_cvt_pk_bf16_f32 v160, v96, v97
  v_cvt_pk_bf16_f32 v161, v98, v99
  v_cvt_pk_bf16_f32 v162, v100, v101
  v_cvt_pk_bf16_f32 v163, v102, v103
  v_cvt_pk_bf16_f32 v164, v104, v105
  v_cvt_pk_bf16_f32 v165, v106, v107
  v_cvt_pk_bf16_f32 v166, v108, v109
  v_cvt_pk_bf16_f32 v167, v110, v111
  v_cvt_pk_bf16_f32 v168, v112, v113
  v_cvt_pk_bf16_f32 v169, v114, v115
  v_cvt_pk_bf16_f32 v170, v116, v117
  v_cvt_pk_bf16_f32 v171, v118, v119
  v_cvt_pk_bf16_f32 v172, v120, v121
  v_cvt_pk_bf16_f32 v173, v122, v123
  v_cvt_pk_bf16_f32 v174, v124, v125
  v_cvt_pk_bf16_f32 v175, v126, v127
  v_cvt_pk_bf16_f32 v176, v128, v129
  v_cvt_pk_bf16_f32 v177, v130, v131
  v_cvt_pk_bf16_f32 v178, v132, v133
  v_cvt_pk_bf16_f32 v179, v134, v135
  v_cvt_pk_bf16_f32 v180, v136, v137
  v_cvt_pk_bf16_f32 v181, v138, v139
  v_cvt_pk_bf16_f32 v182, v140, v141
  v_cvt_pk_bf16_f32 v183, v142, v143
  v_cvt_pk_bf16_f32 v184, v144, v145
  v_cvt_pk_bf16_f32 v185, v146, v147
  v_cvt_pk_bf16_f32 v186, v148, v149
  v_cvt_pk_bf16_f32 v187, v150, v151
  s_nop 1
  v_mfma_f32_16x16x32_bf16 v[188:191], a[120:123], v[152:155], 0
  v_mfma_f32_16x16x32_bf16 v[192:195], a[124:127], v[152:155], 0
  v_mfma_f32_16x16x32_bf16 v[196:199], v[240:243], v[152:155], 0
  v_mfma_f32_16x16x32_bf16 v[188:191], a[128:131], v[156:159], v[188:191]
  v_mfma_f32_16x16x32_bf16 v[192:195], a[132:135], v[156:159], v[192:195]
  v_mfma_f32_16x16x32_bf16 v[196:199], v[240:243], v[156:159], v[196:199]
  v_mfma_f32_16x16x32_bf16 v[188:191], a[136:139], v[160:163], v[188:191]
  v_mfma_f32_16x16x32_bf16 v[192:195], a[140:143], v[160:163], v[192:195]
  v_mfma_f32_16x16x32_bf16 v[196:199], v[240:243], v[160:163], v[196:199]
  v_mfma_f32_16x16x32_bf16 v[188:191], a[144:147], v[164:167], v[188:191]
  v_mfma_f32_16x16x32_bf16 v[192:195], a[148:151], v[164:167], v[192:195]
  v_mfma_f32_16x16x32_bf16 v[196:199], v[240:243], v[164:167], v[196:199]
  v_mfma_f32_16x16x32_bf16 v[188:191], a[152:155], v[168:171], v[188:191]
  v_mfma_f32_16x16x32_bf16 v[192:195], a[156:159], v[168:171], v[192:195]
  v_mfma_f32_16x16x32_bf16 v[196:199], v[240:243], v[168:171], v[196:199]
  v_mfma_f32_16x16x32_bf16 v[188:191], a[160:163], v[172:175], v[188:191]
  v_mfma_f32_16x16x32_bf16 v[192:195], a[164:167], v[172:175], v[192:195]
  v_mfma_f32_16x16x32_bf16 v[196:199], v[240:243], v[172:175], v[196:199]
  v_mfma_f32_16x16x32_bf16 v[188:191], a[168:171], v[176:179], v[188:191]
  v_mfma_f32_16x16x32_bf16 v[192:195], a[172:175], v[176:179], v[192:195]
  v_mfma_f32_16x16x32_bf16 v[196:199], v[240:243], v[176:179], v[196:199]
  v_mfma_f32_16x16x32_bf16 v[188:191], a[176:179], v[180:183], v[188:191]
  v_mfma_f32_16x16x32_bf16 v[192:195], a[180:183], v[180:183], v[192:195]
  v_mfma_f32_16x16x32_bf16 v[196:199], v[240:243], v[180:183], v[196:199]
  v_mfma_f32_16x16x32_bf16 v[188:191], a[184:187], v[184:187], v[188:191]
  v_mfma_f32_16x16x32_bf16 v[192:195], a[188:191], v[184:187], v[192:195]
  v_mfma_f32_16x16x32_bf16 v[196:199], v[240:243], v[184:187], v[196:199]
  s_nop 7
  v_rcp_f32 v204, v196
  s_nop 0
  v_mul_f32 v206, v188, v204
  v_mul_f32 v207, v189, v204
  v_mul_f32 v208, v190, v204
  v_mul_f32 v209, v191, v204
  v_mul_f32 v210, v192, v204
  v_mul_f32 v211, v193, v204
  v_mul_f32 v212, v194, v204
  v_mul_f32 v213, v195, v204
  v_cvt_pk_bf16_f32 v220, v206, v207
  v_cvt_pk_bf16_f32 v221, v208, v209
  v_cvt_pk_bf16_f32 v222, v210, v211
  v_cvt_pk_bf16_f32 v223, v212, v213
  buffer_store_dwordx4 v[220:223], v1, s[32:35], s61 offen offset:3072 sc1
  s_waitcnt vmcnt(0)
  s_barrier
  s_cmp_eq_u32 s40, 0
  s_cbranch_scc0 sig_9
  s_lshl_b32 s56, s43, 5
  s_add_u32 s56, s56, s78
  s_add_u32 s56, s56, 512
  s_lshl_b32 s56, s56, 7
  s_add_u32 s56, s56, 4096
  v_mov_b32 v16, s76
  v_mov_b32 v17, s77
  v_mov_b32 v18, 0
  s_mov_b64 exec, 1
  buffer_store_dwordx2 v[16:17], v18, s[72:75], s56 offen sc1
  s_mov_b64 exec, -1
sig_9:
  s_mul_i32 s64, s45, 262144
  s_add_u32 s64, s64, 33554432
  s_add_u32 s12, s6, s64
  s_addc_u32 s13, s7, 0
  s_mov_b32 s14, 262144
  s_mov_b32 s15, 0x20000
  s_cmp_eq_u32 s40, 0
  s_cbranch_scc0 poll_10_done
  s_lshr_b32 s56, s45, 1
  s_lshl_b32 s56, s56, 5
  s_add_u32 s56, s56, 512
  s_lshl_b32 s56, s56, 7
  s_add_u32 s56, s56, 4096
  v_bfe_u32 v18, v0, 1, 3
  v_lshlrev_b32 v18, 2, v18
  v_and_b32 v19, 1, v0
  v_add_u32 v18, v18, v19
  v_lshlrev_b32 v18, 7, v18
  s_mov_b32 s57, 0
  buffer_load_dwordx2 v[240:241], v18, s[72:75], s56 offen sc1
poll_10:
  buffer_load_dwordx2 v[242:243], v18, s[72:75], s56 offen sc1
  s_add_u32 s57, s57, 1
  s_waitcnt vmcnt(1)
  v_cmp_eq_u32 vcc, s76, v240
  v_cmp_eq_u32 s[58:59], s77, v241
  s_nop 1
  s_and_b64 vcc, vcc, s[58:59]
  s_cmp_eq_u64 vcc, exec
  s_cbranch_scc1 poll_10_ok
  buffer_load_dwordx2 v[240:241], v18, s[72:75], s56 offen sc1
  s_add_u32 s57, s57, 1
  s_waitcnt vmcnt(1)
  v_cmp_eq_u32 vcc, s76, v242
  v_cmp_eq_u32 s[58:59], s77, v243
  s_nop 1
  s_and_b64 vcc, vcc, s[58:59]
  s_cmp_eq_u64 vcc, exec
  s_cbranch_scc1 poll_10_ok
  s_cmp_lt_u32 s57, 0x80000
  s_cbranch_scc1 poll_10
poll_10_ok:
poll_10_done:
  s_barrier
  s_add_u32 m0, s51, 0
  s_nop 0
  buffer_load_dwordx4 v2, s[12:15], s48 offen offset:0 sc1 lds
  buffer_load_dwordx4 v2, s[12:15], s48 offen offset:1024 sc1 lds
  buffer_load_dwordx4 v2, s[12:15], s48 offen offset:2048 sc1 lds
  buffer_load_dwordx4 v2, s[12:15], s48 offen offset:3072 sc1 lds
  s_add_u32 s48, s48, 16384
  s_add_u32 m0, s51, 16384
  s_nop 0
  buffer_load_dwordx4 v2, s[12:15], s48 offen offset:0 sc1 lds
  buffer_load_dwordx4 v2, s[12:15], s48 offen offset:1024 sc1 lds
  buffer_load_dwordx4 v2, s[12:15], s48 offen offset:2048 sc1 lds
  buffer_load_dwordx4 v2, s[12:15], s48 offen offset:3072 sc1 lds
  s_add_u32 s48, s48, 16384
  s_add_u32 m0, s51, 32768
  s_nop 0
  buffer_load_dwordx4 v2, s[12:15], s48 offen offset:0 sc1 lds
  buffer_load_dwordx4 v2, s[12:15], s48 offen offset:1024 sc1 lds
  buffer_load_dwordx4 v2, s[12:15], s48 offen offset:2048 sc1 lds
  buffer_load_dwordx4 v2, s[12:15], s48 offen offset:3072 sc1 lds
  s_add_u32 s48, s48, 16384
  s_add_u32 m0, s51, 49152
  s_nop 0
  buffer_load_dwordx4 v2, s[12:15], s48 offen offset:0 sc1 lds
  buffer_load_dwordx4 v2, s[12:15], s48 offen offset:1024 sc1 lds
  buffer_load_dwordx4 v2, s[12:15], s48 offen offset:2048 sc1 lds
  buffer_load_dwordx4 v2, s[12:15], s48 offen offset:3072 sc1 lds
  s_add_u32 s48, s48, 16384
  s_add_u32 m0, s51, 65536
  s_nop 0
  buffer_load_dwordx4 v2, s[12:15], s48 offen offset:0 sc1 lds
  buffer_load_dwordx4 v2, s[12:15], s48 offen offset:1024 sc1 lds
  buffer_load_dwordx4 v2, s[12:15], s48 offen offset:2048 sc1 lds
  buffer_load_dwordx4 v2, s[12:15], s48 offen offset:3072 sc1 lds
  s_add_u32 s48, s48, 16384
  s_waitcnt vmcnt(16)
  s_barrier
  ds_read_b128 v[16:19], v4 offset:0
  ds_read_b128 v[20:23], v4 offset:1024
  ds_read_b128 v[24:27], v4 offset:2048
  ds_read_b128 v[28:31], v4 offset:3072
  ds_read_b128 v[32:35], v4 offset:8192
  ds_read_b128 v[36:39], v4 offset:9216
  ds_read_b128 v[40:43], v4 offset:10240
  ds_read_b128 v[44:47], v4 offset:11264
  ds_read_b64_tr_b16 v[80:81], v10 offset:0
  ds_read_b64_tr_b16 v[82:83], v10 offset:2048
  ds_read_b64_tr_b16 v[84:85], v11 offset:0
  ds_read_b64_tr_b16 v[86:87], v11 offset:2048
  ds_read_b64_tr_b16 v[88:89], v12 offset:0
  ds_read_b64_tr_b16 v[90:91], v12 offset:2048
  ds_read_b64_tr_b16 v[92:93], v13 offset:0
  ds_read_b64_tr_b16 v[94:95], v13 offset:2048
  ds_read_b64_tr_b16 v[96:97], v10 offset:4096
  ds_read_b64_tr_b16 v[98:99], v10 offset:6144
  ds_read_b64_tr_b16 v[100:101], v11 offset:4096
  ds_read_b64_tr_b16 v[102:103], v11 offset:6144
  ds_read_b64_tr_b16 v[104:105], v12 offset:4096
  ds_read_b64_tr_b16 v[106:107], v12 offset:6144
  ds_read_b64_tr_b16 v[108:109], v13 offset:4096
  ds_read_b64_tr_b16 v[110:111], v13 offset:6144
  s_waitcnt vmcnt(12) lgkmcnt(0)
  s_barrier
  v_mfma_f32_16x16x32_bf16 a[0:3], v[80:83], v[16:19], 0
  ds_read_b128 v[48:51], v4 offset:16384
  s_add_u32 m0, s51, 0
  v_mfma_f32_16x16x32_bf16 a[4:7], v[80:83], v[20:23], 0
  ds_read_b64_tr_b16 v[112:113], v6 offset:0
  v_mfma_f32_16x16x32_bf16 a[8:11], v[80:83], v[24:27], 0
  buffer_load_dwordx4 v2, s[12:15], s48 offen offset:0 sc1 lds
  v_mfma_f32_16x16x32_bf16 a[12:15], v[80:83], v[28:31], 0
  ds_read_b64_tr_b16 v[114:115], v6 offset:2048
  ds_read_b128 v[52:55], v4 offset:17408
  v_mfma_f32_16x16x32_bf16 a[16:19], v[84:87], v[16:19], 0
  buffer_load_dwordx4 v2, s[12:15], s48 offen offset:1024 sc1 lds
  v_mfma_f32_16x16x32_bf16 a[20:23], v[84:87], v[20:23], 0
  ds_read_b64_tr_b16 v[116:117], v7 offset:0
  ds_read_b64_tr_b16 v[118:119], v7 offset:2048
  v_mfma_f32_16x16x32_bf16 a[24:27], v[84:87], v[24:27], 0
  buffer_load_dwordx4 v2, s[12:15], s48 offen offset:2048 sc1 lds
  v_mfma_f32_16x16x32_bf16 a[28:31], v[84:87], v[28:31], 0
  ds_read_b128 v[56:59], v4 offset:18432
  v_mfma_f32_16x16x32_bf16 a[32:35], v[88:91], v[16:19], 0
  buffer_load_dwordx4 v2, s[12:15], s48 offen offset:3072 sc1 lds
  v_mfma_f32_16x16x32_bf16 a[36:39], v[88:91], v[20:23], 0
  ds_read_b64_tr_b16 v[120:121], v8 offset:0
  ds_read_b64_tr_b16 v[122:123], v8 offset:2048
  v_mfma_f32_16x16x32_bf16 a[40:43], v[88:91], v[24:27], 0
  s_add_u32 s48, s48, 16384
  ds_read_b128 v[60:63], v4 offset:19456
  v_mfma_f32_16x16x32_bf16 a[44:47], v[88:91], v[28:31], 0
  ds_read_b64_tr_b16 v[124:125], v9 offset:0
  s_add_u32 m0, s52, 65536
  v_mfma_f32_16x16x32_bf16 a[48:51], v[92:95], v[16:19], 0
  ds_read_b64_tr_b16 v[126:127], v9 offset:2048
  v_mfma_f32_16x16x32_bf16 a[52:55], v[92:95], v[20:23], 0
  buffer_load_dwordx4 v3, s[16:19], s49 offen lds
  v_mfma_f32_16x16x32_bf16 a[56:59], v[92:95], v[24:27], 0
  ds_read_b128 v[64:67], v4 offset:24576
  v_mfma_f32_16x16x32_bf16 a[60:63], v[92:95], v[28:31], 0
  ds_read_b64_tr_b16 v[128:129], v6 offset:4096
  s_add_u32 m0, s52, 66560
  v_mfma_f32_16x16x32_bf16 a[0:3], v[96:99], v[32:35], a[0:3]
  ds_read_b64_tr_b16 v[130:131], v6 offset:6144
  v_mfma_f32_16x16x32_bf16 a[4:7], v[96:99], v[36:39], a[4:7]
  buffer_load_dwordx4 v3, s[16:19], s50 offen lds
  v_mfma_f32_16x16x32_bf16 a[8:11], v[96:99], v[40:43], a[8:11]
  ds_read_b128 v[68:71], v4 offset:25600
  ds_read_b64_tr_b16 v[132:133], v7 offset:4096
  v_mfma_f32_16x16x32_bf16 a[12:15], v[96:99], v[44:47], a[12:15]
  s_add_u32 m0, s52, 73728
  ds_read_b64_tr_b16 v[134:135], v7 offset:6144
  v_mfma_f32_16x16x32_bf16 a[16:19], v[100:103], v[32:35], a[16:19]
  buffer_load_dwordx4 v3, s[20:23], s49 offen lds
  v_mfma_f32_16x16x32_bf16 a[20:23], v[100:103], v[36:39], a[20:23]
  ds_read_b128 v[72:75], v4 offset:26624
  v_mfma_f32_16x16x32_bf16 a[24:27], v[100:103], v[40:43], a[24:27]
  ds_read_b64_tr_b16 v[136:137], v8 offset:4096
  s_add_u32 m0, s52, 74752
  v_mfma_f32_16x16x32_bf16 a[28:31], v[100:103], v[44:47], a[28:31]
  ds_read_b64_tr_b16 v[138:139], v8 offset:6144
  v_mfma_f32_16x16x32_bf16 a[32:35], v[104:107], v[32:35], a[32:35]
  ds_read_b128 v[76:79], v4 offset:27648
  v_mfma_f32_16x16x32_bf16 a[36:39], v[104:107], v[36:39], a[36:39]
  buffer_load_dwordx4 v3, s[20:23], s50 offen lds
  v_mfma_f32_16x16x32_bf16 a[40:43], v[104:107], v[40:43], a[40:43]
  ds_read_b64_tr_b16 v[140:141], v9 offset:4096
  ds_read_b64_tr_b16 v[142:143], v9 offset:6144
  v_mfma_f32_16x16x32_bf16 a[44:47], v[104:107], v[44:47], a[44:47]
  s_add_u32 s49, s49, 131072
  v_mfma_f32_16x16x32_bf16 a[48:51], v[108:111], v[32:35], a[48:51]
  s_add_u32 s50, s50, 131072
  v_mfma_f32_16x16x32_bf16 a[52:55], v[108:111], v[36:39], a[52:55]
  v_mfma_f32_16x16x32_bf16 a[56:59], v[108:111], v[40:43], a[56:59]
  v_mfma_f32_16x16x32_bf16 a[60:63], v[108:111], v[44:47], a[60:63]
  s_waitcnt vmcnt(16) lgkmcnt(0)
  s_barrier
  v_mfma_f32_16x16x32_bf16 a[0:3], v[112:115], v[48:51], a[0:3]
  ds_read_b128 v[16:19], v4 offset:32768
  s_add_u32 m0, s51, 16384
  v_mfma_f32_16x16x32_bf16 a[4:7], v[112:115], v[52:55], a[4:7]
  ds_read_b64_tr_b16 v[80:81], v6 offset:16384
  v_mfma_f32_16x16x32_bf16 a[8:11], v[112:115], v[56:59], a[8:11]
  buffer_load_dwordx4 v2, s[12:15], s48 offen offset:0 sc1 lds
  v_mfma_f32_16x16x32_bf16 a[12:15], v[112:115], v[60:63], a[12:15]
  ds_read_b64_tr_b16 v[82:83], v6 offset:18432
  ds_read_b128 v[20:23], v4 offset:33792
  v_mfma_f32_16x16x32_bf16 a[16:19], v[116:119], v[48:51], a[16:19]
  buffer_load_dwordx4 v2, s[12:15], s48 offen offset:1024 sc1 lds
  v_mfma_f32_16x16x32_bf16 a[20:23], v[116:119], v[52:55], a[20:23]
  ds_read_b64_tr_b16 v[84:85], v7 offset:16384
  ds_read_b64_tr_b16 v[86:87], v7 offset:18432
  v_mfma_f32_16x16x32_bf16 a[24:27], v[116:119], v[56:59], a[24:27]
  buffer_load_dwordx4 v2, s[12:15], s48 offen offset:2048 sc1 lds
  v_mfma_f32_16x16x32_bf16 a[28:31], v[116:119], v[60:63], a[28:31]
  ds_read_b128 v[24:27], v4 offset:34816
  v_mfma_f32_16x16x32_bf16 a[32:35], v[120:123], v[48:51], a[32:35]
  buffer_load_dwordx4 v2, s[12:15], s48 offen offset:3072 sc1 lds
  v_mfma_f32_16x16x32_bf16 a[36:39], v[120:123], v[52:55], a[36:39]
  ds_read_b64_tr_b16 v[88:89], v8 offset:16384
  ds_read_b64_tr_b16 v[90:91], v8 offset:18432
  v_mfma_f32_16x16x32_bf16 a[40:43], v[120:123], v[56:59], a[40:43]
  s_add_u32 s48, s48, 16384
  ds_read_b128 v[28:31], v4 offset:35840
  v_mfma_f32_16x16x32_bf16 a[44:47], v[120:123], v[60:63], a[44:47]
  ds_read_b64_tr_b16 v[92:93], v9 offset:16384
  s_add_u32 m0, s52, 0
  v_mfma_f32_16x16x32_bf16 a[48:51], v[124:127], v[48:51], a[48:51]
  ds_read_b64_tr_b16 v[94:95], v9 offset:18432
  v_mfma_f32_16x16x32_bf16 a[52:55], v[124:127], v[52:55], a[52:55]
  buffer_load_dwordx4 v3, s[16:19], s49 offen lds
  v_mfma_f32_16x16x32_bf16 a[56:59], v[124:127], v[56:59], a[56:59]
  ds_read_b128 v[32:35], v4 offset:40960
  v_mfma_f32_16x16x32_bf16 a[60:63], v[124:127], v[60:63], a[60:63]
  ds_read_b64_tr_b16 v[96:97], v6 offset:20480
  s_add_u32 m0, s52, 1024
  v_mfma_f32_16x16x32_bf16 a[0:3], v[128:131], v[64:67], a[0:3]
  ds_read_b64_tr_b16 v[98:99], v6 offset:22528
  v_mfma_f32_16x16x32_bf16 a[4:7], v[128:131], v[68:71], a[4:7]
  buffer_load_dwordx4 v3, s[16:19], s50 offen lds
  v_mfma_f32_16x16x32_bf16 a[8:11], v[128:131], v[72:75], a[8:11]
  ds_read_b128 v[36:39], v4 offset:41984
  ds_read_b64_tr_b16 v[100:101], v7 offset:20480
  v_mfma_f32_16x16x32_bf16 a[12:15], v[128:131], v[76:79], a[12:15]
  s_add_u32 m0, s52, 8192
  ds_read_b64_tr_b16 v[102:103], v7 offset:22528
  v_mfma_f32_16x16x32_bf16 a[16:19], v[132:135], v[64:67], a[16:19]
  buffer_load_dwordx4 v3, s[20:23], s49 offen lds
  v_mfma_f32_16x16x32_bf16 a[20:23], v[132:135], v[68:71], a[20:23]
  ds_read_b128 v[40:43], v4 offset:43008
  v_mfma_f32_16x16x32_bf16 a[24:27], v[132:135], v[72:75], a[24:27]
  ds_read_b64_tr_b16 v[104:105], v8 offset:20480
  s_add_u32 m0, s52, 9216
  v_mfma_f32_16x16x32_bf16 a[28:31], v[132:135], v[76:79], a[28:31]
  ds_read_b64_tr_b16 v[106:107], v8 offset:22528
  v_mfma_f32_16x16x32_bf16 a[32:35], v[136:139], v[64:67], a[32:35]
  ds_read_b128 v[44:47], v4 offset:44032
  v_mfma_f32_16x16x32_bf16 a[36:39], v[136:139], v[68:71], a[36:39]
  buffer_load_dwordx4 v3, s[20:23], s50 offen lds
  v_mfma_f32_16x16x32_bf16 a[40:43], v[136:139], v[72:75], a[40:43]
  ds_read_b64_tr_b16 v[108:109], v9 offset:20480
  ds_read_b64_tr_b16 v[110:111], v9 offset:22528
  v_mfma_f32_16x16x32_bf16 a[44:47], v[136:139], v[76:79], a[44:47]
  s_add_u32 s49, s49, 131072
  v_mfma_f32_16x16x32_bf16 a[48:51], v[140:143], v[64:67], a[48:51]
  s_add_u32 s50, s50, 131072
  v_mfma_f32_16x16x32_bf16 a[52:55], v[140:143], v[68:71], a[52:55]
  v_mfma_f32_16x16x32_bf16 a[56:59], v[140:143], v[72:75], a[56:59]
  v_mfma_f32_16x16x32_bf16 a[60:63], v[140:143], v[76:79], a[60:63]
  s_waitcnt vmcnt(20) lgkmcnt(0)
  s_barrier
  v_mfma_f32_16x16x32_bf16 a[0:3], v[80:83], v[16:19], a[0:3]
  ds_read_b128 v[48:51], v4 offset:49152
  s_add_u32 m0, s51, 32768
  v_mfma_f32_16x16x32_bf16 a[4:7], v[80:83], v[20:23], a[4:7]
  ds_read_b64_tr_b16 v[112:113], v6 offset:32768
  v_mfma_f32_16x16x32_bf16 a[8:11], v[80:83], v[24:27], a[8:11]
  buffer_load_dwordx4 v2, s[12:15], s48 offen offset:0 sc1 lds
  v_mfma_f32_16x16x32_bf16 a[12:15], v[80:83], v[28:31], a[12:15]
  ds_read_b64_tr_b16 v[114:115], v6 offset:34816
  ds_read_b128 v[52:55], v4 offset:50176
  v_mfma_f32_16x16x32_bf16 a[16:19], v[84:87], v[16:19], a[16:19]
  buffer_load_dwordx4 v2, s[12:15], s48 offen offset:1024 sc1 lds
  v_mfma_f32_16x16x32_bf16 a[20:23], v[84:87], v[20:23], a[20:23]
  ds_read_b64_tr_b16 v[116:117], v7 offset:32768
  ds_read_b64_tr_b16 v[118:119], v7 offset:34816
  v_mfma_f32_16x16x32_bf16 a[24:27], v[84:87], v[24:27], a[24:27]
  buffer_load_dwordx4 v2, s[12:15], s48 offen offset:2048 sc1 lds
  v_mfma_f32_16x16x32_bf16 a[28:31], v[84:87], v[28:31], a[28:31]
  ds_read_b128 v[56:59], v4 offset:51200
  v_mfma_f32_16x16x32_bf16 a[32:35], v[88:91], v[16:19], a[32:35]
  buffer_load_dwordx4 v2, s[12:15], s48 offen offset:3072 sc1 lds
  v_mfma_f32_16x16x32_bf16 a[36:39], v[88:91], v[20:23], a[36:39]
  ds_read_b64_tr_b16 v[120:121], v8 offset:32768
  ds_read_b64_tr_b16 v[122:123], v8 offset:34816
  v_mfma_f32_16x16x32_bf16 a[40:43], v[88:91], v[24:27], a[40:43]
  s_add_u32 s48, s48, 16384
  ds_read_b128 v[60:63], v4 offset:52224
  v_mfma_f32_16x16x32_bf16 a[44:47], v[88:91], v[28:31], a[44:47]
  ds_read_b64_tr_b16 v[124:125], v9 offset:32768
  s_add_u32 m0, s52, 16384
  v_mfma_f32_16x16x32_bf16 a[48:51], v[92:95], v[16:19], a[48:51]
  ds_read_b64_tr_b16 v[126:127], v9 offset:34816
  v_mfma_f32_16x16x32_bf16 a[52:55], v[92:95], v[20:23], a[52:55]
  buffer_load_dwordx4 v3, s[16:19], s49 offen lds
  v_mfma_f32_16x16x32_bf16 a[56:59], v[92:95], v[24:27], a[56:59]
  ds_read_b128 v[64:67], v4 offset:57344
  v_mfma_f32_16x16x32_bf16 a[60:63], v[92:95], v[28:31], a[60:63]
  ds_read_b64_tr_b16 v[128:129], v6 offset:36864
  s_add_u32 m0, s52, 17408
  v_mfma_f32_16x16x32_bf16 a[0:3], v[96:99], v[32:35], a[0:3]
  ds_read_b64_tr_b16 v[130:131], v6 offset:38912
  v_mfma_f32_16x16x32_bf16 a[4:7], v[96:99], v[36:39], a[4:7]
  buffer_load_dwordx4 v3, s[16:19], s50 offen lds
  v_mfma_f32_16x16x32_bf16 a[8:11], v[96:99], v[40:43], a[8:11]
  ds_read_b128 v[68:71], v4 offset:58368
  ds_read_b64_tr_b16 v[132:133], v7 offset:36864
  v_mfma_f32_16x16x32_bf16 a[12:15], v[96:99], v[44:47], a[12:15]
  s_add_u32 m0, s52, 24576
  ds_read_b64_tr_b16 v[134:135], v7 offset:38912
  v_mfma_f32_16x16x32_bf16 a[16:19], v[100:103], v[32:35], a[16:19]
  buffer_load_dwordx4 v3, s[20:23], s49 offen lds
  v_mfma_f32_16x16x32_bf16 a[20:23], v[100:103], v[36:39], a[20:23]
  ds_read_b128 v[72:75], v4 offset:59392
  v_mfma_f32_16x16x32_bf16 a[24:27], v[100:103], v[40:43], a[24:27]
  ds_read_b64_tr_b16 v[136:137], v8 offset:36864
  s_add_u32 m0, s52, 25600
  v_mfma_f32_16x16x32_bf16 a[28:31], v[100:103], v[44:47], a[28:31]
  ds_read_b64_tr_b16 v[138:139], v8 offset:38912
  v_mfma_f32_16x16x32_bf16 a[32:35], v[104:107], v[32:35], a[32:35]
  ds_read_b128 v[76:79], v4 offset:60416
  v_mfma_f32_16x16x32_bf16 a[36:39], v[104:107], v[36:39], a[36:39]
  buffer_load_dwordx4 v3, s[20:23], s50 offen lds
  v_mfma_f32_16x16x32_bf16 a[40:43], v[104:107], v[40:43], a[40:43]
  ds_read_b64_tr_b16 v[140:141], v9 offset:36864
  ds_read_b64_tr_b16 v[142:143], v9 offset:38912
  v_mfma_f32_16x16x32_bf16 a[44:47], v[104:107], v[44:47], a[44:47]
  s_add_u32 s49, s49, 131072
  v_mfma_f32_16x16x32_bf16 a[48:51], v[108:111], v[32:35], a[48:51]
  s_add_u32 s50, s50, 131072
  v_mfma_f32_16x16x32_bf16 a[52:55], v[108:111], v[36:39], a[52:55]
  v_mfma_f32_16x16x32_bf16 a[56:59], v[108:111], v[40:43], a[56:59]
  v_mfma_f32_16x16x32_bf16 a[60:63], v[108:111], v[44:47], a[60:63]
  s_waitcnt vmcnt(24) lgkmcnt(0)
  s_barrier
  v_mfma_f32_16x16x32_bf16 a[0:3], v[112:115], v[48:51], a[0:3]
  ds_read_b128 v[16:19], v5 offset:0
  s_add_u32 m0, s51, 49152
  v_mfma_f32_16x16x32_bf16 a[4:7], v[112:115], v[52:55], a[4:7]
  ds_read_b64_tr_b16 v[80:81], v6 offset:49152
  v_mfma_f32_16x16x32_bf16 a[8:11], v[112:115], v[56:59], a[8:11]
  buffer_load_dwordx4 v2, s[12:15], s48 offen offset:0 sc1 lds
  v_mfma_f32_16x16x32_bf16 a[12:15], v[112:115], v[60:63], a[12:15]
  ds_read_b64_tr_b16 v[82:83], v6 offset:51200
  ds_read_b128 v[20:23], v5 offset:1024
  v_mfma_f32_16x16x32_bf16 a[16:19], v[116:119], v[48:51], a[16:19]
  buffer_load_dwordx4 v2, s[12:15], s48 offen offset:1024 sc1 lds
  v_mfma_f32_16x16x32_bf16 a[20:23], v[116:119], v[52:55], a[20:23]
  ds_read_b64_tr_b16 v[84:85], v7 offset:49152
  ds_read_b64_tr_b16 v[86:87], v7 offset:51200
  v_mfma_f32_16x16x32_bf16 a[24:27], v[116:119], v[56:59], a[24:27]
  buffer_load_dwordx4 v2, s[12:15], s48 offen offset:2048 sc1 lds
  v_mfma_f32_16x16x32_bf16 a[28:31], v[116:119], v[60:63], a[28:31]
  ds_read_b128 v[24:27], v5 offset:2048
  v_mfma_f32_16x16x32_bf16 a[32:35], v[120:123], v[48:51], a[32:35]
  buffer_load_dwordx4 v2, s[12:15], s48 offen offset:3072 sc1 lds
  v_mfma_f32_16x16x32_bf16 a[36:39], v[120:123], v[52:55], a[36:39]
  ds_read_b64_tr_b16 v[88:89], v8 offset:49152
  ds_read_b64_tr_b16 v[90:91], v8 offset:51200
  v_mfma_f32_16x16x32_bf16 a[40:43], v[120:123], v[56:59], a[40:43]
  s_add_u32 s48, s48, 16384
  ds_read_b128 v[28:31], v5 offset:3072
  v_mfma_f32_16x16x32_bf16 a[44:47], v[120:123], v[60:63], a[44:47]
  ds_read_b64_tr_b16 v[92:93], v9 offset:49152
  s_add_u32 m0, s52, 32768
  v_mfma_f32_16x16x32_bf16 a[48:51], v[124:127], v[48:51], a[48:51]
  ds_read_b64_tr_b16 v[94:95], v9 offset:51200
  v_mfma_f32_16x16x32_bf16 a[52:55], v[124:127], v[52:55], a[52:55]
  buffer_load_dwordx4 v3, s[16:19], s49 offen lds
  v_mfma_f32_16x16x32_bf16 a[56:59], v[124:127], v[56:59], a[56:59]
  ds_read_b128 v[32:35], v5 offset:8192
  v_mfma_f32_16x16x32_bf16 a[60:63], v[124:127], v[60:63], a[60:63]
  ds_read_b64_tr_b16 v[96:97], v6 offset:53248
  s_add_u32 m0, s52, 33792
  v_mfma_f32_16x16x32_bf16 a[0:3], v[128:131], v[64:67], a[0:3]
  ds_read_b64_tr_b16 v[98:99], v6 offset:55296
  v_mfma_f32_16x16x32_bf16 a[4:7], v[128:131], v[68:71], a[4:7]
  buffer_load_dwordx4 v3, s[16:19], s50 offen lds
  v_mfma_f32_16x16x32_bf16 a[8:11], v[128:131], v[72:75], a[8:11]
  ds_read_b128 v[36:39], v5 offset:9216
  ds_read_b64_tr_b16 v[100:101], v7 offset:53248
  v_mfma_f32_16x16x32_bf16 a[12:15], v[128:131], v[76:79], a[12:15]
  s_add_u32 m0, s52, 40960
  ds_read_b64_tr_b16 v[102:103], v7 offset:55296
  v_mfma_f32_16x16x32_bf16 a[16:19], v[132:135], v[64:67], a[16:19]
  buffer_load_dwordx4 v3, s[20:23], s49 offen lds
  v_mfma_f32_16x16x32_bf16 a[20:23], v[132:135], v[68:71], a[20:23]
  ds_read_b128 v[40:43], v5 offset:10240
  v_mfma_f32_16x16x32_bf16 a[24:27], v[132:135], v[72:75], a[24:27]
  ds_read_b64_tr_b16 v[104:105], v8 offset:53248
  s_add_u32 m0, s52, 41984
  v_mfma_f32_16x16x32_bf16 a[28:31], v[132:135], v[76:79], a[28:31]
  ds_read_b64_tr_b16 v[106:107], v8 offset:55296
  v_mfma_f32_16x16x32_bf16 a[32:35], v[136:139], v[64:67], a[32:35]
  ds_read_b128 v[44:47], v5 offset:11264
  v_mfma_f32_16x16x32_bf16 a[36:39], v[136:139], v[68:71], a[36:39]
  buffer_load_dwordx4 v3, s[20:23], s50 offen lds
  v_mfma_f32_16x16x32_bf16 a[40:43], v[136:139], v[72:75], a[40:43]
  ds_read_b64_tr_b16 v[108:109], v9 offset:53248
  ds_read_b64_tr_b16 v[110:111], v9 offset:55296
  v_mfma_f32_16x16x32_bf16 a[44:47], v[136:139], v[76:79], a[44:47]
  s_add_u32 s49, s49, 131072
  v_mfma_f32_16x16x32_bf16 a[48:51], v[140:143], v[64:67], a[48:51]
  s_add_u32 s50, s50, 131072
  v_mfma_f32_16x16x32_bf16 a[52:55], v[140:143], v[68:71], a[52:55]
  v_mfma_f32_16x16x32_bf16 a[56:59], v[140:143], v[72:75], a[56:59]
  v_mfma_f32_16x16x32_bf16 a[60:63], v[140:143], v[76:79], a[60:63]
  s_waitcnt vmcnt(24) lgkmcnt(0)
  s_barrier
  v_mfma_f32_16x16x32_bf16 a[0:3], v[80:83], v[16:19], a[0:3]
  ds_read_b128 v[48:51], v4 offset:0
  s_add_u32 m0, s51, 65536
  v_mfma_f32_16x16x32_bf16 a[4:7], v[80:83], v[20:23], a[4:7]
  ds_read_b64_tr_b16 v[112:113], v10 offset:0
  v_mfma_f32_16x16x32_bf16 a[8:11], v[80:83], v[24:27], a[8:11]
  buffer_load_dwordx4 v2, s[12:15], s48 offen offset:0 sc1 lds
  v_mfma_f32_16x16x32_bf16 a[12:15], v[80:83], v[28:31], a[12:15]
  ds_read_b64_tr_b16 v[114:115], v10 offset:2048
  ds_read_b128 v[52:55], v4 offset:1024
  v_mfma_f32_16x16x32_bf16 a[16:19], v[84:87], v[16:19], a[16:19]
  buffer_load_dwordx4 v2, s[12:15], s48 offen offset:1024 sc1 lds
  v_mfma_f32_16x16x32_bf16 a[20:23], v[84:87], v[20:23], a[20:23]
  ds_read_b64_tr_b16 v[116:117], v11 offset:0
  ds_read_b64_tr_b16 v[118:119], v11 offset:2048
  v_mfma_f32_16x16x32_bf16 a[24:27], v[84:87], v[24:27], a[24:27]
  buffer_load_dwordx4 v2, s[12:15], s48 offen offset:2048 sc1 lds
  v_mfma_f32_16x16x32_bf16 a[28:31], v[84:87], v[28:31], a[28:31]
  ds_read_b128 v[56:59], v4 offset:2048
  v_mfma_f32_16x16x32_bf16 a[32:35], v[88:91], v[16:19], a[32:35]
  buffer_load_dwordx4 v2, s[12:15], s48 offen offset:3072 sc1 lds
  v_mfma_f32_16x16x32_bf16 a[36:39], v[88:91], v[20:23], a[36:39]
  ds_read_b64_tr_b16 v[120:121], v12 offset:0
  ds_read_b64_tr_b16 v[122:123], v12 offset:2048
  v_mfma_f32_16x16x32_bf16 a[40:43], v[88:91], v[24:27], a[40:43]
  s_add_u32 s48, s48, 16384
  ds_read_b128 v[60:63], v4 offset:3072
  v_mfma_f32_16x16x32_bf16 a[44:47], v[88:91], v[28:31], a[44:47]
  ds_read_b64_tr_b16 v[124:125], v13 offset:0
  s_add_u32 m0, s52, 49152
  v_mfma_f32_16x16x32_bf16 a[48:51], v[92:95], v[16:19], a[48:51]
  ds_read_b64_tr_b16 v[126:127], v13 offset:2048
  v_mfma_f32_16x16x32_bf16 a[52:55], v[92:95], v[20:23], a[52:55]
  buffer_load_dwordx4 v3, s[16:19], s49 offen lds
  v_mfma_f32_16x16x32_bf16 a[56:59], v[92:95], v[24:27], a[56:59]
  ds_read_b128 v[64:67], v4 offset:8192
  v_mfma_f32_16x16x32_bf16 a[60:63], v[92:95], v[28:31], a[60:63]
  ds_read_b64_tr_b16 v[128:129], v10 offset:4096
  s_add_u32 m0, s52, 50176
  v_mfma_f32_16x16x32_bf16 a[0:3], v[96:99], v[32:35], a[0:3]
  ds_read_b64_tr_b16 v[130:131], v10 offset:6144
  v_mfma_f32_16x16x32_bf16 a[4:7], v[96:99], v[36:39], a[4:7]
  buffer_load_dwordx4 v3, s[16:19], s50 offen lds
  v_mfma_f32_16x16x32_bf16 a[8:11], v[96:99], v[40:43], a[8:11]
  ds_read_b128 v[68:71], v4 offset:9216
  ds_read_b64_tr_b16 v[132:133], v11 offset:4096
  v_mfma_f32_16x16x32_bf16 a[12:15], v[96:99], v[44:47], a[12:15]
  s_add_u32 m0, s52, 57344
  ds_read_b64_tr_b16 v[134:135], v11 offset:6144
  v_mfma_f32_16x16x32_bf16 a[16:19], v[100:103], v[32:35], a[16:19]
  buffer_load_dwordx4 v3, s[20:23], s49 offen lds
  v_mfma_f32_16x16x32_bf16 a[20:23], v[100:103], v[36:39], a[20:23]
  ds_read_b128 v[72:75], v4 offset:10240
  v_mfma_f32_16x16x32_bf16 a[24:27], v[100:103], v[40:43], a[24:27]
  ds_read_b64_tr_b16 v[136:137], v12 offset:4096
  s_add_u32 m0, s52, 58368
  v_mfma_f32_16x16x32_bf16 a[28:31], v[100:103], v[44:47], a[28:31]
  ds_read_b64_tr_b16 v[138:139], v12 offset:6144
  v_mfma_f32_16x16x32_bf16 a[32:35], v[104:107], v[32:35], a[32:35]
  ds_read_b128 v[76:79], v4 offset:11264
  v_mfma_f32_16x16x32_bf16 a[36:39], v[104:107], v[36:39], a[36:39]
  buffer_load_dwordx4 v3, s[20:23], s50 offen lds
  v_mfma_f32_16x16x32_bf16 a[40:43], v[104:107], v[40:43], a[40:43]
  ds_read_b64_tr_b16 v[140:141], v13 offset:4096
  ds_read_b64_tr_b16 v[142:143], v13 offset:6144
  v_mfma_f32_16x16x32_bf16 a[44:47], v[104:107], v[44:47], a[44:47]
  s_add_u32 s49, s49, 131072
  v_mfma_f32_16x16x32_bf16 a[48:51], v[108:111], v[32:35], a[48:51]
  s_add_u32 s50, s50, 131072
  v_mfma_f32_16x16x32_bf16 a[52:55], v[108:111], v[36:39], a[52:55]
  v_mfma_f32_16x16x32_bf16 a[56:59], v[108:111], v[40:43], a[56:59]
  v_mfma_f32_16x16x32_bf16 a[60:63], v[108:111], v[44:47], a[60:63]
  s_waitcnt vmcnt(24) lgkmcnt(0)
  s_barrier
  v_mfma_f32_16x16x32_bf16 a[0:3], v[112:115], v[48:51], a[0:3]
  ds_read_b128 v[16:19], v4 offset:16384
  s_add_u32 m0, s51, 0
  v_mfma_f32_16x16x32_bf16 a[4:7], v[112:115], v[52:55], a[4:7]
  ds_read_b64_tr_b16 v[80:81], v6 offset:0
  v_mfma_f32_16x16x32_bf16 a[8:11], v[112:115], v[56:59], a[8:11]
  buffer_load_dwordx4 v2, s[12:15], s48 offen offset:0 sc1 lds
  v_mfma_f32_16x16x32_bf16 a[12:15], v[112:115], v[60:63], a[12:15]
  ds_read_b64_tr_b16 v[82:83], v6 offset:2048
  ds_read_b128 v[20:23], v4 offset:17408
  v_mfma_f32_16x16x32_bf16 a[16:19], v[116:119], v[48:51], a[16:19]
  buffer_load_dwordx4 v2, s[12:15], s48 offen offset:1024 sc1 lds
  v_mfma_f32_16x16x32_bf16 a[20:23], v[116:119], v[52:55], a[20:23]
  ds_read_b64_tr_b16 v[84:85], v7 offset:0
  ds_read_b64_tr_b16 v[86:87], v7 offset:2048
  v_mfma_f32_16x16x32_bf16 a[24:27], v[116:119], v[56:59], a[24:27]
  buffer_load_dwordx4 v2, s[12:15], s48 offen offset:2048 sc1 lds
  v_mfma_f32_16x16x32_bf16 a[28:31], v[116:119], v[60:63], a[28:31]
  ds_read_b128 v[24:27], v4 offset:18432
  v_mfma_f32_16x16x32_bf16 a[32:35], v[120:123], v[48:51], a[32:35]
  buffer_load_dwordx4 v2, s[12:15], s48 offen offset:3072 sc1 lds
  v_mfma_f32_16x16x32_bf16 a[36:39], v[120:123], v[52:55], a[36:39]
  ds_read_b64_tr_b16 v[88:89], v8 offset:0
  ds_read_b64_tr_b16 v[90:91], v8 offset:2048
  v_mfma_f32_16x16x32_bf16 a[40:43], v[120:123], v[56:59], a[40:43]
  s_add_u32 s48, s48, 16384
  ds_read_b128 v[28:31], v4 offset:19456
  v_mfma_f32_16x16x32_bf16 a[44:47], v[120:123], v[60:63], a[44:47]
  ds_read_b64_tr_b16 v[92:93], v9 offset:0
  s_add_u32 m0, s52, 65536
  v_mfma_f32_16x16x32_bf16 a[48:51], v[124:127], v[48:51], a[48:51]
  ds_read_b64_tr_b16 v[94:95], v9 offset:2048
  v_mfma_f32_16x16x32_bf16 a[52:55], v[124:127], v[52:55], a[52:55]
  buffer_load_dwordx4 v3, s[16:19], s49 offen lds
  v_mfma_f32_16x16x32_bf16 a[56:59], v[124:127], v[56:59], a[56:59]
  ds_read_b128 v[32:35], v4 offset:24576
  v_mfma_f32_16x16x32_bf16 a[60:63], v[124:127], v[60:63], a[60:63]
  ds_read_b64_tr_b16 v[96:97], v6 offset:4096
  s_add_u32 m0, s52, 66560
  v_mfma_f32_16x16x32_bf16 a[0:3], v[128:131], v[64:67], a[0:3]
  ds_read_b64_tr_b16 v[98:99], v6 offset:6144
  v_mfma_f32_16x16x32_bf16 a[4:7], v[128:131], v[68:71], a[4:7]
  buffer_load_dwordx4 v3, s[16:19], s50 offen lds
  v_mfma_f32_16x16x32_bf16 a[8:11], v[128:131], v[72:75], a[8:11]
  ds_read_b128 v[36:39], v4 offset:25600
  ds_read_b64_tr_b16 v[100:101], v7 offset:4096
  v_mfma_f32_16x16x32_bf16 a[12:15], v[128:131], v[76:79], a[12:15]
  s_add_u32 m0, s52, 73728
  ds_read_b64_tr_b16 v[102:103], v7 offset:6144
  v_mfma_f32_16x16x32_bf16 a[16:19], v[132:135], v[64:67], a[16:19]
  buffer_load_dwordx4 v3, s[20:23], s49 offen lds
  v_mfma_f32_16x16x32_bf16 a[20:23], v[132:135], v[68:71], a[20:23]
  ds_read_b128 v[40:43], v4 offset:26624
  v_mfma_f32_16x16x32_bf16 a[24:27], v[132:135], v[72:75], a[24:27]
  ds_read_b64_tr_b16 v[104:105], v8 offset:4096
  s_add_u32 m0, s52, 74752
  v_mfma_f32_16x16x32_bf16 a[28:31], v[132:135], v[76:79], a[28:31]
  ds_read_b64_tr_b16 v[106:107], v8 offset:6144
  v_mfma_f32_16x16x32_bf16 a[32:35], v[136:139], v[64:67], a[32:35]
  ds_read_b128 v[44:47], v4 offset:27648
  v_mfma_f32_16x16x32_bf16 a[36:39], v[136:139], v[68:71], a[36:39]
  buffer_load_dwordx4 v3, s[20:23], s50 offen lds
  v_mfma_f32_16x16x32_bf16 a[40:43], v[136:139], v[72:75], a[40:43]
  ds_read_b64_tr_b16 v[108:109], v9 offset:4096
  ds_read_b64_tr_b16 v[110:111], v9 offset:6144
  v_mfma_f32_16x16x32_bf16 a[44:47], v[136:139], v[76:79], a[44:47]
  s_add_u32 s49, s49, 131072
  v_mfma_f32_16x16x32_bf16 a[48:51], v[140:143], v[64:67], a[48:51]
  s_add_u32 s50, s50, 131072
  v_mfma_f32_16x16x32_bf16 a[52:55], v[140:143], v[68:71], a[52:55]
  v_mfma_f32_16x16x32_bf16 a[56:59], v[140:143], v[72:75], a[56:59]
  v_mfma_f32_16x16x32_bf16 a[60:63], v[140:143], v[76:79], a[60:63]
  s_waitcnt vmcnt(24) lgkmcnt(0)
  s_barrier
  v_mfma_f32_16x16x32_bf16 a[0:3], v[80:83], v[16:19], a[0:3]
  ds_read_b128 v[48:51], v4 offset:32768
  s_add_u32 m0, s51, 16384
  v_mfma_f32_16x16x32_bf16 a[4:7], v[80:83], v[20:23], a[4:7]
  ds_read_b64_tr_b16 v[112:113], v6 offset:16384
  v_mfma_f32_16x16x32_bf16 a[8:11], v[80:83], v[24:27], a[8:11]
  buffer_load_dwordx4 v2, s[12:15], s48 offen offset:0 sc1 lds
  v_mfma_f32_16x16x32_bf16 a[12:15], v[80:83], v[28:31], a[12:15]
  ds_read_b64_tr_b16 v[114:115], v6 offset:18432
  ds_read_b128 v[52:55], v4 offset:33792
  v_mfma_f32_16x16x32_bf16 a[16:19], v[84:87], v[16:19], a[16:19]
  buffer_load_dwordx4 v2, s[12:15], s48 offen offset:1024 sc1 lds
  v_mfma_f32_16x16x32_bf16 a[20:23], v[84:87], v[20:23], a[20:23]
  ds_read_b64_tr_b16 v[116:117], v7 offset:16384
  ds_read_b64_tr_b16 v[118:119], v7 offset:18432
  v_mfma_f32_16x16x32_bf16 a[24:27], v[84:87], v[24:27], a[24:27]
  buffer_load_dwordx4 v2, s[12:15], s48 offen offset:2048 sc1 lds
  v_mfma_f32_16x16x32_bf16 a[28:31], v[84:87], v[28:31], a[28:31]
  ds_read_b128 v[56:59], v4 offset:34816
  v_mfma_f32_16x16x32_bf16 a[32:35], v[88:91], v[16:19], a[32:35]
  buffer_load_dwordx4 v2, s[12:15], s48 offen offset:3072 sc1 lds
  v_mfma_f32_16x16x32_bf16 a[36:39], v[88:91], v[20:23], a[36:39]
  ds_read_b64_tr_b16 v[120:121], v8 offset:16384
  ds_read_b64_tr_b16 v[122:123], v8 offset:18432
  v_mfma_f32_16x16x32_bf16 a[40:43], v[88:91], v[24:27], a[40:43]
  s_add_u32 s48, s48, 16384
  ds_read_b128 v[60:63], v4 offset:35840
  v_mfma_f32_16x16x32_bf16 a[44:47], v[88:91], v[28:31], a[44:47]
  ds_read_b64_tr_b16 v[124:125], v9 offset:16384
  s_add_u32 m0, s52, 0
  v_mfma_f32_16x16x32_bf16 a[48:51], v[92:95], v[16:19], a[48:51]
  ds_read_b64_tr_b16 v[126:127], v9 offset:18432
  v_mfma_f32_16x16x32_bf16 a[52:55], v[92:95], v[20:23], a[52:55]
  buffer_load_dwordx4 v3, s[16:19], s49 offen lds
  v_mfma_f32_16x16x32_bf16 a[56:59], v[92:95], v[24:27], a[56:59]
  ds_read_b128 v[64:67], v4 offset:40960
  v_mfma_f32_16x16x32_bf16 a[60:63], v[92:95], v[28:31], a[60:63]
  ds_read_b64_tr_b16 v[128:129], v6 offset:20480
  s_add_u32 m0, s52, 1024
  v_mfma_f32_16x16x32_bf16 a[0:3], v[96:99], v[32:35], a[0:3]
  ds_read_b64_tr_b16 v[130:131], v6 offset:22528
  v_mfma_f32_16x16x32_bf16 a[4:7], v[96:99], v[36:39], a[4:7]
  buffer_load_dwordx4 v3, s[16:19], s50 offen lds
  v_mfma_f32_16x16x32_bf16 a[8:11], v[96:99], v[40:43], a[8:11]
  ds_read_b128 v[68:71], v4 offset:41984
  ds_read_b64_tr_b16 v[132:133], v7 offset:20480
  v_mfma_f32_16x16x32_bf16 a[12:15], v[96:99], v[44:47], a[12:15]
  s_add_u32 m0, s52, 8192
  ds_read_b64_tr_b16 v[134:135], v7 offset:22528
  v_mfma_f32_16x16x32_bf16 a[16:19], v[100:103], v[32:35], a[16:19]
  buffer_load_dwordx4 v3, s[20:23], s49 offen lds
  v_mfma_f32_16x16x32_bf16 a[20:23], v[100:103], v[36:39], a[20:23]
  ds_read_b128 v[72:75], v4 offset:43008
  v_mfma_f32_16x16x32_bf16 a[24:27], v[100:103], v[40:43], a[24:27]
  ds_read_b64_tr_b16 v[136:137], v8 offset:20480
  s_add_u32 m0, s52, 9216
  v_mfma_f32_16x16x32_bf16 a[28:31], v[100:103], v[44:47], a[28:31]
  ds_read_b64_tr_b16 v[138:139], v8 offset:22528
  v_mfma_f32_16x16x32_bf16 a[32:35], v[104:107], v[32:35], a[32:35]
  ds_read_b128 v[76:79], v4 offset:44032
  v_mfma_f32_16x16x32_bf16 a[36:39], v[104:107], v[36:39], a[36:39]
  buffer_load_dwordx4 v3, s[20:23], s50 offen lds
  v_mfma_f32_16x16x32_bf16 a[40:43], v[104:107], v[40:43], a[40:43]
  ds_read_b64_tr_b16 v[140:141], v9 offset:20480
  ds_read_b64_tr_b16 v[142:143], v9 offset:22528
  v_mfma_f32_16x16x32_bf16 a[44:47], v[104:107], v[44:47], a[44:47]
  s_add_u32 s49, s49, 131072
  v_mfma_f32_16x16x32_bf16 a[48:51], v[108:111], v[32:35], a[48:51]
  s_add_u32 s50, s50, 131072
  v_mfma_f32_16x16x32_bf16 a[52:55], v[108:111], v[36:39], a[52:55]
  v_mfma_f32_16x16x32_bf16 a[56:59], v[108:111], v[40:43], a[56:59]
  v_mfma_f32_16x16x32_bf16 a[60:63], v[108:111], v[44:47], a[60:63]
  s_waitcnt vmcnt(24) lgkmcnt(0)
  s_barrier
  v_mfma_f32_16x16x32_bf16 a[0:3], v[112:115], v[48:51], a[0:3]
  ds_read_b128 v[16:19], v4 offset:49152
  s_add_u32 m0, s51, 32768
  v_mfma_f32_16x16x32_bf16 a[4:7], v[112:115], v[52:55], a[4:7]
  ds_read_b64_tr_b16 v[80:81], v6 offset:32768
  v_mfma_f32_16x16x32_bf16 a[8:11], v[112:115], v[56:59], a[8:11]
  buffer_load_dwordx4 v2, s[12:15], s48 offen offset:0 sc1 lds
  v_mfma_f32_16x16x32_bf16 a[12:15], v[112:115], v[60:63], a[12:15]
  ds_read_b64_tr_b16 v[82:83], v6 offset:34816
  ds_read_b128 v[20:23], v4 offset:50176
  v_mfma_f32_16x16x32_bf16 a[16:19], v[116:119], v[48:51], a[16:19]
  buffer_load_dwordx4 v2, s[12:15], s48 offen offset:1024 sc1 lds
  v_mfma_f32_16x16x32_bf16 a[20:23], v[116:119], v[52:55], a[20:23]
  ds_read_b64_tr_b16 v[84:85], v7 offset:32768
  ds_read_b64_tr_b16 v[86:87], v7 offset:34816
  v_mfma_f32_16x16x32_bf16 a[24:27], v[116:119], v[56:59], a[24:27]
  buffer_load_dwordx4 v2, s[12:15], s48 offen offset:2048 sc1 lds
  v_mfma_f32_16x16x32_bf16 a[28:31], v[116:119], v[60:63], a[28:31]
  ds_read_b128 v[24:27], v4 offset:51200
  v_mfma_f32_16x16x32_bf16 a[32:35], v[120:123], v[48:51], a[32:35]
  buffer_load_dwordx4 v2, s[12:15], s48 offen offset:3072 sc1 lds
  v_mfma_f32_16x16x32_bf16 a[36:39], v[120:123], v[52:55], a[36:39]
  ds_read_b64_tr_b16 v[88:89], v8 offset:32768
  ds_read_b64_tr_b16 v[90:91], v8 offset:34816
  v_mfma_f32_16x16x32_bf16 a[40:43], v[120:123], v[56:59], a[40:43]
  s_add_u32 s48, s48, 16384
  ds_read_b128 v[28:31], v4 offset:52224
  v_mfma_f32_16x16x32_bf16 a[44:47], v[120:123], v[60:63], a[44:47]
  ds_read_b64_tr_b16 v[92:93], v9 offset:32768
  s_add_u32 m0, s52, 16384
  v_mfma_f32_16x16x32_bf16 a[48:51], v[124:127], v[48:51], a[48:51]
  ds_read_b64_tr_b16 v[94:95], v9 offset:34816
  v_mfma_f32_16x16x32_bf16 a[52:55], v[124:127], v[52:55], a[52:55]
  buffer_load_dwordx4 v3, s[16:19], s49 offen lds
  v_mfma_f32_16x16x32_bf16 a[56:59], v[124:127], v[56:59], a[56:59]
  ds_read_b128 v[32:35], v4 offset:57344
  v_mfma_f32_16x16x32_bf16 a[60:63], v[124:127], v[60:63], a[60:63]
  ds_read_b64_tr_b16 v[96:97], v6 offset:36864
  s_add_u32 m0, s52, 17408
  v_mfma_f32_16x16x32_bf16 a[0:3], v[128:131], v[64:67], a[0:3]
  ds_read_b64_tr_b16 v[98:99], v6 offset:38912
  v_mfma_f32_16x16x32_bf16 a[4:7], v[128:131], v[68:71], a[4:7]
  buffer_load_dwordx4 v3, s[16:19], s50 offen lds
  v_mfma_f32_16x16x32_bf16 a[8:11], v[128:131], v[72:75], a[8:11]
  ds_read_b128 v[36:39], v4 offset:58368
  ds_read_b64_tr_b16 v[100:101], v7 offset:36864
  v_mfma_f32_16x16x32_bf16 a[12:15], v[128:131], v[76:79], a[12:15]
  s_add_u32 m0, s52, 24576
  ds_read_b64_tr_b16 v[102:103], v7 offset:38912
  v_mfma_f32_16x16x32_bf16 a[16:19], v[132:135], v[64:67], a[16:19]
  buffer_load_dwordx4 v3, s[20:23], s49 offen lds
  v_mfma_f32_16x16x32_bf16 a[20:23], v[132:135], v[68:71], a[20:23]
  ds_read_b128 v[40:43], v4 offset:59392
  v_mfma_f32_16x16x32_bf16 a[24:27], v[132:135], v[72:75], a[24:27]
  ds_read_b64_tr_b16 v[104:105], v8 offset:36864
  s_add_u32 m0, s52, 25600
  v_mfma_f32_16x16x32_bf16 a[28:31], v[132:135], v[76:79], a[28:31]
  ds_read_b64_tr_b16 v[106:107], v8 offset:38912
  v_mfma_f32_16x16x32_bf16 a[32:35], v[136:139], v[64:67], a[32:35]
  ds_read_b128 v[44:47], v4 offset:60416
  v_mfma_f32_16x16x32_bf16 a[36:39], v[136:139], v[68:71], a[36:39]
  buffer_load_dwordx4 v3, s[20:23], s50 offen lds
  v_mfma_f32_16x16x32_bf16 a[40:43], v[136:139], v[72:75], a[40:43]
  ds_read_b64_tr_b16 v[108:109], v9 offset:36864
  ds_read_b64_tr_b16 v[110:111], v9 offset:38912
  v_mfma_f32_16x16x32_bf16 a[44:47], v[136:139], v[76:79], a[44:47]
  s_add_u32 s49, s49, 131072
  v_mfma_f32_16x16x32_bf16 a[48:51], v[140:143], v[64:67], a[48:51]
  s_add_u32 s50, s50, 131072
  v_mfma_f32_16x16x32_bf16 a[52:55], v[140:143], v[68:71], a[52:55]
  v_mfma_f32_16x16x32_bf16 a[56:59], v[140:143], v[72:75], a[56:59]
  v_mfma_f32_16x16x32_bf16 a[60:63], v[140:143], v[76:79], a[60:63]
  s_waitcnt vmcnt(24) lgkmcnt(0)
  s_barrier
  v_mfma_f32_16x16x32_bf16 a[0:3], v[80:83], v[16:19], a[0:3]
  ds_read_b128 v[48:51], v5 offset:0
  s_add_u32 m0, s51, 49152
  v_mfma_f32_16x16x32_bf16 a[4:7], v[80:83], v[20:23], a[4:7]
  ds_read_b64_tr_b16 v[112:113], v6 offset:49152
  v_mfma_f32_16x16x32_bf16 a[8:11], v[80:83], v[24:27], a[8:11]
  buffer_load_dwordx4 v2, s[12:15], s48 offen offset:0 sc1 lds
  v_mfma_f32_16x16x32_bf16 a[12:15], v[80:83], v[28:31], a[12:15]
  ds_read_b64_tr_b16 v[114:115], v6 offset:51200
  ds_read_b128 v[52:55], v5 offset:1024
  v_mfma_f32_16x16x32_bf16 a[16:19], v[84:87], v[16:19], a[16:19]
  buffer_load_dwordx4 v2, s[12:15], s48 offen offset:1024 sc1 lds
  v_mfma_f32_16x16x32_bf16 a[20:23], v[84:87], v[20:23], a[20:23]
  ds_read_b64_tr_b16 v[116:117], v7 offset:49152
  ds_read_b64_tr_b16 v[118:119], v7 offset:51200
  v_mfma_f32_16x16x32_bf16 a[24:27], v[84:87], v[24:27], a[24:27]
  buffer_load_dwordx4 v2, s[12:15], s48 offen offset:2048 sc1 lds
  v_mfma_f32_16x16x32_bf16 a[28:31], v[84:87], v[28:31], a[28:31]
  ds_read_b128 v[56:59], v5 offset:2048
  v_mfma_f32_16x16x32_bf16 a[32:35], v[88:91], v[16:19], a[32:35]
  buffer_load_dwordx4 v2, s[12:15], s48 offen offset:3072 sc1 lds
  v_mfma_f32_16x16x32_bf16 a[36:39], v[88:91], v[20:23], a[36:39]
  ds_read_b64_tr_b16 v[120:121], v8 offset:49152
  ds_read_b64_tr_b16 v[122:123], v8 offset:51200
  v_mfma_f32_16x16x32_bf16 a[40:43], v[88:91], v[24:27], a[40:43]
  s_add_u32 s48, s48, 16384
  ds_read_b128 v[60:63], v5 offset:3072
  v_mfma_f32_16x16x32_bf16 a[44:47], v[88:91], v[28:31], a[44:47]
  ds_read_b64_tr_b16 v[124:125], v9 offset:49152
  s_add_u32 m0, s52, 32768
  v_mfma_f32_16x16x32_bf16 a[48:51], v[92:95], v[16:19], a[48:51]
  ds_read_b64_tr_b16 v[126:127], v9 offset:51200
  v_mfma_f32_16x16x32_bf16 a[52:55], v[92:95], v[20:23], a[52:55]
  buffer_load_dwordx4 v3, s[16:19], s49 offen lds
  v_mfma_f32_16x16x32_bf16 a[56:59], v[92:95], v[24:27], a[56:59]
  ds_read_b128 v[64:67], v5 offset:8192
  v_mfma_f32_16x16x32_bf16 a[60:63], v[92:95], v[28:31], a[60:63]
  ds_read_b64_tr_b16 v[128:129], v6 offset:53248
  s_add_u32 m0, s52, 33792
  v_mfma_f32_16x16x32_bf16 a[0:3], v[96:99], v[32:35], a[0:3]
  ds_read_b64_tr_b16 v[130:131], v6 offset:55296
  v_mfma_f32_16x16x32_bf16 a[4:7], v[96:99], v[36:39], a[4:7]
  buffer_load_dwordx4 v3, s[16:19], s50 offen lds
  v_mfma_f32_16x16x32_bf16 a[8:11], v[96:99], v[40:43], a[8:11]
  ds_read_b128 v[68:71], v5 offset:9216
  ds_read_b64_tr_b16 v[132:133], v7 offset:53248
  v_mfma_f32_16x16x32_bf16 a[12:15], v[96:99], v[44:47], a[12:15]
  s_add_u32 m0, s52, 40960
  ds_read_b64_tr_b16 v[134:135], v7 offset:55296
  v_mfma_f32_16x16x32_bf16 a[16:19], v[100:103], v[32:35], a[16:19]
  buffer_load_dwordx4 v3, s[20:23], s49 offen lds
  v_mfma_f32_16x16x32_bf16 a[20:23], v[100:103], v[36:39], a[20:23]
  ds_read_b128 v[72:75], v5 offset:10240
  v_mfma_f32_16x16x32_bf16 a[24:27], v[100:103], v[40:43], a[24:27]
  ds_read_b64_tr_b16 v[136:137], v8 offset:53248
  s_add_u32 m0, s52, 41984
  v_mfma_f32_16x16x32_bf16 a[28:31], v[100:103], v[44:47], a[28:31]
  ds_read_b64_tr_b16 v[138:139], v8 offset:55296
  v_mfma_f32_16x16x32_bf16 a[32:35], v[104:107], v[32:35], a[32:35]
  ds_read_b128 v[76:79], v5 offset:11264
  v_mfma_f32_16x16x32_bf16 a[36:39], v[104:107], v[36:39], a[36:39]
  buffer_load_dwordx4 v3, s[20:23], s50 offen lds
  v_mfma_f32_16x16x32_bf16 a[40:43], v[104:107], v[40:43], a[40:43]
  ds_read_b64_tr_b16 v[140:141], v9 offset:53248
  ds_read_b64_tr_b16 v[142:143], v9 offset:55296
  v_mfma_f32_16x16x32_bf16 a[44:47], v[104:107], v[44:47], a[44:47]
  s_add_u32 s49, s49, 131072
  v_mfma_f32_16x16x32_bf16 a[48:51], v[108:111], v[32:35], a[48:51]
  s_add_u32 s50, s50, 131072
  v_mfma_f32_16x16x32_bf16 a[52:55], v[108:111], v[36:39], a[52:55]
  v_mfma_f32_16x16x32_bf16 a[56:59], v[108:111], v[40:43], a[56:59]
  v_mfma_f32_16x16x32_bf16 a[60:63], v[108:111], v[44:47], a[60:63]
  s_waitcnt vmcnt(24) lgkmcnt(0)
  s_barrier
  v_mfma_f32_16x16x32_bf16 a[0:3], v[112:115], v[48:51], a[0:3]
  ds_read_b128 v[16:19], v4 offset:0
  s_add_u32 m0, s51, 65536
  v_mfma_f32_16x16x32_bf16 a[4:7], v[112:115], v[52:55], a[4:7]
  ds_read_b64_tr_b16 v[80:81], v10 offset:0
  v_mfma_f32_16x16x32_bf16 a[8:11], v[112:115], v[56:59], a[8:11]
  buffer_load_dwordx4 v2, s[12:15], s48 offen offset:0 sc1 lds
  v_mfma_f32_16x16x32_bf16 a[12:15], v[112:115], v[60:63], a[12:15]
  ds_read_b64_tr_b16 v[82:83], v10 offset:2048
  ds_read_b128 v[20:23], v4 offset:1024
  v_mfma_f32_16x16x32_bf16 a[16:19], v[116:119], v[48:51], a[16:19]
  buffer_load_dwordx4 v2, s[12:15], s48 offen offset:1024 sc1 lds
  v_mfma_f32_16x16x32_bf16 a[20:23], v[116:119], v[52:55], a[20:23]
  ds_read_b64_tr_b16 v[84:85], v11 offset:0
  ds_read_b64_tr_b16 v[86:87], v11 offset:2048
  v_mfma_f32_16x16x32_bf16 a[24:27], v[116:119], v[56:59], a[24:27]
  buffer_load_dwordx4 v2, s[12:15], s48 offen offset:2048 sc1 lds
  v_mfma_f32_16x16x32_bf16 a[28:31], v[116:119], v[60:63], a[28:31]
  ds_read_b128 v[24:27], v4 offset:2048
  v_mfma_f32_16x16x32_bf16 a[32:35], v[120:123], v[48:51], a[32:35]
  buffer_load_dwordx4 v2, s[12:15], s48 offen offset:3072 sc1 lds
  v_mfma_f32_16x16x32_bf16 a[36:39], v[120:123], v[52:55], a[36:39]
  ds_read_b64_tr_b16 v[88:89], v12 offset:0
  ds_read_b64_tr_b16 v[90:91], v12 offset:2048
  v_mfma_f32_16x16x32_bf16 a[40:43], v[120:123], v[56:59], a[40:43]
  s_add_u32 s48, s48, 16384
  ds_read_b128 v[28:31], v4 offset:3072
  v_mfma_f32_16x16x32_bf16 a[44:47], v[120:123], v[60:63], a[44:47]
  ds_read_b64_tr_b16 v[92:93], v13 offset:0
  s_add_u32 m0, s52, 49152
  v_mfma_f32_16x16x32_bf16 a[48:51], v[124:127], v[48:51], a[48:51]
  ds_read_b64_tr_b16 v[94:95], v13 offset:2048
  v_mfma_f32_16x16x32_bf16 a[52:55], v[124:127], v[52:55], a[52:55]
  buffer_load_dwordx4 v3, s[16:19], s49 offen lds
  v_mfma_f32_16x16x32_bf16 a[56:59], v[124:127], v[56:59], a[56:59]
  ds_read_b128 v[32:35], v4 offset:8192
  v_mfma_f32_16x16x32_bf16 a[60:63], v[124:127], v[60:63], a[60:63]
  ds_read_b64_tr_b16 v[96:97], v10 offset:4096
  s_add_u32 m0, s52, 50176
  v_mfma_f32_16x16x32_bf16 a[0:3], v[128:131], v[64:67], a[0:3]
  ds_read_b64_tr_b16 v[98:99], v10 offset:6144
  v_mfma_f32_16x16x32_bf16 a[4:7], v[128:131], v[68:71], a[4:7]
  buffer_load_dwordx4 v3, s[16:19], s50 offen lds
  v_mfma_f32_16x16x32_bf16 a[8:11], v[128:131], v[72:75], a[8:11]
  ds_read_b128 v[36:39], v4 offset:9216
  ds_read_b64_tr_b16 v[100:101], v11 offset:4096
  v_mfma_f32_16x16x32_bf16 a[12:15], v[128:131], v[76:79], a[12:15]
  s_add_u32 m0, s52, 57344
  ds_read_b64_tr_b16 v[102:103], v11 offset:6144
  v_mfma_f32_16x16x32_bf16 a[16:19], v[132:135], v[64:67], a[16:19]
  buffer_load_dwordx4 v3, s[20:23], s49 offen lds
  v_mfma_f32_16x16x32_bf16 a[20:23], v[132:135], v[68:71], a[20:23]
  ds_read_b128 v[40:43], v4 offset:10240
  v_mfma_f32_16x16x32_bf16 a[24:27], v[132:135], v[72:75], a[24:27]
  ds_read_b64_tr_b16 v[104:105], v12 offset:4096
  s_add_u32 m0, s52, 58368
  v_mfma_f32_16x16x32_bf16 a[28:31], v[132:135], v[76:79], a[28:31]
  ds_read_b64_tr_b16 v[106:107], v12 offset:6144
  v_mfma_f32_16x16x32_bf16 a[32:35], v[136:139], v[64:67], a[32:35]
  ds_read_b128 v[44:47], v4 offset:11264
  v_mfma_f32_16x16x32_bf16 a[36:39], v[136:139], v[68:71], a[36:39]
  buffer_load_dwordx4 v3, s[20:23], s50 offen lds
  v_mfma_f32_16x16x32_bf16 a[40:43], v[136:139], v[72:75], a[40:43]
  ds_read_b64_tr_b16 v[108:109], v13 offset:4096
  ds_read_b64_tr_b16 v[110:111], v13 offset:6144
  v_mfma_f32_16x16x32_bf16 a[44:47], v[136:139], v[76:79], a[44:47]
  s_add_u32 s49, s49, 131072
  v_mfma_f32_16x16x32_bf16 a[48:51], v[140:143], v[64:67], a[48:51]
  s_add_u32 s50, s50, 131072
  v_mfma_f32_16x16x32_bf16 a[52:55], v[140:143], v[68:71], a[52:55]
  v_mfma_f32_16x16x32_bf16 a[56:59], v[140:143], v[72:75], a[56:59]
  v_mfma_f32_16x16x32_bf16 a[60:63], v[140:143], v[76:79], a[60:63]
  s_waitcnt vmcnt(24) lgkmcnt(0)
  s_barrier
  v_mfma_f32_16x16x32_bf16 a[0:3], v[80:83], v[16:19], a[0:3]
  ds_read_b128 v[48:51], v4 offset:16384
  s_add_u32 m0, s51, 0
  v_mfma_f32_16x16x32_bf16 a[4:7], v[80:83], v[20:23], a[4:7]
  ds_read_b64_tr_b16 v[112:113], v6 offset:0
  v_mfma_f32_16x16x32_bf16 a[8:11], v[80:83], v[24:27], a[8:11]
  buffer_load_dwordx4 v2, s[12:15], s48 offen offset:0 sc1 lds
  v_mfma_f32_16x16x32_bf16 a[12:15], v[80:83], v[28:31], a[12:15]
  ds_read_b64_tr_b16 v[114:115], v6 offset:2048
  ds_read_b128 v[52:55], v4 offset:17408
  v_mfma_f32_16x16x32_bf16 a[16:19], v[84:87], v[16:19], a[16:19]
  buffer_load_dwordx4 v2, s[12:15], s48 offen offset:1024 sc1 lds
  v_mfma_f32_16x16x32_bf16 a[20:23], v[84:87], v[20:23], a[20:23]
  ds_read_b64_tr_b16 v[116:117], v7 offset:0
  ds_read_b64_tr_b16 v[118:119], v7 offset:2048
  v_mfma_f32_16x16x32_bf16 a[24:27], v[84:87], v[24:27], a[24:27]
  buffer_load_dwordx4 v2, s[12:15], s48 offen offset:2048 sc1 lds
  v_mfma_f32_16x16x32_bf16 a[28:31], v[84:87], v[28:31], a[28:31]
  ds_read_b128 v[56:59], v4 offset:18432
  v_mfma_f32_16x16x32_bf16 a[32:35], v[88:91], v[16:19], a[32:35]
  buffer_load_dwordx4 v2, s[12:15], s48 offen offset:3072 sc1 lds
  v_mfma_f32_16x16x32_bf16 a[36:39], v[88:91], v[20:23], a[36:39]
  ds_read_b64_tr_b16 v[120:121], v8 offset:0
  ds_read_b64_tr_b16 v[122:123], v8 offset:2048
  v_mfma_f32_16x16x32_bf16 a[40:43], v[88:91], v[24:27], a[40:43]
  s_add_u32 s48, s48, 16384
  ds_read_b128 v[60:63], v4 offset:19456
  v_mfma_f32_16x16x32_bf16 a[44:47], v[88:91], v[28:31], a[44:47]
  ds_read_b64_tr_b16 v[124:125], v9 offset:0
  s_add_u32 m0, s52, 65536
  v_mfma_f32_16x16x32_bf16 a[48:51], v[92:95], v[16:19], a[48:51]
  ds_read_b64_tr_b16 v[126:127], v9 offset:2048
  v_mfma_f32_16x16x32_bf16 a[52:55], v[92:95], v[20:23], a[52:55]
  buffer_load_dwordx4 v3, s[16:19], s49 offen lds
  v_mfma_f32_16x16x32_bf16 a[56:59], v[92:95], v[24:27], a[56:59]
  ds_read_b128 v[64:67], v4 offset:24576
  v_mfma_f32_16x16x32_bf16 a[60:63], v[92:95], v[28:31], a[60:63]
  ds_read_b64_tr_b16 v[128:129], v6 offset:4096
  s_add_u32 m0, s52, 66560
  v_mfma_f32_16x16x32_bf16 a[0:3], v[96:99], v[32:35], a[0:3]
  ds_read_b64_tr_b16 v[130:131], v6 offset:6144
  v_mfma_f32_16x16x32_bf16 a[4:7], v[96:99], v[36:39], a[4:7]
  buffer_load_dwordx4 v3, s[16:19], s50 offen lds
  v_mfma_f32_16x16x32_bf16 a[8:11], v[96:99], v[40:43], a[8:11]
  ds_read_b128 v[68:71], v4 offset:25600
  ds_read_b64_tr_b16 v[132:133], v7 offset:4096
  v_mfma_f32_16x16x32_bf16 a[12:15], v[96:99], v[44:47], a[12:15]
  s_add_u32 m0, s52, 73728
  ds_read_b64_tr_b16 v[134:135], v7 offset:6144
  v_mfma_f32_16x16x32_bf16 a[16:19], v[100:103], v[32:35], a[16:19]
  buffer_load_dwordx4 v3, s[20:23], s49 offen lds
  v_mfma_f32_16x16x32_bf16 a[20:23], v[100:103], v[36:39], a[20:23]
  ds_read_b128 v[72:75], v4 offset:26624
  v_mfma_f32_16x16x32_bf16 a[24:27], v[100:103], v[40:43], a[24:27]
  ds_read_b64_tr_b16 v[136:137], v8 offset:4096
  s_add_u32 m0, s52, 74752
  v_mfma_f32_16x16x32_bf16 a[28:31], v[100:103], v[44:47], a[28:31]
  ds_read_b64_tr_b16 v[138:139], v8 offset:6144
  v_mfma_f32_16x16x32_bf16 a[32:35], v[104:107], v[32:35], a[32:35]
  ds_read_b128 v[76:79], v4 offset:27648
  v_mfma_f32_16x16x32_bf16 a[36:39], v[104:107], v[36:39], a[36:39]
  buffer_load_dwordx4 v3, s[20:23], s50 offen lds
  v_mfma_f32_16x16x32_bf16 a[40:43], v[104:107], v[40:43], a[40:43]
  ds_read_b64_tr_b16 v[140:141], v9 offset:4096
  ds_read_b64_tr_b16 v[142:143], v9 offset:6144
  v_mfma_f32_16x16x32_bf16 a[44:47], v[104:107], v[44:47], a[44:47]
  s_add_u32 s49, s49, 131072
  v_mfma_f32_16x16x32_bf16 a[48:51], v[108:111], v[32:35], a[48:51]
  s_add_u32 s50, s50, 131072
  v_mfma_f32_16x16x32_bf16 a[52:55], v[108:111], v[36:39], a[52:55]
  v_mfma_f32_16x16x32_bf16 a[56:59], v[108:111], v[40:43], a[56:59]
  v_mfma_f32_16x16x32_bf16 a[60:63], v[108:111], v[44:47], a[60:63]
  s_waitcnt vmcnt(24) lgkmcnt(0)
  s_barrier
  v_mfma_f32_16x16x32_bf16 a[0:3], v[112:115], v[48:51], a[0:3]
  ds_read_b128 v[16:19], v4 offset:32768
  v_mfma_f32_16x16x32_bf16 a[4:7], v[112:115], v[52:55], a[4:7]
  ds_read_b64_tr_b16 v[80:81], v6 offset:16384
  v_mfma_f32_16x16x32_bf16 a[8:11], v[112:115], v[56:59], a[8:11]
  ds_read_b64_tr_b16 v[82:83], v6 offset:18432
  v_mfma_f32_16x16x32_bf16 a[12:15], v[112:115], v[60:63], a[12:15]
  ds_read_b128 v[20:23], v4 offset:33792
  v_mfma_f32_16x16x32_bf16 a[16:19], v[116:119], v[48:51], a[16:19]
  ds_read_b64_tr_b16 v[84:85], v7 offset:16384
  v_mfma_f32_16x16x32_bf16 a[20:23], v[116:119], v[52:55], a[20:23]
  ds_read_b64_tr_b16 v[86:87], v7 offset:18432
  v_mfma_f32_16x16x32_bf16 a[24:27], v[116:119], v[56:59], a[24:27]
  v_mfma_f32_16x16x32_bf16 a[28:31], v[116:119], v[60:63], a[28:31]
  ds_read_b128 v[24:27], v4 offset:34816
  v_mfma_f32_16x16x32_bf16 a[32:35], v[120:123], v[48:51], a[32:35]
  ds_read_b64_tr_b16 v[88:89], v8 offset:16384
  v_mfma_f32_16x16x32_bf16 a[36:39], v[120:123], v[52:55], a[36:39]
  ds_read_b64_tr_b16 v[90:91], v8 offset:18432
  v_mfma_f32_16x16x32_bf16 a[40:43], v[120:123], v[56:59], a[40:43]
  ds_read_b128 v[28:31], v4 offset:35840
  v_mfma_f32_16x16x32_bf16 a[44:47], v[120:123], v[60:63], a[44:47]
  ds_read_b64_tr_b16 v[92:93], v9 offset:16384
  v_mfma_f32_16x16x32_bf16 a[48:51], v[124:127], v[48:51], a[48:51]
  ds_read_b64_tr_b16 v[94:95], v9 offset:18432
  v_mfma_f32_16x16x32_bf16 a[52:55], v[124:127], v[52:55], a[52:55]
  v_mfma_f32_16x16x32_bf16 a[56:59], v[124:127], v[56:59], a[56:59]
  ds_read_b128 v[32:35], v4 offset:40960
  v_mfma_f32_16x16x32_bf16 a[60:63], v[124:127], v[60:63], a[60:63]
  ds_read_b64_tr_b16 v[96:97], v6 offset:20480
  v_mfma_f32_16x16x32_bf16 a[0:3], v[128:131], v[64:67], a[0:3]
  ds_read_b64_tr_b16 v[98:99], v6 offset:22528
  v_mfma_f32_16x16x32_bf16 a[4:7], v[128:131], v[68:71], a[4:7]
  ds_read_b128 v[36:39], v4 offset:41984
  v_mfma_f32_16x16x32_bf16 a[8:11], v[128:131], v[72:75], a[8:11]
  ds_read_b64_tr_b16 v[100:101], v7 offset:20480
  v_mfma_f32_16x16x32_bf16 a[12:15], v[128:131], v[76:79], a[12:15]
  ds_read_b64_tr_b16 v[102:103], v7 offset:22528
  v_mfma_f32_16x16x32_bf16 a[16:19], v[132:135], v[64:67], a[16:19]
  v_mfma_f32_16x16x32_bf16 a[20:23], v[132:135], v[68:71], a[20:23]
  ds_read_b128 v[40:43], v4 offset:43008
  v_mfma_f32_16x16x32_bf16 a[24:27], v[132:135], v[72:75], a[24:27]
  ds_read_b64_tr_b16 v[104:105], v8 offset:20480
  v_mfma_f32_16x16x32_bf16 a[28:31], v[132:135], v[76:79], a[28:31]
  ds_read_b64_tr_b16 v[106:107], v8 offset:22528
  v_mfma_f32_16x16x32_bf16 a[32:35], v[136:139], v[64:67], a[32:35]
  ds_read_b128 v[44:47], v4 offset:44032
  v_mfma_f32_16x16x32_bf16 a[36:39], v[136:139], v[68:71], a[36:39]
  ds_read_b64_tr_b16 v[108:109], v9 offset:20480
  v_mfma_f32_16x16x32_bf16 a[40:43], v[136:139], v[72:75], a[40:43]
  ds_read_b64_tr_b16 v[110:111], v9 offset:22528
  v_mfma_f32_16x16x32_bf16 a[44:47], v[136:139], v[76:79], a[44:47]
  v_mfma_f32_16x16x32_bf16 a[48:51], v[140:143], v[64:67], a[48:51]
  v_mfma_f32_16x16x32_bf16 a[52:55], v[140:143], v[68:71], a[52:55]
  v_mfma_f32_16x16x32_bf16 a[56:59], v[140:143], v[72:75], a[56:59]
  v_mfma_f32_16x16x32_bf16 a[60:63], v[140:143], v[76:79], a[60:63]
  s_waitcnt vmcnt(16) lgkmcnt(0)
  s_barrier
  v_mfma_f32_16x16x32_bf16 a[0:3], v[80:83], v[16:19], a[0:3]
  ds_read_b128 v[48:51], v4 offset:49152
  v_mfma_f32_16x16x32_bf16 a[4:7], v[80:83], v[20:23], a[4:7]
  ds_read_b64_tr_b16 v[112:113], v6 offset:32768
  v_mfma_f32_16x16x32_bf16 a[8:11], v[80:83], v[24:27], a[8:11]
  ds_read_b64_tr_b16 v[114:115], v6 offset:34816
  v_mfma_f32_16x16x32_bf16 a[12:15], v[80:83], v[28:31], a[12:15]
  ds_read_b128 v[52:55], v4 offset:50176
  v_mfma_f32_16x16x32_bf16 a[16:19], v[84:87], v[16:19], a[16:19]
  ds_read_b64_tr_b16 v[116:117], v7 offset:32768
  v_mfma_f32_16x16x32_bf16 a[20:23], v[84:87], v[20:23], a[20:23]
  ds_read_b64_tr_b16 v[118:119], v7 offset:34816
  v_mfma_f32_16x16x32_bf16 a[24:27], v[84:87], v[24:27], a[24:27]
  v_mfma_f32_16x16x32_bf16 a[28:31], v[84:87], v[28:31], a[28:31]
  ds_read_b128 v[56:59], v4 offset:51200
  v_mfma_f32_16x16x32_bf16 a[32:35], v[88:91], v[16:19], a[32:35]
  ds_read_b64_tr_b16 v[120:121], v8 offset:32768
  v_mfma_f32_16x16x32_bf16 a[36:39], v[88:91], v[20:23], a[36:39]
  ds_read_b64_tr_b16 v[122:123], v8 offset:34816
  v_mfma_f32_16x16x32_bf16 a[40:43], v[88:91], v[24:27], a[40:43]
  ds_read_b128 v[60:63], v4 offset:52224
  v_mfma_f32_16x16x32_bf16 a[44:47], v[88:91], v[28:31], a[44:47]
  ds_read_b64_tr_b16 v[124:125], v9 offset:32768
  v_mfma_f32_16x16x32_bf16 a[48:51], v[92:95], v[16:19], a[48:51]
  ds_read_b64_tr_b16 v[126:127], v9 offset:34816
  v_mfma_f32_16x16x32_bf16 a[52:55], v[92:95], v[20:23], a[52:55]
  v_mfma_f32_16x16x32_bf16 a[56:59], v[92:95], v[24:27], a[56:59]
  ds_read_b128 v[64:67], v4 offset:57344
  v_mfma_f32_16x16x32_bf16 a[60:63], v[92:95], v[28:31], a[60:63]
  ds_read_b64_tr_b16 v[128:129], v6 offset:36864
  v_mfma_f32_16x16x32_bf16 a[0:3], v[96:99], v[32:35], a[0:3]
  ds_read_b64_tr_b16 v[130:131], v6 offset:38912
  v_mfma_f32_16x16x32_bf16 a[4:7], v[96:99], v[36:39], a[4:7]
  ds_read_b128 v[68:71], v4 offset:58368
  v_mfma_f32_16x16x32_bf16 a[8:11], v[96:99], v[40:43], a[8:11]
  ds_read_b64_tr_b16 v[132:133], v7 offset:36864
  v_mfma_f32_16x16x32_bf16 a[12:15], v[96:99], v[44:47], a[12:15]
  ds_read_b64_tr_b16 v[134:135], v7 offset:38912
  v_mfma_f32_16x16x32_bf16 a[16:19], v[100:103], v[32:35], a[16:19]
  v_mfma_f32_16x16x32_bf16 a[20:23], v[100:103], v[36:39], a[20:23]
  ds_read_b128 v[72:75], v4 offset:59392
  v_mfma_f32_16x16x32_bf16 a[24:27], v[100:103], v[40:43], a[24:27]
  ds_read_b64_tr_b16 v[136:137], v8 offset:36864
  v_mfma_f32_16x16x32_bf16 a[28:31], v[100:103], v[44:47], a[28:31]
  ds_read_b64_tr_b16 v[138:139], v8 offset:38912
  v_mfma_f32_16x16x32_bf16 a[32:35], v[104:107], v[32:35], a[32:35]
  ds_read_b128 v[76:79], v4 offset:60416
  v_mfma_f32_16x16x32_bf16 a[36:39], v[104:107], v[36:39], a[36:39]
  ds_read_b64_tr_b16 v[140:141], v9 offset:36864
  v_mfma_f32_16x16x32_bf16 a[40:43], v[104:107], v[40:43], a[40:43]
  ds_read_b64_tr_b16 v[142:143], v9 offset:38912
  v_mfma_f32_16x16x32_bf16 a[44:47], v[104:107], v[44:47], a[44:47]
  v_mfma_f32_16x16x32_bf16 a[48:51], v[108:111], v[32:35], a[48:51]
  v_mfma_f32_16x16x32_bf16 a[52:55], v[108:111], v[36:39], a[52:55]
  v_mfma_f32_16x16x32_bf16 a[56:59], v[108:111], v[40:43], a[56:59]
  v_mfma_f32_16x16x32_bf16 a[60:63], v[108:111], v[44:47], a[60:63]
  s_waitcnt vmcnt(8) lgkmcnt(0)
  s_barrier
  v_mfma_f32_16x16x32_bf16 a[0:3], v[112:115], v[48:51], a[0:3]
  ds_read_b128 v[16:19], v5 offset:0
  v_mfma_f32_16x16x32_bf16 a[4:7], v[112:115], v[52:55], a[4:7]
  ds_read_b64_tr_b16 v[80:81], v6 offset:49152
  v_mfma_f32_16x16x32_bf16 a[8:11], v[112:115], v[56:59], a[8:11]
  ds_read_b64_tr_b16 v[82:83], v6 offset:51200
  v_mfma_f32_16x16x32_bf16 a[12:15], v[112:115], v[60:63], a[12:15]
  ds_read_b128 v[20:23], v5 offset:1024
  v_mfma_f32_16x16x32_bf16 a[16:19], v[116:119], v[48:51], a[16:19]
  ds_read_b64_tr_b16 v[84:85], v7 offset:49152
  v_mfma_f32_16x16x32_bf16 a[20:23], v[116:119], v[52:55], a[20:23]
  ds_read_b64_tr_b16 v[86:87], v7 offset:51200
  v_mfma_f32_16x16x32_bf16 a[24:27], v[116:119], v[56:59], a[24:27]
  v_mfma_f32_16x16x32_bf16 a[28:31], v[116:119], v[60:63], a[28:31]
  ds_read_b128 v[24:27], v5 offset:2048
  v_mfma_f32_16x16x32_bf16 a[32:35], v[120:123], v[48:51], a[32:35]
  ds_read_b64_tr_b16 v[88:89], v8 offset:49152
  v_mfma_f32_16x16x32_bf16 a[36:39], v[120:123], v[52:55], a[36:39]
  ds_read_b64_tr_b16 v[90:91], v8 offset:51200
  v_mfma_f32_16x16x32_bf16 a[40:43], v[120:123], v[56:59], a[40:43]
  ds_read_b128 v[28:31], v5 offset:3072
  v_mfma_f32_16x16x32_bf16 a[44:47], v[120:123], v[60:63], a[44:47]
  ds_read_b64_tr_b16 v[92:93], v9 offset:49152
  v_mfma_f32_16x16x32_bf16 a[48:51], v[124:127], v[48:51], a[48:51]
  ds_read_b64_tr_b16 v[94:95], v9 offset:51200
  v_mfma_f32_16x16x32_bf16 a[52:55], v[124:127], v[52:55], a[52:55]
  v_mfma_f32_16x16x32_bf16 a[56:59], v[124:127], v[56:59], a[56:59]
  ds_read_b128 v[32:35], v5 offset:8192
  v_mfma_f32_16x16x32_bf16 a[60:63], v[124:127], v[60:63], a[60:63]
  ds_read_b64_tr_b16 v[96:97], v6 offset:53248
  v_mfma_f32_16x16x32_bf16 a[0:3], v[128:131], v[64:67], a[0:3]
  ds_read_b64_tr_b16 v[98:99], v6 offset:55296
  v_mfma_f32_16x16x32_bf16 a[4:7], v[128:131], v[68:71], a[4:7]
  ds_read_b128 v[36:39], v5 offset:9216
  v_mfma_f32_16x16x32_bf16 a[8:11], v[128:131], v[72:75], a[8:11]
  ds_read_b64_tr_b16 v[100:101], v7 offset:53248
  v_mfma_f32_16x16x32_bf16 a[12:15], v[128:131], v[76:79], a[12:15]
  ds_read_b64_tr_b16 v[102:103], v7 offset:55296
  v_mfma_f32_16x16x32_bf16 a[16:19], v[132:135], v[64:67], a[16:19]
  v_mfma_f32_16x16x32_bf16 a[20:23], v[132:135], v[68:71], a[20:23]
  ds_read_b128 v[40:43], v5 offset:10240
  v_mfma_f32_16x16x32_bf16 a[24:27], v[132:135], v[72:75], a[24:27]
  ds_read_b64_tr_b16 v[104:105], v8 offset:53248
  v_mfma_f32_16x16x32_bf16 a[28:31], v[132:135], v[76:79], a[28:31]
  ds_read_b64_tr_b16 v[106:107], v8 offset:55296
  v_mfma_f32_16x16x32_bf16 a[32:35], v[136:139], v[64:67], a[32:35]
  ds_read_b128 v[44:47], v5 offset:11264
  v_mfma_f32_16x16x32_bf16 a[36:39], v[136:139], v[68:71], a[36:39]
  ds_read_b64_tr_b16 v[108:109], v9 offset:53248
  v_mfma_f32_16x16x32_bf16 a[40:43], v[136:139], v[72:75], a[40:43]
  ds_read_b64_tr_b16 v[110:111], v9 offset:55296
  v_mfma_f32_16x16x32_bf16 a[44:47], v[136:139], v[76:79], a[44:47]
  v_mfma_f32_16x16x32_bf16 a[48:51], v[140:143], v[64:67], a[48:51]
  v_mfma_f32_16x16x32_bf16 a[52:55], v[140:143], v[68:71], a[52:55]
  v_mfma_f32_16x16x32_bf16 a[56:59], v[140:143], v[72:75], a[56:59]
  v_mfma_f32_16x16x32_bf16 a[60:63], v[140:143], v[76:79], a[60:63]
  s_waitcnt vmcnt(0) lgkmcnt(0)
  s_barrier
  v_mfma_f32_16x16x32_bf16 a[0:3], v[80:83], v[16:19], a[0:3]
  ds_read_b128 v[48:51], v4 offset:0
  v_mfma_f32_16x16x32_bf16 a[4:7], v[80:83], v[20:23], a[4:7]
  ds_read_b64_tr_b16 v[112:113], v10 offset:0
  v_mfma_f32_16x16x32_bf16 a[8:11], v[80:83], v[24:27], a[8:11]
  ds_read_b64_tr_b16 v[114:115], v10 offset:2048
  v_mfma_f32_16x16x32_bf16 a[12:15], v[80:83], v[28:31], a[12:15]
  ds_read_b128 v[52:55], v4 offset:1024
  v_mfma_f32_16x16x32_bf16 a[16:19], v[84:87], v[16:19], a[16:19]
  ds_read_b64_tr_b16 v[116:117], v11 offset:0
  v_mfma_f32_16x16x32_bf16 a[20:23], v[84:87], v[20:23], a[20:23]
  ds_read_b64_tr_b16 v[118:119], v11 offset:2048
  v_mfma_f32_16x16x32_bf16 a[24:27], v[84:87], v[24:27], a[24:27]
  v_mfma_f32_16x16x32_bf16 a[28:31], v[84:87], v[28:31], a[28:31]
  ds_read_b128 v[56:59], v4 offset:2048
  v_mfma_f32_16x16x32_bf16 a[32:35], v[88:91], v[16:19], a[32:35]
  ds_read_b64_tr_b16 v[120:121], v12 offset:0
  v_mfma_f32_16x16x32_bf16 a[36:39], v[88:91], v[20:23], a[36:39]
  ds_read_b64_tr_b16 v[122:123], v12 offset:2048
  v_mfma_f32_16x16x32_bf16 a[40:43], v[88:91], v[24:27], a[40:43]
  ds_read_b128 v[60:63], v4 offset:3072
  v_mfma_f32_16x16x32_bf16 a[44:47], v[88:91], v[28:31], a[44:47]
  ds_read_b64_tr_b16 v[124:125], v13 offset:0
  v_mfma_f32_16x16x32_bf16 a[48:51], v[92:95], v[16:19], a[48:51]
  ds_read_b64_tr_b16 v[126:127], v13 offset:2048
  v_mfma_f32_16x16x32_bf16 a[52:55], v[92:95], v[20:23], a[52:55]
  v_mfma_f32_16x16x32_bf16 a[56:59], v[92:95], v[24:27], a[56:59]
  ds_read_b128 v[64:67], v4 offset:8192
  v_mfma_f32_16x16x32_bf16 a[60:63], v[92:95], v[28:31], a[60:63]
  ds_read_b64_tr_b16 v[128:129], v10 offset:4096
  v_mfma_f32_16x16x32_bf16 a[0:3], v[96:99], v[32:35], a[0:3]
  ds_read_b64_tr_b16 v[130:131], v10 offset:6144
  v_mfma_f32_16x16x32_bf16 a[4:7], v[96:99], v[36:39], a[4:7]
  ds_read_b128 v[68:71], v4 offset:9216
  v_mfma_f32_16x16x32_bf16 a[8:11], v[96:99], v[40:43], a[8:11]
  ds_read_b64_tr_b16 v[132:133], v11 offset:4096
  v_mfma_f32_16x16x32_bf16 a[12:15], v[96:99], v[44:47], a[12:15]
  ds_read_b64_tr_b16 v[134:135], v11 offset:6144
  v_mfma_f32_16x16x32_bf16 a[16:19], v[100:103], v[32:35], a[16:19]
  v_mfma_f32_16x16x32_bf16 a[20:23], v[100:103], v[36:39], a[20:23]
  ds_read_b128 v[72:75], v4 offset:10240
  v_mfma_f32_16x16x32_bf16 a[24:27], v[100:103], v[40:43], a[24:27]
  ds_read_b64_tr_b16 v[136:137], v12 offset:4096
  v_mfma_f32_16x16x32_bf16 a[28:31], v[100:103], v[44:47], a[28:31]
  ds_read_b64_tr_b16 v[138:139], v12 offset:6144
  v_mfma_f32_16x16x32_bf16 a[32:35], v[104:107], v[32:35], a[32:35]
  ds_read_b128 v[76:79], v4 offset:11264
  v_mfma_f32_16x16x32_bf16 a[36:39], v[104:107], v[36:39], a[36:39]
  ds_read_b64_tr_b16 v[140:141], v13 offset:4096
  v_mfma_f32_16x16x32_bf16 a[40:43], v[104:107], v[40:43], a[40:43]
  ds_read_b64_tr_b16 v[142:143], v13 offset:6144
  v_mfma_f32_16x16x32_bf16 a[44:47], v[104:107], v[44:47], a[44:47]
  v_mfma_f32_16x16x32_bf16 a[48:51], v[108:111], v[32:35], a[48:51]
  v_mfma_f32_16x16x32_bf16 a[52:55], v[108:111], v[36:39], a[52:55]
  v_mfma_f32_16x16x32_bf16 a[56:59], v[108:111], v[40:43], a[56:59]
  v_mfma_f32_16x16x32_bf16 a[60:63], v[108:111], v[44:47], a[60:63]
  s_waitcnt lgkmcnt(0)
  s_barrier
  v_mfma_f32_16x16x32_bf16 a[0:3], v[112:115], v[48:51], a[0:3]
  v_mfma_f32_16x16x32_bf16 a[4:7], v[112:115], v[52:55], a[4:7]
  v_mfma_f32_16x16x32_bf16 a[8:11], v[112:115], v[56:59], a[8:11]
  v_mfma_f32_16x16x32_bf16 a[12:15], v[112:115], v[60:63], a[12:15]
  v_mfma_f32_16x16x32_bf16 a[16:19], v[116:119], v[48:51], a[16:19]
  v_mfma_f32_16x16x32_bf16 a[20:23], v[116:119], v[52:55], a[20:23]
  v_mfma_f32_16x16x32_bf16 a[24:27], v[116:119], v[56:59], a[24:27]
  v_mfma_f32_16x16x32_bf16 a[28:31], v[116:119], v[60:63], a[28:31]
  v_mfma_f32_16x16x32_bf16 a[32:35], v[120:123], v[48:51], a[32:35]
  v_mfma_f32_16x16x32_bf16 a[36:39], v[120:123], v[52:55], a[36:39]
  v_mfma_f32_16x16x32_bf16 a[40:43], v[120:123], v[56:59], a[40:43]
  v_mfma_f32_16x16x32_bf16 a[44:47], v[120:123], v[60:63], a[44:47]
  v_mfma_f32_16x16x32_bf16 a[48:51], v[124:127], v[48:51], a[48:51]
  v_mfma_f32_16x16x32_bf16 a[52:55], v[124:127], v[52:55], a[52:55]
  v_mfma_f32_16x16x32_bf16 a[56:59], v[124:127], v[56:59], a[56:59]
  v_mfma_f32_16x16x32_bf16 a[60:63], v[124:127], v[60:63], a[60:63]
  v_mfma_f32_16x16x32_bf16 a[0:3], v[128:131], v[64:67], a[0:3]
  v_mfma_f32_16x16x32_bf16 a[4:7], v[128:131], v[68:71], a[4:7]
  v_mfma_f32_16x16x32_bf16 a[8:11], v[128:131], v[72:75], a[8:11]
  v_mfma_f32_16x16x32_bf16 a[12:15], v[128:131], v[76:79], a[12:15]
  v_mfma_f32_16x16x32_bf16 a[16:19], v[132:135], v[64:67], a[16:19]
  v_mfma_f32_16x16x32_bf16 a[20:23], v[132:135], v[68:71], a[20:23]
  v_mfma_f32_16x16x32_bf16 a[24:27], v[132:135], v[72:75], a[24:27]
  v_mfma_f32_16x16x32_bf16 a[28:31], v[132:135], v[76:79], a[28:31]
  v_mfma_f32_16x16x32_bf16 a[32:35], v[136:139], v[64:67], a[32:35]
  v_mfma_f32_16x16x32_bf16 a[36:39], v[136:139], v[68:71], a[36:39]
  v_mfma_f32_16x16x32_bf16 a[40:43], v[136:139], v[72:75], a[40:43]
  v_mfma_f32_16x16x32_bf16 a[44:47], v[136:139], v[76:79], a[44:47]
  v_mfma_f32_16x16x32_bf16 a[48:51], v[140:143], v[64:67], a[48:51]
  v_mfma_f32_16x16x32_bf16 a[52:55], v[140:143], v[68:71], a[52:55]
  v_mfma_f32_16x16x32_bf16 a[56:59], v[140:143], v[72:75], a[56:59]
  v_mfma_f32_16x16x32_bf16 a[60:63], v[140:143], v[76:79], a[60:63]
  s_add_u32 s32, s6, 41943040
  s_addc_u32 s33, s7, 0
  s_mov_b32 s34, 4194304
  s_mov_b32 s35, 0x20000
  s_lshl_b32 s56, s47, 2
  s_add_u32 s56, s56, s40
  s_lshl_b32 s56, s56, 13
  s_add_u32 s57, s56, 4096
  s_nop 7
  v_accvgpr_read_b32 v212, a0
  v_accvgpr_read_b32 v213, a1
  v_accvgpr_read_b32 v214, a2
  v_accvgpr_read_b32 v215, a3
  v_accvgpr_read_b32 v216, a16
  v_accvgpr_read_b32 v217, a17
  v_accvgpr_read_b32 v218, a18
  v_accvgpr_read_b32 v219, a19
  v_cvt_pk_bf16_f32 v208, v212, v213
  v_cvt_pk_bf16_f32 v209, v214, v215
  v_cvt_pk_bf16_f32 v210, v216, v217
  v_cvt_pk_bf16_f32 v211, v218, v219
  buffer_store_dwordx4 v[208:211], v1, s[32:35], s56 offen offset:0 sc1
  v_accvgpr_read_b32 v224, a4
  v_accvgpr_read_b32 v225, a5
  v_accvgpr_read_b32 v226, a6
  v_accvgpr_read_b32 v227, a7
  v_accvgpr_read_b32 v228, a20
  v_accvgpr_read_b32 v229, a21
  v_accvgpr_read_b32 v230, a22
  v_accvgpr_read_b32 v231, a23
  v_cvt_pk_bf16_f32 v220, v224, v225
  v_cvt_pk_bf16_f32 v221, v226, v227
  v_cvt_pk_bf16_f32 v222, v228, v229
  v_cvt_pk_bf16_f32 v223, v230, v231
  buffer_store_dwordx4 v[220:223], v1, s[32:35], s56 offen offset:1024 sc1
  v_accvgpr_read_b32 v236, a8
  v_accvgpr_read_b32 v237, a9
  v_accvgpr_read_b32 v238, a10
  v_accvgpr_read_b32 v239, a11
  v_accvgpr_read_b32 v240, a24
  v_accvgpr_read_b32 v241, a25
  v_accvgpr_read_b32 v242, a26
  v_accvgpr_read_b32 v243, a27
  v_cvt_pk_bf16_f32 v232, v236, v237
  v_cvt_pk_bf16_f32 v233, v238, v239
  v_cvt_pk_bf16_f32 v234, v240, v241
  v_cvt_pk_bf16_f32 v235, v242, v243
  buffer_store_dwordx4 v[232:235], v1, s[32:35], s56 offen offset:2048 sc1
  v_accvgpr_read_b32 v212, a12
  v_accvgpr_read_b32 v213, a13
  v_accvgpr_read_b32 v214, a14
  v_accvgpr_read_b32 v215, a15
  v_accvgpr_read_b32 v216, a28
  v_accvgpr_read_b32 v217, a29
  v_accvgpr_read_b32 v218, a30
  v_accvgpr_read_b32 v219, a31
  v_cvt_pk_bf16_f32 v208, v212, v213
  v_cvt_pk_bf16_f32 v209, v214, v215
  v_cvt_pk_bf16_f32 v210, v216, v217
  v_cvt_pk_bf16_f32 v211, v218, v219
  buffer_store_dwordx4 v[208:211], v1, s[32:35], s56 offen offset:3072 sc1
  v_accvgpr_read_b32 v224, a32
  v_accvgpr_read_b32 v225, a33
  v_accvgpr_read_b32 v226, a34
  v_accvgpr_read_b32 v227, a35
  v_accvgpr_read_b32 v228, a48
  v_accvgpr_read_b32 v229, a49
  v_accvgpr_read_b32 v230, a50
  v_accvgpr_read_b32 v231, a51
  v_cvt_pk_bf16_f32 v220, v224, v225
  v_cvt_pk_bf16_f32 v221, v226, v227
  v_cvt_pk_bf16_f32 v222, v228, v229
  v_cvt_pk_bf16_f32 v223, v230, v231
  buffer_store_dwordx4 v[220:223], v1, s[32:35], s57 offen offset:0 sc1
  v_accvgpr_read_b32 v236, a36
  v_accvgpr_read_b32 v237, a37
  v_accvgpr_read_b32 v238, a38
  v_accvgpr_read_b32 v239, a39
  v_accvgpr_read_b32 v240, a52
  v_accvgpr_read_b32 v241, a53
  v_accvgpr_read_b32 v242, a54
  v_accvgpr_read_b32 v243, a55
  v_cvt_pk_bf16_f32 v232, v236, v237
  v_cvt_pk_bf16_f32 v233, v238, v239
  v_cvt_pk_bf16_f32 v234, v240, v241
  v_cvt_pk_bf16_f32 v235, v242, v243
  buffer_store_dwordx4 v[232:235], v1, s[32:35], s57 offen offset:1024 sc1
  v_accvgpr_read_b32 v212, a40
  v_accvgpr_read_b32 v213, a41
  v_accvgpr_read_b32 v214, a42
  v_accvgpr_read_b32 v215, a43
  v_accvgpr_read_b32 v216, a56
  v_accvgpr_read_b32 v217, a57
  v_accvgpr_read_b32 v218, a58
  v_accvgpr_read_b32 v219, a59
  v_cvt_pk_bf16_f32 v208, v212, v213
  v_cvt_pk_bf16_f32 v209, v214, v215
  v_cvt_pk_bf16_f32 v210, v216, v217
  v_cvt_pk_bf16_f32 v211, v218, v219
  buffer_store_dwordx4 v[208:211], v1, s[32:35], s57 offen offset:2048 sc1
  v_accvgpr_read_b32 v224, a44
  v_accvgpr_read_b32 v225, a45
  v_accvgpr_read_b32 v226, a46
  v_accvgpr_read_b32 v227, a47
  v_accvgpr_read_b32 v228, a60
  v_accvgpr_read_b32 v229, a61
  v_accvgpr_read_b32 v230, a62
  v_accvgpr_read_b32 v231, a63
  v_cvt_pk_bf16_f32 v220, v224, v225
  v_cvt_pk_bf16_f32 v221, v226, v227
  v_cvt_pk_bf16_f32 v222, v228, v229
  v_cvt_pk_bf16_f32 v223, v230, v231
  buffer_store_dwordx4 v[220:223], v1, s[32:35], s57 offen offset:3072 sc1
  s_waitcnt vmcnt(0)
  s_barrier
  s_cmp_eq_u32 s40, 0
  s_cbranch_scc0 sig_11
  s_lshl_b32 s56, s43, 5
  s_add_u32 s56, s56, s78
  s_add_u32 s56, s56, 768
  s_lshl_b32 s56, s56, 7
  s_add_u32 s56, s56, 4096
  v_mov_b32 v16, s76
  v_mov_b32 v17, s77
  v_mov_b32 v18, 0
  s_mov_b64 exec, 1
  buffer_store_dwordx2 v[16:17], v18, s[72:75], s56 offen sc1
  s_mov_b64 exec, -1
sig_11:
  s_cmp_eq_u32 s2, 0
  s_cbranch_scc0 fz_q_done
  s_cmp_eq_u32 s40, 0
  s_cbranch_scc0 fz_q_done
  s_cmp_eq_u32 s40, 0
  s_cbranch_scc0 poll_12_done
  s_mov_b32 s56, 0
  s_add_u32 s56, s56, 0
  s_lshl_b32 s56, s56, 7
  s_add_u32 s56, s56, 4096
  v_mov_b32 v18, v0
  v_lshlrev_b32 v18, 7, v18
  s_mov_b32 s57, 0
  buffer_load_dwordx2 v[16:17], v18, s[72:75], s56 offen sc1
poll_12:
  buffer_load_dwordx2 v[20:21], v18, s[72:75], s56 offen sc1
  s_add_u32 s57, s57, 1
  s_waitcnt vmcnt(1)
  v_cmp_eq_u32 vcc, s76, v16
  v_cmp_eq_u32 s[58:59], s77, v17
  s_nop 1
  s_and_b64 vcc, vcc, s[58:59]
  s_cmp_eq_u64 vcc, exec
  s_cbranch_scc1 poll_12_ok
  buffer_load_dwordx2 v[16:17], v18, s[72:75], s56 offen sc1
  s_add_u32 s57, s57, 1
  s_waitcnt vmcnt(1)
  v_cmp_eq_u32 vcc, s76, v20
  v_cmp_eq_u32 s[58:59], s77, v21
  s_nop 1
  s_and_b64 vcc, vcc, s[58:59]
  s_cmp_eq_u64 vcc, exec
  s_cbranch_scc1 poll_12_ok
  s_cmp_lt_u32 s57, 0x80000
  s_cbranch_scc1 poll_12
poll_12_ok:
  s_waitcnt vmcnt(0)
poll_12_done:
  s_cmp_eq_u32 s40, 0
  s_cbranch_scc0 poll_13_done
  s_mov_b32 s56, 64
  s_add_u32 s56, s56, 0
  s_lshl_b32 s56, s56, 7
  s_add_u32 s56, s56, 4096
  v_mov_b32 v18, v0
  v_lshlrev_b32 v18, 7, v18
  s_mov_b32 s57, 0
  buffer_load_dwordx2 v[16:17], v18, s[72:75], s56 offen sc1
poll_13:
  buffer_load_dwordx2 v[20:21], v18, s[72:75], s56 offen sc1
  s_add_u32 s57, s57, 1
  s_waitcnt vmcnt(1)
  v_cmp_eq_u32 vcc, s76, v16
  v_cmp_eq_u32 s[58:59], s77, v17
  s_nop 1
  s_and_b64 vcc, vcc, s[58:59]
  s_cmp_eq_u64 vcc, exec
  s_cbranch_scc1 poll_13_ok
  buffer_load_dwordx2 v[16:17], v18, s[72:75], s56 offen sc1
  s_add_u32 s57, s57, 1
  s_waitcnt vmcnt(1)
  v_cmp_eq_u32 vcc, s76, v20
  v_cmp_eq_u32 s[58:59], s77, v21
  s_nop 1
  s_and_b64 vcc, vcc, s[58:59]
  s_cmp_eq_u64 vcc, exec
  s_cbranch_scc1 poll_13_ok
  s_cmp_lt_u32 s57, 0x80000
  s_cbranch_scc1 poll_13
poll_13_ok:
  s_waitcnt vmcnt(0)
poll_13_done:
  s_cmp_eq_u32 s40, 0
  s_cbranch_scc0 poll_14_done
  s_mov_b32 s56, 128
  s_add_u32 s56, s56, 0
  s_lshl_b32 s56, s56, 7
  s_add_u32 s56, s56, 4096
  v_mov_b32 v18, v0
  v_lshlrev_b32 v18, 7, v18
  s_mov_b32 s57, 0
  buffer_load_dwordx2 v[16:17], v18, s[72:75], s56 offen sc1
poll_14:
  buffer_load_dwordx2 v[20:21], v18, s[72:75], s56 offen sc1
  s_add_u32 s57, s57, 1
  s_waitcnt vmcnt(1)
  v_cmp_eq_u32 vcc, s76, v16
  v_cmp_eq_u32 s[58:59], s77, v17
  s_nop 1
  s_and_b64 vcc, vcc, s[58:59]
  s_cmp_eq_u64 vcc, exec
  s_cbranch_scc1 poll_14_ok
  buffer_load_dwordx2 v[16:17], v18, s[72:75], s56 offen sc1
  s_add_u32 s57, s57, 1
  s_waitcnt vmcnt(1)
  v_cmp_eq_u32 vcc, s76, v20
  v_cmp_eq_u32 s[58:59], s77, v21
  s_nop 1
  s_and_b64 vcc, vcc, s[58:59]
  s_cmp_eq_u64 vcc, exec
  s_cbranch_scc1 poll_14_ok
  s_cmp_lt_u32 s57, 0x80000
  s_cbranch_scc1 poll_14
poll_14_ok:
  s_waitcnt vmcnt(0)
poll_14_done:
  s_cmp_eq_u32 s40, 0
  s_cbranch_scc0 poll_15_done
  s_mov_b32 s56, 192
  s_add_u32 s56, s56, 0
  s_lshl_b32 s56, s56, 7
  s_add_u32 s56, s56, 4096
  v_mov_b32 v18, v0
  v_lshlrev_b32 v18, 7, v18
  s_mov_b32 s57, 0
  buffer_load_dwordx2 v[16:17], v18, s[72:75], s56 offen sc1
poll_15:
  buffer_load_dwordx2 v[20:21], v18, s[72:75], s56 offen sc1
  s_add_u32 s57, s57, 1
  s_waitcnt vmcnt(1)
  v_cmp_eq_u32 vcc, s76, v16
  v_cmp_eq_u32 s[58:59], s77, v17
  s_nop 1
  s_and_b64 vcc, vcc, s[58:59]
  s_cmp_eq_u64 vcc, exec
  s_cbranch_scc1 poll_15_ok
  buffer_load_dwordx2 v[16:17], v18, s[72:75], s56 offen sc1
  s_add_u32 s57, s57, 1
  s_waitcnt vmcnt(1)
  v_cmp_eq_u32 vcc, s76, v20
  v_cmp_eq_u32 s[58:59], s77, v21
  s_nop 1
  s_and_b64 vcc, vcc, s[58:59]
  s_cmp_eq_u64 vcc, exec
  s_cbranch_scc1 poll_15_ok
  s_cmp_lt_u32 s57, 0x80000
  s_cbranch_scc1 poll_15
poll_15_ok:
  s_waitcnt vmcnt(0)
poll_15_done:
  s_add_u32 s72, s6, 62914560
  s_addc_u32 s73, s7, 0
  s_mov_b32 s74, 64
  s_mov_b32 s75, 0x20000
  v_mov_b32 v16, s76
  v_mov_b32 v17, s77
  v_mov_b32 v18, 0
  s_mov_b64 exec, 1
  buffer_store_dwordx2 v[16:17], v18, s[72:75], 0 offen sc1
  s_mov_b64 exec, -1
fz_q_done:
  s_endpgm
fz_g_path:
  s_waitcnt vmcnt(12)
  s_barrier
  ds_read_b128 v[16:19], v6 offset:0
  ds_read_b128 v[20:23], v6 offset:1024
  ds_read_b128 v[24:27], v6 offset:2048
  ds_read_b128 v[28:31], v6 offset:3072
  ds_read_b128 v[32:35], v6 offset:4096
  ds_read_b128 v[36:39], v6 offset:5120
  ds_read_b128 v[40:43], v6 offset:6144
  ds_read_b128 v[44:47], v6 offset:7168
  ds_read_b64_tr_b16 v[80:81], v7 offset:0
  ds_read_b64_tr_b16 v[82:83], v7 offset:2048
  ds_read_b64_tr_b16 v[84:85], v8 offset:0
  ds_read_b64_tr_b16 v[86:87], v8 offset:2048
  ds_read_b64_tr_b16 v[88:89], v7 offset:4096
  ds_read_b64_tr_b16 v[90:91], v7 offset:6144
  ds_read_b64_tr_b16 v[92:93], v8 offset:4096
  ds_read_b64_tr_b16 v[94:95], v8 offset:6144
  ds_read_b64_tr_b16 v[96:97], v7 offset:8192
  ds_read_b64_tr_b16 v[98:99], v7 offset:10240
  ds_read_b64_tr_b16 v[100:101], v8 offset:8192
  ds_read_b64_tr_b16 v[102:103], v8 offset:10240
  ds_read_b64_tr_b16 v[104:105], v7 offset:12288
  ds_read_b64_tr_b16 v[106:107], v7 offset:14336
  ds_read_b64_tr_b16 v[108:109], v8 offset:12288
  ds_read_b64_tr_b16 v[110:111], v8 offset:14336
  ds_read_b64_tr_b16 v[112:113], v9 offset:0
  ds_read_b64_tr_b16 v[114:115], v9 offset:2048
  ds_read_b64_tr_b16 v[116:117], v10 offset:0
  ds_read_b64_tr_b16 v[118:119], v10 offset:2048
  s_waitcnt vmcnt(8) lgkmcnt(0)
  s_barrier
  v_mfma_f32_16x16x32_bf16 a[0:3], v[80:83], v[16:19], 0
  ds_read_b128 v[48:51], v6 offset:16384
  s_add_u32 m0, s52, 0
  v_mfma_f32_16x16x32_bf16 a[4:7], v[80:83], v[20:23], 0
  s_mov_b32 s70, 0
  v_mfma_f32_16x16x32_bf16 a[8:11], v[80:83], v[24:27], 0
  ds_read_b64_tr_b16 v[120:121], v7 offset:16384
  v_mfma_f32_16x16x32_bf16 a[12:15], v[80:83], v[28:31], 0
  v_mfma_f32_16x16x32_bf16 a[16:19], v[80:83], v[32:35], 0
  buffer_load_dwordx4 v188, s[12:15], s45 offen offset:0 sc1 lds
  v_mfma_f32_16x16x32_bf16 a[20:23], v[80:83], v[36:39], 0
  ds_read_b64_tr_b16 v[122:123], v7 offset:18432
  v_mfma_f32_16x16x32_bf16 a[24:27], v[80:83], v[40:43], 0
  v_mfma_f32_16x16x32_bf16 a[28:31], v[80:83], v[44:47], 0
  ds_read_b128 v[52:55], v6 offset:17408
  v_mfma_f32_16x16x32_bf16 a[32:35], v[84:87], v[16:19], 0
  buffer_load_dwordx4 v188, s[12:15], s45 offen offset:1024 sc1 lds
  v_mfma_f32_16x16x32_bf16 a[36:39], v[84:87], v[20:23], 0
  v_mfma_f32_16x16x32_bf16 a[40:43], v[84:87], v[24:27], 0
  ds_read_b64_tr_b16 v[124:125], v8 offset:16384
  v_mfma_f32_16x16x32_bf16 a[44:47], v[84:87], v[28:31], 0
  v_mfma_f32_16x16x32_bf16 a[48:51], v[84:87], v[32:35], 0
  ds_read_b64_tr_b16 v[126:127], v8 offset:18432
  v_mfma_f32_16x16x32_bf16 a[52:55], v[84:87], v[36:39], 0
  buffer_load_dwordx4 v188, s[12:15], s45 offen offset:2048 sc1 lds
  v_mfma_f32_16x16x32_bf16 a[56:59], v[84:87], v[40:43], 0
  v_mfma_f32_16x16x32_bf16 a[60:63], v[84:87], v[44:47], 0
  ds_read_b64_tr_b16 v[128:129], v7 offset:20480
  v_mfma_f32_16x16x32_bf16 a[64:67], v[88:91], v[16:19], 0
  buffer_load_dwordx4 v188, s[12:15], s45 offen offset:3072 sc1 lds
  v_mfma_f32_16x16x32_bf16 a[68:71], v[88:91], v[20:23], 0
  v_mfma_f32_16x16x32_bf16 a[72:75], v[88:91], v[24:27], 0
  ds_read_b128 v[56:59], v6 offset:18432
  v_mfma_f32_16x16x32_bf16 a[76:79], v[88:91], v[28:31], 0
  v_mfma_f32_16x16x32_bf16 a[80:83], v[88:91], v[32:35], 0
  ds_read_b64_tr_b16 v[130:131], v7 offset:22528
  s_add_u32 s45, s45, 16384
  v_mfma_f32_16x16x32_bf16 a[84:87], v[88:91], v[36:39], 0
  v_mfma_f32_16x16x32_bf16 a[88:91], v[88:91], v[40:43], 0
  v_mfma_f32_16x16x32_bf16 a[92:95], v[88:91], v[44:47], 0
  ds_read_b64_tr_b16 v[132:133], v8 offset:20480
  v_mfma_f32_16x16x32_bf16 a[96:99], v[92:95], v[16:19], 0
  s_add_u32 m0, s53, 0
  v_mfma_f32_16x16x32_bf16 a[100:103], v[92:95], v[20:23], 0
  ds_read_b128 v[60:63], v6 offset:19456
  v_mfma_f32_16x16x32_bf16 a[104:107], v[92:95], v[24:27], 0
  v_mfma_f32_16x16x32_bf16 a[108:111], v[92:95], v[28:31], 0
  v_mfma_f32_16x16x32_bf16 a[112:115], v[92:95], v[32:35], 0
  ds_read_b64_tr_b16 v[134:135], v8 offset:22528
  v_mfma_f32_16x16x32_bf16 a[116:119], v[92:95], v[36:39], 0
  buffer_load_dwordx4 v2, s[16:19], s46 offen lds
  v_mfma_f32_16x16x32_bf16 a[120:123], v[92:95], v[40:43], 0
  ds_read_b64_tr_b16 v[136:137], v7 offset:24576
  v_mfma_f32_16x16x32_bf16 a[124:127], v[92:95], v[44:47], 0
  v_mfma_f32_16x16x32_bf16 a[128:131], v[96:99], v[16:19], 0
  s_add_u32 m0, s53, 4096
  v_mfma_f32_16x16x32_bf16 a[132:135], v[96:99], v[20:23], 0
  ds_read_b64_tr_b16 v[138:139], v7 offset:26624
  v_mfma_f32_16x16x32_bf16 a[136:139], v[96:99], v[24:27], 0
  v_mfma_f32_16x16x32_bf16 a[140:143], v[96:99], v[28:31], 0
  v_mfma_f32_16x16x32_bf16 a[144:147], v[96:99], v[32:35], 0
  ds_read_b128 v[64:67], v6 offset:20480
  v_mfma_f32_16x16x32_bf16 a[148:151], v[96:99], v[36:39], 0
  buffer_load_dwordx4 v2, s[20:23], s46 offen lds
  v_mfma_f32_16x16x32_bf16 a[152:155], v[96:99], v[40:43], 0
  ds_read_b64_tr_b16 v[140:141], v8 offset:24576
  v_mfma_f32_16x16x32_bf16 a[156:159], v[96:99], v[44:47], 0
  v_mfma_f32_16x16x32_bf16 a[160:163], v[100:103], v[16:19], 0
  buffer_load_dword v191, v187, s[36:39], s70 offen
  v_mfma_f32_16x16x32_bf16 a[164:167], v[100:103], v[20:23], 0
  ds_read_b64_tr_b16 v[142:143], v8 offset:26624
  s_add_u32 m0, s53, 8192
  v_mfma_f32_16x16x32_bf16 a[168:171], v[100:103], v[24:27], 0
  v_mfma_f32_16x16x32_bf16 a[172:175], v[100:103], v[28:31], 0
  ds_read_b128 v[68:71], v6 offset:21504
  v_mfma_f32_16x16x32_bf16 a[176:179], v[100:103], v[32:35], 0
  v_mfma_f32_16x16x32_bf16 a[180:183], v[100:103], v[36:39], 0
  buffer_load_dwordx4 v3, s[24:27], s47 offen lds
  v_mfma_f32_16x16x32_bf16 a[184:187], v[100:103], v[40:43], 0
  ds_read_b64_tr_b16 v[144:145], v7 offset:28672
  v_mfma_f32_16x16x32_bf16 a[188:191], v[100:103], v[44:47], 0
  v_mfma_f32_16x16x32_bf16 a[192:195], v[104:107], v[16:19], 0
  ds_read_b64_tr_b16 v[146:147], v7 offset:30720
  v_mfma_f32_16x16x32_bf16 a[196:199], v[104:107], v[20:23], 0
  s_add_u32 m0, s53, 12288
  v_mfma_f32_16x16x32_bf16 a[200:203], v[104:107], v[24:27], 0
  v_mfma_f32_16x16x32_bf16 a[204:207], v[104:107], v[28:31], 0
  ds_read_b64_tr_b16 v[148:149], v8 offset:28672
  v_mfma_f32_16x16x32_bf16 a[208:211], v[104:107], v[32:35], 0
  v_mfma_f32_16x16x32_bf16 a[212:215], v[104:107], v[36:39], 0
  buffer_load_dwordx4 v3, s[28:31], s47 offen lds
  v_mfma_f32_16x16x32_bf16 a[216:219], v[104:107], v[40:43], 0
  ds_read_b128 v[72:75], v6 offset:22528
  v_mfma_f32_16x16x32_bf16 a[220:223], v[104:107], v[44:47], 0
  v_mfma_f32_16x16x32_bf16 a[224:227], v[108:111], v[16:19], 0
  ds_read_b64_tr_b16 v[150:151], v8 offset:30720
  v_mfma_f32_16x16x32_bf16 a[228:231], v[108:111], v[20:23], 0
  s_add_u32 m0, s54, 0
  v_mfma_f32_16x16x32_bf16 a[232:235], v[108:111], v[24:27], 0
  v_mfma_f32_16x16x32_bf16 a[236:239], v[108:111], v[28:31], 0
  ds_read_b64_tr_b16 v[152:153], v9 offset:4096
  v_mfma_f32_16x16x32_bf16 a[240:243], v[108:111], v[32:35], 0
  v_mfma_f32_16x16x32_bf16 a[244:247], v[108:111], v[36:39], 0
  ds_read_b128 v[76:79], v6 offset:23552
  v_mfma_f32_16x16x32_bf16 a[248:251], v[108:111], v[40:43], 0
  global_load_lds_dwordx4 v[4:5], off
  v_mfma_f32_16x16x32_bf16 a[252:255], v[108:111], v[44:47], 0
  v_mfma_f32_16x16x32_bf16 v[192:195], v[112:115], v[16:19], 0
  ds_read_b64_tr_b16 v[154:155], v9 offset:6144
  v_mfma_f32_16x16x32_bf16 v[196:199], v[112:115], v[20:23], 0
  s_add_u32 s46, s46, s48
  v_mfma_f32_16x16x32_bf16 v[200:203], v[112:115], v[24:27], 0
  ds_read_b64_tr_b16 v[156:157], v10 offset:4096
  v_mfma_f32_16x16x32_bf16 v[204:207], v[112:115], v[28:31], 0
  v_mfma_f32_16x16x32_bf16 v[208:211], v[112:115], v[32:35], 0
  v_mfma_f32_16x16x32_bf16 v[212:215], v[112:115], v[36:39], 0
  ds_read_b64_tr_b16 v[158:159], v10 offset:6144
  s_add_u32 s47, s47, s49
  v_mfma_f32_16x16x32_bf16 v[216:219], v[112:115], v[40:43], 0
  v_mfma_f32_16x16x32_bf16 v[220:223], v[112:115], v[44:47], 0
  v_mfma_f32_16x16x32_bf16 v[224:227], v[116:119], v[16:19], 0
  v_mfma_f32_16x16x32_bf16 v[228:231], v[116:119], v[20:23], 0
  v_lshl_add_u64 v[4:5], s[50:51], 0, v[4:5]
  v_mfma_f32_16x16x32_bf16 v[232:235], v[116:119], v[24:27], 0
  v_mfma_f32_16x16x32_bf16 v[236:239], v[116:119], v[28:31], 0
  v_mfma_f32_16x16x32_bf16 v[240:243], v[116:119], v[32:35], 0
  v_mfma_f32_16x16x32_bf16 v[244:247], v[116:119], v[36:39], 0
  v_mfma_f32_16x16x32_bf16 v[248:251], v[116:119], v[40:43], 0
  v_mfma_f32_16x16x32_bf16 v[252:255], v[116:119], v[44:47], 0
  s_waitcnt vmcnt(14) lgkmcnt(0)
  s_barrier
  v_mfma_f32_16x16x32_bf16 a[0:3], v[120:123], v[48:51], a[0:3]
  ds_read_b128 v[16:19], v6 offset:32768
  s_add_u32 m0, s52, 16384
  v_mfma_f32_16x16x32_bf16 a[4:7], v[120:123], v[52:55], a[4:7]
  s_mov_b32 s70, 2048
  v_mfma_f32_16x16x32_bf16 a[8:11], v[120:123], v[56:59], a[8:11]
  ds_read_b64_tr_b16 v[80:81], v7 offset:32768
  v_mfma_f32_16x16x32_bf16 a[12:15], v[120:123], v[60:63], a[12:15]
  v_mfma_f32_16x16x32_bf16 a[16:19], v[120:123], v[64:67], a[16:19]
  buffer_load_dwordx4 v188, s[12:15], s45 offen offset:0 sc1 lds
  v_mfma_f32_16x16x32_bf16 a[20:23], v[120:123], v[68:71], a[20:23]
  ds_read_b64_tr_b16 v[82:83], v7 offset:34816
  v_mfma_f32_16x16x32_bf16 a[24:27], v[120:123], v[72:75], a[24:27]
  v_mfma_f32_16x16x32_bf16 a[28:31], v[120:123], v[76:79], a[28:31]
  ds_read_b128 v[20:23], v6 offset:33792
  v_mfma_f32_16x16x32_bf16 a[32:35], v[124:127], v[48:51], a[32:35]
  buffer_load_dwordx4 v188, s[12:15], s45 offen offset:1024 sc1 lds
  v_mfma_f32_16x16x32_bf16 a[36:39], v[124:127], v[52:55], a[36:39]
  v_mfma_f32_16x16x32_bf16 a[40:43], v[124:127], v[56:59], a[40:43]
  ds_read_b64_tr_b16 v[84:85], v8 offset:32768
  v_mfma_f32_16x16x32_bf16 a[44:47], v[124:127], v[60:63], a[44:47]
  v_mfma_f32_16x16x32_bf16 a[48:51], v[124:127], v[64:67], a[48:51]
  ds_read_b64_tr_b16 v[86:87], v8 offset:34816
  v_mfma_f32_16x16x32_bf16 a[52:55], v[124:127], v[68:71], a[52:55]
  buffer_load_dwordx4 v188, s[12:15], s45 offen offset:2048 sc1 lds
  v_mfma_f32_16x16x32_bf16 a[56:59], v[124:127], v[72:75], a[56:59]
  v_mfma_f32_16x16x32_bf16 a[60:63], v[124:127], v[76:79], a[60:63]
  ds_read_b64_tr_b16 v[88:89], v7 offset:36864
  v_mfma_f32_16x16x32_bf16 a[64:67], v[128:131], v[48:51], a[64:67]
  buffer_load_dwordx4 v188, s[12:15], s45 offen offset:3072 sc1 lds
  v_mfma_f32_16x16x32_bf16 a[68:71], v[128:131], v[52:55], a[68:71]
  v_mfma_f32_16x16x32_bf16 a[72:75], v[128:131], v[56:59], a[72:75]
  ds_read_b128 v[24:27], v6 offset:34816
  v_mfma_f32_16x16x32_bf16 a[76:79], v[128:131], v[60:63], a[76:79]
  v_mfma_f32_16x16x32_bf16 a[80:83], v[128:131], v[64:67], a[80:83]
  ds_read_b64_tr_b16 v[90:91], v7 offset:38912
  s_add_u32 s45, s45, 16384
  v_mfma_f32_16x16x32_bf16 a[84:87], v[128:131], v[68:71], a[84:87]
  v_mfma_f32_16x16x32_bf16 a[88:91], v[128:131], v[72:75], a[88:91]
  v_mfma_f32_16x16x32_bf16 a[92:95], v[128:131], v[76:79], a[92:95]
  ds_read_b64_tr_b16 v[92:93], v8 offset:36864
  v_mfma_f32_16x16x32_bf16 a[96:99], v[132:135], v[48:51], a[96:99]
  s_add_u32 m0, s53, 16384
  v_mfma_f32_16x16x32_bf16 a[100:103], v[132:135], v[52:55], a[100:103]
  ds_read_b128 v[28:31], v6 offset:35840
  v_mfma_f32_16x16x32_bf16 a[104:107], v[132:135], v[56:59], a[104:107]
  v_mfma_f32_16x16x32_bf16 a[108:111], v[132:135], v[60:63], a[108:111]
  v_mfma_f32_16x16x32_bf16 a[112:115], v[132:135], v[64:67], a[112:115]
  ds_read_b64_tr_b16 v[94:95], v8 offset:38912
  v_mfma_f32_16x16x32_bf16 a[116:119], v[132:135], v[68:71], a[116:119]
  buffer_load_dwordx4 v2, s[16:19], s46 offen lds
  v_mfma_f32_16x16x32_bf16 a[120:123], v[132:135], v[72:75], a[120:123]
  ds_read_b64_tr_b16 v[96:97], v7 offset:40960
  v_mfma_f32_16x16x32_bf16 a[124:127], v[132:135], v[76:79], a[124:127]
  v_mfma_f32_16x16x32_bf16 a[128:131], v[136:139], v[48:51], a[128:131]
  s_add_u32 m0, s53, 20480
  v_mfma_f32_16x16x32_bf16 a[132:135], v[136:139], v[52:55], a[132:135]
  ds_read_b64_tr_b16 v[98:99], v7 offset:43008
  v_mfma_f32_16x16x32_bf16 a[136:139], v[136:139], v[56:59], a[136:139]
  v_mfma_f32_16x16x32_bf16 a[140:143], v[136:139], v[60:63], a[140:143]
  v_mfma_f32_16x16x32_bf16 a[144:147], v[136:139], v[64:67], a[144:147]
  ds_read_b128 v[32:35], v6 offset:36864
  v_mfma_f32_16x16x32_bf16 a[148:151], v[136:139], v[68:71], a[148:151]
  buffer_load_dwordx4 v2, s[20:23], s46 offen lds
  v_mfma_f32_16x16x32_bf16 a[152:155], v[136:139], v[72:75], a[152:155]
  ds_read_b64_tr_b16 v[100:101], v8 offset:40960
  v_mfma_f32_16x16x32_bf16 a[156:159], v[136:139], v[76:79], a[156:159]
  v_mfma_f32_16x16x32_bf16 a[160:163], v[140:143], v[48:51], a[160:163]
  buffer_load_dword v191, v187, s[36:39], s70 offen
  v_mfma_f32_16x16x32_bf16 a[164:167], v[140:143], v[52:55], a[164:167]
  ds_read_b64_tr_b16 v[102:103], v8 offset:43008
  s_add_u32 m0, s53, 24576
  v_mfma_f32_16x16x32_bf16 a[168:171], v[140:143], v[56:59], a[168:171]
  v_mfma_f32_16x16x32_bf16 a[172:175], v[140:143], v[60:63], a[172:175]
  ds_read_b128 v[36:39], v6 offset:37888
  v_mfma_f32_16x16x32_bf16 a[176:179], v[140:143], v[64:67], a[176:179]
  v_mfma_f32_16x16x32_bf16 a[180:183], v[140:143], v[68:71], a[180:183]
  buffer_load_dwordx4 v3, s[24:27], s47 offen lds
  v_mfma_f32_16x16x32_bf16 a[184:187], v[140:143], v[72:75], a[184:187]
  ds_read_b64_tr_b16 v[104:105], v7 offset:45056
  v_mfma_f32_16x16x32_bf16 a[188:191], v[140:143], v[76:79], a[188:191]
  v_mfma_f32_16x16x32_bf16 a[192:195], v[144:147], v[48:51], a[192:195]
  ds_read_b64_tr_b16 v[106:107], v7 offset:47104
  v_mfma_f32_16x16x32_bf16 a[196:199], v[144:147], v[52:55], a[196:199]
  s_add_u32 m0, s53, 28672
  v_mfma_f32_16x16x32_bf16 a[200:203], v[144:147], v[56:59], a[200:203]
  v_mfma_f32_16x16x32_bf16 a[204:207], v[144:147], v[60:63], a[204:207]
  ds_read_b64_tr_b16 v[108:109], v8 offset:45056
  v_mfma_f32_16x16x32_bf16 a[208:211], v[144:147], v[64:67], a[208:211]
  v_mfma_f32_16x16x32_bf16 a[212:215], v[144:147], v[68:71], a[212:215]
  buffer_load_dwordx4 v3, s[28:31], s47 offen lds
  v_mfma_f32_16x16x32_bf16 a[216:219], v[144:147], v[72:75], a[216:219]
  ds_read_b128 v[40:43], v6 offset:38912
  v_mfma_f32_16x16x32_bf16 a[220:223], v[144:147], v[76:79], a[220:223]
  v_mfma_f32_16x16x32_bf16 a[224:227], v[148:151], v[48:51], a[224:227]
  ds_read_b64_tr_b16 v[110:111], v8 offset:47104
  v_mfma_f32_16x16x32_bf16 a[228:231], v[148:151], v[52:55], a[228:231]
  s_add_u32 m0, s54, 4096
  v_mfma_f32_16x16x32_bf16 a[232:235], v[148:151], v[56:59], a[232:235]
  v_mfma_f32_16x16x32_bf16 a[236:239], v[148:151], v[60:63], a[236:239]
  ds_read_b64_tr_b16 v[112:113], v9 offset:8192
  v_mfma_f32_16x16x32_bf16 a[240:243], v[148:151], v[64:67], a[240:243]
  v_mfma_f32_16x16x32_bf16 a[244:247], v[148:151], v[68:71], a[244:247]
  ds_read_b128 v[44:47], v6 offset:39936
  v_mfma_f32_16x16x32_bf16 a[248:251], v[148:151], v[72:75], a[248:251]
  global_load_lds_dwordx4 v[4:5], off
  v_mfma_f32_16x16x32_bf16 a[252:255], v[148:151], v[76:79], a[252:255]
  v_mfma_f32_16x16x32_bf16 v[192:195], v[152:155], v[48:51], v[192:195]
  ds_read_b64_tr_b16 v[114:115], v9 offset:10240
  v_mfma_f32_16x16x32_bf16 v[196:199], v[152:155], v[52:55], v[196:199]
  s_add_u32 s46, s46, s48
  v_mfma_f32_16x16x32_bf16 v[200:203], v[152:155], v[56:59], v[200:203]
  ds_read_b64_tr_b16 v[116:117], v10 offset:8192
  v_mfma_f32_16x16x32_bf16 v[204:207], v[152:155], v[60:63], v[204:207]
  v_mfma_f32_16x16x32_bf16 v[208:211], v[152:155], v[64:67], v[208:211]
  v_mfma_f32_16x16x32_bf16 v[212:215], v[152:155], v[68:71], v[212:215]
  ds_read_b64_tr_b16 v[118:119], v10 offset:10240
  s_add_u32 s47, s47, s49
  v_mfma_f32_16x16x32_bf16 v[216:219], v[152:155], v[72:75], v[216:219]
  v_mfma_f32_16x16x32_bf16 v[220:223], v[152:155], v[76:79], v[220:223]
  v_mfma_f32_16x16x32_bf16 v[224:227], v[156:159], v[48:51], v[224:227]
  v_mfma_f32_16x16x32_bf16 v[228:231], v[156:159], v[52:55], v[228:231]
  v_lshl_add_u64 v[4:5], s[50:51], 0, v[4:5]
  v_mfma_f32_16x16x32_bf16 v[232:235], v[156:159], v[56:59], v[232:235]
  v_mfma_f32_16x16x32_bf16 v[236:239], v[156:159], v[60:63], v[236:239]
  v_mfma_f32_16x16x32_bf16 v[240:243], v[156:159], v[64:67], v[240:243]
  v_mfma_f32_16x16x32_bf16 v[244:247], v[156:159], v[68:71], v[244:247]
  v_mfma_f32_16x16x32_bf16 v[248:251], v[156:159], v[72:75], v[248:251]
  v_mfma_f32_16x16x32_bf16 v[252:255], v[156:159], v[76:79], v[252:255]
  s_waitcnt vmcnt(20) lgkmcnt(0)
  s_barrier
  v_mfma_f32_16x16x32_bf16 a[0:3], v[80:83], v[16:19], a[0:3]
  ds_read_b128 v[48:51], v6 offset:49152
  s_add_u32 m0, s52, 32768
  v_mfma_f32_16x16x32_bf16 a[4:7], v[80:83], v[20:23], a[4:7]
  s_mov_b32 s70, 4096
  v_mfma_f32_16x16x32_bf16 a[8:11], v[80:83], v[24:27], a[8:11]
  ds_read_b64_tr_b16 v[120:121], v7 offset:49152
  v_mfma_f32_16x16x32_bf16 a[12:15], v[80:83], v[28:31], a[12:15]
  v_mfma_f32_16x16x32_bf16 a[16:19], v[80:83], v[32:35], a[16:19]
  buffer_load_dwordx4 v188, s[12:15], s45 offen offset:0 sc1 lds
  v_mfma_f32_16x16x32_bf16 a[20:23], v[80:83], v[36:39], a[20:23]
  ds_read_b64_tr_b16 v[122:123], v7 offset:51200
  v_mfma_f32_16x16x32_bf16 a[24:27], v[80:83], v[40:43], a[24:27]
  v_mfma_f32_16x16x32_bf16 a[28:31], v[80:83], v[44:47], a[28:31]
  ds_read_b128 v[52:55], v6 offset:50176
  v_mfma_f32_16x16x32_bf16 a[32:35], v[84:87], v[16:19], a[32:35]
  buffer_load_dwordx4 v188, s[12:15], s45 offen offset:1024 sc1 lds
  v_mfma_f32_16x16x32_bf16 a[36:39], v[84:87], v[20:23], a[36:39]
  v_mfma_f32_16x16x32_bf16 a[40:43], v[84:87], v[24:27], a[40:43]
  ds_read_b64_tr_b16 v[124:125], v8 offset:49152
  v_mfma_f32_16x16x32_bf16 a[44:47], v[84:87], v[28:31], a[44:47]
  v_mfma_f32_16x16x32_bf16 a[48:51], v[84:87], v[32:35], a[48:51]
  ds_read_b64_tr_b16 v[126:127], v8 offset:51200
  v_mfma_f32_16x16x32_bf16 a[52:55], v[84:87], v[36:39], a[52:55]
  buffer_load_dwordx4 v188, s[12:15], s45 offen offset:2048 sc1 lds
  v_mfma_f32_16x16x32_bf16 a[56:59], v[84:87], v[40:43], a[56:59]
  v_mfma_f32_16x16x32_bf16 a[60:63], v[84:87], v[44:47], a[60:63]
  ds_read_b64_tr_b16 v[128:129], v7 offset:53248
  v_mfma_f32_16x16x32_bf16 a[64:67], v[88:91], v[16:19], a[64:67]
  buffer_load_dwordx4 v188, s[12:15], s45 offen offset:3072 sc1 lds
  v_mfma_f32_16x16x32_bf16 a[68:71], v[88:91], v[20:23], a[68:71]
  v_mfma_f32_16x16x32_bf16 a[72:75], v[88:91], v[24:27], a[72:75]
  ds_read_b128 v[56:59], v6 offset:51200
  v_mfma_f32_16x16x32_bf16 a[76:79], v[88:91], v[28:31], a[76:79]
  v_mfma_f32_16x16x32_bf16 a[80:83], v[88:91], v[32:35], a[80:83]
  ds_read_b64_tr_b16 v[130:131], v7 offset:55296
  s_add_u32 s45, s45, 16384
  v_mfma_f32_16x16x32_bf16 a[84:87], v[88:91], v[36:39], a[84:87]
  v_mfma_f32_16x16x32_bf16 a[88:91], v[88:91], v[40:43], a[88:91]
  v_mfma_f32_16x16x32_bf16 a[92:95], v[88:91], v[44:47], a[92:95]
  ds_read_b64_tr_b16 v[132:133], v8 offset:53248
  v_mfma_f32_16x16x32_bf16 a[96:99], v[92:95], v[16:19], a[96:99]
  s_add_u32 m0, s53, 32768
  v_mfma_f32_16x16x32_bf16 a[100:103], v[92:95], v[20:23], a[100:103]
  ds_read_b128 v[60:63], v6 offset:52224
  v_mfma_f32_16x16x32_bf16 a[104:107], v[92:95], v[24:27], a[104:107]
  v_mfma_f32_16x16x32_bf16 a[108:111], v[92:95], v[28:31], a[108:111]
  v_mfma_f32_16x16x32_bf16 a[112:115], v[92:95], v[32:35], a[112:115]
  ds_read_b64_tr_b16 v[134:135], v8 offset:55296
  v_mfma_f32_16x16x32_bf16 a[116:119], v[92:95], v[36:39], a[116:119]
  buffer_load_dwordx4 v2, s[16:19], s46 offen lds
  v_mfma_f32_16x16x32_bf16 a[120:123], v[92:95], v[40:43], a[120:123]
  ds_read_b64_tr_b16 v[136:137], v7 offset:57344
  v_mfma_f32_16x16x32_bf16 a[124:127], v[92:95], v[44:47], a[124:127]
  v_mfma_f32_16x16x32_bf16 a[128:131], v[96:99], v[16:19], a[128:131]
  s_add_u32 m0, s53, 36864
  v_mfma_f32_16x16x32_bf16 a[132:135], v[96:99], v[20:23], a[132:135]
  ds_read_b64_tr_b16 v[138:139], v7 offset:59392
  v_mfma_f32_16x16x32_bf16 a[136:139], v[96:99], v[24:27], a[136:139]
  v_mfma_f32_16x16x32_bf16 a[140:143], v[96:99], v[28:31], a[140:143]
  v_mfma_f32_16x16x32_bf16 a[144:147], v[96:99], v[32:35], a[144:147]
  ds_read_b128 v[64:67], v6 offset:53248
  v_mfma_f32_16x16x32_bf16 a[148:151], v[96:99], v[36:39], a[148:151]
  buffer_load_dwordx4 v2, s[20:23], s46 offen lds
  v_mfma_f32_16x16x32_bf16 a[152:155], v[96:99], v[40:43], a[152:155]
  ds_read_b64_tr_b16 v[140:141], v8 offset:57344
  v_mfma_f32_16x16x32_bf16 a[156:159], v[96:99], v[44:47], a[156:159]
  v_mfma_f32_16x16x32_bf16 a[160:163], v[100:103], v[16:19], a[160:163]
  buffer_load_dword v191, v187, s[36:39], s70 offen
  v_mfma_f32_16x16x32_bf16 a[164:167], v[100:103], v[20:23], a[164:167]
  ds_read_b64_tr_b16 v[142:143], v8 offset:59392
  s_add_u32 m0, s53, 40960
  v_mfma_f32_16x16x32_bf16 a[168:171], v[100:103], v[24:27], a[168:171]
  v_mfma_f32_16x16x32_bf16 a[172:175], v[100:103], v[28:31], a[172:175]
  ds_read_b128 v[68:71], v6 offset:54272
  v_mfma_f32_16x16x32_bf16 a[176:179], v[100:103], v[32:35], a[176:179]
  v_mfma_f32_16x16x32_bf16 a[180:183], v[100:103], v[36:39], a[180:183]
  buffer_load_dwordx4 v3, s[24:27], s47 offen lds
  v_mfma_f32_16x16x32_bf16 a[184:187], v[100:103], v[40:43], a[184:187]
  ds_read_b64_tr_b16 v[144:145], v7 offset:61440
  v_mfma_f32_16x16x32_bf16 a[188:191], v[100:103], v[44:47], a[188:191]
  v_mfma_f32_16x16x32_bf16 a[192:195], v[104:107], v[16:19], a[192:195]
  ds_read_b64_tr_b16 v[146:147], v7 offset:63488
  v_mfma_f32_16x16x32_bf16 a[196:199], v[104:107], v[20:23], a[196:199]
  s_add_u32 m0, s53, 45056
  v_mfma_f32_16x16x32_bf16 a[200:203], v[104:107], v[24:27], a[200:203]
  v_mfma_f32_16x16x32_bf16 a[204:207], v[104:107], v[28:31], a[204:207]
  ds_read_b64_tr_b16 v[148:149], v8 offset:61440
  v_mfma_f32_16x16x32_bf16 a[208:211], v[104:107], v[32:35], a[208:211]
  v_mfma_f32_16x16x32_bf16 a[212:215], v[104:107], v[36:39], a[212:215]
  buffer_load_dwordx4 v3, s[28:31], s47 offen lds
  v_mfma_f32_16x16x32_bf16 a[216:219], v[104:107], v[40:43], a[216:219]
  ds_read_b128 v[72:75], v6 offset:55296
  v_mfma_f32_16x16x32_bf16 a[220:223], v[104:107], v[44:47], a[220:223]
  v_mfma_f32_16x16x32_bf16 a[224:227], v[108:111], v[16:19], a[224:227]
  ds_read_b64_tr_b16 v[150:151], v8 offset:63488
  v_mfma_f32_16x16x32_bf16 a[228:231], v[108:111], v[20:23], a[228:231]
  s_add_u32 m0, s54, 8192
  v_mfma_f32_16x16x32_bf16 a[232:235], v[108:111], v[24:27], a[232:235]
  v_mfma_f32_16x16x32_bf16 a[236:239], v[108:111], v[28:31], a[236:239]
  ds_read_b64_tr_b16 v[152:153], v9 offset:12288
  v_mfma_f32_16x16x32_bf16 a[240:243], v[108:111], v[32:35], a[240:243]
  v_mfma_f32_16x16x32_bf16 a[244:247], v[108:111], v[36:39], a[244:247]
  ds_read_b128 v[76:79], v6 offset:56320
  v_mfma_f32_16x16x32_bf16 a[248:251], v[108:111], v[40:43], a[248:251]
  global_load_lds_dwordx4 v[4:5], off
  v_mfma_f32_16x16x32_bf16 a[252:255], v[108:111], v[44:47], a[252:255]
  v_mfma_f32_16x16x32_bf16 v[192:195], v[112:115], v[16:19], v[192:195]
  ds_read_b64_tr_b16 v[154:155], v9 offset:14336
  v_mfma_f32_16x16x32_bf16 v[196:199], v[112:115], v[20:23], v[196:199]
  s_add_u32 s46, s46, s48
  v_mfma_f32_16x16x32_bf16 v[200:203], v[112:115], v[24:27], v[200:203]
  ds_read_b64_tr_b16 v[156:157], v10 offset:12288
  v_mfma_f32_16x16x32_bf16 v[204:207], v[112:115], v[28:31], v[204:207]
  v_mfma_f32_16x16x32_bf16 v[208:211], v[112:115], v[32:35], v[208:211]
  v_mfma_f32_16x16x32_bf16 v[212:215], v[112:115], v[36:39], v[212:215]
  ds_read_b64_tr_b16 v[158:159], v10 offset:14336
  s_add_u32 s47, s47, s49
  v_mfma_f32_16x16x32_bf16 v[216:219], v[112:115], v[40:43], v[216:219]
  v_mfma_f32_16x16x32_bf16 v[220:223], v[112:115], v[44:47], v[220:223]
  v_mfma_f32_16x16x32_bf16 v[224:227], v[116:119], v[16:19], v[224:227]
  v_mfma_f32_16x16x32_bf16 v[228:231], v[116:119], v[20:23], v[228:231]
  v_lshl_add_u64 v[4:5], s[50:51], 0, v[4:5]
  v_mfma_f32_16x16x32_bf16 v[232:235], v[116:119], v[24:27], v[232:235]
  v_mfma_f32_16x16x32_bf16 v[236:239], v[116:119], v[28:31], v[236:239]
  v_mfma_f32_16x16x32_bf16 v[240:243], v[116:119], v[32:35], v[240:243]
  v_mfma_f32_16x16x32_bf16 v[244:247], v[116:119], v[36:39], v[244:247]
  v_mfma_f32_16x16x32_bf16 v[248:251], v[116:119], v[40:43], v[248:251]
  v_mfma_f32_16x16x32_bf16 v[252:255], v[116:119], v[44:47], v[252:255]
  s_waitcnt vmcnt(20) lgkmcnt(0)
  s_barrier
  v_mfma_f32_16x16x32_bf16 a[0:3], v[120:123], v[48:51], a[0:3]
  ds_read_b128 v[16:19], v6 offset:0
  s_add_u32 m0, s52, 49152
  v_mfma_f32_16x16x32_bf16 a[4:7], v[120:123], v[52:55], a[4:7]
  s_mov_b32 s70, 6144
  v_mfma_f32_16x16x32_bf16 a[8:11], v[120:123], v[56:59], a[8:11]
  ds_read_b64_tr_b16 v[80:81], v7 offset:0
  v_mfma_f32_16x16x32_bf16 a[12:15], v[120:123], v[60:63], a[12:15]
  v_mfma_f32_16x16x32_bf16 a[16:19], v[120:123], v[64:67], a[16:19]
  buffer_load_dwordx4 v188, s[12:15], s45 offen offset:0 sc1 lds
  v_mfma_f32_16x16x32_bf16 a[20:23], v[120:123], v[68:71], a[20:23]
  ds_read_b64_tr_b16 v[82:83], v7 offset:2048
  v_mfma_f32_16x16x32_bf16 a[24:27], v[120:123], v[72:75], a[24:27]
  v_mfma_f32_16x16x32_bf16 a[28:31], v[120:123], v[76:79], a[28:31]
  ds_read_b128 v[20:23], v6 offset:1024
  v_mfma_f32_16x16x32_bf16 a[32:35], v[124:127], v[48:51], a[32:35]
  buffer_load_dwordx4 v188, s[12:15], s45 offen offset:1024 sc1 lds
  v_mfma_f32_16x16x32_bf16 a[36:39], v[124:127], v[52:55], a[36:39]
  v_mfma_f32_16x16x32_bf16 a[40:43], v[124:127], v[56:59], a[40:43]
  ds_read_b64_tr_b16 v[84:85], v8 offset:0
  v_mfma_f32_16x16x32_bf16 a[44:47], v[124:127], v[60:63], a[44:47]
  v_mfma_f32_16x16x32_bf16 a[48:51], v[124:127], v[64:67], a[48:51]
  ds_read_b64_tr_b16 v[86:87], v8 offset:2048
  v_mfma_f32_16x16x32_bf16 a[52:55], v[124:127], v[68:71], a[52:55]
  buffer_load_dwordx4 v188, s[12:15], s45 offen offset:2048 sc1 lds
  v_mfma_f32_16x16x32_bf16 a[56:59], v[124:127], v[72:75], a[56:59]
  v_mfma_f32_16x16x32_bf16 a[60:63], v[124:127], v[76:79], a[60:63]
  ds_read_b64_tr_b16 v[88:89], v7 offset:4096
  v_mfma_f32_16x16x32_bf16 a[64:67], v[128:131], v[48:51], a[64:67]
  buffer_load_dwordx4 v188, s[12:15], s45 offen offset:3072 sc1 lds
  v_mfma_f32_16x16x32_bf16 a[68:71], v[128:131], v[52:55], a[68:71]
  v_mfma_f32_16x16x32_bf16 a[72:75], v[128:131], v[56:59], a[72:75]
  ds_read_b128 v[24:27], v6 offset:2048
  v_mfma_f32_16x16x32_bf16 a[76:79], v[128:131], v[60:63], a[76:79]
  v_mfma_f32_16x16x32_bf16 a[80:83], v[128:131], v[64:67], a[80:83]
  ds_read_b64_tr_b16 v[90:91], v7 offset:6144
  s_add_u32 s45, s45, 16384
  v_mfma_f32_16x16x32_bf16 a[84:87], v[128:131], v[68:71], a[84:87]
  v_mfma_f32_16x16x32_bf16 a[88:91], v[128:131], v[72:75], a[88:91]
  v_mfma_f32_16x16x32_bf16 a[92:95], v[128:131], v[76:79], a[92:95]
  ds_read_b64_tr_b16 v[92:93], v8 offset:4096
  v_mfma_f32_16x16x32_bf16 a[96:99], v[132:135], v[48:51], a[96:99]
  s_add_u32 m0, s53, 49152
  v_mfma_f32_16x16x32_bf16 a[100:103], v[132:135], v[52:55], a[100:103]
  ds_read_b128 v[28:31], v6 offset:3072
  v_mfma_f32_16x16x32_bf16 a[104:107], v[132:135], v[56:59], a[104:107]
  v_mfma_f32_16x16x32_bf16 a[108:111], v[132:135], v[60:63], a[108:111]
  v_mfma_f32_16x16x32_bf16 a[112:115], v[132:135], v[64:67], a[112:115]
  ds_read_b64_tr_b16 v[94:95], v8 offset:6144
  v_mfma_f32_16x16x32_bf16 a[116:119], v[132:135], v[68:71], a[116:119]
  buffer_load_dwordx4 v2, s[16:19], s46 offen lds
  v_mfma_f32_16x16x32_bf16 a[120:123], v[132:135], v[72:75], a[120:123]
  ds_read_b64_tr_b16 v[96:97], v7 offset:8192
  v_mfma_f32_16x16x32_bf16 a[124:127], v[132:135], v[76:79], a[124:127]
  v_mfma_f32_16x16x32_bf16 a[128:131], v[136:139], v[48:51], a[128:131]
  s_add_u32 m0, s53, 53248
  v_mfma_f32_16x16x32_bf16 a[132:135], v[136:139], v[52:55], a[132:135]
  ds_read_b64_tr_b16 v[98:99], v7 offset:10240
  v_mfma_f32_16x16x32_bf16 a[136:139], v[136:139], v[56:59], a[136:139]
  v_mfma_f32_16x16x32_bf16 a[140:143], v[136:139], v[60:63], a[140:143]
  v_mfma_f32_16x16x32_bf16 a[144:147], v[136:139], v[64:67], a[144:147]
  ds_read_b128 v[32:35], v6 offset:4096
  v_mfma_f32_16x16x32_bf16 a[148:151], v[136:139], v[68:71], a[148:151]
  buffer_load_dwordx4 v2, s[20:23], s46 offen lds
  v_mfma_f32_16x16x32_bf16 a[152:155], v[136:139], v[72:75], a[152:155]
  ds_read_b64_tr_b16 v[100:101], v8 offset:8192
  v_mfma_f32_16x16x32_bf16 a[156:159], v[136:139], v[76:79], a[156:159]
  v_mfma_f32_16x16x32_bf16 a[160:163], v[140:143], v[48:51], a[160:163]
  buffer_load_dword v191, v187, s[36:39], s70 offen
  v_mfma_f32_16x16x32_bf16 a[164:167], v[140:143], v[52:55], a[164:167]
  ds_read_b64_tr_b16 v[102:103], v8 offset:10240
  s_add_u32 m0, s53, 57344
  v_mfma_f32_16x16x32_bf16 a[168:171], v[140:143], v[56:59], a[168:171]
  v_mfma_f32_16x16x32_bf16 a[172:175], v[140:143], v[60:63], a[172:175]
  ds_read_b128 v[36:39], v6 offset:5120
  v_mfma_f32_16x16x32_bf16 a[176:179], v[140:143], v[64:67], a[176:179]
  v_mfma_f32_16x16x32_bf16 a[180:183], v[140:143], v[68:71], a[180:183]
  buffer_load_dwordx4 v3, s[24:27], s47 offen lds
  v_mfma_f32_16x16x32_bf16 a[184:187], v[140:143], v[72:75], a[184:187]
  ds_read_b64_tr_b16 v[104:105], v7 offset:12288
  v_mfma_f32_16x16x32_bf16 a[188:191], v[140:143], v[76:79], a[188:191]
  v_mfma_f32_16x16x32_bf16 a[192:195], v[144:147], v[48:51], a[192:195]
  ds_read_b64_tr_b16 v[106:107], v7 offset:14336
  v_mfma_f32_16x16x32_bf16 a[196:199], v[144:147], v[52:55], a[196:199]
  s_add_u32 m0, s53, 61440
  v_mfma_f32_16x16x32_bf16 a[200:203], v[144:147], v[56:59], a[200:203]
  v_mfma_f32_16x16x32_bf16 a[204:207], v[144:147], v[60:63], a[204:207]
  ds_read_b64_tr_b16 v[108:109], v8 offset:12288
  v_mfma_f32_16x16x32_bf16 a[208:211], v[144:147], v[64:67], a[208:211]
  v_mfma_f32_16x16x32_bf16 a[212:215], v[144:147], v[68:71], a[212:215]
  buffer_load_dwordx4 v3, s[28:31], s47 offen lds
  v_mfma_f32_16x16x32_bf16 a[216:219], v[144:147], v[72:75], a[216:219]
  ds_read_b128 v[40:43], v6 offset:6144
  v_mfma_f32_16x16x32_bf16 a[220:223], v[144:147], v[76:79], a[220:223]
  v_mfma_f32_16x16x32_bf16 a[224:227], v[148:151], v[48:51], a[224:227]
  ds_read_b64_tr_b16 v[110:111], v8 offset:14336
  v_mfma_f32_16x16x32_bf16 a[228:231], v[148:151], v[52:55], a[228:231]
  s_add_u32 m0, s54, 12288
  v_mfma_f32_16x16x32_bf16 a[232:235], v[148:151], v[56:59], a[232:235]
  v_mfma_f32_16x16x32_bf16 a[236:239], v[148:151], v[60:63], a[236:239]
  ds_read_b64_tr_b16 v[112:113], v9 offset:0
  v_mfma_f32_16x16x32_bf16 a[240:243], v[148:151], v[64:67], a[240:243]
  v_mfma_f32_16x16x32_bf16 a[244:247], v[148:151], v[68:71], a[244:247]
  ds_read_b128 v[44:47], v6 offset:7168
  v_mfma_f32_16x16x32_bf16 a[248:251], v[148:151], v[72:75], a[248:251]
  global_load_lds_dwordx4 v[4:5], off
  v_mfma_f32_16x16x32_bf16 a[252:255], v[148:151], v[76:79], a[252:255]
  v_mfma_f32_16x16x32_bf16 v[192:195], v[152:155], v[48:51], v[192:195]
  ds_read_b64_tr_b16 v[114:115], v9 offset:2048
  v_mfma_f32_16x16x32_bf16 v[196:199], v[152:155], v[52:55], v[196:199]
  s_add_u32 s46, s46, s48
  v_mfma_f32_16x16x32_bf16 v[200:203], v[152:155], v[56:59], v[200:203]
  ds_read_b64_tr_b16 v[116:117], v10 offset:0
  v_mfma_f32_16x16x32_bf16 v[204:207], v[152:155], v[60:63], v[204:207]
  v_mfma_f32_16x16x32_bf16 v[208:211], v[152:155], v[64:67], v[208:211]
  v_mfma_f32_16x16x32_bf16 v[212:215], v[152:155], v[68:71], v[212:215]
  ds_read_b64_tr_b16 v[118:119], v10 offset:2048
  s_add_u32 s47, s47, s49
  v_mfma_f32_16x16x32_bf16 v[216:219], v[152:155], v[72:75], v[216:219]
  v_mfma_f32_16x16x32_bf16 v[220:223], v[152:155], v[76:79], v[220:223]
  v_mfma_f32_16x16x32_bf16 v[224:227], v[156:159], v[48:51], v[224:227]
  v_mfma_f32_16x16x32_bf16 v[228:231], v[156:159], v[52:55], v[228:231]
  v_lshl_add_u64 v[4:5], s[50:51], 0, v[4:5]
  v_mfma_f32_16x16x32_bf16 v[232:235], v[156:159], v[56:59], v[232:235]
  v_mfma_f32_16x16x32_bf16 v[236:239], v[156:159], v[60:63], v[236:239]
  v_mfma_f32_16x16x32_bf16 v[240:243], v[156:159], v[64:67], v[240:243]
  v_mfma_f32_16x16x32_bf16 v[244:247], v[156:159], v[68:71], v[244:247]
  v_mfma_f32_16x16x32_bf16 v[248:251], v[156:159], v[72:75], v[248:251]
  v_mfma_f32_16x16x32_bf16 v[252:255], v[156:159], v[76:79], v[252:255]
  s_waitcnt vmcnt(20) lgkmcnt(0)
  s_barrier
  s_mov_b32 s71, 0
g1_loop_G:
  v_mfma_f32_16x16x32_bf16 a[0:3], v[80:83], v[16:19], a[0:3]
  ds_read_b128 v[48:51], v6 offset:16384
  s_add_u32 m0, s52, 0
  v_mfma_f32_16x16x32_bf16 a[4:7], v[80:83], v[20:23], a[4:7]
  v_mfma_f32_16x16x32_bf16 a[8:11], v[80:83], v[24:27], a[8:11]
  ds_read_b64_tr_b16 v[120:121], v7 offset:16384
  v_mfma_f32_16x16x32_bf16 a[12:15], v[80:83], v[28:31], a[12:15]
  v_mfma_f32_16x16x32_bf16 a[16:19], v[80:83], v[32:35], a[16:19]
  buffer_load_dwordx4 v188, s[12:15], s45 offen offset:0 sc1 lds
  v_mfma_f32_16x16x32_bf16 a[20:23], v[80:83], v[36:39], a[20:23]
  ds_read_b64_tr_b16 v[122:123], v7 offset:18432
  v_mfma_f32_16x16x32_bf16 a[24:27], v[80:83], v[40:43], a[24:27]
  v_mfma_f32_16x16x32_bf16 a[28:31], v[80:83], v[44:47], a[28:31]
  ds_read_b128 v[52:55], v6 offset:17408
  v_mfma_f32_16x16x32_bf16 a[32:35], v[84:87], v[16:19], a[32:35]
  buffer_load_dwordx4 v188, s[12:15], s45 offen offset:1024 sc1 lds
  v_mfma_f32_16x16x32_bf16 a[36:39], v[84:87], v[20:23], a[36:39]
  v_mfma_f32_16x16x32_bf16 a[40:43], v[84:87], v[24:27], a[40:43]
  ds_read_b64_tr_b16 v[124:125], v8 offset:16384
  v_mfma_f32_16x16x32_bf16 a[44:47], v[84:87], v[28:31], a[44:47]
  v_mfma_f32_16x16x32_bf16 a[48:51], v[84:87], v[32:35], a[48:51]
  ds_read_b64_tr_b16 v[126:127], v8 offset:18432
  v_mfma_f32_16x16x32_bf16 a[52:55], v[84:87], v[36:39], a[52:55]
  buffer_load_dwordx4 v188, s[12:15], s45 offen offset:2048 sc1 lds
  v_mfma_f32_16x16x32_bf16 a[56:59], v[84:87], v[40:43], a[56:59]
  v_mfma_f32_16x16x32_bf16 a[60:63], v[84:87], v[44:47], a[60:63]
  ds_read_b64_tr_b16 v[128:129], v7 offset:20480
  v_mfma_f32_16x16x32_bf16 a[64:67], v[88:91], v[16:19], a[64:67]
  buffer_load_dwordx4 v188, s[12:15], s45 offen offset:3072 sc1 lds
  v_mfma_f32_16x16x32_bf16 a[68:71], v[88:91], v[20:23], a[68:71]
  v_mfma_f32_16x16x32_bf16 a[72:75], v[88:91], v[24:27], a[72:75]
  ds_read_b128 v[56:59], v6 offset:18432
  v_mfma_f32_16x16x32_bf16 a[76:79], v[88:91], v[28:31], a[76:79]
  v_mfma_f32_16x16x32_bf16 a[80:83], v[88:91], v[32:35], a[80:83]
  ds_read_b64_tr_b16 v[130:131], v7 offset:22528
  s_add_u32 s45, s45, 16384
  v_mfma_f32_16x16x32_bf16 a[84:87], v[88:91], v[36:39], a[84:87]
  v_mfma_f32_16x16x32_bf16 a[88:91], v[88:91], v[40:43], a[88:91]
  v_mfma_f32_16x16x32_bf16 a[92:95], v[88:91], v[44:47], a[92:95]
  ds_read_b64_tr_b16 v[132:133], v8 offset:20480
  v_mfma_f32_16x16x32_bf16 a[96:99], v[92:95], v[16:19], a[96:99]
  s_add_u32 m0, s53, 0
  v_mfma_f32_16x16x32_bf16 a[100:103], v[92:95], v[20:23], a[100:103]
  ds_read_b128 v[60:63], v6 offset:19456
  v_mfma_f32_16x16x32_bf16 a[104:107], v[92:95], v[24:27], a[104:107]
  v_mfma_f32_16x16x32_bf16 a[108:111], v[92:95], v[28:31], a[108:111]
  v_mfma_f32_16x16x32_bf16 a[112:115], v[92:95], v[32:35], a[112:115]
  ds_read_b64_tr_b16 v[134:135], v8 offset:22528
  v_mfma_f32_16x16x32_bf16 a[116:119], v[92:95], v[36:39], a[116:119]
  buffer_load_dwordx4 v2, s[16:19], s46 offen lds
  v_mfma_f32_16x16x32_bf16 a[120:123], v[92:95], v[40:43], a[120:123]
  ds_read_b64_tr_b16 v[136:137], v7 offset:24576
  v_mfma_f32_16x16x32_bf16 a[124:127], v[92:95], v[44:47], a[124:127]
  v_mfma_f32_16x16x32_bf16 a[128:131], v[96:99], v[16:19], a[128:131]
  s_add_u32 m0, s53, 4096
  v_mfma_f32_16x16x32_bf16 a[132:135], v[96:99], v[20:23], a[132:135]
  ds_read_b64_tr_b16 v[138:139], v7 offset:26624
  v_mfma_f32_16x16x32_bf16 a[136:139], v[96:99], v[24:27], a[136:139]
  v_mfma_f32_16x16x32_bf16 a[140:143], v[96:99], v[28:31], a[140:143]
  v_mfma_f32_16x16x32_bf16 a[144:147], v[96:99], v[32:35], a[144:147]
  ds_read_b128 v[64:67], v6 offset:20480
  v_mfma_f32_16x16x32_bf16 a[148:151], v[96:99], v[36:39], a[148:151]
  buffer_load_dwordx4 v2, s[20:23], s46 offen lds
  v_mfma_f32_16x16x32_bf16 a[152:155], v[96:99], v[40:43], a[152:155]
  ds_read_b64_tr_b16 v[140:141], v8 offset:24576
  v_mfma_f32_16x16x32_bf16 a[156:159], v[96:99], v[44:47], a[156:159]
  v_mfma_f32_16x16x32_bf16 a[160:163], v[100:103], v[16:19], a[160:163]
  v_mfma_f32_16x16x32_bf16 a[164:167], v[100:103], v[20:23], a[164:167]
  ds_read_b64_tr_b16 v[142:143], v8 offset:26624
  s_add_u32 m0, s53, 8192
  v_mfma_f32_16x16x32_bf16 a[168:171], v[100:103], v[24:27], a[168:171]
  v_mfma_f32_16x16x32_bf16 a[172:175], v[100:103], v[28:31], a[172:175]
  ds_read_b128 v[68:71], v6 offset:21504
  v_mfma_f32_16x16x32_bf16 a[176:179], v[100:103], v[32:35], a[176:179]
  v_mfma_f32_16x16x32_bf16 a[180:183], v[100:103], v[36:39], a[180:183]
  buffer_load_dwordx4 v3, s[24:27], s47 offen lds
  v_mfma_f32_16x16x32_bf16 a[184:187], v[100:103], v[40:43], a[184:187]
  ds_read_b64_tr_b16 v[144:145], v7 offset:28672
  v_mfma_f32_16x16x32_bf16 a[188:191], v[100:103], v[44:47], a[188:191]
  v_mfma_f32_16x16x32_bf16 a[192:195], v[104:107], v[16:19], a[192:195]
  ds_read_b64_tr_b16 v[146:147], v7 offset:30720
  v_mfma_f32_16x16x32_bf16 a[196:199], v[104:107], v[20:23], a[196:199]
  s_add_u32 m0, s53, 12288
  v_mfma_f32_16x16x32_bf16 a[200:203], v[104:107], v[24:27], a[200:203]
  v_mfma_f32_16x16x32_bf16 a[204:207], v[104:107], v[28:31], a[204:207]
  ds_read_b64_tr_b16 v[148:149], v8 offset:28672
  v_mfma_f32_16x16x32_bf16 a[208:211], v[104:107], v[32:35], a[208:211]
  v_mfma_f32_16x16x32_bf16 a[212:215], v[104:107], v[36:39], a[212:215]
  buffer_load_dwordx4 v3, s[28:31], s47 offen lds
  v_mfma_f32_16x16x32_bf16 a[216:219], v[104:107], v[40:43], a[216:219]
  ds_read_b128 v[72:75], v6 offset:22528
  v_mfma_f32_16x16x32_bf16 a[220:223], v[104:107], v[44:47], a[220:223]
  v_mfma_f32_16x16x32_bf16 a[224:227], v[108:111], v[16:19], a[224:227]
  ds_read_b64_tr_b16 v[150:151], v8 offset:30720
  v_mfma_f32_16x16x32_bf16 a[228:231], v[108:111], v[20:23], a[228:231]
  s_add_u32 m0, s54, 0
  v_mfma_f32_16x16x32_bf16 a[232:235], v[108:111], v[24:27], a[232:235]
  v_mfma_f32_16x16x32_bf16 a[236:239], v[108:111], v[28:31], a[236:239]
  ds_read_b64_tr_b16 v[152:153], v9 offset:4096
  v_mfma_f32_16x16x32_bf16 a[240:243], v[108:111], v[32:35], a[240:243]
  v_mfma_f32_16x16x32_bf16 a[244:247], v[108:111], v[36:39], a[244:247]
  ds_read_b128 v[76:79], v6 offset:23552
  v_mfma_f32_16x16x32_bf16 a[248:251], v[108:111], v[40:43], a[248:251]
  global_load_lds_dwordx4 v[4:5], off
  v_mfma_f32_16x16x32_bf16 a[252:255], v[108:111], v[44:47], a[252:255]
  v_mfma_f32_16x16x32_bf16 v[192:195], v[112:115], v[16:19], v[192:195]
  ds_read_b64_tr_b16 v[154:155], v9 offset:6144
  v_mfma_f32_16x16x32_bf16 v[196:199], v[112:115], v[20:23], v[196:199]
  s_add_u32 s46, s46, s48
  v_mfma_f32_16x16x32_bf16 v[200:203], v[112:115], v[24:27], v[200:203]
  ds_read_b64_tr_b16 v[156:157], v10 offset:4096
  v_mfma_f32_16x16x32_bf16 v[204:207], v[112:115], v[28:31], v[204:207]
  v_mfma_f32_16x16x32_bf16 v[208:211], v[112:115], v[32:35], v[208:211]
  v_mfma_f32_16x16x32_bf16 v[212:215], v[112:115], v[36:39], v[212:215]
  ds_read_b64_tr_b16 v[158:159], v10 offset:6144
  s_add_u32 s47, s47, s49
  v_mfma_f32_16x16x32_bf16 v[216:219], v[112:115], v[40:43], v[216:219]
  v_mfma_f32_16x16x32_bf16 v[220:223], v[112:115], v[44:47], v[220:223]
  v_mfma_f32_16x16x32_bf16 v[224:227], v[116:119], v[16:19], v[224:227]
  v_mfma_f32_16x16x32_bf16 v[228:231], v[116:119], v[20:23], v[228:231]
  v_lshl_add_u64 v[4:5], s[50:51], 0, v[4:5]
  v_mfma_f32_16x16x32_bf16 v[232:235], v[116:119], v[24:27], v[232:235]
  v_mfma_f32_16x16x32_bf16 v[236:239], v[116:119], v[28:31], v[236:239]
  v_mfma_f32_16x16x32_bf16 v[240:243], v[116:119], v[32:35], v[240:243]
  v_mfma_f32_16x16x32_bf16 v[244:247], v[116:119], v[36:39], v[244:247]
  v_mfma_f32_16x16x32_bf16 v[248:251], v[116:119], v[40:43], v[248:251]
  v_mfma_f32_16x16x32_bf16 v[252:255], v[116:119], v[44:47], v[252:255]
  s_waitcnt vmcnt(18) lgkmcnt(0)
  s_barrier
  v_mfma_f32_16x16x32_bf16 a[0:3], v[120:123], v[48:51], a[0:3]
  ds_read_b128 v[16:19], v6 offset:32768
  s_add_u32 m0, s52, 16384
  v_mfma_f32_16x16x32_bf16 a[4:7], v[120:123], v[52:55], a[4:7]
  v_mfma_f32_16x16x32_bf16 a[8:11], v[120:123], v[56:59], a[8:11]
  ds_read_b64_tr_b16 v[80:81], v7 offset:32768
  v_mfma_f32_16x16x32_bf16 a[12:15], v[120:123], v[60:63], a[12:15]
  v_mfma_f32_16x16x32_bf16 a[16:19], v[120:123], v[64:67], a[16:19]
  buffer_load_dwordx4 v188, s[12:15], s45 offen offset:0 sc1 lds
  v_mfma_f32_16x16x32_bf16 a[20:23], v[120:123], v[68:71], a[20:23]
  ds_read_b64_tr_b16 v[82:83], v7 offset:34816
  v_mfma_f32_16x16x32_bf16 a[24:27], v[120:123], v[72:75], a[24:27]
  v_mfma_f32_16x16x32_bf16 a[28:31], v[120:123], v[76:79], a[28:31]
  ds_read_b128 v[20:23], v6 offset:33792
  v_mfma_f32_16x16x32_bf16 a[32:35], v[124:127], v[48:51], a[32:35]
  buffer_load_dwordx4 v188, s[12:15], s45 offen offset:1024 sc1 lds
  v_mfma_f32_16x16x32_bf16 a[36:39], v[124:127], v[52:55], a[36:39]
  v_mfma_f32_16x16x32_bf16 a[40:43], v[124:127], v[56:59], a[40:43]
  ds_read_b64_tr_b16 v[84:85], v8 offset:32768
  v_mfma_f32_16x16x32_bf16 a[44:47], v[124:127], v[60:63], a[44:47]
  v_mfma_f32_16x16x32_bf16 a[48:51], v[124:127], v[64:67], a[48:51]
  ds_read_b64_tr_b16 v[86:87], v8 offset:34816
  v_mfma_f32_16x16x32_bf16 a[52:55], v[124:127], v[68:71], a[52:55]
  buffer_load_dwordx4 v188, s[12:15], s45 offen offset:2048 sc1 lds
  v_mfma_f32_16x16x32_bf16 a[56:59], v[124:127], v[72:75], a[56:59]
  v_mfma_f32_16x16x32_bf16 a[60:63], v[124:127], v[76:79], a[60:63]
  ds_read_b64_tr_b16 v[88:89], v7 offset:36864
  v_mfma_f32_16x16x32_bf16 a[64:67], v[128:131], v[48:51], a[64:67]
  buffer_load_dwordx4 v188, s[12:15], s45 offen offset:3072 sc1 lds
  v_mfma_f32_16x16x32_bf16 a[68:71], v[128:131], v[52:55], a[68:71]
  v_mfma_f32_16x16x32_bf16 a[72:75], v[128:131], v[56:59], a[72:75]
  ds_read_b128 v[24:27], v6 offset:34816
  v_mfma_f32_16x16x32_bf16 a[76:79], v[128:131], v[60:63], a[76:79]
  v_mfma_f32_16x16x32_bf16 a[80:83], v[128:131], v[64:67], a[80:83]
  ds_read_b64_tr_b16 v[90:91], v7 offset:38912
  s_add_u32 s45, s45, 16384
  v_mfma_f32_16x16x32_bf16 a[84:87], v[128:131], v[68:71], a[84:87]
  v_mfma_f32_16x16x32_bf16 a[88:91], v[128:131], v[72:75], a[88:91]
  v_mfma_f32_16x16x32_bf16 a[92:95], v[128:131], v[76:79], a[92:95]
  ds_read_b64_tr_b16 v[92:93], v8 offset:36864
  v_mfma_f32_16x16x32_bf16 a[96:99], v[132:135], v[48:51], a[96:99]
  s_add_u32 m0, s53, 16384
  v_mfma_f32_16x16x32_bf16 a[100:103], v[132:135], v[52:55], a[100:103]
  ds_read_b128 v[28:31], v6 offset:35840
  v_mfma_f32_16x16x32_bf16 a[104:107], v[132:135], v[56:59], a[104:107]
  v_mfma_f32_16x16x32_bf16 a[108:111], v[132:135], v[60:63], a[108:111]
  v_mfma_f32_16x16x32_bf16 a[112:115], v[132:135], v[64:67], a[112:115]
  ds_read_b64_tr_b16 v[94:95], v8 offset:38912
  v_mfma_f32_16x16x32_bf16 a[116:119], v[132:135], v[68:71], a[116:119]
  buffer_load_dwordx4 v2, s[16:19], s46 offen lds
  v_mfma_f32_16x16x32_bf16 a[120:123], v[132:135], v[72:75], a[120:123]
  ds_read_b64_tr_b16 v[96:97], v7 offset:40960
  v_mfma_f32_16x16x32_bf16 a[124:127], v[132:135], v[76:79], a[124:127]
  v_mfma_f32_16x16x32_bf16 a[128:131], v[136:139], v[48:51], a[128:131]
  s_add_u32 m0, s53, 20480
  v_mfma_f32_16x16x32_bf16 a[132:135], v[136:139], v[52:55], a[132:135]
  ds_read_b64_tr_b16 v[98:99], v7 offset:43008
  v_mfma_f32_16x16x32_bf16 a[136:139], v[136:139], v[56:59], a[136:139]
  v_mfma_f32_16x16x32_bf16 a[140:143], v[136:139], v[60:63], a[140:143]
  v_mfma_f32_16x16x32_bf16 a[144:147], v[136:139], v[64:67], a[144:147]
  ds_read_b128 v[32:35], v6 offset:36864
  v_mfma_f32_16x16x32_bf16 a[148:151], v[136:139], v[68:71], a[148:151]
  buffer_load_dwordx4 v2, s[20:23], s46 offen lds
  v_mfma_f32_16x16x32_bf16 a[152:155], v[136:139], v[72:75], a[152:155]
  ds_read_b64_tr_b16 v[100:101], v8 offset:40960
  v_mfma_f32_16x16x32_bf16 a[156:159], v[136:139], v[76:79], a[156:159]
  v_mfma_f32_16x16x32_bf16 a[160:163], v[140:143], v[48:51], a[160:163]
  v_mfma_f32_16x16x32_bf16 a[164:167], v[140:143], v[52:55], a[164:167]
  ds_read_b64_tr_b16 v[102:103], v8 offset:43008
  s_add_u32 m0, s53, 24576
  v_mfma_f32_16x16x32_bf16 a[168:171], v[140:143], v[56:59], a[168:171]
  v_mfma_f32_16x16x32_bf16 a[172:175], v[140:143], v[60:63], a[172:175]
  ds_read_b128 v[36:39], v6 offset:37888
  v_mfma_f32_16x16x32_bf16 a[176:179], v[140:143], v[64:67], a[176:179]
  v_mfma_f32_16x16x32_bf16 a[180:183], v[140:143], v[68:71], a[180:183]
  buffer_load_dwordx4 v3, s[24:27], s47 offen lds
  v_mfma_f32_16x16x32_bf16 a[184:187], v[140:143], v[72:75], a[184:187]
  ds_read_b64_tr_b16 v[104:105], v7 offset:45056
  v_mfma_f32_16x16x32_bf16 a[188:191], v[140:143], v[76:79], a[188:191]
  v_mfma_f32_16x16x32_bf16 a[192:195], v[144:147], v[48:51], a[192:195]
  ds_read_b64_tr_b16 v[106:107], v7 offset:47104
  v_mfma_f32_16x16x32_bf16 a[196:199], v[144:147], v[52:55], a[196:199]
  s_add_u32 m0, s53, 28672
  v_mfma_f32_16x16x32_bf16 a[200:203], v[144:147], v[56:59], a[200:203]
  v_mfma_f32_16x16x32_bf16 a[204:207], v[144:147], v[60:63], a[204:207]
  ds_read_b64_tr_b16 v[108:109], v8 offset:45056
  v_mfma_f32_16x16x32_bf16 a[208:211], v[144:147], v[64:67], a[208:211]
  v_mfma_f32_16x16x32_bf16 a[212:215], v[144:147], v[68:71], a[212:215]
  buffer_load_dwordx4 v3, s[28:31], s47 offen lds
  v_mfma_f32_16x16x32_bf16 a[216:219], v[144:147], v[72:75], a[216:219]
  ds_read_b128 v[40:43], v6 offset:38912
  v_mfma_f32_16x16x32_bf16 a[220:223], v[144:147], v[76:79], a[220:223]
  v_mfma_f32_16x16x32_bf16 a[224:227], v[148:151], v[48:51], a[224:227]
  ds_read_b64_tr_b16 v[110:111], v8 offset:47104
  v_mfma_f32_16x16x32_bf16 a[228:231], v[148:151], v[52:55], a[228:231]
  s_add_u32 m0, s54, 4096
  v_mfma_f32_16x16x32_bf16 a[232:235], v[148:151], v[56:59], a[232:235]
  v_mfma_f32_16x16x32_bf16 a[236:239], v[148:151], v[60:63], a[236:239]
  ds_read_b64_tr_b16 v[112:113], v9 offset:8192
  v_mfma_f32_16x16x32_bf16 a[240:243], v[148:151], v[64:67], a[240:243]
  v_mfma_f32_16x16x32_bf16 a[244:247], v[148:151], v[68:71], a[244:247]
  ds_read_b128 v[44:47], v6 offset:39936
  v_mfma_f32_16x16x32_bf16 a[248:251], v[148:151], v[72:75], a[248:251]
  global_load_lds_dwordx4 v[4:5], off
  v_mfma_f32_16x16x32_bf16 a[252:255], v[148:151], v[76:79], a[252:255]
  v_mfma_f32_16x16x32_bf16 v[192:195], v[152:155], v[48:51], v[192:195]
  ds_read_b64_tr_b16 v[114:115], v9 offset:10240
  v_mfma_f32_16x16x32_bf16 v[196:199], v[152:155], v[52:55], v[196:199]
  s_add_u32 s46, s46, s48
  v_mfma_f32_16x16x32_bf16 v[200:203], v[152:155], v[56:59], v[200:203]
  ds_read_b64_tr_b16 v[116:117], v10 offset:8192
  v_mfma_f32_16x16x32_bf16 v[204:207], v[152:155], v[60:63], v[204:207]
  v_mfma_f32_16x16x32_bf16 v[208:211], v[152:155], v[64:67], v[208:211]
  v_mfma_f32_16x16x32_bf16 v[212:215], v[152:155], v[68:71], v[212:215]
  ds_read_b64_tr_b16 v[118:119], v10 offset:10240
  s_add_u32 s47, s47, s49
  v_mfma_f32_16x16x32_bf16 v[216:219], v[152:155], v[72:75], v[216:219]
  v_mfma_f32_16x16x32_bf16 v[220:223], v[152:155], v[76:79], v[220:223]
  v_mfma_f32_16x16x32_bf16 v[224:227], v[156:159], v[48:51], v[224:227]
  v_mfma_f32_16x16x32_bf16 v[228:231], v[156:159], v[52:55], v[228:231]
  v_lshl_add_u64 v[4:5], s[50:51], 0, v[4:5]
  v_mfma_f32_16x16x32_bf16 v[232:235], v[156:159], v[56:59], v[232:235]
  v_mfma_f32_16x16x32_bf16 v[236:239], v[156:159], v[60:63], v[236:239]
  v_mfma_f32_16x16x32_bf16 v[240:243], v[156:159], v[64:67], v[240:243]
  v_mfma_f32_16x16x32_bf16 v[244:247], v[156:159], v[68:71], v[244:247]
  v_mfma_f32_16x16x32_bf16 v[248:251], v[156:159], v[72:75], v[248:251]
  v_mfma_f32_16x16x32_bf16 v[252:255], v[156:159], v[76:79], v[252:255]
  s_waitcnt vmcnt(18) lgkmcnt(0)
  s_barrier
  v_mfma_f32_16x16x32_bf16 a[0:3], v[80:83], v[16:19], a[0:3]
  ds_read_b128 v[48:51], v6 offset:49152
  s_add_u32 m0, s52, 32768
  v_mfma_f32_16x16x32_bf16 a[4:7], v[80:83], v[20:23], a[4:7]
  v_mfma_f32_16x16x32_bf16 a[8:11], v[80:83], v[24:27], a[8:11]
  ds_read_b64_tr_b16 v[120:121], v7 offset:49152
  v_mfma_f32_16x16x32_bf16 a[12:15], v[80:83], v[28:31], a[12:15]
  v_mfma_f32_16x16x32_bf16 a[16:19], v[80:83], v[32:35], a[16:19]
  buffer_load_dwordx4 v188, s[12:15], s45 offen offset:0 sc1 lds
  v_mfma_f32_16x16x32_bf16 a[20:23], v[80:83], v[36:39], a[20:23]
  ds_read_b64_tr_b16 v[122:123], v7 offset:51200
  v_mfma_f32_16x16x32_bf16 a[24:27], v[80:83], v[40:43], a[24:27]
  v_mfma_f32_16x16x32_bf16 a[28:31], v[80:83], v[44:47], a[28:31]
  ds_read_b128 v[52:55], v6 offset:50176
  v_mfma_f32_16x16x32_bf16 a[32:35], v[84:87], v[16:19], a[32:35]
  buffer_load_dwordx4 v188, s[12:15], s45 offen offset:1024 sc1 lds
  v_mfma_f32_16x16x32_bf16 a[36:39], v[84:87], v[20:23], a[36:39]
  v_mfma_f32_16x16x32_bf16 a[40:43], v[84:87], v[24:27], a[40:43]
  ds_read_b64_tr_b16 v[124:125], v8 offset:49152
  v_mfma_f32_16x16x32_bf16 a[44:47], v[84:87], v[28:31], a[44:47]
  v_mfma_f32_16x16x32_bf16 a[48:51], v[84:87], v[32:35], a[48:51]
  ds_read_b64_tr_b16 v[126:127], v8 offset:51200
  v_mfma_f32_16x16x32_bf16 a[52:55], v[84:87], v[36:39], a[52:55]
  buffer_load_dwordx4 v188, s[12:15], s45 offen offset:2048 sc1 lds
  v_mfma_f32_16x16x32_bf16 a[56:59], v[84:87], v[40:43], a[56:59]
  v_mfma_f32_16x16x32_bf16 a[60:63], v[84:87], v[44:47], a[60:63]
  ds_read_b64_tr_b16 v[128:129], v7 offset:53248
  v_mfma_f32_16x16x32_bf16 a[64:67], v[88:91], v[16:19], a[64:67]
  buffer_load_dwordx4 v188, s[12:15], s45 offen offset:3072 sc1 lds
  v_mfma_f32_16x16x32_bf16 a[68:71], v[88:91], v[20:23], a[68:71]
  v_mfma_f32_16x16x32_bf16 a[72:75], v[88:91], v[24:27], a[72:75]
  ds_read_b128 v[56:59], v6 offset:51200
  v_mfma_f32_16x16x32_bf16 a[76:79], v[88:91], v[28:31], a[76:79]
  v_mfma_f32_16x16x32_bf16 a[80:83], v[88:91], v[32:35], a[80:83]
  ds_read_b64_tr_b16 v[130:131], v7 offset:55296
  s_add_u32 s45, s45, 16384
  v_mfma_f32_16x16x32_bf16 a[84:87], v[88:91], v[36:39], a[84:87]
  v_mfma_f32_16x16x32_bf16 a[88:91], v[88:91], v[40:43], a[88:91]
  v_mfma_f32_16x16x32_bf16 a[92:95], v[88:91], v[44:47], a[92:95]
  ds_read_b64_tr_b16 v[132:133], v8 offset:53248
  v_mfma_f32_16x16x32_bf16 a[96:99], v[92:95], v[16:19], a[96:99]
  s_add_u32 m0, s53, 32768
  v_mfma_f32_16x16x32_bf16 a[100:103], v[92:95], v[20:23], a[100:103]
  ds_read_b128 v[60:63], v6 offset:52224
  v_mfma_f32_16x16x32_bf16 a[104:107], v[92:95], v[24:27], a[104:107]
  v_mfma_f32_16x16x32_bf16 a[108:111], v[92:95], v[28:31], a[108:111]
  v_mfma_f32_16x16x32_bf16 a[112:115], v[92:95], v[32:35], a[112:115]
  ds_read_b64_tr_b16 v[134:135], v8 offset:55296
  v_mfma_f32_16x16x32_bf16 a[116:119], v[92:95], v[36:39], a[116:119]
  buffer_load_dwordx4 v2, s[16:19], s46 offen lds
  v_mfma_f32_16x16x32_bf16 a[120:123], v[92:95], v[40:43], a[120:123]
  ds_read_b64_tr_b16 v[136:137], v7 offset:57344
  v_mfma_f32_16x16x32_bf16 a[124:127], v[92:95], v[44:47], a[124:127]
  v_mfma_f32_16x16x32_bf16 a[128:131], v[96:99], v[16:19], a[128:131]
  s_add_u32 m0, s53, 36864
  v_mfma_f32_16x16x32_bf16 a[132:135], v[96:99], v[20:23], a[132:135]
  ds_read_b64_tr_b16 v[138:139], v7 offset:59392
  v_mfma_f32_16x16x32_bf16 a[136:139], v[96:99], v[24:27], a[136:139]
  v_mfma_f32_16x16x32_bf16 a[140:143], v[96:99], v[28:31], a[140:143]
  v_mfma_f32_16x16x32_bf16 a[144:147], v[96:99], v[32:35], a[144:147]
  ds_read_b128 v[64:67], v6 offset:53248
  v_mfma_f32_16x16x32_bf16 a[148:151], v[96:99], v[36:39], a[148:151]
  buffer_load_dwordx4 v2, s[20:23], s46 offen lds
  v_mfma_f32_16x16x32_bf16 a[152:155], v[96:99], v[40:43], a[152:155]
  ds_read_b64_tr_b16 v[140:141], v8 offset:57344
  v_mfma_f32_16x16x32_bf16 a[156:159], v[96:99], v[44:47], a[156:159]
  v_mfma_f32_16x16x32_bf16 a[160:163], v[100:103], v[16:19], a[160:163]
  v_mfma_f32_16x16x32_bf16 a[164:167], v[100:103], v[20:23], a[164:167]
  ds_read_b64_tr_b16 v[142:143], v8 offset:59392
  s_add_u32 m0, s53, 40960
  v_mfma_f32_16x16x32_bf16 a[168:171], v[100:103], v[24:27], a[168:171]
  v_mfma_f32_16x16x32_bf16 a[172:175], v[100:103], v[28:31], a[172:175]
  ds_read_b128 v[68:71], v6 offset:54272
  v_mfma_f32_16x16x32_bf16 a[176:179], v[100:103], v[32:35], a[176:179]
  v_mfma_f32_16x16x32_bf16 a[180:183], v[100:103], v[36:39], a[180:183]
  buffer_load_dwordx4 v3, s[24:27], s47 offen lds
  v_mfma_f32_16x16x32_bf16 a[184:187], v[100:103], v[40:43], a[184:187]
  ds_read_b64_tr_b16 v[144:145], v7 offset:61440
  v_mfma_f32_16x16x32_bf16 a[188:191], v[100:103], v[44:47], a[188:191]
  v_mfma_f32_16x16x32_bf16 a[192:195], v[104:107], v[16:19], a[192:195]
  ds_read_b64_tr_b16 v[146:147], v7 offset:63488
  v_mfma_f32_16x16x32_bf16 a[196:199], v[104:107], v[20:23], a[196:199]
  s_add_u32 m0, s53, 45056
  v_mfma_f32_16x16x32_bf16 a[200:203], v[104:107], v[24:27], a[200:203]
  v_mfma_f32_16x16x32_bf16 a[204:207], v[104:107], v[28:31], a[204:207]
  ds_read_b64_tr_b16 v[148:149], v8 offset:61440
  v_mfma_f32_16x16x32_bf16 a[208:211], v[104:107], v[32:35], a[208:211]
  v_mfma_f32_16x16x32_bf16 a[212:215], v[104:107], v[36:39], a[212:215]
  buffer_load_dwordx4 v3, s[28:31], s47 offen lds
  v_mfma_f32_16x16x32_bf16 a[216:219], v[104:107], v[40:43], a[216:219]
  ds_read_b128 v[72:75], v6 offset:55296
  v_mfma_f32_16x16x32_bf16 a[220:223], v[104:107], v[44:47], a[220:223]
  v_mfma_f32_16x16x32_bf16 a[224:227], v[108:111], v[16:19], a[224:227]
  ds_read_b64_tr_b16 v[150:151], v8 offset:63488
  v_mfma_f32_16x16x32_bf16 a[228:231], v[108:111], v[20:23], a[228:231]
  s_add_u32 m0, s54, 8192
  v_mfma_f32_16x16x32_bf16 a[232:235], v[108:111], v[24:27], a[232:235]
  v_mfma_f32_16x16x32_bf16 a[236:239], v[108:111], v[28:31], a[236:239]
  ds_read_b64_tr_b16 v[152:153], v9 offset:12288
  v_mfma_f32_16x16x32_bf16 a[240:243], v[108:111], v[32:35], a[240:243]
  v_mfma_f32_16x16x32_bf16 a[244:247], v[108:111], v[36:39], a[244:247]
  ds_read_b128 v[76:79], v6 offset:56320
  v_mfma_f32_16x16x32_bf16 a[248:251], v[108:111], v[40:43], a[248:251]
  global_load_lds_dwordx4 v[4:5], off
  v_mfma_f32_16x16x32_bf16 a[252:255], v[108:111], v[44:47], a[252:255]
  v_mfma_f32_16x16x32_bf16 v[192:195], v[112:115], v[16:19], v[192:195]
  ds_read_b64_tr_b16 v[154:155], v9 offset:14336
  v_mfma_f32_16x16x32_bf16 v[196:199], v[112:115], v[20:23], v[196:199]
  s_add_u32 s46, s46, s48
  v_mfma_f32_16x16x32_bf16 v[200:203], v[112:115], v[24:27], v[200:203]
  ds_read_b64_tr_b16 v[156:157], v10 offset:12288
  v_mfma_f32_16x16x32_bf16 v[204:207], v[112:115], v[28:31], v[204:207]
  v_mfma_f32_16x16x32_bf16 v[208:211], v[112:115], v[32:35], v[208:211]
  v_mfma_f32_16x16x32_bf16 v[212:215], v[112:115], v[36:39], v[212:215]
  ds_read_b64_tr_b16 v[158:159], v10 offset:14336
  s_add_u32 s47, s47, s49
  v_mfma_f32_16x16x32_bf16 v[216:219], v[112:115], v[40:43], v[216:219]
  v_mfma_f32_16x16x32_bf16 v[220:223], v[112:115], v[44:47], v[220:223]
  v_mfma_f32_16x16x32_bf16 v[224:227], v[116:119], v[16:19], v[224:227]
  v_mfma_f32_16x16x32_bf16 v[228:231], v[116:119], v[20:23], v[228:231]
  v_lshl_add_u64 v[4:5], s[50:51], 0, v[4:5]
  v_mfma_f32_16x16x32_bf16 v[232:235], v[116:119], v[24:27], v[232:235]
  v_mfma_f32_16x16x32_bf16 v[236:239], v[116:119], v[28:31], v[236:239]
  v_mfma_f32_16x16x32_bf16 v[240:243], v[116:119], v[32:35], v[240:243]
  v_mfma_f32_16x16x32_bf16 v[244:247], v[116:119], v[36:39], v[244:247]
  v_mfma_f32_16x16x32_bf16 v[248:251], v[116:119], v[40:43], v[248:251]
  v_mfma_f32_16x16x32_bf16 v[252:255], v[116:119], v[44:47], v[252:255]
  s_waitcnt vmcnt(18) lgkmcnt(0)
  s_barrier
  v_mfma_f32_16x16x32_bf16 a[0:3], v[120:123], v[48:51], a[0:3]
  ds_read_b128 v[16:19], v6 offset:0
  s_add_u32 m0, s52, 49152
  v_mfma_f32_16x16x32_bf16 a[4:7], v[120:123], v[52:55], a[4:7]
  v_mfma_f32_16x16x32_bf16 a[8:11], v[120:123], v[56:59], a[8:11]
  ds_read_b64_tr_b16 v[80:81], v7 offset:0
  v_mfma_f32_16x16x32_bf16 a[12:15], v[120:123], v[60:63], a[12:15]
  v_mfma_f32_16x16x32_bf16 a[16:19], v[120:123], v[64:67], a[16:19]
  buffer_load_dwordx4 v188, s[12:15], s45 offen offset:0 sc1 lds
  v_mfma_f32_16x16x32_bf16 a[20:23], v[120:123], v[68:71], a[20:23]
  ds_read_b64_tr_b16 v[82:83], v7 offset:2048
  v_mfma_f32_16x16x32_bf16 a[24:27], v[120:123], v[72:75], a[24:27]
  v_mfma_f32_16x16x32_bf16 a[28:31], v[120:123], v[76:79], a[28:31]
  ds_read_b128 v[20:23], v6 offset:1024
  v_mfma_f32_16x16x32_bf16 a[32:35], v[124:127], v[48:51], a[32:35]
  buffer_load_dwordx4 v188, s[12:15], s45 offen offset:1024 sc1 lds
  v_mfma_f32_16x16x32_bf16 a[36:39], v[124:127], v[52:55], a[36:39]
  v_mfma_f32_16x16x32_bf16 a[40:43], v[124:127], v[56:59], a[40:43]
  ds_read_b64_tr_b16 v[84:85], v8 offset:0
  v_mfma_f32_16x16x32_bf16 a[44:47], v[124:127], v[60:63], a[44:47]
  v_mfma_f32_16x16x32_bf16 a[48:51], v[124:127], v[64:67], a[48:51]
  ds_read_b64_tr_b16 v[86:87], v8 offset:2048
  v_mfma_f32_16x16x32_bf16 a[52:55], v[124:127], v[68:71], a[52:55]
  buffer_load_dwordx4 v188, s[12:15], s45 offen offset:2048 sc1 lds
  v_mfma_f32_16x16x32_bf16 a[56:59], v[124:127], v[72:75], a[56:59]
  v_mfma_f32_16x16x32_bf16 a[60:63], v[124:127], v[76:79], a[60:63]
  ds_read_b64_tr_b16 v[88:89], v7 offset:4096
  v_mfma_f32_16x16x32_bf16 a[64:67], v[128:131], v[48:51], a[64:67]
  buffer_load_dwordx4 v188, s[12:15], s45 offen offset:3072 sc1 lds
  v_mfma_f32_16x16x32_bf16 a[68:71], v[128:131], v[52:55], a[68:71]
  v_mfma_f32_16x16x32_bf16 a[72:75], v[128:131], v[56:59], a[72:75]
  ds_read_b128 v[24:27], v6 offset:2048
  v_mfma_f32_16x16x32_bf16 a[76:79], v[128:131], v[60:63], a[76:79]
  v_mfma_f32_16x16x32_bf16 a[80:83], v[128:131], v[64:67], a[80:83]
  ds_read_b64_tr_b16 v[90:91], v7 offset:6144
  s_add_u32 s45, s45, 16384
  v_mfma_f32_16x16x32_bf16 a[84:87], v[128:131], v[68:71], a[84:87]
  v_mfma_f32_16x16x32_bf16 a[88:91], v[128:131], v[72:75], a[88:91]
  v_mfma_f32_16x16x32_bf16 a[92:95], v[128:131], v[76:79], a[92:95]
  ds_read_b64_tr_b16 v[92:93], v8 offset:4096
  v_mfma_f32_16x16x32_bf16 a[96:99], v[132:135], v[48:51], a[96:99]
  s_add_u32 m0, s53, 49152
  v_mfma_f32_16x16x32_bf16 a[100:103], v[132:135], v[52:55], a[100:103]
  ds_read_b128 v[28:31], v6 offset:3072
  v_mfma_f32_16x16x32_bf16 a[104:107], v[132:135], v[56:59], a[104:107]
  v_mfma_f32_16x16x32_bf16 a[108:111], v[132:135], v[60:63], a[108:111]
  v_mfma_f32_16x16x32_bf16 a[112:115], v[132:135], v[64:67], a[112:115]
  ds_read_b64_tr_b16 v[94:95], v8 offset:6144
  v_mfma_f32_16x16x32_bf16 a[116:119], v[132:135], v[68:71], a[116:119]
  buffer_load_dwordx4 v2, s[16:19], s46 offen lds
  v_mfma_f32_16x16x32_bf16 a[120:123], v[132:135], v[72:75], a[120:123]
  ds_read_b64_tr_b16 v[96:97], v7 offset:8192
  v_mfma_f32_16x16x32_bf16 a[124:127], v[132:135], v[76:79], a[124:127]
  v_mfma_f32_16x16x32_bf16 a[128:131], v[136:139], v[48:51], a[128:131]
  s_add_u32 m0, s53, 53248
  v_mfma_f32_16x16x32_bf16 a[132:135], v[136:139], v[52:55], a[132:135]
  ds_read_b64_tr_b16 v[98:99], v7 offset:10240
  v_mfma_f32_16x16x32_bf16 a[136:139], v[136:139], v[56:59], a[136:139]
  v_mfma_f32_16x16x32_bf16 a[140:143], v[136:139], v[60:63], a[140:143]
  v_mfma_f32_16x16x32_bf16 a[144:147], v[136:139], v[64:67], a[144:147]
  ds_read_b128 v[32:35], v6 offset:4096
  v_mfma_f32_16x16x32_bf16 a[148:151], v[136:139], v[68:71], a[148:151]
  buffer_load_dwordx4 v2, s[20:23], s46 offen lds
  v_mfma_f32_16x16x32_bf16 a[152:155], v[136:139], v[72:75], a[152:155]
  ds_read_b64_tr_b16 v[100:101], v8 offset:8192
  v_mfma_f32_16x16x32_bf16 a[156:159], v[136:139], v[76:79], a[156:159]
  v_mfma_f32_16x16x32_bf16 a[160:163], v[140:143], v[48:51], a[160:163]
  v_mfma_f32_16x16x32_bf16 a[164:167], v[140:143], v[52:55], a[164:167]
  ds_read_b64_tr_b16 v[102:103], v8 offset:10240
  s_add_u32 m0, s53, 57344
  v_mfma_f32_16x16x32_bf16 a[168:171], v[140:143], v[56:59], a[168:171]
  v_mfma_f32_16x16x32_bf16 a[172:175], v[140:143], v[60:63], a[172:175]
  ds_read_b128 v[36:39], v6 offset:5120
  v_mfma_f32_16x16x32_bf16 a[176:179], v[140:143], v[64:67], a[176:179]
  v_mfma_f32_16x16x32_bf16 a[180:183], v[140:143], v[68:71], a[180:183]
  buffer_load_dwordx4 v3, s[24:27], s47 offen lds
  v_mfma_f32_16x16x32_bf16 a[184:187], v[140:143], v[72:75], a[184:187]
  ds_read_b64_tr_b16 v[104:105], v7 offset:12288
  v_mfma_f32_16x16x32_bf16 a[188:191], v[140:143], v[76:79], a[188:191]
  v_mfma_f32_16x16x32_bf16 a[192:195], v[144:147], v[48:51], a[192:195]
  ds_read_b64_tr_b16 v[106:107], v7 offset:14336
  v_mfma_f32_16x16x32_bf16 a[196:199], v[144:147], v[52:55], a[196:199]
  s_add_u32 m0, s53, 61440
  v_mfma_f32_16x16x32_bf16 a[200:203], v[144:147], v[56:59], a[200:203]
  v_mfma_f32_16x16x32_bf16 a[204:207], v[144:147], v[60:63], a[204:207]
  ds_read_b64_tr_b16 v[108:109], v8 offset:12288
  v_mfma_f32_16x16x32_bf16 a[208:211], v[144:147], v[64:67], a[208:211]
  v_mfma_f32_16x16x32_bf16 a[212:215], v[144:147], v[68:71], a[212:215]
  buffer_load_dwordx4 v3, s[28:31], s47 offen lds
  v_mfma_f32_16x16x32_bf16 a[216:219], v[144:147], v[72:75], a[216:219]
  ds_read_b128 v[40:43], v6 offset:6144
  v_mfma_f32_16x16x32_bf16 a[220:223], v[144:147], v[76:79], a[220:223]
  v_mfma_f32_16x16x32_bf16 a[224:227], v[148:151], v[48:51], a[224:227]
  ds_read_b64_tr_b16 v[110:111], v8 offset:14336
  v_mfma_f32_16x16x32_bf16 a[228:231], v[148:151], v[52:55], a[228:231]
  s_add_u32 m0, s54, 12288
  v_mfma_f32_16x16x32_bf16 a[232:235], v[148:151], v[56:59], a[232:235]
  v_mfma_f32_16x16x32_bf16 a[236:239], v[148:151], v[60:63], a[236:239]
  ds_read_b64_tr_b16 v[112:113], v9 offset:0
  v_mfma_f32_16x16x32_bf16 a[240:243], v[148:151], v[64:67], a[240:243]
  v_mfma_f32_16x16x32_bf16 a[244:247], v[148:151], v[68:71], a[244:247]
  ds_read_b128 v[44:47], v6 offset:7168
  v_mfma_f32_16x16x32_bf16 a[248:251], v[148:151], v[72:75], a[248:251]
  global_load_lds_dwordx4 v[4:5], off
  v_mfma_f32_16x16x32_bf16 a[252:255], v[148:151], v[76:79], a[252:255]
  v_mfma_f32_16x16x32_bf16 v[192:195], v[152:155], v[48:51], v[192:195]
  ds_read_b64_tr_b16 v[114:115], v9 offset:2048
  v_mfma_f32_16x16x32_bf16 v[196:199], v[152:155], v[52:55], v[196:199]
  s_add_u32 s46, s46, s48
  v_mfma_f32_16x16x32_bf16 v[200:203], v[152:155], v[56:59], v[200:203]
  ds_read_b64_tr_b16 v[116:117], v10 offset:0
  v_mfma_f32_16x16x32_bf16 v[204:207], v[152:155], v[60:63], v[204:207]
  v_mfma_f32_16x16x32_bf16 v[208:211], v[152:155], v[64:67], v[208:211]
  v_mfma_f32_16x16x32_bf16 v[212:215], v[152:155], v[68:71], v[212:215]
  ds_read_b64_tr_b16 v[118:119], v10 offset:2048
  s_add_u32 s47, s47, s49
  v_mfma_f32_16x16x32_bf16 v[216:219], v[152:155], v[72:75], v[216:219]
  v_mfma_f32_16x16x32_bf16 v[220:223], v[152:155], v[76:79], v[220:223]
  v_mfma_f32_16x16x32_bf16 v[224:227], v[156:159], v[48:51], v[224:227]
  v_mfma_f32_16x16x32_bf16 v[228:231], v[156:159], v[52:55], v[228:231]
  v_lshl_add_u64 v[4:5], s[50:51], 0, v[4:5]
  v_mfma_f32_16x16x32_bf16 v[232:235], v[156:159], v[56:59], v[232:235]
  v_mfma_f32_16x16x32_bf16 v[236:239], v[156:159], v[60:63], v[236:239]
  v_mfma_f32_16x16x32_bf16 v[240:243], v[156:159], v[64:67], v[240:243]
  v_mfma_f32_16x16x32_bf16 v[244:247], v[156:159], v[68:71], v[244:247]
  v_mfma_f32_16x16x32_bf16 v[248:251], v[156:159], v[72:75], v[248:251]
  v_mfma_f32_16x16x32_bf16 v[252:255], v[156:159], v[76:79], v[252:255]
  s_waitcnt vmcnt(18) lgkmcnt(0)
  s_barrier
  s_add_u32 s71, s71, 1
  s_cmp_lt_u32 s71, 3
  s_cbranch_scc1 g1_loop_G
  v_mfma_f32_16x16x32_bf16 a[0:3], v[80:83], v[16:19], a[0:3]
  ds_read_b128 v[48:51], v6 offset:16384
  s_add_u32 m0, s52, 0
  v_mfma_f32_16x16x32_bf16 a[4:7], v[80:83], v[20:23], a[4:7]
  s_mov_b32 s70, 0
  v_mfma_f32_16x16x32_bf16 a[8:11], v[80:83], v[24:27], a[8:11]
  ds_read_b64_tr_b16 v[120:121], v7 offset:16384
  v_mfma_f32_16x16x32_bf16 a[12:15], v[80:83], v[28:31], a[12:15]
  v_mfma_f32_16x16x32_bf16 a[16:19], v[80:83], v[32:35], a[16:19]
  v_mfma_f32_16x16x32_bf16 a[20:23], v[80:83], v[36:39], a[20:23]
  ds_read_b64_tr_b16 v[122:123], v7 offset:18432
  v_mfma_f32_16x16x32_bf16 a[24:27], v[80:83], v[40:43], a[24:27]
  v_mfma_f32_16x16x32_bf16 a[28:31], v[80:83], v[44:47], a[28:31]
  ds_read_b128 v[52:55], v6 offset:17408
  v_mfma_f32_16x16x32_bf16 a[32:35], v[84:87], v[16:19], a[32:35]
  buffer_load_dwordx4 v188, s[12:15], s45 offen offset:0 sc1 lds
  v_mfma_f32_16x16x32_bf16 a[36:39], v[84:87], v[20:23], a[36:39]
  v_mfma_f32_16x16x32_bf16 a[40:43], v[84:87], v[24:27], a[40:43]
  ds_read_b64_tr_b16 v[124:125], v8 offset:16384
  v_mfma_f32_16x16x32_bf16 a[44:47], v[84:87], v[28:31], a[44:47]
  v_mfma_f32_16x16x32_bf16 a[48:51], v[84:87], v[32:35], a[48:51]
  ds_read_b64_tr_b16 v[126:127], v8 offset:18432
  v_mfma_f32_16x16x32_bf16 a[52:55], v[84:87], v[36:39], a[52:55]
  v_mfma_f32_16x16x32_bf16 a[56:59], v[84:87], v[40:43], a[56:59]
  buffer_load_dwordx4 v188, s[12:15], s45 offen offset:1024 sc1 lds
  v_mfma_f32_16x16x32_bf16 a[60:63], v[84:87], v[44:47], a[60:63]
  ds_read_b64_tr_b16 v[128:129], v7 offset:20480
  v_mfma_f32_16x16x32_bf16 a[64:67], v[88:91], v[16:19], a[64:67]
  v_mfma_f32_16x16x32_bf16 a[68:71], v[88:91], v[20:23], a[68:71]
  v_mfma_f32_16x16x32_bf16 a[72:75], v[88:91], v[24:27], a[72:75]
  ds_read_b128 v[56:59], v6 offset:18432
  v_mfma_f32_16x16x32_bf16 a[76:79], v[88:91], v[28:31], a[76:79]
  v_mfma_f32_16x16x32_bf16 a[80:83], v[88:91], v[32:35], a[80:83]
  ds_read_b64_tr_b16 v[130:131], v7 offset:22528
  v_mfma_f32_16x16x32_bf16 a[84:87], v[88:91], v[36:39], a[84:87]
  buffer_load_dwordx4 v188, s[12:15], s45 offen offset:2048 sc1 lds
  v_mfma_f32_16x16x32_bf16 a[88:91], v[88:91], v[40:43], a[88:91]
  v_mfma_f32_16x16x32_bf16 a[92:95], v[88:91], v[44:47], a[92:95]
  ds_read_b64_tr_b16 v[132:133], v8 offset:20480
  v_mfma_f32_16x16x32_bf16 a[96:99], v[92:95], v[16:19], a[96:99]
  v_mfma_f32_16x16x32_bf16 a[100:103], v[92:95], v[20:23], a[100:103]
  ds_read_b128 v[60:63], v6 offset:19456
  v_mfma_f32_16x16x32_bf16 a[104:107], v[92:95], v[24:27], a[104:107]
  v_mfma_f32_16x16x32_bf16 a[108:111], v[92:95], v[28:31], a[108:111]
  v_mfma_f32_16x16x32_bf16 a[112:115], v[92:95], v[32:35], a[112:115]
  ds_read_b64_tr_b16 v[134:135], v8 offset:22528
  v_mfma_f32_16x16x32_bf16 a[116:119], v[92:95], v[36:39], a[116:119]
  buffer_load_dwordx4 v188, s[12:15], s45 offen offset:3072 sc1 lds
  v_mfma_f32_16x16x32_bf16 a[120:123], v[92:95], v[40:43], a[120:123]
  ds_read_b64_tr_b16 v[136:137], v7 offset:24576
  v_mfma_f32_16x16x32_bf16 a[124:127], v[92:95], v[44:47], a[124:127]
  v_mfma_f32_16x16x32_bf16 a[128:131], v[96:99], v[16:19], a[128:131]
  v_mfma_f32_16x16x32_bf16 a[132:135], v[96:99], v[20:23], a[132:135]
  ds_read_b64_tr_b16 v[138:139], v7 offset:26624
  v_mfma_f32_16x16x32_bf16 a[136:139], v[96:99], v[24:27], a[136:139]
  v_mfma_f32_16x16x32_bf16 a[140:143], v[96:99], v[28:31], a[140:143]
  s_add_u32 s45, s45, 16384
  v_mfma_f32_16x16x32_bf16 a[144:147], v[96:99], v[32:35], a[144:147]
  ds_read_b128 v[64:67], v6 offset:20480
  v_mfma_f32_16x16x32_bf16 a[148:151], v[96:99], v[36:39], a[148:151]
  v_mfma_f32_16x16x32_bf16 a[152:155], v[96:99], v[40:43], a[152:155]
  ds_read_b64_tr_b16 v[140:141], v8 offset:24576
  v_mfma_f32_16x16x32_bf16 a[156:159], v[96:99], v[44:47], a[156:159]
  v_mfma_f32_16x16x32_bf16 a[160:163], v[100:103], v[16:19], a[160:163]
  buffer_load_dword v191, v190, s[32:35], s70 offen
  v_mfma_f32_16x16x32_bf16 a[164:167], v[100:103], v[20:23], a[164:167]
  ds_read_b64_tr_b16 v[142:143], v8 offset:26624
  v_mfma_f32_16x16x32_bf16 a[168:171], v[100:103], v[24:27], a[168:171]
  s_add_u32 m0, s53, 0
  v_mfma_f32_16x16x32_bf16 a[172:175], v[100:103], v[28:31], a[172:175]
  ds_read_b128 v[68:71], v6 offset:21504
  v_mfma_f32_16x16x32_bf16 a[176:179], v[100:103], v[32:35], a[176:179]
  v_mfma_f32_16x16x32_bf16 a[180:183], v[100:103], v[36:39], a[180:183]
  v_mfma_f32_16x16x32_bf16 a[184:187], v[100:103], v[40:43], a[184:187]
  ds_read_b64_tr_b16 v[144:145], v7 offset:28672
  v_mfma_f32_16x16x32_bf16 a[188:191], v[100:103], v[44:47], a[188:191]
  v_mfma_f32_16x16x32_bf16 a[192:195], v[104:107], v[16:19], a[192:195]
  ds_read_b64_tr_b16 v[146:147], v7 offset:30720
  v_mfma_f32_16x16x32_bf16 a[196:199], v[104:107], v[20:23], a[196:199]
  buffer_load_dwordx4 v2, s[16:19], s46 offen lds
  v_mfma_f32_16x16x32_bf16 a[200:203], v[104:107], v[24:27], a[200:203]
  v_mfma_f32_16x16x32_bf16 a[204:207], v[104:107], v[28:31], a[204:207]
  ds_read_b64_tr_b16 v[148:149], v8 offset:28672
  v_mfma_f32_16x16x32_bf16 a[208:211], v[104:107], v[32:35], a[208:211]
  v_mfma_f32_16x16x32_bf16 a[212:215], v[104:107], v[36:39], a[212:215]
  v_mfma_f32_16x16x32_bf16 a[216:219], v[104:107], v[40:43], a[216:219]
  ds_read_b128 v[72:75], v6 offset:22528
  v_mfma_f32_16x16x32_bf16 a[220:223], v[104:107], v[44:47], a[220:223]
  v_mfma_f32_16x16x32_bf16 a[224:227], v[108:111], v[16:19], a[224:227]
  ds_read_b64_tr_b16 v[150:151], v8 offset:30720
  s_add_u32 m0, s53, 4096
  v_mfma_f32_16x16x32_bf16 a[228:231], v[108:111], v[20:23], a[228:231]
  v_mfma_f32_16x16x32_bf16 a[232:235], v[108:111], v[24:27], a[232:235]
  v_mfma_f32_16x16x32_bf16 a[236:239], v[108:111], v[28:31], a[236:239]
  ds_read_b64_tr_b16 v[152:153], v9 offset:4096
  v_mfma_f32_16x16x32_bf16 a[240:243], v[108:111], v[32:35], a[240:243]
  v_mfma_f32_16x16x32_bf16 a[244:247], v[108:111], v[36:39], a[244:247]
  ds_read_b128 v[76:79], v6 offset:23552
  v_mfma_f32_16x16x32_bf16 a[248:251], v[108:111], v[40:43], a[248:251]
  v_mfma_f32_16x16x32_bf16 a[252:255], v[108:111], v[44:47], a[252:255]
  buffer_load_dwordx4 v2, s[20:23], s46 offen lds
  v_mfma_f32_16x16x32_bf16 v[192:195], v[112:115], v[16:19], v[192:195]
  ds_read_b64_tr_b16 v[154:155], v9 offset:6144
  v_mfma_f32_16x16x32_bf16 v[196:199], v[112:115], v[20:23], v[196:199]
  v_mfma_f32_16x16x32_bf16 v[200:203], v[112:115], v[24:27], v[200:203]
  ds_read_b64_tr_b16 v[156:157], v10 offset:4096
  v_mfma_f32_16x16x32_bf16 v[204:207], v[112:115], v[28:31], v[204:207]
  v_mfma_f32_16x16x32_bf16 v[208:211], v[112:115], v[32:35], v[208:211]
  v_mfma_f32_16x16x32_bf16 v[212:215], v[112:115], v[36:39], v[212:215]
  ds_read_b64_tr_b16 v[158:159], v10 offset:6144
  v_mfma_f32_16x16x32_bf16 v[216:219], v[112:115], v[40:43], v[216:219]
  s_add_u32 s46, s46, s48
  v_mfma_f32_16x16x32_bf16 v[220:223], v[112:115], v[44:47], v[220:223]
  v_mfma_f32_16x16x32_bf16 v[224:227], v[116:119], v[16:19], v[224:227]
  v_mfma_f32_16x16x32_bf16 v[228:231], v[116:119], v[20:23], v[228:231]
  v_mfma_f32_16x16x32_bf16 v[232:235], v[116:119], v[24:27], v[232:235]
  v_mfma_f32_16x16x32_bf16 v[236:239], v[116:119], v[28:31], v[236:239]
  v_mfma_f32_16x16x32_bf16 v[240:243], v[116:119], v[32:35], v[240:243]
  v_mfma_f32_16x16x32_bf16 v[244:247], v[116:119], v[36:39], v[244:247]
  v_mfma_f32_16x16x32_bf16 v[248:251], v[116:119], v[40:43], v[248:251]
  v_mfma_f32_16x16x32_bf16 v[252:255], v[116:119], v[44:47], v[252:255]
  s_waitcnt vmcnt(16) lgkmcnt(0)
  s_barrier
  v_mfma_f32_16x16x32_bf16 a[0:3], v[120:123], v[48:51], a[0:3]
  ds_read_b128 v[16:19], v6 offset:32768
  s_add_u32 m0, s52, 16384
  v_mfma_f32_16x16x32_bf16 a[4:7], v[120:123], v[52:55], a[4:7]
  s_mov_b32 s70, 2048
  v_mfma_f32_16x16x32_bf16 a[8:11], v[120:123], v[56:59], a[8:11]
  ds_read_b64_tr_b16 v[80:81], v7 offset:32768
  v_mfma_f32_16x16x32_bf16 a[12:15], v[120:123], v[60:63], a[12:15]
  v_mfma_f32_16x16x32_bf16 a[16:19], v[120:123], v[64:67], a[16:19]
  v_mfma_f32_16x16x32_bf16 a[20:23], v[120:123], v[68:71], a[20:23]
  ds_read_b64_tr_b16 v[82:83], v7 offset:34816
  v_mfma_f32_16x16x32_bf16 a[24:27], v[120:123], v[72:75], a[24:27]
  v_mfma_f32_16x16x32_bf16 a[28:31], v[120:123], v[76:79], a[28:31]
  ds_read_b128 v[20:23], v6 offset:33792
  v_mfma_f32_16x16x32_bf16 a[32:35], v[124:127], v[48:51], a[32:35]
  buffer_load_dwordx4 v188, s[12:15], s45 offen offset:0 sc1 lds
  v_mfma_f32_16x16x32_bf16 a[36:39], v[124:127], v[52:55], a[36:39]
  v_mfma_f32_16x16x32_bf16 a[40:43], v[124:127], v[56:59], a[40:43]
  ds_read_b64_tr_b16 v[84:85], v8 offset:32768
  v_mfma_f32_16x16x32_bf16 a[44:47], v[124:127], v[60:63], a[44:47]
  v_mfma_f32_16x16x32_bf16 a[48:51], v[124:127], v[64:67], a[48:51]
  ds_read_b64_tr_b16 v[86:87], v8 offset:34816
  v_mfma_f32_16x16x32_bf16 a[52:55], v[124:127], v[68:71], a[52:55]
  v_mfma_f32_16x16x32_bf16 a[56:59], v[124:127], v[72:75], a[56:59]
  buffer_load_dwordx4 v188, s[12:15], s45 offen offset:1024 sc1 lds
  v_mfma_f32_16x16x32_bf16 a[60:63], v[124:127], v[76:79], a[60:63]
  ds_read_b64_tr_b16 v[88:89], v7 offset:36864
  v_mfma_f32_16x16x32_bf16 a[64:67], v[128:131], v[48:51], a[64:67]
  v_mfma_f32_16x16x32_bf16 a[68:71], v[128:131], v[52:55], a[68:71]
  v_mfma_f32_16x16x32_bf16 a[72:75], v[128:131], v[56:59], a[72:75]
  ds_read_b128 v[24:27], v6 offset:34816
  v_mfma_f32_16x16x32_bf16 a[76:79], v[128:131], v[60:63], a[76:79]
  v_mfma_f32_16x16x32_bf16 a[80:83], v[128:131], v[64:67], a[80:83]
  ds_read_b64_tr_b16 v[90:91], v7 offset:38912
  v_mfma_f32_16x16x32_bf16 a[84:87], v[128:131], v[68:71], a[84:87]
  buffer_load_dwordx4 v188, s[12:15], s45 offen offset:2048 sc1 lds
  v_mfma_f32_16x16x32_bf16 a[88:91], v[128:131], v[72:75], a[88:91]
  v_mfma_f32_16x16x32_bf16 a[92:95], v[128:131], v[76:79], a[92:95]
  ds_read_b64_tr_b16 v[92:93], v8 offset:36864
  v_mfma_f32_16x16x32_bf16 a[96:99], v[132:135], v[48:51], a[96:99]
  v_mfma_f32_16x16x32_bf16 a[100:103], v[132:135], v[52:55], a[100:103]
  ds_read_b128 v[28:31], v6 offset:35840
  v_mfma_f32_16x16x32_bf16 a[104:107], v[132:135], v[56:59], a[104:107]
  v_mfma_f32_16x16x32_bf16 a[108:111], v[132:135], v[60:63], a[108:111]
  v_mfma_f32_16x16x32_bf16 a[112:115], v[132:135], v[64:67], a[112:115]
  ds_read_b64_tr_b16 v[94:95], v8 offset:38912
  v_mfma_f32_16x16x32_bf16 a[116:119], v[132:135], v[68:71], a[116:119]
  buffer_load_dwordx4 v188, s[12:15], s45 offen offset:3072 sc1 lds
  v_mfma_f32_16x16x32_bf16 a[120:123], v[132:135], v[72:75], a[120:123]
  ds_read_b64_tr_b16 v[96:97], v7 offset:40960
  v_mfma_f32_16x16x32_bf16 a[124:127], v[132:135], v[76:79], a[124:127]
  v_mfma_f32_16x16x32_bf16 a[128:131], v[136:139], v[48:51], a[128:131]
  v_mfma_f32_16x16x32_bf16 a[132:135], v[136:139], v[52:55], a[132:135]
  ds_read_b64_tr_b16 v[98:99], v7 offset:43008
  v_mfma_f32_16x16x32_bf16 a[136:139], v[136:139], v[56:59], a[136:139]
  v_mfma_f32_16x16x32_bf16 a[140:143], v[136:139], v[60:63], a[140:143]
  s_add_u32 s45, s45, 16384
  v_mfma_f32_16x16x32_bf16 a[144:147], v[136:139], v[64:67], a[144:147]
  ds_read_b128 v[32:35], v6 offset:36864
  v_mfma_f32_16x16x32_bf16 a[148:151], v[136:139], v[68:71], a[148:151]
  v_mfma_f32_16x16x32_bf16 a[152:155], v[136:139], v[72:75], a[152:155]
  ds_read_b64_tr_b16 v[100:101], v8 offset:40960
  v_mfma_f32_16x16x32_bf16 a[156:159], v[136:139], v[76:79], a[156:159]
  v_mfma_f32_16x16x32_bf16 a[160:163], v[140:143], v[48:51], a[160:163]
  buffer_load_dword v191, v190, s[32:35], s70 offen
  v_mfma_f32_16x16x32_bf16 a[164:167], v[140:143], v[52:55], a[164:167]
  ds_read_b64_tr_b16 v[102:103], v8 offset:43008
  v_mfma_f32_16x16x32_bf16 a[168:171], v[140:143], v[56:59], a[168:171]
  s_add_u32 m0, s53, 16384
  v_mfma_f32_16x16x32_bf16 a[172:175], v[140:143], v[60:63], a[172:175]
  ds_read_b128 v[36:39], v6 offset:37888
  v_mfma_f32_16x16x32_bf16 a[176:179], v[140:143], v[64:67], a[176:179]
  v_mfma_f32_16x16x32_bf16 a[180:183], v[140:143], v[68:71], a[180:183]
  v_mfma_f32_16x16x32_bf16 a[184:187], v[140:143], v[72:75], a[184:187]
  ds_read_b64_tr_b16 v[104:105], v7 offset:45056
  v_mfma_f32_16x16x32_bf16 a[188:191], v[140:143], v[76:79], a[188:191]
  v_mfma_f32_16x16x32_bf16 a[192:195], v[144:147], v[48:51], a[192:195]
  ds_read_b64_tr_b16 v[106:107], v7 offset:47104
  v_mfma_f32_16x16x32_bf16 a[196:199], v[144:147], v[52:55], a[196:199]
  buffer_load_dwordx4 v2, s[16:19], s46 offen lds
  v_mfma_f32_16x16x32_bf16 a[200:203], v[144:147], v[56:59], a[200:203]
  v_mfma_f32_16x16x32_bf16 a[204:207], v[144:147], v[60:63], a[204:207]
  ds_read_b64_tr_b16 v[108:109], v8 offset:45056
  v_mfma_f32_16x16x32_bf16 a[208:211], v[144:147], v[64:67], a[208:211]
  v_mfma_f32_16x16x32_bf16 a[212:215], v[144:147], v[68:71], a[212:215]
  v_mfma_f32_16x16x32_bf16 a[216:219], v[144:147], v[72:75], a[216:219]
  ds_read_b128 v[40:43], v6 offset:38912
  v_mfma_f32_16x16x32_bf16 a[220:223], v[144:147], v[76:79], a[220:223]
  v_mfma_f32_16x16x32_bf16 a[224:227], v[148:151], v[48:51], a[224:227]
  ds_read_b64_tr_b16 v[110:111], v8 offset:47104
  s_add_u32 m0, s53, 20480
  v_mfma_f32_16x16x32_bf16 a[228:231], v[148:151], v[52:55], a[228:231]
  v_mfma_f32_16x16x32_bf16 a[232:235], v[148:151], v[56:59], a[232:235]
  v_mfma_f32_16x16x32_bf16 a[236:239], v[148:151], v[60:63], a[236:239]
  ds_read_b64_tr_b16 v[112:113], v9 offset:8192
  v_mfma_f32_16x16x32_bf16 a[240:243], v[148:151], v[64:67], a[240:243]
  v_mfma_f32_16x16x32_bf16 a[244:247], v[148:151], v[68:71], a[244:247]
  ds_read_b128 v[44:47], v6 offset:39936
  v_mfma_f32_16x16x32_bf16 a[248:251], v[148:151], v[72:75], a[248:251]
  v_mfma_f32_16x16x32_bf16 a[252:255], v[148:151], v[76:79], a[252:255]
  buffer_load_dwordx4 v2, s[20:23], s46 offen lds
  v_mfma_f32_16x16x32_bf16 v[192:195], v[152:155], v[48:51], v[192:195]
  ds_read_b64_tr_b16 v[114:115], v9 offset:10240
  v_mfma_f32_16x16x32_bf16 v[196:199], v[152:155], v[52:55], v[196:199]
  v_mfma_f32_16x16x32_bf16 v[200:203], v[152:155], v[56:59], v[200:203]
  ds_read_b64_tr_b16 v[116:117], v10 offset:8192
  v_mfma_f32_16x16x32_bf16 v[204:207], v[152:155], v[60:63], v[204:207]
  v_mfma_f32_16x16x32_bf16 v[208:211], v[152:155], v[64:67], v[208:211]
  v_mfma_f32_16x16x32_bf16 v[212:215], v[152:155], v[68:71], v[212:215]
  ds_read_b64_tr_b16 v[118:119], v10 offset:10240
  v_mfma_f32_16x16x32_bf16 v[216:219], v[152:155], v[72:75], v[216:219]
  s_add_u32 s46, s46, s48
  v_mfma_f32_16x16x32_bf16 v[220:223], v[152:155], v[76:79], v[220:223]
  v_mfma_f32_16x16x32_bf16 v[224:227], v[156:159], v[48:51], v[224:227]
  v_mfma_f32_16x16x32_bf16 v[228:231], v[156:159], v[52:55], v[228:231]
  v_mfma_f32_16x16x32_bf16 v[232:235], v[156:159], v[56:59], v[232:235]
  v_mfma_f32_16x16x32_bf16 v[236:239], v[156:159], v[60:63], v[236:239]
  v_mfma_f32_16x16x32_bf16 v[240:243], v[156:159], v[64:67], v[240:243]
  v_mfma_f32_16x16x32_bf16 v[244:247], v[156:159], v[68:71], v[244:247]
  v_mfma_f32_16x16x32_bf16 v[248:251], v[156:159], v[72:75], v[248:251]
  v_mfma_f32_16x16x32_bf16 v[252:255], v[156:159], v[76:79], v[252:255]
  s_waitcnt vmcnt(14) lgkmcnt(0)
  s_barrier
  v_mfma_f32_16x16x32_bf16 a[0:3], v[80:83], v[16:19], a[0:3]
  ds_read_b128 v[48:51], v6 offset:49152
  s_add_u32 m0, s52, 32768
  v_mfma_f32_16x16x32_bf16 a[4:7], v[80:83], v[20:23], a[4:7]
  s_mov_b32 s70, 4096
  v_mfma_f32_16x16x32_bf16 a[8:11], v[80:83], v[24:27], a[8:11]
  ds_read_b64_tr_b16 v[120:121], v7 offset:49152
  v_mfma_f32_16x16x32_bf16 a[12:15], v[80:83], v[28:31], a[12:15]
  v_mfma_f32_16x16x32_bf16 a[16:19], v[80:83], v[32:35], a[16:19]
  v_mfma_f32_16x16x32_bf16 a[20:23], v[80:83], v[36:39], a[20:23]
  ds_read_b64_tr_b16 v[122:123], v7 offset:51200
  v_mfma_f32_16x16x32_bf16 a[24:27], v[80:83], v[40:43], a[24:27]
  v_mfma_f32_16x16x32_bf16 a[28:31], v[80:83], v[44:47], a[28:31]
  ds_read_b128 v[52:55], v6 offset:50176
  v_mfma_f32_16x16x32_bf16 a[32:35], v[84:87], v[16:19], a[32:35]
  buffer_load_dwordx4 v188, s[12:15], s45 offen offset:0 sc1 lds
  v_mfma_f32_16x16x32_bf16 a[36:39], v[84:87], v[20:23], a[36:39]
  v_mfma_f32_16x16x32_bf16 a[40:43], v[84:87], v[24:27], a[40:43]
  ds_read_b64_tr_b16 v[124:125], v8 offset:49152
  v_mfma_f32_16x16x32_bf16 a[44:47], v[84:87], v[28:31], a[44:47]
  v_mfma_f32_16x16x32_bf16 a[48:51], v[84:87], v[32:35], a[48:51]
  ds_read_b64_tr_b16 v[126:127], v8 offset:51200
  v_mfma_f32_16x16x32_bf16 a[52:55], v[84:87], v[36:39], a[52:55]
  v_mfma_f32_16x16x32_bf16 a[56:59], v[84:87], v[40:43], a[56:59]
  buffer_load_dwordx4 v188, s[12:15], s45 offen offset:1024 sc1 lds
  v_mfma_f32_16x16x32_bf16 a[60:63], v[84:87], v[44:47], a[60:63]
  ds_read_b64_tr_b16 v[128:129], v7 offset:53248
  v_mfma_f32_16x16x32_bf16 a[64:67], v[88:91], v[16:19], a[64:67]
  v_mfma_f32_16x16x32_bf16 a[68:71], v[88:91], v[20:23], a[68:71]
  v_mfma_f32_16x16x32_bf16 a[72:75], v[88:91], v[24:27], a[72:75]
  ds_read_b128 v[56:59], v6 offset:51200
  v_mfma_f32_16x16x32_bf16 a[76:79], v[88:91], v[28:31], a[76:79]
  v_mfma_f32_16x16x32_bf16 a[80:83], v[88:91], v[32:35], a[80:83]
  ds_read_b64_tr_b16 v[130:131], v7 offset:55296
  v_mfma_f32_16x16x32_bf16 a[84:87], v[88:91], v[36:39], a[84:87]
  buffer_load_dwordx4 v188, s[12:15], s45 offen offset:2048 sc1 lds
  v_mfma_f32_16x16x32_bf16 a[88:91], v[88:91], v[40:43], a[88:91]
  v_mfma_f32_16x16x32_bf16 a[92:95], v[88:91], v[44:47], a[92:95]
  ds_read_b64_tr_b16 v[132:133], v8 offset:53248
  v_mfma_f32_16x16x32_bf16 a[96:99], v[92:95], v[16:19], a[96:99]
  v_mfma_f32_16x16x32_bf16 a[100:103], v[92:95], v[20:23], a[100:103]
  ds_read_b128 v[60:63], v6 offset:52224
  v_mfma_f32_16x16x32_bf16 a[104:107], v[92:95], v[24:27], a[104:107]
  v_mfma_f32_16x16x32_bf16 a[108:111], v[92:95], v[28:31], a[108:111]
  v_mfma_f32_16x16x32_bf16 a[112:115], v[92:95], v[32:35], a[112:115]
  ds_read_b64_tr_b16 v[134:135], v8 offset:55296
  v_mfma_f32_16x16x32_bf16 a[116:119], v[92:95], v[36:39], a[116:119]
  buffer_load_dwordx4 v188, s[12:15], s45 offen offset:3072 sc1 lds
  v_mfma_f32_16x16x32_bf16 a[120:123], v[92:95], v[40:43], a[120:123]
  ds_read_b64_tr_b16 v[136:137], v7 offset:57344
  v_mfma_f32_16x16x32_bf16 a[124:127], v[92:95], v[44:47], a[124:127]
  v_mfma_f32_16x16x32_bf16 a[128:131], v[96:99], v[16:19], a[128:131]
  v_mfma_f32_16x16x32_bf16 a[132:135], v[96:99], v[20:23], a[132:135]
  ds_read_b64_tr_b16 v[138:139], v7 offset:59392
  v_mfma_f32_16x16x32_bf16 a[136:139], v[96:99], v[24:27], a[136:139]
  v_mfma_f32_16x16x32_bf16 a[140:143], v[96:99], v[28:31], a[140:143]
  s_add_u32 s45, s45, 16384
  v_mfma_f32_16x16x32_bf16 a[144:147], v[96:99], v[32:35], a[144:147]
  ds_read_b128 v[64:67], v6 offset:53248
  v_mfma_f32_16x16x32_bf16 a[148:151], v[96:99], v[36:39], a[148:151]
  v_mfma_f32_16x16x32_bf16 a[152:155], v[96:99], v[40:43], a[152:155]
  ds_read_b64_tr_b16 v[140:141], v8 offset:57344
  v_mfma_f32_16x16x32_bf16 a[156:159], v[96:99], v[44:47], a[156:159]
  v_mfma_f32_16x16x32_bf16 a[160:163], v[100:103], v[16:19], a[160:163]
  buffer_load_dword v191, v190, s[32:35], s70 offen
  v_mfma_f32_16x16x32_bf16 a[164:167], v[100:103], v[20:23], a[164:167]
  ds_read_b64_tr_b16 v[142:143], v8 offset:59392
  v_mfma_f32_16x16x32_bf16 a[168:171], v[100:103], v[24:27], a[168:171]
  s_add_u32 m0, s53, 32768
  v_mfma_f32_16x16x32_bf16 a[172:175], v[100:103], v[28:31], a[172:175]
  ds_read_b128 v[68:71], v6 offset:54272
  v_mfma_f32_16x16x32_bf16 a[176:179], v[100:103], v[32:35], a[176:179]
  v_mfma_f32_16x16x32_bf16 a[180:183], v[100:103], v[36:39], a[180:183]
  v_mfma_f32_16x16x32_bf16 a[184:187], v[100:103], v[40:43], a[184:187]
  ds_read_b64_tr_b16 v[144:145], v7 offset:61440
  v_mfma_f32_16x16x32_bf16 a[188:191], v[100:103], v[44:47], a[188:191]
  v_mfma_f32_16x16x32_bf16 a[192:195], v[104:107], v[16:19], a[192:195]
  ds_read_b64_tr_b16 v[146:147], v7 offset:63488
  v_mfma_f32_16x16x32_bf16 a[196:199], v[104:107], v[20:23], a[196:199]
  buffer_load_dwordx4 v2, s[16:19], s46 offen lds
  v_mfma_f32_16x16x32_bf16 a[200:203], v[104:107], v[24:27], a[200:203]
  v_mfma_f32_16x16x32_bf16 a[204:207], v[104:107], v[28:31], a[204:207]
  ds_read_b64_tr_b16 v[148:149], v8 offset:61440
  v_mfma_f32_16x16x32_bf16 a[208:211], v[104:107], v[32:35], a[208:211]
  v_mfma_f32_16x16x32_bf16 a[212:215], v[104:107], v[36:39], a[212:215]
  v_mfma_f32_16x16x32_bf16 a[216:219], v[104:107], v[40:43], a[216:219]
  ds_read_b128 v[72:75], v6 offset:55296
  v_mfma_f32_16x16x32_bf16 a[220:223], v[104:107], v[44:47], a[220:223]
  v_mfma_f32_16x16x32_bf16 a[224:227], v[108:111], v[16:19], a[224:227]
  ds_read_b64_tr_b16 v[150:151], v8 offset:63488
  s_add_u32 m0, s53, 36864
  v_mfma_f32_16x16x32_bf16 a[228:231], v[108:111], v[20:23], a[228:231]
  v_mfma_f32_16x16x32_bf16 a[232:235], v[108:111], v[24:27], a[232:235]
  v_mfma_f32_16x16x32_bf16 a[236:239], v[108:111], v[28:31], a[236:239]
  ds_read_b64_tr_b16 v[152:153], v9 offset:12288
  v_mfma_f32_16x16x32_bf16 a[240:243], v[108:111], v[32:35], a[240:243]
  v_mfma_f32_16x16x32_bf16 a[244:247], v[108:111], v[36:39], a[244:247]
  ds_read_b128 v[76:79], v6 offset:56320
  v_mfma_f32_16x16x32_bf16 a[248:251], v[108:111], v[40:43], a[248:251]
  v_mfma_f32_16x16x32_bf16 a[252:255], v[108:111], v[44:47], a[252:255]
  buffer_load_dwordx4 v2, s[20:23], s46 offen lds
  v_mfma_f32_16x16x32_bf16 v[192:195], v[112:115], v[16:19], v[192:195]
  ds_read_b64_tr_b16 v[154:155], v9 offset:14336
  v_mfma_f32_16x16x32_bf16 v[196:199], v[112:115], v[20:23], v[196:199]
  v_mfma_f32_16x16x32_bf16 v[200:203], v[112:115], v[24:27], v[200:203]
  ds_read_b64_tr_b16 v[156:157], v10 offset:12288
  v_mfma_f32_16x16x32_bf16 v[204:207], v[112:115], v[28:31], v[204:207]
  v_mfma_f32_16x16x32_bf16 v[208:211], v[112:115], v[32:35], v[208:211]
  v_mfma_f32_16x16x32_bf16 v[212:215], v[112:115], v[36:39], v[212:215]
  ds_read_b64_tr_b16 v[158:159], v10 offset:14336
  v_mfma_f32_16x16x32_bf16 v[216:219], v[112:115], v[40:43], v[216:219]
  s_add_u32 s46, s46, s48
  v_mfma_f32_16x16x32_bf16 v[220:223], v[112:115], v[44:47], v[220:223]
  v_mfma_f32_16x16x32_bf16 v[224:227], v[116:119], v[16:19], v[224:227]
  v_mfma_f32_16x16x32_bf16 v[228:231], v[116:119], v[20:23], v[228:231]
  v_mfma_f32_16x16x32_bf16 v[232:235], v[116:119], v[24:27], v[232:235]
  v_mfma_f32_16x16x32_bf16 v[236:239], v[116:119], v[28:31], v[236:239]
  v_mfma_f32_16x16x32_bf16 v[240:243], v[116:119], v[32:35], v[240:243]
  v_mfma_f32_16x16x32_bf16 v[244:247], v[116:119], v[36:39], v[244:247]
  v_mfma_f32_16x16x32_bf16 v[248:251], v[116:119], v[40:43], v[248:251]
  v_mfma_f32_16x16x32_bf16 v[252:255], v[116:119], v[44:47], v[252:255]
  s_waitcnt vmcnt(14) lgkmcnt(0)
  s_barrier
  v_mfma_f32_16x16x32_bf16 a[0:3], v[120:123], v[48:51], a[0:3]
  ds_read_b128 v[16:19], v6 offset:0
  s_add_u32 m0, s52, 49152
  v_mfma_f32_16x16x32_bf16 a[4:7], v[120:123], v[52:55], a[4:7]
  s_mov_b32 s70, 6144
  v_mfma_f32_16x16x32_bf16 a[8:11], v[120:123], v[56:59], a[8:11]
  v_mfma_f32_16x16x32_bf16 a[12:15], v[120:123], v[60:63], a[12:15]
  v_mfma_f32_16x16x32_bf16 a[16:19], v[120:123], v[64:67], a[16:19]
  ds_read_b64_tr_b16 v[80:81], v7 offset:0
  v_mfma_f32_16x16x32_bf16 a[20:23], v[120:123], v[68:71], a[20:23]
  v_mfma_f32_16x16x32_bf16 a[24:27], v[120:123], v[72:75], a[24:27]
  v_mfma_f32_16x16x32_bf16 a[28:31], v[120:123], v[76:79], a[28:31]
  buffer_load_dwordx4 v188, s[12:15], s45 offen offset:0 sc1 lds
  v_mfma_f32_16x16x32_bf16 a[32:35], v[124:127], v[48:51], a[32:35]
  v_mfma_f32_16x16x32_bf16 a[36:39], v[124:127], v[52:55], a[36:39]
  ds_read_b128 v[20:23], v6 offset:1024
  v_mfma_f32_16x16x32_bf16 a[40:43], v[124:127], v[56:59], a[40:43]
  v_mfma_f32_16x16x32_bf16 a[44:47], v[124:127], v[60:63], a[44:47]
  v_mfma_f32_16x16x32_bf16 a[48:51], v[124:127], v[64:67], a[48:51]
  v_mfma_f32_16x16x32_bf16 a[52:55], v[124:127], v[68:71], a[52:55]
  ds_read_b64_tr_b16 v[82:83], v7 offset:2048
  v_mfma_f32_16x16x32_bf16 a[56:59], v[124:127], v[72:75], a[56:59]
  buffer_load_dwordx4 v188, s[12:15], s45 offen offset:1024 sc1 lds
  v_mfma_f32_16x16x32_bf16 a[60:63], v[124:127], v[76:79], a[60:63]
  v_mfma_f32_16x16x32_bf16 a[64:67], v[128:131], v[48:51], a[64:67]
  v_mfma_f32_16x16x32_bf16 a[68:71], v[128:131], v[52:55], a[68:71]
  v_mfma_f32_16x16x32_bf16 a[72:75], v[128:131], v[56:59], a[72:75]
  ds_read_b128 v[24:27], v6 offset:2048
  v_mfma_f32_16x16x32_bf16 a[76:79], v[128:131], v[60:63], a[76:79]
  v_mfma_f32_16x16x32_bf16 a[80:83], v[128:131], v[64:67], a[80:83]
  v_mfma_f32_16x16x32_bf16 a[84:87], v[128:131], v[68:71], a[84:87]
  buffer_load_dwordx4 v188, s[12:15], s45 offen offset:2048 sc1 lds
  v_mfma_f32_16x16x32_bf16 a[88:91], v[128:131], v[72:75], a[88:91]
  ds_read_b64_tr_b16 v[84:85], v8 offset:0
  v_mfma_f32_16x16x32_bf16 a[92:95], v[128:131], v[76:79], a[92:95]
  v_mfma_f32_16x16x32_bf16 a[96:99], v[132:135], v[48:51], a[96:99]
  v_mfma_f32_16x16x32_bf16 a[100:103], v[132:135], v[52:55], a[100:103]
  v_mfma_f32_16x16x32_bf16 a[104:107], v[132:135], v[56:59], a[104:107]
  v_mfma_f32_16x16x32_bf16 a[108:111], v[132:135], v[60:63], a[108:111]
  ds_read_b128 v[28:31], v6 offset:3072
  v_mfma_f32_16x16x32_bf16 a[112:115], v[132:135], v[64:67], a[112:115]
  buffer_load_dwordx4 v188, s[12:15], s45 offen offset:3072 sc1 lds
  v_mfma_f32_16x16x32_bf16 a[116:119], v[132:135], v[68:71], a[116:119]
  v_mfma_f32_16x16x32_bf16 a[120:123], v[132:135], v[72:75], a[120:123]
  v_mfma_f32_16x16x32_bf16 a[124:127], v[132:135], v[76:79], a[124:127]
  ds_read_b64_tr_b16 v[86:87], v8 offset:2048
  v_mfma_f32_16x16x32_bf16 a[128:131], v[136:139], v[48:51], a[128:131]
  v_mfma_f32_16x16x32_bf16 a[132:135], v[136:139], v[52:55], a[132:135]
  v_mfma_f32_16x16x32_bf16 a[136:139], v[136:139], v[56:59], a[136:139]
  v_mfma_f32_16x16x32_bf16 a[140:143], v[136:139], v[60:63], a[140:143]
  s_add_u32 s45, s45, 16384
  v_mfma_f32_16x16x32_bf16 a[144:147], v[136:139], v[64:67], a[144:147]
  ds_read_b128 v[32:35], v6 offset:4096
  v_mfma_f32_16x16x32_bf16 a[148:151], v[136:139], v[68:71], a[148:151]
  v_mfma_f32_16x16x32_bf16 a[152:155], v[136:139], v[72:75], a[152:155]
  v_mfma_f32_16x16x32_bf16 a[156:159], v[136:139], v[76:79], a[156:159]
  v_mfma_f32_16x16x32_bf16 a[160:163], v[140:143], v[48:51], a[160:163]
  ds_read_b64_tr_b16 v[88:89], v7 offset:4096
  v_mfma_f32_16x16x32_bf16 a[164:167], v[140:143], v[52:55], a[164:167]
  buffer_load_dword v191, v190, s[32:35], s70 offen
  v_mfma_f32_16x16x32_bf16 a[168:171], v[140:143], v[56:59], a[168:171]
  s_add_u32 m0, s53, 49152
  v_mfma_f32_16x16x32_bf16 a[172:175], v[140:143], v[60:63], a[172:175]
  v_mfma_f32_16x16x32_bf16 a[176:179], v[140:143], v[64:67], a[176:179]
  v_mfma_f32_16x16x32_bf16 a[180:183], v[140:143], v[68:71], a[180:183]
  ds_read_b128 v[36:39], v6 offset:5120
  v_mfma_f32_16x16x32_bf16 a[184:187], v[140:143], v[72:75], a[184:187]
  v_mfma_f32_16x16x32_bf16 a[188:191], v[140:143], v[76:79], a[188:191]
  v_mfma_f32_16x16x32_bf16 a[192:195], v[144:147], v[48:51], a[192:195]
  v_mfma_f32_16x16x32_bf16 a[196:199], v[144:147], v[52:55], a[196:199]
  ds_read_b64_tr_b16 v[90:91], v7 offset:6144
  v_mfma_f32_16x16x32_bf16 a[200:203], v[144:147], v[56:59], a[200:203]
  buffer_load_dwordx4 v2, s[16:19], s46 offen lds
  v_mfma_f32_16x16x32_bf16 a[204:207], v[144:147], v[60:63], a[204:207]
  v_mfma_f32_16x16x32_bf16 a[208:211], v[144:147], v[64:67], a[208:211]
  v_mfma_f32_16x16x32_bf16 a[212:215], v[144:147], v[68:71], a[212:215]
  v_mfma_f32_16x16x32_bf16 a[216:219], v[144:147], v[72:75], a[216:219]
  ds_read_b128 v[40:43], v6 offset:6144
  v_mfma_f32_16x16x32_bf16 a[220:223], v[144:147], v[76:79], a[220:223]
  v_mfma_f32_16x16x32_bf16 a[224:227], v[148:151], v[48:51], a[224:227]
  s_add_u32 m0, s53, 53248
  v_mfma_f32_16x16x32_bf16 a[228:231], v[148:151], v[52:55], a[228:231]
  v_mfma_f32_16x16x32_bf16 a[232:235], v[148:151], v[56:59], a[232:235]
  ds_read_b64_tr_b16 v[92:93], v8 offset:4096
  v_mfma_f32_16x16x32_bf16 a[236:239], v[148:151], v[60:63], a[236:239]
  v_mfma_f32_16x16x32_bf16 a[240:243], v[148:151], v[64:67], a[240:243]
  v_mfma_f32_16x16x32_bf16 a[244:247], v[148:151], v[68:71], a[244:247]
  v_mfma_f32_16x16x32_bf16 a[248:251], v[148:151], v[72:75], a[248:251]
  v_mfma_f32_16x16x32_bf16 a[252:255], v[148:151], v[76:79], a[252:255]
  ds_read_b128 v[44:47], v6 offset:7168
  v_mfma_f32_16x16x32_bf16 v[192:195], v[152:155], v[48:51], v[192:195]
  buffer_load_dwordx4 v2, s[20:23], s46 offen lds
  v_mfma_f32_16x16x32_bf16 v[196:199], v[152:155], v[52:55], v[196:199]
  v_mfma_f32_16x16x32_bf16 v[200:203], v[152:155], v[56:59], v[200:203]
  v_mfma_f32_16x16x32_bf16 v[204:207], v[152:155], v[60:63], v[204:207]
  ds_read_b64_tr_b16 v[94:95], v8 offset:6144
  v_mfma_f32_16x16x32_bf16 v[208:211], v[152:155], v[64:67], v[208:211]
  v_mfma_f32_16x16x32_bf16 v[212:215], v[152:155], v[68:71], v[212:215]
  v_mfma_f32_16x16x32_bf16 v[216:219], v[152:155], v[72:75], v[216:219]
  s_add_u32 s46, s46, s48
  v_mfma_f32_16x16x32_bf16 v[220:223], v[152:155], v[76:79], v[220:223]
  v_mfma_f32_16x16x32_bf16 v[224:227], v[156:159], v[48:51], v[224:227]
  v_mfma_f32_16x16x32_bf16 v[228:231], v[156:159], v[52:55], v[228:231]
  v_mfma_f32_16x16x32_bf16 v[232:235], v[156:159], v[56:59], v[232:235]
  v_mfma_f32_16x16x32_bf16 v[236:239], v[156:159], v[60:63], v[236:239]
  v_mfma_f32_16x16x32_bf16 v[240:243], v[156:159], v[64:67], v[240:243]
  v_mfma_f32_16x16x32_bf16 v[244:247], v[156:159], v[68:71], v[244:247]
  v_mfma_f32_16x16x32_bf16 v[248:251], v[156:159], v[72:75], v[248:251]
  v_mfma_f32_16x16x32_bf16 v[252:255], v[156:159], v[76:79], v[252:255]
  s_waitcnt vmcnt(14) lgkmcnt(0)
  s_barrier
  v_mfma_f32_16x16x32_bf16 a[0:3], v[80:83], v[16:19], a[0:3]
  ds_read_b128 v[48:51], v6 offset:16384
  s_add_u32 m0, s52, 0
  v_mfma_f32_16x16x32_bf16 a[4:7], v[80:83], v[20:23], a[4:7]
  ds_read_b64_tr_b16 v[120:121], v7 offset:16384
  v_mfma_f32_16x16x32_bf16 a[8:11], v[80:83], v[24:27], a[8:11]
  s_mov_b32 s36, s68
  s_mov_b32 s37, s69
  s_mov_b32 s38, 8192
  s_mov_b32 s39, 0x20000
  v_mfma_f32_16x16x32_bf16 a[12:15], v[80:83], v[28:31], a[12:15]
  buffer_load_dwordx4 v188, s[12:15], s45 offen offset:0 sc1 lds
  v_mfma_f32_16x16x32_bf16 a[16:19], v[80:83], v[32:35], a[16:19]
  ds_read_b128 v[52:55], v6 offset:17408
  ds_read_b64_tr_b16 v[122:123], v7 offset:18432
  v_mfma_f32_16x16x32_bf16 a[20:23], v[80:83], v[36:39], a[20:23]
  buffer_load_dwordx4 v188, s[12:15], s45 offen offset:1024 sc1 lds
  v_mfma_f32_16x16x32_bf16 a[24:27], v[80:83], v[40:43], a[24:27]
  ds_read_b128 v[56:59], v6 offset:18432
  v_mfma_f32_16x16x32_bf16 a[28:31], v[80:83], v[44:47], a[28:31]
  ds_read_b64_tr_b16 v[124:125], v8 offset:16384
  v_mfma_f32_16x16x32_bf16 a[32:35], v[84:87], v[16:19], a[32:35]
  buffer_load_dwordx4 v188, s[12:15], s45 offen offset:2048 sc1 lds
  v_mfma_f32_16x16x32_bf16 a[36:39], v[84:87], v[20:23], a[36:39]
  ds_read_b128 v[60:63], v6 offset:19456
  v_mfma_f32_16x16x32_bf16 a[40:43], v[84:87], v[24:27], a[40:43]
  ds_read_b64_tr_b16 v[126:127], v8 offset:18432
  v_mfma_f32_16x16x32_bf16 a[44:47], v[84:87], v[28:31], a[44:47]
  buffer_load_dwordx4 v188, s[12:15], s45 offen offset:3072 sc1 lds
  v_mfma_f32_16x16x32_bf16 a[48:51], v[84:87], v[32:35], a[48:51]
  ds_read_b128 v[64:67], v6 offset:20480
  v_mfma_f32_16x16x32_bf16 a[52:55], v[84:87], v[36:39], a[52:55]
  ds_read_b64_tr_b16 v[128:129], v7 offset:20480
  s_add_u32 s45, s45, 16384
  v_mfma_f32_16x16x32_bf16 a[56:59], v[84:87], v[40:43], a[56:59]
  v_mfma_f32_16x16x32_bf16 a[60:63], v[84:87], v[44:47], a[60:63]
  ds_read_b128 v[68:71], v6 offset:21504
  v_mfma_f32_16x16x32_bf16 a[64:67], v[88:91], v[16:19], a[64:67]
  ds_read_b64_tr_b16 v[130:131], v7 offset:22528
  s_add_u32 m0, s53, 0
  v_mfma_f32_16x16x32_bf16 a[68:71], v[88:91], v[20:23], a[68:71]
  buffer_load_dword v191, v15, s[36:39], 0 offen
  v_mfma_f32_16x16x32_bf16 a[72:75], v[88:91], v[24:27], a[72:75]
  ds_read_b128 v[72:75], v6 offset:22528
  v_mfma_f32_16x16x32_bf16 a[76:79], v[88:91], v[28:31], a[76:79]
  ds_read_b64_tr_b16 v[132:133], v8 offset:20480
  v_mfma_f32_16x16x32_bf16 a[80:83], v[88:91], v[32:35], a[80:83]
  buffer_load_dwordx4 v2, s[16:19], s46 offen lds
  v_mfma_f32_16x16x32_bf16 a[84:87], v[88:91], v[36:39], a[84:87]
  ds_read_b128 v[76:79], v6 offset:23552
  s_add_u32 m0, s53, 4096
  v_mfma_f32_16x16x32_bf16 a[88:91], v[88:91], v[40:43], a[88:91]
  ds_read_b64_tr_b16 v[134:135], v8 offset:22528
  v_mfma_f32_16x16x32_bf16 a[92:95], v[88:91], v[44:47], a[92:95]
  v_mfma_f32_16x16x32_bf16 a[96:99], v[92:95], v[16:19], a[96:99]
  buffer_load_dwordx4 v2, s[20:23], s46 offen lds
  v_mfma_f32_16x16x32_bf16 a[100:103], v[92:95], v[20:23], a[100:103]
  v_mfma_f32_16x16x32_bf16 a[104:107], v[92:95], v[24:27], a[104:107]
  v_mfma_f32_16x16x32_bf16 a[108:111], v[92:95], v[28:31], a[108:111]
  s_add_u32 s46, s46, s48
  v_mfma_f32_16x16x32_bf16 a[112:115], v[92:95], v[32:35], a[112:115]
  v_mfma_f32_16x16x32_bf16 a[116:119], v[92:95], v[36:39], a[116:119]
  v_mfma_f32_16x16x32_bf16 a[120:123], v[92:95], v[40:43], a[120:123]
  v_mfma_f32_16x16x32_bf16 a[124:127], v[92:95], v[44:47], a[124:127]
  s_waitcnt vmcnt(14) lgkmcnt(0)
  s_barrier
  v_mfma_f32_16x16x32_bf16 a[0:3], v[120:123], v[48:51], a[0:3]
  ds_read_b128 v[16:19], v6 offset:32768
  s_add_u32 m0, s52, 16384
  v_mfma_f32_16x16x32_bf16 a[4:7], v[120:123], v[52:55], a[4:7]
  ds_read_b64_tr_b16 v[80:81], v7 offset:32768
  v_mfma_f32_16x16x32_bf16 a[8:11], v[120:123], v[56:59], a[8:11]
  buffer_load_dwordx4 v188, s[12:15], s45 offen offset:0 sc1 lds
  v_mfma_f32_16x16x32_bf16 a[12:15], v[120:123], v[60:63], a[12:15]
  ds_read_b128 v[20:23], v6 offset:33792
  v_mfma_f32_16x16x32_bf16 a[16:19], v[120:123], v[64:67], a[16:19]
  ds_read_b64_tr_b16 v[82:83], v7 offset:34816
  v_mfma_f32_16x16x32_bf16 a[20:23], v[120:123], v[68:71], a[20:23]
  buffer_load_dwordx4 v188, s[12:15], s45 offen offset:1024 sc1 lds
  v_mfma_f32_16x16x32_bf16 a[24:27], v[120:123], v[72:75], a[24:27]
  ds_read_b128 v[24:27], v6 offset:34816
  v_mfma_f32_16x16x32_bf16 a[28:31], v[120:123], v[76:79], a[28:31]
  ds_read_b64_tr_b16 v[84:85], v8 offset:32768
  v_mfma_f32_16x16x32_bf16 a[32:35], v[124:127], v[48:51], a[32:35]
  buffer_load_dwordx4 v188, s[12:15], s45 offen offset:2048 sc1 lds
  v_mfma_f32_16x16x32_bf16 a[36:39], v[124:127], v[52:55], a[36:39]
  ds_read_b128 v[28:31], v6 offset:35840
  v_mfma_f32_16x16x32_bf16 a[40:43], v[124:127], v[56:59], a[40:43]
  ds_read_b64_tr_b16 v[86:87], v8 offset:34816
  v_mfma_f32_16x16x32_bf16 a[44:47], v[124:127], v[60:63], a[44:47]
  buffer_load_dwordx4 v188, s[12:15], s45 offen offset:3072 sc1 lds
  v_mfma_f32_16x16x32_bf16 a[48:51], v[124:127], v[64:67], a[48:51]
  ds_read_b128 v[32:35], v6 offset:36864
  v_mfma_f32_16x16x32_bf16 a[52:55], v[124:127], v[68:71], a[52:55]
  ds_read_b64_tr_b16 v[88:89], v7 offset:36864
  s_add_u32 s45, s45, 16384
  v_mfma_f32_16x16x32_bf16 a[56:59], v[124:127], v[72:75], a[56:59]
  v_mfma_f32_16x16x32_bf16 a[60:63], v[124:127], v[76:79], a[60:63]
  ds_read_b128 v[36:39], v6 offset:37888
  v_mfma_f32_16x16x32_bf16 a[64:67], v[128:131], v[48:51], a[64:67]
  ds_read_b64_tr_b16 v[90:91], v7 offset:38912
  s_add_u32 m0, s53, 16384
  v_mfma_f32_16x16x32_bf16 a[68:71], v[128:131], v[52:55], a[68:71]
  v_mfma_f32_16x16x32_bf16 a[72:75], v[128:131], v[56:59], a[72:75]
  ds_read_b128 v[40:43], v6 offset:38912
  v_mfma_f32_16x16x32_bf16 a[76:79], v[128:131], v[60:63], a[76:79]
  ds_read_b64_tr_b16 v[92:93], v8 offset:36864
  v_mfma_f32_16x16x32_bf16 a[80:83], v[128:131], v[64:67], a[80:83]
  buffer_load_dwordx4 v2, s[16:19], s46 offen lds
  v_mfma_f32_16x16x32_bf16 a[84:87], v[128:131], v[68:71], a[84:87]
  ds_read_b128 v[44:47], v6 offset:39936
  s_add_u32 m0, s53, 20480
  v_mfma_f32_16x16x32_bf16 a[88:91], v[128:131], v[72:75], a[88:91]
  ds_read_b64_tr_b16 v[94:95], v8 offset:38912
  v_mfma_f32_16x16x32_bf16 a[92:95], v[128:131], v[76:79], a[92:95]
  v_mfma_f32_16x16x32_bf16 a[96:99], v[132:135], v[48:51], a[96:99]
  buffer_load_dwordx4 v2, s[20:23], s46 offen lds
  v_mfma_f32_16x16x32_bf16 a[100:103], v[132:135], v[52:55], a[100:103]
  v_mfma_f32_16x16x32_bf16 a[104:107], v[132:135], v[56:59], a[104:107]
  v_mfma_f32_16x16x32_bf16 a[108:111], v[132:135], v[60:63], a[108:111]
  s_add_u32 s46, s46, s48
  v_mfma_f32_16x16x32_bf16 a[112:115], v[132:135], v[64:67], a[112:115]
  v_mfma_f32_16x16x32_bf16 a[116:119], v[132:135], v[68:71], a[116:119]
  v_mfma_f32_16x16x32_bf16 a[120:123], v[132:135], v[72:75], a[120:123]
  v_mfma_f32_16x16x32_bf16 a[124:127], v[132:135], v[76:79], a[124:127]
  s_waitcnt vmcnt(13) lgkmcnt(0)
  s_barrier
  v_mfma_f32_16x16x32_bf16 a[0:3], v[80:83], v[16:19], a[0:3]
  ds_read_b128 v[48:51], v6 offset:49152
  s_add_u32 m0, s52, 32768
  v_mfma_f32_16x16x32_bf16 a[4:7], v[80:83], v[20:23], a[4:7]
  ds_read_b64_tr_b16 v[120:121], v7 offset:49152
  v_mfma_f32_16x16x32_bf16 a[8:11], v[80:83], v[24:27], a[8:11]
  buffer_load_dwordx4 v188, s[12:15], s45 offen offset:0 sc1 lds
  v_mfma_f32_16x16x32_bf16 a[12:15], v[80:83], v[28:31], a[12:15]
  ds_read_b128 v[52:55], v6 offset:50176
  v_mfma_f32_16x16x32_bf16 a[16:19], v[80:83], v[32:35], a[16:19]
  ds_read_b64_tr_b16 v[122:123], v7 offset:51200
  v_mfma_f32_16x16x32_bf16 a[20:23], v[80:83], v[36:39], a[20:23]
  buffer_load_dwordx4 v188, s[12:15], s45 offen offset:1024 sc1 lds
  v_mfma_f32_16x16x32_bf16 a[24:27], v[80:83], v[40:43], a[24:27]
  ds_read_b128 v[56:59], v6 offset:51200
  v_mfma_f32_16x16x32_bf16 a[28:31], v[80:83], v[44:47], a[28:31]
  ds_read_b64_tr_b16 v[124:125], v8 offset:49152
  v_mfma_f32_16x16x32_bf16 a[32:35], v[84:87], v[16:19], a[32:35]
  buffer_load_dwordx4 v188, s[12:15], s45 offen offset:2048 sc1 lds
  v_mfma_f32_16x16x32_bf16 a[36:39], v[84:87], v[20:23], a[36:39]
  ds_read_b128 v[60:63], v6 offset:52224
  v_mfma_f32_16x16x32_bf16 a[40:43], v[84:87], v[24:27], a[40:43]
  ds_read_b64_tr_b16 v[126:127], v8 offset:51200
  v_mfma_f32_16x16x32_bf16 a[44:47], v[84:87], v[28:31], a[44:47]
  buffer_load_dwordx4 v188, s[12:15], s45 offen offset:3072 sc1 lds
  v_mfma_f32_16x16x32_bf16 a[48:51], v[84:87], v[32:35], a[48:51]
  ds_read_b128 v[64:67], v6 offset:53248
  v_mfma_f32_16x16x32_bf16 a[52:55], v[84:87], v[36:39], a[52:55]
  ds_read_b64_tr_b16 v[128:129], v7 offset:53248
  s_add_u32 s45, s45, 16384
  v_mfma_f32_16x16x32_bf16 a[56:59], v[84:87], v[40:43], a[56:59]
  v_mfma_f32_16x16x32_bf16 a[60:63], v[84:87], v[44:47], a[60:63]
  ds_read_b128 v[68:71], v6 offset:54272
  v_mfma_f32_16x16x32_bf16 a[64:67], v[88:91], v[16:19], a[64:67]
  ds_read_b64_tr_b16 v[130:131], v7 offset:55296
  s_add_u32 m0, s53, 32768
  v_mfma_f32_16x16x32_bf16 a[68:71], v[88:91], v[20:23], a[68:71]
  v_mfma_f32_16x16x32_bf16 a[72:75], v[88:91], v[24:27], a[72:75]
  ds_read_b128 v[72:75], v6 offset:55296
  v_mfma_f32_16x16x32_bf16 a[76:79], v[88:91], v[28:31], a[76:79]
  ds_read_b64_tr_b16 v[132:133], v8 offset:53248
  v_mfma_f32_16x16x32_bf16 a[80:83], v[88:91], v[32:35], a[80:83]
  buffer_load_dwordx4 v2, s[16:19], s46 offen lds
  v_mfma_f32_16x16x32_bf16 a[84:87], v[88:91], v[36:39], a[84:87]
  ds_read_b128 v[76:79], v6 offset:56320
  s_add_u32 m0, s53, 36864
  v_mfma_f32_16x16x32_bf16 a[88:91], v[88:91], v[40:43], a[88:91]
  ds_read_b64_tr_b16 v[134:135], v8 offset:55296
  v_mfma_f32_16x16x32_bf16 a[92:95], v[88:91], v[44:47], a[92:95]
  v_mfma_f32_16x16x32_bf16 a[96:99], v[92:95], v[16:19], a[96:99]
  buffer_load_dwordx4 v2, s[20:23], s46 offen lds
  v_mfma_f32_16x16x32_bf16 a[100:103], v[92:95], v[20:23], a[100:103]
  v_mfma_f32_16x16x32_bf16 a[104:107], v[92:95], v[24:27], a[104:107]
  v_mfma_f32_16x16x32_bf16 a[108:111], v[92:95], v[28:31], a[108:111]
  s_add_u32 s46, s46, s48
  v_mfma_f32_16x16x32_bf16 a[112:115], v[92:95], v[32:35], a[112:115]
  v_mfma_f32_16x16x32_bf16 a[116:119], v[92:95], v[36:39], a[116:119]
  v_mfma_f32_16x16x32_bf16 a[120:123], v[92:95], v[40:43], a[120:123]
  v_mfma_f32_16x16x32_bf16 a[124:127], v[92:95], v[44:47], a[124:127]
  s_waitcnt vmcnt(12) lgkmcnt(0)
  s_barrier
  v_mfma_f32_16x16x32_bf16 a[0:3], v[120:123], v[48:51], a[0:3]
  ds_read_b128 v[16:19], v6 offset:0
  s_add_u32 m0, s52, 49152
  v_mfma_f32_16x16x32_bf16 a[4:7], v[120:123], v[52:55], a[4:7]
  ds_read_b64_tr_b16 v[80:81], v7 offset:0
  v_mfma_f32_16x16x32_bf16 a[8:11], v[120:123], v[56:59], a[8:11]
  buffer_load_dwordx4 v188, s[12:15], s45 offen offset:0 sc1 lds
  v_mfma_f32_16x16x32_bf16 a[12:15], v[120:123], v[60:63], a[12:15]
  ds_read_b128 v[20:23], v6 offset:1024
  v_mfma_f32_16x16x32_bf16 a[16:19], v[120:123], v[64:67], a[16:19]
  ds_read_b64_tr_b16 v[82:83], v7 offset:2048
  v_mfma_f32_16x16x32_bf16 a[20:23], v[120:123], v[68:71], a[20:23]
  buffer_load_dwordx4 v188, s[12:15], s45 offen offset:1024 sc1 lds
  v_mfma_f32_16x16x32_bf16 a[24:27], v[120:123], v[72:75], a[24:27]
  ds_read_b128 v[24:27], v6 offset:2048
  v_mfma_f32_16x16x32_bf16 a[28:31], v[120:123], v[76:79], a[28:31]
  ds_read_b64_tr_b16 v[84:85], v8 offset:0
  v_mfma_f32_16x16x32_bf16 a[32:35], v[124:127], v[48:51], a[32:35]
  buffer_load_dwordx4 v188, s[12:15], s45 offen offset:2048 sc1 lds
  v_mfma_f32_16x16x32_bf16 a[36:39], v[124:127], v[52:55], a[36:39]
  ds_read_b128 v[28:31], v6 offset:3072
  v_mfma_f32_16x16x32_bf16 a[40:43], v[124:127], v[56:59], a[40:43]
  ds_read_b64_tr_b16 v[86:87], v8 offset:2048
  v_mfma_f32_16x16x32_bf16 a[44:47], v[124:127], v[60:63], a[44:47]
  buffer_load_dwordx4 v188, s[12:15], s45 offen offset:3072 sc1 lds
  v_mfma_f32_16x16x32_bf16 a[48:51], v[124:127], v[64:67], a[48:51]
  ds_read_b128 v[32:35], v6 offset:4096
  v_mfma_f32_16x16x32_bf16 a[52:55], v[124:127], v[68:71], a[52:55]
  ds_read_b64_tr_b16 v[88:89], v7 offset:4096
  s_add_u32 s45, s45, 16384
  v_mfma_f32_16x16x32_bf16 a[56:59], v[124:127], v[72:75], a[56:59]
  v_mfma_f32_16x16x32_bf16 a[60:63], v[124:127], v[76:79], a[60:63]
  ds_read_b128 v[36:39], v6 offset:5120
  v_mfma_f32_16x16x32_bf16 a[64:67], v[128:131], v[48:51], a[64:67]
  ds_read_b64_tr_b16 v[90:91], v7 offset:6144
  s_add_u32 m0, s53, 49152
  v_mfma_f32_16x16x32_bf16 a[68:71], v[128:131], v[52:55], a[68:71]
  v_mfma_f32_16x16x32_bf16 a[72:75], v[128:131], v[56:59], a[72:75]
  ds_read_b128 v[40:43], v6 offset:6144
  v_mfma_f32_16x16x32_bf16 a[76:79], v[128:131], v[60:63], a[76:79]
  ds_read_b64_tr_b16 v[92:93], v8 offset:4096
  v_mfma_f32_16x16x32_bf16 a[80:83], v[128:131], v[64:67], a[80:83]
  buffer_load_dwordx4 v2, s[16:19], s46 offen lds
  v_mfma_f32_16x16x32_bf16 a[84:87], v[128:131], v[68:71], a[84:87]
  ds_read_b128 v[44:47], v6 offset:7168
  s_add_u32 m0, s53, 53248
  v_mfma_f32_16x16x32_bf16 a[88:91], v[128:131], v[72:75], a[88:91]
  ds_read_b64_tr_b16 v[94:95], v8 offset:6144
  v_mfma_f32_16x16x32_bf16 a[92:95], v[128:131], v[76:79], a[92:95]
  v_mfma_f32_16x16x32_bf16 a[96:99], v[132:135], v[48:51], a[96:99]
  buffer_load_dwordx4 v2, s[20:23], s46 offen lds
  v_mfma_f32_16x16x32_bf16 a[100:103], v[132:135], v[52:55], a[100:103]
  v_mfma_f32_16x16x32_bf16 a[104:107], v[132:135], v[56:59], a[104:107]
  v_mfma_f32_16x16x32_bf16 a[108:111], v[132:135], v[60:63], a[108:111]
  s_add_u32 s46, s46, s48
  v_mfma_f32_16x16x32_bf16 a[112:115], v[132:135], v[64:67], a[112:115]
  v_mfma_f32_16x16x32_bf16 a[116:119], v[132:135], v[68:71], a[116:119]
  v_mfma_f32_16x16x32_bf16 a[120:123], v[132:135], v[72:75], a[120:123]
  v_mfma_f32_16x16x32_bf16 a[124:127], v[132:135], v[76:79], a[124:127]
  s_waitcnt vmcnt(12) lgkmcnt(0)
  s_barrier
  v_mfma_f32_16x16x32_bf16 a[0:3], v[80:83], v[16:19], a[0:3]
  ds_read_b128 v[48:51], v6 offset:16384
  s_add_u32 m0, s52, 0
  v_mfma_f32_16x16x32_bf16 a[4:7], v[80:83], v[20:23], a[4:7]
  ds_read_b64_tr_b16 v[120:121], v7 offset:16384
  v_mfma_f32_16x16x32_bf16 a[8:11], v[80:83], v[24:27], a[8:11]
  buffer_load_dwordx4 v188, s[12:15], s45 offen offset:0 sc1 lds
  v_mfma_f32_16x16x32_bf16 a[12:15], v[80:83], v[28:31], a[12:15]
  ds_read_b128 v[52:55], v6 offset:17408
  v_mfma_f32_16x16x32_bf16 a[16:19], v[80:83], v[32:35], a[16:19]
  ds_read_b64_tr_b16 v[122:123], v7 offset:18432
  v_mfma_f32_16x16x32_bf16 a[20:23], v[80:83], v[36:39], a[20:23]
  buffer_load_dwordx4 v188, s[12:15], s45 offen offset:1024 sc1 lds
  v_mfma_f32_16x16x32_bf16 a[24:27], v[80:83], v[40:43], a[24:27]
  ds_read_b128 v[56:59], v6 offset:18432
  v_mfma_f32_16x16x32_bf16 a[28:31], v[80:83], v[44:47], a[28:31]
  ds_read_b64_tr_b16 v[124:125], v8 offset:16384
  v_mfma_f32_16x16x32_bf16 a[32:35], v[84:87], v[16:19], a[32:35]
  buffer_load_dwordx4 v188, s[12:15], s45 offen offset:2048 sc1 lds
  v_mfma_f32_16x16x32_bf16 a[36:39], v[84:87], v[20:23], a[36:39]
  ds_read_b128 v[60:63], v6 offset:19456
  v_mfma_f32_16x16x32_bf16 a[40:43], v[84:87], v[24:27], a[40:43]
  ds_read_b64_tr_b16 v[126:127], v8 offset:18432
  v_mfma_f32_16x16x32_bf16 a[44:47], v[84:87], v[28:31], a[44:47]
  buffer_load_dwordx4 v188, s[12:15], s45 offen offset:3072 sc1 lds
  v_mfma_f32_16x16x32_bf16 a[48:51], v[84:87], v[32:35], a[48:51]
  ds_read_b128 v[64:67], v6 offset:20480
  v_mfma_f32_16x16x32_bf16 a[52:55], v[84:87], v[36:39], a[52:55]
  ds_read_b64_tr_b16 v[128:129], v7 offset:20480
  s_add_u32 s45, s45, 16384
  v_mfma_f32_16x16x32_bf16 a[56:59], v[84:87], v[40:43], a[56:59]
  v_mfma_f32_16x16x32_bf16 a[60:63], v[84:87], v[44:47], a[60:63]
  ds_read_b128 v[68:71], v6 offset:21504
  v_mfma_f32_16x16x32_bf16 a[64:67], v[88:91], v[16:19], a[64:67]
  ds_read_b64_tr_b16 v[130:131], v7 offset:22528
  s_add_u32 m0, s53, 0
  v_mfma_f32_16x16x32_bf16 a[68:71], v[88:91], v[20:23], a[68:71]
  v_mfma_f32_16x16x32_bf16 a[72:75], v[88:91], v[24:27], a[72:75]
  ds_read_b128 v[72:75], v6 offset:22528
  v_mfma_f32_16x16x32_bf16 a[76:79], v[88:91], v[28:31], a[76:79]
  ds_read_b64_tr_b16 v[132:133], v8 offset:20480
  v_mfma_f32_16x16x32_bf16 a[80:83], v[88:91], v[32:35], a[80:83]
  buffer_load_dwordx4 v2, s[16:19], s46 offen lds
  v_mfma_f32_16x16x32_bf16 a[84:87], v[88:91], v[36:39], a[84:87]
  ds_read_b128 v[76:79], v6 offset:23552
  s_add_u32 m0, s53, 4096
  v_mfma_f32_16x16x32_bf16 a[88:91], v[88:91], v[40:43], a[88:91]
  ds_read_b64_tr_b16 v[134:135], v8 offset:22528
  v_mfma_f32_16x16x32_bf16 a[92:95], v[88:91], v[44:47], a[92:95]
  v_mfma_f32_16x16x32_bf16 a[96:99], v[92:95], v[16:19], a[96:99]
  buffer_load_dwordx4 v2, s[20:23], s46 offen lds
  v_mfma_f32_16x16x32_bf16 a[100:103], v[92:95], v[20:23], a[100:103]
  v_mfma_f32_16x16x32_bf16 a[104:107], v[92:95], v[24:27], a[104:107]
  v_mfma_f32_16x16x32_bf16 a[108:111], v[92:95], v[28:31], a[108:111]
  s_add_u32 s46, s46, s48
  v_mfma_f32_16x16x32_bf16 a[112:115], v[92:95], v[32:35], a[112:115]
  v_mfma_f32_16x16x32_bf16 a[116:119], v[92:95], v[36:39], a[116:119]
  v_mfma_f32_16x16x32_bf16 a[120:123], v[92:95], v[40:43], a[120:123]
  v_mfma_f32_16x16x32_bf16 a[124:127], v[92:95], v[44:47], a[124:127]
  s_waitcnt vmcnt(12) lgkmcnt(0)
  s_barrier
  v_mfma_f32_16x16x32_bf16 a[0:3], v[120:123], v[48:51], a[0:3]
  ds_read_b128 v[16:19], v6 offset:32768
  s_add_u32 m0, s52, 16384
  v_mfma_f32_16x16x32_bf16 a[4:7], v[120:123], v[52:55], a[4:7]
  ds_read_b64_tr_b16 v[80:81], v7 offset:32768
  v_mfma_f32_16x16x32_bf16 a[8:11], v[120:123], v[56:59], a[8:11]
  buffer_load_dwordx4 v188, s[12:15], s45 offen offset:0 sc1 lds
  v_mfma_f32_16x16x32_bf16 a[12:15], v[120:123], v[60:63], a[12:15]
  ds_read_b128 v[20:23], v6 offset:33792
  v_mfma_f32_16x16x32_bf16 a[16:19], v[120:123], v[64:67], a[16:19]
  ds_read_b64_tr_b16 v[82:83], v7 offset:34816
  v_mfma_f32_16x16x32_bf16 a[20:23], v[120:123], v[68:71], a[20:23]
  buffer_load_dwordx4 v188, s[12:15], s45 offen offset:1024 sc1 lds
  v_mfma_f32_16x16x32_bf16 a[24:27], v[120:123], v[72:75], a[24:27]
  ds_read_b128 v[24:27], v6 offset:34816
  v_mfma_f32_16x16x32_bf16 a[28:31], v[120:123], v[76:79], a[28:31]
  ds_read_b64_tr_b16 v[84:85], v8 offset:32768
  v_mfma_f32_16x16x32_bf16 a[32:35], v[124:127], v[48:51], a[32:35]
  buffer_load_dwordx4 v188, s[12:15], s45 offen offset:2048 sc1 lds
  v_mfma_f32_16x16x32_bf16 a[36:39], v[124:127], v[52:55], a[36:39]
  ds_read_b128 v[28:31], v6 offset:35840
  v_mfma_f32_16x16x32_bf16 a[40:43], v[124:127], v[56:59], a[40:43]
  ds_read_b64_tr_b16 v[86:87], v8 offset:34816
  v_mfma_f32_16x16x32_bf16 a[44:47], v[124:127], v[60:63], a[44:47]
  buffer_load_dwordx4 v188, s[12:15], s45 offen offset:3072 sc1 lds
  v_mfma_f32_16x16x32_bf16 a[48:51], v[124:127], v[64:67], a[48:51]
  ds_read_b128 v[32:35], v6 offset:36864
  v_mfma_f32_16x16x32_bf16 a[52:55], v[124:127], v[68:71], a[52:55]
  ds_read_b64_tr_b16 v[88:89], v7 offset:36864
  s_add_u32 s45, s45, 16384
  v_mfma_f32_16x16x32_bf16 a[56:59], v[124:127], v[72:75], a[56:59]
  v_mfma_f32_16x16x32_bf16 a[60:63], v[124:127], v[76:79], a[60:63]
  ds_read_b128 v[36:39], v6 offset:37888
  v_mfma_f32_16x16x32_bf16 a[64:67], v[128:131], v[48:51], a[64:67]
  ds_read_b64_tr_b16 v[90:91], v7 offset:38912
  s_add_u32 m0, s53, 16384
  v_mfma_f32_16x16x32_bf16 a[68:71], v[128:131], v[52:55], a[68:71]
  v_mfma_f32_16x16x32_bf16 a[72:75], v[128:131], v[56:59], a[72:75]
  ds_read_b128 v[40:43], v6 offset:38912
  v_mfma_f32_16x16x32_bf16 a[76:79], v[128:131], v[60:63], a[76:79]
  ds_read_b64_tr_b16 v[92:93], v8 offset:36864
  v_mfma_f32_16x16x32_bf16 a[80:83], v[128:131], v[64:67], a[80:83]
  buffer_load_dwordx4 v2, s[16:19], s46 offen lds
  v_mfma_f32_16x16x32_bf16 a[84:87], v[128:131], v[68:71], a[84:87]
  ds_read_b128 v[44:47], v6 offset:39936
  s_add_u32 m0, s53, 20480
  v_mfma_f32_16x16x32_bf16 a[88:91], v[128:131], v[72:75], a[88:91]
  ds_read_b64_tr_b16 v[94:95], v8 offset:38912
  v_mfma_f32_16x16x32_bf16 a[92:95], v[128:131], v[76:79], a[92:95]
  v_mfma_f32_16x16x32_bf16 a[96:99], v[132:135], v[48:51], a[96:99]
  buffer_load_dwordx4 v2, s[20:23], s46 offen lds
  v_mfma_f32_16x16x32_bf16 a[100:103], v[132:135], v[52:55], a[100:103]
  v_mfma_f32_16x16x32_bf16 a[104:107], v[132:135], v[56:59], a[104:107]
  v_mfma_f32_16x16x32_bf16 a[108:111], v[132:135], v[60:63], a[108:111]
  s_add_u32 s46, s46, s48
  v_mfma_f32_16x16x32_bf16 a[112:115], v[132:135], v[64:67], a[112:115]
  v_mfma_f32_16x16x32_bf16 a[116:119], v[132:135], v[68:71], a[116:119]
  v_mfma_f32_16x16x32_bf16 a[120:123], v[132:135], v[72:75], a[120:123]
  v_mfma_f32_16x16x32_bf16 a[124:127], v[132:135], v[76:79], a[124:127]
  s_waitcnt vmcnt(12) lgkmcnt(0)
  s_barrier
  v_mfma_f32_16x16x32_bf16 a[0:3], v[80:83], v[16:19], a[0:3]
  ds_read_b128 v[48:51], v6 offset:49152
  s_add_u32 m0, s52, 32768
  v_mfma_f32_16x16x32_bf16 a[4:7], v[80:83], v[20:23], a[4:7]
  ds_read_b64_tr_b16 v[120:121], v7 offset:49152
  v_mfma_f32_16x16x32_bf16 a[8:11], v[80:83], v[24:27], a[8:11]
  buffer_load_dwordx4 v188, s[12:15], s45 offen offset:0 sc1 lds
  v_mfma_f32_16x16x32_bf16 a[12:15], v[80:83], v[28:31], a[12:15]
  ds_read_b128 v[52:55], v6 offset:50176
  v_mfma_f32_16x16x32_bf16 a[16:19], v[80:83], v[32:35], a[16:19]
  ds_read_b64_tr_b16 v[122:123], v7 offset:51200
  v_mfma_f32_16x16x32_bf16 a[20:23], v[80:83], v[36:39], a[20:23]
  buffer_load_dwordx4 v188, s[12:15], s45 offen offset:1024 sc1 lds
  v_mfma_f32_16x16x32_bf16 a[24:27], v[80:83], v[40:43], a[24:27]
  ds_read_b128 v[56:59], v6 offset:51200
  v_mfma_f32_16x16x32_bf16 a[28:31], v[80:83], v[44:47], a[28:31]
  ds_read_b64_tr_b16 v[124:125], v8 offset:49152
  v_mfma_f32_16x16x32_bf16 a[32:35], v[84:87], v[16:19], a[32:35]
  buffer_load_dwordx4 v188, s[12:15], s45 offen offset:2048 sc1 lds
  v_mfma_f32_16x16x32_bf16 a[36:39], v[84:87], v[20:23], a[36:39]
  ds_read_b128 v[60:63], v6 offset:52224
  v_mfma_f32_16x16x32_bf16 a[40:43], v[84:87], v[24:27], a[40:43]
  ds_read_b64_tr_b16 v[126:127], v8 offset:51200
  v_mfma_f32_16x16x32_bf16 a[44:47], v[84:87], v[28:31], a[44:47]
  buffer_load_dwordx4 v188, s[12:15], s45 offen offset:3072 sc1 lds
  v_mfma_f32_16x16x32_bf16 a[48:51], v[84:87], v[32:35], a[48:51]
  ds_read_b128 v[64:67], v6 offset:53248
  v_mfma_f32_16x16x32_bf16 a[52:55], v[84:87], v[36:39], a[52:55]
  ds_read_b64_tr_b16 v[128:129], v7 offset:53248
  s_add_u32 s45, s45, 16384
  v_mfma_f32_16x16x32_bf16 a[56:59], v[84:87], v[40:43], a[56:59]
  v_mfma_f32_16x16x32_bf16 a[60:63], v[84:87], v[44:47], a[60:63]
  ds_read_b128 v[68:71], v6 offset:54272
  v_mfma_f32_16x16x32_bf16 a[64:67], v[88:91], v[16:19], a[64:67]
  ds_read_b64_tr_b16 v[130:131], v7 offset:55296
  s_add_u32 m0, s53, 32768
  v_mfma_f32_16x16x32_bf16 a[68:71], v[88:91], v[20:23], a[68:71]
  v_mfma_f32_16x16x32_bf16 a[72:75], v[88:91], v[24:27], a[72:75]
  ds_read_b128 v[72:75], v6 offset:55296
  v_mfma_f32_16x16x32_bf16 a[76:79], v[88:91], v[28:31], a[76:79]
  ds_read_b64_tr_b16 v[132:133], v8 offset:53248
  v_mfma_f32_16x16x32_bf16 a[80:83], v[88:91], v[32:35], a[80:83]
  buffer_load_dwordx4 v2, s[16:19], s46 offen lds
  v_mfma_f32_16x16x32_bf16 a[84:87], v[88:91], v[36:39], a[84:87]
  ds_read_b128 v[76:79], v6 offset:56320
  s_add_u32 m0, s53, 36864
  v_mfma_f32_16x16x32_bf16 a[88:91], v[88:91], v[40:43], a[88:91]
  ds_read_b64_tr_b16 v[134:135], v8 offset:55296
  v_mfma_f32_16x16x32_bf16 a[92:95], v[88:91], v[44:47], a[92:95]
  v_mfma_f32_16x16x32_bf16 a[96:99], v[92:95], v[16:19], a[96:99]
  buffer_load_dwordx4 v2, s[20:23], s46 offen lds
  v_mfma_f32_16x16x32_bf16 a[100:103], v[92:95], v[20:23], a[100:103]
  v_mfma_f32_16x16x32_bf16 a[104:107], v[92:95], v[24:27], a[104:107]
  v_mfma_f32_16x16x32_bf16 a[108:111], v[92:95], v[28:31], a[108:111]
  s_add_u32 s46, s46, s48
  v_mfma_f32_16x16x32_bf16 a[112:115], v[92:95], v[32:35], a[112:115]
  v_mfma_f32_16x16x32_bf16 a[116:119], v[92:95], v[36:39], a[116:119]
  v_mfma_f32_16x16x32_bf16 a[120:123], v[92:95], v[40:43], a[120:123]
  v_mfma_f32_16x16x32_bf16 a[124:127], v[92:95], v[44:47], a[124:127]
  s_waitcnt vmcnt(12) lgkmcnt(0)
  s_barrier
  v_mfma_f32_16x16x32_bf16 a[0:3], v[120:123], v[48:51], a[0:3]
  ds_read_b128 v[16:19], v6 offset:0
  s_add_u32 m0, s52, 49152
  v_mfma_f32_16x16x32_bf16 a[4:7], v[120:123], v[52:55], a[4:7]
  ds_read_b64_tr_b16 v[80:81], v7 offset:0
  v_mfma_f32_16x16x32_bf16 a[8:11], v[120:123], v[56:59], a[8:11]
  buffer_load_dwordx4 v188, s[12:15], s45 offen offset:0 sc1 lds
  v_mfma_f32_16x16x32_bf16 a[12:15], v[120:123], v[60:63], a[12:15]
  ds_read_b128 v[20:23], v6 offset:1024
  v_mfma_f32_16x16x32_bf16 a[16:19], v[120:123], v[64:67], a[16:19]
  ds_read_b64_tr_b16 v[82:83], v7 offset:2048
  v_mfma_f32_16x16x32_bf16 a[20:23], v[120:123], v[68:71], a[20:23]
  buffer_load_dwordx4 v188, s[12:15], s45 offen offset:1024 sc1 lds
  v_mfma_f32_16x16x32_bf16 a[24:27], v[120:123], v[72:75], a[24:27]
  ds_read_b128 v[24:27], v6 offset:2048
  v_mfma_f32_16x16x32_bf16 a[28:31], v[120:123], v[76:79], a[28:31]
  ds_read_b64_tr_b16 v[84:85], v8 offset:0
  v_mfma_f32_16x16x32_bf16 a[32:35], v[124:127], v[48:51], a[32:35]
  buffer_load_dwordx4 v188, s[12:15], s45 offen offset:2048 sc1 lds
  v_mfma_f32_16x16x32_bf16 a[36:39], v[124:127], v[52:55], a[36:39]
  ds_read_b128 v[28:31], v6 offset:3072
  v_mfma_f32_16x16x32_bf16 a[40:43], v[124:127], v[56:59], a[40:43]
  ds_read_b64_tr_b16 v[86:87], v8 offset:2048
  v_mfma_f32_16x16x32_bf16 a[44:47], v[124:127], v[60:63], a[44:47]
  buffer_load_dwordx4 v188, s[12:15], s45 offen offset:3072 sc1 lds
  v_mfma_f32_16x16x32_bf16 a[48:51], v[124:127], v[64:67], a[48:51]
  ds_read_b128 v[32:35], v6 offset:4096
  v_mfma_f32_16x16x32_bf16 a[52:55], v[124:127], v[68:71], a[52:55]
  ds_read_b64_tr_b16 v[88:89], v7 offset:4096
  s_add_u32 s45, s45, 16384
  v_mfma_f32_16x16x32_bf16 a[56:59], v[124:127], v[72:75], a[56:59]
  v_mfma_f32_16x16x32_bf16 a[60:63], v[124:127], v[76:79], a[60:63]
  ds_read_b128 v[36:39], v6 offset:5120
  v_mfma_f32_16x16x32_bf16 a[64:67], v[128:131], v[48:51], a[64:67]
  ds_read_b64_tr_b16 v[90:91], v7 offset:6144
  s_add_u32 m0, s53, 49152
  v_mfma_f32_16x16x32_bf16 a[68:71], v[128:131], v[52:55], a[68:71]
  v_mfma_f32_16x16x32_bf16 a[72:75], v[128:131], v[56:59], a[72:75]
  ds_read_b128 v[40:43], v6 offset:6144
  v_mfma_f32_16x16x32_bf16 a[76:79], v[128:131], v[60:63], a[76:79]
  ds_read_b64_tr_b16 v[92:93], v8 offset:4096
  v_mfma_f32_16x16x32_bf16 a[80:83], v[128:131], v[64:67], a[80:83]
  buffer_load_dwordx4 v2, s[16:19], s46 offen lds
  v_mfma_f32_16x16x32_bf16 a[84:87], v[128:131], v[68:71], a[84:87]
  ds_read_b128 v[44:47], v6 offset:7168
  s_add_u32 m0, s53, 53248
  v_mfma_f32_16x16x32_bf16 a[88:91], v[128:131], v[72:75], a[88:91]
  ds_read_b64_tr_b16 v[94:95], v8 offset:6144
  v_mfma_f32_16x16x32_bf16 a[92:95], v[128:131], v[76:79], a[92:95]
  v_mfma_f32_16x16x32_bf16 a[96:99], v[132:135], v[48:51], a[96:99]
  buffer_load_dwordx4 v2, s[20:23], s46 offen lds
  v_mfma_f32_16x16x32_bf16 a[100:103], v[132:135], v[52:55], a[100:103]
  v_mfma_f32_16x16x32_bf16 a[104:107], v[132:135], v[56:59], a[104:107]
  v_mfma_f32_16x16x32_bf16 a[108:111], v[132:135], v[60:63], a[108:111]
  s_add_u32 s46, s46, s48
  v_mfma_f32_16x16x32_bf16 a[112:115], v[132:135], v[64:67], a[112:115]
  v_mfma_f32_16x16x32_bf16 a[116:119], v[132:135], v[68:71], a[116:119]
  v_mfma_f32_16x16x32_bf16 a[120:123], v[132:135], v[72:75], a[120:123]
  v_mfma_f32_16x16x32_bf16 a[124:127], v[132:135], v[76:79], a[124:127]
  s_waitcnt vmcnt(12) lgkmcnt(0)
  s_barrier
  v_mfma_f32_16x16x32_bf16 a[0:3], v[80:83], v[16:19], a[0:3]
  ds_read_b128 v[48:51], v6 offset:16384
  s_mov_b32 s45, 327680
  v_mfma_f32_16x16x32_bf16 a[4:7], v[80:83], v[20:23], a[4:7]
  ds_read_b64_tr_b16 v[120:121], v7 offset:16384
  v_mfma_f32_16x16x32_bf16 a[8:11], v[80:83], v[24:27], a[8:11]
  s_add_u32 m0, s52, 0
  v_mfma_f32_16x16x32_bf16 a[12:15], v[80:83], v[28:31], a[12:15]
  ds_read_b128 v[52:55], v6 offset:17408
  v_mfma_f32_16x16x32_bf16 a[16:19], v[80:83], v[32:35], a[16:19]
  ds_read_b64_tr_b16 v[122:123], v7 offset:18432
  v_mfma_f32_16x16x32_bf16 a[20:23], v[80:83], v[36:39], a[20:23]
  buffer_load_dwordx4 v188, s[12:15], s45 offen offset:0 sc1 lds
  v_mfma_f32_16x16x32_bf16 a[24:27], v[80:83], v[40:43], a[24:27]
  ds_read_b128 v[56:59], v6 offset:18432
  v_mfma_f32_16x16x32_bf16 a[28:31], v[80:83], v[44:47], a[28:31]
  buffer_load_dwordx4 v188, s[12:15], s45 offen offset:1024 sc1 lds
  v_mfma_f32_16x16x32_bf16 a[32:35], v[84:87], v[16:19], a[32:35]
  ds_read_b64_tr_b16 v[124:125], v8 offset:16384
  v_mfma_f32_16x16x32_bf16 a[36:39], v[84:87], v[20:23], a[36:39]
  buffer_load_dwordx4 v188, s[12:15], s45 offen offset:2048 sc1 lds
  v_mfma_f32_16x16x32_bf16 a[40:43], v[84:87], v[24:27], a[40:43]
  ds_read_b128 v[60:63], v6 offset:19456
  ds_read_b64_tr_b16 v[126:127], v8 offset:18432
  v_mfma_f32_16x16x32_bf16 a[44:47], v[84:87], v[28:31], a[44:47]
  buffer_load_dwordx4 v188, s[12:15], s45 offen offset:3072 sc1 lds
  v_mfma_f32_16x16x32_bf16 a[48:51], v[84:87], v[32:35], a[48:51]
  ds_read_b128 v[64:67], v6 offset:20480
  s_add_u32 s45, s45, 16384
  v_mfma_f32_16x16x32_bf16 a[52:55], v[84:87], v[36:39], a[52:55]
  ds_read_b64_tr_b16 v[128:129], v7 offset:20480
  v_mfma_f32_16x16x32_bf16 a[56:59], v[84:87], v[40:43], a[56:59]
  s_add_u32 m0, s53, 8192
  v_mfma_f32_16x16x32_bf16 a[60:63], v[84:87], v[44:47], a[60:63]
  ds_read_b128 v[68:71], v6 offset:21504
  v_mfma_f32_16x16x32_bf16 a[64:67], v[88:91], v[16:19], a[64:67]
  ds_read_b64_tr_b16 v[130:131], v7 offset:22528
  v_mfma_f32_16x16x32_bf16 a[68:71], v[88:91], v[20:23], a[68:71]
  buffer_load_dwordx4 v3, s[24:27], s47 offen lds
  v_mfma_f32_16x16x32_bf16 a[72:75], v[88:91], v[24:27], a[72:75]
  ds_read_b128 v[72:75], v6 offset:22528
  s_add_u32 m0, s53, 12288
  v_mfma_f32_16x16x32_bf16 a[76:79], v[88:91], v[28:31], a[76:79]
  ds_read_b64_tr_b16 v[132:133], v8 offset:20480
  v_mfma_f32_16x16x32_bf16 a[80:83], v[88:91], v[32:35], a[80:83]
  buffer_load_dwordx4 v3, s[28:31], s47 offen lds
  v_mfma_f32_16x16x32_bf16 a[84:87], v[88:91], v[36:39], a[84:87]
  ds_read_b128 v[76:79], v6 offset:23552
  v_mfma_f32_16x16x32_bf16 a[88:91], v[88:91], v[40:43], a[88:91]
  ds_read_b64_tr_b16 v[134:135], v8 offset:22528
  s_add_u32 m0, s54, 0
  v_mfma_f32_16x16x32_bf16 a[92:95], v[88:91], v[44:47], a[92:95]
  v_mfma_f32_16x16x32_bf16 a[96:99], v[92:95], v[16:19], a[96:99]
  global_load_lds_dwordx4 v[4:5], off
  v_mfma_f32_16x16x32_bf16 a[100:103], v[92:95], v[20:23], a[100:103]
  v_mfma_f32_16x16x32_bf16 a[104:107], v[92:95], v[24:27], a[104:107]
  s_add_u32 s47, s47, s49
  v_mfma_f32_16x16x32_bf16 a[108:111], v[92:95], v[28:31], a[108:111]
  v_mfma_f32_16x16x32_bf16 a[112:115], v[92:95], v[32:35], a[112:115]
  v_lshl_add_u64 v[4:5], s[50:51], 0, v[4:5]
  v_mfma_f32_16x16x32_bf16 a[116:119], v[92:95], v[36:39], a[116:119]
  v_mfma_f32_16x16x32_bf16 a[120:123], v[92:95], v[40:43], a[120:123]
  v_mfma_f32_16x16x32_bf16 a[124:127], v[92:95], v[44:47], a[124:127]
  s_waitcnt vmcnt(13) lgkmcnt(0)
  s_barrier
  v_mfma_f32_16x16x32_bf16 a[0:3], v[120:123], v[48:51], a[0:3]
  ds_read_b128 v[16:19], v6 offset:32768
  s_add_u32 m0, s52, 16384
  v_mfma_f32_16x16x32_bf16 a[4:7], v[120:123], v[52:55], a[4:7]
  ds_read_b64_tr_b16 v[80:81], v7 offset:32768
  v_mfma_f32_16x16x32_bf16 a[8:11], v[120:123], v[56:59], a[8:11]
  buffer_load_dwordx4 v188, s[12:15], s45 offen offset:0 sc1 lds
  v_mfma_f32_16x16x32_bf16 a[12:15], v[120:123], v[60:63], a[12:15]
  ds_read_b128 v[20:23], v6 offset:33792
  v_mfma_f32_16x16x32_bf16 a[16:19], v[120:123], v[64:67], a[16:19]
  ds_read_b64_tr_b16 v[82:83], v7 offset:34816
  v_mfma_f32_16x16x32_bf16 a[20:23], v[120:123], v[68:71], a[20:23]
  buffer_load_dwordx4 v188, s[12:15], s45 offen offset:1024 sc1 lds
  v_mfma_f32_16x16x32_bf16 a[24:27], v[120:123], v[72:75], a[24:27]
  ds_read_b128 v[24:27], v6 offset:34816
  v_mfma_f32_16x16x32_bf16 a[28:31], v[120:123], v[76:79], a[28:31]
  buffer_load_dwordx4 v188, s[12:15], s45 offen offset:2048 sc1 lds
  v_mfma_f32_16x16x32_bf16 a[32:35], v[124:127], v[48:51], a[32:35]
  ds_read_b64_tr_b16 v[84:85], v8 offset:32768
  v_mfma_f32_16x16x32_bf16 a[36:39], v[124:127], v[52:55], a[36:39]
  buffer_load_dwordx4 v188, s[12:15], s45 offen offset:3072 sc1 lds
  v_mfma_f32_16x16x32_bf16 a[40:43], v[124:127], v[56:59], a[40:43]
  ds_read_b128 v[28:31], v6 offset:35840
  ds_read_b64_tr_b16 v[86:87], v8 offset:34816
  v_mfma_f32_16x16x32_bf16 a[44:47], v[124:127], v[60:63], a[44:47]
  s_add_u32 s45, s45, 16384
  v_mfma_f32_16x16x32_bf16 a[48:51], v[124:127], v[64:67], a[48:51]
  ds_read_b128 v[32:35], v6 offset:36864
  s_add_u32 m0, s53, 24576
  v_mfma_f32_16x16x32_bf16 a[52:55], v[124:127], v[68:71], a[52:55]
  ds_read_b64_tr_b16 v[88:89], v7 offset:36864
  v_mfma_f32_16x16x32_bf16 a[56:59], v[124:127], v[72:75], a[56:59]
  v_mfma_f32_16x16x32_bf16 a[60:63], v[124:127], v[76:79], a[60:63]
  ds_read_b128 v[36:39], v6 offset:37888
  v_mfma_f32_16x16x32_bf16 a[64:67], v[128:131], v[48:51], a[64:67]
  buffer_load_dwordx4 v3, s[24:27], s47 offen lds
  v_mfma_f32_16x16x32_bf16 a[68:71], v[128:131], v[52:55], a[68:71]
  ds_read_b64_tr_b16 v[90:91], v7 offset:38912
  s_add_u32 m0, s53, 28672
  v_mfma_f32_16x16x32_bf16 a[72:75], v[128:131], v[56:59], a[72:75]
  ds_read_b128 v[40:43], v6 offset:38912
  v_mfma_f32_16x16x32_bf16 a[76:79], v[128:131], v[60:63], a[76:79]
  ds_read_b64_tr_b16 v[92:93], v8 offset:36864
  v_mfma_f32_16x16x32_bf16 a[80:83], v[128:131], v[64:67], a[80:83]
  buffer_load_dwordx4 v3, s[28:31], s47 offen lds
  v_mfma_f32_16x16x32_bf16 a[84:87], v[128:131], v[68:71], a[84:87]
  ds_read_b128 v[44:47], v6 offset:39936
  s_add_u32 m0, s54, 4096
  v_mfma_f32_16x16x32_bf16 a[88:91], v[128:131], v[72:75], a[88:91]
  ds_read_b64_tr_b16 v[94:95], v8 offset:38912
  v_mfma_f32_16x16x32_bf16 a[92:95], v[128:131], v[76:79], a[92:95]
  global_load_lds_dwordx4 v[4:5], off
  v_mfma_f32_16x16x32_bf16 a[96:99], v[132:135], v[48:51], a[96:99]
  v_mfma_f32_16x16x32_bf16 a[100:103], v[132:135], v[52:55], a[100:103]
  s_add_u32 s47, s47, s49
  v_mfma_f32_16x16x32_bf16 a[104:107], v[132:135], v[56:59], a[104:107]
  v_mfma_f32_16x16x32_bf16 a[108:111], v[132:135], v[60:63], a[108:111]
  v_lshl_add_u64 v[4:5], s[50:51], 0, v[4:5]
  v_mfma_f32_16x16x32_bf16 a[112:115], v[132:135], v[64:67], a[112:115]
  v_mfma_f32_16x16x32_bf16 a[116:119], v[132:135], v[68:71], a[116:119]
  v_mfma_f32_16x16x32_bf16 a[120:123], v[132:135], v[72:75], a[120:123]
  v_mfma_f32_16x16x32_bf16 a[124:127], v[132:135], v[76:79], a[124:127]
  s_waitcnt vmcnt(14) lgkmcnt(0)
  s_barrier
  v_mfma_f32_16x16x32_bf16 a[0:3], v[80:83], v[16:19], a[0:3]
  ds_read_b128 v[48:51], v6 offset:49152
  s_add_u32 m0, s52, 32768
  v_mfma_f32_16x16x32_bf16 a[4:7], v[80:83], v[20:23], a[4:7]
  ds_read_b64_tr_b16 v[120:121], v7 offset:49152
  v_mfma_f32_16x16x32_bf16 a[8:11], v[80:83], v[24:27], a[8:11]
  s_getpc_b64 s[58:59]
pfc_16:
  s_sub_u32 s58, s58, pfc_16-fz_start
  s_subb_u32 s59, s59, 0
  v_mfma_f32_16x16x32_bf16 a[12:15], v[80:83], v[28:31], a[12:15]
  buffer_load_dwordx4 v188, s[12:15], s45 offen offset:0 sc1 lds
  v_mfma_f32_16x16x32_bf16 a[16:19], v[80:83], v[32:35], a[16:19]
  s_lshl_b32 s60, s3, 2
  ds_read_b128 v[52:55], v6 offset:50176
  v_mfma_f32_16x16x32_bf16 a[20:23], v[80:83], v[36:39], a[20:23]
  ds_read_b64_tr_b16 v[122:123], v7 offset:51200
  s_and_b32 s61, s44, 3
  v_mfma_f32_16x16x32_bf16 a[24:27], v[80:83], v[40:43], a[24:27]
  buffer_load_dwordx4 v188, s[12:15], s45 offen offset:1024 sc1 lds
  v_mfma_f32_16x16x32_bf16 a[28:31], v[80:83], v[44:47], a[28:31]
  ds_read_b128 v[56:59], v6 offset:51200
  s_add_u32 s60, s60, s61
  v_mfma_f32_16x16x32_bf16 a[32:35], v[84:87], v[16:19], a[32:35]
  buffer_load_dwordx4 v188, s[12:15], s45 offen offset:2048 sc1 lds
  v_mfma_f32_16x16x32_bf16 a[36:39], v[84:87], v[20:23], a[36:39]
  ds_read_b64_tr_b16 v[124:125], v8 offset:49152
  s_lshl_b32 s60, s60, 2
  v_mfma_f32_16x16x32_bf16 a[40:43], v[84:87], v[24:27], a[40:43]
  buffer_load_dwordx4 v188, s[12:15], s45 offen offset:3072 sc1 lds
  v_mfma_f32_16x16x32_bf16 a[44:47], v[84:87], v[28:31], a[44:47]
  ds_read_b128 v[60:63], v6 offset:52224
  s_and_b32 s61, s43, 3
  v_mfma_f32_16x16x32_bf16 a[48:51], v[84:87], v[32:35], a[48:51]
  ds_read_b64_tr_b16 v[126:127], v8 offset:51200
  s_add_u32 s45, s45, 16384
  v_mfma_f32_16x16x32_bf16 a[52:55], v[84:87], v[36:39], a[52:55]
  s_add_u32 s60, s60, s61
  ds_read_b128 v[64:67], v6 offset:53248
  v_mfma_f32_16x16x32_bf16 a[56:59], v[84:87], v[40:43], a[56:59]
  s_add_u32 m0, s53, 40960
  ds_read_b64_tr_b16 v[128:129], v7 offset:53248
  v_mfma_f32_16x16x32_bf16 a[60:63], v[84:87], v[44:47], a[60:63]
  s_lshl_b32 s60, s60, 2
  s_add_u32 s60, s60, s40
  v_mfma_f32_16x16x32_bf16 a[64:67], v[88:91], v[16:19], a[64:67]
  ds_read_b128 v[68:71], v6 offset:54272
  ds_read_b64_tr_b16 v[130:131], v7 offset:55296
  v_mfma_f32_16x16x32_bf16 a[68:71], v[88:91], v[20:23], a[68:71]
  buffer_load_dwordx4 v3, s[24:27], s47 offen lds
  v_mfma_f32_16x16x32_bf16 a[72:75], v[88:91], v[24:27], a[72:75]
  s_lshl_b32 s60, s60, 10
  s_add_u32 m0, s53, 45056
  v_mfma_f32_16x16x32_bf16 a[76:79], v[88:91], v[28:31], a[76:79]
  ds_read_b128 v[72:75], v6 offset:55296
  v_and_b32 v12, 7, v0
  v_mfma_f32_16x16x32_bf16 a[80:83], v[88:91], v[32:35], a[80:83]
  ds_read_b64_tr_b16 v[132:133], v8 offset:53248
  v_lshlrev_b32 v12, 7, v12
  v_mfma_f32_16x16x32_bf16 a[84:87], v[88:91], v[36:39], a[84:87]
  buffer_load_dwordx4 v3, s[28:31], s47 offen lds
  v_mfma_f32_16x16x32_bf16 a[88:91], v[88:91], v[40:43], a[88:91]
  ds_read_b128 v[76:79], v6 offset:56320
  s_add_u32 m0, s54, 8192
  v_mfma_f32_16x16x32_bf16 a[92:95], v[88:91], v[44:47], a[92:95]
  ds_read_b64_tr_b16 v[134:135], v8 offset:55296
  v_add_u32 v12, s60, v12
  v_mfma_f32_16x16x32_bf16 a[96:99], v[92:95], v[16:19], a[96:99]
  global_load_lds_dwordx4 v[4:5], off
  v_mfma_f32_16x16x32_bf16 a[100:103], v[92:95], v[20:23], a[100:103]
  s_mov_b32 s60, fz_end-fz_start-4
  s_add_u32 s47, s47, s49
  v_mfma_f32_16x16x32_bf16 a[104:107], v[92:95], v[24:27], a[104:107]
  v_min_u32 v12, s60, v12
  v_mov_b32 v13, s59
  v_mfma_f32_16x16x32_bf16 a[108:111], v[92:95], v[28:31], a[108:111]
  v_lshl_add_u64 v[4:5], s[50:51], 0, v[4:5]
  v_mfma_f32_16x16x32_bf16 a[112:115], v[92:95], v[32:35], a[112:115]
  v_add_co_u32 v12, vcc, s58, v12
  s_nop 1
  v_addc_co_u32 v13, vcc, 0, v13, vcc
  v_mfma_f32_16x16x32_bf16 a[116:119], v[92:95], v[36:39], a[116:119]
  v_mfma_f32_16x16x32_bf16 a[120:123], v[92:95], v[40:43], a[120:123]
  global_load_dword v191, v[12:13], off
  v_mfma_f32_16x16x32_bf16 a[124:127], v[92:95], v[44:47], a[124:127]
  s_waitcnt vmcnt(15) lgkmcnt(0)
  s_barrier
  v_mfma_f32_16x16x32_bf16 a[0:3], v[120:123], v[48:51], a[0:3]
  ds_read_b128 v[16:19], v6 offset:0
  s_add_u32 m0, s52, 49152
  v_mfma_f32_16x16x32_bf16 a[4:7], v[120:123], v[52:55], a[4:7]
  ds_read_b64_tr_b16 v[96:97], v7 offset:8192
  v_mfma_f32_16x16x32_bf16 a[8:11], v[120:123], v[56:59], a[8:11]
  ds_read_b128 v[20:23], v6 offset:1024
  v_mfma_f32_16x16x32_bf16 a[12:15], v[120:123], v[60:63], a[12:15]
  buffer_load_dwordx4 v188, s[12:15], s45 offen offset:0 sc1 lds
  v_mfma_f32_16x16x32_bf16 a[16:19], v[120:123], v[64:67], a[16:19]
  ds_read_b64_tr_b16 v[98:99], v7 offset:10240
  ds_read_b64_tr_b16 v[100:101], v8 offset:8192
  v_mfma_f32_16x16x32_bf16 a[20:23], v[120:123], v[68:71], a[20:23]
  buffer_load_dwordx4 v188, s[12:15], s45 offen offset:1024 sc1 lds
  v_mfma_f32_16x16x32_bf16 a[24:27], v[120:123], v[72:75], a[24:27]
  ds_read_b128 v[24:27], v6 offset:2048
  v_mfma_f32_16x16x32_bf16 a[28:31], v[120:123], v[76:79], a[28:31]
  buffer_load_dwordx4 v188, s[12:15], s45 offen offset:2048 sc1 lds
  v_mfma_f32_16x16x32_bf16 a[32:35], v[124:127], v[48:51], a[32:35]
  ds_read_b64_tr_b16 v[102:103], v8 offset:10240
  ds_read_b128 v[28:31], v6 offset:3072
  v_mfma_f32_16x16x32_bf16 a[36:39], v[124:127], v[52:55], a[36:39]
  buffer_load_dwordx4 v188, s[12:15], s45 offen offset:3072 sc1 lds
  v_mfma_f32_16x16x32_bf16 a[40:43], v[124:127], v[56:59], a[40:43]
  ds_read_b64_tr_b16 v[104:105], v7 offset:12288
  ds_read_b64_tr_b16 v[106:107], v7 offset:14336
  v_mfma_f32_16x16x32_bf16 a[44:47], v[124:127], v[60:63], a[44:47]
  s_add_u32 s45, s45, 16384
  v_mfma_f32_16x16x32_bf16 a[48:51], v[124:127], v[64:67], a[48:51]
  ds_read_b128 v[32:35], v6 offset:4096
  s_add_u32 m0, s53, 57344
  v_mfma_f32_16x16x32_bf16 a[52:55], v[124:127], v[68:71], a[52:55]
  ds_read_b64_tr_b16 v[108:109], v8 offset:12288
  v_mfma_f32_16x16x32_bf16 a[56:59], v[124:127], v[72:75], a[56:59]
  ds_read_b128 v[36:39], v6 offset:5120
  v_mfma_f32_16x16x32_bf16 a[60:63], v[124:127], v[76:79], a[60:63]
  ds_read_b64_tr_b16 v[110:111], v8 offset:14336
  v_mfma_f32_16x16x32_bf16 a[64:67], v[128:131], v[48:51], a[64:67]
  buffer_load_dwordx4 v3, s[24:27], s47 offen lds
  v_mfma_f32_16x16x32_bf16 a[68:71], v[128:131], v[52:55], a[68:71]
  ds_read_b64_tr_b16 v[112:113], v9 offset:0
  s_add_u32 m0, s53, 61440
  v_mfma_f32_16x16x32_bf16 a[72:75], v[128:131], v[56:59], a[72:75]
  ds_read_b128 v[40:43], v6 offset:6144
  v_mfma_f32_16x16x32_bf16 a[76:79], v[128:131], v[60:63], a[76:79]
  ds_read_b64_tr_b16 v[114:115], v9 offset:2048
  v_mfma_f32_16x16x32_bf16 a[80:83], v[128:131], v[64:67], a[80:83]
  buffer_load_dwordx4 v3, s[28:31], s47 offen lds
  v_mfma_f32_16x16x32_bf16 a[84:87], v[128:131], v[68:71], a[84:87]
  ds_read_b128 v[44:47], v6 offset:7168
  ds_read_b64_tr_b16 v[116:117], v10 offset:0
  v_mfma_f32_16x16x32_bf16 a[88:91], v[128:131], v[72:75], a[88:91]
  s_add_u32 m0, s54, 12288
  ds_read_b64_tr_b16 v[118:119], v10 offset:2048
  v_mfma_f32_16x16x32_bf16 a[92:95], v[128:131], v[76:79], a[92:95]
  global_load_lds_dwordx4 v[4:5], off
  v_mfma_f32_16x16x32_bf16 a[96:99], v[132:135], v[48:51], a[96:99]
  v_mfma_f32_16x16x32_bf16 a[100:103], v[132:135], v[52:55], a[100:103]
  s_add_u32 s47, s47, s49
  v_mfma_f32_16x16x32_bf16 a[104:107], v[132:135], v[56:59], a[104:107]
  v_mfma_f32_16x16x32_bf16 a[108:111], v[132:135], v[60:63], a[108:111]
  v_lshl_add_u64 v[4:5], s[50:51], 0, v[4:5]
  v_mfma_f32_16x16x32_bf16 a[112:115], v[132:135], v[64:67], a[112:115]
  v_mfma_f32_16x16x32_bf16 a[116:119], v[132:135], v[68:71], a[116:119]
  v_mfma_f32_16x16x32_bf16 a[120:123], v[132:135], v[72:75], a[120:123]
  v_mfma_f32_16x16x32_bf16 a[124:127], v[132:135], v[76:79], a[124:127]
  s_waitcnt vmcnt(15) lgkmcnt(0)
  s_barrier
  v_mfma_f32_16x16x32_bf16 a[128:131], v[96:99], v[16:19], a[128:131]
  ds_read_b128 v[48:51], v6 offset:16384
  s_add_u32 m0, s52, 0
  v_mfma_f32_16x16x32_bf16 a[132:135], v[96:99], v[20:23], a[132:135]
  s_lshl_b32 s60, s43, 4
  s_lshl_b32 s61, s41, 3
  v_mfma_f32_16x16x32_bf16 a[136:139], v[96:99], v[24:27], a[136:139]
  ds_read_b64_tr_b16 v[136:137], v7 offset:24576
  s_add_u32 s60, s60, s61
  v_mfma_f32_16x16x32_bf16 a[140:143], v[96:99], v[28:31], a[140:143]
  buffer_load_dwordx4 v188, s[12:15], s45 offen offset:0 sc1 lds
  v_mfma_f32_16x16x32_bf16 a[144:147], v[96:99], v[32:35], a[144:147]
  s_add_u32 s32, s6, 16777216
  s_addc_u32 s33, s7, 0
  s_mov_b32 s34, 14680064
  s_mov_b32 s35, 0x20000
  v_mfma_f32_16x16x32_bf16 a[148:151], v[96:99], v[36:39], a[148:151]
  ds_read_b128 v[52:55], v6 offset:17408
  s_lshl_b32 s62, s44, 1
  v_mfma_f32_16x16x32_bf16 a[152:155], v[96:99], v[40:43], a[152:155]
  s_add_u32 s62, s62, s42
  s_lshr_b32 s56, s60, 3
  v_mfma_f32_16x16x32_bf16 a[156:159], v[96:99], v[44:47], a[156:159]
  ds_read_b64_tr_b16 v[138:139], v7 offset:26624
  s_mul_i32 s56, s56, 112
  v_mfma_f32_16x16x32_bf16 a[160:163], v[100:103], v[16:19], a[160:163]
  buffer_load_dwordx4 v188, s[12:15], s45 offen offset:1024 sc1 lds
  v_mfma_f32_16x16x32_bf16 a[164:167], v[100:103], v[20:23], a[164:167]
  s_add_u32 s56, s56, s62
  ds_read_b64_tr_b16 v[140:141], v8 offset:24576
  v_mfma_f32_16x16x32_bf16 a[168:171], v[100:103], v[24:27], a[168:171]
  s_lshl_b32 s56, s56, 13
  s_add_u32 s57, s56, 4096
  v_mfma_f32_16x16x32_bf16 a[172:175], v[100:103], v[28:31], a[172:175]
  buffer_load_dwordx4 v188, s[12:15], s45 offen offset:2048 sc1 lds
  v_mfma_f32_16x16x32_bf16 a[176:179], v[100:103], v[32:35], a[176:179]
  v_accvgpr_read_b32 v164, a0
  ds_read_b128 v[56:59], v6 offset:18432
  v_mfma_f32_16x16x32_bf16 a[180:183], v[100:103], v[36:39], a[180:183]
  v_accvgpr_read_b32 v168, a64
  v_accvgpr_read_b32 v165, a1
  v_mfma_f32_16x16x32_bf16 a[184:187], v[100:103], v[40:43], a[184:187]
  v_accvgpr_read_b32 v169, a65
  ds_read_b64_tr_b16 v[142:143], v8 offset:26624
  v_mfma_f32_16x16x32_bf16 a[188:191], v[100:103], v[44:47], a[188:191]
  v_accvgpr_read_b32 v166, a2
  v_accvgpr_read_b32 v170, a66
  v_mfma_f32_16x16x32_bf16 a[192:195], v[104:107], v[16:19], a[192:195]
  buffer_load_dwordx4 v188, s[12:15], s45 offen offset:3072 sc1 lds
  v_mfma_f32_16x16x32_bf16 a[196:199], v[104:107], v[20:23], a[196:199]
  ds_read_b128 v[60:63], v6 offset:19456
  v_accvgpr_read_b32 v167, a3
  v_mfma_f32_16x16x32_bf16 a[200:203], v[104:107], v[24:27], a[200:203]
  v_accvgpr_read_b32 v171, a67
  v_mul_f32 v164, v164, v168
  v_mfma_f32_16x16x32_bf16 a[204:207], v[104:107], v[28:31], a[204:207]
  ds_read_b64_tr_b16 v[144:145], v7 offset:28672
  s_add_u32 s45, s45, 16384
  v_mfma_f32_16x16x32_bf16 a[208:211], v[104:107], v[32:35], a[208:211]
  v_mul_f32 v165, v165, v169
  v_mul_f32 v166, v166, v170
  v_mfma_f32_16x16x32_bf16 a[212:215], v[104:107], v[36:39], a[212:215]
  ds_read_b64_tr_b16 v[146:147], v7 offset:30720
  v_mul_f32 v167, v167, v171
  v_mfma_f32_16x16x32_bf16 a[216:219], v[104:107], v[40:43], a[216:219]
  s_add_u32 m0, s53, 8192
  v_cvt_pk_bf16_f32 v160, v164, v165
  v_mfma_f32_16x16x32_bf16 a[220:223], v[104:107], v[44:47], a[220:223]
  v_cvt_pk_bf16_f32 v161, v166, v167
  ds_read_b128 v[64:67], v6 offset:20480
  v_mfma_f32_16x16x32_bf16 a[224:227], v[108:111], v[16:19], a[224:227]
  v_accvgpr_read_b32 v164, a32
  v_accvgpr_read_b32 v168, a96
  v_mfma_f32_16x16x32_bf16 a[228:231], v[108:111], v[20:23], a[228:231]
  ds_read_b64_tr_b16 v[148:149], v8 offset:28672
  v_accvgpr_read_b32 v165, a33
  v_mfma_f32_16x16x32_bf16 a[232:235], v[108:111], v[24:27], a[232:235]
  v_accvgpr_read_b32 v169, a97
  v_accvgpr_read_b32 v166, a34
  v_mfma_f32_16x16x32_bf16 a[236:239], v[108:111], v[28:31], a[236:239]
  buffer_load_dwordx4 v3, s[24:27], s47 offen lds
  v_mfma_f32_16x16x32_bf16 a[240:243], v[108:111], v[32:35], a[240:243]
  ds_read_b128 v[68:71], v6 offset:21504
  v_accvgpr_read_b32 v170, a98
  v_mfma_f32_16x16x32_bf16 a[244:247], v[108:111], v[36:39], a[244:247]
  v_accvgpr_read_b32 v167, a35
  ds_read_b64_tr_b16 v[150:151], v8 offset:30720
  v_mfma_f32_16x16x32_bf16 a[248:251], v[108:111], v[40:43], a[248:251]
  s_add_u32 m0, s53, 12288
  v_accvgpr_read_b32 v171, a99
  v_mfma_f32_16x16x32_bf16 a[252:255], v[108:111], v[44:47], a[252:255]
  v_mul_f32 v164, v164, v168
  v_mul_f32 v165, v165, v169
  v_mfma_f32_16x16x32_bf16 v[192:195], v[112:115], v[16:19], v[192:195]
  ds_read_b64_tr_b16 v[152:153], v9 offset:4096
  v_mul_f32 v166, v166, v170
  v_mfma_f32_16x16x32_bf16 v[196:199], v[112:115], v[20:23], v[196:199]
  buffer_load_dwordx4 v3, s[28:31], s47 offen lds
  v_mfma_f32_16x16x32_bf16 v[200:203], v[112:115], v[24:27], v[200:203]
  v_mul_f32 v167, v167, v171
  v_cvt_pk_bf16_f32 v162, v164, v165
  v_mfma_f32_16x16x32_bf16 v[204:207], v[112:115], v[28:31], v[204:207]
  ds_read_b128 v[72:75], v6 offset:22528
  v_cvt_pk_bf16_f32 v163, v166, v167
  v_mfma_f32_16x16x32_bf16 v[208:211], v[112:115], v[32:35], v[208:211]
  buffer_store_dwordx4 v[160:163], v1, s[32:35], s56 offen offset:0 sc1
  v_mfma_f32_16x16x32_bf16 v[212:215], v[112:115], v[36:39], v[212:215]
  ds_read_b64_tr_b16 v[154:155], v9 offset:6144
  s_add_u32 m0, s54, 0
  v_mfma_f32_16x16x32_bf16 v[216:219], v[112:115], v[40:43], v[216:219]
  v_accvgpr_read_b32 v176, a4
  v_accvgpr_read_b32 v180, a68
  v_mfma_f32_16x16x32_bf16 v[220:223], v[112:115], v[44:47], v[220:223]
  v_accvgpr_read_b32 v177, a5
  ds_read_b128 v[76:79], v6 offset:23552
  ds_read_b64_tr_b16 v[156:157], v10 offset:4096
  ds_read_b64_tr_b16 v[158:159], v10 offset:6144
  v_mfma_f32_16x16x32_bf16 v[224:227], v[116:119], v[16:19], v[224:227]
  v_accvgpr_read_b32 v181, a69
  v_accvgpr_read_b32 v178, a6
  v_mfma_f32_16x16x32_bf16 v[228:231], v[116:119], v[20:23], v[228:231]
  v_accvgpr_read_b32 v182, a70
  v_accvgpr_read_b32 v179, a7
  v_mfma_f32_16x16x32_bf16 v[232:235], v[116:119], v[24:27], v[232:235]
  v_accvgpr_read_b32 v183, a71
  v_mul_f32 v176, v176, v180
  v_mfma_f32_16x16x32_bf16 v[236:239], v[116:119], v[28:31], v[236:239]
  v_mul_f32 v177, v177, v181
  v_mul_f32 v178, v178, v182
  v_mfma_f32_16x16x32_bf16 v[240:243], v[116:119], v[32:35], v[240:243]
  global_load_lds_dwordx4 v[4:5], off
  v_mfma_f32_16x16x32_bf16 v[244:247], v[116:119], v[36:39], v[244:247]
  s_add_u32 s47, s47, s49
  v_mul_f32 v179, v179, v183
  v_lshl_add_u64 v[4:5], s[50:51], 0, v[4:5]
  v_mfma_f32_16x16x32_bf16 v[248:251], v[116:119], v[40:43], v[248:251]
  v_cvt_pk_bf16_f32 v172, v176, v177
  v_cvt_pk_bf16_f32 v173, v178, v179
  v_mfma_f32_16x16x32_bf16 v[252:255], v[116:119], v[44:47], v[252:255]
  v_accvgpr_read_b32 v176, a36
  v_accvgpr_read_b32 v180, a100
  v_accvgpr_read_b32 v177, a37
  v_accvgpr_read_b32 v181, a101
  v_accvgpr_read_b32 v178, a38
  v_accvgpr_read_b32 v182, a102
  s_waitcnt vmcnt(16) lgkmcnt(0)
  s_barrier
  v_mfma_f32_16x16x32_bf16 a[128:131], v[136:139], v[48:51], a[128:131]
  ds_read_b128 v[16:19], v6 offset:32768
  s_add_u32 m0, s52, 16384
  v_mfma_f32_16x16x32_bf16 a[132:135], v[136:139], v[52:55], a[132:135]
  v_accvgpr_read_b32 v179, a39
  v_accvgpr_read_b32 v183, a103
  v_mfma_f32_16x16x32_bf16 a[136:139], v[136:139], v[56:59], a[136:139]
  ds_read_b64_tr_b16 v[96:97], v7 offset:40960
  v_mul_f32 v176, v176, v180
  v_mfma_f32_16x16x32_bf16 a[140:143], v[136:139], v[60:63], a[140:143]
  buffer_load_dwordx4 v188, s[12:15], s45 offen offset:0 sc1 lds
  v_mfma_f32_16x16x32_bf16 a[144:147], v[136:139], v[64:67], a[144:147]
  v_mul_f32 v177, v177, v181
  ds_read_b128 v[20:23], v6 offset:33792
  v_mfma_f32_16x16x32_bf16 a[148:151], v[136:139], v[68:71], a[148:151]
  v_mul_f32 v178, v178, v182
  v_mul_f32 v179, v179, v183
  v_mfma_f32_16x16x32_bf16 a[152:155], v[136:139], v[72:75], a[152:155]
  v_cvt_pk_bf16_f32 v174, v176, v177
  ds_read_b64_tr_b16 v[98:99], v7 offset:43008
  v_mfma_f32_16x16x32_bf16 a[156:159], v[136:139], v[76:79], a[156:159]
  buffer_load_dwordx4 v188, s[12:15], s45 offen offset:1024 sc1 lds
  v_mfma_f32_16x16x32_bf16 a[160:163], v[140:143], v[48:51], a[160:163]
  v_cvt_pk_bf16_f32 v175, v178, v179
  ds_read_b64_tr_b16 v[100:101], v8 offset:40960
  v_mfma_f32_16x16x32_bf16 a[164:167], v[140:143], v[52:55], a[164:167]
  buffer_store_dwordx4 v[172:175], v1, s[32:35], s56 offen offset:1024 sc1
  v_mfma_f32_16x16x32_bf16 a[168:171], v[140:143], v[56:59], a[168:171]
  v_accvgpr_read_b32 v164, a8
  v_accvgpr_read_b32 v168, a72
  v_mfma_f32_16x16x32_bf16 a[172:175], v[140:143], v[60:63], a[172:175]
  buffer_load_dwordx4 v188, s[12:15], s45 offen offset:2048 sc1 lds
  v_mfma_f32_16x16x32_bf16 a[176:179], v[140:143], v[64:67], a[176:179]
  v_accvgpr_read_b32 v165, a9
  ds_read_b128 v[24:27], v6 offset:34816
  v_mfma_f32_16x16x32_bf16 a[180:183], v[140:143], v[68:71], a[180:183]
  v_accvgpr_read_b32 v169, a73
  v_accvgpr_read_b32 v166, a10
  v_mfma_f32_16x16x32_bf16 a[184:187], v[140:143], v[72:75], a[184:187]
  v_accvgpr_read_b32 v170, a74
  ds_read_b64_tr_b16 v[102:103], v8 offset:43008
  v_mfma_f32_16x16x32_bf16 a[188:191], v[140:143], v[76:79], a[188:191]
  v_accvgpr_read_b32 v167, a11
  v_accvgpr_read_b32 v171, a75
  v_mfma_f32_16x16x32_bf16 a[192:195], v[144:147], v[48:51], a[192:195]
  buffer_load_dwordx4 v188, s[12:15], s45 offen offset:3072 sc1 lds
  v_mfma_f32_16x16x32_bf16 a[196:199], v[144:147], v[52:55], a[196:199]
  ds_read_b128 v[28:31], v6 offset:35840
  v_mul_f32 v164, v164, v168
  v_mfma_f32_16x16x32_bf16 a[200:203], v[144:147], v[56:59], a[200:203]
  v_mul_f32 v165, v165, v169
  v_mul_f32 v166, v166, v170
  v_mfma_f32_16x16x32_bf16 a[204:207], v[144:147], v[60:63], a[204:207]
  ds_read_b64_tr_b16 v[104:105], v7 offset:45056
  s_add_u32 s45, s45, 16384
  v_mfma_f32_16x16x32_bf16 a[208:211], v[144:147], v[64:67], a[208:211]
  v_mul_f32 v167, v167, v171
  v_cvt_pk_bf16_f32 v160, v164, v165
  v_mfma_f32_16x16x32_bf16 a[212:215], v[144:147], v[68:71], a[212:215]
  v_cvt_pk_bf16_f32 v161, v166, v167
  ds_read_b64_tr_b16 v[106:107], v7 offset:47104
  v_mfma_f32_16x16x32_bf16 a[216:219], v[144:147], v[72:75], a[216:219]
  v_accvgpr_read_b32 v164, a40
  s_add_u32 m0, s53, 24576
  v_mfma_f32_16x16x32_bf16 a[220:223], v[144:147], v[76:79], a[220:223]
  v_accvgpr_read_b32 v168, a104
  ds_read_b128 v[32:35], v6 offset:36864
  v_mfma_f32_16x16x32_bf16 a[224:227], v[148:151], v[48:51], a[224:227]
  v_accvgpr_read_b32 v165, a41
  v_accvgpr_read_b32 v169, a105
  v_mfma_f32_16x16x32_bf16 a[228:231], v[148:151], v[52:55], a[228:231]
  v_accvgpr_read_b32 v166, a42
  ds_read_b64_tr_b16 v[108:109], v8 offset:45056
  v_mfma_f32_16x16x32_bf16 a[232:235], v[148:151], v[56:59], a[232:235]
  v_accvgpr_read_b32 v170, a106
  v_accvgpr_read_b32 v167, a43
  v_mfma_f32_16x16x32_bf16 a[236:239], v[148:151], v[60:63], a[236:239]
  buffer_load_dwordx4 v3, s[24:27], s47 offen lds
  v_mfma_f32_16x16x32_bf16 a[240:243], v[148:151], v[64:67], a[240:243]
  ds_read_b128 v[36:39], v6 offset:37888
  v_accvgpr_read_b32 v171, a107
  v_mfma_f32_16x16x32_bf16 a[244:247], v[148:151], v[68:71], a[244:247]
  v_mul_f32 v164, v164, v168
  v_mul_f32 v165, v165, v169
  v_mfma_f32_16x16x32_bf16 a[248:251], v[148:151], v[72:75], a[248:251]
  ds_read_b64_tr_b16 v[110:111], v8 offset:47104
  s_add_u32 m0, s53, 28672
  v_mfma_f32_16x16x32_bf16 a[252:255], v[148:151], v[76:79], a[252:255]
  v_mul_f32 v166, v166, v170
  v_mul_f32 v167, v167, v171
  v_mfma_f32_16x16x32_bf16 v[192:195], v[152:155], v[48:51], v[192:195]
  v_cvt_pk_bf16_f32 v162, v164, v165
  ds_read_b64_tr_b16 v[112:113], v9 offset:8192
  v_mfma_f32_16x16x32_bf16 v[196:199], v[152:155], v[52:55], v[196:199]
  v_cvt_pk_bf16_f32 v163, v166, v167
  ds_read_b128 v[40:43], v6 offset:38912
  v_mfma_f32_16x16x32_bf16 v[200:203], v[152:155], v[56:59], v[200:203]
  buffer_load_dwordx4 v3, s[28:31], s47 offen lds
  v_mfma_f32_16x16x32_bf16 v[204:207], v[152:155], v[60:63], v[204:207]
  buffer_store_dwordx4 v[160:163], v1, s[32:35], s56 offen offset:2048 sc1
  v_mfma_f32_16x16x32_bf16 v[208:211], v[152:155], v[64:67], v[208:211]
  v_accvgpr_read_b32 v176, a12
  v_accvgpr_read_b32 v180, a76
  v_mfma_f32_16x16x32_bf16 v[212:215], v[152:155], v[68:71], v[212:215]
  v_accvgpr_read_b32 v177, a13
  ds_read_b64_tr_b16 v[114:115], v9 offset:10240
  v_mfma_f32_16x16x32_bf16 v[216:219], v[152:155], v[72:75], v[216:219]
  v_accvgpr_read_b32 v181, a77
  v_accvgpr_read_b32 v178, a14
  v_mfma_f32_16x16x32_bf16 v[220:223], v[152:155], v[76:79], v[220:223]
  ds_read_b128 v[44:47], v6 offset:39936
  v_accvgpr_read_b32 v182, a78
  ds_read_b64_tr_b16 v[116:117], v10 offset:8192
  ds_read_b64_tr_b16 v[118:119], v10 offset:10240
  v_mfma_f32_16x16x32_bf16 v[224:227], v[156:159], v[48:51], v[224:227]
  v_accvgpr_read_b32 v179, a15
  v_accvgpr_read_b32 v183, a79
  v_mfma_f32_16x16x32_bf16 v[228:231], v[156:159], v[52:55], v[228:231]
  v_mul_f32 v176, v176, v180
  v_mul_f32 v177, v177, v181
  v_mfma_f32_16x16x32_bf16 v[232:235], v[156:159], v[56:59], v[232:235]
  v_mul_f32 v178, v178, v182
  v_mul_f32 v179, v179, v183
  v_mfma_f32_16x16x32_bf16 v[236:239], v[156:159], v[60:63], v[236:239]
  v_cvt_pk_bf16_f32 v172, v176, v177
  v_cvt_pk_bf16_f32 v173, v178, v179
  v_mfma_f32_16x16x32_bf16 v[240:243], v[156:159], v[64:67], v[240:243]
  s_add_u32 m0, s54, 4096
  v_accvgpr_read_b32 v176, a44
  v_mfma_f32_16x16x32_bf16 v[244:247], v[156:159], v[68:71], v[244:247]
  global_load_lds_dwordx4 v[4:5], off
  s_add_u32 s47, s47, s49
  v_lshl_add_u64 v[4:5], s[50:51], 0, v[4:5]
  v_mfma_f32_16x16x32_bf16 v[248:251], v[156:159], v[72:75], v[248:251]
  v_accvgpr_read_b32 v180, a108
  v_accvgpr_read_b32 v177, a45
  v_mfma_f32_16x16x32_bf16 v[252:255], v[156:159], v[76:79], v[252:255]
  v_accvgpr_read_b32 v181, a109
  v_accvgpr_read_b32 v178, a46
  v_accvgpr_read_b32 v182, a110
  v_accvgpr_read_b32 v179, a47
  v_accvgpr_read_b32 v183, a111
  v_mul_f32 v176, v176, v180
  s_waitcnt vmcnt(17) lgkmcnt(0)
  s_barrier
  v_mfma_f32_16x16x32_bf16 a[128:131], v[96:99], v[16:19], a[128:131]
  ds_read_b128 v[48:51], v6 offset:49152
  s_add_u32 m0, s52, 32768
  v_mfma_f32_16x16x32_bf16 a[132:135], v[96:99], v[20:23], a[132:135]
  v_mul_f32 v177, v177, v181
  v_mul_f32 v178, v178, v182
  v_mfma_f32_16x16x32_bf16 a[136:139], v[96:99], v[24:27], a[136:139]
  ds_read_b64_tr_b16 v[136:137], v7 offset:57344
  v_mul_f32 v179, v179, v183
  v_mfma_f32_16x16x32_bf16 a[140:143], v[96:99], v[28:31], a[140:143]
  buffer_load_dwordx4 v188, s[12:15], s45 offen offset:0 sc1 lds
  v_mfma_f32_16x16x32_bf16 a[144:147], v[96:99], v[32:35], a[144:147]
  v_cvt_pk_bf16_f32 v174, v176, v177
  ds_read_b128 v[52:55], v6 offset:50176
  v_mfma_f32_16x16x32_bf16 a[148:151], v[96:99], v[36:39], a[148:151]
  v_cvt_pk_bf16_f32 v175, v178, v179
  v_mfma_f32_16x16x32_bf16 a[152:155], v[96:99], v[40:43], a[152:155]
  buffer_store_dwordx4 v[172:175], v1, s[32:35], s56 offen offset:3072 sc1
  v_mfma_f32_16x16x32_bf16 a[156:159], v[96:99], v[44:47], a[156:159]
  v_accvgpr_read_b32 v164, a16
  ds_read_b64_tr_b16 v[138:139], v7 offset:59392
  v_mfma_f32_16x16x32_bf16 a[160:163], v[100:103], v[16:19], a[160:163]
  buffer_load_dwordx4 v188, s[12:15], s45 offen offset:1024 sc1 lds
  v_mfma_f32_16x16x32_bf16 a[164:167], v[100:103], v[20:23], a[164:167]
  v_accvgpr_read_b32 v168, a80
  v_accvgpr_read_b32 v165, a17
  v_mfma_f32_16x16x32_bf16 a[168:171], v[100:103], v[24:27], a[168:171]
  v_accvgpr_read_b32 v169, a81
  ds_read_b64_tr_b16 v[140:141], v8 offset:57344
  v_mfma_f32_16x16x32_bf16 a[172:175], v[100:103], v[28:31], a[172:175]
  v_accvgpr_read_b32 v166, a18
  v_accvgpr_read_b32 v170, a82
  v_mfma_f32_16x16x32_bf16 a[176:179], v[100:103], v[32:35], a[176:179]
  buffer_load_dwordx4 v188, s[12:15], s45 offen offset:2048 sc1 lds
  v_mfma_f32_16x16x32_bf16 a[180:183], v[100:103], v[36:39], a[180:183]
  ds_read_b128 v[56:59], v6 offset:51200
  v_accvgpr_read_b32 v167, a19
  v_mfma_f32_16x16x32_bf16 a[184:187], v[100:103], v[40:43], a[184:187]
  v_accvgpr_read_b32 v171, a83
  v_mul_f32 v164, v164, v168
  v_mfma_f32_16x16x32_bf16 a[188:191], v[100:103], v[44:47], a[188:191]
  ds_read_b64_tr_b16 v[142:143], v8 offset:59392
  v_mul_f32 v165, v165, v169
  v_mfma_f32_16x16x32_bf16 a[192:195], v[104:107], v[16:19], a[192:195]
  buffer_load_dwordx4 v188, s[12:15], s45 offen offset:3072 sc1 lds
  v_mfma_f32_16x16x32_bf16 a[196:199], v[104:107], v[20:23], a[196:199]
  v_mul_f32 v166, v166, v170
  v_mul_f32 v167, v167, v171
  v_mfma_f32_16x16x32_bf16 a[200:203], v[104:107], v[24:27], a[200:203]
  ds_read_b128 v[60:63], v6 offset:52224
  v_cvt_pk_bf16_f32 v160, v164, v165
  v_mfma_f32_16x16x32_bf16 a[204:207], v[104:107], v[28:31], a[204:207]
  v_cvt_pk_bf16_f32 v161, v166, v167
  ds_read_b64_tr_b16 v[144:145], v7 offset:61440
  v_mfma_f32_16x16x32_bf16 a[208:211], v[104:107], v[32:35], a[208:211]
  s_add_u32 s45, s45, 16384
  v_accvgpr_read_b32 v164, a48
  v_mfma_f32_16x16x32_bf16 a[212:215], v[104:107], v[36:39], a[212:215]
  v_accvgpr_read_b32 v168, a112
  v_accvgpr_read_b32 v165, a49
  v_mfma_f32_16x16x32_bf16 a[216:219], v[104:107], v[40:43], a[216:219]
  ds_read_b64_tr_b16 v[146:147], v7 offset:63488
  v_accvgpr_read_b32 v169, a113
  v_mfma_f32_16x16x32_bf16 a[220:223], v[104:107], v[44:47], a[220:223]
  s_add_u32 m0, s53, 40960
  v_accvgpr_read_b32 v166, a50
  v_mfma_f32_16x16x32_bf16 a[224:227], v[108:111], v[16:19], a[224:227]
  v_accvgpr_read_b32 v170, a114
  ds_read_b128 v[64:67], v6 offset:53248
  v_mfma_f32_16x16x32_bf16 a[228:231], v[108:111], v[20:23], a[228:231]
  v_accvgpr_read_b32 v167, a51
  v_accvgpr_read_b32 v171, a115
  v_mfma_f32_16x16x32_bf16 a[232:235], v[108:111], v[24:27], a[232:235]
  ds_read_b64_tr_b16 v[148:149], v8 offset:61440
  v_mul_f32 v164, v164, v168
  v_mfma_f32_16x16x32_bf16 a[236:239], v[108:111], v[28:31], a[236:239]
  v_mul_f32 v165, v165, v169
  v_mul_f32 v166, v166, v170
  v_mfma_f32_16x16x32_bf16 a[240:243], v[108:111], v[32:35], a[240:243]
  buffer_load_dwordx4 v3, s[24:27], s47 offen lds
  v_mfma_f32_16x16x32_bf16 a[244:247], v[108:111], v[36:39], a[244:247]
  ds_read_b128 v[68:71], v6 offset:54272
  v_mul_f32 v167, v167, v171
  v_mfma_f32_16x16x32_bf16 a[248:251], v[108:111], v[40:43], a[248:251]
  v_cvt_pk_bf16_f32 v162, v164, v165
  ds_read_b64_tr_b16 v[150:151], v8 offset:63488
  v_mfma_f32_16x16x32_bf16 a[252:255], v[108:111], v[44:47], a[252:255]
  s_add_u32 m0, s53, 45056
  v_cvt_pk_bf16_f32 v163, v166, v167
  v_mfma_f32_16x16x32_bf16 v[192:195], v[112:115], v[16:19], v[192:195]
  buffer_store_dwordx4 v[160:163], v1, s[32:35], s57 offen offset:0 sc1
  v_mfma_f32_16x16x32_bf16 v[196:199], v[112:115], v[20:23], v[196:199]
  v_accvgpr_read_b32 v176, a20
  ds_read_b64_tr_b16 v[152:153], v9 offset:12288
  v_mfma_f32_16x16x32_bf16 v[200:203], v[112:115], v[24:27], v[200:203]
  v_accvgpr_read_b32 v180, a84
  v_accvgpr_read_b32 v177, a21
  v_mfma_f32_16x16x32_bf16 v[204:207], v[112:115], v[28:31], v[204:207]
  buffer_load_dwordx4 v3, s[28:31], s47 offen lds
  v_mfma_f32_16x16x32_bf16 v[208:211], v[112:115], v[32:35], v[208:211]
  v_accvgpr_read_b32 v181, a85
  v_accvgpr_read_b32 v178, a22
  v_mfma_f32_16x16x32_bf16 v[212:215], v[112:115], v[36:39], v[212:215]
  ds_read_b128 v[72:75], v6 offset:55296
  v_accvgpr_read_b32 v182, a86
  v_mfma_f32_16x16x32_bf16 v[216:219], v[112:115], v[40:43], v[216:219]
  ds_read_b64_tr_b16 v[154:155], v9 offset:14336
  v_accvgpr_read_b32 v179, a23
  v_mfma_f32_16x16x32_bf16 v[220:223], v[112:115], v[44:47], v[220:223]
  v_accvgpr_read_b32 v183, a87
  v_mul_f32 v176, v176, v180
  ds_read_b128 v[76:79], v6 offset:56320
  ds_read_b64_tr_b16 v[156:157], v10 offset:12288
  ds_read_b64_tr_b16 v[158:159], v10 offset:14336
  v_mfma_f32_16x16x32_bf16 v[224:227], v[116:119], v[16:19], v[224:227]
  v_mul_f32 v177, v177, v181
  v_mul_f32 v178, v178, v182
  v_mfma_f32_16x16x32_bf16 v[228:231], v[116:119], v[20:23], v[228:231]
  v_mul_f32 v179, v179, v183
  v_cvt_pk_bf16_f32 v172, v176, v177
  v_mfma_f32_16x16x32_bf16 v[232:235], v[116:119], v[24:27], v[232:235]
  v_cvt_pk_bf16_f32 v173, v178, v179
  v_accvgpr_read_b32 v176, a52
  v_mfma_f32_16x16x32_bf16 v[236:239], v[116:119], v[28:31], v[236:239]
  v_accvgpr_read_b32 v180, a116
  v_accvgpr_read_b32 v177, a53
  v_mfma_f32_16x16x32_bf16 v[240:243], v[116:119], v[32:35], v[240:243]
  s_add_u32 m0, s54, 8192
  v_accvgpr_read_b32 v181, a117
  v_mfma_f32_16x16x32_bf16 v[244:247], v[116:119], v[36:39], v[244:247]
  global_load_lds_dwordx4 v[4:5], off
  s_add_u32 s47, s47, s49
  v_lshl_add_u64 v[4:5], s[50:51], 0, v[4:5]
  v_mfma_f32_16x16x32_bf16 v[248:251], v[116:119], v[40:43], v[248:251]
  v_accvgpr_read_b32 v178, a54
  v_accvgpr_read_b32 v182, a118
  v_mfma_f32_16x16x32_bf16 v[252:255], v[116:119], v[44:47], v[252:255]
  v_accvgpr_read_b32 v179, a55
  v_accvgpr_read_b32 v183, a119
  v_mul_f32 v176, v176, v180
  v_mul_f32 v177, v177, v181
  v_mul_f32 v178, v178, v182
  v_mul_f32 v179, v179, v183
  v_cvt_pk_bf16_f32 v174, v176, v177
  s_waitcnt vmcnt(18) lgkmcnt(0)
  s_barrier
  v_mfma_f32_16x16x32_bf16 a[128:131], v[136:139], v[48:51], a[128:131]
  ds_read_b128 v[16:19], v6 offset:0
  s_add_u32 m0, s52, 49152
  v_mfma_f32_16x16x32_bf16 a[132:135], v[136:139], v[52:55], a[132:135]
  v_cvt_pk_bf16_f32 v175, v178, v179
  v_mfma_f32_16x16x32_bf16 a[136:139], v[136:139], v[56:59], a[136:139]
  buffer_store_dwordx4 v[172:175], v1, s[32:35], s57 offen offset:1024 sc1
  v_mfma_f32_16x16x32_bf16 a[140:143], v[136:139], v[60:63], a[140:143]
  ds_read_b64_tr_b16 v[96:97], v7 offset:8192
  v_accvgpr_read_b32 v164, a24
  v_mfma_f32_16x16x32_bf16 a[144:147], v[136:139], v[64:67], a[144:147]
  buffer_load_dwordx4 v188, s[12:15], s45 offen offset:0 sc1 lds
  v_mfma_f32_16x16x32_bf16 a[148:151], v[136:139], v[68:71], a[148:151]
  v_accvgpr_read_b32 v168, a88
  ds_read_b128 v[20:23], v6 offset:1024
  v_mfma_f32_16x16x32_bf16 a[152:155], v[136:139], v[72:75], a[152:155]
  v_accvgpr_read_b32 v165, a25
  v_accvgpr_read_b32 v169, a89
  v_mfma_f32_16x16x32_bf16 a[156:159], v[136:139], v[76:79], a[156:159]
  v_accvgpr_read_b32 v166, a26
  ds_read_b64_tr_b16 v[98:99], v7 offset:10240
  v_mfma_f32_16x16x32_bf16 a[160:163], v[140:143], v[48:51], a[160:163]
  buffer_load_dwordx4 v188, s[12:15], s45 offen offset:1024 sc1 lds
  v_mfma_f32_16x16x32_bf16 a[164:167], v[140:143], v[52:55], a[164:167]
  v_accvgpr_read_b32 v170, a90
  v_accvgpr_read_b32 v167, a27
  v_mfma_f32_16x16x32_bf16 a[168:171], v[140:143], v[56:59], a[168:171]
  ds_read_b64_tr_b16 v[100:101], v8 offset:8192
  v_accvgpr_read_b32 v171, a91
  v_mfma_f32_16x16x32_bf16 a[172:175], v[140:143], v[60:63], a[172:175]
  v_mul_f32 v164, v164, v168
  v_mul_f32 v165, v165, v169
  v_mfma_f32_16x16x32_bf16 a[176:179], v[140:143], v[64:67], a[176:179]
  buffer_load_dwordx4 v188, s[12:15], s45 offen offset:2048 sc1 lds
  v_mfma_f32_16x16x32_bf16 a[180:183], v[140:143], v[68:71], a[180:183]
  ds_read_b128 v[24:27], v6 offset:2048
  v_mul_f32 v166, v166, v170
  v_mfma_f32_16x16x32_bf16 a[184:187], v[140:143], v[72:75], a[184:187]
  v_mul_f32 v167, v167, v171
  v_cvt_pk_bf16_f32 v160, v164, v165
  v_mfma_f32_16x16x32_bf16 a[188:191], v[140:143], v[76:79], a[188:191]
  ds_read_b64_tr_b16 v[102:103], v8 offset:10240
  v_cvt_pk_bf16_f32 v161, v166, v167
  v_mfma_f32_16x16x32_bf16 a[192:195], v[144:147], v[48:51], a[192:195]
  buffer_load_dwordx4 v188, s[12:15], s45 offen offset:3072 sc1 lds
  v_mfma_f32_16x16x32_bf16 a[196:199], v[144:147], v[52:55], a[196:199]
  v_accvgpr_read_b32 v164, a56
  ds_read_b128 v[28:31], v6 offset:3072
  v_mfma_f32_16x16x32_bf16 a[200:203], v[144:147], v[56:59], a[200:203]
  v_accvgpr_read_b32 v168, a120
  v_accvgpr_read_b32 v165, a57
  v_mfma_f32_16x16x32_bf16 a[204:207], v[144:147], v[60:63], a[204:207]
  v_accvgpr_read_b32 v169, a121
  ds_read_b64_tr_b16 v[104:105], v7 offset:12288
  v_mfma_f32_16x16x32_bf16 a[208:211], v[144:147], v[64:67], a[208:211]
  s_add_u32 s45, s45, 16384
  v_accvgpr_read_b32 v166, a58
  v_mfma_f32_16x16x32_bf16 a[212:215], v[144:147], v[68:71], a[212:215]
  v_accvgpr_read_b32 v170, a122
  ds_read_b64_tr_b16 v[106:107], v7 offset:14336
  v_mfma_f32_16x16x32_bf16 a[216:219], v[144:147], v[72:75], a[216:219]
  v_accvgpr_read_b32 v167, a59
  s_add_u32 m0, s53, 57344
  v_mfma_f32_16x16x32_bf16 a[220:223], v[144:147], v[76:79], a[220:223]
  v_accvgpr_read_b32 v171, a123
  v_mul_f32 v164, v164, v168
  v_mfma_f32_16x16x32_bf16 a[224:227], v[148:151], v[48:51], a[224:227]
  ds_read_b128 v[32:35], v6 offset:4096
  v_mul_f32 v165, v165, v169
  v_mfma_f32_16x16x32_bf16 a[228:231], v[148:151], v[52:55], a[228:231]
  v_mul_f32 v166, v166, v170
  ds_read_b64_tr_b16 v[108:109], v8 offset:12288
  v_mfma_f32_16x16x32_bf16 a[232:235], v[148:151], v[56:59], a[232:235]
  v_mul_f32 v167, v167, v171
  v_cvt_pk_bf16_f32 v162, v164, v165
  v_mfma_f32_16x16x32_bf16 a[236:239], v[148:151], v[60:63], a[236:239]
  buffer_load_dwordx4 v3, s[24:27], s47 offen lds
  v_mfma_f32_16x16x32_bf16 a[240:243], v[148:151], v[64:67], a[240:243]
  v_cvt_pk_bf16_f32 v163, v166, v167
  ds_read_b128 v[36:39], v6 offset:5120
  v_mfma_f32_16x16x32_bf16 a[244:247], v[148:151], v[68:71], a[244:247]
  buffer_store_dwordx4 v[160:163], v1, s[32:35], s57 offen offset:2048 sc1
  v_mfma_f32_16x16x32_bf16 a[248:251], v[148:151], v[72:75], a[248:251]
  v_accvgpr_read_b32 v176, a28
  ds_read_b64_tr_b16 v[110:111], v8 offset:14336
  v_mfma_f32_16x16x32_bf16 a[252:255], v[148:151], v[76:79], a[252:255]
  s_add_u32 m0, s53, 61440
  v_accvgpr_read_b32 v180, a92
  v_mfma_f32_16x16x32_bf16 v[192:195], v[152:155], v[48:51], v[192:195]
  v_accvgpr_read_b32 v177, a29
  v_accvgpr_read_b32 v181, a93
  v_mfma_f32_16x16x32_bf16 v[196:199], v[152:155], v[52:55], v[196:199]
  ds_read_b64_tr_b16 v[112:113], v9 offset:0
  v_accvgpr_read_b32 v178, a30
  v_mfma_f32_16x16x32_bf16 v[200:203], v[152:155], v[56:59], v[200:203]
  buffer_load_dwordx4 v3, s[28:31], s47 offen lds
  v_mfma_f32_16x16x32_bf16 v[204:207], v[152:155], v[60:63], v[204:207]
  v_accvgpr_read_b32 v182, a94
  v_accvgpr_read_b32 v179, a31
  v_mfma_f32_16x16x32_bf16 v[208:211], v[152:155], v[64:67], v[208:211]
  ds_read_b128 v[40:43], v6 offset:6144
  v_accvgpr_read_b32 v183, a95
  v_mfma_f32_16x16x32_bf16 v[212:215], v[152:155], v[68:71], v[212:215]
  v_mul_f32 v176, v176, v180
  ds_read_b64_tr_b16 v[114:115], v9 offset:2048
  v_mfma_f32_16x16x32_bf16 v[216:219], v[152:155], v[72:75], v[216:219]
  v_mul_f32 v177, v177, v181
  v_mul_f32 v178, v178, v182
  v_mfma_f32_16x16x32_bf16 v[220:223], v[152:155], v[76:79], v[220:223]
  v_mul_f32 v179, v179, v183
  ds_read_b128 v[44:47], v6 offset:7168
  ds_read_b64_tr_b16 v[116:117], v10 offset:0
  ds_read_b64_tr_b16 v[118:119], v10 offset:2048
  v_mfma_f32_16x16x32_bf16 v[224:227], v[156:159], v[48:51], v[224:227]
  v_cvt_pk_bf16_f32 v172, v176, v177
  v_cvt_pk_bf16_f32 v173, v178, v179
  v_mfma_f32_16x16x32_bf16 v[228:231], v[156:159], v[52:55], v[228:231]
  v_accvgpr_read_b32 v176, a60
  v_accvgpr_read_b32 v180, a124
  v_mfma_f32_16x16x32_bf16 v[232:235], v[156:159], v[56:59], v[232:235]
  v_accvgpr_read_b32 v177, a61
  v_accvgpr_read_b32 v181, a125
  v_mfma_f32_16x16x32_bf16 v[236:239], v[156:159], v[60:63], v[236:239]
  v_accvgpr_read_b32 v178, a62
  v_accvgpr_read_b32 v182, a126
  v_mfma_f32_16x16x32_bf16 v[240:243], v[156:159], v[64:67], v[240:243]
  s_add_u32 m0, s54, 12288
  v_accvgpr_read_b32 v179, a63
  v_mfma_f32_16x16x32_bf16 v[244:247], v[156:159], v[68:71], v[244:247]
  global_load_lds_dwordx4 v[4:5], off
  s_add_u32 s47, s47, s49
  v_lshl_add_u64 v[4:5], s[50:51], 0, v[4:5]
  v_mfma_f32_16x16x32_bf16 v[248:251], v[156:159], v[72:75], v[248:251]
  v_accvgpr_read_b32 v183, a127
  v_mul_f32 v176, v176, v180
  v_mfma_f32_16x16x32_bf16 v[252:255], v[156:159], v[76:79], v[252:255]
  v_mul_f32 v177, v177, v181
  v_mul_f32 v178, v178, v182
  v_mul_f32 v179, v179, v183
  v_cvt_pk_bf16_f32 v174, v176, v177
  v_cvt_pk_bf16_f32 v175, v178, v179
  buffer_store_dwordx4 v[172:175], v1, s[32:35], s57 offen offset:3072 sc1
  s_waitcnt vmcnt(19) lgkmcnt(0)
  s_barrier
  v_mfma_f32_16x16x32_bf16 a[128:131], v[96:99], v[16:19], a[128:131]
  ds_read_b128 v[48:51], v6 offset:16384
  s_add_u32 m0, s52, 0
  v_mfma_f32_16x16x32_bf16 a[132:135], v[96:99], v[20:23], a[132:135]
  v_mfma_f32_16x16x32_bf16 a[136:139], v[96:99], v[24:27], a[136:139]
  ds_read_b64_tr_b16 v[136:137], v7 offset:24576
  v_mfma_f32_16x16x32_bf16 a[140:143], v[96:99], v[28:31], a[140:143]
  buffer_load_dwordx4 v188, s[12:15], s45 offen offset:0 sc1 lds
  v_mfma_f32_16x16x32_bf16 a[144:147], v[96:99], v[32:35], a[144:147]
  ds_read_b128 v[52:55], v6 offset:17408
  v_mfma_f32_16x16x32_bf16 a[148:151], v[96:99], v[36:39], a[148:151]
  v_mfma_f32_16x16x32_bf16 a[152:155], v[96:99], v[40:43], a[152:155]
  ds_read_b64_tr_b16 v[138:139], v7 offset:26624
  v_mfma_f32_16x16x32_bf16 a[156:159], v[96:99], v[44:47], a[156:159]
  buffer_load_dwordx4 v188, s[12:15], s45 offen offset:1024 sc1 lds
  v_mfma_f32_16x16x32_bf16 a[160:163], v[100:103], v[16:19], a[160:163]
  ds_read_b64_tr_b16 v[140:141], v8 offset:24576
  v_mfma_f32_16x16x32_bf16 a[164:167], v[100:103], v[20:23], a[164:167]
  buffer_load_dwordx4 v188, s[12:15], s45 offen offset:2048 sc1 lds
  v_mfma_f32_16x16x32_bf16 a[168:171], v[100:103], v[24:27], a[168:171]
  ds_read_b128 v[56:59], v6 offset:18432
  v_mfma_f32_16x16x32_bf16 a[172:175], v[100:103], v[28:31], a[172:175]
  v_mfma_f32_16x16x32_bf16 a[176:179], v[100:103], v[32:35], a[176:179]
  ds_read_b64_tr_b16 v[142:143], v8 offset:26624
  v_mfma_f32_16x16x32_bf16 a[180:183], v[100:103], v[36:39], a[180:183]
  buffer_load_dwordx4 v188, s[12:15], s45 offen offset:3072 sc1 lds
  v_mfma_f32_16x16x32_bf16 a[184:187], v[100:103], v[40:43], a[184:187]
  ds_read_b128 v[60:63], v6 offset:19456
  v_mfma_f32_16x16x32_bf16 a[188:191], v[100:103], v[44:47], a[188:191]
  v_mfma_f32_16x16x32_bf16 a[192:195], v[104:107], v[16:19], a[192:195]
  ds_read_b64_tr_b16 v[144:145], v7 offset:28672
  s_add_u32 s45, s45, 16384
  v_mfma_f32_16x16x32_bf16 a[196:199], v[104:107], v[20:23], a[196:199]
  v_mfma_f32_16x16x32_bf16 a[200:203], v[104:107], v[24:27], a[200:203]
  ds_read_b64_tr_b16 v[146:147], v7 offset:30720
  v_mfma_f32_16x16x32_bf16 a[204:207], v[104:107], v[28:31], a[204:207]
  s_add_u32 m0, s53, 8192
  v_mfma_f32_16x16x32_bf16 a[208:211], v[104:107], v[32:35], a[208:211]
  ds_read_b128 v[64:67], v6 offset:20480
  v_mfma_f32_16x16x32_bf16 a[212:215], v[104:107], v[36:39], a[212:215]
  v_mfma_f32_16x16x32_bf16 a[216:219], v[104:107], v[40:43], a[216:219]
  ds_read_b64_tr_b16 v[148:149], v8 offset:28672
  v_mfma_f32_16x16x32_bf16 a[220:223], v[104:107], v[44:47], a[220:223]
  buffer_load_dwordx4 v3, s[24:27], s47 offen lds
  v_mfma_f32_16x16x32_bf16 a[224:227], v[108:111], v[16:19], a[224:227]
  ds_read_b128 v[68:71], v6 offset:21504
  v_mfma_f32_16x16x32_bf16 a[228:231], v[108:111], v[20:23], a[228:231]
  v_mfma_f32_16x16x32_bf16 a[232:235], v[108:111], v[24:27], a[232:235]
  ds_read_b64_tr_b16 v[150:151], v8 offset:30720
  s_add_u32 m0, s53, 12288
  v_mfma_f32_16x16x32_bf16 a[236:239], v[108:111], v[28:31], a[236:239]
  v_mfma_f32_16x16x32_bf16 a[240:243], v[108:111], v[32:35], a[240:243]
  ds_read_b64_tr_b16 v[152:153], v9 offset:4096
  v_mfma_f32_16x16x32_bf16 a[244:247], v[108:111], v[36:39], a[244:247]
  buffer_load_dwordx4 v3, s[28:31], s47 offen lds
  v_mfma_f32_16x16x32_bf16 a[248:251], v[108:111], v[40:43], a[248:251]
  ds_read_b128 v[72:75], v6 offset:22528
  v_mfma_f32_16x16x32_bf16 a[252:255], v[108:111], v[44:47], a[252:255]
  v_mfma_f32_16x16x32_bf16 v[192:195], v[112:115], v[16:19], v[192:195]
  ds_read_b64_tr_b16 v[154:155], v9 offset:6144
  s_add_u32 m0, s54, 0
  v_mfma_f32_16x16x32_bf16 v[196:199], v[112:115], v[20:23], v[196:199]
  v_mfma_f32_16x16x32_bf16 v[200:203], v[112:115], v[24:27], v[200:203]
  ds_read_b128 v[76:79], v6 offset:23552
  v_mfma_f32_16x16x32_bf16 v[204:207], v[112:115], v[28:31], v[204:207]
  v_mfma_f32_16x16x32_bf16 v[208:211], v[112:115], v[32:35], v[208:211]
  ds_read_b64_tr_b16 v[156:157], v10 offset:4096
  v_mfma_f32_16x16x32_bf16 v[212:215], v[112:115], v[36:39], v[212:215]
  global_load_lds_dwordx4 v[4:5], off
  v_mfma_f32_16x16x32_bf16 v[216:219], v[112:115], v[40:43], v[216:219]
  ds_read_b64_tr_b16 v[158:159], v10 offset:6144
  v_mfma_f32_16x16x32_bf16 v[220:223], v[112:115], v[44:47], v[220:223]
  s_add_u32 s47, s47, s49
  v_mfma_f32_16x16x32_bf16 v[224:227], v[116:119], v[16:19], v[224:227]
  v_mfma_f32_16x16x32_bf16 v[228:231], v[116:119], v[20:23], v[228:231]
  v_mfma_f32_16x16x32_bf16 v[232:235], v[116:119], v[24:27], v[232:235]
  v_lshl_add_u64 v[4:5], s[50:51], 0, v[4:5]
  v_mfma_f32_16x16x32_bf16 v[236:239], v[116:119], v[28:31], v[236:239]
  v_mfma_f32_16x16x32_bf16 v[240:243], v[116:119], v[32:35], v[240:243]
  v_mfma_f32_16x16x32_bf16 v[244:247], v[116:119], v[36:39], v[244:247]
  v_mfma_f32_16x16x32_bf16 v[248:251], v[116:119], v[40:43], v[248:251]
  v_mfma_f32_16x16x32_bf16 v[252:255], v[116:119], v[44:47], v[252:255]
  s_waitcnt vmcnt(17) lgkmcnt(0)
  s_barrier
  v_mfma_f32_16x16x32_bf16 a[128:131], v[136:139], v[48:51], a[128:131]
  ds_read_b128 v[16:19], v6 offset:32768
  s_add_u32 m0, s52, 16384
  v_mfma_f32_16x16x32_bf16 a[132:135], v[136:139], v[52:55], a[132:135]
  v_mfma_f32_16x16x32_bf16 a[136:139], v[136:139], v[56:59], a[136:139]
  ds_read_b64_tr_b16 v[96:97], v7 offset:40960
  v_mfma_f32_16x16x32_bf16 a[140:143], v[136:139], v[60:63], a[140:143]
  buffer_load_dwordx4 v188, s[12:15], s45 offen offset:0 sc1 lds
  v_mfma_f32_16x16x32_bf16 a[144:147], v[136:139], v[64:67], a[144:147]
  ds_read_b128 v[20:23], v6 offset:33792
  v_mfma_f32_16x16x32_bf16 a[148:151], v[136:139], v[68:71], a[148:151]
  v_mfma_f32_16x16x32_bf16 a[152:155], v[136:139], v[72:75], a[152:155]
  ds_read_b64_tr_b16 v[98:99], v7 offset:43008
  v_mfma_f32_16x16x32_bf16 a[156:159], v[136:139], v[76:79], a[156:159]
  buffer_load_dwordx4 v188, s[12:15], s45 offen offset:1024 sc1 lds
  v_mfma_f32_16x16x32_bf16 a[160:163], v[140:143], v[48:51], a[160:163]
  ds_read_b64_tr_b16 v[100:101], v8 offset:40960
  v_mfma_f32_16x16x32_bf16 a[164:167], v[140:143], v[52:55], a[164:167]
  buffer_load_dwordx4 v188, s[12:15], s45 offen offset:2048 sc1 lds
  v_mfma_f32_16x16x32_bf16 a[168:171], v[140:143], v[56:59], a[168:171]
  ds_read_b128 v[24:27], v6 offset:34816
  v_mfma_f32_16x16x32_bf16 a[172:175], v[140:143], v[60:63], a[172:175]
  v_mfma_f32_16x16x32_bf16 a[176:179], v[140:143], v[64:67], a[176:179]
  ds_read_b64_tr_b16 v[102:103], v8 offset:43008
  v_mfma_f32_16x16x32_bf16 a[180:183], v[140:143], v[68:71], a[180:183]
  buffer_load_dwordx4 v188, s[12:15], s45 offen offset:3072 sc1 lds
  v_mfma_f32_16x16x32_bf16 a[184:187], v[140:143], v[72:75], a[184:187]
  ds_read_b128 v[28:31], v6 offset:35840
  v_mfma_f32_16x16x32_bf16 a[188:191], v[140:143], v[76:79], a[188:191]
  v_mfma_f32_16x16x32_bf16 a[192:195], v[144:147], v[48:51], a[192:195]
  ds_read_b64_tr_b16 v[104:105], v7 offset:45056
  s_add_u32 s45, s45, 16384
  v_mfma_f32_16x16x32_bf16 a[196:199], v[144:147], v[52:55], a[196:199]
  v_mfma_f32_16x16x32_bf16 a[200:203], v[144:147], v[56:59], a[200:203]
  ds_read_b64_tr_b16 v[106:107], v7 offset:47104
  v_mfma_f32_16x16x32_bf16 a[204:207], v[144:147], v[60:63], a[204:207]
  s_add_u32 m0, s53, 24576
  v_mfma_f32_16x16x32_bf16 a[208:211], v[144:147], v[64:67], a[208:211]
  ds_read_b128 v[32:35], v6 offset:36864
  v_mfma_f32_16x16x32_bf16 a[212:215], v[144:147], v[68:71], a[212:215]
  v_mfma_f32_16x16x32_bf16 a[216:219], v[144:147], v[72:75], a[216:219]
  ds_read_b64_tr_b16 v[108:109], v8 offset:45056
  v_mfma_f32_16x16x32_bf16 a[220:223], v[144:147], v[76:79], a[220:223]
  buffer_load_dwordx4 v3, s[24:27], s47 offen lds
  v_mfma_f32_16x16x32_bf16 a[224:227], v[148:151], v[48:51], a[224:227]
  ds_read_b128 v[36:39], v6 offset:37888
  v_mfma_f32_16x16x32_bf16 a[228:231], v[148:151], v[52:55], a[228:231]
  v_mfma_f32_16x16x32_bf16 a[232:235], v[148:151], v[56:59], a[232:235]
  ds_read_b64_tr_b16 v[110:111], v8 offset:47104
  s_add_u32 m0, s53, 28672
  v_mfma_f32_16x16x32_bf16 a[236:239], v[148:151], v[60:63], a[236:239]
  v_mfma_f32_16x16x32_bf16 a[240:243], v[148:151], v[64:67], a[240:243]
  ds_read_b64_tr_b16 v[112:113], v9 offset:8192
  v_mfma_f32_16x16x32_bf16 a[244:247], v[148:151], v[68:71], a[244:247]
  buffer_load_dwordx4 v3, s[28:31], s47 offen lds
  v_mfma_f32_16x16x32_bf16 a[248:251], v[148:151], v[72:75], a[248:251]
  ds_read_b128 v[40:43], v6 offset:38912
  v_mfma_f32_16x16x32_bf16 a[252:255], v[148:151], v[76:79], a[252:255]
  v_mfma_f32_16x16x32_bf16 v[192:195], v[152:155], v[48:51], v[192:195]
  ds_read_b64_tr_b16 v[114:115], v9 offset:10240
  s_add_u32 m0, s54, 4096
  v_mfma_f32_16x16x32_bf16 v[196:199], v[152:155], v[52:55], v[196:199]
  v_mfma_f32_16x16x32_bf16 v[200:203], v[152:155], v[56:59], v[200:203]
  ds_read_b128 v[44:47], v6 offset:39936
  v_mfma_f32_16x16x32_bf16 v[204:207], v[152:155], v[60:63], v[204:207]
  v_mfma_f32_16x16x32_bf16 v[208:211], v[152:155], v[64:67], v[208:211]
  ds_read_b64_tr_b16 v[116:117], v10 offset:8192
  v_mfma_f32_16x16x32_bf16 v[212:215], v[152:155], v[68:71], v[212:215]
  global_load_lds_dwordx4 v[4:5], off
  v_mfma_f32_16x16x32_bf16 v[216:219], v[152:155], v[72:75], v[216:219]
  ds_read_b64_tr_b16 v[118:119], v10 offset:10240
  v_mfma_f32_16x16x32_bf16 v[220:223], v[152:155], v[76:79], v[220:223]
  s_add_u32 s47, s47, s49
  v_mfma_f32_16x16x32_bf16 v[224:227], v[156:159], v[48:51], v[224:227]
  v_mfma_f32_16x16x32_bf16 v[228:231], v[156:159], v[52:55], v[228:231]
  v_mfma_f32_16x16x32_bf16 v[232:235], v[156:159], v[56:59], v[232:235]
  v_lshl_add_u64 v[4:5], s[50:51], 0, v[4:5]
  v_mfma_f32_16x16x32_bf16 v[236:239], v[156:159], v[60:63], v[236:239]
  v_mfma_f32_16x16x32_bf16 v[240:243], v[156:159], v[64:67], v[240:243]
  v_mfma_f32_16x16x32_bf16 v[244:247], v[156:159], v[68:71], v[244:247]
  v_mfma_f32_16x16x32_bf16 v[248:251], v[156:159], v[72:75], v[248:251]
  v_mfma_f32_16x16x32_bf16 v[252:255], v[156:159], v[76:79], v[252:255]
  s_waitcnt vmcnt(14) lgkmcnt(0)
  s_barrier
  s_cmp_eq_u32 s40, 0
  s_cbranch_scc0 sig_17
  s_lshl_b32 s66, s43, 5
  s_add_u32 s66, s66, s78
  s_add_u32 s66, s66, 256
  s_lshl_b32 s66, s66, 7
  s_add_u32 s66, s66, 4096
  v_mov_b32 v12, s76
  v_mov_b32 v13, s77
  v_mov_b32 v14, 0
  s_mov_b64 exec, 1
  buffer_store_dwordx2 v[12:13], v14, s[72:75], s66 offen sc1
  s_mov_b64 exec, -1
sig_17:
  v_mfma_f32_16x16x32_bf16 a[128:131], v[96:99], v[16:19], a[128:131]
  ds_read_b128 v[48:51], v6 offset:49152
  s_add_u32 m0, s52, 32768
  v_mfma_f32_16x16x32_bf16 a[132:135], v[96:99], v[20:23], a[132:135]
  v_mfma_f32_16x16x32_bf16 a[136:139], v[96:99], v[24:27], a[136:139]
  ds_read_b64_tr_b16 v[136:137], v7 offset:57344
  v_mfma_f32_16x16x32_bf16 a[140:143], v[96:99], v[28:31], a[140:143]
  buffer_load_dwordx4 v188, s[12:15], s45 offen offset:0 sc1 lds
  v_mfma_f32_16x16x32_bf16 a[144:147], v[96:99], v[32:35], a[144:147]
  ds_read_b128 v[52:55], v6 offset:50176
  v_mfma_f32_16x16x32_bf16 a[148:151], v[96:99], v[36:39], a[148:151]
  v_mfma_f32_16x16x32_bf16 a[152:155], v[96:99], v[40:43], a[152:155]
  ds_read_b64_tr_b16 v[138:139], v7 offset:59392
  v_mfma_f32_16x16x32_bf16 a[156:159], v[96:99], v[44:47], a[156:159]
  buffer_load_dwordx4 v188, s[12:15], s45 offen offset:1024 sc1 lds
  v_mfma_f32_16x16x32_bf16 a[160:163], v[100:103], v[16:19], a[160:163]
  ds_read_b64_tr_b16 v[140:141], v8 offset:57344
  v_mfma_f32_16x16x32_bf16 a[164:167], v[100:103], v[20:23], a[164:167]
  buffer_load_dwordx4 v188, s[12:15], s45 offen offset:2048 sc1 lds
  v_mfma_f32_16x16x32_bf16 a[168:171], v[100:103], v[24:27], a[168:171]
  ds_read_b128 v[56:59], v6 offset:51200
  v_mfma_f32_16x16x32_bf16 a[172:175], v[100:103], v[28:31], a[172:175]
  v_mfma_f32_16x16x32_bf16 a[176:179], v[100:103], v[32:35], a[176:179]
  ds_read_b64_tr_b16 v[142:143], v8 offset:59392
  v_mfma_f32_16x16x32_bf16 a[180:183], v[100:103], v[36:39], a[180:183]
  buffer_load_dwordx4 v188, s[12:15], s45 offen offset:3072 sc1 lds
  v_mfma_f32_16x16x32_bf16 a[184:187], v[100:103], v[40:43], a[184:187]
  ds_read_b128 v[60:63], v6 offset:52224
  v_mfma_f32_16x16x32_bf16 a[188:191], v[100:103], v[44:47], a[188:191]
  v_mfma_f32_16x16x32_bf16 a[192:195], v[104:107], v[16:19], a[192:195]
  ds_read_b64_tr_b16 v[144:145], v7 offset:61440
  s_add_u32 s45, s45, 16384
  v_mfma_f32_16x16x32_bf16 a[196:199], v[104:107], v[20:23], a[196:199]
  v_mfma_f32_16x16x32_bf16 a[200:203], v[104:107], v[24:27], a[200:203]
  ds_read_b64_tr_b16 v[146:147], v7 offset:63488
  v_mfma_f32_16x16x32_bf16 a[204:207], v[104:107], v[28:31], a[204:207]
  s_add_u32 m0, s53, 40960
  v_mfma_f32_16x16x32_bf16 a[208:211], v[104:107], v[32:35], a[208:211]
  ds_read_b128 v[64:67], v6 offset:53248
  v_mfma_f32_16x16x32_bf16 a[212:215], v[104:107], v[36:39], a[212:215]
  v_mfma_f32_16x16x32_bf16 a[216:219], v[104:107], v[40:43], a[216:219]
  ds_read_b64_tr_b16 v[148:149], v8 offset:61440
  v_mfma_f32_16x16x32_bf16 a[220:223], v[104:107], v[44:47], a[220:223]
  buffer_load_dwordx4 v3, s[24:27], s47 offen lds
  v_mfma_f32_16x16x32_bf16 a[224:227], v[108:111], v[16:19], a[224:227]
  ds_read_b128 v[68:71], v6 offset:54272
  v_mfma_f32_16x16x32_bf16 a[228:231], v[108:111], v[20:23], a[228:231]
  v_mfma_f32_16x16x32_bf16 a[232:235], v[108:111], v[24:27], a[232:235]
  ds_read_b64_tr_b16 v[150:151], v8 offset:63488
  s_add_u32 m0, s53, 45056
  v_mfma_f32_16x16x32_bf16 a[236:239], v[108:111], v[28:31], a[236:239]
  v_mfma_f32_16x16x32_bf16 a[240:243], v[108:111], v[32:35], a[240:243]
  ds_read_b64_tr_b16 v[152:153], v9 offset:12288
  v_mfma_f32_16x16x32_bf16 a[244:247], v[108:111], v[36:39], a[244:247]
  buffer_load_dwordx4 v3, s[28:31], s47 offen lds
  v_mfma_f32_16x16x32_bf16 a[248:251], v[108:111], v[40:43], a[248:251]
  ds_read_b128 v[72:75], v6 offset:55296
  v_mfma_f32_16x16x32_bf16 a[252:255], v[108:111], v[44:47], a[252:255]
  v_mfma_f32_16x16x32_bf16 v[192:195], v[112:115], v[16:19], v[192:195]
  ds_read_b64_tr_b16 v[154:155], v9 offset:14336
  s_add_u32 m0, s54, 8192
  v_mfma_f32_16x16x32_bf16 v[196:199], v[112:115], v[20:23], v[196:199]
  v_mfma_f32_16x16x32_bf16 v[200:203], v[112:115], v[24:27], v[200:203]
  ds_read_b128 v[76:79], v6 offset:56320
  v_mfma_f32_16x16x32_bf16 v[204:207], v[112:115], v[28:31], v[204:207]
  v_mfma_f32_16x16x32_bf16 v[208:211], v[112:115], v[32:35], v[208:211]
  ds_read_b64_tr_b16 v[156:157], v10 offset:12288
  v_mfma_f32_16x16x32_bf16 v[212:215], v[112:115], v[36:39], v[212:215]
  global_load_lds_dwordx4 v[4:5], off
  v_mfma_f32_16x16x32_bf16 v[216:219], v[112:115], v[40:43], v[216:219]
  ds_read_b64_tr_b16 v[158:159], v10 offset:14336
  v_mfma_f32_16x16x32_bf16 v[220:223], v[112:115], v[44:47], v[220:223]
  s_add_u32 s47, s47, s49
  v_mfma_f32_16x16x32_bf16 v[224:227], v[116:119], v[16:19], v[224:227]
  v_mfma_f32_16x16x32_bf16 v[228:231], v[116:119], v[20:23], v[228:231]
  v_mfma_f32_16x16x32_bf16 v[232:235], v[116:119], v[24:27], v[232:235]
  v_lshl_add_u64 v[4:5], s[50:51], 0, v[4:5]
  v_mfma_f32_16x16x32_bf16 v[236:239], v[116:119], v[28:31], v[236:239]
  v_mfma_f32_16x16x32_bf16 v[240:243], v[116:119], v[32:35], v[240:243]
  v_mfma_f32_16x16x32_bf16 v[244:247], v[116:119], v[36:39], v[244:247]
  v_mfma_f32_16x16x32_bf16 v[248:251], v[116:119], v[40:43], v[248:251]
  v_mfma_f32_16x16x32_bf16 v[252:255], v[116:119], v[44:47], v[252:255]
  s_waitcnt vmcnt(14) lgkmcnt(0)
  s_barrier
  v_mfma_f32_16x16x32_bf16 a[128:131], v[136:139], v[48:51], a[128:131]
  ds_read_b128 v[16:19], v6 offset:0
  s_add_u32 m0, s52, 49152
  v_mfma_f32_16x16x32_bf16 a[132:135], v[136:139], v[52:55], a[132:135]
  s_lshr_b32 s66, s44, 1
  v_mfma_f32_16x16x32_bf16 a[136:139], v[136:139], v[56:59], a[136:139]
  ds_read_b64_tr_b16 v[96:97], v7 offset:8192
  v_mfma_f32_16x16x32_bf16 a[140:143], v[136:139], v[60:63], a[140:143]
  buffer_load_dwordx4 v188, s[12:15], s45 offen offset:0 sc1 lds
  v_mfma_f32_16x16x32_bf16 a[144:147], v[136:139], v[64:67], a[144:147]
  ds_read_b128 v[20:23], v6 offset:1024
  s_lshl_b32 s66, s66, 5
  v_mfma_f32_16x16x32_bf16 a[148:151], v[136:139], v[68:71], a[148:151]
  v_mfma_f32_16x16x32_bf16 a[152:155], v[136:139], v[72:75], a[152:155]
  ds_read_b64_tr_b16 v[98:99], v7 offset:10240
  v_mfma_f32_16x16x32_bf16 a[156:159], v[136:139], v[76:79], a[156:159]
  buffer_load_dwordx4 v188, s[12:15], s45 offen offset:1024 sc1 lds
  v_mfma_f32_16x16x32_bf16 a[160:163], v[140:143], v[48:51], a[160:163]
  ds_read_b64_tr_b16 v[100:101], v8 offset:8192
  s_add_u32 s66, s66, 256
  v_mfma_f32_16x16x32_bf16 a[164:167], v[140:143], v[52:55], a[164:167]
  buffer_load_dwordx4 v188, s[12:15], s45 offen offset:2048 sc1 lds
  v_mfma_f32_16x16x32_bf16 a[168:171], v[140:143], v[56:59], a[168:171]
  ds_read_b128 v[24:27], v6 offset:2048
  v_mfma_f32_16x16x32_bf16 a[172:175], v[140:143], v[60:63], a[172:175]
  s_lshl_b32 s66, s66, 7
  v_mfma_f32_16x16x32_bf16 a[176:179], v[140:143], v[64:67], a[176:179]
  ds_read_b64_tr_b16 v[102:103], v8 offset:10240
  v_mfma_f32_16x16x32_bf16 a[180:183], v[140:143], v[68:71], a[180:183]
  buffer_load_dwordx4 v188, s[12:15], s45 offen offset:3072 sc1 lds
  v_mfma_f32_16x16x32_bf16 a[184:187], v[140:143], v[72:75], a[184:187]
  ds_read_b128 v[28:31], v6 offset:3072
  v_mfma_f32_16x16x32_bf16 a[188:191], v[140:143], v[76:79], a[188:191]
  s_add_u32 s66, s66, 4096
  v_mfma_f32_16x16x32_bf16 a[192:195], v[144:147], v[48:51], a[192:195]
  ds_read_b64_tr_b16 v[104:105], v7 offset:12288
  s_add_u32 s45, s45, 16384
  v_mfma_f32_16x16x32_bf16 a[196:199], v[144:147], v[52:55], a[196:199]
  v_mfma_f32_16x16x32_bf16 a[200:203], v[144:147], v[56:59], a[200:203]
  ds_read_b64_tr_b16 v[106:107], v7 offset:14336
  v_mfma_f32_16x16x32_bf16 a[204:207], v[144:147], v[60:63], a[204:207]
  s_add_u32 m0, s53, 57344
  v_bfe_u32 v186, v0, 1, 3
  v_mfma_f32_16x16x32_bf16 a[208:211], v[144:147], v[64:67], a[208:211]
  ds_read_b128 v[32:35], v6 offset:4096
  v_mfma_f32_16x16x32_bf16 a[212:215], v[144:147], v[68:71], a[212:215]
  v_mfma_f32_16x16x32_bf16 a[216:219], v[144:147], v[72:75], a[216:219]
  ds_read_b64_tr_b16 v[108:109], v8 offset:12288
  v_lshlrev_b32 v186, 2, v186
  v_mfma_f32_16x16x32_bf16 a[220:223], v[144:147], v[76:79], a[220:223]
  buffer_load_dwordx4 v3, s[24:27], s47 offen lds
  v_mfma_f32_16x16x32_bf16 a[224:227], v[148:151], v[48:51], a[224:227]
  ds_read_b128 v[36:39], v6 offset:5120
  v_mfma_f32_16x16x32_bf16 a[228:231], v[148:151], v[52:55], a[228:231]
  v_mfma_f32_16x16x32_bf16 a[232:235], v[148:151], v[56:59], a[232:235]
  ds_read_b64_tr_b16 v[110:111], v8 offset:14336
  s_add_u32 m0, s53, 61440
  v_mfma_f32_16x16x32_bf16 a[236:239], v[148:151], v[60:63], a[236:239]
  v_and_b32 v184, 1, v0
  v_mfma_f32_16x16x32_bf16 a[240:243], v[148:151], v[64:67], a[240:243]
  ds_read_b64_tr_b16 v[112:113], v9 offset:0
  v_mfma_f32_16x16x32_bf16 a[244:247], v[148:151], v[68:71], a[244:247]
  buffer_load_dwordx4 v3, s[28:31], s47 offen lds
  v_mfma_f32_16x16x32_bf16 a[248:251], v[148:151], v[72:75], a[248:251]
  v_add_u32 v186, v186, v184
  ds_read_b128 v[40:43], v6 offset:6144
  v_mfma_f32_16x16x32_bf16 a[252:255], v[148:151], v[76:79], a[252:255]
  v_mfma_f32_16x16x32_bf16 v[192:195], v[152:155], v[48:51], v[192:195]
  ds_read_b64_tr_b16 v[114:115], v9 offset:2048
  s_add_u32 m0, s54, 12288
  v_mfma_f32_16x16x32_bf16 v[196:199], v[152:155], v[52:55], v[196:199]
  v_add_u32 v186, 2, v186
  v_mfma_f32_16x16x32_bf16 v[200:203], v[152:155], v[56:59], v[200:203]
  ds_read_b128 v[44:47], v6 offset:7168
  v_mfma_f32_16x16x32_bf16 v[204:207], v[152:155], v[60:63], v[204:207]
  v_mfma_f32_16x16x32_bf16 v[208:211], v[152:155], v[64:67], v[208:211]
  ds_read_b64_tr_b16 v[116:117], v10 offset:0
  v_mfma_f32_16x16x32_bf16 v[212:215], v[152:155], v[68:71], v[212:215]
  global_load_lds_dwordx4 v[4:5], off
  v_mfma_f32_16x16x32_bf16 v[216:219], v[152:155], v[72:75], v[216:219]
  v_lshlrev_b32 v186, 7, v186
  ds_read_b64_tr_b16 v[118:119], v10 offset:2048
  v_mfma_f32_16x16x32_bf16 v[220:223], v[152:155], v[76:79], v[220:223]
  s_add_u32 s47, s47, s49
  v_mfma_f32_16x16x32_bf16 v[224:227], v[156:159], v[48:51], v[224:227]
  v_add_u32 v186, s66, v186
  v_mfma_f32_16x16x32_bf16 v[228:231], v[156:159], v[52:55], v[228:231]
  v_mfma_f32_16x16x32_bf16 v[232:235], v[156:159], v[56:59], v[232:235]
  v_lshl_add_u64 v[4:5], s[50:51], 0, v[4:5]
  v_mfma_f32_16x16x32_bf16 v[236:239], v[156:159], v[60:63], v[236:239]
  v_mfma_f32_16x16x32_bf16 v[240:243], v[156:159], v[64:67], v[240:243]
  buffer_load_dwordx2 v[184:185], v186, s[72:75], 0 offen sc1
  v_mfma_f32_16x16x32_bf16 v[244:247], v[156:159], v[68:71], v[244:247]
  v_mfma_f32_16x16x32_bf16 v[248:251], v[156:159], v[72:75], v[248:251]
  v_mfma_f32_16x16x32_bf16 v[252:255], v[156:159], v[76:79], v[252:255]
  s_waitcnt vmcnt(15) lgkmcnt(0)
  s_barrier
  v_mfma_f32_16x16x32_bf16 a[128:131], v[96:99], v[16:19], a[128:131]
  ds_read_b128 v[48:51], v6 offset:16384
  v_mfma_f32_16x16x32_bf16 a[132:135], v[96:99], v[20:23], a[132:135]
  s_mov_b32 s45, s44
  v_mfma_f32_16x16x32_bf16 a[136:139], v[96:99], v[24:27], a[136:139]
  ds_read_b64_tr_b16 v[136:137], v7 offset:24576
  s_mov_b32 s46, s43
  v_mfma_f32_16x16x32_bf16 a[140:143], v[96:99], v[28:31], a[140:143]
  v_mfma_f32_16x16x32_bf16 a[144:147], v[96:99], v[32:35], a[144:147]
  ds_read_b128 v[52:55], v6 offset:17408
  s_lshl_b32 s47, s45, 3
  v_mfma_f32_16x16x32_bf16 a[148:151], v[96:99], v[36:39], a[148:151]
  s_add_u32 s47, s47, s46
  v_mfma_f32_16x16x32_bf16 a[152:155], v[96:99], v[40:43], a[152:155]
  ds_read_b64_tr_b16 v[138:139], v7 offset:26624
  v_mfma_f32_16x16x32_bf16 a[156:159], v[96:99], v[44:47], a[156:159]
  s_lshl_b32 s56, s40, 11
  v_mfma_f32_16x16x32_bf16 a[160:163], v[100:103], v[16:19], a[160:163]
  ds_read_b64_tr_b16 v[140:141], v8 offset:24576
  s_add_u32 s52, s56, 81920
  v_mfma_f32_16x16x32_bf16 a[164:167], v[100:103], v[20:23], a[164:167]
  v_mfma_f32_16x16x32_bf16 a[168:171], v[100:103], v[24:27], a[168:171]
  ds_read_b128 v[56:59], v6 offset:18432
  v_lshrrev_b32 v14, 3, v0
  v_mfma_f32_16x16x32_bf16 a[172:175], v[100:103], v[28:31], a[172:175]
  v_and_b32 v15, 6, v14
  v_mfma_f32_16x16x32_bf16 a[176:179], v[100:103], v[32:35], a[176:179]
  ds_read_b64_tr_b16 v[142:143], v8 offset:26624
  v_mfma_f32_16x16x32_bf16 a[180:183], v[100:103], v[36:39], a[180:183]
  v_and_b32 v187, 7, v0
  v_mfma_f32_16x16x32_bf16 a[184:187], v[100:103], v[40:43], a[184:187]
  ds_read_b128 v[60:63], v6 offset:19456
  v_mfma_f32_16x16x32_bf16 a[188:191], v[100:103], v[44:47], a[188:191]
  v_xor_b32 v15, v15, v187
  v_mfma_f32_16x16x32_bf16 a[192:195], v[104:107], v[16:19], a[192:195]
  ds_read_b64_tr_b16 v[144:145], v7 offset:28672
  s_lshl_b32 s56, s40, 4
  v_mfma_f32_16x16x32_bf16 a[196:199], v[104:107], v[20:23], a[196:199]
  v_mfma_f32_16x16x32_bf16 a[200:203], v[104:107], v[24:27], a[200:203]
  ds_read_b64_tr_b16 v[146:147], v7 offset:30720
  v_add_u32 v14, s56, v14
  v_mfma_f32_16x16x32_bf16 a[204:207], v[104:107], v[28:31], a[204:207]
  v_lshlrev_b32 v14, 11, v14
  v_mfma_f32_16x16x32_bf16 a[208:211], v[104:107], v[32:35], a[208:211]
  ds_read_b128 v[64:67], v6 offset:20480
  v_mfma_f32_16x16x32_bf16 a[212:215], v[104:107], v[36:39], a[212:215]
  v_lshlrev_b32 v15, 4, v15
  v_mfma_f32_16x16x32_bf16 a[216:219], v[104:107], v[40:43], a[216:219]
  ds_read_b64_tr_b16 v[148:149], v8 offset:28672
  v_add_u32 v3, v14, v15
  v_mfma_f32_16x16x32_bf16 a[220:223], v[104:107], v[44:47], a[220:223]
  v_mfma_f32_16x16x32_bf16 a[224:227], v[108:111], v[16:19], a[224:227]
  ds_read_b128 v[68:71], v6 offset:21504
  s_mov_b32 s49, 0
  v_mfma_f32_16x16x32_bf16 a[228:231], v[108:111], v[20:23], a[228:231]
  v_mfma_f32_16x16x32_bf16 a[232:235], v[108:111], v[24:27], a[232:235]
  ds_read_b64_tr_b16 v[150:151], v8 offset:30720
  s_mov_b32 s50, 16384
  v_mfma_f32_16x16x32_bf16 a[236:239], v[108:111], v[28:31], a[236:239]
  s_lshl_b32 s58, s46, 8
  v_mfma_f32_16x16x32_bf16 a[240:243], v[108:111], v[32:35], a[240:243]
  ds_read_b64_tr_b16 v[152:153], v9 offset:4096
  v_mfma_f32_16x16x32_bf16 a[244:247], v[108:111], v[36:39], a[244:247]
  s_add_u32 s16, s4, s58
  s_addc_u32 s17, s5, 0
  s_sub_u32 s18, 7340032, s58
  s_mov_b32 s19, 0x20000
  v_mfma_f32_16x16x32_bf16 a[248:251], v[108:111], v[40:43], a[248:251]
  ds_read_b128 v[72:75], v6 offset:22528
  v_mfma_f32_16x16x32_bf16 a[252:255], v[108:111], v[44:47], a[252:255]
  s_add_u32 s20, s16, 128
  s_addc_u32 s21, s17, 0
  s_sub_u32 s22, s18, 128
  s_mov_b32 s23, 0x20000
  v_mfma_f32_16x16x32_bf16 v[192:195], v[112:115], v[16:19], v[192:195]
  ds_read_b64_tr_b16 v[154:155], v9 offset:6144
  s_add_u32 m0, s52, 65536
  v_mfma_f32_16x16x32_bf16 v[196:199], v[112:115], v[20:23], v[196:199]
  buffer_load_dwordx4 v3, s[16:19], s49 offen lds
  v_mfma_f32_16x16x32_bf16 v[200:203], v[112:115], v[24:27], v[200:203]
  ds_read_b128 v[76:79], v6 offset:23552
  v_mfma_f32_16x16x32_bf16 v[204:207], v[112:115], v[28:31], v[204:207]
  s_add_u32 m0, s52, 66560
  v_mfma_f32_16x16x32_bf16 v[208:211], v[112:115], v[32:35], v[208:211]
  ds_read_b64_tr_b16 v[156:157], v10 offset:4096
  v_mfma_f32_16x16x32_bf16 v[212:215], v[112:115], v[36:39], v[212:215]
  buffer_load_dwordx4 v3, s[16:19], s50 offen lds
  v_mfma_f32_16x16x32_bf16 v[216:219], v[112:115], v[40:43], v[216:219]
  ds_read_b64_tr_b16 v[158:159], v10 offset:6144
  s_add_u32 m0, s52, 73728
  v_mfma_f32_16x16x32_bf16 v[220:223], v[112:115], v[44:47], v[220:223]
  v_mfma_f32_16x16x32_bf16 v[224:227], v[116:119], v[16:19], v[224:227]
  buffer_load_dwordx4 v3, s[20:23], s49 offen lds
  v_mfma_f32_16x16x32_bf16 v[228:231], v[116:119], v[20:23], v[228:231]
  s_add_u32 m0, s52, 74752
  v_mfma_f32_16x16x32_bf16 v[232:235], v[116:119], v[24:27], v[232:235]
  v_mfma_f32_16x16x32_bf16 v[236:239], v[116:119], v[28:31], v[236:239]
  buffer_load_dwordx4 v3, s[20:23], s50 offen lds
  v_mfma_f32_16x16x32_bf16 v[240:243], v[116:119], v[32:35], v[240:243]
  s_add_u32 s49, s49, 131072
  v_mfma_f32_16x16x32_bf16 v[244:247], v[116:119], v[36:39], v[244:247]
  v_mfma_f32_16x16x32_bf16 v[248:251], v[116:119], v[40:43], v[248:251]
  s_add_u32 s50, s50, 131072
  v_mfma_f32_16x16x32_bf16 v[252:255], v[116:119], v[44:47], v[252:255]
  s_waitcnt vmcnt(12) lgkmcnt(0)
  s_barrier
  v_mfma_f32_16x16x32_bf16 a[128:131], v[136:139], v[48:51], a[128:131]
  ds_read_b128 v[16:19], v6 offset:32768
  v_mfma_f32_16x16x32_bf16 a[132:135], v[136:139], v[52:55], a[132:135]
  s_add_u32 m0, s52, 0
  v_mfma_f32_16x16x32_bf16 a[136:139], v[136:139], v[56:59], a[136:139]
  ds_read_b64_tr_b16 v[96:97], v7 offset:40960
  v_mfma_f32_16x16x32_bf16 a[140:143], v[136:139], v[60:63], a[140:143]
  buffer_load_dwordx4 v3, s[16:19], s49 offen lds
  v_mfma_f32_16x16x32_bf16 a[144:147], v[136:139], v[64:67], a[144:147]
  ds_read_b128 v[20:23], v6 offset:33792
  v_mfma_f32_16x16x32_bf16 a[148:151], v[136:139], v[68:71], a[148:151]
  v_mfma_f32_16x16x32_bf16 a[152:155], v[136:139], v[72:75], a[152:155]
  ds_read_b64_tr_b16 v[98:99], v7 offset:43008
  s_add_u32 m0, s52, 1024
  v_mfma_f32_16x16x32_bf16 a[156:159], v[136:139], v[76:79], a[156:159]
  v_mfma_f32_16x16x32_bf16 a[160:163], v[140:143], v[48:51], a[160:163]
  ds_read_b64_tr_b16 v[100:101], v8 offset:40960
  v_mfma_f32_16x16x32_bf16 a[164:167], v[140:143], v[52:55], a[164:167]
  buffer_load_dwordx4 v3, s[16:19], s50 offen lds
  v_mfma_f32_16x16x32_bf16 a[168:171], v[140:143], v[56:59], a[168:171]
  ds_read_b128 v[24:27], v6 offset:34816
  v_mfma_f32_16x16x32_bf16 a[172:175], v[140:143], v[60:63], a[172:175]
  v_mfma_f32_16x16x32_bf16 a[176:179], v[140:143], v[64:67], a[176:179]
  ds_read_b64_tr_b16 v[102:103], v8 offset:43008
  s_add_u32 m0, s52, 8192
  v_mfma_f32_16x16x32_bf16 a[180:183], v[140:143], v[68:71], a[180:183]
  v_mfma_f32_16x16x32_bf16 a[184:187], v[140:143], v[72:75], a[184:187]
  ds_read_b128 v[28:31], v6 offset:35840
  v_mfma_f32_16x16x32_bf16 a[188:191], v[140:143], v[76:79], a[188:191]
  buffer_load_dwordx4 v3, s[20:23], s49 offen lds
  v_mfma_f32_16x16x32_bf16 a[192:195], v[144:147], v[48:51], a[192:195]
  ds_read_b64_tr_b16 v[104:105], v7 offset:45056
  v_mfma_f32_16x16x32_bf16 a[196:199], v[144:147], v[52:55], a[196:199]
  v_mfma_f32_16x16x32_bf16 a[200:203], v[144:147], v[56:59], a[200:203]
  ds_read_b64_tr_b16 v[106:107], v7 offset:47104
  s_add_u32 m0, s52, 9216
  v_mfma_f32_16x16x32_bf16 a[204:207], v[144:147], v[60:63], a[204:207]
  v_mfma_f32_16x16x32_bf16 a[208:211], v[144:147], v[64:67], a[208:211]
  ds_read_b128 v[32:35], v6 offset:36864
  v_mfma_f32_16x16x32_bf16 a[212:215], v[144:147], v[68:71], a[212:215]
  buffer_load_dwordx4 v3, s[20:23], s50 offen lds
  v_mfma_f32_16x16x32_bf16 a[216:219], v[144:147], v[72:75], a[216:219]
  ds_read_b64_tr_b16 v[108:109], v8 offset:45056
  v_mfma_f32_16x16x32_bf16 a[220:223], v[144:147], v[76:79], a[220:223]
  v_mfma_f32_16x16x32_bf16 a[224:227], v[148:151], v[48:51], a[224:227]
  ds_read_b128 v[36:39], v6 offset:37888
  s_add_u32 s49, s49, 131072
  v_mfma_f32_16x16x32_bf16 a[228:231], v[148:151], v[52:55], a[228:231]
  v_mfma_f32_16x16x32_bf16 a[232:235], v[148:151], v[56:59], a[232:235]
  ds_read_b64_tr_b16 v[110:111], v8 offset:47104
  v_mfma_f32_16x16x32_bf16 a[236:239], v[148:151], v[60:63], a[236:239]
  s_add_u32 s50, s50, 131072
  v_mfma_f32_16x16x32_bf16 a[240:243], v[148:151], v[64:67], a[240:243]
  ds_read_b64_tr_b16 v[112:113], v9 offset:8192
  v_mfma_f32_16x16x32_bf16 a[244:247], v[148:151], v[68:71], a[244:247]
  v_mfma_f32_16x16x32_bf16 a[248:251], v[148:151], v[72:75], a[248:251]
  ds_read_b128 v[40:43], v6 offset:38912
  s_mul_i32 s64, s45, 917504
  v_mfma_f32_16x16x32_bf16 a[252:255], v[148:151], v[76:79], a[252:255]
  v_mfma_f32_16x16x32_bf16 v[192:195], v[152:155], v[48:51], v[192:195]
  ds_read_b64_tr_b16 v[114:115], v9 offset:10240
  v_mfma_f32_16x16x32_bf16 v[196:199], v[152:155], v[52:55], v[196:199]
  s_add_u32 s64, s64, 16777216
  v_mfma_f32_16x16x32_bf16 v[200:203], v[152:155], v[56:59], v[200:203]
  ds_read_b128 v[44:47], v6 offset:39936
  v_mfma_f32_16x16x32_bf16 v[204:207], v[152:155], v[60:63], v[204:207]
  v_mfma_f32_16x16x32_bf16 v[208:211], v[152:155], v[64:67], v[208:211]
  ds_read_b64_tr_b16 v[116:117], v10 offset:8192
  v_mfma_f32_16x16x32_bf16 v[212:215], v[152:155], v[68:71], v[212:215]
  s_add_u32 s12, s6, s64
  s_addc_u32 s13, s7, 0
  s_mov_b32 s14, 917504
  s_mov_b32 s15, 0x20000
  v_mfma_f32_16x16x32_bf16 v[216:219], v[152:155], v[72:75], v[216:219]
  ds_read_b64_tr_b16 v[118:119], v10 offset:10240
  v_mfma_f32_16x16x32_bf16 v[220:223], v[152:155], v[76:79], v[220:223]
  s_lshl_b32 s51, s40, 12
  v_mfma_f32_16x16x32_bf16 v[224:227], v[156:159], v[48:51], v[224:227]
  v_mfma_f32_16x16x32_bf16 v[228:231], v[156:159], v[52:55], v[228:231]
  v_mfma_f32_16x16x32_bf16 v[232:235], v[156:159], v[56:59], v[232:235]
  v_add_u32 v2, s51, v1
  v_mfma_f32_16x16x32_bf16 v[236:239], v[156:159], v[60:63], v[236:239]
  v_mfma_f32_16x16x32_bf16 v[240:243], v[156:159], v[64:67], v[240:243]
  v_mfma_f32_16x16x32_bf16 v[244:247], v[156:159], v[68:71], v[244:247]
  s_mov_b32 s48, 0
  v_mfma_f32_16x16x32_bf16 v[248:251], v[156:159], v[72:75], v[248:251]
  v_mfma_f32_16x16x32_bf16 v[252:255], v[156:159], v[76:79], v[252:255]
  s_waitcnt vmcnt(8) lgkmcnt(0)
  s_barrier
  s_mov_b32 s67, 0
chk_18:
  v_cmp_eq_u32 vcc, s76, v184
  v_cmp_eq_u32 s[68:69], s77, v185
  s_nop 1
  s_and_b64 vcc, vcc, s[68:69]
  s_cmp_eq_u64 vcc, exec
  s_cbranch_scc1 chk_18_ok
  s_add_u32 s67, s67, 1
  s_cmp_ge_u32 s67, 0x40000
  s_cbranch_scc1 chk_18_ok
  s_sleep 1
  buffer_load_dwordx2 v[184:185], v186, s[72:75], 0 offen sc1
  s_waitcnt vmcnt(0)
  s_branch chk_18
chk_18_ok:
  v_mfma_f32_16x16x32_bf16 a[128:131], v[96:99], v[16:19], a[128:131]
  ds_read_b128 v[48:51], v6 offset:49152
  v_mfma_f32_16x16x32_bf16 a[132:135], v[96:99], v[20:23], a[132:135]
  s_add_u32 m0, s51, 0
  v_mfma_f32_16x16x32_bf16 a[136:139], v[96:99], v[24:27], a[136:139]
  ds_read_b64_tr_b16 v[136:137], v7 offset:57344
  v_mfma_f32_16x16x32_bf16 a[140:143], v[96:99], v[28:31], a[140:143]
  buffer_load_dwordx4 v2, s[12:15], s48 offen offset:0 sc1 lds
  v_mfma_f32_16x16x32_bf16 a[144:147], v[96:99], v[32:35], a[144:147]
  ds_read_b128 v[52:55], v6 offset:50176
  v_mfma_f32_16x16x32_bf16 a[148:151], v[96:99], v[36:39], a[148:151]
  buffer_load_dwordx4 v2, s[12:15], s48 offen offset:1024 sc1 lds
  v_mfma_f32_16x16x32_bf16 a[152:155], v[96:99], v[40:43], a[152:155]
  ds_read_b64_tr_b16 v[138:139], v7 offset:59392
  v_mfma_f32_16x16x32_bf16 a[156:159], v[96:99], v[44:47], a[156:159]
  buffer_load_dwordx4 v2, s[12:15], s48 offen offset:2048 sc1 lds
  v_mfma_f32_16x16x32_bf16 a[160:163], v[100:103], v[16:19], a[160:163]
  ds_read_b64_tr_b16 v[140:141], v8 offset:57344
  v_mfma_f32_16x16x32_bf16 a[164:167], v[100:103], v[20:23], a[164:167]
  buffer_load_dwordx4 v2, s[12:15], s48 offen offset:3072 sc1 lds
  v_mfma_f32_16x16x32_bf16 a[168:171], v[100:103], v[24:27], a[168:171]
  ds_read_b128 v[56:59], v6 offset:51200
  v_mfma_f32_16x16x32_bf16 a[172:175], v[100:103], v[28:31], a[172:175]
  s_add_u32 s48, s48, 16384
  v_mfma_f32_16x16x32_bf16 a[176:179], v[100:103], v[32:35], a[176:179]
  ds_read_b64_tr_b16 v[142:143], v8 offset:59392
  v_mfma_f32_16x16x32_bf16 a[180:183], v[100:103], v[36:39], a[180:183]
  s_add_u32 m0, s52, 16384
  v_mfma_f32_16x16x32_bf16 a[184:187], v[100:103], v[40:43], a[184:187]
  ds_read_b128 v[60:63], v6 offset:52224
  v_mfma_f32_16x16x32_bf16 a[188:191], v[100:103], v[44:47], a[188:191]
  buffer_load_dwordx4 v3, s[16:19], s49 offen lds
  v_mfma_f32_16x16x32_bf16 a[192:195], v[104:107], v[16:19], a[192:195]
  ds_read_b64_tr_b16 v[144:145], v7 offset:61440
  v_mfma_f32_16x16x32_bf16 a[196:199], v[104:107], v[20:23], a[196:199]
  v_mfma_f32_16x16x32_bf16 a[200:203], v[104:107], v[24:27], a[200:203]
  ds_read_b64_tr_b16 v[146:147], v7 offset:63488
  s_add_u32 m0, s52, 17408
  v_mfma_f32_16x16x32_bf16 a[204:207], v[104:107], v[28:31], a[204:207]
  v_mfma_f32_16x16x32_bf16 a[208:211], v[104:107], v[32:35], a[208:211]
  ds_read_b128 v[64:67], v6 offset:53248
  v_mfma_f32_16x16x32_bf16 a[212:215], v[104:107], v[36:39], a[212:215]
  buffer_load_dwordx4 v3, s[16:19], s50 offen lds
  v_mfma_f32_16x16x32_bf16 a[216:219], v[104:107], v[40:43], a[216:219]
  ds_read_b64_tr_b16 v[148:149], v8 offset:61440
  s_add_u32 m0, s52, 24576
  v_mfma_f32_16x16x32_bf16 a[220:223], v[104:107], v[44:47], a[220:223]
  v_mfma_f32_16x16x32_bf16 a[224:227], v[108:111], v[16:19], a[224:227]
  ds_read_b128 v[68:71], v6 offset:54272
  v_mfma_f32_16x16x32_bf16 a[228:231], v[108:111], v[20:23], a[228:231]
  buffer_load_dwordx4 v3, s[20:23], s49 offen lds
  v_mfma_f32_16x16x32_bf16 a[232:235], v[108:111], v[24:27], a[232:235]
  ds_read_b64_tr_b16 v[150:151], v8 offset:63488
  s_add_u32 m0, s52, 25600
  v_mfma_f32_16x16x32_bf16 a[236:239], v[108:111], v[28:31], a[236:239]
  v_mfma_f32_16x16x32_bf16 a[240:243], v[108:111], v[32:35], a[240:243]
  ds_read_b64_tr_b16 v[152:153], v9 offset:12288
  v_mfma_f32_16x16x32_bf16 a[244:247], v[108:111], v[36:39], a[244:247]
  buffer_load_dwordx4 v3, s[20:23], s50 offen lds
  v_mfma_f32_16x16x32_bf16 a[248:251], v[108:111], v[40:43], a[248:251]
  ds_read_b128 v[72:75], v6 offset:55296
  s_add_u32 s49, s49, 131072
  v_mfma_f32_16x16x32_bf16 a[252:255], v[108:111], v[44:47], a[252:255]
  v_mfma_f32_16x16x32_bf16 v[192:195], v[112:115], v[16:19], v[192:195]
  ds_read_b64_tr_b16 v[154:155], v9 offset:14336
  v_mfma_f32_16x16x32_bf16 v[196:199], v[112:115], v[20:23], v[196:199]
  s_add_u32 s50, s50, 131072
  v_mfma_f32_16x16x32_bf16 v[200:203], v[112:115], v[24:27], v[200:203]
  ds_read_b128 v[76:79], v6 offset:56320
  v_mfma_f32_16x16x32_bf16 v[204:207], v[112:115], v[28:31], v[204:207]
  s_add_u32 m0, s51, 16384
  v_mfma_f32_16x16x32_bf16 v[208:211], v[112:115], v[32:35], v[208:211]
  ds_read_b64_tr_b16 v[156:157], v10 offset:12288
  v_mfma_f32_16x16x32_bf16 v[212:215], v[112:115], v[36:39], v[212:215]
  buffer_load_dwordx4 v2, s[12:15], s48 offen offset:0 sc1 lds
  v_mfma_f32_16x16x32_bf16 v[216:219], v[112:115], v[40:43], v[216:219]
  ds_read_b64_tr_b16 v[158:159], v10 offset:14336
  v_mfma_f32_16x16x32_bf16 v[220:223], v[112:115], v[44:47], v[220:223]
  buffer_load_dwordx4 v2, s[12:15], s48 offen offset:1024 sc1 lds
  v_mfma_f32_16x16x32_bf16 v[224:227], v[116:119], v[16:19], v[224:227]
  v_mfma_f32_16x16x32_bf16 v[228:231], v[116:119], v[20:23], v[228:231]
  buffer_load_dwordx4 v2, s[12:15], s48 offen offset:2048 sc1 lds
  v_mfma_f32_16x16x32_bf16 v[232:235], v[116:119], v[24:27], v[232:235]
  v_mfma_f32_16x16x32_bf16 v[236:239], v[116:119], v[28:31], v[236:239]
  buffer_load_dwordx4 v2, s[12:15], s48 offen offset:3072 sc1 lds
  v_mfma_f32_16x16x32_bf16 v[240:243], v[116:119], v[32:35], v[240:243]
  v_mfma_f32_16x16x32_bf16 v[244:247], v[116:119], v[36:39], v[244:247]
  s_add_u32 s48, s48, 16384
  v_mfma_f32_16x16x32_bf16 v[248:251], v[116:119], v[40:43], v[248:251]
  v_mfma_f32_16x16x32_bf16 v[252:255], v[116:119], v[44:47], v[252:255]
  s_waitcnt lgkmcnt(0)
  s_barrier
  v_mfma_f32_16x16x32_bf16 a[128:131], v[136:139], v[48:51], a[128:131]
  v_mfma_f32_16x16x32_bf16 a[132:135], v[136:139], v[52:55], a[132:135]
  s_add_u32 m0, s51, 32768
  v_mfma_f32_16x16x32_bf16 a[136:139], v[136:139], v[56:59], a[136:139]
  buffer_load_dwordx4 v2, s[12:15], s48 offen offset:0 sc1 lds
  v_mfma_f32_16x16x32_bf16 a[140:143], v[136:139], v[60:63], a[140:143]
  buffer_load_dwordx4 v2, s[12:15], s48 offen offset:1024 sc1 lds
  v_mfma_f32_16x16x32_bf16 a[144:147], v[136:139], v[64:67], a[144:147]
  buffer_load_dwordx4 v2, s[12:15], s48 offen offset:2048 sc1 lds
  v_mfma_f32_16x16x32_bf16 a[148:151], v[136:139], v[68:71], a[148:151]
  buffer_load_dwordx4 v2, s[12:15], s48 offen offset:3072 sc1 lds
  v_mfma_f32_16x16x32_bf16 a[152:155], v[136:139], v[72:75], a[152:155]
  s_add_u32 s48, s48, 16384
  s_add_u32 m0, s52, 32768
  v_mfma_f32_16x16x32_bf16 a[156:159], v[136:139], v[76:79], a[156:159]
  buffer_load_dwordx4 v3, s[16:19], s49 offen lds
  v_mfma_f32_16x16x32_bf16 a[160:163], v[140:143], v[48:51], a[160:163]
  s_add_u32 m0, s52, 33792
  v_mfma_f32_16x16x32_bf16 a[164:167], v[140:143], v[52:55], a[164:167]
  buffer_load_dwordx4 v3, s[16:19], s50 offen lds
  v_mfma_f32_16x16x32_bf16 a[168:171], v[140:143], v[56:59], a[168:171]
  s_add_u32 m0, s52, 40960
  v_mfma_f32_16x16x32_bf16 a[172:175], v[140:143], v[60:63], a[172:175]
  buffer_load_dwordx4 v3, s[20:23], s49 offen lds
  v_mfma_f32_16x16x32_bf16 a[176:179], v[140:143], v[64:67], a[176:179]
  s_add_u32 m0, s52, 41984
  v_mfma_f32_16x16x32_bf16 a[180:183], v[140:143], v[68:71], a[180:183]
  buffer_load_dwordx4 v3, s[20:23], s50 offen lds
  v_mfma_f32_16x16x32_bf16 a[184:187], v[140:143], v[72:75], a[184:187]
  s_add_u32 s49, s49, 131072
  s_add_u32 s50, s50, 131072
  v_mfma_f32_16x16x32_bf16 a[188:191], v[140:143], v[76:79], a[188:191]
  s_add_u32 m0, s51, 49152
  v_mfma_f32_16x16x32_bf16 a[192:195], v[144:147], v[48:51], a[192:195]
  buffer_load_dwordx4 v2, s[12:15], s48 offen offset:0 sc1 lds
  v_mfma_f32_16x16x32_bf16 a[196:199], v[144:147], v[52:55], a[196:199]
  buffer_load_dwordx4 v2, s[12:15], s48 offen offset:1024 sc1 lds
  v_mfma_f32_16x16x32_bf16 a[200:203], v[144:147], v[56:59], a[200:203]
  buffer_load_dwordx4 v2, s[12:15], s48 offen offset:2048 sc1 lds
  v_mfma_f32_16x16x32_bf16 a[204:207], v[144:147], v[60:63], a[204:207]
  buffer_load_dwordx4 v2, s[12:15], s48 offen offset:3072 sc1 lds
  v_mfma_f32_16x16x32_bf16 a[208:211], v[144:147], v[64:67], a[208:211]
  s_add_u32 s48, s48, 16384
  s_add_u32 m0, s52, 49152
  v_mfma_f32_16x16x32_bf16 a[212:215], v[144:147], v[68:71], a[212:215]
  buffer_load_dwordx4 v3, s[16:19], s49 offen lds
  v_mfma_f32_16x16x32_bf16 a[216:219], v[144:147], v[72:75], a[216:219]
  s_add_u32 m0, s52, 50176
  v_mfma_f32_16x16x32_bf16 a[220:223], v[144:147], v[76:79], a[220:223]
  buffer_load_dwordx4 v3, s[16:19], s50 offen lds
  v_mfma_f32_16x16x32_bf16 a[224:227], v[148:151], v[48:51], a[224:227]
  s_add_u32 m0, s52, 57344
  v_mfma_f32_16x16x32_bf16 a[228:231], v[148:151], v[52:55], a[228:231]
  buffer_load_dwordx4 v3, s[20:23], s49 offen lds
  v_mfma_f32_16x16x32_bf16 a[232:235], v[148:151], v[56:59], a[232:235]
  s_add_u32 m0, s52, 58368
  v_mfma_f32_16x16x32_bf16 a[236:239], v[148:151], v[60:63], a[236:239]
  buffer_load_dwordx4 v3, s[20:23], s50 offen lds
  v_mfma_f32_16x16x32_bf16 a[240:243], v[148:151], v[64:67], a[240:243]
  s_add_u32 s49, s49, 131072
  s_add_u32 s50, s50, 131072
  v_mfma_f32_16x16x32_bf16 a[244:247], v[148:151], v[68:71], a[244:247]
  s_add_u32 m0, s51, 65536
  v_mfma_f32_16x16x32_bf16 a[248:251], v[148:151], v[72:75], a[248:251]
  buffer_load_dwordx4 v2, s[12:15], s48 offen offset:0 sc1 lds
  v_mfma_f32_16x16x32_bf16 a[252:255], v[148:151], v[76:79], a[252:255]
  buffer_load_dwordx4 v2, s[12:15], s48 offen offset:1024 sc1 lds
  v_mfma_f32_16x16x32_bf16 v[192:195], v[152:155], v[48:51], v[192:195]
  buffer_load_dwordx4 v2, s[12:15], s48 offen offset:2048 sc1 lds
  v_mfma_f32_16x16x32_bf16 v[196:199], v[152:155], v[52:55], v[196:199]
  buffer_load_dwordx4 v2, s[12:15], s48 offen offset:3072 sc1 lds
  v_mfma_f32_16x16x32_bf16 v[200:203], v[152:155], v[56:59], v[200:203]
  s_add_u32 s48, s48, 16384
  s_lshl_b32 s56, s41, 12
  v_mfma_f32_16x16x32_bf16 v[204:207], v[152:155], v[60:63], v[204:207]
  v_add_u32 v4, s56, v1
  v_add_u32 v5, 0x10000, v4
  v_mfma_f32_16x16x32_bf16 v[208:211], v[152:155], v[64:67], v[208:211]
  v_lshrrev_b32 v14, 2, v0
  v_and_b32 v15, 6, v14
  v_mfma_f32_16x16x32_bf16 v[212:215], v[152:155], v[68:71], v[212:215]
  v_lshlrev_b32 v14, 7, v14
  v_bfe_u32 v187, v0, 1, 1
  v_mfma_f32_16x16x32_bf16 v[216:219], v[152:155], v[72:75], v[216:219]
  v_lshlrev_b32 v187, 4, v187
  v_add_u32 v14, v14, v187
  v_mfma_f32_16x16x32_bf16 v[220:223], v[152:155], v[76:79], v[220:223]
  v_and_b32 v187, 1, v0
  v_lshlrev_b32 v187, 3, v187
  v_mfma_f32_16x16x32_bf16 v[224:227], v[156:159], v[48:51], v[224:227]
  v_add_u32 v14, v14, v187
  s_lshl_b32 s56, s42, 13
  v_mfma_f32_16x16x32_bf16 v[228:231], v[156:159], v[52:55], v[228:231]
  s_add_u32 s56, s56, 81920
  v_xor_b32 v187, 0, v15
  v_mfma_f32_16x16x32_bf16 v[232:235], v[156:159], v[56:59], v[232:235]
  v_lshlrev_b32 v187, 4, v187
  v_add_u32 v187, v187, v14
  v_mfma_f32_16x16x32_bf16 v[236:239], v[156:159], v[60:63], v[236:239]
  v_add_u32 v6, s56, v187
  v_add_u32 v10, 0x10000, v6
  v_mfma_f32_16x16x32_bf16 v[240:243], v[156:159], v[64:67], v[240:243]
  v_xor_b32 v187, 2, v15
  v_lshlrev_b32 v187, 4, v187
  v_mfma_f32_16x16x32_bf16 v[244:247], v[156:159], v[68:71], v[244:247]
  v_add_u32 v187, v187, v14
  v_add_u32 v7, s56, v187
  v_mfma_f32_16x16x32_bf16 v[248:251], v[156:159], v[72:75], v[248:251]
  v_add_u32 v11, 0x10000, v7
  v_xor_b32 v187, 4, v15
  v_mfma_f32_16x16x32_bf16 v[252:255], v[156:159], v[76:79], v[252:255]
  v_lshlrev_b32 v187, 4, v187
  v_add_u32 v187, v187, v14
  v_add_u32 v8, s56, v187
  v_add_u32 v12, 0x10000, v8
  v_xor_b32 v187, 6, v15
  v_lshlrev_b32 v187, 4, v187
  v_add_u32 v187, v187, v14
  v_add_u32 v9, s56, v187
  v_add_u32 v13, 0x10000, v9
  s_nop 7
  s_lshl_b32 s60, s43, 4
  s_lshl_b32 s61, s41, 3
  s_add_u32 s60, s60, s61
  s_add_u32 s32, s6, 16777216
  s_addc_u32 s33, s7, 0
  s_mov_b32 s34, 14680064
  s_mov_b32 s35, 0x20000
  s_lshl_b32 s58, s42, 3
  v_add_u32 v189, s58, v1
  s_mul_i32 s63, s44, 3
  s_add_u32 s63, s63, 32
  s_and_b32 s58, s44, 1
  s_add_u32 s62, s63, s58
  s_add_u32 s62, s62, s42
  s_xor_b32 s58, s58, 1
  s_lshl_b32 s58, s58, 1
  s_add_u32 s63, s63, s58
  s_lshr_b32 s56, s60, 3
  s_mul_i32 s56, s56, 112
  s_add_u32 s56, s56, s62
  s_lshl_b32 s56, s56, 13
  s_add_u32 s57, s56, 4096
  v_accvgpr_read_b32 v164, a128
  v_accvgpr_read_b32 v168, a192
  v_accvgpr_read_b32 v165, a129
  v_accvgpr_read_b32 v169, a193
  v_accvgpr_read_b32 v166, a130
  v_accvgpr_read_b32 v170, a194
  v_accvgpr_read_b32 v167, a131
  v_accvgpr_read_b32 v171, a195
  v_mul_f32 v164, v164, v168
  v_mul_f32 v165, v165, v169
  v_mul_f32 v166, v166, v170
  v_mul_f32 v167, v167, v171
  v_cvt_pk_bf16_f32 v160, v164, v165
  v_cvt_pk_bf16_f32 v161, v166, v167
  v_accvgpr_read_b32 v164, a160
  v_accvgpr_read_b32 v168, a224
  v_accvgpr_read_b32 v165, a161
  v_accvgpr_read_b32 v169, a225
  v_accvgpr_read_b32 v166, a162
  v_accvgpr_read_b32 v170, a226
  v_accvgpr_read_b32 v167, a163
  v_accvgpr_read_b32 v171, a227
  v_mul_f32 v164, v164, v168
  v_mul_f32 v165, v165, v169
  v_mul_f32 v166, v166, v170
  v_mul_f32 v167, v167, v171
  v_cvt_pk_bf16_f32 v162, v164, v165
  v_cvt_pk_bf16_f32 v163, v166, v167
  buffer_store_dwordx4 v[160:163], v1, s[32:35], s56 offen offset:0 sc1
  v_accvgpr_read_b32 v176, a132
  v_accvgpr_read_b32 v180, a196
  v_accvgpr_read_b32 v177, a133
  v_accvgpr_read_b32 v181, a197
  v_accvgpr_read_b32 v178, a134
  v_accvgpr_read_b32 v182, a198
  v_accvgpr_read_b32 v179, a135
  v_accvgpr_read_b32 v183, a199
  v_mul_f32 v176, v176, v180
  v_mul_f32 v177, v177, v181
  v_mul_f32 v178, v178, v182
  v_mul_f32 v179, v179, v183
  v_cvt_pk_bf16_f32 v172, v176, v177
  v_cvt_pk_bf16_f32 v173, v178, v179
  v_accvgpr_read_b32 v176, a164
  v_accvgpr_read_b32 v180, a228
  v_accvgpr_read_b32 v177, a165
  v_accvgpr_read_b32 v181, a229
  v_accvgpr_read_b32 v178, a166
  v_accvgpr_read_b32 v182, a230
  v_accvgpr_read_b32 v179, a167
  v_accvgpr_read_b32 v183, a231
  v_mul_f32 v176, v176, v180
  v_mul_f32 v177, v177, v181
  v_mul_f32 v178, v178, v182
  v_mul_f32 v179, v179, v183
  v_cvt_pk_bf16_f32 v174, v176, v177
  v_cvt_pk_bf16_f32 v175, v178, v179
  buffer_store_dwordx4 v[172:175], v1, s[32:35], s56 offen offset:1024 sc1
  v_accvgpr_read_b32 v164, a136
  v_accvgpr_read_b32 v168, a200
  v_accvgpr_read_b32 v165, a137
  v_accvgpr_read_b32 v169, a201
  v_accvgpr_read_b32 v166, a138
  v_accvgpr_read_b32 v170, a202
  v_accvgpr_read_b32 v167, a139
  v_accvgpr_read_b32 v171, a203
  v_mul_f32 v164, v164, v168
  v_mul_f32 v165, v165, v169
  v_mul_f32 v166, v166, v170
  v_mul_f32 v167, v167, v171
  v_cvt_pk_bf16_f32 v160, v164, v165
  v_cvt_pk_bf16_f32 v161, v166, v167
  v_accvgpr_read_b32 v164, a168
  v_accvgpr_read_b32 v168, a232
  v_accvgpr_read_b32 v165, a169
  v_accvgpr_read_b32 v169, a233
  v_accvgpr_read_b32 v166, a170
  v_accvgpr_read_b32 v170, a234
  v_accvgpr_read_b32 v167, a171
  v_accvgpr_read_b32 v171, a235
  v_mul_f32 v164, v164, v168
  v_mul_f32 v165, v165, v169
  v_mul_f32 v166, v166, v170
  v_mul_f32 v167, v167, v171
  v_cvt_pk_bf16_f32 v162, v164, v165
  v_cvt_pk_bf16_f32 v163, v166, v167
  buffer_store_dwordx4 v[160:163], v1, s[32:35], s56 offen offset:2048 sc1
  v_accvgpr_read_b32 v176, a140
  v_accvgpr_read_b32 v180, a204
  v_accvgpr_read_b32 v177, a141
  v_accvgpr_read_b32 v181, a205
  v_accvgpr_read_b32 v178, a142
  v_accvgpr_read_b32 v182, a206
  v_accvgpr_read_b32 v179, a143
  v_accvgpr_read_b32 v183, a207
  v_mul_f32 v176, v176, v180
  v_mul_f32 v177, v177, v181
  v_mul_f32 v178, v178, v182
  v_mul_f32 v179, v179, v183
  v_cvt_pk_bf16_f32 v172, v176, v177
  v_cvt_pk_bf16_f32 v173, v178, v179
  v_accvgpr_read_b32 v176, a172
  v_accvgpr_read_b32 v180, a236
  v_accvgpr_read_b32 v177, a173
  v_accvgpr_read_b32 v181, a237
  v_accvgpr_read_b32 v178, a174
  v_accvgpr_read_b32 v182, a238
  v_accvgpr_read_b32 v179, a175
  v_accvgpr_read_b32 v183, a239
  v_mul_f32 v176, v176, v180
  v_mul_f32 v177, v177, v181
  v_mul_f32 v178, v178, v182
  v_mul_f32 v179, v179, v183
  v_cvt_pk_bf16_f32 v174, v176, v177
  v_cvt_pk_bf16_f32 v175, v178, v179
  buffer_store_dwordx4 v[172:175], v1, s[32:35], s56 offen offset:3072 sc1
  v_accvgpr_read_b32 v164, a144
  v_accvgpr_read_b32 v168, a208
  v_accvgpr_read_b32 v165, a145
  v_accvgpr_read_b32 v169, a209
  v_accvgpr_read_b32 v166, a146
  v_accvgpr_read_b32 v170, a210
  v_accvgpr_read_b32 v167, a147
  v_accvgpr_read_b32 v171, a211
  v_mul_f32 v164, v164, v168
  v_mul_f32 v165, v165, v169
  v_mul_f32 v166, v166, v170
  v_mul_f32 v167, v167, v171
  v_cvt_pk_bf16_f32 v160, v164, v165
  v_cvt_pk_bf16_f32 v161, v166, v167
  v_accvgpr_read_b32 v164, a176
  v_accvgpr_read_b32 v168, a240
  v_accvgpr_read_b32 v165, a177
  v_accvgpr_read_b32 v169, a241
  v_accvgpr_read_b32 v166, a178
  v_accvgpr_read_b32 v170, a242
  v_accvgpr_read_b32 v167, a179
  v_accvgpr_read_b32 v171, a243
  v_mul_f32 v164, v164, v168
  v_mul_f32 v165, v165, v169
  v_mul_f32 v166, v166, v170
  v_mul_f32 v167, v167, v171
  v_cvt_pk_bf16_f32 v162, v164, v165
  v_cvt_pk_bf16_f32 v163, v166, v167
  buffer_store_dwordx4 v[160:163], v1, s[32:35], s57 offen offset:0 sc1
  v_accvgpr_read_b32 v176, a148
  v_accvgpr_read_b32 v180, a212
  v_accvgpr_read_b32 v177, a149
  v_accvgpr_read_b32 v181, a213
  v_accvgpr_read_b32 v178, a150
  v_accvgpr_read_b32 v182, a214
  v_accvgpr_read_b32 v179, a151
  v_accvgpr_read_b32 v183, a215
  v_mul_f32 v176, v176, v180
  v_mul_f32 v177, v177, v181
  v_mul_f32 v178, v178, v182
  v_mul_f32 v179, v179, v183
  v_cvt_pk_bf16_f32 v172, v176, v177
  v_cvt_pk_bf16_f32 v173, v178, v179
  v_accvgpr_read_b32 v176, a180
  v_accvgpr_read_b32 v180, a244
  v_accvgpr_read_b32 v177, a181
  v_accvgpr_read_b32 v181, a245
  v_accvgpr_read_b32 v178, a182
  v_accvgpr_read_b32 v182, a246
  v_accvgpr_read_b32 v179, a183
  v_accvgpr_read_b32 v183, a247
  v_mul_f32 v176, v176, v180
  v_mul_f32 v177, v177, v181
  v_mul_f32 v178, v178, v182
  v_mul_f32 v179, v179, v183
  v_cvt_pk_bf16_f32 v174, v176, v177
  v_cvt_pk_bf16_f32 v175, v178, v179
  buffer_store_dwordx4 v[172:175], v1, s[32:35], s57 offen offset:1024 sc1
  v_accvgpr_read_b32 v164, a152
  v_accvgpr_read_b32 v168, a216
  v_accvgpr_read_b32 v165, a153
  v_accvgpr_read_b32 v169, a217
  v_accvgpr_read_b32 v166, a154
  v_accvgpr_read_b32 v170, a218
  v_accvgpr_read_b32 v167, a155
  v_accvgpr_read_b32 v171, a219
  v_mul_f32 v164, v164, v168
  v_mul_f32 v165, v165, v169
  v_mul_f32 v166, v166, v170
  v_mul_f32 v167, v167, v171
  v_cvt_pk_bf16_f32 v160, v164, v165
  v_cvt_pk_bf16_f32 v161, v166, v167
  v_accvgpr_read_b32 v164, a184
  v_accvgpr_read_b32 v168, a248
  v_accvgpr_read_b32 v165, a185
  v_accvgpr_read_b32 v169, a249
  v_accvgpr_read_b32 v166, a186
  v_accvgpr_read_b32 v170, a250
  v_accvgpr_read_b32 v167, a187
  v_accvgpr_read_b32 v171, a251
  v_mul_f32 v164, v164, v168
  v_mul_f32 v165, v165, v169
  v_mul_f32 v166, v166, v170
  v_mul_f32 v167, v167, v171
  v_cvt_pk_bf16_f32 v162, v164, v165
  v_cvt_pk_bf16_f32 v163, v166, v167
  buffer_store_dwordx4 v[160:163], v1, s[32:35], s57 offen offset:2048 sc1
  v_accvgpr_read_b32 v176, a156
  v_accvgpr_read_b32 v180, a220
  v_accvgpr_read_b32 v177, a157
  v_accvgpr_read_b32 v181, a221
  v_accvgpr_read_b32 v178, a158
  v_accvgpr_read_b32 v182, a222
  v_accvgpr_read_b32 v179, a159
  v_accvgpr_read_b32 v183, a223
  v_mul_f32 v176, v176, v180
  v_mul_f32 v177, v177, v181
  v_mul_f32 v178, v178, v182
  v_mul_f32 v179, v179, v183
  v_cvt_pk_bf16_f32 v172, v176, v177
  v_cvt_pk_bf16_f32 v173, v178, v179
  v_accvgpr_read_b32 v176, a188
  v_accvgpr_read_b32 v180, a252
  v_accvgpr_read_b32 v177, a189
  v_accvgpr_read_b32 v181, a253
  v_accvgpr_read_b32 v178, a190
  v_accvgpr_read_b32 v182, a254
  v_accvgpr_read_b32 v179, a191
  v_accvgpr_read_b32 v183, a255
  v_mul_f32 v176, v176, v180
  v_mul_f32 v177, v177, v181
  v_mul_f32 v178, v178, v182
  v_mul_f32 v179, v179, v183
  v_cvt_pk_bf16_f32 v174, v176, v177
  v_cvt_pk_bf16_f32 v175, v178, v179
  buffer_store_dwordx4 v[172:175], v1, s[32:35], s57 offen offset:3072 sc1
  s_lshr_b32 s56, s60, 3
  s_mul_i32 s56, s56, 112
  s_add_u32 s56, s56, s63
  s_lshl_b32 s56, s56, 13
  s_add_u32 s57, s56, 4096
  v_mul_f32 v164, v192, v224
  v_mul_f32 v165, v193, v225
  v_mul_f32 v166, v194, v226
  v_mul_f32 v167, v195, v227
  v_cvt_pk_bf16_f32 v160, v164, v165
  v_cvt_pk_bf16_f32 v161, v166, v167
  buffer_store_dwordx2 v[160:161], v189, s[32:35], s56 offen offset:0 sc1
  v_mul_f32 v176, v196, v228
  v_mul_f32 v177, v197, v229
  v_mul_f32 v178, v198, v230
  v_mul_f32 v179, v199, v231
  v_cvt_pk_bf16_f32 v172, v176, v177
  v_cvt_pk_bf16_f32 v173, v178, v179
  buffer_store_dwordx2 v[172:173], v189, s[32:35], s56 offen offset:1024 sc1
  v_mul_f32 v164, v200, v232
  v_mul_f32 v165, v201, v233
  v_mul_f32 v166, v202, v234
  v_mul_f32 v167, v203, v235
  v_cvt_pk_bf16_f32 v160, v164, v165
  v_cvt_pk_bf16_f32 v161, v166, v167
  buffer_store_dwordx2 v[160:161], v189, s[32:35], s56 offen offset:2048 sc1
  v_mul_f32 v176, v204, v236
  v_mul_f32 v177, v205, v237
  v_mul_f32 v178, v206, v238
  v_mul_f32 v179, v207, v239
  v_cvt_pk_bf16_f32 v172, v176, v177
  v_cvt_pk_bf16_f32 v173, v178, v179
  buffer_store_dwordx2 v[172:173], v189, s[32:35], s56 offen offset:3072 sc1
  v_mul_f32 v164, v208, v240
  v_mul_f32 v165, v209, v241
  v_mul_f32 v166, v210, v242
  v_mul_f32 v167, v211, v243
  v_cvt_pk_bf16_f32 v160, v164, v165
  v_cvt_pk_bf16_f32 v161, v166, v167
  buffer_store_dwordx2 v[160:161], v189, s[32:35], s57 offen offset:0 sc1
  v_mul_f32 v176, v212, v244
  v_mul_f32 v177, v213, v245
  v_mul_f32 v178, v214, v246
  v_mul_f32 v179, v215, v247
  v_cvt_pk_bf16_f32 v172, v176, v177
  v_cvt_pk_bf16_f32 v173, v178, v179
  buffer_store_dwordx2 v[172:173], v189, s[32:35], s57 offen offset:1024 sc1
  v_mul_f32 v164, v216, v248
  v_mul_f32 v165, v217, v249
  v_mul_f32 v166, v218, v250
  v_mul_f32 v167, v219, v251
  v_cvt_pk_bf16_f32 v160, v164, v165
  v_cvt_pk_bf16_f32 v161, v166, v167
  buffer_store_dwordx2 v[160:161], v189, s[32:35], s57 offen offset:2048 sc1
  v_mul_f32 v176, v220, v252
  v_mul_f32 v177, v221, v253
  v_mul_f32 v178, v222, v254
  v_mul_f32 v179, v223, v255
  v_cvt_pk_bf16_f32 v172, v176, v177
  v_cvt_pk_bf16_f32 v173, v178, v179
  buffer_store_dwordx2 v[172:173], v189, s[32:35], s57 offen offset:3072 sc1
  s_waitcnt vmcnt(44)
  s_barrier
  ds_read_b128 v[16:19], v4 offset:0
  ds_read_b128 v[20:23], v4 offset:1024
  ds_read_b128 v[24:27], v4 offset:2048
  ds_read_b128 v[28:31], v4 offset:3072
  ds_read_b128 v[32:35], v4 offset:8192
  ds_read_b128 v[36:39], v4 offset:9216
  ds_read_b128 v[40:43], v4 offset:10240
  ds_read_b128 v[44:47], v4 offset:11264
  ds_read_b64_tr_b16 v[80:81], v10 offset:0
  ds_read_b64_tr_b16 v[82:83], v10 offset:2048
  ds_read_b64_tr_b16 v[84:85], v11 offset:0
  ds_read_b64_tr_b16 v[86:87], v11 offset:2048
  ds_read_b64_tr_b16 v[88:89], v12 offset:0
  ds_read_b64_tr_b16 v[90:91], v12 offset:2048
  ds_read_b64_tr_b16 v[92:93], v13 offset:0
  ds_read_b64_tr_b16 v[94:95], v13 offset:2048
  ds_read_b64_tr_b16 v[96:97], v10 offset:4096
  ds_read_b64_tr_b16 v[98:99], v10 offset:6144
  ds_read_b64_tr_b16 v[100:101], v11 offset:4096
  ds_read_b64_tr_b16 v[102:103], v11 offset:6144
  ds_read_b64_tr_b16 v[104:105], v12 offset:4096
  ds_read_b64_tr_b16 v[106:107], v12 offset:6144
  ds_read_b64_tr_b16 v[108:109], v13 offset:4096
  ds_read_b64_tr_b16 v[110:111], v13 offset:6144
  s_waitcnt vmcnt(36) lgkmcnt(0)
  s_barrier
  v_mfma_f32_16x16x32_bf16 a[0:3], v[80:83], v[16:19], 0
  ds_read_b128 v[48:51], v4 offset:16384
  s_add_u32 m0, s51, 0
  v_mfma_f32_16x16x32_bf16 a[4:7], v[80:83], v[20:23], 0
  ds_read_b64_tr_b16 v[112:113], v6 offset:0
  v_mfma_f32_16x16x32_bf16 a[8:11], v[80:83], v[24:27], 0
  buffer_load_dwordx4 v2, s[12:15], s48 offen offset:0 sc1 lds
  v_mfma_f32_16x16x32_bf16 a[12:15], v[80:83], v[28:31], 0
  ds_read_b64_tr_b16 v[114:115], v6 offset:2048
  ds_read_b128 v[52:55], v4 offset:17408
  v_mfma_f32_16x16x32_bf16 a[16:19], v[84:87], v[16:19], 0
  buffer_load_dwordx4 v2, s[12:15], s48 offen offset:1024 sc1 lds
  v_mfma_f32_16x16x32_bf16 a[20:23], v[84:87], v[20:23], 0
  ds_read_b64_tr_b16 v[116:117], v7 offset:0
  ds_read_b64_tr_b16 v[118:119], v7 offset:2048
  v_mfma_f32_16x16x32_bf16 a[24:27], v[84:87], v[24:27], 0
  buffer_load_dwordx4 v2, s[12:15], s48 offen offset:2048 sc1 lds
  v_mfma_f32_16x16x32_bf16 a[28:31], v[84:87], v[28:31], 0
  ds_read_b128 v[56:59], v4 offset:18432
  v_mfma_f32_16x16x32_bf16 a[32:35], v[88:91], v[16:19], 0
  buffer_load_dwordx4 v2, s[12:15], s48 offen offset:3072 sc1 lds
  v_mfma_f32_16x16x32_bf16 a[36:39], v[88:91], v[20:23], 0
  ds_read_b64_tr_b16 v[120:121], v8 offset:0
  ds_read_b64_tr_b16 v[122:123], v8 offset:2048
  v_mfma_f32_16x16x32_bf16 a[40:43], v[88:91], v[24:27], 0
  s_add_u32 s48, s48, 16384
  ds_read_b128 v[60:63], v4 offset:19456
  v_mfma_f32_16x16x32_bf16 a[44:47], v[88:91], v[28:31], 0
  ds_read_b64_tr_b16 v[124:125], v9 offset:0
  s_add_u32 m0, s52, 65536
  v_mfma_f32_16x16x32_bf16 a[48:51], v[92:95], v[16:19], 0
  ds_read_b64_tr_b16 v[126:127], v9 offset:2048
  v_mfma_f32_16x16x32_bf16 a[52:55], v[92:95], v[20:23], 0
  buffer_load_dwordx4 v3, s[16:19], s49 offen lds
  v_mfma_f32_16x16x32_bf16 a[56:59], v[92:95], v[24:27], 0
  ds_read_b128 v[64:67], v4 offset:24576
  v_mfma_f32_16x16x32_bf16 a[60:63], v[92:95], v[28:31], 0
  ds_read_b64_tr_b16 v[128:129], v6 offset:4096
  s_add_u32 m0, s52, 66560
  v_mfma_f32_16x16x32_bf16 a[0:3], v[96:99], v[32:35], a[0:3]
  ds_read_b64_tr_b16 v[130:131], v6 offset:6144
  v_mfma_f32_16x16x32_bf16 a[4:7], v[96:99], v[36:39], a[4:7]
  buffer_load_dwordx4 v3, s[16:19], s50 offen lds
  v_mfma_f32_16x16x32_bf16 a[8:11], v[96:99], v[40:43], a[8:11]
  ds_read_b128 v[68:71], v4 offset:25600
  ds_read_b64_tr_b16 v[132:133], v7 offset:4096
  v_mfma_f32_16x16x32_bf16 a[12:15], v[96:99], v[44:47], a[12:15]
  s_add_u32 m0, s52, 73728
  ds_read_b64_tr_b16 v[134:135], v7 offset:6144
  v_mfma_f32_16x16x32_bf16 a[16:19], v[100:103], v[32:35], a[16:19]
  buffer_load_dwordx4 v3, s[20:23], s49 offen lds
  v_mfma_f32_16x16x32_bf16 a[20:23], v[100:103], v[36:39], a[20:23]
  ds_read_b128 v[72:75], v4 offset:26624
  v_mfma_f32_16x16x32_bf16 a[24:27], v[100:103], v[40:43], a[24:27]
  ds_read_b64_tr_b16 v[136:137], v8 offset:4096
  s_add_u32 m0, s52, 74752
  v_mfma_f32_16x16x32_bf16 a[28:31], v[100:103], v[44:47], a[28:31]
  ds_read_b64_tr_b16 v[138:139], v8 offset:6144
  v_mfma_f32_16x16x32_bf16 a[32:35], v[104:107], v[32:35], a[32:35]
  ds_read_b128 v[76:79], v4 offset:27648
  v_mfma_f32_16x16x32_bf16 a[36:39], v[104:107], v[36:39], a[36:39]
  buffer_load_dwordx4 v3, s[20:23], s50 offen lds
  v_mfma_f32_16x16x32_bf16 a[40:43], v[104:107], v[40:43], a[40:43]
  ds_read_b64_tr_b16 v[140:141], v9 offset:4096
  ds_read_b64_tr_b16 v[142:143], v9 offset:6144
  v_mfma_f32_16x16x32_bf16 a[44:47], v[104:107], v[44:47], a[44:47]
  s_add_u32 s49, s49, 131072
  v_mfma_f32_16x16x32_bf16 a[48:51], v[108:111], v[32:35], a[48:51]
  s_add_u32 s50, s50, 131072
  v_mfma_f32_16x16x32_bf16 a[52:55], v[108:111], v[36:39], a[52:55]
  v_mfma_f32_16x16x32_bf16 a[56:59], v[108:111], v[40:43], a[56:59]
  v_mfma_f32_16x16x32_bf16 a[60:63], v[108:111], v[44:47], a[60:63]
  s_waitcnt vmcnt(40) lgkmcnt(0)
  s_barrier
  v_mfma_f32_16x16x32_bf16 a[0:3], v[112:115], v[48:51], a[0:3]
  ds_read_b128 v[16:19], v4 offset:32768
  s_add_u32 m0, s51, 16384
  v_mfma_f32_16x16x32_bf16 a[4:7], v[112:115], v[52:55], a[4:7]
  ds_read_b64_tr_b16 v[80:81], v6 offset:16384
  v_mfma_f32_16x16x32_bf16 a[8:11], v[112:115], v[56:59], a[8:11]
  buffer_load_dwordx4 v2, s[12:15], s48 offen offset:0 sc1 lds
  v_mfma_f32_16x16x32_bf16 a[12:15], v[112:115], v[60:63], a[12:15]
  ds_read_b64_tr_b16 v[82:83], v6 offset:18432
  ds_read_b128 v[20:23], v4 offset:33792
  v_mfma_f32_16x16x32_bf16 a[16:19], v[116:119], v[48:51], a[16:19]
  buffer_load_dwordx4 v2, s[12:15], s48 offen offset:1024 sc1 lds
  v_mfma_f32_16x16x32_bf16 a[20:23], v[116:119], v[52:55], a[20:23]
  ds_read_b64_tr_b16 v[84:85], v7 offset:16384
  ds_read_b64_tr_b16 v[86:87], v7 offset:18432
  v_mfma_f32_16x16x32_bf16 a[24:27], v[116:119], v[56:59], a[24:27]
  buffer_load_dwordx4 v2, s[12:15], s48 offen offset:2048 sc1 lds
  v_mfma_f32_16x16x32_bf16 a[28:31], v[116:119], v[60:63], a[28:31]
  ds_read_b128 v[24:27], v4 offset:34816
  v_mfma_f32_16x16x32_bf16 a[32:35], v[120:123], v[48:51], a[32:35]
  buffer_load_dwordx4 v2, s[12:15], s48 offen offset:3072 sc1 lds
  v_mfma_f32_16x16x32_bf16 a[36:39], v[120:123], v[52:55], a[36:39]
  ds_read_b64_tr_b16 v[88:89], v8 offset:16384
  ds_read_b64_tr_b16 v[90:91], v8 offset:18432
  v_mfma_f32_16x16x32_bf16 a[40:43], v[120:123], v[56:59], a[40:43]
  s_add_u32 s48, s48, 16384
  ds_read_b128 v[28:31], v4 offset:35840
  v_mfma_f32_16x16x32_bf16 a[44:47], v[120:123], v[60:63], a[44:47]
  ds_read_b64_tr_b16 v[92:93], v9 offset:16384
  s_add_u32 m0, s52, 0
  v_mfma_f32_16x16x32_bf16 a[48:51], v[124:127], v[48:51], a[48:51]
  ds_read_b64_tr_b16 v[94:95], v9 offset:18432
  v_mfma_f32_16x16x32_bf16 a[52:55], v[124:127], v[52:55], a[52:55]
  buffer_load_dwordx4 v3, s[16:19], s49 offen lds
  v_mfma_f32_16x16x32_bf16 a[56:59], v[124:127], v[56:59], a[56:59]
  ds_read_b128 v[32:35], v4 offset:40960
  v_mfma_f32_16x16x32_bf16 a[60:63], v[124:127], v[60:63], a[60:63]
  ds_read_b64_tr_b16 v[96:97], v6 offset:20480
  s_add_u32 m0, s52, 1024
  v_mfma_f32_16x16x32_bf16 a[0:3], v[128:131], v[64:67], a[0:3]
  ds_read_b64_tr_b16 v[98:99], v6 offset:22528
  v_mfma_f32_16x16x32_bf16 a[4:7], v[128:131], v[68:71], a[4:7]
  buffer_load_dwordx4 v3, s[16:19], s50 offen lds
  v_mfma_f32_16x16x32_bf16 a[8:11], v[128:131], v[72:75], a[8:11]
  ds_read_b128 v[36:39], v4 offset:41984
  ds_read_b64_tr_b16 v[100:101], v7 offset:20480
  v_mfma_f32_16x16x32_bf16 a[12:15], v[128:131], v[76:79], a[12:15]
  s_add_u32 m0, s52, 8192
  ds_read_b64_tr_b16 v[102:103], v7 offset:22528
  v_mfma_f32_16x16x32_bf16 a[16:19], v[132:135], v[64:67], a[16:19]
  buffer_load_dwordx4 v3, s[20:23], s49 offen lds
  v_mfma_f32_16x16x32_bf16 a[20:23], v[132:135], v[68:71], a[20:23]
  ds_read_b128 v[40:43], v4 offset:43008
  v_mfma_f32_16x16x32_bf16 a[24:27], v[132:135], v[72:75], a[24:27]
  ds_read_b64_tr_b16 v[104:105], v8 offset:20480
  s_add_u32 m0, s52, 9216
  v_mfma_f32_16x16x32_bf16 a[28:31], v[132:135], v[76:79], a[28:31]
  ds_read_b64_tr_b16 v[106:107], v8 offset:22528
  v_mfma_f32_16x16x32_bf16 a[32:35], v[136:139], v[64:67], a[32:35]
  ds_read_b128 v[44:47], v4 offset:44032
  v_mfma_f32_16x16x32_bf16 a[36:39], v[136:139], v[68:71], a[36:39]
  buffer_load_dwordx4 v3, s[20:23], s50 offen lds
  v_mfma_f32_16x16x32_bf16 a[40:43], v[136:139], v[72:75], a[40:43]
  ds_read_b64_tr_b16 v[108:109], v9 offset:20480
  ds_read_b64_tr_b16 v[110:111], v9 offset:22528
  v_mfma_f32_16x16x32_bf16 a[44:47], v[136:139], v[76:79], a[44:47]
  s_add_u32 s49, s49, 131072
  v_mfma_f32_16x16x32_bf16 a[48:51], v[140:143], v[64:67], a[48:51]
  s_add_u32 s50, s50, 131072
  v_mfma_f32_16x16x32_bf16 a[52:55], v[140:143], v[68:71], a[52:55]
  v_mfma_f32_16x16x32_bf16 a[56:59], v[140:143], v[72:75], a[56:59]
  v_mfma_f32_16x16x32_bf16 a[60:63], v[140:143], v[76:79], a[60:63]
  s_waitcnt vmcnt(40) lgkmcnt(0)
  s_barrier
  v_mfma_f32_16x16x32_bf16 a[0:3], v[80:83], v[16:19], a[0:3]
  ds_read_b128 v[48:51], v4 offset:49152
  s_add_u32 m0, s51, 32768
  v_mfma_f32_16x16x32_bf16 a[4:7], v[80:83], v[20:23], a[4:7]
  ds_read_b64_tr_b16 v[112:113], v6 offset:32768
  v_mfma_f32_16x16x32_bf16 a[8:11], v[80:83], v[24:27], a[8:11]
  buffer_load_dwordx4 v2, s[12:15], s48 offen offset:0 sc1 lds
  v_mfma_f32_16x16x32_bf16 a[12:15], v[80:83], v[28:31], a[12:15]
  ds_read_b64_tr_b16 v[114:115], v6 offset:34816
  ds_read_b128 v[52:55], v4 offset:50176
  v_mfma_f32_16x16x32_bf16 a[16:19], v[84:87], v[16:19], a[16:19]
  buffer_load_dwordx4 v2, s[12:15], s48 offen offset:1024 sc1 lds
  v_mfma_f32_16x16x32_bf16 a[20:23], v[84:87], v[20:23], a[20:23]
  ds_read_b64_tr_b16 v[116:117], v7 offset:32768
  ds_read_b64_tr_b16 v[118:119], v7 offset:34816
  v_mfma_f32_16x16x32_bf16 a[24:27], v[84:87], v[24:27], a[24:27]
  buffer_load_dwordx4 v2, s[12:15], s48 offen offset:2048 sc1 lds
  v_mfma_f32_16x16x32_bf16 a[28:31], v[84:87], v[28:31], a[28:31]
  ds_read_b128 v[56:59], v4 offset:51200
  v_mfma_f32_16x16x32_bf16 a[32:35], v[88:91], v[16:19], a[32:35]
  buffer_load_dwordx4 v2, s[12:15], s48 offen offset:3072 sc1 lds
  v_mfma_f32_16x16x32_bf16 a[36:39], v[88:91], v[20:23], a[36:39]
  ds_read_b64_tr_b16 v[120:121], v8 offset:32768
  ds_read_b64_tr_b16 v[122:123], v8 offset:34816
  v_mfma_f32_16x16x32_bf16 a[40:43], v[88:91], v[24:27], a[40:43]
  s_add_u32 s48, s48, 16384
  ds_read_b128 v[60:63], v4 offset:52224
  v_mfma_f32_16x16x32_bf16 a[44:47], v[88:91], v[28:31], a[44:47]
  ds_read_b64_tr_b16 v[124:125], v9 offset:32768
  s_add_u32 m0, s52, 16384
  v_mfma_f32_16x16x32_bf16 a[48:51], v[92:95], v[16:19], a[48:51]
  ds_read_b64_tr_b16 v[126:127], v9 offset:34816
  v_mfma_f32_16x16x32_bf16 a[52:55], v[92:95], v[20:23], a[52:55]
  buffer_load_dwordx4 v3, s[16:19], s49 offen lds
  v_mfma_f32_16x16x32_bf16 a[56:59], v[92:95], v[24:27], a[56:59]
  ds_read_b128 v[64:67], v4 offset:57344
  v_mfma_f32_16x16x32_bf16 a[60:63], v[92:95], v[28:31], a[60:63]
  ds_read_b64_tr_b16 v[128:129], v6 offset:36864
  s_add_u32 m0, s52, 17408
  v_mfma_f32_16x16x32_bf16 a[0:3], v[96:99], v[32:35], a[0:3]
  ds_read_b64_tr_b16 v[130:131], v6 offset:38912
  v_mfma_f32_16x16x32_bf16 a[4:7], v[96:99], v[36:39], a[4:7]
  buffer_load_dwordx4 v3, s[16:19], s50 offen lds
  v_mfma_f32_16x16x32_bf16 a[8:11], v[96:99], v[40:43], a[8:11]
  ds_read_b128 v[68:71], v4 offset:58368
  ds_read_b64_tr_b16 v[132:133], v7 offset:36864
  v_mfma_f32_16x16x32_bf16 a[12:15], v[96:99], v[44:47], a[12:15]
  s_add_u32 m0, s52, 24576
  ds_read_b64_tr_b16 v[134:135], v7 offset:38912
  v_mfma_f32_16x16x32_bf16 a[16:19], v[100:103], v[32:35], a[16:19]
  buffer_load_dwordx4 v3, s[20:23], s49 offen lds
  v_mfma_f32_16x16x32_bf16 a[20:23], v[100:103], v[36:39], a[20:23]
  ds_read_b128 v[72:75], v4 offset:59392
  v_mfma_f32_16x16x32_bf16 a[24:27], v[100:103], v[40:43], a[24:27]
  ds_read_b64_tr_b16 v[136:137], v8 offset:36864
  s_add_u32 m0, s52, 25600
  v_mfma_f32_16x16x32_bf16 a[28:31], v[100:103], v[44:47], a[28:31]
  ds_read_b64_tr_b16 v[138:139], v8 offset:38912
  v_mfma_f32_16x16x32_bf16 a[32:35], v[104:107], v[32:35], a[32:35]
  ds_read_b128 v[76:79], v4 offset:60416
  v_mfma_f32_16x16x32_bf16 a[36:39], v[104:107], v[36:39], a[36:39]
  buffer_load_dwordx4 v3, s[20:23], s50 offen lds
  v_mfma_f32_16x16x32_bf16 a[40:43], v[104:107], v[40:43], a[40:43]
  ds_read_b64_tr_b16 v[140:141], v9 offset:36864
  ds_read_b64_tr_b16 v[142:143], v9 offset:38912
  v_mfma_f32_16x16x32_bf16 a[44:47], v[104:107], v[44:47], a[44:47]
  s_add_u32 s49, s49, 131072
  v_mfma_f32_16x16x32_bf16 a[48:51], v[108:111], v[32:35], a[48:51]
  s_add_u32 s50, s50, 131072
  v_mfma_f32_16x16x32_bf16 a[52:55], v[108:111], v[36:39], a[52:55]
  v_mfma_f32_16x16x32_bf16 a[56:59], v[108:111], v[40:43], a[56:59]
  v_mfma_f32_16x16x32_bf16 a[60:63], v[108:111], v[44:47], a[60:63]
  s_waitcnt vmcnt(40) lgkmcnt(0)
  s_barrier
  v_mfma_f32_16x16x32_bf16 a[0:3], v[112:115], v[48:51], a[0:3]
  ds_read_b128 v[16:19], v5 offset:0
  s_add_u32 m0, s51, 49152
  v_mfma_f32_16x16x32_bf16 a[4:7], v[112:115], v[52:55], a[4:7]
  ds_read_b64_tr_b16 v[80:81], v6 offset:49152
  v_mfma_f32_16x16x32_bf16 a[8:11], v[112:115], v[56:59], a[8:11]
  buffer_load_dwordx4 v2, s[12:15], s48 offen offset:0 sc1 lds
  v_mfma_f32_16x16x32_bf16 a[12:15], v[112:115], v[60:63], a[12:15]
  ds_read_b64_tr_b16 v[82:83], v6 offset:51200
  ds_read_b128 v[20:23], v5 offset:1024
  v_mfma_f32_16x16x32_bf16 a[16:19], v[116:119], v[48:51], a[16:19]
  buffer_load_dwordx4 v2, s[12:15], s48 offen offset:1024 sc1 lds
  v_mfma_f32_16x16x32_bf16 a[20:23], v[116:119], v[52:55], a[20:23]
  ds_read_b64_tr_b16 v[84:85], v7 offset:49152
  ds_read_b64_tr_b16 v[86:87], v7 offset:51200
  v_mfma_f32_16x16x32_bf16 a[24:27], v[116:119], v[56:59], a[24:27]
  buffer_load_dwordx4 v2, s[12:15], s48 offen offset:2048 sc1 lds
  v_mfma_f32_16x16x32_bf16 a[28:31], v[116:119], v[60:63], a[28:31]
  ds_read_b128 v[24:27], v5 offset:2048
  v_mfma_f32_16x16x32_bf16 a[32:35], v[120:123], v[48:51], a[32:35]
  buffer_load_dwordx4 v2, s[12:15], s48 offen offset:3072 sc1 lds
  v_mfma_f32_16x16x32_bf16 a[36:39], v[120:123], v[52:55], a[36:39]
  ds_read_b64_tr_b16 v[88:89], v8 offset:49152
  ds_read_b64_tr_b16 v[90:91], v8 offset:51200
  v_mfma_f32_16x16x32_bf16 a[40:43], v[120:123], v[56:59], a[40:43]
  s_add_u32 s48, s48, 16384
  ds_read_b128 v[28:31], v5 offset:3072
  v_mfma_f32_16x16x32_bf16 a[44:47], v[120:123], v[60:63], a[44:47]
  ds_read_b64_tr_b16 v[92:93], v9 offset:49152
  s_add_u32 m0, s52, 32768
  v_mfma_f32_16x16x32_bf16 a[48:51], v[124:127], v[48:51], a[48:51]
  ds_read_b64_tr_b16 v[94:95], v9 offset:51200
  v_mfma_f32_16x16x32_bf16 a[52:55], v[124:127], v[52:55], a[52:55]
  buffer_load_dwordx4 v3, s[16:19], s49 offen lds
  v_mfma_f32_16x16x32_bf16 a[56:59], v[124:127], v[56:59], a[56:59]
  ds_read_b128 v[32:35], v5 offset:8192
  v_mfma_f32_16x16x32_bf16 a[60:63], v[124:127], v[60:63], a[60:63]
  ds_read_b64_tr_b16 v[96:97], v6 offset:53248
  s_add_u32 m0, s52, 33792
  v_mfma_f32_16x16x32_bf16 a[0:3], v[128:131], v[64:67], a[0:3]
  ds_read_b64_tr_b16 v[98:99], v6 offset:55296
  v_mfma_f32_16x16x32_bf16 a[4:7], v[128:131], v[68:71], a[4:7]
  buffer_load_dwordx4 v3, s[16:19], s50 offen lds
  v_mfma_f32_16x16x32_bf16 a[8:11], v[128:131], v[72:75], a[8:11]
  ds_read_b128 v[36:39], v5 offset:9216
  ds_read_b64_tr_b16 v[100:101], v7 offset:53248
  v_mfma_f32_16x16x32_bf16 a[12:15], v[128:131], v[76:79], a[12:15]
  s_add_u32 m0, s52, 40960
  ds_read_b64_tr_b16 v[102:103], v7 offset:55296
  v_mfma_f32_16x16x32_bf16 a[16:19], v[132:135], v[64:67], a[16:19]
  buffer_load_dwordx4 v3, s[20:23], s49 offen lds
  v_mfma_f32_16x16x32_bf16 a[20:23], v[132:135], v[68:71], a[20:23]
  ds_read_b128 v[40:43], v5 offset:10240
  v_mfma_f32_16x16x32_bf16 a[24:27], v[132:135], v[72:75], a[24:27]
  ds_read_b64_tr_b16 v[104:105], v8 offset:53248
  s_add_u32 m0, s52, 41984
  v_mfma_f32_16x16x32_bf16 a[28:31], v[132:135], v[76:79], a[28:31]
  ds_read_b64_tr_b16 v[106:107], v8 offset:55296
  v_mfma_f32_16x16x32_bf16 a[32:35], v[136:139], v[64:67], a[32:35]
  ds_read_b128 v[44:47], v5 offset:11264
  v_mfma_f32_16x16x32_bf16 a[36:39], v[136:139], v[68:71], a[36:39]
  buffer_load_dwordx4 v3, s[20:23], s50 offen lds
  v_mfma_f32_16x16x32_bf16 a[40:43], v[136:139], v[72:75], a[40:43]
  ds_read_b64_tr_b16 v[108:109], v9 offset:53248
  ds_read_b64_tr_b16 v[110:111], v9 offset:55296
  v_mfma_f32_16x16x32_bf16 a[44:47], v[136:139], v[76:79], a[44:47]
  s_add_u32 s49, s49, 131072
  v_mfma_f32_16x16x32_bf16 a[48:51], v[140:143], v[64:67], a[48:51]
  s_add_u32 s50, s50, 131072
  v_mfma_f32_16x16x32_bf16 a[52:55], v[140:143], v[68:71], a[52:55]
  v_mfma_f32_16x16x32_bf16 a[56:59], v[140:143], v[72:75], a[56:59]
  v_mfma_f32_16x16x32_bf16 a[60:63], v[140:143], v[76:79], a[60:63]
  s_waitcnt vmcnt(24) lgkmcnt(0)
  s_barrier
  s_cmp_eq_u32 s40, 0
  s_cbranch_scc0 sig_19
  s_lshl_b32 s66, s43, 5
  s_add_u32 s66, s66, s78
  s_add_u32 s66, s66, 1024
  s_lshl_b32 s66, s66, 7
  s_add_u32 s66, s66, 4096
  v_mov_b32 v204, s76
  v_mov_b32 v205, s77
  v_mov_b32 v206, 0
  s_mov_b64 exec, 1
  buffer_store_dwordx2 v[204:205], v206, s[72:75], s66 offen sc1
  s_mov_b64 exec, -1
sig_19:
  v_mfma_f32_16x16x32_bf16 a[0:3], v[80:83], v[16:19], a[0:3]
  ds_read_b128 v[48:51], v4 offset:0
  s_add_u32 m0, s51, 65536
  v_mfma_f32_16x16x32_bf16 a[4:7], v[80:83], v[20:23], a[4:7]
  ds_read_b64_tr_b16 v[112:113], v10 offset:0
  v_mfma_f32_16x16x32_bf16 a[8:11], v[80:83], v[24:27], a[8:11]
  buffer_load_dwordx4 v2, s[12:15], s48 offen offset:0 sc1 lds
  v_mfma_f32_16x16x32_bf16 a[12:15], v[80:83], v[28:31], a[12:15]
  ds_read_b64_tr_b16 v[114:115], v10 offset:2048
  ds_read_b128 v[52:55], v4 offset:1024
  v_mfma_f32_16x16x32_bf16 a[16:19], v[84:87], v[16:19], a[16:19]
  buffer_load_dwordx4 v2, s[12:15], s48 offen offset:1024 sc1 lds
  v_mfma_f32_16x16x32_bf16 a[20:23], v[84:87], v[20:23], a[20:23]
  ds_read_b64_tr_b16 v[116:117], v11 offset:0
  ds_read_b64_tr_b16 v[118:119], v11 offset:2048
  v_mfma_f32_16x16x32_bf16 a[24:27], v[84:87], v[24:27], a[24:27]
  buffer_load_dwordx4 v2, s[12:15], s48 offen offset:2048 sc1 lds
  v_mfma_f32_16x16x32_bf16 a[28:31], v[84:87], v[28:31], a[28:31]
  ds_read_b128 v[56:59], v4 offset:2048
  v_mfma_f32_16x16x32_bf16 a[32:35], v[88:91], v[16:19], a[32:35]
  buffer_load_dwordx4 v2, s[12:15], s48 offen offset:3072 sc1 lds
  v_mfma_f32_16x16x32_bf16 a[36:39], v[88:91], v[20:23], a[36:39]
  ds_read_b64_tr_b16 v[120:121], v12 offset:0
  ds_read_b64_tr_b16 v[122:123], v12 offset:2048
  v_mfma_f32_16x16x32_bf16 a[40:43], v[88:91], v[24:27], a[40:43]
  s_add_u32 s48, s48, 16384
  ds_read_b128 v[60:63], v4 offset:3072
  v_mfma_f32_16x16x32_bf16 a[44:47], v[88:91], v[28:31], a[44:47]
  ds_read_b64_tr_b16 v[124:125], v13 offset:0
  s_add_u32 m0, s52, 49152
  v_mfma_f32_16x16x32_bf16 a[48:51], v[92:95], v[16:19], a[48:51]
  ds_read_b64_tr_b16 v[126:127], v13 offset:2048
  v_mfma_f32_16x16x32_bf16 a[52:55], v[92:95], v[20:23], a[52:55]
  buffer_load_dwordx4 v3, s[16:19], s49 offen lds
  v_mfma_f32_16x16x32_bf16 a[56:59], v[92:95], v[24:27], a[56:59]
  ds_read_b128 v[64:67], v4 offset:8192
  v_mfma_f32_16x16x32_bf16 a[60:63], v[92:95], v[28:31], a[60:63]
  ds_read_b64_tr_b16 v[128:129], v10 offset:4096
  s_add_u32 m0, s52, 50176
  v_mfma_f32_16x16x32_bf16 a[0:3], v[96:99], v[32:35], a[0:3]
  ds_read_b64_tr_b16 v[130:131], v10 offset:6144
  v_mfma_f32_16x16x32_bf16 a[4:7], v[96:99], v[36:39], a[4:7]
  buffer_load_dwordx4 v3, s[16:19], s50 offen lds
  v_mfma_f32_16x16x32_bf16 a[8:11], v[96:99], v[40:43], a[8:11]
  ds_read_b128 v[68:71], v4 offset:9216
  ds_read_b64_tr_b16 v[132:133], v11 offset:4096
  v_mfma_f32_16x16x32_bf16 a[12:15], v[96:99], v[44:47], a[12:15]
  s_add_u32 m0, s52, 57344
  ds_read_b64_tr_b16 v[134:135], v11 offset:6144
  v_mfma_f32_16x16x32_bf16 a[16:19], v[100:103], v[32:35], a[16:19]
  buffer_load_dwordx4 v3, s[20:23], s49 offen lds
  v_mfma_f32_16x16x32_bf16 a[20:23], v[100:103], v[36:39], a[20:23]
  ds_read_b128 v[72:75], v4 offset:10240
  v_mfma_f32_16x16x32_bf16 a[24:27], v[100:103], v[40:43], a[24:27]
  ds_read_b64_tr_b16 v[136:137], v12 offset:4096
  s_add_u32 m0, s52, 58368
  v_mfma_f32_16x16x32_bf16 a[28:31], v[100:103], v[44:47], a[28:31]
  ds_read_b64_tr_b16 v[138:139], v12 offset:6144
  v_mfma_f32_16x16x32_bf16 a[32:35], v[104:107], v[32:35], a[32:35]
  ds_read_b128 v[76:79], v4 offset:11264
  v_mfma_f32_16x16x32_bf16 a[36:39], v[104:107], v[36:39], a[36:39]
  buffer_load_dwordx4 v3, s[20:23], s50 offen lds
  v_mfma_f32_16x16x32_bf16 a[40:43], v[104:107], v[40:43], a[40:43]
  ds_read_b64_tr_b16 v[140:141], v13 offset:4096
  ds_read_b64_tr_b16 v[142:143], v13 offset:6144
  v_mfma_f32_16x16x32_bf16 a[44:47], v[104:107], v[44:47], a[44:47]
  s_add_u32 s49, s49, 131072
  v_mfma_f32_16x16x32_bf16 a[48:51], v[108:111], v[32:35], a[48:51]
  s_add_u32 s50, s50, 131072
  v_mfma_f32_16x16x32_bf16 a[52:55], v[108:111], v[36:39], a[52:55]
  v_mfma_f32_16x16x32_bf16 a[56:59], v[108:111], v[40:43], a[56:59]
  v_mfma_f32_16x16x32_bf16 a[60:63], v[108:111], v[44:47], a[60:63]
  s_waitcnt vmcnt(24) lgkmcnt(0)
  s_barrier
  v_mfma_f32_16x16x32_bf16 a[0:3], v[112:115], v[48:51], a[0:3]
  ds_read_b128 v[16:19], v4 offset:16384
  s_add_u32 m0, s51, 0
  v_mfma_f32_16x16x32_bf16 a[4:7], v[112:115], v[52:55], a[4:7]
  ds_read_b64_tr_b16 v[80:81], v6 offset:0
  s_lshr_b32 s66, s45, 1
  v_mfma_f32_16x16x32_bf16 a[8:11], v[112:115], v[56:59], a[8:11]
  buffer_load_dwordx4 v2, s[12:15], s48 offen offset:0 sc1 lds
  v_mfma_f32_16x16x32_bf16 a[12:15], v[112:115], v[60:63], a[12:15]
  ds_read_b64_tr_b16 v[82:83], v6 offset:2048
  ds_read_b128 v[20:23], v4 offset:17408
  v_mfma_f32_16x16x32_bf16 a[16:19], v[116:119], v[48:51], a[16:19]
  buffer_load_dwordx4 v2, s[12:15], s48 offen offset:1024 sc1 lds
  v_mfma_f32_16x16x32_bf16 a[20:23], v[116:119], v[52:55], a[20:23]
  s_lshl_b32 s66, s66, 5
  ds_read_b64_tr_b16 v[84:85], v7 offset:0
  v_mfma_f32_16x16x32_bf16 a[24:27], v[116:119], v[56:59], a[24:27]
  ds_read_b64_tr_b16 v[86:87], v7 offset:2048
  s_add_u32 s66, s66, 1024
  v_mfma_f32_16x16x32_bf16 a[28:31], v[116:119], v[60:63], a[28:31]
  buffer_load_dwordx4 v2, s[12:15], s48 offen offset:2048 sc1 lds
  v_mfma_f32_16x16x32_bf16 a[32:35], v[120:123], v[48:51], a[32:35]
  ds_read_b128 v[24:27], v4 offset:18432
  ds_read_b64_tr_b16 v[88:89], v8 offset:0
  v_mfma_f32_16x16x32_bf16 a[36:39], v[120:123], v[52:55], a[36:39]
  buffer_load_dwordx4 v2, s[12:15], s48 offen offset:3072 sc1 lds
  v_mfma_f32_16x16x32_bf16 a[40:43], v[120:123], v[56:59], a[40:43]
  ds_read_b64_tr_b16 v[90:91], v8 offset:2048
  s_add_u32 s48, s48, 16384
  v_mfma_f32_16x16x32_bf16 a[44:47], v[120:123], v[60:63], a[44:47]
  s_lshl_b32 s66, s66, 7
  ds_read_b128 v[28:31], v4 offset:19456
  v_mfma_f32_16x16x32_bf16 a[48:51], v[124:127], v[48:51], a[48:51]
  ds_read_b64_tr_b16 v[92:93], v9 offset:0
  s_add_u32 m0, s52, 65536
  v_mfma_f32_16x16x32_bf16 a[52:55], v[124:127], v[52:55], a[52:55]
  ds_read_b64_tr_b16 v[94:95], v9 offset:2048
  s_add_u32 s66, s66, 4096
  v_mfma_f32_16x16x32_bf16 a[56:59], v[124:127], v[56:59], a[56:59]
  buffer_load_dwordx4 v3, s[16:19], s49 offen lds
  v_mfma_f32_16x16x32_bf16 a[60:63], v[124:127], v[60:63], a[60:63]
  ds_read_b128 v[32:35], v4 offset:24576
  ds_read_b64_tr_b16 v[96:97], v6 offset:4096
  v_mfma_f32_16x16x32_bf16 a[0:3], v[128:131], v[64:67], a[0:3]
  s_add_u32 m0, s52, 66560
  v_bfe_u32 v202, v0, 1, 3
  v_mfma_f32_16x16x32_bf16 a[4:7], v[128:131], v[68:71], a[4:7]
  ds_read_b64_tr_b16 v[98:99], v6 offset:6144
  ds_read_b128 v[36:39], v4 offset:25600
  v_mfma_f32_16x16x32_bf16 a[8:11], v[128:131], v[72:75], a[8:11]
  buffer_load_dwordx4 v3, s[16:19], s50 offen lds
  v_mfma_f32_16x16x32_bf16 a[12:15], v[128:131], v[76:79], a[12:15]
  v_lshlrev_b32 v202, 2, v202
  ds_read_b64_tr_b16 v[100:101], v7 offset:4096
  v_mfma_f32_16x16x32_bf16 a[16:19], v[132:135], v[64:67], a[16:19]
  s_add_u32 m0, s52, 73728
  ds_read_b64_tr_b16 v[102:103], v7 offset:6144
  v_mfma_f32_16x16x32_bf16 a[20:23], v[132:135], v[68:71], a[20:23]
  buffer_load_dwordx4 v3, s[20:23], s49 offen lds
  v_mfma_f32_16x16x32_bf16 a[24:27], v[132:135], v[72:75], a[24:27]
  v_and_b32 v200, 1, v0
  ds_read_b128 v[40:43], v4 offset:26624
  v_mfma_f32_16x16x32_bf16 a[28:31], v[132:135], v[76:79], a[28:31]
  ds_read_b64_tr_b16 v[104:105], v8 offset:4096
  s_add_u32 m0, s52, 74752
  v_mfma_f32_16x16x32_bf16 a[32:35], v[136:139], v[64:67], a[32:35]
  ds_read_b64_tr_b16 v[106:107], v8 offset:6144
  v_add_u32 v202, v202, v200
  v_mfma_f32_16x16x32_bf16 a[36:39], v[136:139], v[68:71], a[36:39]
  ds_read_b128 v[44:47], v4 offset:27648
  ds_read_b64_tr_b16 v[108:109], v9 offset:4096
  v_mfma_f32_16x16x32_bf16 a[40:43], v[136:139], v[72:75], a[40:43]
  buffer_load_dwordx4 v3, s[20:23], s50 offen lds
  v_mfma_f32_16x16x32_bf16 a[44:47], v[136:139], v[76:79], a[44:47]
  ds_read_b64_tr_b16 v[110:111], v9 offset:6144
  s_add_u32 s49, s49, 131072
  v_mfma_f32_16x16x32_bf16 a[48:51], v[140:143], v[64:67], a[48:51]
  v_lshlrev_b32 v202, 7, v202
  s_add_u32 s50, s50, 131072
  v_mfma_f32_16x16x32_bf16 a[52:55], v[140:143], v[68:71], a[52:55]
  v_add_u32 v202, s66, v202
  v_mfma_f32_16x16x32_bf16 a[56:59], v[140:143], v[72:75], a[56:59]
  v_mfma_f32_16x16x32_bf16 a[60:63], v[140:143], v[76:79], a[60:63]
  s_waitcnt vmcnt(24) lgkmcnt(0)
  s_barrier
  v_mfma_f32_16x16x32_bf16 a[0:3], v[80:83], v[16:19], a[0:3]
  ds_read_b128 v[48:51], v4 offset:32768
  s_add_u32 m0, s51, 16384
  v_mfma_f32_16x16x32_bf16 a[4:7], v[80:83], v[20:23], a[4:7]
  ds_read_b64_tr_b16 v[112:113], v6 offset:16384
  v_mfma_f32_16x16x32_bf16 a[8:11], v[80:83], v[24:27], a[8:11]
  buffer_load_dwordx4 v2, s[12:15], s48 offen offset:0 sc1 lds
  v_mfma_f32_16x16x32_bf16 a[12:15], v[80:83], v[28:31], a[12:15]
  ds_read_b64_tr_b16 v[114:115], v6 offset:18432
  ds_read_b128 v[52:55], v4 offset:33792
  v_mfma_f32_16x16x32_bf16 a[16:19], v[84:87], v[16:19], a[16:19]
  buffer_load_dwordx4 v2, s[12:15], s48 offen offset:1024 sc1 lds
  v_mfma_f32_16x16x32_bf16 a[20:23], v[84:87], v[20:23], a[20:23]
  ds_read_b64_tr_b16 v[116:117], v7 offset:16384
  ds_read_b64_tr_b16 v[118:119], v7 offset:18432
  v_mfma_f32_16x16x32_bf16 a[24:27], v[84:87], v[24:27], a[24:27]
  buffer_load_dwordx4 v2, s[12:15], s48 offen offset:2048 sc1 lds
  v_mfma_f32_16x16x32_bf16 a[28:31], v[84:87], v[28:31], a[28:31]
  ds_read_b128 v[56:59], v4 offset:34816
  v_mfma_f32_16x16x32_bf16 a[32:35], v[88:91], v[16:19], a[32:35]
  buffer_load_dwordx4 v2, s[12:15], s48 offen offset:3072 sc1 lds
  v_mfma_f32_16x16x32_bf16 a[36:39], v[88:91], v[20:23], a[36:39]
  ds_read_b64_tr_b16 v[120:121], v8 offset:16384
  ds_read_b64_tr_b16 v[122:123], v8 offset:18432
  v_mfma_f32_16x16x32_bf16 a[40:43], v[88:91], v[24:27], a[40:43]
  s_add_u32 s48, s48, 16384
  ds_read_b128 v[60:63], v4 offset:35840
  v_mfma_f32_16x16x32_bf16 a[44:47], v[88:91], v[28:31], a[44:47]
  ds_read_b64_tr_b16 v[124:125], v9 offset:16384
  s_add_u32 m0, s52, 0
  v_mfma_f32_16x16x32_bf16 a[48:51], v[92:95], v[16:19], a[48:51]
  ds_read_b64_tr_b16 v[126:127], v9 offset:18432
  v_mfma_f32_16x16x32_bf16 a[52:55], v[92:95], v[20:23], a[52:55]
  buffer_load_dwordx4 v3, s[16:19], s49 offen lds
  v_mfma_f32_16x16x32_bf16 a[56:59], v[92:95], v[24:27], a[56:59]
  ds_read_b128 v[64:67], v4 offset:40960
  v_mfma_f32_16x16x32_bf16 a[60:63], v[92:95], v[28:31], a[60:63]
  ds_read_b64_tr_b16 v[128:129], v6 offset:20480
  s_add_u32 m0, s52, 1024
  v_mfma_f32_16x16x32_bf16 a[0:3], v[96:99], v[32:35], a[0:3]
  ds_read_b64_tr_b16 v[130:131], v6 offset:22528
  v_mfma_f32_16x16x32_bf16 a[4:7], v[96:99], v[36:39], a[4:7]
  buffer_load_dwordx4 v3, s[16:19], s50 offen lds
  v_mfma_f32_16x16x32_bf16 a[8:11], v[96:99], v[40:43], a[8:11]
  ds_read_b128 v[68:71], v4 offset:41984
  ds_read_b64_tr_b16 v[132:133], v7 offset:20480
  v_mfma_f32_16x16x32_bf16 a[12:15], v[96:99], v[44:47], a[12:15]
  s_add_u32 m0, s52, 8192
  ds_read_b64_tr_b16 v[134:135], v7 offset:22528
  v_mfma_f32_16x16x32_bf16 a[16:19], v[100:103], v[32:35], a[16:19]
  buffer_load_dwordx4 v3, s[20:23], s49 offen lds
  v_mfma_f32_16x16x32_bf16 a[20:23], v[100:103], v[36:39], a[20:23]
  ds_read_b128 v[72:75], v4 offset:43008
  v_mfma_f32_16x16x32_bf16 a[24:27], v[100:103], v[40:43], a[24:27]
  ds_read_b64_tr_b16 v[136:137], v8 offset:20480
  s_add_u32 m0, s52, 9216
  v_mfma_f32_16x16x32_bf16 a[28:31], v[100:103], v[44:47], a[28:31]
  ds_read_b64_tr_b16 v[138:139], v8 offset:22528
  v_mfma_f32_16x16x32_bf16 a[32:35], v[104:107], v[32:35], a[32:35]
  ds_read_b128 v[76:79], v4 offset:44032
  v_mfma_f32_16x16x32_bf16 a[36:39], v[104:107], v[36:39], a[36:39]
  buffer_load_dwordx4 v3, s[20:23], s50 offen lds
  v_mfma_f32_16x16x32_bf16 a[40:43], v[104:107], v[40:43], a[40:43]
  ds_read_b64_tr_b16 v[140:141], v9 offset:20480
  ds_read_b64_tr_b16 v[142:143], v9 offset:22528
  v_mfma_f32_16x16x32_bf16 a[44:47], v[104:107], v[44:47], a[44:47]
  s_add_u32 s49, s49, 131072
  v_mfma_f32_16x16x32_bf16 a[48:51], v[108:111], v[32:35], a[48:51]
  s_add_u32 s50, s50, 131072
  v_mfma_f32_16x16x32_bf16 a[52:55], v[108:111], v[36:39], a[52:55]
  v_mfma_f32_16x16x32_bf16 a[56:59], v[108:111], v[40:43], a[56:59]
  v_mfma_f32_16x16x32_bf16 a[60:63], v[108:111], v[44:47], a[60:63]
  s_waitcnt vmcnt(24) lgkmcnt(0)
  s_barrier
  buffer_load_dwordx2 v[200:201], v202, s[72:75], 0 offen sc1
  v_mfma_f32_16x16x32_bf16 a[0:3], v[112:115], v[48:51], a[0:3]
  ds_read_b128 v[16:19], v4 offset:49152
  s_add_u32 m0, s51, 32768
  v_mfma_f32_16x16x32_bf16 a[4:7], v[112:115], v[52:55], a[4:7]
  ds_read_b64_tr_b16 v[80:81], v6 offset:32768
  v_mfma_f32_16x16x32_bf16 a[8:11], v[112:115], v[56:59], a[8:11]
  buffer_load_dwordx4 v2, s[12:15], s48 offen offset:0 sc1 lds
  v_mfma_f32_16x16x32_bf16 a[12:15], v[112:115], v[60:63], a[12:15]
  ds_read_b64_tr_b16 v[82:83], v6 offset:34816
  ds_read_b128 v[20:23], v4 offset:50176
  v_mfma_f32_16x16x32_bf16 a[16:19], v[116:119], v[48:51], a[16:19]
  buffer_load_dwordx4 v2, s[12:15], s48 offen offset:1024 sc1 lds
  v_mfma_f32_16x16x32_bf16 a[20:23], v[116:119], v[52:55], a[20:23]
  ds_read_b64_tr_b16 v[84:85], v7 offset:32768
  ds_read_b64_tr_b16 v[86:87], v7 offset:34816
  v_mfma_f32_16x16x32_bf16 a[24:27], v[116:119], v[56:59], a[24:27]
  buffer_load_dwordx4 v2, s[12:15], s48 offen offset:2048 sc1 lds
  v_mfma_f32_16x16x32_bf16 a[28:31], v[116:119], v[60:63], a[28:31]
  ds_read_b128 v[24:27], v4 offset:51200
  v_mfma_f32_16x16x32_bf16 a[32:35], v[120:123], v[48:51], a[32:35]
  buffer_load_dwordx4 v2, s[12:15], s48 offen offset:3072 sc1 lds
  v_mfma_f32_16x16x32_bf16 a[36:39], v[120:123], v[52:55], a[36:39]
  ds_read_b64_tr_b16 v[88:89], v8 offset:32768
  ds_read_b64_tr_b16 v[90:91], v8 offset:34816
  v_mfma_f32_16x16x32_bf16 a[40:43], v[120:123], v[56:59], a[40:43]
  s_add_u32 s48, s48, 16384
  ds_read_b128 v[28:31], v4 offset:52224
  v_mfma_f32_16x16x32_bf16 a[44:47], v[120:123], v[60:63], a[44:47]
  ds_read_b64_tr_b16 v[92:93], v9 offset:32768
  s_add_u32 m0, s52, 16384
  v_mfma_f32_16x16x32_bf16 a[48:51], v[124:127], v[48:51], a[48:51]
  ds_read_b64_tr_b16 v[94:95], v9 offset:34816
  v_mfma_f32_16x16x32_bf16 a[52:55], v[124:127], v[52:55], a[52:55]
  buffer_load_dwordx4 v3, s[16:19], s49 offen lds
  v_mfma_f32_16x16x32_bf16 a[56:59], v[124:127], v[56:59], a[56:59]
  ds_read_b128 v[32:35], v4 offset:57344
  v_mfma_f32_16x16x32_bf16 a[60:63], v[124:127], v[60:63], a[60:63]
  ds_read_b64_tr_b16 v[96:97], v6 offset:36864
  s_add_u32 m0, s52, 17408
  v_mfma_f32_16x16x32_bf16 a[0:3], v[128:131], v[64:67], a[0:3]
  ds_read_b64_tr_b16 v[98:99], v6 offset:38912
  v_mfma_f32_16x16x32_bf16 a[4:7], v[128:131], v[68:71], a[4:7]
  buffer_load_dwordx4 v3, s[16:19], s50 offen lds
  v_mfma_f32_16x16x32_bf16 a[8:11], v[128:131], v[72:75], a[8:11]
  ds_read_b128 v[36:39], v4 offset:58368
  ds_read_b64_tr_b16 v[100:101], v7 offset:36864
  v_mfma_f32_16x16x32_bf16 a[12:15], v[128:131], v[76:79], a[12:15]
  s_add_u32 m0, s52, 24576
  ds_read_b64_tr_b16 v[102:103], v7 offset:38912
  v_mfma_f32_16x16x32_bf16 a[16:19], v[132:135], v[64:67], a[16:19]
  buffer_load_dwordx4 v3, s[20:23], s49 offen lds
  v_mfma_f32_16x16x32_bf16 a[20:23], v[132:135], v[68:71], a[20:23]
  ds_read_b128 v[40:43], v4 offset:59392
  v_mfma_f32_16x16x32_bf16 a[24:27], v[132:135], v[72:75], a[24:27]
  ds_read_b64_tr_b16 v[104:105], v8 offset:36864
  s_add_u32 m0, s52, 25600
  v_mfma_f32_16x16x32_bf16 a[28:31], v[132:135], v[76:79], a[28:31]
  ds_read_b64_tr_b16 v[106:107], v8 offset:38912
  v_mfma_f32_16x16x32_bf16 a[32:35], v[136:139], v[64:67], a[32:35]
  ds_read_b128 v[44:47], v4 offset:60416
  v_mfma_f32_16x16x32_bf16 a[36:39], v[136:139], v[68:71], a[36:39]
  buffer_load_dwordx4 v3, s[20:23], s50 offen lds
  v_mfma_f32_16x16x32_bf16 a[40:43], v[136:139], v[72:75], a[40:43]
  ds_read_b64_tr_b16 v[108:109], v9 offset:36864
  ds_read_b64_tr_b16 v[110:111], v9 offset:38912
  v_mfma_f32_16x16x32_bf16 a[44:47], v[136:139], v[76:79], a[44:47]
  s_add_u32 s49, s49, 131072
  v_mfma_f32_16x16x32_bf16 a[48:51], v[140:143], v[64:67], a[48:51]
  s_add_u32 s50, s50, 131072
  v_mfma_f32_16x16x32_bf16 a[52:55], v[140:143], v[68:71], a[52:55]
  v_mfma_f32_16x16x32_bf16 a[56:59], v[140:143], v[72:75], a[56:59]
  v_mfma_f32_16x16x32_bf16 a[60:63], v[140:143], v[76:79], a[60:63]
  s_waitcnt vmcnt(25) lgkmcnt(0)
  s_barrier
  v_mfma_f32_16x16x32_bf16 a[0:3], v[80:83], v[16:19], a[0:3]
  ds_read_b128 v[48:51], v5 offset:0
  s_add_u32 m0, s51, 49152
  v_mfma_f32_16x16x32_bf16 a[4:7], v[80:83], v[20:23], a[4:7]
  ds_read_b64_tr_b16 v[112:113], v6 offset:49152
  v_mfma_f32_16x16x32_bf16 a[8:11], v[80:83], v[24:27], a[8:11]
  buffer_load_dwordx4 v2, s[12:15], s48 offen offset:0 sc1 lds
  v_mfma_f32_16x16x32_bf16 a[12:15], v[80:83], v[28:31], a[12:15]
  ds_read_b64_tr_b16 v[114:115], v6 offset:51200
  ds_read_b128 v[52:55], v5 offset:1024
  v_mfma_f32_16x16x32_bf16 a[16:19], v[84:87], v[16:19], a[16:19]
  buffer_load_dwordx4 v2, s[12:15], s48 offen offset:1024 sc1 lds
  v_mfma_f32_16x16x32_bf16 a[20:23], v[84:87], v[20:23], a[20:23]
  ds_read_b64_tr_b16 v[116:117], v7 offset:49152
  ds_read_b64_tr_b16 v[118:119], v7 offset:51200
  v_mfma_f32_16x16x32_bf16 a[24:27], v[84:87], v[24:27], a[24:27]
  buffer_load_dwordx4 v2, s[12:15], s48 offen offset:2048 sc1 lds
  v_mfma_f32_16x16x32_bf16 a[28:31], v[84:87], v[28:31], a[28:31]
  ds_read_b128 v[56:59], v5 offset:2048
  v_mfma_f32_16x16x32_bf16 a[32:35], v[88:91], v[16:19], a[32:35]
  buffer_load_dwordx4 v2, s[12:15], s48 offen offset:3072 sc1 lds
  v_mfma_f32_16x16x32_bf16 a[36:39], v[88:91], v[20:23], a[36:39]
  ds_read_b64_tr_b16 v[120:121], v8 offset:49152
  ds_read_b64_tr_b16 v[122:123], v8 offset:51200
  v_mfma_f32_16x16x32_bf16 a[40:43], v[88:91], v[24:27], a[40:43]
  s_add_u32 s48, s48, 16384
  ds_read_b128 v[60:63], v5 offset:3072
  v_mfma_f32_16x16x32_bf16 a[44:47], v[88:91], v[28:31], a[44:47]
  ds_read_b64_tr_b16 v[124:125], v9 offset:49152
  s_add_u32 m0, s52, 32768
  v_mfma_f32_16x16x32_bf16 a[48:51], v[92:95], v[16:19], a[48:51]
  ds_read_b64_tr_b16 v[126:127], v9 offset:51200
  v_mfma_f32_16x16x32_bf16 a[52:55], v[92:95], v[20:23], a[52:55]
  buffer_load_dwordx4 v3, s[16:19], s49 offen lds
  v_mfma_f32_16x16x32_bf16 a[56:59], v[92:95], v[24:27], a[56:59]
  ds_read_b128 v[64:67], v5 offset:8192
  v_mfma_f32_16x16x32_bf16 a[60:63], v[92:95], v[28:31], a[60:63]
  ds_read_b64_tr_b16 v[128:129], v6 offset:53248
  s_add_u32 m0, s52, 33792
  v_mfma_f32_16x16x32_bf16 a[0:3], v[96:99], v[32:35], a[0:3]
  ds_read_b64_tr_b16 v[130:131], v6 offset:55296
  v_mfma_f32_16x16x32_bf16 a[4:7], v[96:99], v[36:39], a[4:7]
  buffer_load_dwordx4 v3, s[16:19], s50 offen lds
  v_mfma_f32_16x16x32_bf16 a[8:11], v[96:99], v[40:43], a[8:11]
  ds_read_b128 v[68:71], v5 offset:9216
  ds_read_b64_tr_b16 v[132:133], v7 offset:53248
  v_mfma_f32_16x16x32_bf16 a[12:15], v[96:99], v[44:47], a[12:15]
  s_add_u32 m0, s52, 40960
  ds_read_b64_tr_b16 v[134:135], v7 offset:55296
  v_mfma_f32_16x16x32_bf16 a[16:19], v[100:103], v[32:35], a[16:19]
  buffer_load_dwordx4 v3, s[20:23], s49 offen lds
  v_mfma_f32_16x16x32_bf16 a[20:23], v[100:103], v[36:39], a[20:23]
  ds_read_b128 v[72:75], v5 offset:10240
  v_mfma_f32_16x16x32_bf16 a[24:27], v[100:103], v[40:43], a[24:27]
  ds_read_b64_tr_b16 v[136:137], v8 offset:53248
  s_add_u32 m0, s52, 41984
  v_mfma_f32_16x16x32_bf16 a[28:31], v[100:103], v[44:47], a[28:31]
  ds_read_b64_tr_b16 v[138:139], v8 offset:55296
  v_mfma_f32_16x16x32_bf16 a[32:35], v[104:107], v[32:35], a[32:35]
  ds_read_b128 v[76:79], v5 offset:11264
  v_mfma_f32_16x16x32_bf16 a[36:39], v[104:107], v[36:39], a[36:39]
  buffer_load_dwordx4 v3, s[20:23], s50 offen lds
  v_mfma_f32_16x16x32_bf16 a[40:43], v[104:107], v[40:43], a[40:43]
  ds_read_b64_tr_b16 v[140:141], v9 offset:53248
  ds_read_b64_tr_b16 v[142:143], v9 offset:55296
  v_mfma_f32_16x16x32_bf16 a[44:47], v[104:107], v[44:47], a[44:47]
  s_add_u32 s49, s49, 131072
  v_mfma_f32_16x16x32_bf16 a[48:51], v[108:111], v[32:35], a[48:51]
  s_add_u32 s50, s50, 131072
  v_mfma_f32_16x16x32_bf16 a[52:55], v[108:111], v[36:39], a[52:55]
  v_mfma_f32_16x16x32_bf16 a[56:59], v[108:111], v[40:43], a[56:59]
  v_mfma_f32_16x16x32_bf16 a[60:63], v[108:111], v[44:47], a[60:63]
  s_waitcnt vmcnt(25) lgkmcnt(0)
  s_barrier
  v_mfma_f32_16x16x32_bf16 a[0:3], v[112:115], v[48:51], a[0:3]
  ds_read_b128 v[16:19], v4 offset:0
  s_add_u32 m0, s51, 65536
  v_mfma_f32_16x16x32_bf16 a[4:7], v[112:115], v[52:55], a[4:7]
  ds_read_b64_tr_b16 v[80:81], v10 offset:0
  v_mfma_f32_16x16x32_bf16 a[8:11], v[112:115], v[56:59], a[8:11]
  buffer_load_dwordx4 v2, s[12:15], s48 offen offset:0 sc1 lds
  v_mfma_f32_16x16x32_bf16 a[12:15], v[112:115], v[60:63], a[12:15]
  ds_read_b64_tr_b16 v[82:83], v10 offset:2048
  ds_read_b128 v[20:23], v4 offset:1024
  v_mfma_f32_16x16x32_bf16 a[16:19], v[116:119], v[48:51], a[16:19]
  buffer_load_dwordx4 v2, s[12:15], s48 offen offset:1024 sc1 lds
  v_mfma_f32_16x16x32_bf16 a[20:23], v[116:119], v[52:55], a[20:23]
  ds_read_b64_tr_b16 v[84:85], v11 offset:0
  ds_read_b64_tr_b16 v[86:87], v11 offset:2048
  v_mfma_f32_16x16x32_bf16 a[24:27], v[116:119], v[56:59], a[24:27]
  buffer_load_dwordx4 v2, s[12:15], s48 offen offset:2048 sc1 lds
  v_mfma_f32_16x16x32_bf16 a[28:31], v[116:119], v[60:63], a[28:31]
  ds_read_b128 v[24:27], v4 offset:2048
  v_mfma_f32_16x16x32_bf16 a[32:35], v[120:123], v[48:51], a[32:35]
  buffer_load_dwordx4 v2, s[12:15], s48 offen offset:3072 sc1 lds
  v_mfma_f32_16x16x32_bf16 a[36:39], v[120:123], v[52:55], a[36:39]
  ds_read_b64_tr_b16 v[88:89], v12 offset:0
  ds_read_b64_tr_b16 v[90:91], v12 offset:2048
  v_mfma_f32_16x16x32_bf16 a[40:43], v[120:123], v[56:59], a[40:43]
  s_add_u32 s48, s48, 16384
  ds_read_b128 v[28:31], v4 offset:3072
  v_mfma_f32_16x16x32_bf16 a[44:47], v[120:123], v[60:63], a[44:47]
  ds_read_b64_tr_b16 v[92:93], v13 offset:0
  s_add_u32 m0, s52, 49152
  v_mfma_f32_16x16x32_bf16 a[48:51], v[124:127], v[48:51], a[48:51]
  ds_read_b64_tr_b16 v[94:95], v13 offset:2048
  v_mfma_f32_16x16x32_bf16 a[52:55], v[124:127], v[52:55], a[52:55]
  buffer_load_dwordx4 v3, s[16:19], s49 offen lds
  v_mfma_f32_16x16x32_bf16 a[56:59], v[124:127], v[56:59], a[56:59]
  ds_read_b128 v[32:35], v4 offset:8192
  v_mfma_f32_16x16x32_bf16 a[60:63], v[124:127], v[60:63], a[60:63]
  ds_read_b64_tr_b16 v[96:97], v10 offset:4096
  s_add_u32 m0, s52, 50176
  v_mfma_f32_16x16x32_bf16 a[0:3], v[128:131], v[64:67], a[0:3]
  ds_read_b64_tr_b16 v[98:99], v10 offset:6144
  v_mfma_f32_16x16x32_bf16 a[4:7], v[128:131], v[68:71], a[4:7]
  buffer_load_dwordx4 v3, s[16:19], s50 offen lds
  v_mfma_f32_16x16x32_bf16 a[8:11], v[128:131], v[72:75], a[8:11]
  ds_read_b128 v[36:39], v4 offset:9216
  ds_read_b64_tr_b16 v[100:101], v11 offset:4096
  v_mfma_f32_16x16x32_bf16 a[12:15], v[128:131], v[76:79], a[12:15]
  s_add_u32 m0, s52, 57344
  ds_read_b64_tr_b16 v[102:103], v11 offset:6144
  v_mfma_f32_16x16x32_bf16 a[16:19], v[132:135], v[64:67], a[16:19]
  buffer_load_dwordx4 v3, s[20:23], s49 offen lds
  v_mfma_f32_16x16x32_bf16 a[20:23], v[132:135], v[68:71], a[20:23]
  ds_read_b128 v[40:43], v4 offset:10240
  v_mfma_f32_16x16x32_bf16 a[24:27], v[132:135], v[72:75], a[24:27]
  ds_read_b64_tr_b16 v[104:105], v12 offset:4096
  s_add_u32 m0, s52, 58368
  v_mfma_f32_16x16x32_bf16 a[28:31], v[132:135], v[76:79], a[28:31]
  ds_read_b64_tr_b16 v[106:107], v12 offset:6144
  v_mfma_f32_16x16x32_bf16 a[32:35], v[136:139], v[64:67], a[32:35]
  ds_read_b128 v[44:47], v4 offset:11264
  v_mfma_f32_16x16x32_bf16 a[36:39], v[136:139], v[68:71], a[36:39]
  buffer_load_dwordx4 v3, s[20:23], s50 offen lds
  v_mfma_f32_16x16x32_bf16 a[40:43], v[136:139], v[72:75], a[40:43]
  ds_read_b64_tr_b16 v[108:109], v13 offset:4096
  ds_read_b64_tr_b16 v[110:111], v13 offset:6144
  v_mfma_f32_16x16x32_bf16 a[44:47], v[136:139], v[76:79], a[44:47]
  s_add_u32 s49, s49, 131072
  v_mfma_f32_16x16x32_bf16 a[48:51], v[140:143], v[64:67], a[48:51]
  s_add_u32 s50, s50, 131072
  v_mfma_f32_16x16x32_bf16 a[52:55], v[140:143], v[68:71], a[52:55]
  v_mfma_f32_16x16x32_bf16 a[56:59], v[140:143], v[72:75], a[56:59]
  v_mfma_f32_16x16x32_bf16 a[60:63], v[140:143], v[76:79], a[60:63]
  s_waitcnt vmcnt(25) lgkmcnt(0)
  s_barrier
  v_mfma_f32_16x16x32_bf16 a[0:3], v[80:83], v[16:19], a[0:3]
  ds_read_b128 v[48:51], v4 offset:16384
  s_add_u32 m0, s51, 0
  v_mfma_f32_16x16x32_bf16 a[4:7], v[80:83], v[20:23], a[4:7]
  ds_read_b64_tr_b16 v[112:113], v6 offset:0
  v_mfma_f32_16x16x32_bf16 a[8:11], v[80:83], v[24:27], a[8:11]
  buffer_load_dwordx4 v2, s[12:15], s48 offen offset:0 sc1 lds
  v_mfma_f32_16x16x32_bf16 a[12:15], v[80:83], v[28:31], a[12:15]
  ds_read_b64_tr_b16 v[114:115], v6 offset:2048
  ds_read_b128 v[52:55], v4 offset:17408
  v_mfma_f32_16x16x32_bf16 a[16:19], v[84:87], v[16:19], a[16:19]
  buffer_load_dwordx4 v2, s[12:15], s48 offen offset:1024 sc1 lds
  v_mfma_f32_16x16x32_bf16 a[20:23], v[84:87], v[20:23], a[20:23]
  ds_read_b64_tr_b16 v[116:117], v7 offset:0
  ds_read_b64_tr_b16 v[118:119], v7 offset:2048
  v_mfma_f32_16x16x32_bf16 a[24:27], v[84:87], v[24:27], a[24:27]
  buffer_load_dwordx4 v2, s[12:15], s48 offen offset:2048 sc1 lds
  v_mfma_f32_16x16x32_bf16 a[28:31], v[84:87], v[28:31], a[28:31]
  ds_read_b128 v[56:59], v4 offset:18432
  v_mfma_f32_16x16x32_bf16 a[32:35], v[88:91], v[16:19], a[32:35]
  buffer_load_dwordx4 v2, s[12:15], s48 offen offset:3072 sc1 lds
  v_mfma_f32_16x16x32_bf16 a[36:39], v[88:91], v[20:23], a[36:39]
  ds_read_b64_tr_b16 v[120:121], v8 offset:0
  ds_read_b64_tr_b16 v[122:123], v8 offset:2048
  v_mfma_f32_16x16x32_bf16 a[40:43], v[88:91], v[24:27], a[40:43]
  s_add_u32 s48, s48, 16384
  ds_read_b128 v[60:63], v4 offset:19456
  v_mfma_f32_16x16x32_bf16 a[44:47], v[88:91], v[28:31], a[44:47]
  ds_read_b64_tr_b16 v[124:125], v9 offset:0
  s_add_u32 m0, s52, 65536
  v_mfma_f32_16x16x32_bf16 a[48:51], v[92:95], v[16:19], a[48:51]
  ds_read_b64_tr_b16 v[126:127], v9 offset:2048
  v_mfma_f32_16x16x32_bf16 a[52:55], v[92:95], v[20:23], a[52:55]
  buffer_load_dwordx4 v3, s[16:19], s49 offen lds
  v_mfma_f32_16x16x32_bf16 a[56:59], v[92:95], v[24:27], a[56:59]
  ds_read_b128 v[64:67], v4 offset:24576
  v_mfma_f32_16x16x32_bf16 a[60:63], v[92:95], v[28:31], a[60:63]
  ds_read_b64_tr_b16 v[128:129], v6 offset:4096
  s_add_u32 m0, s52, 66560
  v_mfma_f32_16x16x32_bf16 a[0:3], v[96:99], v[32:35], a[0:3]
  ds_read_b64_tr_b16 v[130:131], v6 offset:6144
  v_mfma_f32_16x16x32_bf16 a[4:7], v[96:99], v[36:39], a[4:7]
  buffer_load_dwordx4 v3, s[16:19], s50 offen lds
  v_mfma_f32_16x16x32_bf16 a[8:11], v[96:99], v[40:43], a[8:11]
  ds_read_b128 v[68:71], v4 offset:25600
  ds_read_b64_tr_b16 v[132:133], v7 offset:4096
  v_mfma_f32_16x16x32_bf16 a[12:15], v[96:99], v[44:47], a[12:15]
  s_add_u32 m0, s52, 73728
  ds_read_b64_tr_b16 v[134:135], v7 offset:6144
  v_mfma_f32_16x16x32_bf16 a[16:19], v[100:103], v[32:35], a[16:19]
  buffer_load_dwordx4 v3, s[20:23], s49 offen lds
  v_mfma_f32_16x16x32_bf16 a[20:23], v[100:103], v[36:39], a[20:23]
  ds_read_b128 v[72:75], v4 offset:26624
  v_mfma_f32_16x16x32_bf16 a[24:27], v[100:103], v[40:43], a[24:27]
  ds_read_b64_tr_b16 v[136:137], v8 offset:4096
  s_add_u32 m0, s52, 74752
  v_mfma_f32_16x16x32_bf16 a[28:31], v[100:103], v[44:47], a[28:31]
  ds_read_b64_tr_b16 v[138:139], v8 offset:6144
  v_mfma_f32_16x16x32_bf16 a[32:35], v[104:107], v[32:35], a[32:35]
  ds_read_b128 v[76:79], v4 offset:27648
  v_mfma_f32_16x16x32_bf16 a[36:39], v[104:107], v[36:39], a[36:39]
  buffer_load_dwordx4 v3, s[20:23], s50 offen lds
  v_mfma_f32_16x16x32_bf16 a[40:43], v[104:107], v[40:43], a[40:43]
  ds_read_b64_tr_b16 v[140:141], v9 offset:4096
  ds_read_b64_tr_b16 v[142:143], v9 offset:6144
  v_mfma_f32_16x16x32_bf16 a[44:47], v[104:107], v[44:47], a[44:47]
  s_add_u32 s49, s49, 131072
  v_mfma_f32_16x16x32_bf16 a[48:51], v[108:111], v[32:35], a[48:51]
  s_add_u32 s50, s50, 131072
  v_mfma_f32_16x16x32_bf16 a[52:55], v[108:111], v[36:39], a[52:55]
  v_mfma_f32_16x16x32_bf16 a[56:59], v[108:111], v[40:43], a[56:59]
  v_mfma_f32_16x16x32_bf16 a[60:63], v[108:111], v[44:47], a[60:63]
  s_waitcnt vmcnt(24) lgkmcnt(0)
  s_barrier
  s_mov_b32 s67, 0
chk_20:
  v_cmp_eq_u32 vcc, s76, v200
  v_cmp_eq_u32 s[68:69], s77, v201
  s_nop 1
  s_and_b64 vcc, vcc, s[68:69]
  s_cmp_eq_u64 vcc, exec
  s_cbranch_scc1 chk_20_ok
  s_add_u32 s67, s67, 1
  s_cmp_ge_u32 s67, 0x40000
  s_cbranch_scc1 chk_20_ok
  s_sleep 1
  buffer_load_dwordx2 v[200:201], v202, s[72:75], 0 offen sc1
  s_waitcnt vmcnt(0)
  s_branch chk_20
chk_20_ok:
  v_mfma_f32_16x16x32_bf16 a[0:3], v[112:115], v[48:51], a[0:3]
  ds_read_b128 v[16:19], v4 offset:32768
  s_mov_b32 s48, 655360
  v_mfma_f32_16x16x32_bf16 a[4:7], v[112:115], v[52:55], a[4:7]
  ds_read_b64_tr_b16 v[80:81], v6 offset:16384
  s_mov_b32 s49, 5242880
  v_mfma_f32_16x16x32_bf16 a[8:11], v[112:115], v[56:59], a[8:11]
  ds_read_b64_tr_b16 v[82:83], v6 offset:18432
  v_mfma_f32_16x16x32_bf16 a[12:15], v[112:115], v[60:63], a[12:15]
  ds_read_b128 v[20:23], v4 offset:33792
  s_mov_b32 s50, 5259264
  v_mfma_f32_16x16x32_bf16 a[16:19], v[116:119], v[48:51], a[16:19]
  ds_read_b64_tr_b16 v[84:85], v7 offset:16384
  s_add_u32 m0, s51, 16384
  v_mfma_f32_16x16x32_bf16 a[20:23], v[116:119], v[52:55], a[20:23]
  ds_read_b64_tr_b16 v[86:87], v7 offset:18432
  v_mfma_f32_16x16x32_bf16 a[24:27], v[116:119], v[56:59], a[24:27]
  buffer_load_dwordx4 v2, s[12:15], s48 offen offset:0 sc1 lds
  v_mfma_f32_16x16x32_bf16 a[28:31], v[116:119], v[60:63], a[28:31]
  ds_read_b128 v[24:27], v4 offset:34816
  v_mfma_f32_16x16x32_bf16 a[32:35], v[120:123], v[48:51], a[32:35]
  buffer_load_dwordx4 v2, s[12:15], s48 offen offset:1024 sc1 lds
  v_mfma_f32_16x16x32_bf16 a[36:39], v[120:123], v[52:55], a[36:39]
  ds_read_b64_tr_b16 v[88:89], v8 offset:16384
  ds_read_b64_tr_b16 v[90:91], v8 offset:18432
  v_mfma_f32_16x16x32_bf16 a[40:43], v[120:123], v[56:59], a[40:43]
  buffer_load_dwordx4 v2, s[12:15], s48 offen offset:2048 sc1 lds
  v_mfma_f32_16x16x32_bf16 a[44:47], v[120:123], v[60:63], a[44:47]
  ds_read_b128 v[28:31], v4 offset:35840
  ds_read_b64_tr_b16 v[92:93], v9 offset:16384
  v_mfma_f32_16x16x32_bf16 a[48:51], v[124:127], v[48:51], a[48:51]
  buffer_load_dwordx4 v2, s[12:15], s48 offen offset:3072 sc1 lds
  v_mfma_f32_16x16x32_bf16 a[52:55], v[124:127], v[52:55], a[52:55]
  ds_read_b64_tr_b16 v[94:95], v9 offset:18432
  s_add_u32 s48, s48, 16384
  v_mfma_f32_16x16x32_bf16 a[56:59], v[124:127], v[56:59], a[56:59]
  ds_read_b128 v[32:35], v4 offset:40960
  s_add_u32 m0, s52, 0
  v_mfma_f32_16x16x32_bf16 a[60:63], v[124:127], v[60:63], a[60:63]
  ds_read_b64_tr_b16 v[96:97], v6 offset:20480
  v_mfma_f32_16x16x32_bf16 a[0:3], v[128:131], v[64:67], a[0:3]
  buffer_load_dwordx4 v3, s[16:19], s49 offen lds
  v_mfma_f32_16x16x32_bf16 a[4:7], v[128:131], v[68:71], a[4:7]
  ds_read_b64_tr_b16 v[98:99], v6 offset:22528
  ds_read_b128 v[36:39], v4 offset:41984
  v_mfma_f32_16x16x32_bf16 a[8:11], v[128:131], v[72:75], a[8:11]
  s_add_u32 m0, s52, 1024
  ds_read_b64_tr_b16 v[100:101], v7 offset:20480
  v_mfma_f32_16x16x32_bf16 a[12:15], v[128:131], v[76:79], a[12:15]
  buffer_load_dwordx4 v3, s[16:19], s50 offen lds
  v_mfma_f32_16x16x32_bf16 a[16:19], v[132:135], v[64:67], a[16:19]
  ds_read_b64_tr_b16 v[102:103], v7 offset:22528
  s_add_u32 m0, s52, 8192
  v_mfma_f32_16x16x32_bf16 a[20:23], v[132:135], v[68:71], a[20:23]
  ds_read_b128 v[40:43], v4 offset:43008
  v_mfma_f32_16x16x32_bf16 a[24:27], v[132:135], v[72:75], a[24:27]
  ds_read_b64_tr_b16 v[104:105], v8 offset:20480
  v_mfma_f32_16x16x32_bf16 a[28:31], v[132:135], v[76:79], a[28:31]
  buffer_load_dwordx4 v3, s[20:23], s49 offen lds
  v_mfma_f32_16x16x32_bf16 a[32:35], v[136:139], v[64:67], a[32:35]
  ds_read_b64_tr_b16 v[106:107], v8 offset:22528
  s_add_u32 m0, s52, 9216
  v_mfma_f32_16x16x32_bf16 a[36:39], v[136:139], v[68:71], a[36:39]
  ds_read_b128 v[44:47], v4 offset:44032
  ds_read_b64_tr_b16 v[108:109], v9 offset:20480
  v_mfma_f32_16x16x32_bf16 a[40:43], v[136:139], v[72:75], a[40:43]
  buffer_load_dwordx4 v3, s[20:23], s50 offen lds
  v_mfma_f32_16x16x32_bf16 a[44:47], v[136:139], v[76:79], a[44:47]
  ds_read_b64_tr_b16 v[110:111], v9 offset:22528
  s_add_u32 s49, s49, 131072
  v_mfma_f32_16x16x32_bf16 a[48:51], v[140:143], v[64:67], a[48:51]
  s_add_u32 s50, s50, 131072
  v_mfma_f32_16x16x32_bf16 a[52:55], v[140:143], v[68:71], a[52:55]
  v_mfma_f32_16x16x32_bf16 a[56:59], v[140:143], v[72:75], a[56:59]
  v_mfma_f32_16x16x32_bf16 a[60:63], v[140:143], v[76:79], a[60:63]
  s_waitcnt vmcnt(24) lgkmcnt(0)
  s_barrier
  v_mfma_f32_16x16x32_bf16 a[0:3], v[80:83], v[16:19], a[0:3]
  ds_read_b128 v[48:51], v4 offset:49152
  s_add_u32 m0, s51, 32768
  v_mfma_f32_16x16x32_bf16 a[4:7], v[80:83], v[20:23], a[4:7]
  ds_read_b64_tr_b16 v[112:113], v6 offset:32768
  v_mfma_f32_16x16x32_bf16 a[8:11], v[80:83], v[24:27], a[8:11]
  buffer_load_dwordx4 v2, s[12:15], s48 offen offset:0 sc1 lds
  v_mfma_f32_16x16x32_bf16 a[12:15], v[80:83], v[28:31], a[12:15]
  ds_read_b64_tr_b16 v[114:115], v6 offset:34816
  ds_read_b128 v[52:55], v4 offset:50176
  v_mfma_f32_16x16x32_bf16 a[16:19], v[84:87], v[16:19], a[16:19]
  buffer_load_dwordx4 v2, s[12:15], s48 offen offset:1024 sc1 lds
  v_mfma_f32_16x16x32_bf16 a[20:23], v[84:87], v[20:23], a[20:23]
  ds_read_b64_tr_b16 v[116:117], v7 offset:32768
  ds_read_b64_tr_b16 v[118:119], v7 offset:34816
  v_mfma_f32_16x16x32_bf16 a[24:27], v[84:87], v[24:27], a[24:27]
  buffer_load_dwordx4 v2, s[12:15], s48 offen offset:2048 sc1 lds
  v_mfma_f32_16x16x32_bf16 a[28:31], v[84:87], v[28:31], a[28:31]
  ds_read_b128 v[56:59], v4 offset:51200
  v_mfma_f32_16x16x32_bf16 a[32:35], v[88:91], v[16:19], a[32:35]
  buffer_load_dwordx4 v2, s[12:15], s48 offen offset:3072 sc1 lds
  v_mfma_f32_16x16x32_bf16 a[36:39], v[88:91], v[20:23], a[36:39]
  ds_read_b64_tr_b16 v[120:121], v8 offset:32768
  ds_read_b64_tr_b16 v[122:123], v8 offset:34816
  v_mfma_f32_16x16x32_bf16 a[40:43], v[88:91], v[24:27], a[40:43]
  s_add_u32 s48, s48, 16384
  ds_read_b128 v[60:63], v4 offset:52224
  v_mfma_f32_16x16x32_bf16 a[44:47], v[88:91], v[28:31], a[44:47]
  ds_read_b64_tr_b16 v[124:125], v9 offset:32768
  s_add_u32 m0, s52, 16384
  v_mfma_f32_16x16x32_bf16 a[48:51], v[92:95], v[16:19], a[48:51]
  ds_read_b64_tr_b16 v[126:127], v9 offset:34816
  v_mfma_f32_16x16x32_bf16 a[52:55], v[92:95], v[20:23], a[52:55]
  buffer_load_dwordx4 v3, s[16:19], s49 offen lds
  v_mfma_f32_16x16x32_bf16 a[56:59], v[92:95], v[24:27], a[56:59]
  ds_read_b128 v[64:67], v4 offset:57344
  v_mfma_f32_16x16x32_bf16 a[60:63], v[92:95], v[28:31], a[60:63]
  ds_read_b64_tr_b16 v[128:129], v6 offset:36864
  s_add_u32 m0, s52, 17408
  v_mfma_f32_16x16x32_bf16 a[0:3], v[96:99], v[32:35], a[0:3]
  ds_read_b64_tr_b16 v[130:131], v6 offset:38912
  v_mfma_f32_16x16x32_bf16 a[4:7], v[96:99], v[36:39], a[4:7]
  buffer_load_dwordx4 v3, s[16:19], s50 offen lds
  v_mfma_f32_16x16x32_bf16 a[8:11], v[96:99], v[40:43], a[8:11]
  ds_read_b128 v[68:71], v4 offset:58368
  ds_read_b64_tr_b16 v[132:133], v7 offset:36864
  v_mfma_f32_16x16x32_bf16 a[12:15], v[96:99], v[44:47], a[12:15]
  s_add_u32 m0, s52, 24576
  ds_read_b64_tr_b16 v[134:135], v7 offset:38912
  v_mfma_f32_16x16x32_bf16 a[16:19], v[100:103], v[32:35], a[16:19]
  buffer_load_dwordx4 v3, s[20:23], s49 offen lds
  v_mfma_f32_16x16x32_bf16 a[20:23], v[100:103], v[36:39], a[20:23]
  ds_read_b128 v[72:75], v4 offset:59392
  v_mfma_f32_16x16x32_bf16 a[24:27], v[100:103], v[40:43], a[24:27]
  ds_read_b64_tr_b16 v[136:137], v8 offset:36864
  s_add_u32 m0, s52, 25600
  v_mfma_f32_16x16x32_bf16 a[28:31], v[100:103], v[44:47], a[28:31]
  ds_read_b64_tr_b16 v[138:139], v8 offset:38912
  v_mfma_f32_16x16x32_bf16 a[32:35], v[104:107], v[32:35], a[32:35]
  ds_read_b128 v[76:79], v4 offset:60416
  v_mfma_f32_16x16x32_bf16 a[36:39], v[104:107], v[36:39], a[36:39]
  buffer_load_dwordx4 v3, s[20:23], s50 offen lds
  v_mfma_f32_16x16x32_bf16 a[40:43], v[104:107], v[40:43], a[40:43]
  ds_read_b64_tr_b16 v[140:141], v9 offset:36864
  ds_read_b64_tr_b16 v[142:143], v9 offset:38912
  v_mfma_f32_16x16x32_bf16 a[44:47], v[104:107], v[44:47], a[44:47]
  s_add_u32 s49, s49, 131072
  v_mfma_f32_16x16x32_bf16 a[48:51], v[108:111], v[32:35], a[48:51]
  s_add_u32 s50, s50, 131072
  v_mfma_f32_16x16x32_bf16 a[52:55], v[108:111], v[36:39], a[52:55]
  v_mfma_f32_16x16x32_bf16 a[56:59], v[108:111], v[40:43], a[56:59]
  v_mfma_f32_16x16x32_bf16 a[60:63], v[108:111], v[44:47], a[60:63]
  s_waitcnt vmcnt(24) lgkmcnt(0)
  s_barrier
  v_mfma_f32_16x16x32_bf16 a[0:3], v[112:115], v[48:51], a[0:3]
  ds_read_b128 v[16:19], v5 offset:0
  s_add_u32 m0, s51, 49152
  v_mfma_f32_16x16x32_bf16 a[4:7], v[112:115], v[52:55], a[4:7]
  ds_read_b64_tr_b16 v[80:81], v6 offset:49152
  v_mfma_f32_16x16x32_bf16 a[8:11], v[112:115], v[56:59], a[8:11]
  buffer_load_dwordx4 v2, s[12:15], s48 offen offset:0 sc1 lds
  v_mfma_f32_16x16x32_bf16 a[12:15], v[112:115], v[60:63], a[12:15]
  ds_read_b64_tr_b16 v[82:83], v6 offset:51200
  ds_read_b128 v[20:23], v5 offset:1024
  v_mfma_f32_16x16x32_bf16 a[16:19], v[116:119], v[48:51], a[16:19]
  buffer_load_dwordx4 v2, s[12:15], s48 offen offset:1024 sc1 lds
  v_mfma_f32_16x16x32_bf16 a[20:23], v[116:119], v[52:55], a[20:23]
  ds_read_b64_tr_b16 v[84:85], v7 offset:49152
  ds_read_b64_tr_b16 v[86:87], v7 offset:51200
  v_mfma_f32_16x16x32_bf16 a[24:27], v[116:119], v[56:59], a[24:27]
  buffer_load_dwordx4 v2, s[12:15], s48 offen offset:2048 sc1 lds
  v_mfma_f32_16x16x32_bf16 a[28:31], v[116:119], v[60:63], a[28:31]
  ds_read_b128 v[24:27], v5 offset:2048
  v_mfma_f32_16x16x32_bf16 a[32:35], v[120:123], v[48:51], a[32:35]
  buffer_load_dwordx4 v2, s[12:15], s48 offen offset:3072 sc1 lds
  v_mfma_f32_16x16x32_bf16 a[36:39], v[120:123], v[52:55], a[36:39]
  ds_read_b64_tr_b16 v[88:89], v8 offset:49152
  ds_read_b64_tr_b16 v[90:91], v8 offset:51200
  v_mfma_f32_16x16x32_bf16 a[40:43], v[120:123], v[56:59], a[40:43]
  s_add_u32 s48, s48, 16384
  ds_read_b128 v[28:31], v5 offset:3072
  v_mfma_f32_16x16x32_bf16 a[44:47], v[120:123], v[60:63], a[44:47]
  ds_read_b64_tr_b16 v[92:93], v9 offset:49152
  s_add_u32 m0, s52, 32768
  v_mfma_f32_16x16x32_bf16 a[48:51], v[124:127], v[48:51], a[48:51]
  ds_read_b64_tr_b16 v[94:95], v9 offset:51200
  v_mfma_f32_16x16x32_bf16 a[52:55], v[124:127], v[52:55], a[52:55]
  buffer_load_dwordx4 v3, s[16:19], s49 offen lds
  v_mfma_f32_16x16x32_bf16 a[56:59], v[124:127], v[56:59], a[56:59]
  ds_read_b128 v[32:35], v5 offset:8192
  v_mfma_f32_16x16x32_bf16 a[60:63], v[124:127], v[60:63], a[60:63]
  ds_read_b64_tr_b16 v[96:97], v6 offset:53248
  s_add_u32 m0, s52, 33792
  v_mfma_f32_16x16x32_bf16 a[0:3], v[128:131], v[64:67], a[0:3]
  ds_read_b64_tr_b16 v[98:99], v6 offset:55296
  v_mfma_f32_16x16x32_bf16 a[4:7], v[128:131], v[68:71], a[4:7]
  buffer_load_dwordx4 v3, s[16:19], s50 offen lds
  v_mfma_f32_16x16x32_bf16 a[8:11], v[128:131], v[72:75], a[8:11]
  ds_read_b128 v[36:39], v5 offset:9216
  ds_read_b64_tr_b16 v[100:101], v7 offset:53248
  v_mfma_f32_16x16x32_bf16 a[12:15], v[128:131], v[76:79], a[12:15]
  s_add_u32 m0, s52, 40960
  ds_read_b64_tr_b16 v[102:103], v7 offset:55296
  v_mfma_f32_16x16x32_bf16 a[16:19], v[132:135], v[64:67], a[16:19]
  buffer_load_dwordx4 v3, s[20:23], s49 offen lds
  v_mfma_f32_16x16x32_bf16 a[20:23], v[132:135], v[68:71], a[20:23]
  ds_read_b128 v[40:43], v5 offset:10240
  v_mfma_f32_16x16x32_bf16 a[24:27], v[132:135], v[72:75], a[24:27]
  ds_read_b64_tr_b16 v[104:105], v8 offset:53248
  s_add_u32 m0, s52, 41984
  v_mfma_f32_16x16x32_bf16 a[28:31], v[132:135], v[76:79], a[28:31]
  ds_read_b64_tr_b16 v[106:107], v8 offset:55296
  v_mfma_f32_16x16x32_bf16 a[32:35], v[136:139], v[64:67], a[32:35]
  ds_read_b128 v[44:47], v5 offset:11264
  v_mfma_f32_16x16x32_bf16 a[36:39], v[136:139], v[68:71], a[36:39]
  buffer_load_dwordx4 v3, s[20:23], s50 offen lds
  v_mfma_f32_16x16x32_bf16 a[40:43], v[136:139], v[72:75], a[40:43]
  ds_read_b64_tr_b16 v[108:109], v9 offset:53248
  ds_read_b64_tr_b16 v[110:111], v9 offset:55296
  v_mfma_f32_16x16x32_bf16 a[44:47], v[136:139], v[76:79], a[44:47]
  s_add_u32 s49, s49, 131072
  v_mfma_f32_16x16x32_bf16 a[48:51], v[140:143], v[64:67], a[48:51]
  s_add_u32 s50, s50, 131072
  v_mfma_f32_16x16x32_bf16 a[52:55], v[140:143], v[68:71], a[52:55]
  v_mfma_f32_16x16x32_bf16 a[56:59], v[140:143], v[72:75], a[56:59]
  v_mfma_f32_16x16x32_bf16 a[60:63], v[140:143], v[76:79], a[60:63]
  s_waitcnt vmcnt(24) lgkmcnt(0)
  s_barrier
  v_mfma_f32_16x16x32_bf16 a[0:3], v[80:83], v[16:19], a[0:3]
  ds_read_b128 v[48:51], v4 offset:0
  s_add_u32 m0, s51, 65536
  v_mfma_f32_16x16x32_bf16 a[4:7], v[80:83], v[20:23], a[4:7]
  ds_read_b64_tr_b16 v[112:113], v10 offset:0
  v_mfma_f32_16x16x32_bf16 a[8:11], v[80:83], v[24:27], a[8:11]
  buffer_load_dwordx4 v2, s[12:15], s48 offen offset:0 sc1 lds
  v_mfma_f32_16x16x32_bf16 a[12:15], v[80:83], v[28:31], a[12:15]
  ds_read_b64_tr_b16 v[114:115], v10 offset:2048
  ds_read_b128 v[52:55], v4 offset:1024
  v_mfma_f32_16x16x32_bf16 a[16:19], v[84:87], v[16:19], a[16:19]
  buffer_load_dwordx4 v2, s[12:15], s48 offen offset:1024 sc1 lds
  v_mfma_f32_16x16x32_bf16 a[20:23], v[84:87], v[20:23], a[20:23]
  ds_read_b64_tr_b16 v[116:117], v11 offset:0
  ds_read_b64_tr_b16 v[118:119], v11 offset:2048
  v_mfma_f32_16x16x32_bf16 a[24:27], v[84:87], v[24:27], a[24:27]
  buffer_load_dwordx4 v2, s[12:15], s48 offen offset:2048 sc1 lds
  v_mfma_f32_16x16x32_bf16 a[28:31], v[84:87], v[28:31], a[28:31]
  ds_read_b128 v[56:59], v4 offset:2048
  v_mfma_f32_16x16x32_bf16 a[32:35], v[88:91], v[16:19], a[32:35]
  buffer_load_dwordx4 v2, s[12:15], s48 offen offset:3072 sc1 lds
  v_mfma_f32_16x16x32_bf16 a[36:39], v[88:91], v[20:23], a[36:39]
  ds_read_b64_tr_b16 v[120:121], v12 offset:0
  ds_read_b64_tr_b16 v[122:123], v12 offset:2048
  v_mfma_f32_16x16x32_bf16 a[40:43], v[88:91], v[24:27], a[40:43]
  s_add_u32 s48, s48, 16384
  ds_read_b128 v[60:63], v4 offset:3072
  v_mfma_f32_16x16x32_bf16 a[44:47], v[88:91], v[28:31], a[44:47]
  ds_read_b64_tr_b16 v[124:125], v13 offset:0
  s_add_u32 m0, s52, 49152
  v_mfma_f32_16x16x32_bf16 a[48:51], v[92:95], v[16:19], a[48:51]
  ds_read_b64_tr_b16 v[126:127], v13 offset:2048
  v_mfma_f32_16x16x32_bf16 a[52:55], v[92:95], v[20:23], a[52:55]
  buffer_load_dwordx4 v3, s[16:19], s49 offen lds
  v_mfma_f32_16x16x32_bf16 a[56:59], v[92:95], v[24:27], a[56:59]
  ds_read_b128 v[64:67], v4 offset:8192
  v_mfma_f32_16x16x32_bf16 a[60:63], v[92:95], v[28:31], a[60:63]
  ds_read_b64_tr_b16 v[128:129], v10 offset:4096
  s_add_u32 m0, s52, 50176
  v_mfma_f32_16x16x32_bf16 a[0:3], v[96:99], v[32:35], a[0:3]
  ds_read_b64_tr_b16 v[130:131], v10 offset:6144
  v_mfma_f32_16x16x32_bf16 a[4:7], v[96:99], v[36:39], a[4:7]
  buffer_load_dwordx4 v3, s[16:19], s50 offen lds
  v_mfma_f32_16x16x32_bf16 a[8:11], v[96:99], v[40:43], a[8:11]
  ds_read_b128 v[68:71], v4 offset:9216
  ds_read_b64_tr_b16 v[132:133], v11 offset:4096
  v_mfma_f32_16x16x32_bf16 a[12:15], v[96:99], v[44:47], a[12:15]
  s_add_u32 m0, s52, 57344
  ds_read_b64_tr_b16 v[134:135], v11 offset:6144
  v_mfma_f32_16x16x32_bf16 a[16:19], v[100:103], v[32:35], a[16:19]
  buffer_load_dwordx4 v3, s[20:23], s49 offen lds
  v_mfma_f32_16x16x32_bf16 a[20:23], v[100:103], v[36:39], a[20:23]
  ds_read_b128 v[72:75], v4 offset:10240
  v_mfma_f32_16x16x32_bf16 a[24:27], v[100:103], v[40:43], a[24:27]
  ds_read_b64_tr_b16 v[136:137], v12 offset:4096
  s_add_u32 m0, s52, 58368
  v_mfma_f32_16x16x32_bf16 a[28:31], v[100:103], v[44:47], a[28:31]
  ds_read_b64_tr_b16 v[138:139], v12 offset:6144
  v_mfma_f32_16x16x32_bf16 a[32:35], v[104:107], v[32:35], a[32:35]
  ds_read_b128 v[76:79], v4 offset:11264
  v_mfma_f32_16x16x32_bf16 a[36:39], v[104:107], v[36:39], a[36:39]
  buffer_load_dwordx4 v3, s[20:23], s50 offen lds
  v_mfma_f32_16x16x32_bf16 a[40:43], v[104:107], v[40:43], a[40:43]
  ds_read_b64_tr_b16 v[140:141], v13 offset:4096
  ds_read_b64_tr_b16 v[142:143], v13 offset:6144
  v_mfma_f32_16x16x32_bf16 a[44:47], v[104:107], v[44:47], a[44:47]
  s_add_u32 s49, s49, 131072
  v_mfma_f32_16x16x32_bf16 a[48:51], v[108:111], v[32:35], a[48:51]
  s_add_u32 s50, s50, 131072
  v_mfma_f32_16x16x32_bf16 a[52:55], v[108:111], v[36:39], a[52:55]
  v_mfma_f32_16x16x32_bf16 a[56:59], v[108:111], v[40:43], a[56:59]
  v_mfma_f32_16x16x32_bf16 a[60:63], v[108:111], v[44:47], a[60:63]
  s_waitcnt vmcnt(24) lgkmcnt(0)
  s_barrier
  v_mfma_f32_16x16x32_bf16 a[0:3], v[112:115], v[48:51], a[0:3]
  ds_read_b128 v[16:19], v4 offset:16384
  s_add_u32 m0, s51, 0
  v_mfma_f32_16x16x32_bf16 a[4:7], v[112:115], v[52:55], a[4:7]
  ds_read_b64_tr_b16 v[80:81], v6 offset:0
  v_mfma_f32_16x16x32_bf16 a[8:11], v[112:115], v[56:59], a[8:11]
  buffer_load_dwordx4 v2, s[12:15], s48 offen offset:0 sc1 lds
  v_mfma_f32_16x16x32_bf16 a[12:15], v[112:115], v[60:63], a[12:15]
  ds_read_b64_tr_b16 v[82:83], v6 offset:2048
  ds_read_b128 v[20:23], v4 offset:17408
  v_mfma_f32_16x16x32_bf16 a[16:19], v[116:119], v[48:51], a[16:19]
  buffer_load_dwordx4 v2, s[12:15], s48 offen offset:1024 sc1 lds
  v_mfma_f32_16x16x32_bf16 a[20:23], v[116:119], v[52:55], a[20:23]
  ds_read_b64_tr_b16 v[84:85], v7 offset:0
  ds_read_b64_tr_b16 v[86:87], v7 offset:2048
  v_mfma_f32_16x16x32_bf16 a[24:27], v[116:119], v[56:59], a[24:27]
  buffer_load_dwordx4 v2, s[12:15], s48 offen offset:2048 sc1 lds
  v_mfma_f32_16x16x32_bf16 a[28:31], v[116:119], v[60:63], a[28:31]
  ds_read_b128 v[24:27], v4 offset:18432
  v_mfma_f32_16x16x32_bf16 a[32:35], v[120:123], v[48:51], a[32:35]
  buffer_load_dwordx4 v2, s[12:15], s48 offen offset:3072 sc1 lds
  v_mfma_f32_16x16x32_bf16 a[36:39], v[120:123], v[52:55], a[36:39]
  ds_read_b64_tr_b16 v[88:89], v8 offset:0
  ds_read_b64_tr_b16 v[90:91], v8 offset:2048
  v_mfma_f32_16x16x32_bf16 a[40:43], v[120:123], v[56:59], a[40:43]
  s_add_u32 s48, s48, 16384
  ds_read_b128 v[28:31], v4 offset:19456
  v_mfma_f32_16x16x32_bf16 a[44:47], v[120:123], v[60:63], a[44:47]
  ds_read_b64_tr_b16 v[92:93], v9 offset:0
  s_add_u32 m0, s52, 65536
  v_mfma_f32_16x16x32_bf16 a[48:51], v[124:127], v[48:51], a[48:51]
  ds_read_b64_tr_b16 v[94:95], v9 offset:2048
  v_mfma_f32_16x16x32_bf16 a[52:55], v[124:127], v[52:55], a[52:55]
  buffer_load_dwordx4 v3, s[16:19], s49 offen lds
  v_mfma_f32_16x16x32_bf16 a[56:59], v[124:127], v[56:59], a[56:59]
  ds_read_b128 v[32:35], v4 offset:24576
  v_mfma_f32_16x16x32_bf16 a[60:63], v[124:127], v[60:63], a[60:63]
  ds_read_b64_tr_b16 v[96:97], v6 offset:4096
  s_add_u32 m0, s52, 66560
  v_mfma_f32_16x16x32_bf16 a[0:3], v[128:131], v[64:67], a[0:3]
  ds_read_b64_tr_b16 v[98:99], v6 offset:6144
  v_mfma_f32_16x16x32_bf16 a[4:7], v[128:131], v[68:71], a[4:7]
  buffer_load_dwordx4 v3, s[16:19], s50 offen lds
  v_mfma_f32_16x16x32_bf16 a[8:11], v[128:131], v[72:75], a[8:11]
  ds_read_b128 v[36:39], v4 offset:25600
  ds_read_b64_tr_b16 v[100:101], v7 offset:4096
  v_mfma_f32_16x16x32_bf16 a[12:15], v[128:131], v[76:79], a[12:15]
  s_add_u32 m0, s52, 73728
  ds_read_b64_tr_b16 v[102:103], v7 offset:6144
  v_mfma_f32_16x16x32_bf16 a[16:19], v[132:135], v[64:67], a[16:19]
  buffer_load_dwordx4 v3, s[20:23], s49 offen lds
  v_mfma_f32_16x16x32_bf16 a[20:23], v[132:135], v[68:71], a[20:23]
  ds_read_b128 v[40:43], v4 offset:26624
  v_mfma_f32_16x16x32_bf16 a[24:27], v[132:135], v[72:75], a[24:27]
  ds_read_b64_tr_b16 v[104:105], v8 offset:4096
  s_add_u32 m0, s52, 74752
  v_mfma_f32_16x16x32_bf16 a[28:31], v[132:135], v[76:79], a[28:31]
  ds_read_b64_tr_b16 v[106:107], v8 offset:6144
  v_mfma_f32_16x16x32_bf16 a[32:35], v[136:139], v[64:67], a[32:35]
  ds_read_b128 v[44:47], v4 offset:27648
  v_mfma_f32_16x16x32_bf16 a[36:39], v[136:139], v[68:71], a[36:39]
  buffer_load_dwordx4 v3, s[20:23], s50 offen lds
  v_mfma_f32_16x16x32_bf16 a[40:43], v[136:139], v[72:75], a[40:43]
  ds_read_b64_tr_b16 v[108:109], v9 offset:4096
  ds_read_b64_tr_b16 v[110:111], v9 offset:6144
  v_mfma_f32_16x16x32_bf16 a[44:47], v[136:139], v[76:79], a[44:47]
  s_add_u32 s49, s49, 131072
  v_mfma_f32_16x16x32_bf16 a[48:51], v[140:143], v[64:67], a[48:51]
  s_add_u32 s50, s50, 131072
  v_mfma_f32_16x16x32_bf16 a[52:55], v[140:143], v[68:71], a[52:55]
  v_mfma_f32_16x16x32_bf16 a[56:59], v[140:143], v[72:75], a[56:59]
  v_mfma_f32_16x16x32_bf16 a[60:63], v[140:143], v[76:79], a[60:63]
  s_waitcnt vmcnt(24) lgkmcnt(0)
  s_barrier
  v_mfma_f32_16x16x32_bf16 a[0:3], v[80:83], v[16:19], a[0:3]
  ds_read_b128 v[48:51], v4 offset:32768
  s_add_u32 m0, s51, 16384
  v_mfma_f32_16x16x32_bf16 a[4:7], v[80:83], v[20:23], a[4:7]
  ds_read_b64_tr_b16 v[112:113], v6 offset:16384
  v_mfma_f32_16x16x32_bf16 a[8:11], v[80:83], v[24:27], a[8:11]
  buffer_load_dwordx4 v2, s[12:15], s48 offen offset:0 sc1 lds
  v_mfma_f32_16x16x32_bf16 a[12:15], v[80:83], v[28:31], a[12:15]
  ds_read_b64_tr_b16 v[114:115], v6 offset:18432
  ds_read_b128 v[52:55], v4 offset:33792
  v_mfma_f32_16x16x32_bf16 a[16:19], v[84:87], v[16:19], a[16:19]
  buffer_load_dwordx4 v2, s[12:15], s48 offen offset:1024 sc1 lds
  v_mfma_f32_16x16x32_bf16 a[20:23], v[84:87], v[20:23], a[20:23]
  ds_read_b64_tr_b16 v[116:117], v7 offset:16384
  ds_read_b64_tr_b16 v[118:119], v7 offset:18432
  v_mfma_f32_16x16x32_bf16 a[24:27], v[84:87], v[24:27], a[24:27]
  buffer_load_dwordx4 v2, s[12:15], s48 offen offset:2048 sc1 lds
  v_mfma_f32_16x16x32_bf16 a[28:31], v[84:87], v[28:31], a[28:31]
  ds_read_b128 v[56:59], v4 offset:34816
  v_mfma_f32_16x16x32_bf16 a[32:35], v[88:91], v[16:19], a[32:35]
  buffer_load_dwordx4 v2, s[12:15], s48 offen offset:3072 sc1 lds
  v_mfma_f32_16x16x32_bf16 a[36:39], v[88:91], v[20:23], a[36:39]
  ds_read_b64_tr_b16 v[120:121], v8 offset:16384
  ds_read_b64_tr_b16 v[122:123], v8 offset:18432
  v_mfma_f32_16x16x32_bf16 a[40:43], v[88:91], v[24:27], a[40:43]
  s_add_u32 s48, s48, 16384
  ds_read_b128 v[60:63], v4 offset:35840
  v_mfma_f32_16x16x32_bf16 a[44:47], v[88:91], v[28:31], a[44:47]
  ds_read_b64_tr_b16 v[124:125], v9 offset:16384
  s_add_u32 m0, s52, 0
  v_mfma_f32_16x16x32_bf16 a[48:51], v[92:95], v[16:19], a[48:51]
  ds_read_b64_tr_b16 v[126:127], v9 offset:18432
  v_mfma_f32_16x16x32_bf16 a[52:55], v[92:95], v[20:23], a[52:55]
  buffer_load_dwordx4 v3, s[16:19], s49 offen lds
  v_mfma_f32_16x16x32_bf16 a[56:59], v[92:95], v[24:27], a[56:59]
  ds_read_b128 v[64:67], v4 offset:40960
  v_mfma_f32_16x16x32_bf16 a[60:63], v[92:95], v[28:31], a[60:63]
  ds_read_b64_tr_b16 v[128:129], v6 offset:20480
  s_add_u32 m0, s52, 1024
  v_mfma_f32_16x16x32_bf16 a[0:3], v[96:99], v[32:35], a[0:3]
  ds_read_b64_tr_b16 v[130:131], v6 offset:22528
  v_mfma_f32_16x16x32_bf16 a[4:7], v[96:99], v[36:39], a[4:7]
  buffer_load_dwordx4 v3, s[16:19], s50 offen lds
  v_mfma_f32_16x16x32_bf16 a[8:11], v[96:99], v[40:43], a[8:11]
  ds_read_b128 v[68:71], v4 offset:41984
  ds_read_b64_tr_b16 v[132:133], v7 offset:20480
  v_mfma_f32_16x16x32_bf16 a[12:15], v[96:99], v[44:47], a[12:15]
  s_add_u32 m0, s52, 8192
  ds_read_b64_tr_b16 v[134:135], v7 offset:22528
  v_mfma_f32_16x16x32_bf16 a[16:19], v[100:103], v[32:35], a[16:19]
  buffer_load_dwordx4 v3, s[20:23], s49 offen lds
  v_mfma_f32_16x16x32_bf16 a[20:23], v[100:103], v[36:39], a[20:23]
  ds_read_b128 v[72:75], v4 offset:43008
  v_mfma_f32_16x16x32_bf16 a[24:27], v[100:103], v[40:43], a[24:27]
  ds_read_b64_tr_b16 v[136:137], v8 offset:20480
  s_add_u32 m0, s52, 9216
  v_mfma_f32_16x16x32_bf16 a[28:31], v[100:103], v[44:47], a[28:31]
  ds_read_b64_tr_b16 v[138:139], v8 offset:22528
  v_mfma_f32_16x16x32_bf16 a[32:35], v[104:107], v[32:35], a[32:35]
  ds_read_b128 v[76:79], v4 offset:44032
  v_mfma_f32_16x16x32_bf16 a[36:39], v[104:107], v[36:39], a[36:39]
  buffer_load_dwordx4 v3, s[20:23], s50 offen lds
  v_mfma_f32_16x16x32_bf16 a[40:43], v[104:107], v[40:43], a[40:43]
  ds_read_b64_tr_b16 v[140:141], v9 offset:20480
  ds_read_b64_tr_b16 v[142:143], v9 offset:22528
  v_mfma_f32_16x16x32_bf16 a[44:47], v[104:107], v[44:47], a[44:47]
  s_add_u32 s49, s49, 131072
  v_mfma_f32_16x16x32_bf16 a[48:51], v[108:111], v[32:35], a[48:51]
  s_add_u32 s50, s50, 131072
  v_mfma_f32_16x16x32_bf16 a[52:55], v[108:111], v[36:39], a[52:55]
  v_mfma_f32_16x16x32_bf16 a[56:59], v[108:111], v[40:43], a[56:59]
  v_mfma_f32_16x16x32_bf16 a[60:63], v[108:111], v[44:47], a[60:63]
  s_waitcnt vmcnt(24) lgkmcnt(0)
  s_barrier
  v_mfma_f32_16x16x32_bf16 a[0:3], v[112:115], v[48:51], a[0:3]
  ds_read_b128 v[16:19], v4 offset:49152
  s_add_u32 m0, s51, 32768
  v_mfma_f32_16x16x32_bf16 a[4:7], v[112:115], v[52:55], a[4:7]
  ds_read_b64_tr_b16 v[80:81], v6 offset:32768
  v_mfma_f32_16x16x32_bf16 a[8:11], v[112:115], v[56:59], a[8:11]
  buffer_load_dwordx4 v2, s[12:15], s48 offen offset:0 sc1 lds
  v_mfma_f32_16x16x32_bf16 a[12:15], v[112:115], v[60:63], a[12:15]
  ds_read_b64_tr_b16 v[82:83], v6 offset:34816
  ds_read_b128 v[20:23], v4 offset:50176
  v_mfma_f32_16x16x32_bf16 a[16:19], v[116:119], v[48:51], a[16:19]
  buffer_load_dwordx4 v2, s[12:15], s48 offen offset:1024 sc1 lds
  v_mfma_f32_16x16x32_bf16 a[20:23], v[116:119], v[52:55], a[20:23]
  ds_read_b64_tr_b16 v[84:85], v7 offset:32768
  ds_read_b64_tr_b16 v[86:87], v7 offset:34816
  v_mfma_f32_16x16x32_bf16 a[24:27], v[116:119], v[56:59], a[24:27]
  buffer_load_dwordx4 v2, s[12:15], s48 offen offset:2048 sc1 lds
  v_mfma_f32_16x16x32_bf16 a[28:31], v[116:119], v[60:63], a[28:31]
  ds_read_b128 v[24:27], v4 offset:51200
  v_mfma_f32_16x16x32_bf16 a[32:35], v[120:123], v[48:51], a[32:35]
  buffer_load_dwordx4 v2, s[12:15], s48 offen offset:3072 sc1 lds
  v_mfma_f32_16x16x32_bf16 a[36:39], v[120:123], v[52:55], a[36:39]
  ds_read_b64_tr_b16 v[88:89], v8 offset:32768
  ds_read_b64_tr_b16 v[90:91], v8 offset:34816
  v_mfma_f32_16x16x32_bf16 a[40:43], v[120:123], v[56:59], a[40:43]
  s_add_u32 s48, s48, 16384
  ds_read_b128 v[28:31], v4 offset:52224
  v_mfma_f32_16x16x32_bf16 a[44:47], v[120:123], v[60:63], a[44:47]
  ds_read_b64_tr_b16 v[92:93], v9 offset:32768
  s_add_u32 m0, s52, 16384
  v_mfma_f32_16x16x32_bf16 a[48:51], v[124:127], v[48:51], a[48:51]
  ds_read_b64_tr_b16 v[94:95], v9 offset:34816
  v_mfma_f32_16x16x32_bf16 a[52:55], v[124:127], v[52:55], a[52:55]
  buffer_load_dwordx4 v3, s[16:19], s49 offen lds
  v_mfma_f32_16x16x32_bf16 a[56:59], v[124:127], v[56:59], a[56:59]
  ds_read_b128 v[32:35], v4 offset:57344
  v_mfma_f32_16x16x32_bf16 a[60:63], v[124:127], v[60:63], a[60:63]
  ds_read_b64_tr_b16 v[96:97], v6 offset:36864
  s_add_u32 m0, s52, 17408
  v_mfma_f32_16x16x32_bf16 a[0:3], v[128:131], v[64:67], a[0:3]
  ds_read_b64_tr_b16 v[98:99], v6 offset:38912
  v_mfma_f32_16x16x32_bf16 a[4:7], v[128:131], v[68:71], a[4:7]
  buffer_load_dwordx4 v3, s[16:19], s50 offen lds
  v_mfma_f32_16x16x32_bf16 a[8:11], v[128:131], v[72:75], a[8:11]
  ds_read_b128 v[36:39], v4 offset:58368
  ds_read_b64_tr_b16 v[100:101], v7 offset:36864
  v_mfma_f32_16x16x32_bf16 a[12:15], v[128:131], v[76:79], a[12:15]
  s_add_u32 m0, s52, 24576
  ds_read_b64_tr_b16 v[102:103], v7 offset:38912
  v_mfma_f32_16x16x32_bf16 a[16:19], v[132:135], v[64:67], a[16:19]
  buffer_load_dwordx4 v3, s[20:23], s49 offen lds
  v_mfma_f32_16x16x32_bf16 a[20:23], v[132:135], v[68:71], a[20:23]
  ds_read_b128 v[40:43], v4 offset:59392
  v_mfma_f32_16x16x32_bf16 a[24:27], v[132:135], v[72:75], a[24:27]
  ds_read_b64_tr_b16 v[104:105], v8 offset:36864
  s_add_u32 m0, s52, 25600
  v_mfma_f32_16x16x32_bf16 a[28:31], v[132:135], v[76:79], a[28:31]
  ds_read_b64_tr_b16 v[106:107], v8 offset:38912
  v_mfma_f32_16x16x32_bf16 a[32:35], v[136:139], v[64:67], a[32:35]
  ds_read_b128 v[44:47], v4 offset:60416
  v_mfma_f32_16x16x32_bf16 a[36:39], v[136:139], v[68:71], a[36:39]
  buffer_load_dwordx4 v3, s[20:23], s50 offen lds
  v_mfma_f32_16x16x32_bf16 a[40:43], v[136:139], v[72:75], a[40:43]
  ds_read_b64_tr_b16 v[108:109], v9 offset:36864
  ds_read_b64_tr_b16 v[110:111], v9 offset:38912
  v_mfma_f32_16x16x32_bf16 a[44:47], v[136:139], v[76:79], a[44:47]
  s_add_u32 s49, s49, 131072
  v_mfma_f32_16x16x32_bf16 a[48:51], v[140:143], v[64:67], a[48:51]
  s_add_u32 s50, s50, 131072
  v_mfma_f32_16x16x32_bf16 a[52:55], v[140:143], v[68:71], a[52:55]
  v_mfma_f32_16x16x32_bf16 a[56:59], v[140:143], v[72:75], a[56:59]
  v_mfma_f32_16x16x32_bf16 a[60:63], v[140:143], v[76:79], a[60:63]
  s_waitcnt vmcnt(24) lgkmcnt(0)
  s_barrier
  v_mfma_f32_16x16x32_bf16 a[0:3], v[80:83], v[16:19], a[0:3]
  ds_read_b128 v[48:51], v5 offset:0
  s_add_u32 m0, s51, 49152
  v_mfma_f32_16x16x32_bf16 a[4:7], v[80:83], v[20:23], a[4:7]
  ds_read_b64_tr_b16 v[112:113], v6 offset:49152
  v_mfma_f32_16x16x32_bf16 a[8:11], v[80:83], v[24:27], a[8:11]
  buffer_load_dwordx4 v2, s[12:15], s48 offen offset:0 sc1 lds
  v_mfma_f32_16x16x32_bf16 a[12:15], v[80:83], v[28:31], a[12:15]
  ds_read_b64_tr_b16 v[114:115], v6 offset:51200
  ds_read_b128 v[52:55], v5 offset:1024
  v_mfma_f32_16x16x32_bf16 a[16:19], v[84:87], v[16:19], a[16:19]
  buffer_load_dwordx4 v2, s[12:15], s48 offen offset:1024 sc1 lds
  v_mfma_f32_16x16x32_bf16 a[20:23], v[84:87], v[20:23], a[20:23]
  ds_read_b64_tr_b16 v[116:117], v7 offset:49152
  ds_read_b64_tr_b16 v[118:119], v7 offset:51200
  v_mfma_f32_16x16x32_bf16 a[24:27], v[84:87], v[24:27], a[24:27]
  buffer_load_dwordx4 v2, s[12:15], s48 offen offset:2048 sc1 lds
  v_mfma_f32_16x16x32_bf16 a[28:31], v[84:87], v[28:31], a[28:31]
  ds_read_b128 v[56:59], v5 offset:2048
  v_mfma_f32_16x16x32_bf16 a[32:35], v[88:91], v[16:19], a[32:35]
  buffer_load_dwordx4 v2, s[12:15], s48 offen offset:3072 sc1 lds
  v_mfma_f32_16x16x32_bf16 a[36:39], v[88:91], v[20:23], a[36:39]
  ds_read_b64_tr_b16 v[120:121], v8 offset:49152
  ds_read_b64_tr_b16 v[122:123], v8 offset:51200
  v_mfma_f32_16x16x32_bf16 a[40:43], v[88:91], v[24:27], a[40:43]
  s_add_u32 s48, s48, 16384
  ds_read_b128 v[60:63], v5 offset:3072
  v_mfma_f32_16x16x32_bf16 a[44:47], v[88:91], v[28:31], a[44:47]
  ds_read_b64_tr_b16 v[124:125], v9 offset:49152
  s_add_u32 m0, s52, 32768
  v_mfma_f32_16x16x32_bf16 a[48:51], v[92:95], v[16:19], a[48:51]
  ds_read_b64_tr_b16 v[126:127], v9 offset:51200
  v_mfma_f32_16x16x32_bf16 a[52:55], v[92:95], v[20:23], a[52:55]
  buffer_load_dwordx4 v3, s[16:19], s49 offen lds
  v_mfma_f32_16x16x32_bf16 a[56:59], v[92:95], v[24:27], a[56:59]
  ds_read_b128 v[64:67], v5 offset:8192
  v_mfma_f32_16x16x32_bf16 a[60:63], v[92:95], v[28:31], a[60:63]
  ds_read_b64_tr_b16 v[128:129], v6 offset:53248
  s_add_u32 m0, s52, 33792
  v_mfma_f32_16x16x32_bf16 a[0:3], v[96:99], v[32:35], a[0:3]
  ds_read_b64_tr_b16 v[130:131], v6 offset:55296
  v_mfma_f32_16x16x32_bf16 a[4:7], v[96:99], v[36:39], a[4:7]
  buffer_load_dwordx4 v3, s[16:19], s50 offen lds
  v_mfma_f32_16x16x32_bf16 a[8:11], v[96:99], v[40:43], a[8:11]
  ds_read_b128 v[68:71], v5 offset:9216
  ds_read_b64_tr_b16 v[132:133], v7 offset:53248
  v_mfma_f32_16x16x32_bf16 a[12:15], v[96:99], v[44:47], a[12:15]
  s_add_u32 m0, s52, 40960
  ds_read_b64_tr_b16 v[134:135], v7 offset:55296
  v_mfma_f32_16x16x32_bf16 a[16:19], v[100:103], v[32:35], a[16:19]
  buffer_load_dwordx4 v3, s[20:23], s49 offen lds
  v_mfma_f32_16x16x32_bf16 a[20:23], v[100:103], v[36:39], a[20:23]
  ds_read_b128 v[72:75], v5 offset:10240
  v_mfma_f32_16x16x32_bf16 a[24:27], v[100:103], v[40:43], a[24:27]
  ds_read_b64_tr_b16 v[136:137], v8 offset:53248
  s_add_u32 m0, s52, 41984
  v_mfma_f32_16x16x32_bf16 a[28:31], v[100:103], v[44:47], a[28:31]
  ds_read_b64_tr_b16 v[138:139], v8 offset:55296
  v_mfma_f32_16x16x32_bf16 a[32:35], v[104:107], v[32:35], a[32:35]
  ds_read_b128 v[76:79], v5 offset:11264
  v_mfma_f32_16x16x32_bf16 a[36:39], v[104:107], v[36:39], a[36:39]
  buffer_load_dwordx4 v3, s[20:23], s50 offen lds
  v_mfma_f32_16x16x32_bf16 a[40:43], v[104:107], v[40:43], a[40:43]
  ds_read_b64_tr_b16 v[140:141], v9 offset:53248
  ds_read_b64_tr_b16 v[142:143], v9 offset:55296
  v_mfma_f32_16x16x32_bf16 a[44:47], v[104:107], v[44:47], a[44:47]
  s_add_u32 s49, s49, 131072
  v_mfma_f32_16x16x32_bf16 a[48:51], v[108:111], v[32:35], a[48:51]
  s_add_u32 s50, s50, 131072
  v_mfma_f32_16x16x32_bf16 a[52:55], v[108:111], v[36:39], a[52:55]
  v_mfma_f32_16x16x32_bf16 a[56:59], v[108:111], v[40:43], a[56:59]
  v_mfma_f32_16x16x32_bf16 a[60:63], v[108:111], v[44:47], a[60:63]
  s_waitcnt vmcnt(24) lgkmcnt(0)
  s_barrier
  v_mfma_f32_16x16x32_bf16 a[0:3], v[112:115], v[48:51], a[0:3]
  ds_read_b128 v[16:19], v4 offset:0
  s_add_u32 m0, s51, 65536
  v_mfma_f32_16x16x32_bf16 a[4:7], v[112:115], v[52:55], a[4:7]
  ds_read_b64_tr_b16 v[80:81], v10 offset:0
  v_mfma_f32_16x16x32_bf16 a[8:11], v[112:115], v[56:59], a[8:11]
  buffer_load_dwordx4 v2, s[12:15], s48 offen offset:0 sc1 lds
  v_mfma_f32_16x16x32_bf16 a[12:15], v[112:115], v[60:63], a[12:15]
  ds_read_b64_tr_b16 v[82:83], v10 offset:2048
  ds_read_b128 v[20:23], v4 offset:1024
  v_mfma_f32_16x16x32_bf16 a[16:19], v[116:119], v[48:51], a[16:19]
  buffer_load_dwordx4 v2, s[12:15], s48 offen offset:1024 sc1 lds
  v_mfma_f32_16x16x32_bf16 a[20:23], v[116:119], v[52:55], a[20:23]
  ds_read_b64_tr_b16 v[84:85], v11 offset:0
  ds_read_b64_tr_b16 v[86:87], v11 offset:2048
  v_mfma_f32_16x16x32_bf16 a[24:27], v[116:119], v[56:59], a[24:27]
  buffer_load_dwordx4 v2, s[12:15], s48 offen offset:2048 sc1 lds
  v_mfma_f32_16x16x32_bf16 a[28:31], v[116:119], v[60:63], a[28:31]
  ds_read_b128 v[24:27], v4 offset:2048
  v_mfma_f32_16x16x32_bf16 a[32:35], v[120:123], v[48:51], a[32:35]
  buffer_load_dwordx4 v2, s[12:15], s48 offen offset:3072 sc1 lds
  v_mfma_f32_16x16x32_bf16 a[36:39], v[120:123], v[52:55], a[36:39]
  ds_read_b64_tr_b16 v[88:89], v12 offset:0
  ds_read_b64_tr_b16 v[90:91], v12 offset:2048
  v_mfma_f32_16x16x32_bf16 a[40:43], v[120:123], v[56:59], a[40:43]
  s_add_u32 s48, s48, 16384
  ds_read_b128 v[28:31], v4 offset:3072
  v_mfma_f32_16x16x32_bf16 a[44:47], v[120:123], v[60:63], a[44:47]
  ds_read_b64_tr_b16 v[92:93], v13 offset:0
  s_add_u32 m0, s52, 49152
  v_mfma_f32_16x16x32_bf16 a[48:51], v[124:127], v[48:51], a[48:51]
  ds_read_b64_tr_b16 v[94:95], v13 offset:2048
  v_mfma_f32_16x16x32_bf16 a[52:55], v[124:127], v[52:55], a[52:55]
  buffer_load_dwordx4 v3, s[16:19], s49 offen lds
  v_mfma_f32_16x16x32_bf16 a[56:59], v[124:127], v[56:59], a[56:59]
  ds_read_b128 v[32:35], v4 offset:8192
  v_mfma_f32_16x16x32_bf16 a[60:63], v[124:127], v[60:63], a[60:63]
  ds_read_b64_tr_b16 v[96:97], v10 offset:4096
  s_add_u32 m0, s52, 50176
  v_mfma_f32_16x16x32_bf16 a[0:3], v[128:131], v[64:67], a[0:3]
  ds_read_b64_tr_b16 v[98:99], v10 offset:6144
  v_mfma_f32_16x16x32_bf16 a[4:7], v[128:131], v[68:71], a[4:7]
  buffer_load_dwordx4 v3, s[16:19], s50 offen lds
  v_mfma_f32_16x16x32_bf16 a[8:11], v[128:131], v[72:75], a[8:11]
  ds_read_b128 v[36:39], v4 offset:9216
  ds_read_b64_tr_b16 v[100:101], v11 offset:4096
  v_mfma_f32_16x16x32_bf16 a[12:15], v[128:131], v[76:79], a[12:15]
  s_add_u32 m0, s52, 57344
  ds_read_b64_tr_b16 v[102:103], v11 offset:6144
  v_mfma_f32_16x16x32_bf16 a[16:19], v[132:135], v[64:67], a[16:19]
  buffer_load_dwordx4 v3, s[20:23], s49 offen lds
  v_mfma_f32_16x16x32_bf16 a[20:23], v[132:135], v[68:71], a[20:23]
  ds_read_b128 v[40:43], v4 offset:10240
  v_mfma_f32_16x16x32_bf16 a[24:27], v[132:135], v[72:75], a[24:27]
  ds_read_b64_tr_b16 v[104:105], v12 offset:4096
  s_add_u32 m0, s52, 58368
  v_mfma_f32_16x16x32_bf16 a[28:31], v[132:135], v[76:79], a[28:31]
  ds_read_b64_tr_b16 v[106:107], v12 offset:6144
  v_mfma_f32_16x16x32_bf16 a[32:35], v[136:139], v[64:67], a[32:35]
  ds_read_b128 v[44:47], v4 offset:11264
  v_mfma_f32_16x16x32_bf16 a[36:39], v[136:139], v[68:71], a[36:39]
  buffer_load_dwordx4 v3, s[20:23], s50 offen lds
  v_mfma_f32_16x16x32_bf16 a[40:43], v[136:139], v[72:75], a[40:43]
  ds_read_b64_tr_b16 v[108:109], v13 offset:4096
  ds_read_b64_tr_b16 v[110:111], v13 offset:6144
  v_mfma_f32_16x16x32_bf16 a[44:47], v[136:139], v[76:79], a[44:47]
  s_add_u32 s49, s49, 131072
  v_mfma_f32_16x16x32_bf16 a[48:51], v[140:143], v[64:67], a[48:51]
  s_add_u32 s50, s50, 131072
  v_mfma_f32_16x16x32_bf16 a[52:55], v[140:143], v[68:71], a[52:55]
  v_mfma_f32_16x16x32_bf16 a[56:59], v[140:143], v[72:75], a[56:59]
  v_mfma_f32_16x16x32_bf16 a[60:63], v[140:143], v[76:79], a[60:63]
  s_waitcnt vmcnt(24) lgkmcnt(0)
  s_barrier
  v_mfma_f32_16x16x32_bf16 a[0:3], v[80:83], v[16:19], a[0:3]
  ds_read_b128 v[48:51], v4 offset:16384
  s_add_u32 m0, s51, 0
  v_mfma_f32_16x16x32_bf16 a[4:7], v[80:83], v[20:23], a[4:7]
  ds_read_b64_tr_b16 v[112:113], v6 offset:0
  v_mfma_f32_16x16x32_bf16 a[8:11], v[80:83], v[24:27], a[8:11]
  buffer_load_dwordx4 v2, s[12:15], s48 offen offset:0 sc1 lds
  v_mfma_f32_16x16x32_bf16 a[12:15], v[80:83], v[28:31], a[12:15]
  ds_read_b64_tr_b16 v[114:115], v6 offset:2048
  ds_read_b128 v[52:55], v4 offset:17408
  v_mfma_f32_16x16x32_bf16 a[16:19], v[84:87], v[16:19], a[16:19]
  buffer_load_dwordx4 v2, s[12:15], s48 offen offset:1024 sc1 lds
  v_mfma_f32_16x16x32_bf16 a[20:23], v[84:87], v[20:23], a[20:23]
  ds_read_b64_tr_b16 v[116:117], v7 offset:0
  ds_read_b64_tr_b16 v[118:119], v7 offset:2048
  v_mfma_f32_16x16x32_bf16 a[24:27], v[84:87], v[24:27], a[24:27]
  buffer_load_dwordx4 v2, s[12:15], s48 offen offset:2048 sc1 lds
  v_mfma_f32_16x16x32_bf16 a[28:31], v[84:87], v[28:31], a[28:31]
  ds_read_b128 v[56:59], v4 offset:18432
  v_mfma_f32_16x16x32_bf16 a[32:35], v[88:91], v[16:19], a[32:35]
  buffer_load_dwordx4 v2, s[12:15], s48 offen offset:3072 sc1 lds
  v_mfma_f32_16x16x32_bf16 a[36:39], v[88:91], v[20:23], a[36:39]
  ds_read_b64_tr_b16 v[120:121], v8 offset:0
  ds_read_b64_tr_b16 v[122:123], v8 offset:2048
  v_mfma_f32_16x16x32_bf16 a[40:43], v[88:91], v[24:27], a[40:43]
  s_add_u32 s48, s48, 16384
  ds_read_b128 v[60:63], v4 offset:19456
  v_mfma_f32_16x16x32_bf16 a[44:47], v[88:91], v[28:31], a[44:47]
  ds_read_b64_tr_b16 v[124:125], v9 offset:0
  s_add_u32 m0, s52, 65536
  v_mfma_f32_16x16x32_bf16 a[48:51], v[92:95], v[16:19], a[48:51]
  ds_read_b64_tr_b16 v[126:127], v9 offset:2048
  v_mfma_f32_16x16x32_bf16 a[52:55], v[92:95], v[20:23], a[52:55]
  buffer_load_dwordx4 v3, s[16:19], s49 offen lds
  v_mfma_f32_16x16x32_bf16 a[56:59], v[92:95], v[24:27], a[56:59]
  ds_read_b128 v[64:67], v4 offset:24576
  v_mfma_f32_16x16x32_bf16 a[60:63], v[92:95], v[28:31], a[60:63]
  ds_read_b64_tr_b16 v[128:129], v6 offset:4096
  s_add_u32 m0, s52, 66560
  v_mfma_f32_16x16x32_bf16 a[0:3], v[96:99], v[32:35], a[0:3]
  ds_read_b64_tr_b16 v[130:131], v6 offset:6144
  v_mfma_f32_16x16x32_bf16 a[4:7], v[96:99], v[36:39], a[4:7]
  buffer_load_dwordx4 v3, s[16:19], s50 offen lds
  v_mfma_f32_16x16x32_bf16 a[8:11], v[96:99], v[40:43], a[8:11]
  ds_read_b128 v[68:71], v4 offset:25600
  ds_read_b64_tr_b16 v[132:133], v7 offset:4096
  v_mfma_f32_16x16x32_bf16 a[12:15], v[96:99], v[44:47], a[12:15]
  s_add_u32 m0, s52, 73728
  ds_read_b64_tr_b16 v[134:135], v7 offset:6144
  v_mfma_f32_16x16x32_bf16 a[16:19], v[100:103], v[32:35], a[16:19]
  buffer_load_dwordx4 v3, s[20:23], s49 offen lds
  v_mfma_f32_16x16x32_bf16 a[20:23], v[100:103], v[36:39], a[20:23]
  ds_read_b128 v[72:75], v4 offset:26624
  v_mfma_f32_16x16x32_bf16 a[24:27], v[100:103], v[40:43], a[24:27]
  ds_read_b64_tr_b16 v[136:137], v8 offset:4096
  s_add_u32 m0, s52, 74752
  v_mfma_f32_16x16x32_bf16 a[28:31], v[100:103], v[44:47], a[28:31]
  ds_read_b64_tr_b16 v[138:139], v8 offset:6144
  v_mfma_f32_16x16x32_bf16 a[32:35], v[104:107], v[32:35], a[32:35]
  ds_read_b128 v[76:79], v4 offset:27648
  v_mfma_f32_16x16x32_bf16 a[36:39], v[104:107], v[36:39], a[36:39]
  buffer_load_dwordx4 v3, s[20:23], s50 offen lds
  v_mfma_f32_16x16x32_bf16 a[40:43], v[104:107], v[40:43], a[40:43]
  ds_read_b64_tr_b16 v[140:141], v9 offset:4096
  ds_read_b64_tr_b16 v[142:143], v9 offset:6144
  v_mfma_f32_16x16x32_bf16 a[44:47], v[104:107], v[44:47], a[44:47]
  s_add_u32 s49, s49, 131072
  v_mfma_f32_16x16x32_bf16 a[48:51], v[108:111], v[32:35], a[48:51]
  s_add_u32 s50, s50, 131072
  v_mfma_f32_16x16x32_bf16 a[52:55], v[108:111], v[36:39], a[52:55]
  v_mfma_f32_16x16x32_bf16 a[56:59], v[108:111], v[40:43], a[56:59]
  v_mfma_f32_16x16x32_bf16 a[60:63], v[108:111], v[44:47], a[60:63]
  s_waitcnt vmcnt(24) lgkmcnt(0)
  s_barrier
  v_mfma_f32_16x16x32_bf16 a[0:3], v[112:115], v[48:51], a[0:3]
  ds_read_b128 v[16:19], v4 offset:32768
  s_add_u32 m0, s51, 16384
  v_mfma_f32_16x16x32_bf16 a[4:7], v[112:115], v[52:55], a[4:7]
  ds_read_b64_tr_b16 v[80:81], v6 offset:16384
  s_lshr_b32 s66, s45, 1
  v_mfma_f32_16x16x32_bf16 a[8:11], v[112:115], v[56:59], a[8:11]
  buffer_load_dwordx4 v2, s[12:15], s48 offen offset:0 sc1 lds
  v_mfma_f32_16x16x32_bf16 a[12:15], v[112:115], v[60:63], a[12:15]
  ds_read_b64_tr_b16 v[82:83], v6 offset:18432
  ds_read_b128 v[20:23], v4 offset:33792
  v_mfma_f32_16x16x32_bf16 a[16:19], v[116:119], v[48:51], a[16:19]
  buffer_load_dwordx4 v2, s[12:15], s48 offen offset:1024 sc1 lds
  v_mfma_f32_16x16x32_bf16 a[20:23], v[116:119], v[52:55], a[20:23]
  s_lshl_b32 s66, s66, 5
  ds_read_b64_tr_b16 v[84:85], v7 offset:16384
  v_mfma_f32_16x16x32_bf16 a[24:27], v[116:119], v[56:59], a[24:27]
  ds_read_b64_tr_b16 v[86:87], v7 offset:18432
  s_add_u32 s66, s66, 1024
  v_mfma_f32_16x16x32_bf16 a[28:31], v[116:119], v[60:63], a[28:31]
  buffer_load_dwordx4 v2, s[12:15], s48 offen offset:2048 sc1 lds
  v_mfma_f32_16x16x32_bf16 a[32:35], v[120:123], v[48:51], a[32:35]
  ds_read_b128 v[24:27], v4 offset:34816
  ds_read_b64_tr_b16 v[88:89], v8 offset:16384
  v_mfma_f32_16x16x32_bf16 a[36:39], v[120:123], v[52:55], a[36:39]
  buffer_load_dwordx4 v2, s[12:15], s48 offen offset:3072 sc1 lds
  v_mfma_f32_16x16x32_bf16 a[40:43], v[120:123], v[56:59], a[40:43]
  s_lshl_b32 s66, s66, 7
  ds_read_b64_tr_b16 v[90:91], v8 offset:18432
  v_mfma_f32_16x16x32_bf16 a[44:47], v[120:123], v[60:63], a[44:47]
  s_add_u32 s48, s48, 16384
  ds_read_b128 v[28:31], v4 offset:35840
  v_mfma_f32_16x16x32_bf16 a[48:51], v[124:127], v[48:51], a[48:51]
  ds_read_b64_tr_b16 v[92:93], v9 offset:16384
  s_add_u32 m0, s52, 0
  v_mfma_f32_16x16x32_bf16 a[52:55], v[124:127], v[52:55], a[52:55]
  s_add_u32 s66, s66, 4096
  ds_read_b64_tr_b16 v[94:95], v9 offset:18432
  v_mfma_f32_16x16x32_bf16 a[56:59], v[124:127], v[56:59], a[56:59]
  buffer_load_dwordx4 v3, s[16:19], s49 offen lds
  v_mfma_f32_16x16x32_bf16 a[60:63], v[124:127], v[60:63], a[60:63]
  v_bfe_u32 v202, v0, 1, 3
  ds_read_b128 v[32:35], v4 offset:40960
  v_mfma_f32_16x16x32_bf16 a[0:3], v[128:131], v[64:67], a[0:3]
  ds_read_b64_tr_b16 v[96:97], v6 offset:20480
  s_add_u32 m0, s52, 1024
  v_mfma_f32_16x16x32_bf16 a[4:7], v[128:131], v[68:71], a[4:7]
  ds_read_b64_tr_b16 v[98:99], v6 offset:22528
  v_lshlrev_b32 v202, 2, v202
  v_mfma_f32_16x16x32_bf16 a[8:11], v[128:131], v[72:75], a[8:11]
  buffer_load_dwordx4 v3, s[16:19], s50 offen lds
  v_mfma_f32_16x16x32_bf16 a[12:15], v[128:131], v[76:79], a[12:15]
  ds_read_b128 v[36:39], v4 offset:41984
  ds_read_b64_tr_b16 v[100:101], v7 offset:20480
  v_mfma_f32_16x16x32_bf16 a[16:19], v[132:135], v[64:67], a[16:19]
  s_add_u32 m0, s52, 8192
  ds_read_b64_tr_b16 v[102:103], v7 offset:22528
  v_mfma_f32_16x16x32_bf16 a[20:23], v[132:135], v[68:71], a[20:23]
  v_and_b32 v200, 1, v0
  ds_read_b128 v[40:43], v4 offset:43008
  v_mfma_f32_16x16x32_bf16 a[24:27], v[132:135], v[72:75], a[24:27]
  buffer_load_dwordx4 v3, s[20:23], s49 offen lds
  v_mfma_f32_16x16x32_bf16 a[28:31], v[132:135], v[76:79], a[28:31]
  v_add_u32 v202, v202, v200
  ds_read_b64_tr_b16 v[104:105], v8 offset:20480
  v_mfma_f32_16x16x32_bf16 a[32:35], v[136:139], v[64:67], a[32:35]
  s_add_u32 m0, s52, 9216
  ds_read_b64_tr_b16 v[106:107], v8 offset:22528
  v_mfma_f32_16x16x32_bf16 a[36:39], v[136:139], v[68:71], a[36:39]
  ds_read_b128 v[44:47], v4 offset:44032
  v_add_u32 v202, 2, v202
  v_mfma_f32_16x16x32_bf16 a[40:43], v[136:139], v[72:75], a[40:43]
  buffer_load_dwordx4 v3, s[20:23], s50 offen lds
  v_mfma_f32_16x16x32_bf16 a[44:47], v[136:139], v[76:79], a[44:47]
  ds_read_b64_tr_b16 v[108:109], v9 offset:20480
  ds_read_b64_tr_b16 v[110:111], v9 offset:22528
  v_mfma_f32_16x16x32_bf16 a[48:51], v[140:143], v[64:67], a[48:51]
  s_add_u32 s49, s49, 131072
  v_lshlrev_b32 v202, 7, v202
  v_mfma_f32_16x16x32_bf16 a[52:55], v[140:143], v[68:71], a[52:55]
  s_add_u32 s50, s50, 131072
  v_add_u32 v202, s66, v202
  v_mfma_f32_16x16x32_bf16 a[56:59], v[140:143], v[72:75], a[56:59]
  v_mfma_f32_16x16x32_bf16 a[60:63], v[140:143], v[76:79], a[60:63]
  s_waitcnt vmcnt(24) lgkmcnt(0)
  s_barrier
  v_mfma_f32_16x16x32_bf16 a[0:3], v[80:83], v[16:19], a[0:3]
  ds_read_b128 v[48:51], v4 offset:49152
  s_add_u32 m0, s51, 32768
  v_mfma_f32_16x16x32_bf16 a[4:7], v[80:83], v[20:23], a[4:7]
  ds_read_b64_tr_b16 v[112:113], v6 offset:32768
  v_mfma_f32_16x16x32_bf16 a[8:11], v[80:83], v[24:27], a[8:11]
  buffer_load_dwordx4 v2, s[12:15], s48 offen offset:0 sc1 lds
  v_mfma_f32_16x16x32_bf16 a[12:15], v[80:83], v[28:31], a[12:15]
  ds_read_b64_tr_b16 v[114:115], v6 offset:34816
  ds_read_b128 v[52:55], v4 offset:50176
  v_mfma_f32_16x16x32_bf16 a[16:19], v[84:87], v[16:19], a[16:19]
  buffer_load_dwordx4 v2, s[12:15], s48 offen offset:1024 sc1 lds
  v_mfma_f32_16x16x32_bf16 a[20:23], v[84:87], v[20:23], a[20:23]
  ds_read_b64_tr_b16 v[116:117], v7 offset:32768
  ds_read_b64_tr_b16 v[118:119], v7 offset:34816
  v_mfma_f32_16x16x32_bf16 a[24:27], v[84:87], v[24:27], a[24:27]
  buffer_load_dwordx4 v2, s[12:15], s48 offen offset:2048 sc1 lds
  v_mfma_f32_16x16x32_bf16 a[28:31], v[84:87], v[28:31], a[28:31]
  ds_read_b128 v[56:59], v4 offset:51200
  v_mfma_f32_16x16x32_bf16 a[32:35], v[88:91], v[16:19], a[32:35]
  buffer_load_dwordx4 v2, s[12:15], s48 offen offset:3072 sc1 lds
  v_mfma_f32_16x16x32_bf16 a[36:39], v[88:91], v[20:23], a[36:39]
  ds_read_b64_tr_b16 v[120:121], v8 offset:32768
  ds_read_b64_tr_b16 v[122:123], v8 offset:34816
  v_mfma_f32_16x16x32_bf16 a[40:43], v[88:91], v[24:27], a[40:43]
  s_add_u32 s48, s48, 16384
  ds_read_b128 v[60:63], v4 offset:52224
  v_mfma_f32_16x16x32_bf16 a[44:47], v[88:91], v[28:31], a[44:47]
  ds_read_b64_tr_b16 v[124:125], v9 offset:32768
  s_add_u32 m0, s52, 16384
  v_mfma_f32_16x16x32_bf16 a[48:51], v[92:95], v[16:19], a[48:51]
  ds_read_b64_tr_b16 v[126:127], v9 offset:34816
  v_mfma_f32_16x16x32_bf16 a[52:55], v[92:95], v[20:23], a[52:55]
  buffer_load_dwordx4 v3, s[16:19], s49 offen lds
  v_mfma_f32_16x16x32_bf16 a[56:59], v[92:95], v[24:27], a[56:59]
  ds_read_b128 v[64:67], v4 offset:57344
  v_mfma_f32_16x16x32_bf16 a[60:63], v[92:95], v[28:31], a[60:63]
  ds_read_b64_tr_b16 v[128:129], v6 offset:36864
  s_add_u32 m0, s52, 17408
  v_mfma_f32_16x16x32_bf16 a[0:3], v[96:99], v[32:35], a[0:3]
  ds_read_b64_tr_b16 v[130:131], v6 offset:38912
  v_mfma_f32_16x16x32_bf16 a[4:7], v[96:99], v[36:39], a[4:7]
  buffer_load_dwordx4 v3, s[16:19], s50 offen lds
  v_mfma_f32_16x16x32_bf16 a[8:11], v[96:99], v[40:43], a[8:11]
  ds_read_b128 v[68:71], v4 offset:58368
  ds_read_b64_tr_b16 v[132:133], v7 offset:36864
  v_mfma_f32_16x16x32_bf16 a[12:15], v[96:99], v[44:47], a[12:15]
  s_add_u32 m0, s52, 24576
  ds_read_b64_tr_b16 v[134:135], v7 offset:38912
  v_mfma_f32_16x16x32_bf16 a[16:19], v[100:103], v[32:35], a[16:19]
  buffer_load_dwordx4 v3, s[20:23], s49 offen lds
  v_mfma_f32_16x16x32_bf16 a[20:23], v[100:103], v[36:39], a[20:23]
  ds_read_b128 v[72:75], v4 offset:59392
  v_mfma_f32_16x16x32_bf16 a[24:27], v[100:103], v[40:43], a[24:27]
  ds_read_b64_tr_b16 v[136:137], v8 offset:36864
  s_add_u32 m0, s52, 25600
  v_mfma_f32_16x16x32_bf16 a[28:31], v[100:103], v[44:47], a[28:31]
  ds_read_b64_tr_b16 v[138:139], v8 offset:38912
  v_mfma_f32_16x16x32_bf16 a[32:35], v[104:107], v[32:35], a[32:35]
  ds_read_b128 v[76:79], v4 offset:60416
  v_mfma_f32_16x16x32_bf16 a[36:39], v[104:107], v[36:39], a[36:39]
  buffer_load_dwordx4 v3, s[20:23], s50 offen lds
  v_mfma_f32_16x16x32_bf16 a[40:43], v[104:107], v[40:43], a[40:43]
  ds_read_b64_tr_b16 v[140:141], v9 offset:36864
  ds_read_b64_tr_b16 v[142:143], v9 offset:38912
  v_mfma_f32_16x16x32_bf16 a[44:47], v[104:107], v[44:47], a[44:47]
  s_add_u32 s49, s49, 131072
  v_mfma_f32_16x16x32_bf16 a[48:51], v[108:111], v[32:35], a[48:51]
  s_add_u32 s50, s50, 131072
  v_mfma_f32_16x16x32_bf16 a[52:55], v[108:111], v[36:39], a[52:55]
  v_mfma_f32_16x16x32_bf16 a[56:59], v[108:111], v[40:43], a[56:59]
  v_mfma_f32_16x16x32_bf16 a[60:63], v[108:111], v[44:47], a[60:63]
  s_waitcnt vmcnt(24) lgkmcnt(0)
  s_barrier
  buffer_load_dwordx2 v[200:201], v202, s[72:75], 0 offen sc1
  v_mfma_f32_16x16x32_bf16 a[0:3], v[112:115], v[48:51], a[0:3]
  ds_read_b128 v[16:19], v5 offset:0
  s_add_u32 m0, s51, 49152
  v_mfma_f32_16x16x32_bf16 a[4:7], v[112:115], v[52:55], a[4:7]
  ds_read_b64_tr_b16 v[80:81], v6 offset:49152
  v_mfma_f32_16x16x32_bf16 a[8:11], v[112:115], v[56:59], a[8:11]
  buffer_load_dwordx4 v2, s[12:15], s48 offen offset:0 sc1 lds
  v_mfma_f32_16x16x32_bf16 a[12:15], v[112:115], v[60:63], a[12:15]
  ds_read_b64_tr_b16 v[82:83], v6 offset:51200
  ds_read_b128 v[20:23], v5 offset:1024
  v_mfma_f32_16x16x32_bf16 a[16:19], v[116:119], v[48:51], a[16:19]
  buffer_load_dwordx4 v2, s[12:15], s48 offen offset:1024 sc1 lds
  v_mfma_f32_16x16x32_bf16 a[20:23], v[116:119], v[52:55], a[20:23]
  ds_read_b64_tr_b16 v[84:85], v7 offset:49152
  ds_read_b64_tr_b16 v[86:87], v7 offset:51200
  v_mfma_f32_16x16x32_bf16 a[24:27], v[116:119], v[56:59], a[24:27]
  buffer_load_dwordx4 v2, s[12:15], s48 offen offset:2048 sc1 lds
  v_mfma_f32_16x16x32_bf16 a[28:31], v[116:119], v[60:63], a[28:31]
  ds_read_b128 v[24:27], v5 offset:2048
  v_mfma_f32_16x16x32_bf16 a[32:35], v[120:123], v[48:51], a[32:35]
  buffer_load_dwordx4 v2, s[12:15], s48 offen offset:3072 sc1 lds
  v_mfma_f32_16x16x32_bf16 a[36:39], v[120:123], v[52:55], a[36:39]
  ds_read_b64_tr_b16 v[88:89], v8 offset:49152
  ds_read_b64_tr_b16 v[90:91], v8 offset:51200
  v_mfma_f32_16x16x32_bf16 a[40:43], v[120:123], v[56:59], a[40:43]
  s_add_u32 s48, s48, 16384
  ds_read_b128 v[28:31], v5 offset:3072
  v_mfma_f32_16x16x32_bf16 a[44:47], v[120:123], v[60:63], a[44:47]
  ds_read_b64_tr_b16 v[92:93], v9 offset:49152
  s_add_u32 m0, s52, 32768
  v_mfma_f32_16x16x32_bf16 a[48:51], v[124:127], v[48:51], a[48:51]
  ds_read_b64_tr_b16 v[94:95], v9 offset:51200
  v_mfma_f32_16x16x32_bf16 a[52:55], v[124:127], v[52:55], a[52:55]
  buffer_load_dwordx4 v3, s[16:19], s49 offen lds
  v_mfma_f32_16x16x32_bf16 a[56:59], v[124:127], v[56:59], a[56:59]
  ds_read_b128 v[32:35], v5 offset:8192
  v_mfma_f32_16x16x32_bf16 a[60:63], v[124:127], v[60:63], a[60:63]
  ds_read_b64_tr_b16 v[96:97], v6 offset:53248
  s_add_u32 m0, s52, 33792
  v_mfma_f32_16x16x32_bf16 a[0:3], v[128:131], v[64:67], a[0:3]
  ds_read_b64_tr_b16 v[98:99], v6 offset:55296
  v_mfma_f32_16x16x32_bf16 a[4:7], v[128:131], v[68:71], a[4:7]
  buffer_load_dwordx4 v3, s[16:19], s50 offen lds
  v_mfma_f32_16x16x32_bf16 a[8:11], v[128:131], v[72:75], a[8:11]
  ds_read_b128 v[36:39], v5 offset:9216
  ds_read_b64_tr_b16 v[100:101], v7 offset:53248
  v_mfma_f32_16x16x32_bf16 a[12:15], v[128:131], v[76:79], a[12:15]
  s_add_u32 m0, s52, 40960
  ds_read_b64_tr_b16 v[102:103], v7 offset:55296
  v_mfma_f32_16x16x32_bf16 a[16:19], v[132:135], v[64:67], a[16:19]
  buffer_load_dwordx4 v3, s[20:23], s49 offen lds
  v_mfma_f32_16x16x32_bf16 a[20:23], v[132:135], v[68:71], a[20:23]
  ds_read_b128 v[40:43], v5 offset:10240
  v_mfma_f32_16x16x32_bf16 a[24:27], v[132:135], v[72:75], a[24:27]
  ds_read_b64_tr_b16 v[104:105], v8 offset:53248
  s_add_u32 m0, s52, 41984
  v_mfma_f32_16x16x32_bf16 a[28:31], v[132:135], v[76:79], a[28:31]
  ds_read_b64_tr_b16 v[106:107], v8 offset:55296
  v_mfma_f32_16x16x32_bf16 a[32:35], v[136:139], v[64:67], a[32:35]
  ds_read_b128 v[44:47], v5 offset:11264
  v_mfma_f32_16x16x32_bf16 a[36:39], v[136:139], v[68:71], a[36:39]
  buffer_load_dwordx4 v3, s[20:23], s50 offen lds
  v_mfma_f32_16x16x32_bf16 a[40:43], v[136:139], v[72:75], a[40:43]
  ds_read_b64_tr_b16 v[108:109], v9 offset:53248
  ds_read_b64_tr_b16 v[110:111], v9 offset:55296
  v_mfma_f32_16x16x32_bf16 a[44:47], v[136:139], v[76:79], a[44:47]
  s_add_u32 s49, s49, 131072
  v_mfma_f32_16x16x32_bf16 a[48:51], v[140:143], v[64:67], a[48:51]
  s_add_u32 s50, s50, 131072
  v_mfma_f32_16x16x32_bf16 a[52:55], v[140:143], v[68:71], a[52:55]
  v_mfma_f32_16x16x32_bf16 a[56:59], v[140:143], v[72:75], a[56:59]
  v_mfma_f32_16x16x32_bf16 a[60:63], v[140:143], v[76:79], a[60:63]
  s_waitcnt vmcnt(25) lgkmcnt(0)
  s_barrier
  v_mfma_f32_16x16x32_bf16 a[0:3], v[80:83], v[16:19], a[0:3]
  ds_read_b128 v[48:51], v4 offset:0
  s_add_u32 m0, s51, 65536
  v_mfma_f32_16x16x32_bf16 a[4:7], v[80:83], v[20:23], a[4:7]
  ds_read_b64_tr_b16 v[112:113], v10 offset:0
  s_lshl_b32 s56, s45, 18
  v_mfma_f32_16x16x32_bf16 a[8:11], v[80:83], v[24:27], a[8:11]
  buffer_load_dwordx4 v2, s[12:15], s48 offen offset:0 sc1 lds
  v_mfma_f32_16x16x32_bf16 a[12:15], v[80:83], v[28:31], a[12:15]
  ds_read_b64_tr_b16 v[114:115], v10 offset:2048
  s_lshl_b32 s57, s46, 8
  v_mfma_f32_16x16x32_bf16 a[16:19], v[84:87], v[16:19], a[16:19]
  ds_read_b128 v[52:55], v4 offset:1024
  ds_read_b64_tr_b16 v[116:117], v11 offset:0
  v_mfma_f32_16x16x32_bf16 a[20:23], v[84:87], v[20:23], a[20:23]
  buffer_load_dwordx4 v2, s[12:15], s48 offen offset:1024 sc1 lds
  v_mfma_f32_16x16x32_bf16 a[24:27], v[84:87], v[24:27], a[24:27]
  s_add_u32 s56, s56, s57
  ds_read_b64_tr_b16 v[118:119], v11 offset:2048
  v_mfma_f32_16x16x32_bf16 a[28:31], v[84:87], v[28:31], a[28:31]
  buffer_load_dwordx4 v2, s[12:15], s48 offen offset:2048 sc1 lds
  v_mfma_f32_16x16x32_bf16 a[32:35], v[88:91], v[16:19], a[32:35]
  s_add_u32 s32, s10, s56
  s_addc_u32 s33, s11, 0
  s_sub_u32 s34, 262144, s57
  s_mov_b32 s35, 0x20000
  v_mfma_f32_16x16x32_bf16 a[36:39], v[88:91], v[20:23], a[36:39]
  ds_read_b128 v[56:59], v4 offset:2048
  ds_read_b64_tr_b16 v[120:121], v12 offset:0
  v_mfma_f32_16x16x32_bf16 a[40:43], v[88:91], v[24:27], a[40:43]
  buffer_load_dwordx4 v2, s[12:15], s48 offen offset:3072 sc1 lds
  v_mfma_f32_16x16x32_bf16 a[44:47], v[88:91], v[28:31], a[44:47]
  v_and_b32 v208, 15, v0
  ds_read_b64_tr_b16 v[122:123], v12 offset:2048
  v_mfma_f32_16x16x32_bf16 a[48:51], v[92:95], v[16:19], a[48:51]
  s_add_u32 s48, s48, 16384
  ds_read_b128 v[60:63], v4 offset:3072
  v_mfma_f32_16x16x32_bf16 a[52:55], v[92:95], v[20:23], a[52:55]
  v_lshlrev_b32 v208, 11, v208
  ds_read_b64_tr_b16 v[124:125], v13 offset:0
  v_mfma_f32_16x16x32_bf16 a[56:59], v[92:95], v[24:27], a[56:59]
  s_add_u32 m0, s52, 49152
  s_lshl_b32 s56, s41, 17
  v_mfma_f32_16x16x32_bf16 a[60:63], v[92:95], v[28:31], a[60:63]
  ds_read_b64_tr_b16 v[126:127], v13 offset:2048
  s_lshl_b32 s57, s42, 7
  v_mfma_f32_16x16x32_bf16 a[0:3], v[96:99], v[32:35], a[0:3]
  buffer_load_dwordx4 v3, s[16:19], s49 offen lds
  v_mfma_f32_16x16x32_bf16 a[4:7], v[96:99], v[36:39], a[4:7]
  ds_read_b128 v[64:67], v4 offset:8192
  ds_read_b64_tr_b16 v[128:129], v10 offset:4096
  v_mfma_f32_16x16x32_bf16 a[8:11], v[96:99], v[40:43], a[8:11]
  s_add_u32 m0, s52, 50176
  s_add_u32 s56, s56, s57
  v_mfma_f32_16x16x32_bf16 a[12:15], v[96:99], v[44:47], a[12:15]
  ds_read_b64_tr_b16 v[130:131], v10 offset:6144
  ds_read_b128 v[68:71], v4 offset:9216
  v_mfma_f32_16x16x32_bf16 a[16:19], v[100:103], v[32:35], a[16:19]
  buffer_load_dwordx4 v3, s[16:19], s50 offen lds
  v_mfma_f32_16x16x32_bf16 a[20:23], v[100:103], v[36:39], a[20:23]
  v_add_u32 v208, s56, v208
  ds_read_b64_tr_b16 v[132:133], v11 offset:4096
  v_mfma_f32_16x16x32_bf16 a[24:27], v[100:103], v[40:43], a[24:27]
  s_add_u32 m0, s52, 57344
  ds_read_b64_tr_b16 v[134:135], v11 offset:6144
  v_mfma_f32_16x16x32_bf16 a[28:31], v[100:103], v[44:47], a[28:31]
  v_lshrrev_b32 v209, 4, v0
  ds_read_b128 v[72:75], v4 offset:10240
  v_mfma_f32_16x16x32_bf16 a[32:35], v[104:107], v[32:35], a[32:35]
  buffer_load_dwordx4 v3, s[20:23], s49 offen lds
  v_mfma_f32_16x16x32_bf16 a[36:39], v[104:107], v[36:39], a[36:39]
  ds_read_b64_tr_b16 v[136:137], v12 offset:4096
  v_and_b32 v210, 1, v209
  v_mfma_f32_16x16x32_bf16 a[40:43], v[104:107], v[40:43], a[40:43]
  ds_read_b64_tr_b16 v[138:139], v12 offset:6144
  ds_read_b128 v[76:79], v4 offset:11264
  v_mfma_f32_16x16x32_bf16 a[44:47], v[104:107], v[44:47], a[44:47]
  ds_read_b64_tr_b16 v[140:141], v13 offset:4096
  ds_read_b64_tr_b16 v[142:143], v13 offset:6144
  v_mfma_f32_16x16x32_bf16 a[48:51], v[108:111], v[32:35], a[48:51]
  s_add_u32 m0, s52, 58368
  v_lshlrev_b32 v210, 5, v210
  v_mfma_f32_16x16x32_bf16 a[52:55], v[108:111], v[36:39], a[52:55]
  buffer_load_dwordx4 v3, s[20:23], s50 offen lds
  s_add_u32 s49, s49, 131072
  s_add_u32 s50, s50, 131072
  v_mfma_f32_16x16x32_bf16 a[56:59], v[108:111], v[40:43], a[56:59]
  v_add_u32 v208, v208, v210
  v_lshrrev_b32 v210, 1, v209
  v_mfma_f32_16x16x32_bf16 a[60:63], v[108:111], v[44:47], a[60:63]
  v_lshlrev_b32 v210, 4, v210
  v_add_u32 v249, v208, v210
  s_waitcnt vmcnt(25) lgkmcnt(0)
  s_barrier
  v_mfma_f32_16x16x32_bf16 a[0:3], v[112:115], v[48:51], a[0:3]
  ds_read_b128 v[16:19], v4 offset:16384
  s_add_u32 m0, s51, 0
  v_mfma_f32_16x16x32_bf16 a[4:7], v[112:115], v[52:55], a[4:7]
  ds_read_b64_tr_b16 v[80:81], v6 offset:0
  v_mfma_f32_16x16x32_bf16 a[8:11], v[112:115], v[56:59], a[8:11]
  buffer_load_dwordx4 v2, s[12:15], s48 offen offset:0 sc1 lds
  v_mfma_f32_16x16x32_bf16 a[12:15], v[112:115], v[60:63], a[12:15]
  s_getpc_b64 s[60:61]
pfc_22:
  s_sub_u32 s60, s60, pfc_22-fz_start
  s_subb_u32 s61, s61, 0
  v_mfma_f32_16x16x32_bf16 a[16:19], v[116:119], v[48:51], a[16:19]
  ds_read_b64_tr_b16 v[82:83], v6 offset:2048
  s_lshl_b32 s62, s3, 2
  v_mfma_f32_16x16x32_bf16 a[20:23], v[116:119], v[52:55], a[20:23]
  ds_read_b128 v[20:23], v4 offset:17408
  ds_read_b64_tr_b16 v[84:85], v7 offset:0
  v_mfma_f32_16x16x32_bf16 a[24:27], v[116:119], v[56:59], a[24:27]
  buffer_load_dwordx4 v2, s[12:15], s48 offen offset:1024 sc1 lds
  v_mfma_f32_16x16x32_bf16 a[28:31], v[116:119], v[60:63], a[28:31]
  s_and_b32 s63, s44, 3
  ds_read_b64_tr_b16 v[86:87], v7 offset:2048
  v_mfma_f32_16x16x32_bf16 a[32:35], v[120:123], v[48:51], a[32:35]
  buffer_load_dwordx4 v2, s[12:15], s48 offen offset:2048 sc1 lds
  v_mfma_f32_16x16x32_bf16 a[36:39], v[120:123], v[52:55], a[36:39]
  s_add_u32 s62, s62, s63
  ds_read_b128 v[24:27], v4 offset:18432
  v_mfma_f32_16x16x32_bf16 a[40:43], v[120:123], v[56:59], a[40:43]
  buffer_load_dwordx4 v2, s[12:15], s48 offen offset:3072 sc1 lds
  v_mfma_f32_16x16x32_bf16 a[44:47], v[120:123], v[60:63], a[44:47]
  s_lshl_b32 s62, s62, 2
  ds_read_b64_tr_b16 v[88:89], v8 offset:0
  v_mfma_f32_16x16x32_bf16 a[48:51], v[124:127], v[48:51], a[48:51]
  ds_read_b64_tr_b16 v[90:91], v8 offset:2048
  s_add_u32 s48, s48, 16384
  v_mfma_f32_16x16x32_bf16 a[52:55], v[124:127], v[52:55], a[52:55]
  s_and_b32 s63, s43, 3
  ds_read_b128 v[28:31], v4 offset:19456
  v_mfma_f32_16x16x32_bf16 a[56:59], v[124:127], v[56:59], a[56:59]
  ds_read_b64_tr_b16 v[92:93], v9 offset:0
  s_add_u32 m0, s52, 65536
  v_mfma_f32_16x16x32_bf16 a[60:63], v[124:127], v[60:63], a[60:63]
  s_add_u32 s62, s62, s63
  ds_read_b64_tr_b16 v[94:95], v9 offset:2048
  v_mfma_f32_16x16x32_bf16 a[0:3], v[128:131], v[64:67], a[0:3]
  buffer_load_dwordx4 v3, s[16:19], s49 offen lds
  v_mfma_f32_16x16x32_bf16 a[4:7], v[128:131], v[68:71], a[4:7]
  s_lshl_b32 s62, s62, 2
  ds_read_b128 v[32:35], v4 offset:24576
  v_mfma_f32_16x16x32_bf16 a[8:11], v[128:131], v[72:75], a[8:11]
  s_add_u32 s62, s62, s40
  ds_read_b64_tr_b16 v[96:97], v6 offset:4096
  v_mfma_f32_16x16x32_bf16 a[12:15], v[128:131], v[76:79], a[12:15]
  s_add_u32 m0, s52, 66560
  ds_read_b64_tr_b16 v[98:99], v6 offset:6144
  v_mfma_f32_16x16x32_bf16 a[16:19], v[132:135], v[64:67], a[16:19]
  buffer_load_dwordx4 v3, s[16:19], s50 offen lds
  v_mfma_f32_16x16x32_bf16 a[20:23], v[132:135], v[68:71], a[20:23]
  s_lshl_b32 s62, s62, 10
  ds_read_b128 v[36:39], v4 offset:25600
  v_mfma_f32_16x16x32_bf16 a[24:27], v[132:135], v[72:75], a[24:27]
  ds_read_b64_tr_b16 v[100:101], v7 offset:4096
  s_add_u32 m0, s52, 73728
  v_mfma_f32_16x16x32_bf16 a[28:31], v[132:135], v[76:79], a[28:31]
  v_and_b32 v250, 7, v0
  ds_read_b64_tr_b16 v[102:103], v7 offset:6144
  v_mfma_f32_16x16x32_bf16 a[32:35], v[136:139], v[64:67], a[32:35]
  v_lshlrev_b32 v250, 7, v250
  ds_read_b128 v[40:43], v4 offset:26624
  v_mfma_f32_16x16x32_bf16 a[36:39], v[136:139], v[68:71], a[36:39]
  ds_read_b64_tr_b16 v[104:105], v8 offset:4096
  v_add_u32 v250, s62, v250
  v_mfma_f32_16x16x32_bf16 a[40:43], v[136:139], v[72:75], a[40:43]
  ds_read_b64_tr_b16 v[106:107], v8 offset:6144
  ds_read_b128 v[44:47], v4 offset:27648
  v_mfma_f32_16x16x32_bf16 a[44:47], v[136:139], v[76:79], a[44:47]
  buffer_load_dwordx4 v3, s[20:23], s49 offen lds
  ds_read_b64_tr_b16 v[108:109], v9 offset:4096
  ds_read_b64_tr_b16 v[110:111], v9 offset:6144
  v_mfma_f32_16x16x32_bf16 a[48:51], v[140:143], v[64:67], a[48:51]
  s_add_u32 m0, s52, 74752
  s_mov_b32 s62, fz_end-fz_start-4
  v_mfma_f32_16x16x32_bf16 a[52:55], v[140:143], v[68:71], a[52:55]
  buffer_load_dwordx4 v3, s[20:23], s50 offen lds
  s_add_u32 s49, s49, 131072
  s_add_u32 s50, s50, 131072
  v_mfma_f32_16x16x32_bf16 a[56:59], v[140:143], v[72:75], a[56:59]
  v_min_u32 v250, s62, v250
  v_mov_b32 v251, s61
  v_mfma_f32_16x16x32_bf16 a[60:63], v[140:143], v[76:79], a[60:63]
  v_add_co_u32 v250, vcc, s60, v250
  s_nop 1
  v_addc_co_u32 v251, vcc, 0, v251, vcc
  global_load_dword v252, v[250:251], off
  s_waitcnt vmcnt(26) lgkmcnt(0)
  s_barrier
  v_mfma_f32_16x16x32_bf16 a[0:3], v[80:83], v[16:19], a[0:3]
  ds_read_b128 v[48:51], v4 offset:32768
  s_add_u32 m0, s51, 16384
  v_mfma_f32_16x16x32_bf16 a[4:7], v[80:83], v[20:23], a[4:7]
  ds_read_b64_tr_b16 v[112:113], v6 offset:16384
  v_mfma_f32_16x16x32_bf16 a[8:11], v[80:83], v[24:27], a[8:11]
  buffer_load_dwordx4 v2, s[12:15], s48 offen offset:0 sc1 lds
  v_mfma_f32_16x16x32_bf16 a[12:15], v[80:83], v[28:31], a[12:15]
  ds_read_b64_tr_b16 v[114:115], v6 offset:18432
  ds_read_b128 v[52:55], v4 offset:33792
  v_mfma_f32_16x16x32_bf16 a[16:19], v[84:87], v[16:19], a[16:19]
  buffer_load_dwordx4 v2, s[12:15], s48 offen offset:1024 sc1 lds
  v_mfma_f32_16x16x32_bf16 a[20:23], v[84:87], v[20:23], a[20:23]
  ds_read_b64_tr_b16 v[116:117], v7 offset:16384
  ds_read_b64_tr_b16 v[118:119], v7 offset:18432
  v_mfma_f32_16x16x32_bf16 a[24:27], v[84:87], v[24:27], a[24:27]
  buffer_load_dwordx4 v2, s[12:15], s48 offen offset:2048 sc1 lds
  v_mfma_f32_16x16x32_bf16 a[28:31], v[84:87], v[28:31], a[28:31]
  ds_read_b128 v[56:59], v4 offset:34816
  v_mfma_f32_16x16x32_bf16 a[32:35], v[88:91], v[16:19], a[32:35]
  buffer_load_dwordx4 v2, s[12:15], s48 offen offset:3072 sc1 lds
  v_mfma_f32_16x16x32_bf16 a[36:39], v[88:91], v[20:23], a[36:39]
  ds_read_b64_tr_b16 v[120:121], v8 offset:16384
  ds_read_b64_tr_b16 v[122:123], v8 offset:18432
  v_mfma_f32_16x16x32_bf16 a[40:43], v[88:91], v[24:27], a[40:43]
  s_add_u32 s48, s48, 16384
  ds_read_b128 v[60:63], v4 offset:35840
  v_mfma_f32_16x16x32_bf16 a[44:47], v[88:91], v[28:31], a[44:47]
  ds_read_b64_tr_b16 v[124:125], v9 offset:16384
  s_add_u32 m0, s52, 0
  v_mfma_f32_16x16x32_bf16 a[48:51], v[92:95], v[16:19], a[48:51]
  ds_read_b64_tr_b16 v[126:127], v9 offset:18432
  v_mfma_f32_16x16x32_bf16 a[52:55], v[92:95], v[20:23], a[52:55]
  buffer_load_dwordx4 v3, s[16:19], s49 offen lds
  v_mfma_f32_16x16x32_bf16 a[56:59], v[92:95], v[24:27], a[56:59]
  ds_read_b128 v[64:67], v4 offset:40960
  v_mfma_f32_16x16x32_bf16 a[60:63], v[92:95], v[28:31], a[60:63]
  ds_read_b64_tr_b16 v[128:129], v6 offset:20480
  s_add_u32 m0, s52, 1024
  v_mfma_f32_16x16x32_bf16 a[0:3], v[96:99], v[32:35], a[0:3]
  ds_read_b64_tr_b16 v[130:131], v6 offset:22528
  v_mfma_f32_16x16x32_bf16 a[4:7], v[96:99], v[36:39], a[4:7]
  buffer_load_dwordx4 v3, s[16:19], s50 offen lds
  v_mfma_f32_16x16x32_bf16 a[8:11], v[96:99], v[40:43], a[8:11]
  ds_read_b128 v[68:71], v4 offset:41984
  ds_read_b64_tr_b16 v[132:133], v7 offset:20480
  v_mfma_f32_16x16x32_bf16 a[12:15], v[96:99], v[44:47], a[12:15]
  s_add_u32 m0, s52, 8192
  ds_read_b64_tr_b16 v[134:135], v7 offset:22528
  v_mfma_f32_16x16x32_bf16 a[16:19], v[100:103], v[32:35], a[16:19]
  buffer_load_dwordx4 v3, s[20:23], s49 offen lds
  v_mfma_f32_16x16x32_bf16 a[20:23], v[100:103], v[36:39], a[20:23]
  ds_read_b128 v[72:75], v4 offset:43008
  v_mfma_f32_16x16x32_bf16 a[24:27], v[100:103], v[40:43], a[24:27]
  ds_read_b64_tr_b16 v[136:137], v8 offset:20480
  s_add_u32 m0, s52, 9216
  v_mfma_f32_16x16x32_bf16 a[28:31], v[100:103], v[44:47], a[28:31]
  ds_read_b64_tr_b16 v[138:139], v8 offset:22528
  v_mfma_f32_16x16x32_bf16 a[32:35], v[104:107], v[32:35], a[32:35]
  ds_read_b128 v[76:79], v4 offset:44032
  v_mfma_f32_16x16x32_bf16 a[36:39], v[104:107], v[36:39], a[36:39]
  buffer_load_dwordx4 v3, s[20:23], s50 offen lds
  v_mfma_f32_16x16x32_bf16 a[40:43], v[104:107], v[40:43], a[40:43]
  ds_read_b64_tr_b16 v[140:141], v9 offset:20480
  ds_read_b64_tr_b16 v[142:143], v9 offset:22528
  v_mfma_f32_16x16x32_bf16 a[44:47], v[104:107], v[44:47], a[44:47]
  s_add_u32 s49, s49, 131072
  v_mfma_f32_16x16x32_bf16 a[48:51], v[108:111], v[32:35], a[48:51]
  s_add_u32 s50, s50, 131072
  v_mfma_f32_16x16x32_bf16 a[52:55], v[108:111], v[36:39], a[52:55]
  v_mfma_f32_16x16x32_bf16 a[56:59], v[108:111], v[40:43], a[56:59]
  v_mfma_f32_16x16x32_bf16 a[60:63], v[108:111], v[44:47], a[60:63]
  s_waitcnt vmcnt(25) lgkmcnt(0)
  s_barrier
  s_mov_b32 s67, 0
chk_21:
  v_cmp_eq_u32 vcc, s76, v200
  v_cmp_eq_u32 s[68:69], s77, v201
  s_nop 1
  s_and_b64 vcc, vcc, s[68:69]
  s_cmp_eq_u64 vcc, exec
  s_cbranch_scc1 chk_21_ok
  s_add_u32 s67, s67, 1
  s_cmp_ge_u32 s67, 0x40000
  s_cbranch_scc1 chk_21_ok
  s_sleep 1
  buffer_load_dwordx2 v[200:201], v202, s[72:75], 0 offen sc1
  s_waitcnt vmcnt(0)
  s_branch chk_21
chk_21_ok:
  v_mfma_f32_16x16x32_bf16 a[0:3], v[112:115], v[48:51], a[0:3]
  ds_read_b128 v[16:19], v4 offset:49152
  s_mov_b32 s48, 262144
  v_mfma_f32_16x16x32_bf16 a[4:7], v[112:115], v[52:55], a[4:7]
  ds_read_b64_tr_b16 v[80:81], v6 offset:32768
  s_mov_b32 s49, 2097152
  v_mfma_f32_16x16x32_bf16 a[8:11], v[112:115], v[56:59], a[8:11]
  ds_read_b64_tr_b16 v[82:83], v6 offset:34816
  v_mfma_f32_16x16x32_bf16 a[12:15], v[112:115], v[60:63], a[12:15]
  ds_read_b128 v[20:23], v4 offset:50176
  s_mov_b32 s50, 2113536
  v_mfma_f32_16x16x32_bf16 a[16:19], v[116:119], v[48:51], a[16:19]
  ds_read_b64_tr_b16 v[84:85], v7 offset:32768
  s_add_u32 m0, s51, 32768
  v_mfma_f32_16x16x32_bf16 a[20:23], v[116:119], v[52:55], a[20:23]
  ds_read_b64_tr_b16 v[86:87], v7 offset:34816
  v_mfma_f32_16x16x32_bf16 a[24:27], v[116:119], v[56:59], a[24:27]
  buffer_load_dwordx4 v2, s[12:15], s48 offen offset:0 sc1 lds
  v_mfma_f32_16x16x32_bf16 a[28:31], v[116:119], v[60:63], a[28:31]
  ds_read_b128 v[24:27], v4 offset:51200
  v_mfma_f32_16x16x32_bf16 a[32:35], v[120:123], v[48:51], a[32:35]
  buffer_load_dwordx4 v2, s[12:15], s48 offen offset:1024 sc1 lds
  v_mfma_f32_16x16x32_bf16 a[36:39], v[120:123], v[52:55], a[36:39]
  ds_read_b64_tr_b16 v[88:89], v8 offset:32768
  ds_read_b64_tr_b16 v[90:91], v8 offset:34816
  v_mfma_f32_16x16x32_bf16 a[40:43], v[120:123], v[56:59], a[40:43]
  buffer_load_dwordx4 v2, s[12:15], s48 offen offset:2048 sc1 lds
  v_mfma_f32_16x16x32_bf16 a[44:47], v[120:123], v[60:63], a[44:47]
  ds_read_b128 v[28:31], v4 offset:52224
  ds_read_b64_tr_b16 v[92:93], v9 offset:32768
  v_mfma_f32_16x16x32_bf16 a[48:51], v[124:127], v[48:51], a[48:51]
  buffer_load_dwordx4 v2, s[12:15], s48 offen offset:3072 sc1 lds
  v_mfma_f32_16x16x32_bf16 a[52:55], v[124:127], v[52:55], a[52:55]
  ds_read_b64_tr_b16 v[94:95], v9 offset:34816
  s_add_u32 s48, s48, 16384
  v_mfma_f32_16x16x32_bf16 a[56:59], v[124:127], v[56:59], a[56:59]
  ds_read_b128 v[32:35], v4 offset:57344
  s_add_u32 m0, s52, 16384
  v_mfma_f32_16x16x32_bf16 a[60:63], v[124:127], v[60:63], a[60:63]
  ds_read_b64_tr_b16 v[96:97], v6 offset:36864
  v_mfma_f32_16x16x32_bf16 a[0:3], v[128:131], v[64:67], a[0:3]
  buffer_load_dwordx4 v3, s[16:19], s49 offen lds
  v_mfma_f32_16x16x32_bf16 a[4:7], v[128:131], v[68:71], a[4:7]
  ds_read_b64_tr_b16 v[98:99], v6 offset:38912
  ds_read_b128 v[36:39], v4 offset:58368
  v_mfma_f32_16x16x32_bf16 a[8:11], v[128:131], v[72:75], a[8:11]
  s_add_u32 m0, s52, 17408
  ds_read_b64_tr_b16 v[100:101], v7 offset:36864
  v_mfma_f32_16x16x32_bf16 a[12:15], v[128:131], v[76:79], a[12:15]
  buffer_load_dwordx4 v3, s[16:19], s50 offen lds
  v_mfma_f32_16x16x32_bf16 a[16:19], v[132:135], v[64:67], a[16:19]
  ds_read_b64_tr_b16 v[102:103], v7 offset:38912
  s_add_u32 m0, s52, 24576
  v_mfma_f32_16x16x32_bf16 a[20:23], v[132:135], v[68:71], a[20:23]
  ds_read_b128 v[40:43], v4 offset:59392
  v_mfma_f32_16x16x32_bf16 a[24:27], v[132:135], v[72:75], a[24:27]
  ds_read_b64_tr_b16 v[104:105], v8 offset:36864
  v_mfma_f32_16x16x32_bf16 a[28:31], v[132:135], v[76:79], a[28:31]
  buffer_load_dwordx4 v3, s[20:23], s49 offen lds
  v_mfma_f32_16x16x32_bf16 a[32:35], v[136:139], v[64:67], a[32:35]
  ds_read_b64_tr_b16 v[106:107], v8 offset:38912
  s_add_u32 m0, s52, 25600
  v_mfma_f32_16x16x32_bf16 a[36:39], v[136:139], v[68:71], a[36:39]
  ds_read_b128 v[44:47], v4 offset:60416
  ds_read_b64_tr_b16 v[108:109], v9 offset:36864
  v_mfma_f32_16x16x32_bf16 a[40:43], v[136:139], v[72:75], a[40:43]
  buffer_load_dwordx4 v3, s[20:23], s50 offen lds
  v_mfma_f32_16x16x32_bf16 a[44:47], v[136:139], v[76:79], a[44:47]
  ds_read_b64_tr_b16 v[110:111], v9 offset:38912
  s_add_u32 s49, s49, 131072
  v_mfma_f32_16x16x32_bf16 a[48:51], v[140:143], v[64:67], a[48:51]
  s_add_u32 s50, s50, 131072
  v_mfma_f32_16x16x32_bf16 a[52:55], v[140:143], v[68:71], a[52:55]
  v_mfma_f32_16x16x32_bf16 a[56:59], v[140:143], v[72:75], a[56:59]
  v_mfma_f32_16x16x32_bf16 a[60:63], v[140:143], v[76:79], a[60:63]
  s_waitcnt vmcnt(25) lgkmcnt(0)
  s_barrier
  s_mov_b32 s55, 0
g3_g_28:
  v_mfma_f32_16x16x32_bf16 a[0:3], v[80:83], v[16:19], a[0:3]
  ds_read_b128 v[48:51], v5 offset:0
  s_add_u32 m0, s51, 49152
  v_mfma_f32_16x16x32_bf16 a[4:7], v[80:83], v[20:23], a[4:7]
  ds_read_b64_tr_b16 v[112:113], v6 offset:49152
  v_mfma_f32_16x16x32_bf16 a[8:11], v[80:83], v[24:27], a[8:11]
  buffer_load_dwordx4 v2, s[12:15], s48 offen offset:0 sc1 lds
  v_mfma_f32_16x16x32_bf16 a[12:15], v[80:83], v[28:31], a[12:15]
  ds_read_b64_tr_b16 v[114:115], v6 offset:51200
  ds_read_b128 v[52:55], v5 offset:1024
  v_mfma_f32_16x16x32_bf16 a[16:19], v[84:87], v[16:19], a[16:19]
  buffer_load_dwordx4 v2, s[12:15], s48 offen offset:1024 sc1 lds
  v_mfma_f32_16x16x32_bf16 a[20:23], v[84:87], v[20:23], a[20:23]
  ds_read_b64_tr_b16 v[116:117], v7 offset:49152
  ds_read_b64_tr_b16 v[118:119], v7 offset:51200
  v_mfma_f32_16x16x32_bf16 a[24:27], v[84:87], v[24:27], a[24:27]
  buffer_load_dwordx4 v2, s[12:15], s48 offen offset:2048 sc1 lds
  v_mfma_f32_16x16x32_bf16 a[28:31], v[84:87], v[28:31], a[28:31]
  ds_read_b128 v[56:59], v5 offset:2048
  v_mfma_f32_16x16x32_bf16 a[32:35], v[88:91], v[16:19], a[32:35]
  buffer_load_dwordx4 v2, s[12:15], s48 offen offset:3072 sc1 lds
  v_mfma_f32_16x16x32_bf16 a[36:39], v[88:91], v[20:23], a[36:39]
  ds_read_b64_tr_b16 v[120:121], v8 offset:49152
  ds_read_b64_tr_b16 v[122:123], v8 offset:51200
  v_mfma_f32_16x16x32_bf16 a[40:43], v[88:91], v[24:27], a[40:43]
  s_add_u32 s48, s48, 16384
  ds_read_b128 v[60:63], v5 offset:3072
  v_mfma_f32_16x16x32_bf16 a[44:47], v[88:91], v[28:31], a[44:47]
  ds_read_b64_tr_b16 v[124:125], v9 offset:49152
  s_add_u32 m0, s52, 32768
  v_mfma_f32_16x16x32_bf16 a[48:51], v[92:95], v[16:19], a[48:51]
  ds_read_b64_tr_b16 v[126:127], v9 offset:51200
  v_mfma_f32_16x16x32_bf16 a[52:55], v[92:95], v[20:23], a[52:55]
  buffer_load_dwordx4 v3, s[16:19], s49 offen lds
  v_mfma_f32_16x16x32_bf16 a[56:59], v[92:95], v[24:27], a[56:59]
  ds_read_b128 v[64:67], v5 offset:8192
  v_mfma_f32_16x16x32_bf16 a[60:63], v[92:95], v[28:31], a[60:63]
  ds_read_b64_tr_b16 v[128:129], v6 offset:53248
  s_add_u32 m0, s52, 33792
  v_mfma_f32_16x16x32_bf16 a[0:3], v[96:99], v[32:35], a[0:3]
  ds_read_b64_tr_b16 v[130:131], v6 offset:55296
  v_mfma_f32_16x16x32_bf16 a[4:7], v[96:99], v[36:39], a[4:7]
  buffer_load_dwordx4 v3, s[16:19], s50 offen lds
  v_mfma_f32_16x16x32_bf16 a[8:11], v[96:99], v[40:43], a[8:11]
  ds_read_b128 v[68:71], v5 offset:9216
  ds_read_b64_tr_b16 v[132:133], v7 offset:53248
  v_mfma_f32_16x16x32_bf16 a[12:15], v[96:99], v[44:47], a[12:15]
  s_add_u32 m0, s52, 40960
  ds_read_b64_tr_b16 v[134:135], v7 offset:55296
  v_mfma_f32_16x16x32_bf16 a[16:19], v[100:103], v[32:35], a[16:19]
  buffer_load_dwordx4 v3, s[20:23], s49 offen lds
  v_mfma_f32_16x16x32_bf16 a[20:23], v[100:103], v[36:39], a[20:23]
  ds_read_b128 v[72:75], v5 offset:10240
  v_mfma_f32_16x16x32_bf16 a[24:27], v[100:103], v[40:43], a[24:27]
  ds_read_b64_tr_b16 v[136:137], v8 offset:53248
  s_add_u32 m0, s52, 41984
  v_mfma_f32_16x16x32_bf16 a[28:31], v[100:103], v[44:47], a[28:31]
  ds_read_b64_tr_b16 v[138:139], v8 offset:55296
  v_mfma_f32_16x16x32_bf16 a[32:35], v[104:107], v[32:35], a[32:35]
  ds_read_b128 v[76:79], v5 offset:11264
  v_mfma_f32_16x16x32_bf16 a[36:39], v[104:107], v[36:39], a[36:39]
  buffer_load_dwordx4 v3, s[20:23], s50 offen lds
  v_mfma_f32_16x16x32_bf16 a[40:43], v[104:107], v[40:43], a[40:43]
  ds_read_b64_tr_b16 v[140:141], v9 offset:53248
  ds_read_b64_tr_b16 v[142:143], v9 offset:55296
  v_mfma_f32_16x16x32_bf16 a[44:47], v[104:107], v[44:47], a[44:47]
  s_add_u32 s49, s49, 131072
  v_mfma_f32_16x16x32_bf16 a[48:51], v[108:111], v[32:35], a[48:51]
  s_add_u32 s50, s50, 131072
  v_mfma_f32_16x16x32_bf16 a[52:55], v[108:111], v[36:39], a[52:55]
  v_mfma_f32_16x16x32_bf16 a[56:59], v[108:111], v[40:43], a[56:59]
  v_mfma_f32_16x16x32_bf16 a[60:63], v[108:111], v[44:47], a[60:63]
  s_waitcnt vmcnt(24) lgkmcnt(0)
  s_barrier
  v_mfma_f32_16x16x32_bf16 a[0:3], v[112:115], v[48:51], a[0:3]
  ds_read_b128 v[16:19], v4 offset:0
  s_add_u32 m0, s51, 65536
  v_mfma_f32_16x16x32_bf16 a[4:7], v[112:115], v[52:55], a[4:7]
  ds_read_b64_tr_b16 v[80:81], v10 offset:0
  v_mfma_f32_16x16x32_bf16 a[8:11], v[112:115], v[56:59], a[8:11]
  buffer_load_dwordx4 v2, s[12:15], s48 offen offset:0 sc1 lds
  v_mfma_f32_16x16x32_bf16 a[12:15], v[112:115], v[60:63], a[12:15]
  ds_read_b64_tr_b16 v[82:83], v10 offset:2048
  ds_read_b128 v[20:23], v4 offset:1024
  v_mfma_f32_16x16x32_bf16 a[16:19], v[116:119], v[48:51], a[16:19]
  buffer_load_dwordx4 v2, s[12:15], s48 offen offset:1024 sc1 lds
  v_mfma_f32_16x16x32_bf16 a[20:23], v[116:119], v[52:55], a[20:23]
  ds_read_b64_tr_b16 v[84:85], v11 offset:0
  ds_read_b64_tr_b16 v[86:87], v11 offset:2048
  v_mfma_f32_16x16x32_bf16 a[24:27], v[116:119], v[56:59], a[24:27]
  buffer_load_dwordx4 v2, s[12:15], s48 offen offset:2048 sc1 lds
  v_mfma_f32_16x16x32_bf16 a[28:31], v[116:119], v[60:63], a[28:31]
  ds_read_b128 v[24:27], v4 offset:2048
  v_mfma_f32_16x16x32_bf16 a[32:35], v[120:123], v[48:51], a[32:35]
  buffer_load_dwordx4 v2, s[12:15], s48 offen offset:3072 sc1 lds
  v_mfma_f32_16x16x32_bf16 a[36:39], v[120:123], v[52:55], a[36:39]
  ds_read_b64_tr_b16 v[88:89], v12 offset:0
  ds_read_b64_tr_b16 v[90:91], v12 offset:2048
  v_mfma_f32_16x16x32_bf16 a[40:43], v[120:123], v[56:59], a[40:43]
  s_add_u32 s48, s48, 16384
  ds_read_b128 v[28:31], v4 offset:3072
  v_mfma_f32_16x16x32_bf16 a[44:47], v[120:123], v[60:63], a[44:47]
  ds_read_b64_tr_b16 v[92:93], v13 offset:0
  s_add_u32 m0, s52, 49152
  v_mfma_f32_16x16x32_bf16 a[48:51], v[124:127], v[48:51], a[48:51]
  ds_read_b64_tr_b16 v[94:95], v13 offset:2048
  v_mfma_f32_16x16x32_bf16 a[52:55], v[124:127], v[52:55], a[52:55]
  buffer_load_dwordx4 v3, s[16:19], s49 offen lds
  v_mfma_f32_16x16x32_bf16 a[56:59], v[124:127], v[56:59], a[56:59]
  ds_read_b128 v[32:35], v4 offset:8192
  v_mfma_f32_16x16x32_bf16 a[60:63], v[124:127], v[60:63], a[60:63]
  ds_read_b64_tr_b16 v[96:97], v10 offset:4096
  s_add_u32 m0, s52, 50176
  v_mfma_f32_16x16x32_bf16 a[0:3], v[128:131], v[64:67], a[0:3]
  ds_read_b64_tr_b16 v[98:99], v10 offset:6144
  v_mfma_f32_16x16x32_bf16 a[4:7], v[128:131], v[68:71], a[4:7]
  buffer_load_dwordx4 v3, s[16:19], s50 offen lds
  v_mfma_f32_16x16x32_bf16 a[8:11], v[128:131], v[72:75], a[8:11]
  ds_read_b128 v[36:39], v4 offset:9216
  ds_read_b64_tr_b16 v[100:101], v11 offset:4096
  v_mfma_f32_16x16x32_bf16 a[12:15], v[128:131], v[76:79], a[12:15]
  s_add_u32 m0, s52, 57344
  ds_read_b64_tr_b16 v[102:103], v11 offset:6144
  v_mfma_f32_16x16x32_bf16 a[16:19], v[132:135], v[64:67], a[16:19]
  buffer_load_dwordx4 v3, s[20:23], s49 offen lds
  v_mfma_f32_16x16x32_bf16 a[20:23], v[132:135], v[68:71], a[20:23]
  ds_read_b128 v[40:43], v4 offset:10240
  v_mfma_f32_16x16x32_bf16 a[24:27], v[132:135], v[72:75], a[24:27]
  ds_read_b64_tr_b16 v[104:105], v12 offset:4096
  s_add_u32 m0, s52, 58368
  v_mfma_f32_16x16x32_bf16 a[28:31], v[132:135], v[76:79], a[28:31]
  ds_read_b64_tr_b16 v[106:107], v12 offset:6144
  v_mfma_f32_16x16x32_bf16 a[32:35], v[136:139], v[64:67], a[32:35]
  ds_read_b128 v[44:47], v4 offset:11264
  v_mfma_f32_16x16x32_bf16 a[36:39], v[136:139], v[68:71], a[36:39]
  buffer_load_dwordx4 v3, s[20:23], s50 offen lds
  v_mfma_f32_16x16x32_bf16 a[40:43], v[136:139], v[72:75], a[40:43]
  ds_read_b64_tr_b16 v[108:109], v13 offset:4096
  ds_read_b64_tr_b16 v[110:111], v13 offset:6144
  v_mfma_f32_16x16x32_bf16 a[44:47], v[136:139], v[76:79], a[44:47]
  s_add_u32 s49, s49, 131072
  v_mfma_f32_16x16x32_bf16 a[48:51], v[140:143], v[64:67], a[48:51]
  s_add_u32 s50, s50, 131072
  v_mfma_f32_16x16x32_bf16 a[52:55], v[140:143], v[68:71], a[52:55]
  v_mfma_f32_16x16x32_bf16 a[56:59], v[140:143], v[72:75], a[56:59]
  v_mfma_f32_16x16x32_bf16 a[60:63], v[140:143], v[76:79], a[60:63]
  s_waitcnt vmcnt(24) lgkmcnt(0)
  s_barrier
  v_mfma_f32_16x16x32_bf16 a[0:3], v[80:83], v[16:19], a[0:3]
  ds_read_b128 v[48:51], v4 offset:16384
  s_add_u32 m0, s51, 0
  v_mfma_f32_16x16x32_bf16 a[4:7], v[80:83], v[20:23], a[4:7]
  ds_read_b64_tr_b16 v[112:113], v6 offset:0
  v_mfma_f32_16x16x32_bf16 a[8:11], v[80:83], v[24:27], a[8:11]
  buffer_load_dwordx4 v2, s[12:15], s48 offen offset:0 sc1 lds
  v_mfma_f32_16x16x32_bf16 a[12:15], v[80:83], v[28:31], a[12:15]
  ds_read_b64_tr_b16 v[114:115], v6 offset:2048
  ds_read_b128 v[52:55], v4 offset:17408
  v_mfma_f32_16x16x32_bf16 a[16:19], v[84:87], v[16:19], a[16:19]
  buffer_load_dwordx4 v2, s[12:15], s48 offen offset:1024 sc1 lds
  v_mfma_f32_16x16x32_bf16 a[20:23], v[84:87], v[20:23], a[20:23]
  ds_read_b64_tr_b16 v[116:117], v7 offset:0
  ds_read_b64_tr_b16 v[118:119], v7 offset:2048
  v_mfma_f32_16x16x32_bf16 a[24:27], v[84:87], v[24:27], a[24:27]
  buffer_load_dwordx4 v2, s[12:15], s48 offen offset:2048 sc1 lds
  v_mfma_f32_16x16x32_bf16 a[28:31], v[84:87], v[28:31], a[28:31]
  ds_read_b128 v[56:59], v4 offset:18432
  v_mfma_f32_16x16x32_bf16 a[32:35], v[88:91], v[16:19], a[32:35]
  buffer_load_dwordx4 v2, s[12:15], s48 offen offset:3072 sc1 lds
  v_mfma_f32_16x16x32_bf16 a[36:39], v[88:91], v[20:23], a[36:39]
  ds_read_b64_tr_b16 v[120:121], v8 offset:0
  ds_read_b64_tr_b16 v[122:123], v8 offset:2048
  v_mfma_f32_16x16x32_bf16 a[40:43], v[88:91], v[24:27], a[40:43]
  s_add_u32 s48, s48, 16384
  ds_read_b128 v[60:63], v4 offset:19456
  v_mfma_f32_16x16x32_bf16 a[44:47], v[88:91], v[28:31], a[44:47]
  ds_read_b64_tr_b16 v[124:125], v9 offset:0
  s_add_u32 m0, s52, 65536
  v_mfma_f32_16x16x32_bf16 a[48:51], v[92:95], v[16:19], a[48:51]
  ds_read_b64_tr_b16 v[126:127], v9 offset:2048
  v_mfma_f32_16x16x32_bf16 a[52:55], v[92:95], v[20:23], a[52:55]
  buffer_load_dwordx4 v3, s[16:19], s49 offen lds
  v_mfma_f32_16x16x32_bf16 a[56:59], v[92:95], v[24:27], a[56:59]
  ds_read_b128 v[64:67], v4 offset:24576
  v_mfma_f32_16x16x32_bf16 a[60:63], v[92:95], v[28:31], a[60:63]
  ds_read_b64_tr_b16 v[128:129], v6 offset:4096
  s_add_u32 m0, s52, 66560
  v_mfma_f32_16x16x32_bf16 a[0:3], v[96:99], v[32:35], a[0:3]
  ds_read_b64_tr_b16 v[130:131], v6 offset:6144
  v_mfma_f32_16x16x32_bf16 a[4:7], v[96:99], v[36:39], a[4:7]
  buffer_load_dwordx4 v3, s[16:19], s50 offen lds
  v_mfma_f32_16x16x32_bf16 a[8:11], v[96:99], v[40:43], a[8:11]
  ds_read_b128 v[68:71], v4 offset:25600
  ds_read_b64_tr_b16 v[132:133], v7 offset:4096
  v_mfma_f32_16x16x32_bf16 a[12:15], v[96:99], v[44:47], a[12:15]
  s_add_u32 m0, s52, 73728
  ds_read_b64_tr_b16 v[134:135], v7 offset:6144
  v_mfma_f32_16x16x32_bf16 a[16:19], v[100:103], v[32:35], a[16:19]
  buffer_load_dwordx4 v3, s[20:23], s49 offen lds
  v_mfma_f32_16x16x32_bf16 a[20:23], v[100:103], v[36:39], a[20:23]
  ds_read_b128 v[72:75], v4 offset:26624
  v_mfma_f32_16x16x32_bf16 a[24:27], v[100:103], v[40:43], a[24:27]
  ds_read_b64_tr_b16 v[136:137], v8 offset:4096
  s_add_u32 m0, s52, 74752
  v_mfma_f32_16x16x32_bf16 a[28:31], v[100:103], v[44:47], a[28:31]
  ds_read_b64_tr_b16 v[138:139], v8 offset:6144
  v_mfma_f32_16x16x32_bf16 a[32:35], v[104:107], v[32:35], a[32:35]
  ds_read_b128 v[76:79], v4 offset:27648
  v_mfma_f32_16x16x32_bf16 a[36:39], v[104:107], v[36:39], a[36:39]
  buffer_load_dwordx4 v3, s[20:23], s50 offen lds
  v_mfma_f32_16x16x32_bf16 a[40:43], v[104:107], v[40:43], a[40:43]
  ds_read_b64_tr_b16 v[140:141], v9 offset:4096
  ds_read_b64_tr_b16 v[142:143], v9 offset:6144
  v_mfma_f32_16x16x32_bf16 a[44:47], v[104:107], v[44:47], a[44:47]
  s_add_u32 s49, s49, 131072
  v_mfma_f32_16x16x32_bf16 a[48:51], v[108:111], v[32:35], a[48:51]
  s_add_u32 s50, s50, 131072
  v_mfma_f32_16x16x32_bf16 a[52:55], v[108:111], v[36:39], a[52:55]
  v_mfma_f32_16x16x32_bf16 a[56:59], v[108:111], v[40:43], a[56:59]
  v_mfma_f32_16x16x32_bf16 a[60:63], v[108:111], v[44:47], a[60:63]
  s_waitcnt vmcnt(24) lgkmcnt(0)
  s_barrier
  v_mfma_f32_16x16x32_bf16 a[0:3], v[112:115], v[48:51], a[0:3]
  ds_read_b128 v[16:19], v4 offset:32768
  s_add_u32 m0, s51, 16384
  v_mfma_f32_16x16x32_bf16 a[4:7], v[112:115], v[52:55], a[4:7]
  ds_read_b64_tr_b16 v[80:81], v6 offset:16384
  v_mfma_f32_16x16x32_bf16 a[8:11], v[112:115], v[56:59], a[8:11]
  buffer_load_dwordx4 v2, s[12:15], s48 offen offset:0 sc1 lds
  v_mfma_f32_16x16x32_bf16 a[12:15], v[112:115], v[60:63], a[12:15]
  ds_read_b64_tr_b16 v[82:83], v6 offset:18432
  ds_read_b128 v[20:23], v4 offset:33792
  v_mfma_f32_16x16x32_bf16 a[16:19], v[116:119], v[48:51], a[16:19]
  buffer_load_dwordx4 v2, s[12:15], s48 offen offset:1024 sc1 lds
  v_mfma_f32_16x16x32_bf16 a[20:23], v[116:119], v[52:55], a[20:23]
  ds_read_b64_tr_b16 v[84:85], v7 offset:16384
  ds_read_b64_tr_b16 v[86:87], v7 offset:18432
  v_mfma_f32_16x16x32_bf16 a[24:27], v[116:119], v[56:59], a[24:27]
  buffer_load_dwordx4 v2, s[12:15], s48 offen offset:2048 sc1 lds
  v_mfma_f32_16x16x32_bf16 a[28:31], v[116:119], v[60:63], a[28:31]
  ds_read_b128 v[24:27], v4 offset:34816
  v_mfma_f32_16x16x32_bf16 a[32:35], v[120:123], v[48:51], a[32:35]
  buffer_load_dwordx4 v2, s[12:15], s48 offen offset:3072 sc1 lds
  v_mfma_f32_16x16x32_bf16 a[36:39], v[120:123], v[52:55], a[36:39]
  ds_read_b64_tr_b16 v[88:89], v8 offset:16384
  ds_read_b64_tr_b16 v[90:91], v8 offset:18432
  v_mfma_f32_16x16x32_bf16 a[40:43], v[120:123], v[56:59], a[40:43]
  s_add_u32 s48, s48, 16384
  ds_read_b128 v[28:31], v4 offset:35840
  v_mfma_f32_16x16x32_bf16 a[44:47], v[120:123], v[60:63], a[44:47]
  ds_read_b64_tr_b16 v[92:93], v9 offset:16384
  s_add_u32 m0, s52, 0
  v_mfma_f32_16x16x32_bf16 a[48:51], v[124:127], v[48:51], a[48:51]
  ds_read_b64_tr_b16 v[94:95], v9 offset:18432
  v_mfma_f32_16x16x32_bf16 a[52:55], v[124:127], v[52:55], a[52:55]
  buffer_load_dwordx4 v3, s[16:19], s49 offen lds
  v_mfma_f32_16x16x32_bf16 a[56:59], v[124:127], v[56:59], a[56:59]
  ds_read_b128 v[32:35], v4 offset:40960
  v_mfma_f32_16x16x32_bf16 a[60:63], v[124:127], v[60:63], a[60:63]
  ds_read_b64_tr_b16 v[96:97], v6 offset:20480
  s_add_u32 m0, s52, 1024
  v_mfma_f32_16x16x32_bf16 a[0:3], v[128:131], v[64:67], a[0:3]
  ds_read_b64_tr_b16 v[98:99], v6 offset:22528
  v_mfma_f32_16x16x32_bf16 a[4:7], v[128:131], v[68:71], a[4:7]
  buffer_load_dwordx4 v3, s[16:19], s50 offen lds
  v_mfma_f32_16x16x32_bf16 a[8:11], v[128:131], v[72:75], a[8:11]
  ds_read_b128 v[36:39], v4 offset:41984
  ds_read_b64_tr_b16 v[100:101], v7 offset:20480
  v_mfma_f32_16x16x32_bf16 a[12:15], v[128:131], v[76:79], a[12:15]
  s_add_u32 m0, s52, 8192
  ds_read_b64_tr_b16 v[102:103], v7 offset:22528
  v_mfma_f32_16x16x32_bf16 a[16:19], v[132:135], v[64:67], a[16:19]
  buffer_load_dwordx4 v3, s[20:23], s49 offen lds
  v_mfma_f32_16x16x32_bf16 a[20:23], v[132:135], v[68:71], a[20:23]
  ds_read_b128 v[40:43], v4 offset:43008
  v_mfma_f32_16x16x32_bf16 a[24:27], v[132:135], v[72:75], a[24:27]
  ds_read_b64_tr_b16 v[104:105], v8 offset:20480
  s_add_u32 m0, s52, 9216
  v_mfma_f32_16x16x32_bf16 a[28:31], v[132:135], v[76:79], a[28:31]
  ds_read_b64_tr_b16 v[106:107], v8 offset:22528
  v_mfma_f32_16x16x32_bf16 a[32:35], v[136:139], v[64:67], a[32:35]
  ds_read_b128 v[44:47], v4 offset:44032
  v_mfma_f32_16x16x32_bf16 a[36:39], v[136:139], v[68:71], a[36:39]
  buffer_load_dwordx4 v3, s[20:23], s50 offen lds
  v_mfma_f32_16x16x32_bf16 a[40:43], v[136:139], v[72:75], a[40:43]
  ds_read_b64_tr_b16 v[108:109], v9 offset:20480
  ds_read_b64_tr_b16 v[110:111], v9 offset:22528
  v_mfma_f32_16x16x32_bf16 a[44:47], v[136:139], v[76:79], a[44:47]
  s_add_u32 s49, s49, 131072
  v_mfma_f32_16x16x32_bf16 a[48:51], v[140:143], v[64:67], a[48:51]
  s_add_u32 s50, s50, 131072
  v_mfma_f32_16x16x32_bf16 a[52:55], v[140:143], v[68:71], a[52:55]
  v_mfma_f32_16x16x32_bf16 a[56:59], v[140:143], v[72:75], a[56:59]
  v_mfma_f32_16x16x32_bf16 a[60:63], v[140:143], v[76:79], a[60:63]
  s_waitcnt vmcnt(24) lgkmcnt(0)
  s_barrier
  v_mfma_f32_16x16x32_bf16 a[0:3], v[80:83], v[16:19], a[0:3]
  ds_read_b128 v[48:51], v4 offset:49152
  s_add_u32 m0, s51, 32768
  v_mfma_f32_16x16x32_bf16 a[4:7], v[80:83], v[20:23], a[4:7]
  ds_read_b64_tr_b16 v[112:113], v6 offset:32768
  v_mfma_f32_16x16x32_bf16 a[8:11], v[80:83], v[24:27], a[8:11]
  buffer_load_dwordx4 v2, s[12:15], s48 offen offset:0 sc1 lds
  v_mfma_f32_16x16x32_bf16 a[12:15], v[80:83], v[28:31], a[12:15]
  ds_read_b64_tr_b16 v[114:115], v6 offset:34816
  ds_read_b128 v[52:55], v4 offset:50176
  v_mfma_f32_16x16x32_bf16 a[16:19], v[84:87], v[16:19], a[16:19]
  buffer_load_dwordx4 v2, s[12:15], s48 offen offset:1024 sc1 lds
  v_mfma_f32_16x16x32_bf16 a[20:23], v[84:87], v[20:23], a[20:23]
  ds_read_b64_tr_b16 v[116:117], v7 offset:32768
  ds_read_b64_tr_b16 v[118:119], v7 offset:34816
  v_mfma_f32_16x16x32_bf16 a[24:27], v[84:87], v[24:27], a[24:27]
  buffer_load_dwordx4 v2, s[12:15], s48 offen offset:2048 sc1 lds
  v_mfma_f32_16x16x32_bf16 a[28:31], v[84:87], v[28:31], a[28:31]
  ds_read_b128 v[56:59], v4 offset:51200
  v_mfma_f32_16x16x32_bf16 a[32:35], v[88:91], v[16:19], a[32:35]
  buffer_load_dwordx4 v2, s[12:15], s48 offen offset:3072 sc1 lds
  v_mfma_f32_16x16x32_bf16 a[36:39], v[88:91], v[20:23], a[36:39]
  ds_read_b64_tr_b16 v[120:121], v8 offset:32768
  ds_read_b64_tr_b16 v[122:123], v8 offset:34816
  v_mfma_f32_16x16x32_bf16 a[40:43], v[88:91], v[24:27], a[40:43]
  s_add_u32 s48, s48, 16384
  ds_read_b128 v[60:63], v4 offset:52224
  v_mfma_f32_16x16x32_bf16 a[44:47], v[88:91], v[28:31], a[44:47]
  ds_read_b64_tr_b16 v[124:125], v9 offset:32768
  s_add_u32 m0, s52, 16384
  v_mfma_f32_16x16x32_bf16 a[48:51], v[92:95], v[16:19], a[48:51]
  ds_read_b64_tr_b16 v[126:127], v9 offset:34816
  v_mfma_f32_16x16x32_bf16 a[52:55], v[92:95], v[20:23], a[52:55]
  buffer_load_dwordx4 v3, s[16:19], s49 offen lds
  v_mfma_f32_16x16x32_bf16 a[56:59], v[92:95], v[24:27], a[56:59]
  ds_read_b128 v[64:67], v4 offset:57344
  v_mfma_f32_16x16x32_bf16 a[60:63], v[92:95], v[28:31], a[60:63]
  ds_read_b64_tr_b16 v[128:129], v6 offset:36864
  s_add_u32 m0, s52, 17408
  v_mfma_f32_16x16x32_bf16 a[0:3], v[96:99], v[32:35], a[0:3]
  ds_read_b64_tr_b16 v[130:131], v6 offset:38912
  v_mfma_f32_16x16x32_bf16 a[4:7], v[96:99], v[36:39], a[4:7]
  buffer_load_dwordx4 v3, s[16:19], s50 offen lds
  v_mfma_f32_16x16x32_bf16 a[8:11], v[96:99], v[40:43], a[8:11]
  ds_read_b128 v[68:71], v4 offset:58368
  ds_read_b64_tr_b16 v[132:133], v7 offset:36864
  v_mfma_f32_16x16x32_bf16 a[12:15], v[96:99], v[44:47], a[12:15]
  s_add_u32 m0, s52, 24576
  ds_read_b64_tr_b16 v[134:135], v7 offset:38912
  v_mfma_f32_16x16x32_bf16 a[16:19], v[100:103], v[32:35], a[16:19]
  buffer_load_dwordx4 v3, s[20:23], s49 offen lds
  v_mfma_f32_16x16x32_bf16 a[20:23], v[100:103], v[36:39], a[20:23]
  ds_read_b128 v[72:75], v4 offset:59392
  v_mfma_f32_16x16x32_bf16 a[24:27], v[100:103], v[40:43], a[24:27]
  ds_read_b64_tr_b16 v[136:137], v8 offset:36864
  s_add_u32 m0, s52, 25600
  v_mfma_f32_16x16x32_bf16 a[28:31], v[100:103], v[44:47], a[28:31]
  ds_read_b64_tr_b16 v[138:139], v8 offset:38912
  v_mfma_f32_16x16x32_bf16 a[32:35], v[104:107], v[32:35], a[32:35]
  ds_read_b128 v[76:79], v4 offset:60416
  v_mfma_f32_16x16x32_bf16 a[36:39], v[104:107], v[36:39], a[36:39]
  buffer_load_dwordx4 v3, s[20:23], s50 offen lds
  v_mfma_f32_16x16x32_bf16 a[40:43], v[104:107], v[40:43], a[40:43]
  ds_read_b64_tr_b16 v[140:141], v9 offset:36864
  ds_read_b64_tr_b16 v[142:143], v9 offset:38912
  v_mfma_f32_16x16x32_bf16 a[44:47], v[104:107], v[44:47], a[44:47]
  s_add_u32 s49, s49, 131072
  v_mfma_f32_16x16x32_bf16 a[48:51], v[108:111], v[32:35], a[48:51]
  s_add_u32 s50, s50, 131072
  v_mfma_f32_16x16x32_bf16 a[52:55], v[108:111], v[36:39], a[52:55]
  v_mfma_f32_16x16x32_bf16 a[56:59], v[108:111], v[40:43], a[56:59]
  v_mfma_f32_16x16x32_bf16 a[60:63], v[108:111], v[44:47], a[60:63]
  s_waitcnt vmcnt(24) lgkmcnt(0)
  s_barrier
  v_mfma_f32_16x16x32_bf16 a[0:3], v[112:115], v[48:51], a[0:3]
  ds_read_b128 v[16:19], v5 offset:0
  s_add_u32 m0, s51, 49152
  v_mfma_f32_16x16x32_bf16 a[4:7], v[112:115], v[52:55], a[4:7]
  ds_read_b64_tr_b16 v[80:81], v6 offset:49152
  v_mfma_f32_16x16x32_bf16 a[8:11], v[112:115], v[56:59], a[8:11]
  buffer_load_dwordx4 v2, s[12:15], s48 offen offset:0 sc1 lds
  v_mfma_f32_16x16x32_bf16 a[12:15], v[112:115], v[60:63], a[12:15]
  ds_read_b64_tr_b16 v[82:83], v6 offset:51200
  ds_read_b128 v[20:23], v5 offset:1024
  v_mfma_f32_16x16x32_bf16 a[16:19], v[116:119], v[48:51], a[16:19]
  buffer_load_dwordx4 v2, s[12:15], s48 offen offset:1024 sc1 lds
  v_mfma_f32_16x16x32_bf16 a[20:23], v[116:119], v[52:55], a[20:23]
  ds_read_b64_tr_b16 v[84:85], v7 offset:49152
  ds_read_b64_tr_b16 v[86:87], v7 offset:51200
  v_mfma_f32_16x16x32_bf16 a[24:27], v[116:119], v[56:59], a[24:27]
  buffer_load_dwordx4 v2, s[12:15], s48 offen offset:2048 sc1 lds
  v_mfma_f32_16x16x32_bf16 a[28:31], v[116:119], v[60:63], a[28:31]
  ds_read_b128 v[24:27], v5 offset:2048
  v_mfma_f32_16x16x32_bf16 a[32:35], v[120:123], v[48:51], a[32:35]
  buffer_load_dwordx4 v2, s[12:15], s48 offen offset:3072 sc1 lds
  v_mfma_f32_16x16x32_bf16 a[36:39], v[120:123], v[52:55], a[36:39]
  ds_read_b64_tr_b16 v[88:89], v8 offset:49152
  ds_read_b64_tr_b16 v[90:91], v8 offset:51200
  v_mfma_f32_16x16x32_bf16 a[40:43], v[120:123], v[56:59], a[40:43]
  s_add_u32 s48, s48, 16384
  ds_read_b128 v[28:31], v5 offset:3072
  v_mfma_f32_16x16x32_bf16 a[44:47], v[120:123], v[60:63], a[44:47]
  ds_read_b64_tr_b16 v[92:93], v9 offset:49152
  s_add_u32 m0, s52, 32768
  v_mfma_f32_16x16x32_bf16 a[48:51], v[124:127], v[48:51], a[48:51]
  ds_read_b64_tr_b16 v[94:95], v9 offset:51200
  v_mfma_f32_16x16x32_bf16 a[52:55], v[124:127], v[52:55], a[52:55]
  buffer_load_dwordx4 v3, s[16:19], s49 offen lds
  v_mfma_f32_16x16x32_bf16 a[56:59], v[124:127], v[56:59], a[56:59]
  ds_read_b128 v[32:35], v5 offset:8192
  v_mfma_f32_16x16x32_bf16 a[60:63], v[124:127], v[60:63], a[60:63]
  ds_read_b64_tr_b16 v[96:97], v6 offset:53248
  s_add_u32 m0, s52, 33792
  v_mfma_f32_16x16x32_bf16 a[0:3], v[128:131], v[64:67], a[0:3]
  ds_read_b64_tr_b16 v[98:99], v6 offset:55296
  v_mfma_f32_16x16x32_bf16 a[4:7], v[128:131], v[68:71], a[4:7]
  buffer_load_dwordx4 v3, s[16:19], s50 offen lds
  v_mfma_f32_16x16x32_bf16 a[8:11], v[128:131], v[72:75], a[8:11]
  ds_read_b128 v[36:39], v5 offset:9216
  ds_read_b64_tr_b16 v[100:101], v7 offset:53248
  v_mfma_f32_16x16x32_bf16 a[12:15], v[128:131], v[76:79], a[12:15]
  s_add_u32 m0, s52, 40960
  ds_read_b64_tr_b16 v[102:103], v7 offset:55296
  v_mfma_f32_16x16x32_bf16 a[16:19], v[132:135], v[64:67], a[16:19]
  buffer_load_dwordx4 v3, s[20:23], s49 offen lds
  v_mfma_f32_16x16x32_bf16 a[20:23], v[132:135], v[68:71], a[20:23]
  ds_read_b128 v[40:43], v5 offset:10240
  v_mfma_f32_16x16x32_bf16 a[24:27], v[132:135], v[72:75], a[24:27]
  ds_read_b64_tr_b16 v[104:105], v8 offset:53248
  s_add_u32 m0, s52, 41984
  v_mfma_f32_16x16x32_bf16 a[28:31], v[132:135], v[76:79], a[28:31]
  ds_read_b64_tr_b16 v[106:107], v8 offset:55296
  v_mfma_f32_16x16x32_bf16 a[32:35], v[136:139], v[64:67], a[32:35]
  ds_read_b128 v[44:47], v5 offset:11264
  v_mfma_f32_16x16x32_bf16 a[36:39], v[136:139], v[68:71], a[36:39]
  buffer_load_dwordx4 v3, s[20:23], s50 offen lds
  v_mfma_f32_16x16x32_bf16 a[40:43], v[136:139], v[72:75], a[40:43]
  ds_read_b64_tr_b16 v[108:109], v9 offset:53248
  ds_read_b64_tr_b16 v[110:111], v9 offset:55296
  v_mfma_f32_16x16x32_bf16 a[44:47], v[136:139], v[76:79], a[44:47]
  s_add_u32 s49, s49, 131072
  v_mfma_f32_16x16x32_bf16 a[48:51], v[140:143], v[64:67], a[48:51]
  s_add_u32 s50, s50, 131072
  v_mfma_f32_16x16x32_bf16 a[52:55], v[140:143], v[68:71], a[52:55]
  v_mfma_f32_16x16x32_bf16 a[56:59], v[140:143], v[72:75], a[56:59]
  v_mfma_f32_16x16x32_bf16 a[60:63], v[140:143], v[76:79], a[60:63]
  s_waitcnt vmcnt(24) lgkmcnt(0)
  s_barrier
  v_mfma_f32_16x16x32_bf16 a[0:3], v[80:83], v[16:19], a[0:3]
  ds_read_b128 v[48:51], v4 offset:0
  s_add_u32 m0, s51, 65536
  v_mfma_f32_16x16x32_bf16 a[4:7], v[80:83], v[20:23], a[4:7]
  ds_read_b64_tr_b16 v[112:113], v10 offset:0
  v_mfma_f32_16x16x32_bf16 a[8:11], v[80:83], v[24:27], a[8:11]
  buffer_load_dwordx4 v2, s[12:15], s48 offen offset:0 sc1 lds
  v_mfma_f32_16x16x32_bf16 a[12:15], v[80:83], v[28:31], a[12:15]
  ds_read_b64_tr_b16 v[114:115], v10 offset:2048
  ds_read_b128 v[52:55], v4 offset:1024
  v_mfma_f32_16x16x32_bf16 a[16:19], v[84:87], v[16:19], a[16:19]
  buffer_load_dwordx4 v2, s[12:15], s48 offen offset:1024 sc1 lds
  v_mfma_f32_16x16x32_bf16 a[20:23], v[84:87], v[20:23], a[20:23]
  ds_read_b64_tr_b16 v[116:117], v11 offset:0
  ds_read_b64_tr_b16 v[118:119], v11 offset:2048
  v_mfma_f32_16x16x32_bf16 a[24:27], v[84:87], v[24:27], a[24:27]
  buffer_load_dwordx4 v2, s[12:15], s48 offen offset:2048 sc1 lds
  v_mfma_f32_16x16x32_bf16 a[28:31], v[84:87], v[28:31], a[28:31]
  ds_read_b128 v[56:59], v4 offset:2048
  v_mfma_f32_16x16x32_bf16 a[32:35], v[88:91], v[16:19], a[32:35]
  buffer_load_dwordx4 v2, s[12:15], s48 offen offset:3072 sc1 lds
  v_mfma_f32_16x16x32_bf16 a[36:39], v[88:91], v[20:23], a[36:39]
  ds_read_b64_tr_b16 v[120:121], v12 offset:0
  ds_read_b64_tr_b16 v[122:123], v12 offset:2048
  v_mfma_f32_16x16x32_bf16 a[40:43], v[88:91], v[24:27], a[40:43]
  s_add_u32 s48, s48, 16384
  ds_read_b128 v[60:63], v4 offset:3072
  v_mfma_f32_16x16x32_bf16 a[44:47], v[88:91], v[28:31], a[44:47]
  ds_read_b64_tr_b16 v[124:125], v13 offset:0
  s_add_u32 m0, s52, 49152
  v_mfma_f32_16x16x32_bf16 a[48:51], v[92:95], v[16:19], a[48:51]
  ds_read_b64_tr_b16 v[126:127], v13 offset:2048
  v_mfma_f32_16x16x32_bf16 a[52:55], v[92:95], v[20:23], a[52:55]
  buffer_load_dwordx4 v3, s[16:19], s49 offen lds
  v_mfma_f32_16x16x32_bf16 a[56:59], v[92:95], v[24:27], a[56:59]
  ds_read_b128 v[64:67], v4 offset:8192
  v_mfma_f32_16x16x32_bf16 a[60:63], v[92:95], v[28:31], a[60:63]
  ds_read_b64_tr_b16 v[128:129], v10 offset:4096
  s_add_u32 m0, s52, 50176
  v_mfma_f32_16x16x32_bf16 a[0:3], v[96:99], v[32:35], a[0:3]
  ds_read_b64_tr_b16 v[130:131], v10 offset:6144
  v_mfma_f32_16x16x32_bf16 a[4:7], v[96:99], v[36:39], a[4:7]
  buffer_load_dwordx4 v3, s[16:19], s50 offen lds
  v_mfma_f32_16x16x32_bf16 a[8:11], v[96:99], v[40:43], a[8:11]
  ds_read_b128 v[68:71], v4 offset:9216
  ds_read_b64_tr_b16 v[132:133], v11 offset:4096
  v_mfma_f32_16x16x32_bf16 a[12:15], v[96:99], v[44:47], a[12:15]
  s_add_u32 m0, s52, 57344
  ds_read_b64_tr_b16 v[134:135], v11 offset:6144
  v_mfma_f32_16x16x32_bf16 a[16:19], v[100:103], v[32:35], a[16:19]
  buffer_load_dwordx4 v3, s[20:23], s49 offen lds
  v_mfma_f32_16x16x32_bf16 a[20:23], v[100:103], v[36:39], a[20:23]
  ds_read_b128 v[72:75], v4 offset:10240
  v_mfma_f32_16x16x32_bf16 a[24:27], v[100:103], v[40:43], a[24:27]
  ds_read_b64_tr_b16 v[136:137], v12 offset:4096
  s_add_u32 m0, s52, 58368
  v_mfma_f32_16x16x32_bf16 a[28:31], v[100:103], v[44:47], a[28:31]
  ds_read_b64_tr_b16 v[138:139], v12 offset:6144
  v_mfma_f32_16x16x32_bf16 a[32:35], v[104:107], v[32:35], a[32:35]
  ds_read_b128 v[76:79], v4 offset:11264
  v_mfma_f32_16x16x32_bf16 a[36:39], v[104:107], v[36:39], a[36:39]
  buffer_load_dwordx4 v3, s[20:23], s50 offen lds
  v_mfma_f32_16x16x32_bf16 a[40:43], v[104:107], v[40:43], a[40:43]
  ds_read_b64_tr_b16 v[140:141], v13 offset:4096
  ds_read_b64_tr_b16 v[142:143], v13 offset:6144
  v_mfma_f32_16x16x32_bf16 a[44:47], v[104:107], v[44:47], a[44:47]
  s_add_u32 s49, s49, 131072
  v_mfma_f32_16x16x32_bf16 a[48:51], v[108:111], v[32:35], a[48:51]
  s_add_u32 s50, s50, 131072
  v_mfma_f32_16x16x32_bf16 a[52:55], v[108:111], v[36:39], a[52:55]
  v_mfma_f32_16x16x32_bf16 a[56:59], v[108:111], v[40:43], a[56:59]
  v_mfma_f32_16x16x32_bf16 a[60:63], v[108:111], v[44:47], a[60:63]
  s_waitcnt vmcnt(24) lgkmcnt(0)
  s_barrier
  v_mfma_f32_16x16x32_bf16 a[0:3], v[112:115], v[48:51], a[0:3]
  ds_read_b128 v[16:19], v4 offset:16384
  s_add_u32 m0, s51, 0
  v_mfma_f32_16x16x32_bf16 a[4:7], v[112:115], v[52:55], a[4:7]
  ds_read_b64_tr_b16 v[80:81], v6 offset:0
  v_mfma_f32_16x16x32_bf16 a[8:11], v[112:115], v[56:59], a[8:11]
  buffer_load_dwordx4 v2, s[12:15], s48 offen offset:0 sc1 lds
  v_mfma_f32_16x16x32_bf16 a[12:15], v[112:115], v[60:63], a[12:15]
  ds_read_b64_tr_b16 v[82:83], v6 offset:2048
  ds_read_b128 v[20:23], v4 offset:17408
  v_mfma_f32_16x16x32_bf16 a[16:19], v[116:119], v[48:51], a[16:19]
  buffer_load_dwordx4 v2, s[12:15], s48 offen offset:1024 sc1 lds
  v_mfma_f32_16x16x32_bf16 a[20:23], v[116:119], v[52:55], a[20:23]
  ds_read_b64_tr_b16 v[84:85], v7 offset:0
  ds_read_b64_tr_b16 v[86:87], v7 offset:2048
  v_mfma_f32_16x16x32_bf16 a[24:27], v[116:119], v[56:59], a[24:27]
  buffer_load_dwordx4 v2, s[12:15], s48 offen offset:2048 sc1 lds
  v_mfma_f32_16x16x32_bf16 a[28:31], v[116:119], v[60:63], a[28:31]
  ds_read_b128 v[24:27], v4 offset:18432
  v_mfma_f32_16x16x32_bf16 a[32:35], v[120:123], v[48:51], a[32:35]
  buffer_load_dwordx4 v2, s[12:15], s48 offen offset:3072 sc1 lds
  v_mfma_f32_16x16x32_bf16 a[36:39], v[120:123], v[52:55], a[36:39]
  ds_read_b64_tr_b16 v[88:89], v8 offset:0
  ds_read_b64_tr_b16 v[90:91], v8 offset:2048
  v_mfma_f32_16x16x32_bf16 a[40:43], v[120:123], v[56:59], a[40:43]
  s_add_u32 s48, s48, 16384
  ds_read_b128 v[28:31], v4 offset:19456
  v_mfma_f32_16x16x32_bf16 a[44:47], v[120:123], v[60:63], a[44:47]
  ds_read_b64_tr_b16 v[92:93], v9 offset:0
  s_add_u32 m0, s52, 65536
  v_mfma_f32_16x16x32_bf16 a[48:51], v[124:127], v[48:51], a[48:51]
  ds_read_b64_tr_b16 v[94:95], v9 offset:2048
  v_mfma_f32_16x16x32_bf16 a[52:55], v[124:127], v[52:55], a[52:55]
  buffer_load_dwordx4 v3, s[16:19], s49 offen lds
  v_mfma_f32_16x16x32_bf16 a[56:59], v[124:127], v[56:59], a[56:59]
  ds_read_b128 v[32:35], v4 offset:24576
  v_mfma_f32_16x16x32_bf16 a[60:63], v[124:127], v[60:63], a[60:63]
  ds_read_b64_tr_b16 v[96:97], v6 offset:4096
  s_add_u32 m0, s52, 66560
  v_mfma_f32_16x16x32_bf16 a[0:3], v[128:131], v[64:67], a[0:3]
  ds_read_b64_tr_b16 v[98:99], v6 offset:6144
  v_mfma_f32_16x16x32_bf16 a[4:7], v[128:131], v[68:71], a[4:7]
  buffer_load_dwordx4 v3, s[16:19], s50 offen lds
  v_mfma_f32_16x16x32_bf16 a[8:11], v[128:131], v[72:75], a[8:11]
  ds_read_b128 v[36:39], v4 offset:25600
  ds_read_b64_tr_b16 v[100:101], v7 offset:4096
  v_mfma_f32_16x16x32_bf16 a[12:15], v[128:131], v[76:79], a[12:15]
  s_add_u32 m0, s52, 73728
  ds_read_b64_tr_b16 v[102:103], v7 offset:6144
  v_mfma_f32_16x16x32_bf16 a[16:19], v[132:135], v[64:67], a[16:19]
  buffer_load_dwordx4 v3, s[20:23], s49 offen lds
  v_mfma_f32_16x16x32_bf16 a[20:23], v[132:135], v[68:71], a[20:23]
  ds_read_b128 v[40:43], v4 offset:26624
  v_mfma_f32_16x16x32_bf16 a[24:27], v[132:135], v[72:75], a[24:27]
  ds_read_b64_tr_b16 v[104:105], v8 offset:4096
  s_add_u32 m0, s52, 74752
  v_mfma_f32_16x16x32_bf16 a[28:31], v[132:135], v[76:79], a[28:31]
  ds_read_b64_tr_b16 v[106:107], v8 offset:6144
  v_mfma_f32_16x16x32_bf16 a[32:35], v[136:139], v[64:67], a[32:35]
  ds_read_b128 v[44:47], v4 offset:27648
  v_mfma_f32_16x16x32_bf16 a[36:39], v[136:139], v[68:71], a[36:39]
  buffer_load_dwordx4 v3, s[20:23], s50 offen lds
  v_mfma_f32_16x16x32_bf16 a[40:43], v[136:139], v[72:75], a[40:43]
  ds_read_b64_tr_b16 v[108:109], v9 offset:4096
  ds_read_b64_tr_b16 v[110:111], v9 offset:6144
  v_mfma_f32_16x16x32_bf16 a[44:47], v[136:139], v[76:79], a[44:47]
  s_add_u32 s49, s49, 131072
  v_mfma_f32_16x16x32_bf16 a[48:51], v[140:143], v[64:67], a[48:51]
  s_add_u32 s50, s50, 131072
  v_mfma_f32_16x16x32_bf16 a[52:55], v[140:143], v[68:71], a[52:55]
  v_mfma_f32_16x16x32_bf16 a[56:59], v[140:143], v[72:75], a[56:59]
  v_mfma_f32_16x16x32_bf16 a[60:63], v[140:143], v[76:79], a[60:63]
  s_waitcnt vmcnt(24) lgkmcnt(0)
  s_barrier
  v_mfma_f32_16x16x32_bf16 a[0:3], v[80:83], v[16:19], a[0:3]
  ds_read_b128 v[48:51], v4 offset:32768
  s_add_u32 m0, s51, 16384
  v_mfma_f32_16x16x32_bf16 a[4:7], v[80:83], v[20:23], a[4:7]
  ds_read_b64_tr_b16 v[112:113], v6 offset:16384
  v_mfma_f32_16x16x32_bf16 a[8:11], v[80:83], v[24:27], a[8:11]
  buffer_load_dwordx4 v2, s[12:15], s48 offen offset:0 sc1 lds
  v_mfma_f32_16x16x32_bf16 a[12:15], v[80:83], v[28:31], a[12:15]
  ds_read_b64_tr_b16 v[114:115], v6 offset:18432
  ds_read_b128 v[52:55], v4 offset:33792
  v_mfma_f32_16x16x32_bf16 a[16:19], v[84:87], v[16:19], a[16:19]
  buffer_load_dwordx4 v2, s[12:15], s48 offen offset:1024 sc1 lds
  v_mfma_f32_16x16x32_bf16 a[20:23], v[84:87], v[20:23], a[20:23]
  ds_read_b64_tr_b16 v[116:117], v7 offset:16384
  ds_read_b64_tr_b16 v[118:119], v7 offset:18432
  v_mfma_f32_16x16x32_bf16 a[24:27], v[84:87], v[24:27], a[24:27]
  buffer_load_dwordx4 v2, s[12:15], s48 offen offset:2048 sc1 lds
  v_mfma_f32_16x16x32_bf16 a[28:31], v[84:87], v[28:31], a[28:31]
  ds_read_b128 v[56:59], v4 offset:34816
  v_mfma_f32_16x16x32_bf16 a[32:35], v[88:91], v[16:19], a[32:35]
  buffer_load_dwordx4 v2, s[12:15], s48 offen offset:3072 sc1 lds
  v_mfma_f32_16x16x32_bf16 a[36:39], v[88:91], v[20:23], a[36:39]
  ds_read_b64_tr_b16 v[120:121], v8 offset:16384
  ds_read_b64_tr_b16 v[122:123], v8 offset:18432
  v_mfma_f32_16x16x32_bf16 a[40:43], v[88:91], v[24:27], a[40:43]
  s_add_u32 s48, s48, 16384
  ds_read_b128 v[60:63], v4 offset:35840
  v_mfma_f32_16x16x32_bf16 a[44:47], v[88:91], v[28:31], a[44:47]
  ds_read_b64_tr_b16 v[124:125], v9 offset:16384
  s_add_u32 m0, s52, 0
  v_mfma_f32_16x16x32_bf16 a[48:51], v[92:95], v[16:19], a[48:51]
  ds_read_b64_tr_b16 v[126:127], v9 offset:18432
  v_mfma_f32_16x16x32_bf16 a[52:55], v[92:95], v[20:23], a[52:55]
  buffer_load_dwordx4 v3, s[16:19], s49 offen lds
  v_mfma_f32_16x16x32_bf16 a[56:59], v[92:95], v[24:27], a[56:59]
  ds_read_b128 v[64:67], v4 offset:40960
  v_mfma_f32_16x16x32_bf16 a[60:63], v[92:95], v[28:31], a[60:63]
  ds_read_b64_tr_b16 v[128:129], v6 offset:20480
  s_add_u32 m0, s52, 1024
  v_mfma_f32_16x16x32_bf16 a[0:3], v[96:99], v[32:35], a[0:3]
  ds_read_b64_tr_b16 v[130:131], v6 offset:22528
  v_mfma_f32_16x16x32_bf16 a[4:7], v[96:99], v[36:39], a[4:7]
  buffer_load_dwordx4 v3, s[16:19], s50 offen lds
  v_mfma_f32_16x16x32_bf16 a[8:11], v[96:99], v[40:43], a[8:11]
  ds_read_b128 v[68:71], v4 offset:41984
  ds_read_b64_tr_b16 v[132:133], v7 offset:20480
  v_mfma_f32_16x16x32_bf16 a[12:15], v[96:99], v[44:47], a[12:15]
  s_add_u32 m0, s52, 8192
  ds_read_b64_tr_b16 v[134:135], v7 offset:22528
  v_mfma_f32_16x16x32_bf16 a[16:19], v[100:103], v[32:35], a[16:19]
  buffer_load_dwordx4 v3, s[20:23], s49 offen lds
  v_mfma_f32_16x16x32_bf16 a[20:23], v[100:103], v[36:39], a[20:23]
  ds_read_b128 v[72:75], v4 offset:43008
  v_mfma_f32_16x16x32_bf16 a[24:27], v[100:103], v[40:43], a[24:27]
  ds_read_b64_tr_b16 v[136:137], v8 offset:20480
  s_add_u32 m0, s52, 9216
  v_mfma_f32_16x16x32_bf16 a[28:31], v[100:103], v[44:47], a[28:31]
  ds_read_b64_tr_b16 v[138:139], v8 offset:22528
  v_mfma_f32_16x16x32_bf16 a[32:35], v[104:107], v[32:35], a[32:35]
  ds_read_b128 v[76:79], v4 offset:44032
  v_mfma_f32_16x16x32_bf16 a[36:39], v[104:107], v[36:39], a[36:39]
  buffer_load_dwordx4 v3, s[20:23], s50 offen lds
  v_mfma_f32_16x16x32_bf16 a[40:43], v[104:107], v[40:43], a[40:43]
  ds_read_b64_tr_b16 v[140:141], v9 offset:20480
  ds_read_b64_tr_b16 v[142:143], v9 offset:22528
  v_mfma_f32_16x16x32_bf16 a[44:47], v[104:107], v[44:47], a[44:47]
  s_add_u32 s49, s49, 131072
  v_mfma_f32_16x16x32_bf16 a[48:51], v[108:111], v[32:35], a[48:51]
  s_add_u32 s50, s50, 131072
  v_mfma_f32_16x16x32_bf16 a[52:55], v[108:111], v[36:39], a[52:55]
  v_mfma_f32_16x16x32_bf16 a[56:59], v[108:111], v[40:43], a[56:59]
  v_mfma_f32_16x16x32_bf16 a[60:63], v[108:111], v[44:47], a[60:63]
  s_waitcnt vmcnt(24) lgkmcnt(0)
  s_barrier
  v_mfma_f32_16x16x32_bf16 a[0:3], v[112:115], v[48:51], a[0:3]
  ds_read_b128 v[16:19], v4 offset:49152
  s_add_u32 m0, s51, 32768
  v_mfma_f32_16x16x32_bf16 a[4:7], v[112:115], v[52:55], a[4:7]
  ds_read_b64_tr_b16 v[80:81], v6 offset:32768
  v_mfma_f32_16x16x32_bf16 a[8:11], v[112:115], v[56:59], a[8:11]
  buffer_load_dwordx4 v2, s[12:15], s48 offen offset:0 sc1 lds
  v_mfma_f32_16x16x32_bf16 a[12:15], v[112:115], v[60:63], a[12:15]
  ds_read_b64_tr_b16 v[82:83], v6 offset:34816
  ds_read_b128 v[20:23], v4 offset:50176
  v_mfma_f32_16x16x32_bf16 a[16:19], v[116:119], v[48:51], a[16:19]
  buffer_load_dwordx4 v2, s[12:15], s48 offen offset:1024 sc1 lds
  v_mfma_f32_16x16x32_bf16 a[20:23], v[116:119], v[52:55], a[20:23]
  ds_read_b64_tr_b16 v[84:85], v7 offset:32768
  ds_read_b64_tr_b16 v[86:87], v7 offset:34816
  v_mfma_f32_16x16x32_bf16 a[24:27], v[116:119], v[56:59], a[24:27]
  buffer_load_dwordx4 v2, s[12:15], s48 offen offset:2048 sc1 lds
  v_mfma_f32_16x16x32_bf16 a[28:31], v[116:119], v[60:63], a[28:31]
  ds_read_b128 v[24:27], v4 offset:51200
  v_mfma_f32_16x16x32_bf16 a[32:35], v[120:123], v[48:51], a[32:35]
  buffer_load_dwordx4 v2, s[12:15], s48 offen offset:3072 sc1 lds
  v_mfma_f32_16x16x32_bf16 a[36:39], v[120:123], v[52:55], a[36:39]
  ds_read_b64_tr_b16 v[88:89], v8 offset:32768
  ds_read_b64_tr_b16 v[90:91], v8 offset:34816
  v_mfma_f32_16x16x32_bf16 a[40:43], v[120:123], v[56:59], a[40:43]
  s_add_u32 s48, s48, 16384
  ds_read_b128 v[28:31], v4 offset:52224
  v_mfma_f32_16x16x32_bf16 a[44:47], v[120:123], v[60:63], a[44:47]
  ds_read_b64_tr_b16 v[92:93], v9 offset:32768
  s_add_u32 m0, s52, 16384
  v_mfma_f32_16x16x32_bf16 a[48:51], v[124:127], v[48:51], a[48:51]
  ds_read_b64_tr_b16 v[94:95], v9 offset:34816
  v_mfma_f32_16x16x32_bf16 a[52:55], v[124:127], v[52:55], a[52:55]
  buffer_load_dwordx4 v3, s[16:19], s49 offen lds
  v_mfma_f32_16x16x32_bf16 a[56:59], v[124:127], v[56:59], a[56:59]
  ds_read_b128 v[32:35], v4 offset:57344
  v_mfma_f32_16x16x32_bf16 a[60:63], v[124:127], v[60:63], a[60:63]
  ds_read_b64_tr_b16 v[96:97], v6 offset:36864
  s_add_u32 m0, s52, 17408
  v_mfma_f32_16x16x32_bf16 a[0:3], v[128:131], v[64:67], a[0:3]
  ds_read_b64_tr_b16 v[98:99], v6 offset:38912
  v_mfma_f32_16x16x32_bf16 a[4:7], v[128:131], v[68:71], a[4:7]
  buffer_load_dwordx4 v3, s[16:19], s50 offen lds
  v_mfma_f32_16x16x32_bf16 a[8:11], v[128:131], v[72:75], a[8:11]
  ds_read_b128 v[36:39], v4 offset:58368
  ds_read_b64_tr_b16 v[100:101], v7 offset:36864
  v_mfma_f32_16x16x32_bf16 a[12:15], v[128:131], v[76:79], a[12:15]
  s_add_u32 m0, s52, 24576
  ds_read_b64_tr_b16 v[102:103], v7 offset:38912
  v_mfma_f32_16x16x32_bf16 a[16:19], v[132:135], v[64:67], a[16:19]
  buffer_load_dwordx4 v3, s[20:23], s49 offen lds
  v_mfma_f32_16x16x32_bf16 a[20:23], v[132:135], v[68:71], a[20:23]
  ds_read_b128 v[40:43], v4 offset:59392
  v_mfma_f32_16x16x32_bf16 a[24:27], v[132:135], v[72:75], a[24:27]
  ds_read_b64_tr_b16 v[104:105], v8 offset:36864
  s_add_u32 m0, s52, 25600
  v_mfma_f32_16x16x32_bf16 a[28:31], v[132:135], v[76:79], a[28:31]
  ds_read_b64_tr_b16 v[106:107], v8 offset:38912
  v_mfma_f32_16x16x32_bf16 a[32:35], v[136:139], v[64:67], a[32:35]
  ds_read_b128 v[44:47], v4 offset:60416
  v_mfma_f32_16x16x32_bf16 a[36:39], v[136:139], v[68:71], a[36:39]
  buffer_load_dwordx4 v3, s[20:23], s50 offen lds
  v_mfma_f32_16x16x32_bf16 a[40:43], v[136:139], v[72:75], a[40:43]
  ds_read_b64_tr_b16 v[108:109], v9 offset:36864
  ds_read_b64_tr_b16 v[110:111], v9 offset:38912
  v_mfma_f32_16x16x32_bf16 a[44:47], v[136:139], v[76:79], a[44:47]
  s_add_u32 s49, s49, 131072
  v_mfma_f32_16x16x32_bf16 a[48:51], v[140:143], v[64:67], a[48:51]
  s_add_u32 s50, s50, 131072
  v_mfma_f32_16x16x32_bf16 a[52:55], v[140:143], v[68:71], a[52:55]
  v_mfma_f32_16x16x32_bf16 a[56:59], v[140:143], v[72:75], a[56:59]
  v_mfma_f32_16x16x32_bf16 a[60:63], v[140:143], v[76:79], a[60:63]
  s_waitcnt vmcnt(24) lgkmcnt(0)
  s_barrier
  s_add_u32 s55, s55, 1
  s_cmp_lt_u32 s55, 2
  s_cbranch_scc1 g3_g_28
  v_mfma_f32_16x16x32_bf16 a[0:3], v[80:83], v[16:19], a[0:3]
  ds_read_b128 v[48:51], v5 offset:0
  s_add_u32 m0, s51, 49152
  v_mfma_f32_16x16x32_bf16 a[4:7], v[80:83], v[20:23], a[4:7]
  ds_read_b64_tr_b16 v[112:113], v6 offset:49152
  v_mfma_f32_16x16x32_bf16 a[8:11], v[80:83], v[24:27], a[8:11]
  buffer_load_dwordx4 v2, s[12:15], s48 offen offset:0 sc1 lds
  v_mfma_f32_16x16x32_bf16 a[12:15], v[80:83], v[28:31], a[12:15]
  ds_read_b64_tr_b16 v[114:115], v6 offset:51200
  ds_read_b128 v[52:55], v5 offset:1024
  v_mfma_f32_16x16x32_bf16 a[16:19], v[84:87], v[16:19], a[16:19]
  buffer_load_dwordx4 v2, s[12:15], s48 offen offset:1024 sc1 lds
  v_mfma_f32_16x16x32_bf16 a[20:23], v[84:87], v[20:23], a[20:23]
  ds_read_b64_tr_b16 v[116:117], v7 offset:49152
  ds_read_b64_tr_b16 v[118:119], v7 offset:51200
  v_mfma_f32_16x16x32_bf16 a[24:27], v[84:87], v[24:27], a[24:27]
  buffer_load_dwordx4 v2, s[12:15], s48 offen offset:2048 sc1 lds
  v_mfma_f32_16x16x32_bf16 a[28:31], v[84:87], v[28:31], a[28:31]
  ds_read_b128 v[56:59], v5 offset:2048
  v_mfma_f32_16x16x32_bf16 a[32:35], v[88:91], v[16:19], a[32:35]
  buffer_load_dwordx4 v2, s[12:15], s48 offen offset:3072 sc1 lds
  v_mfma_f32_16x16x32_bf16 a[36:39], v[88:91], v[20:23], a[36:39]
  ds_read_b64_tr_b16 v[120:121], v8 offset:49152
  ds_read_b64_tr_b16 v[122:123], v8 offset:51200
  v_mfma_f32_16x16x32_bf16 a[40:43], v[88:91], v[24:27], a[40:43]
  s_add_u32 s48, s48, 16384
  ds_read_b128 v[60:63], v5 offset:3072
  v_mfma_f32_16x16x32_bf16 a[44:47], v[88:91], v[28:31], a[44:47]
  ds_read_b64_tr_b16 v[124:125], v9 offset:49152
  s_add_u32 m0, s52, 32768
  v_mfma_f32_16x16x32_bf16 a[48:51], v[92:95], v[16:19], a[48:51]
  ds_read_b64_tr_b16 v[126:127], v9 offset:51200
  v_mfma_f32_16x16x32_bf16 a[52:55], v[92:95], v[20:23], a[52:55]
  buffer_load_dwordx4 v3, s[16:19], s49 offen lds
  v_mfma_f32_16x16x32_bf16 a[56:59], v[92:95], v[24:27], a[56:59]
  ds_read_b128 v[64:67], v5 offset:8192
  v_mfma_f32_16x16x32_bf16 a[60:63], v[92:95], v[28:31], a[60:63]
  ds_read_b64_tr_b16 v[128:129], v6 offset:53248
  s_add_u32 m0, s52, 33792
  v_mfma_f32_16x16x32_bf16 a[0:3], v[96:99], v[32:35], a[0:3]
  ds_read_b64_tr_b16 v[130:131], v6 offset:55296
  v_mfma_f32_16x16x32_bf16 a[4:7], v[96:99], v[36:39], a[4:7]
  buffer_load_dwordx4 v3, s[16:19], s50 offen lds
  v_mfma_f32_16x16x32_bf16 a[8:11], v[96:99], v[40:43], a[8:11]
  ds_read_b128 v[68:71], v5 offset:9216
  ds_read_b64_tr_b16 v[132:133], v7 offset:53248
  v_mfma_f32_16x16x32_bf16 a[12:15], v[96:99], v[44:47], a[12:15]
  s_add_u32 m0, s52, 40960
  ds_read_b64_tr_b16 v[134:135], v7 offset:55296
  v_mfma_f32_16x16x32_bf16 a[16:19], v[100:103], v[32:35], a[16:19]
  buffer_load_dwordx4 v3, s[20:23], s49 offen lds
  v_mfma_f32_16x16x32_bf16 a[20:23], v[100:103], v[36:39], a[20:23]
  ds_read_b128 v[72:75], v5 offset:10240
  v_mfma_f32_16x16x32_bf16 a[24:27], v[100:103], v[40:43], a[24:27]
  ds_read_b64_tr_b16 v[136:137], v8 offset:53248
  s_add_u32 m0, s52, 41984
  v_mfma_f32_16x16x32_bf16 a[28:31], v[100:103], v[44:47], a[28:31]
  ds_read_b64_tr_b16 v[138:139], v8 offset:55296
  v_mfma_f32_16x16x32_bf16 a[32:35], v[104:107], v[32:35], a[32:35]
  ds_read_b128 v[76:79], v5 offset:11264
  v_mfma_f32_16x16x32_bf16 a[36:39], v[104:107], v[36:39], a[36:39]
  buffer_load_dwordx4 v3, s[20:23], s50 offen lds
  v_mfma_f32_16x16x32_bf16 a[40:43], v[104:107], v[40:43], a[40:43]
  ds_read_b64_tr_b16 v[140:141], v9 offset:53248
  ds_read_b64_tr_b16 v[142:143], v9 offset:55296
  v_mfma_f32_16x16x32_bf16 a[44:47], v[104:107], v[44:47], a[44:47]
  s_add_u32 s49, s49, 131072
  v_mfma_f32_16x16x32_bf16 a[48:51], v[108:111], v[32:35], a[48:51]
  s_add_u32 s50, s50, 131072
  v_mfma_f32_16x16x32_bf16 a[52:55], v[108:111], v[36:39], a[52:55]
  v_mfma_f32_16x16x32_bf16 a[56:59], v[108:111], v[40:43], a[56:59]
  v_mfma_f32_16x16x32_bf16 a[60:63], v[108:111], v[44:47], a[60:63]
  s_waitcnt vmcnt(24) lgkmcnt(0)
  s_barrier
  v_mfma_f32_16x16x32_bf16 a[0:3], v[112:115], v[48:51], a[0:3]
  ds_read_b128 v[16:19], v4 offset:0
  s_add_u32 m0, s51, 65536
  v_mfma_f32_16x16x32_bf16 a[4:7], v[112:115], v[52:55], a[4:7]
  ds_read_b64_tr_b16 v[80:81], v10 offset:0
  s_lshl_b32 s66, s43, 5
  v_mfma_f32_16x16x32_bf16 a[8:11], v[112:115], v[56:59], a[8:11]
  buffer_load_dwordx4 v2, s[12:15], s48 offen offset:0 sc1 lds
  v_mfma_f32_16x16x32_bf16 a[12:15], v[112:115], v[60:63], a[12:15]
  ds_read_b64_tr_b16 v[82:83], v10 offset:2048
  ds_read_b128 v[20:23], v4 offset:1024
  v_mfma_f32_16x16x32_bf16 a[16:19], v[116:119], v[48:51], a[16:19]
  buffer_load_dwordx4 v2, s[12:15], s48 offen offset:1024 sc1 lds
  v_mfma_f32_16x16x32_bf16 a[20:23], v[116:119], v[52:55], a[20:23]
  ds_read_b64_tr_b16 v[84:85], v11 offset:0
  s_add_u32 s66, s66, s78
  v_mfma_f32_16x16x32_bf16 a[24:27], v[116:119], v[56:59], a[24:27]
  ds_read_b64_tr_b16 v[86:87], v11 offset:2048
  v_mfma_f32_16x16x32_bf16 a[28:31], v[116:119], v[60:63], a[28:31]
  buffer_load_dwordx4 v2, s[12:15], s48 offen offset:2048 sc1 lds
  v_mfma_f32_16x16x32_bf16 a[32:35], v[120:123], v[48:51], a[32:35]
  ds_read_b128 v[24:27], v4 offset:2048
  s_sub_u32 s66, s66, 2
  v_mfma_f32_16x16x32_bf16 a[36:39], v[120:123], v[52:55], a[36:39]
  buffer_load_dwordx4 v2, s[12:15], s48 offen offset:3072 sc1 lds
  v_mfma_f32_16x16x32_bf16 a[40:43], v[120:123], v[56:59], a[40:43]
  ds_read_b64_tr_b16 v[88:89], v12 offset:0
  ds_read_b64_tr_b16 v[90:91], v12 offset:2048
  v_mfma_f32_16x16x32_bf16 a[44:47], v[120:123], v[60:63], a[44:47]
  s_add_u32 s48, s48, 16384
  ds_read_b128 v[28:31], v4 offset:3072
  v_mfma_f32_16x16x32_bf16 a[48:51], v[124:127], v[48:51], a[48:51]
  ds_read_b64_tr_b16 v[92:93], v13 offset:0
  s_add_u32 m0, s52, 49152
  v_mfma_f32_16x16x32_bf16 a[52:55], v[124:127], v[52:55], a[52:55]
  s_add_u32 s66, s66, 768
  ds_read_b64_tr_b16 v[94:95], v13 offset:2048
  v_mfma_f32_16x16x32_bf16 a[56:59], v[124:127], v[56:59], a[56:59]
  buffer_load_dwordx4 v3, s[16:19], s49 offen lds
  v_mfma_f32_16x16x32_bf16 a[60:63], v[124:127], v[60:63], a[60:63]
  ds_read_b128 v[32:35], v4 offset:8192
  s_lshl_b32 s66, s66, 7
  v_mfma_f32_16x16x32_bf16 a[0:3], v[128:131], v[64:67], a[0:3]
  ds_read_b64_tr_b16 v[96:97], v10 offset:4096
  s_add_u32 m0, s52, 50176
  v_mfma_f32_16x16x32_bf16 a[4:7], v[128:131], v[68:71], a[4:7]
  ds_read_b64_tr_b16 v[98:99], v10 offset:6144
  ds_read_b128 v[36:39], v4 offset:9216
  v_mfma_f32_16x16x32_bf16 a[8:11], v[128:131], v[72:75], a[8:11]
  buffer_load_dwordx4 v3, s[16:19], s50 offen lds
  v_mfma_f32_16x16x32_bf16 a[12:15], v[128:131], v[76:79], a[12:15]
  ds_read_b64_tr_b16 v[100:101], v11 offset:4096
  s_add_u32 m0, s52, 57344
  v_mfma_f32_16x16x32_bf16 a[16:19], v[132:135], v[64:67], a[16:19]
  s_add_u32 s66, s66, 4096
  ds_read_b64_tr_b16 v[102:103], v11 offset:6144
  v_mfma_f32_16x16x32_bf16 a[20:23], v[132:135], v[68:71], a[20:23]
  buffer_load_dwordx4 v3, s[20:23], s49 offen lds
  v_mfma_f32_16x16x32_bf16 a[24:27], v[132:135], v[72:75], a[24:27]
  ds_read_b128 v[40:43], v4 offset:10240
  v_mov_b32 v246, 0
  v_mfma_f32_16x16x32_bf16 a[28:31], v[132:135], v[76:79], a[28:31]
  ds_read_b64_tr_b16 v[104:105], v12 offset:4096
  s_add_u32 m0, s52, 58368
  v_mfma_f32_16x16x32_bf16 a[32:35], v[136:139], v[64:67], a[32:35]
  ds_read_b64_tr_b16 v[106:107], v12 offset:6144
  ds_read_b128 v[44:47], v4 offset:11264
  v_mfma_f32_16x16x32_bf16 a[36:39], v[136:139], v[68:71], a[36:39]
  buffer_load_dwordx4 v3, s[20:23], s50 offen lds
  v_mfma_f32_16x16x32_bf16 a[40:43], v[136:139], v[72:75], a[40:43]
  ds_read_b64_tr_b16 v[108:109], v13 offset:4096
  v_lshlrev_b32 v246, 7, v246
  v_mfma_f32_16x16x32_bf16 a[44:47], v[136:139], v[76:79], a[44:47]
  ds_read_b64_tr_b16 v[110:111], v13 offset:6144
  s_add_u32 s49, s49, 131072
  v_mfma_f32_16x16x32_bf16 a[48:51], v[140:143], v[64:67], a[48:51]
  s_add_u32 s50, s50, 131072
  v_add_u32 v246, s66, v246
  v_mfma_f32_16x16x32_bf16 a[52:55], v[140:143], v[68:71], a[52:55]
  v_mfma_f32_16x16x32_bf16 a[56:59], v[140:143], v[72:75], a[56:59]
  v_mfma_f32_16x16x32_bf16 a[60:63], v[140:143], v[76:79], a[60:63]
  s_waitcnt vmcnt(24) lgkmcnt(0)
  s_barrier
  v_mfma_f32_16x16x32_bf16 a[0:3], v[80:83], v[16:19], a[0:3]
  ds_read_b128 v[48:51], v4 offset:16384
  s_add_u32 m0, s51, 0
  v_mfma_f32_16x16x32_bf16 a[4:7], v[80:83], v[20:23], a[4:7]
  ds_read_b64_tr_b16 v[112:113], v6 offset:0
  v_mfma_f32_16x16x32_bf16 a[8:11], v[80:83], v[24:27], a[8:11]
  buffer_load_dwordx4 v2, s[12:15], s48 offen offset:0 sc1 lds
  v_mfma_f32_16x16x32_bf16 a[12:15], v[80:83], v[28:31], a[12:15]
  ds_read_b64_tr_b16 v[114:115], v6 offset:2048
  ds_read_b128 v[52:55], v4 offset:17408
  v_mfma_f32_16x16x32_bf16 a[16:19], v[84:87], v[16:19], a[16:19]
  buffer_load_dwordx4 v2, s[12:15], s48 offen offset:1024 sc1 lds
  v_mfma_f32_16x16x32_bf16 a[20:23], v[84:87], v[20:23], a[20:23]
  ds_read_b64_tr_b16 v[116:117], v7 offset:0
  ds_read_b64_tr_b16 v[118:119], v7 offset:2048
  v_mfma_f32_16x16x32_bf16 a[24:27], v[84:87], v[24:27], a[24:27]
  buffer_load_dwordx4 v2, s[12:15], s48 offen offset:2048 sc1 lds
  v_mfma_f32_16x16x32_bf16 a[28:31], v[84:87], v[28:31], a[28:31]
  ds_read_b128 v[56:59], v4 offset:18432
  v_mfma_f32_16x16x32_bf16 a[32:35], v[88:91], v[16:19], a[32:35]
  buffer_load_dwordx4 v2, s[12:15], s48 offen offset:3072 sc1 lds
  v_mfma_f32_16x16x32_bf16 a[36:39], v[88:91], v[20:23], a[36:39]
  ds_read_b64_tr_b16 v[120:121], v8 offset:0
  ds_read_b64_tr_b16 v[122:123], v8 offset:2048
  v_mfma_f32_16x16x32_bf16 a[40:43], v[88:91], v[24:27], a[40:43]
  s_add_u32 s48, s48, 16384
  ds_read_b128 v[60:63], v4 offset:19456
  v_mfma_f32_16x16x32_bf16 a[44:47], v[88:91], v[28:31], a[44:47]
  ds_read_b64_tr_b16 v[124:125], v9 offset:0
  s_add_u32 m0, s52, 65536
  v_mfma_f32_16x16x32_bf16 a[48:51], v[92:95], v[16:19], a[48:51]
  ds_read_b64_tr_b16 v[126:127], v9 offset:2048
  v_mfma_f32_16x16x32_bf16 a[52:55], v[92:95], v[20:23], a[52:55]
  buffer_load_dwordx4 v3, s[16:19], s49 offen lds
  v_mfma_f32_16x16x32_bf16 a[56:59], v[92:95], v[24:27], a[56:59]
  ds_read_b128 v[64:67], v4 offset:24576
  v_mfma_f32_16x16x32_bf16 a[60:63], v[92:95], v[28:31], a[60:63]
  ds_read_b64_tr_b16 v[128:129], v6 offset:4096
  s_add_u32 m0, s52, 66560
  v_mfma_f32_16x16x32_bf16 a[0:3], v[96:99], v[32:35], a[0:3]
  ds_read_b64_tr_b16 v[130:131], v6 offset:6144
  v_mfma_f32_16x16x32_bf16 a[4:7], v[96:99], v[36:39], a[4:7]
  buffer_load_dwordx4 v3, s[16:19], s50 offen lds
  v_mfma_f32_16x16x32_bf16 a[8:11], v[96:99], v[40:43], a[8:11]
  ds_read_b128 v[68:71], v4 offset:25600
  ds_read_b64_tr_b16 v[132:133], v7 offset:4096
  v_mfma_f32_16x16x32_bf16 a[12:15], v[96:99], v[44:47], a[12:15]
  s_add_u32 m0, s52, 73728
  ds_read_b64_tr_b16 v[134:135], v7 offset:6144
  v_mfma_f32_16x16x32_bf16 a[16:19], v[100:103], v[32:35], a[16:19]
  buffer_load_dwordx4 v3, s[20:23], s49 offen lds
  v_mfma_f32_16x16x32_bf16 a[20:23], v[100:103], v[36:39], a[20:23]
  ds_read_b128 v[72:75], v4 offset:26624
  v_mfma_f32_16x16x32_bf16 a[24:27], v[100:103], v[40:43], a[24:27]
  ds_read_b64_tr_b16 v[136:137], v8 offset:4096
  s_add_u32 m0, s52, 74752
  v_mfma_f32_16x16x32_bf16 a[28:31], v[100:103], v[44:47], a[28:31]
  ds_read_b64_tr_b16 v[138:139], v8 offset:6144
  v_mfma_f32_16x16x32_bf16 a[32:35], v[104:107], v[32:35], a[32:35]
  ds_read_b128 v[76:79], v4 offset:27648
  v_mfma_f32_16x16x32_bf16 a[36:39], v[104:107], v[36:39], a[36:39]
  buffer_load_dwordx4 v3, s[20:23], s50 offen lds
  v_mfma_f32_16x16x32_bf16 a[40:43], v[104:107], v[40:43], a[40:43]
  ds_read_b64_tr_b16 v[140:141], v9 offset:4096
  ds_read_b64_tr_b16 v[142:143], v9 offset:6144
  v_mfma_f32_16x16x32_bf16 a[44:47], v[104:107], v[44:47], a[44:47]
  s_add_u32 s49, s49, 131072
  v_mfma_f32_16x16x32_bf16 a[48:51], v[108:111], v[32:35], a[48:51]
  s_add_u32 s50, s50, 131072
  v_mfma_f32_16x16x32_bf16 a[52:55], v[108:111], v[36:39], a[52:55]
  v_mfma_f32_16x16x32_bf16 a[56:59], v[108:111], v[40:43], a[56:59]
  v_mfma_f32_16x16x32_bf16 a[60:63], v[108:111], v[44:47], a[60:63]
  s_waitcnt vmcnt(24) lgkmcnt(0)
  s_barrier
  buffer_load_dwordx2 v[244:245], v246, s[72:75], 0 offen sc1
  v_mfma_f32_16x16x32_bf16 a[0:3], v[112:115], v[48:51], a[0:3]
  ds_read_b128 v[16:19], v4 offset:32768
  v_mfma_f32_16x16x32_bf16 a[4:7], v[112:115], v[52:55], a[4:7]
  ds_read_b64_tr_b16 v[80:81], v6 offset:16384
  v_mfma_f32_16x16x32_bf16 a[8:11], v[112:115], v[56:59], a[8:11]
  s_add_u32 s24, s6, 41943040
  s_addc_u32 s25, s7, 0
  s_mov_b32 s26, 8388608
  s_mov_b32 s27, 0x20000
  v_mfma_f32_16x16x32_bf16 a[12:15], v[112:115], v[60:63], a[12:15]
  ds_read_b64_tr_b16 v[82:83], v6 offset:18432
  s_lshl_b32 s56, s45, 18
  v_mfma_f32_16x16x32_bf16 a[16:19], v[116:119], v[48:51], a[16:19]
  ds_read_b128 v[20:23], v4 offset:33792
  ds_read_b64_tr_b16 v[84:85], v7 offset:16384
  v_mfma_f32_16x16x32_bf16 a[20:23], v[116:119], v[52:55], a[20:23]
  s_lshl_b32 s57, s46, 8
  ds_read_b64_tr_b16 v[86:87], v7 offset:18432
  v_mfma_f32_16x16x32_bf16 a[24:27], v[116:119], v[56:59], a[24:27]
  s_add_u32 s56, s56, s57
  v_mfma_f32_16x16x32_bf16 a[28:31], v[116:119], v[60:63], a[28:31]
  ds_read_b128 v[24:27], v4 offset:34816
  v_mfma_f32_16x16x32_bf16 a[32:35], v[120:123], v[48:51], a[32:35]
  ds_read_b64_tr_b16 v[88:89], v8 offset:16384
  v_mfma_f32_16x16x32_bf16 a[36:39], v[120:123], v[52:55], a[36:39]
  s_add_u32 s28, s8, s56
  s_addc_u32 s29, s9, 0
  s_sub_u32 s30, 262144, s57
  s_mov_b32 s31, 0x20000
  v_mfma_f32_16x16x32_bf16 a[40:43], v[120:123], v[56:59], a[40:43]
  ds_read_b64_tr_b16 v[90:91], v8 offset:18432
  ds_read_b128 v[28:31], v4 offset:35840
  v_mfma_f32_16x16x32_bf16 a[44:47], v[120:123], v[60:63], a[44:47]
  s_mov_b32 s56, 0
  ds_read_b64_tr_b16 v[92:93], v9 offset:16384
  v_mfma_f32_16x16x32_bf16 a[48:51], v[124:127], v[48:51], a[48:51]
  buffer_load_dwordx4 v[144:147], v249, s[28:31], s56 offen offset:0
  v_mfma_f32_16x16x32_bf16 a[52:55], v[124:127], v[52:55], a[52:55]
  ds_read_b64_tr_b16 v[94:95], v9 offset:18432
  v_mfma_f32_16x16x32_bf16 a[56:59], v[124:127], v[56:59], a[56:59]
  buffer_load_dwordx4 v[160:163], v249, s[28:31], s56 offen offset:64
  v_mfma_f32_16x16x32_bf16 a[60:63], v[124:127], v[60:63], a[60:63]
  ds_read_b128 v[32:35], v4 offset:40960
  ds_read_b64_tr_b16 v[96:97], v6 offset:20480
  v_mfma_f32_16x16x32_bf16 a[0:3], v[128:131], v[64:67], a[0:3]
  s_mov_b32 s56, 32768
  ds_read_b64_tr_b16 v[98:99], v6 offset:22528
  v_mfma_f32_16x16x32_bf16 a[4:7], v[128:131], v[68:71], a[4:7]
  ds_read_b128 v[36:39], v4 offset:41984
  v_mfma_f32_16x16x32_bf16 a[8:11], v[128:131], v[72:75], a[8:11]
  buffer_load_dwordx4 v[148:151], v249, s[28:31], s56 offen offset:0
  v_mfma_f32_16x16x32_bf16 a[12:15], v[128:131], v[76:79], a[12:15]
  ds_read_b64_tr_b16 v[100:101], v7 offset:20480
  ds_read_b64_tr_b16 v[102:103], v7 offset:22528
  v_mfma_f32_16x16x32_bf16 a[16:19], v[132:135], v[64:67], a[16:19]
  buffer_load_dwordx4 v[164:167], v249, s[28:31], s56 offen offset:64
  v_mfma_f32_16x16x32_bf16 a[20:23], v[132:135], v[68:71], a[20:23]
  ds_read_b128 v[40:43], v4 offset:43008
  s_mov_b32 s56, 65536
  v_mfma_f32_16x16x32_bf16 a[24:27], v[132:135], v[72:75], a[24:27]
  ds_read_b64_tr_b16 v[104:105], v8 offset:20480
  v_mfma_f32_16x16x32_bf16 a[28:31], v[132:135], v[76:79], a[28:31]
  buffer_load_dwordx4 v[152:155], v249, s[28:31], s56 offen offset:0
  v_mfma_f32_16x16x32_bf16 a[32:35], v[136:139], v[64:67], a[32:35]
  ds_read_b64_tr_b16 v[106:107], v8 offset:22528
  ds_read_b128 v[44:47], v4 offset:44032
  v_mfma_f32_16x16x32_bf16 a[36:39], v[136:139], v[68:71], a[36:39]
  buffer_load_dwordx4 v[168:171], v249, s[28:31], s56 offen offset:64
  v_mfma_f32_16x16x32_bf16 a[40:43], v[136:139], v[72:75], a[40:43]
  ds_read_b64_tr_b16 v[108:109], v9 offset:20480
  ds_read_b64_tr_b16 v[110:111], v9 offset:22528
  v_mfma_f32_16x16x32_bf16 a[44:47], v[136:139], v[76:79], a[44:47]
  s_mov_b32 s56, 98304
  v_mfma_f32_16x16x32_bf16 a[48:51], v[140:143], v[64:67], a[48:51]
  buffer_load_dwordx4 v[156:159], v249, s[28:31], s56 offen offset:0
  v_mfma_f32_16x16x32_bf16 a[52:55], v[140:143], v[68:71], a[52:55]
  v_mfma_f32_16x16x32_bf16 a[56:59], v[140:143], v[72:75], a[56:59]
  buffer_load_dwordx4 v[172:175], v249, s[28:31], s56 offen offset:64
  v_mfma_f32_16x16x32_bf16 a[60:63], v[140:143], v[76:79], a[60:63]
  s_waitcnt vmcnt(25) lgkmcnt(0)
  s_barrier
  v_mfma_f32_16x16x32_bf16 a[0:3], v[80:83], v[16:19], a[0:3]
  ds_read_b128 v[48:51], v4 offset:49152
  v_mfma_f32_16x16x32_bf16 a[4:7], v[80:83], v[20:23], a[4:7]
  ds_read_b64_tr_b16 v[112:113], v6 offset:32768
  v_mfma_f32_16x16x32_bf16 a[8:11], v[80:83], v[24:27], a[8:11]
  ds_read_b64_tr_b16 v[114:115], v6 offset:34816
  v_mfma_f32_16x16x32_bf16 a[12:15], v[80:83], v[28:31], a[12:15]
  ds_read_b128 v[52:55], v4 offset:50176
  v_mfma_f32_16x16x32_bf16 a[16:19], v[84:87], v[16:19], a[16:19]
  ds_read_b64_tr_b16 v[116:117], v7 offset:32768
  v_mfma_f32_16x16x32_bf16 a[20:23], v[84:87], v[20:23], a[20:23]
  ds_read_b64_tr_b16 v[118:119], v7 offset:34816
  v_mfma_f32_16x16x32_bf16 a[24:27], v[84:87], v[24:27], a[24:27]
  v_mfma_f32_16x16x32_bf16 a[28:31], v[84:87], v[28:31], a[28:31]
  ds_read_b128 v[56:59], v4 offset:51200
  v_mfma_f32_16x16x32_bf16 a[32:35], v[88:91], v[16:19], a[32:35]
  ds_read_b64_tr_b16 v[120:121], v8 offset:32768
  v_mfma_f32_16x16x32_bf16 a[36:39], v[88:91], v[20:23], a[36:39]
  ds_read_b64_tr_b16 v[122:123], v8 offset:34816
  v_mfma_f32_16x16x32_bf16 a[40:43], v[88:91], v[24:27], a[40:43]
  ds_read_b128 v[60:63], v4 offset:52224
  v_mfma_f32_16x16x32_bf16 a[44:47], v[88:91], v[28:31], a[44:47]
  ds_read_b64_tr_b16 v[124:125], v9 offset:32768
  v_mfma_f32_16x16x32_bf16 a[48:51], v[92:95], v[16:19], a[48:51]
  ds_read_b64_tr_b16 v[126:127], v9 offset:34816
  v_mfma_f32_16x16x32_bf16 a[52:55], v[92:95], v[20:23], a[52:55]
  v_mfma_f32_16x16x32_bf16 a[56:59], v[92:95], v[24:27], a[56:59]
  ds_read_b128 v[64:67], v4 offset:57344
  v_mfma_f32_16x16x32_bf16 a[60:63], v[92:95], v[28:31], a[60:63]
  ds_read_b64_tr_b16 v[128:129], v6 offset:36864
  v_mfma_f32_16x16x32_bf16 a[0:3], v[96:99], v[32:35], a[0:3]
  ds_read_b64_tr_b16 v[130:131], v6 offset:38912
  v_mfma_f32_16x16x32_bf16 a[4:7], v[96:99], v[36:39], a[4:7]
  ds_read_b128 v[68:71], v4 offset:58368
  v_mfma_f32_16x16x32_bf16 a[8:11], v[96:99], v[40:43], a[8:11]
  ds_read_b64_tr_b16 v[132:133], v7 offset:36864
  v_mfma_f32_16x16x32_bf16 a[12:15], v[96:99], v[44:47], a[12:15]
  ds_read_b64_tr_b16 v[134:135], v7 offset:38912
  v_mfma_f32_16x16x32_bf16 a[16:19], v[100:103], v[32:35], a[16:19]
  v_mfma_f32_16x16x32_bf16 a[20:23], v[100:103], v[36:39], a[20:23]
  ds_read_b128 v[72:75], v4 offset:59392
  v_mfma_f32_16x16x32_bf16 a[24:27], v[100:103], v[40:43], a[24:27]
  ds_read_b64_tr_b16 v[136:137], v8 offset:36864
  v_mfma_f32_16x16x32_bf16 a[28:31], v[100:103], v[44:47], a[28:31]
  ds_read_b64_tr_b16 v[138:139], v8 offset:38912
  v_mfma_f32_16x16x32_bf16 a[32:35], v[104:107], v[32:35], a[32:35]
  ds_read_b128 v[76:79], v4 offset:60416
  v_mfma_f32_16x16x32_bf16 a[36:39], v[104:107], v[36:39], a[36:39]
  ds_read_b64_tr_b16 v[140:141], v9 offset:36864
  v_mfma_f32_16x16x32_bf16 a[40:43], v[104:107], v[40:43], a[40:43]
  ds_read_b64_tr_b16 v[142:143], v9 offset:38912
  v_mfma_f32_16x16x32_bf16 a[44:47], v[104:107], v[44:47], a[44:47]
  v_mfma_f32_16x16x32_bf16 a[48:51], v[108:111], v[32:35], a[48:51]
  v_mfma_f32_16x16x32_bf16 a[52:55], v[108:111], v[36:39], a[52:55]
  v_mfma_f32_16x16x32_bf16 a[56:59], v[108:111], v[40:43], a[56:59]
  v_mfma_f32_16x16x32_bf16 a[60:63], v[108:111], v[44:47], a[60:63]
  s_waitcnt vmcnt(17) lgkmcnt(0)
  s_barrier
  v_mfma_f32_16x16x32_bf16 a[0:3], v[112:115], v[48:51], a[0:3]
  ds_read_b128 v[16:19], v5 offset:0
  v_mfma_f32_16x16x32_bf16 a[4:7], v[112:115], v[52:55], a[4:7]
  ds_read_b64_tr_b16 v[80:81], v6 offset:49152
  v_mfma_f32_16x16x32_bf16 a[8:11], v[112:115], v[56:59], a[8:11]
  ds_read_b64_tr_b16 v[82:83], v6 offset:51200
  v_mfma_f32_16x16x32_bf16 a[12:15], v[112:115], v[60:63], a[12:15]
  ds_read_b128 v[20:23], v5 offset:1024
  v_mfma_f32_16x16x32_bf16 a[16:19], v[116:119], v[48:51], a[16:19]
  ds_read_b64_tr_b16 v[84:85], v7 offset:49152
  v_mfma_f32_16x16x32_bf16 a[20:23], v[116:119], v[52:55], a[20:23]
  ds_read_b64_tr_b16 v[86:87], v7 offset:51200
  v_mfma_f32_16x16x32_bf16 a[24:27], v[116:119], v[56:59], a[24:27]
  v_mfma_f32_16x16x32_bf16 a[28:31], v[116:119], v[60:63], a[28:31]
  ds_read_b128 v[24:27], v5 offset:2048
  v_mfma_f32_16x16x32_bf16 a[32:35], v[120:123], v[48:51], a[32:35]
  ds_read_b64_tr_b16 v[88:89], v8 offset:49152
  v_mfma_f32_16x16x32_bf16 a[36:39], v[120:123], v[52:55], a[36:39]
  ds_read_b64_tr_b16 v[90:91], v8 offset:51200
  v_mfma_f32_16x16x32_bf16 a[40:43], v[120:123], v[56:59], a[40:43]
  ds_read_b128 v[28:31], v5 offset:3072
  v_mfma_f32_16x16x32_bf16 a[44:47], v[120:123], v[60:63], a[44:47]
  ds_read_b64_tr_b16 v[92:93], v9 offset:49152
  v_mfma_f32_16x16x32_bf16 a[48:51], v[124:127], v[48:51], a[48:51]
  ds_read_b64_tr_b16 v[94:95], v9 offset:51200
  v_mfma_f32_16x16x32_bf16 a[52:55], v[124:127], v[52:55], a[52:55]
  v_mfma_f32_16x16x32_bf16 a[56:59], v[124:127], v[56:59], a[56:59]
  ds_read_b128 v[32:35], v5 offset:8192
  v_mfma_f32_16x16x32_bf16 a[60:63], v[124:127], v[60:63], a[60:63]
  ds_read_b64_tr_b16 v[96:97], v6 offset:53248
  v_mfma_f32_16x16x32_bf16 a[0:3], v[128:131], v[64:67], a[0:3]
  ds_read_b64_tr_b16 v[98:99], v6 offset:55296
  v_mfma_f32_16x16x32_bf16 a[4:7], v[128:131], v[68:71], a[4:7]
  ds_read_b128 v[36:39], v5 offset:9216
  v_mfma_f32_16x16x32_bf16 a[8:11], v[128:131], v[72:75], a[8:11]
  ds_read_b64_tr_b16 v[100:101], v7 offset:53248
  v_mfma_f32_16x16x32_bf16 a[12:15], v[128:131], v[76:79], a[12:15]
  ds_read_b64_tr_b16 v[102:103], v7 offset:55296
  v_mfma_f32_16x16x32_bf16 a[16:19], v[132:135], v[64:67], a[16:19]
  v_mfma_f32_16x16x32_bf16 a[20:23], v[132:135], v[68:71], a[20:23]
  ds_read_b128 v[40:43], v5 offset:10240
  v_mfma_f32_16x16x32_bf16 a[24:27], v[132:135], v[72:75], a[24:27]
  ds_read_b64_tr_b16 v[104:105], v8 offset:53248
  v_mfma_f32_16x16x32_bf16 a[28:31], v[132:135], v[76:79], a[28:31]
  ds_read_b64_tr_b16 v[106:107], v8 offset:55296
  v_mfma_f32_16x16x32_bf16 a[32:35], v[136:139], v[64:67], a[32:35]
  ds_read_b128 v[44:47], v5 offset:11264
  v_mfma_f32_16x16x32_bf16 a[36:39], v[136:139], v[68:71], a[36:39]
  ds_read_b64_tr_b16 v[108:109], v9 offset:53248
  v_mfma_f32_16x16x32_bf16 a[40:43], v[136:139], v[72:75], a[40:43]
  ds_read_b64_tr_b16 v[110:111], v9 offset:55296
  v_mfma_f32_16x16x32_bf16 a[44:47], v[136:139], v[76:79], a[44:47]
  v_mfma_f32_16x16x32_bf16 a[48:51], v[140:143], v[64:67], a[48:51]
  v_mfma_f32_16x16x32_bf16 a[52:55], v[140:143], v[68:71], a[52:55]
  v_mfma_f32_16x16x32_bf16 a[56:59], v[140:143], v[72:75], a[56:59]
  v_mfma_f32_16x16x32_bf16 a[60:63], v[140:143], v[76:79], a[60:63]
  s_waitcnt vmcnt(8) lgkmcnt(0)
  s_barrier
  s_mov_b32 s67, 0
chk_23:
  v_cmp_eq_u32 vcc, s76, v244
  v_cmp_eq_u32 s[68:69], s77, v245
  s_nop 1
  s_and_b64 vcc, vcc, s[68:69]
  s_cmp_eq_u64 vcc, exec
  s_cbranch_scc1 chk_23_ok
  s_add_u32 s67, s67, 1
  s_cmp_ge_u32 s67, 0x40000
  s_cbranch_scc1 chk_23_ok
  s_sleep 1
  buffer_load_dwordx2 v[244:245], v246, s[72:75], 0 offen sc1
  s_waitcnt vmcnt(0)
  s_branch chk_23
chk_23_ok:
  v_mfma_f32_16x16x32_bf16 a[0:3], v[80:83], v[16:19], a[0:3]
  ds_read_b128 v[48:51], v4 offset:0
  v_mfma_f32_16x16x32_bf16 a[4:7], v[80:83], v[20:23], a[4:7]
  ds_read_b64_tr_b16 v[112:113], v10 offset:0
  s_lshl_b32 s56, s47, 2
  v_mfma_f32_16x16x32_bf16 a[8:11], v[80:83], v[24:27], a[8:11]
  ds_read_b64_tr_b16 v[114:115], v10 offset:2048
  v_mfma_f32_16x16x32_bf16 a[12:15], v[80:83], v[28:31], a[12:15]
  ds_read_b128 v[52:55], v4 offset:1024
  s_add_u32 s56, s56, s40
  v_mfma_f32_16x16x32_bf16 a[16:19], v[84:87], v[16:19], a[16:19]
  ds_read_b64_tr_b16 v[116:117], v11 offset:0
  v_mfma_f32_16x16x32_bf16 a[20:23], v[84:87], v[20:23], a[20:23]
  ds_read_b64_tr_b16 v[118:119], v11 offset:2048
  v_mfma_f32_16x16x32_bf16 a[24:27], v[84:87], v[24:27], a[24:27]
  s_lshl_b32 s56, s56, 13
  v_mfma_f32_16x16x32_bf16 a[28:31], v[84:87], v[28:31], a[28:31]
  ds_read_b128 v[56:59], v4 offset:2048
  v_mfma_f32_16x16x32_bf16 a[32:35], v[88:91], v[16:19], a[32:35]
  ds_read_b64_tr_b16 v[120:121], v12 offset:0
  s_add_u32 s57, s56, 4096
  v_mfma_f32_16x16x32_bf16 a[36:39], v[88:91], v[20:23], a[36:39]
  ds_read_b64_tr_b16 v[122:123], v12 offset:2048
  v_mfma_f32_16x16x32_bf16 a[40:43], v[88:91], v[24:27], a[40:43]
  ds_read_b128 v[60:63], v4 offset:3072
  v_mfma_f32_16x16x32_bf16 a[44:47], v[88:91], v[28:31], a[44:47]
  ds_read_b64_tr_b16 v[124:125], v13 offset:0
  v_mfma_f32_16x16x32_bf16 a[48:51], v[92:95], v[16:19], a[48:51]
  buffer_load_dwordx4 v[176:179], v1, s[24:27], s56 offen offset:0 sc1
  v_mfma_f32_16x16x32_bf16 a[52:55], v[92:95], v[20:23], a[52:55]
  ds_read_b64_tr_b16 v[126:127], v13 offset:2048
  v_mfma_f32_16x16x32_bf16 a[56:59], v[92:95], v[24:27], a[56:59]
  buffer_load_dwordx4 v[180:183], v1, s[24:27], s56 offen offset:1024 sc1
  v_mfma_f32_16x16x32_bf16 a[60:63], v[92:95], v[28:31], a[60:63]
  ds_read_b128 v[64:67], v4 offset:8192
  ds_read_b64_tr_b16 v[128:129], v10 offset:4096
  v_mfma_f32_16x16x32_bf16 a[0:3], v[96:99], v[32:35], a[0:3]
  ds_read_b64_tr_b16 v[130:131], v10 offset:6144
  v_mfma_f32_16x16x32_bf16 a[4:7], v[96:99], v[36:39], a[4:7]
  buffer_load_dwordx4 v[184:187], v1, s[24:27], s56 offen offset:2048 sc1
  v_mfma_f32_16x16x32_bf16 a[8:11], v[96:99], v[40:43], a[8:11]
  ds_read_b128 v[68:71], v4 offset:9216
  ds_read_b64_tr_b16 v[132:133], v11 offset:4096
  v_mfma_f32_16x16x32_bf16 a[12:15], v[96:99], v[44:47], a[12:15]
  ds_read_b64_tr_b16 v[134:135], v11 offset:6144
  v_mfma_f32_16x16x32_bf16 a[16:19], v[100:103], v[32:35], a[16:19]
  buffer_load_dwordx4 v[188:191], v1, s[24:27], s56 offen offset:3072 sc1
  v_mfma_f32_16x16x32_bf16 a[20:23], v[100:103], v[36:39], a[20:23]
  ds_read_b128 v[72:75], v4 offset:10240
  v_mfma_f32_16x16x32_bf16 a[24:27], v[100:103], v[40:43], a[24:27]
  buffer_load_dwordx4 v[192:195], v1, s[24:27], s57 offen offset:0 sc1
  v_mfma_f32_16x16x32_bf16 a[28:31], v[100:103], v[44:47], a[28:31]
  ds_read_b64_tr_b16 v[136:137], v12 offset:4096
  ds_read_b64_tr_b16 v[138:139], v12 offset:6144
  v_mfma_f32_16x16x32_bf16 a[32:35], v[104:107], v[32:35], a[32:35]
  ds_read_b128 v[76:79], v4 offset:11264
  v_mfma_f32_16x16x32_bf16 a[36:39], v[104:107], v[36:39], a[36:39]
  buffer_load_dwordx4 v[196:199], v1, s[24:27], s57 offen offset:1024 sc1
  v_mfma_f32_16x16x32_bf16 a[40:43], v[104:107], v[40:43], a[40:43]
  ds_read_b64_tr_b16 v[140:141], v13 offset:4096
  ds_read_b64_tr_b16 v[142:143], v13 offset:6144
  v_mfma_f32_16x16x32_bf16 a[44:47], v[104:107], v[44:47], a[44:47]
  buffer_load_dwordx4 v[200:203], v1, s[24:27], s57 offen offset:2048 sc1
  v_mfma_f32_16x16x32_bf16 a[48:51], v[108:111], v[32:35], a[48:51]
  v_mfma_f32_16x16x32_bf16 a[52:55], v[108:111], v[36:39], a[52:55]
  buffer_load_dwordx4 v[204:207], v1, s[24:27], s57 offen offset:3072 sc1
  v_mfma_f32_16x16x32_bf16 a[56:59], v[108:111], v[40:43], a[56:59]
  v_mfma_f32_16x16x32_bf16 a[60:63], v[108:111], v[44:47], a[60:63]
  s_waitcnt lgkmcnt(0)
  s_barrier
  v_mfma_f32_16x16x32_bf16 a[0:3], v[112:115], v[48:51], a[0:3]
  v_mfma_f32_16x16x32_bf16 a[4:7], v[112:115], v[52:55], a[4:7]
  v_mfma_f32_16x16x32_bf16 a[8:11], v[112:115], v[56:59], a[8:11]
  v_mfma_f32_16x16x32_bf16 a[12:15], v[112:115], v[60:63], a[12:15]
  v_mfma_f32_16x16x32_bf16 a[16:19], v[116:119], v[48:51], a[16:19]
  v_mfma_f32_16x16x32_bf16 a[20:23], v[116:119], v[52:55], a[20:23]
  v_mfma_f32_16x16x32_bf16 a[24:27], v[116:119], v[56:59], a[24:27]
  v_mfma_f32_16x16x32_bf16 a[28:31], v[116:119], v[60:63], a[28:31]
  v_mfma_f32_16x16x32_bf16 a[32:35], v[120:123], v[48:51], a[32:35]
  v_mfma_f32_16x16x32_bf16 a[36:39], v[120:123], v[52:55], a[36:39]
  v_mfma_f32_16x16x32_bf16 a[40:43], v[120:123], v[56:59], a[40:43]
  v_mfma_f32_16x16x32_bf16 a[44:47], v[120:123], v[60:63], a[44:47]
  v_mfma_f32_16x16x32_bf16 a[48:51], v[124:127], v[48:51], a[48:51]
  v_mfma_f32_16x16x32_bf16 a[52:55], v[124:127], v[52:55], a[52:55]
  v_mfma_f32_16x16x32_bf16 a[56:59], v[124:127], v[56:59], a[56:59]
  v_mfma_f32_16x16x32_bf16 a[60:63], v[124:127], v[60:63], a[60:63]
  v_mfma_f32_16x16x32_bf16 a[0:3], v[128:131], v[64:67], a[0:3]
  v_mfma_f32_16x16x32_bf16 a[4:7], v[128:131], v[68:71], a[4:7]
  v_mfma_f32_16x16x32_bf16 a[8:11], v[128:131], v[72:75], a[8:11]
  v_mfma_f32_16x16x32_bf16 a[12:15], v[128:131], v[76:79], a[12:15]
  v_mfma_f32_16x16x32_bf16 a[16:19], v[132:135], v[64:67], a[16:19]
  v_mfma_f32_16x16x32_bf16 a[20:23], v[132:135], v[68:71], a[20:23]
  v_mfma_f32_16x16x32_bf16 a[24:27], v[132:135], v[72:75], a[24:27]
  v_mfma_f32_16x16x32_bf16 a[28:31], v[132:135], v[76:79], a[28:31]
  v_mfma_f32_16x16x32_bf16 a[32:35], v[136:139], v[64:67], a[32:35]
  v_mfma_f32_16x16x32_bf16 a[36:39], v[136:139], v[68:71], a[36:39]
  v_mfma_f32_16x16x32_bf16 a[40:43], v[136:139], v[72:75], a[40:43]
  v_mfma_f32_16x16x32_bf16 a[44:47], v[136:139], v[76:79], a[44:47]
  v_mfma_f32_16x16x32_bf16 a[48:51], v[140:143], v[64:67], a[48:51]
  v_mfma_f32_16x16x32_bf16 a[52:55], v[140:143], v[68:71], a[52:55]
  v_mfma_f32_16x16x32_bf16 a[56:59], v[140:143], v[72:75], a[56:59]
  v_mfma_f32_16x16x32_bf16 a[60:63], v[140:143], v[76:79], a[60:63]
  s_nop 7
  s_mov_b32 s58, 0xbfb8aa3b
  s_mov_b32 s59, 0xbfb8aa3b
  s_mov_b32 s60, 1.0
  s_mov_b32 s61, 1.0
  v_accvgpr_read_b32 v80, a0
  v_accvgpr_read_b32 v81, a1
  v_accvgpr_read_b32 v82, a2
  v_accvgpr_read_b32 v83, a3
  v_accvgpr_read_b32 v84, a16
  v_accvgpr_read_b32 v85, a17
  v_accvgpr_read_b32 v86, a18
  v_accvgpr_read_b32 v87, a19
  v_pk_mul_f32 v[16:17], v[80:81], s[58:59]
  v_pk_mul_f32 v[18:19], v[82:83], s[58:59]
  v_pk_mul_f32 v[20:21], v[84:85], s[58:59]
  v_pk_mul_f32 v[22:23], v[86:87], s[58:59]
  v_exp_f32 v16, v16
  v_exp_f32 v17, v17
  v_exp_f32 v18, v18
  v_exp_f32 v19, v19
  v_exp_f32 v20, v20
  v_exp_f32 v21, v21
  v_exp_f32 v22, v22
  v_exp_f32 v23, v23
  s_nop 0
  v_pk_add_f32 v[16:17], v[16:17], s[60:61]
  v_pk_add_f32 v[18:19], v[18:19], s[60:61]
  v_pk_add_f32 v[20:21], v[20:21], s[60:61]
  v_pk_add_f32 v[22:23], v[22:23], s[60:61]
  v_rcp_f32 v16, v16
  v_rcp_f32 v17, v17
  v_rcp_f32 v18, v18
  v_rcp_f32 v19, v19
  v_rcp_f32 v20, v20
  v_rcp_f32 v21, v21
  v_rcp_f32 v22, v22
  v_rcp_f32 v23, v23
  s_nop 0
  v_pk_mul_f32 v[16:17], v[16:17], v[80:81]
  v_pk_mul_f32 v[18:19], v[18:19], v[82:83]
  v_pk_mul_f32 v[20:21], v[20:21], v[84:85]
  v_pk_mul_f32 v[22:23], v[22:23], v[86:87]
  v_accvgpr_read_b32 v88, a4
  v_accvgpr_read_b32 v89, a5
  v_accvgpr_read_b32 v90, a6
  v_accvgpr_read_b32 v91, a7
  v_accvgpr_read_b32 v92, a20
  v_accvgpr_read_b32 v93, a21
  v_accvgpr_read_b32 v94, a22
  v_accvgpr_read_b32 v95, a23
  v_pk_mul_f32 v[24:25], v[88:89], s[58:59]
  v_pk_mul_f32 v[26:27], v[90:91], s[58:59]
  v_pk_mul_f32 v[28:29], v[92:93], s[58:59]
  v_pk_mul_f32 v[30:31], v[94:95], s[58:59]
  v_exp_f32 v24, v24
  v_exp_f32 v25, v25
  v_exp_f32 v26, v26
  v_exp_f32 v27, v27
  v_exp_f32 v28, v28
  v_exp_f32 v29, v29
  v_exp_f32 v30, v30
  v_exp_f32 v31, v31
  s_nop 0
  v_pk_add_f32 v[24:25], v[24:25], s[60:61]
  v_pk_add_f32 v[26:27], v[26:27], s[60:61]
  v_pk_add_f32 v[28:29], v[28:29], s[60:61]
  v_pk_add_f32 v[30:31], v[30:31], s[60:61]
  v_rcp_f32 v24, v24
  v_rcp_f32 v25, v25
  v_rcp_f32 v26, v26
  v_rcp_f32 v27, v27
  v_rcp_f32 v28, v28
  v_rcp_f32 v29, v29
  v_rcp_f32 v30, v30
  v_rcp_f32 v31, v31
  s_nop 0
  v_pk_mul_f32 v[24:25], v[24:25], v[88:89]
  v_pk_mul_f32 v[26:27], v[26:27], v[90:91]
  v_pk_mul_f32 v[28:29], v[28:29], v[92:93]
  v_pk_mul_f32 v[30:31], v[30:31], v[94:95]
  v_accvgpr_read_b32 v80, a8
  v_accvgpr_read_b32 v81, a9
  v_accvgpr_read_b32 v82, a10
  v_accvgpr_read_b32 v83, a11
  v_accvgpr_read_b32 v84, a24
  v_accvgpr_read_b32 v85, a25
  v_accvgpr_read_b32 v86, a26
  v_accvgpr_read_b32 v87, a27
  v_pk_mul_f32 v[32:33], v[80:81], s[58:59]
  v_pk_mul_f32 v[34:35], v[82:83], s[58:59]
  v_pk_mul_f32 v[36:37], v[84:85], s[58:59]
  v_pk_mul_f32 v[38:39], v[86:87], s[58:59]
  v_exp_f32 v32, v32
  v_exp_f32 v33, v33
  v_exp_f32 v34, v34
  v_exp_f32 v35, v35
  v_exp_f32 v36, v36
  v_exp_f32 v37, v37
  v_exp_f32 v38, v38
  v_exp_f32 v39, v39
  s_nop 0
  v_pk_add_f32 v[32:33], v[32:33], s[60:61]
  v_pk_add_f32 v[34:35], v[34:35], s[60:61]
  v_pk_add_f32 v[36:37], v[36:37], s[60:61]
  v_pk_add_f32 v[38:39], v[38:39], s[60:61]
  v_rcp_f32 v32, v32
  v_rcp_f32 v33, v33
  v_rcp_f32 v34, v34
  v_rcp_f32 v35, v35
  v_rcp_f32 v36, v36
  v_rcp_f32 v37, v37
  v_rcp_f32 v38, v38
  v_rcp_f32 v39, v39
  s_nop 0
  v_pk_mul_f32 v[32:33], v[32:33], v[80:81]
  v_pk_mul_f32 v[34:35], v[34:35], v[82:83]
  v_pk_mul_f32 v[36:37], v[36:37], v[84:85]
  v_pk_mul_f32 v[38:39], v[38:39], v[86:87]
  v_accvgpr_read_b32 v88, a12
  v_accvgpr_read_b32 v89, a13
  v_accvgpr_read_b32 v90, a14
  v_accvgpr_read_b32 v91, a15
  v_accvgpr_read_b32 v92, a28
  v_accvgpr_read_b32 v93, a29
  v_accvgpr_read_b32 v94, a30
  v_accvgpr_read_b32 v95, a31
  v_pk_mul_f32 v[40:41], v[88:89], s[58:59]
  v_pk_mul_f32 v[42:43], v[90:91], s[58:59]
  v_pk_mul_f32 v[44:45], v[92:93], s[58:59]
  v_pk_mul_f32 v[46:47], v[94:95], s[58:59]
  v_exp_f32 v40, v40
  v_exp_f32 v41, v41
  v_exp_f32 v42, v42
  v_exp_f32 v43, v43
  v_exp_f32 v44, v44
  v_exp_f32 v45, v45
  v_exp_f32 v46, v46
  v_exp_f32 v47, v47
  s_nop 0
  v_pk_add_f32 v[40:41], v[40:41], s[60:61]
  v_pk_add_f32 v[42:43], v[42:43], s[60:61]
  v_pk_add_f32 v[44:45], v[44:45], s[60:61]
  v_pk_add_f32 v[46:47], v[46:47], s[60:61]
  v_rcp_f32 v40, v40
  v_rcp_f32 v41, v41
  v_rcp_f32 v42, v42
  v_rcp_f32 v43, v43
  v_rcp_f32 v44, v44
  v_rcp_f32 v45, v45
  v_rcp_f32 v46, v46
  v_rcp_f32 v47, v47
  s_nop 0
  v_pk_mul_f32 v[40:41], v[40:41], v[88:89]
  v_pk_mul_f32 v[42:43], v[42:43], v[90:91]
  v_pk_mul_f32 v[44:45], v[44:45], v[92:93]
  v_pk_mul_f32 v[46:47], v[46:47], v[94:95]
  v_accvgpr_read_b32 v80, a32
  v_accvgpr_read_b32 v81, a33
  v_accvgpr_read_b32 v82, a34
  v_accvgpr_read_b32 v83, a35
  v_accvgpr_read_b32 v84, a48
  v_accvgpr_read_b32 v85, a49
  v_accvgpr_read_b32 v86, a50
  v_accvgpr_read_b32 v87, a51
  v_pk_mul_f32 v[48:49], v[80:81], s[58:59]
  v_pk_mul_f32 v[50:51], v[82:83], s[58:59]
  v_pk_mul_f32 v[52:53], v[84:85], s[58:59]
  v_pk_mul_f32 v[54:55], v[86:87], s[58:59]
  v_exp_f32 v48, v48
  v_exp_f32 v49, v49
  v_exp_f32 v50, v50
  v_exp_f32 v51, v51
  v_exp_f32 v52, v52
  v_exp_f32 v53, v53
  v_exp_f32 v54, v54
  v_exp_f32 v55, v55
  s_nop 0
  v_pk_add_f32 v[48:49], v[48:49], s[60:61]
  v_pk_add_f32 v[50:51], v[50:51], s[60:61]
  v_pk_add_f32 v[52:53], v[52:53], s[60:61]
  v_pk_add_f32 v[54:55], v[54:55], s[60:61]
  v_rcp_f32 v48, v48
  v_rcp_f32 v49, v49
  v_rcp_f32 v50, v50
  v_rcp_f32 v51, v51
  v_rcp_f32 v52, v52
  v_rcp_f32 v53, v53
  v_rcp_f32 v54, v54
  v_rcp_f32 v55, v55
  s_nop 0
  v_pk_mul_f32 v[48:49], v[48:49], v[80:81]
  v_pk_mul_f32 v[50:51], v[50:51], v[82:83]
  v_pk_mul_f32 v[52:53], v[52:53], v[84:85]
  v_pk_mul_f32 v[54:55], v[54:55], v[86:87]
  v_accvgpr_read_b32 v88, a36
  v_accvgpr_read_b32 v89, a37
  v_accvgpr_read_b32 v90, a38
  v_accvgpr_read_b32 v91, a39
  v_accvgpr_read_b32 v92, a52
  v_accvgpr_read_b32 v93, a53
  v_accvgpr_read_b32 v94, a54
  v_accvgpr_read_b32 v95, a55
  v_pk_mul_f32 v[56:57], v[88:89], s[58:59]
  v_pk_mul_f32 v[58:59], v[90:91], s[58:59]
  v_pk_mul_f32 v[60:61], v[92:93], s[58:59]
  v_pk_mul_f32 v[62:63], v[94:95], s[58:59]
  v_exp_f32 v56, v56
  v_exp_f32 v57, v57
  v_exp_f32 v58, v58
  v_exp_f32 v59, v59
  v_exp_f32 v60, v60
  v_exp_f32 v61, v61
  v_exp_f32 v62, v62
  v_exp_f32 v63, v63
  s_nop 0
  v_pk_add_f32 v[56:57], v[56:57], s[60:61]
  v_pk_add_f32 v[58:59], v[58:59], s[60:61]
  v_pk_add_f32 v[60:61], v[60:61], s[60:61]
  v_pk_add_f32 v[62:63], v[62:63], s[60:61]
  v_rcp_f32 v56, v56
  v_rcp_f32 v57, v57
  v_rcp_f32 v58, v58
  v_rcp_f32 v59, v59
  v_rcp_f32 v60, v60
  v_rcp_f32 v61, v61
  v_rcp_f32 v62, v62
  v_rcp_f32 v63, v63
  s_nop 0
  v_pk_mul_f32 v[56:57], v[56:57], v[88:89]
  v_pk_mul_f32 v[58:59], v[58:59], v[90:91]
  v_pk_mul_f32 v[60:61], v[60:61], v[92:93]
  v_pk_mul_f32 v[62:63], v[62:63], v[94:95]
  v_accvgpr_read_b32 v80, a40
  v_accvgpr_read_b32 v81, a41
  v_accvgpr_read_b32 v82, a42
  v_accvgpr_read_b32 v83, a43
  v_accvgpr_read_b32 v84, a56
  v_accvgpr_read_b32 v85, a57
  v_accvgpr_read_b32 v86, a58
  v_accvgpr_read_b32 v87, a59
  v_pk_mul_f32 v[64:65], v[80:81], s[58:59]
  v_pk_mul_f32 v[66:67], v[82:83], s[58:59]
  v_pk_mul_f32 v[68:69], v[84:85], s[58:59]
  v_pk_mul_f32 v[70:71], v[86:87], s[58:59]
  v_exp_f32 v64, v64
  v_exp_f32 v65, v65
  v_exp_f32 v66, v66
  v_exp_f32 v67, v67
  v_exp_f32 v68, v68
  v_exp_f32 v69, v69
  v_exp_f32 v70, v70
  v_exp_f32 v71, v71
  s_nop 0
  v_pk_add_f32 v[64:65], v[64:65], s[60:61]
  v_pk_add_f32 v[66:67], v[66:67], s[60:61]
  v_pk_add_f32 v[68:69], v[68:69], s[60:61]
  v_pk_add_f32 v[70:71], v[70:71], s[60:61]
  v_rcp_f32 v64, v64
  v_rcp_f32 v65, v65
  v_rcp_f32 v66, v66
  v_rcp_f32 v67, v67
  v_rcp_f32 v68, v68
  v_rcp_f32 v69, v69
  v_rcp_f32 v70, v70
  v_rcp_f32 v71, v71
  s_nop 0
  v_pk_mul_f32 v[64:65], v[64:65], v[80:81]
  v_pk_mul_f32 v[66:67], v[66:67], v[82:83]
  v_pk_mul_f32 v[68:69], v[68:69], v[84:85]
  v_pk_mul_f32 v[70:71], v[70:71], v[86:87]
  v_accvgpr_read_b32 v88, a44
  v_accvgpr_read_b32 v89, a45
  v_accvgpr_read_b32 v90, a46
  v_accvgpr_read_b32 v91, a47
  v_accvgpr_read_b32 v92, a60
  v_accvgpr_read_b32 v93, a61
  v_accvgpr_read_b32 v94, a62
  v_accvgpr_read_b32 v95, a63
  v_pk_mul_f32 v[72:73], v[88:89], s[58:59]
  v_pk_mul_f32 v[74:75], v[90:91], s[58:59]
  v_pk_mul_f32 v[76:77], v[92:93], s[58:59]
  v_pk_mul_f32 v[78:79], v[94:95], s[58:59]
  v_exp_f32 v72, v72
  v_exp_f32 v73, v73
  v_exp_f32 v74, v74
  v_exp_f32 v75, v75
  v_exp_f32 v76, v76
  v_exp_f32 v77, v77
  v_exp_f32 v78, v78
  v_exp_f32 v79, v79
  s_nop 0
  v_pk_add_f32 v[72:73], v[72:73], s[60:61]
  v_pk_add_f32 v[74:75], v[74:75], s[60:61]
  v_pk_add_f32 v[76:77], v[76:77], s[60:61]
  v_pk_add_f32 v[78:79], v[78:79], s[60:61]
  v_rcp_f32 v72, v72
  v_rcp_f32 v73, v73
  v_rcp_f32 v74, v74
  v_rcp_f32 v75, v75
  v_rcp_f32 v76, v76
  v_rcp_f32 v77, v77
  v_rcp_f32 v78, v78
  v_rcp_f32 v79, v79
  s_nop 0
  v_pk_mul_f32 v[72:73], v[72:73], v[88:89]
  v_pk_mul_f32 v[74:75], v[74:75], v[90:91]
  v_pk_mul_f32 v[76:77], v[76:77], v[92:93]
  v_pk_mul_f32 v[78:79], v[78:79], v[94:95]
  s_waitcnt vmcnt(0)
  v_permlane16_swap_b32 v144, v146
  v_permlane16_swap_b32 v145, v147
  v_permlane16_swap_b32 v148, v150
  v_permlane16_swap_b32 v149, v151
  v_permlane16_swap_b32 v152, v154
  v_permlane16_swap_b32 v153, v155
  v_permlane16_swap_b32 v156, v158
  v_permlane16_swap_b32 v157, v159
  v_permlane16_swap_b32 v160, v162
  v_permlane16_swap_b32 v161, v163
  v_permlane16_swap_b32 v164, v166
  v_permlane16_swap_b32 v165, v167
  v_permlane16_swap_b32 v168, v170
  v_permlane16_swap_b32 v169, v171
  v_permlane16_swap_b32 v172, v174
  v_permlane16_swap_b32 v173, v175
  v_lshlrev_b32 v96, 16, v176
  v_and_b32 v97, 0xffff0000, v176
  v_lshlrev_b32 v98, 16, v177
  v_and_b32 v99, 0xffff0000, v177
  v_lshlrev_b32 v100, 16, v178
  v_and_b32 v101, 0xffff0000, v178
  v_lshlrev_b32 v102, 16, v179
  v_and_b32 v103, 0xffff0000, v179
  v_lshlrev_b32 v104, 16, v144
  v_and_b32 v105, 0xffff0000, v144
  v_lshlrev_b32 v106, 16, v145
  v_and_b32 v107, 0xffff0000, v145
  v_lshlrev_b32 v108, 16, v146
  v_and_b32 v109, 0xffff0000, v146
  v_lshlrev_b32 v110, 16, v147
  v_and_b32 v111, 0xffff0000, v147
  v_pk_fma_f32 v[96:97], v[96:97], v[16:17], v[104:105]
  v_pk_fma_f32 v[98:99], v[98:99], v[18:19], v[106:107]
  v_pk_fma_f32 v[100:101], v[100:101], v[20:21], v[108:109]
  v_pk_fma_f32 v[102:103], v[102:103], v[22:23], v[110:111]
  v_cvt_pk_bf16_f32 v112, v96, v97
  v_cvt_pk_bf16_f32 v113, v98, v99
  v_cvt_pk_bf16_f32 v114, v100, v101
  v_cvt_pk_bf16_f32 v115, v102, v103
  s_nop 1
  v_permlane16_swap_b32 v112, v114
  v_permlane16_swap_b32 v113, v115
  s_mov_b32 s59, 0
  buffer_store_dwordx4 v[112:115], v249, s[32:35], s59 offen offset:0 sc1
  v_lshlrev_b32 v116, 16, v180
  v_and_b32 v117, 0xffff0000, v180
  v_lshlrev_b32 v118, 16, v181
  v_and_b32 v119, 0xffff0000, v181
  v_lshlrev_b32 v120, 16, v182
  v_and_b32 v121, 0xffff0000, v182
  v_lshlrev_b32 v122, 16, v183
  v_and_b32 v123, 0xffff0000, v183
  v_lshlrev_b32 v124, 16, v148
  v_and_b32 v125, 0xffff0000, v148
  v_lshlrev_b32 v126, 16, v149
  v_and_b32 v127, 0xffff0000, v149
  v_lshlrev_b32 v128, 16, v150
  v_and_b32 v129, 0xffff0000, v150
  v_lshlrev_b32 v130, 16, v151
  v_and_b32 v131, 0xffff0000, v151
  v_pk_fma_f32 v[116:117], v[116:117], v[24:25], v[124:125]
  v_pk_fma_f32 v[118:119], v[118:119], v[26:27], v[126:127]
  v_pk_fma_f32 v[120:121], v[120:121], v[28:29], v[128:129]
  v_pk_fma_f32 v[122:123], v[122:123], v[30:31], v[130:131]
  v_cvt_pk_bf16_f32 v132, v116, v117
  v_cvt_pk_bf16_f32 v133, v118, v119
  v_cvt_pk_bf16_f32 v134, v120, v121
  v_cvt_pk_bf16_f32 v135, v122, v123
  s_nop 1
  v_permlane16_swap_b32 v132, v134
  v_permlane16_swap_b32 v133, v135
  s_mov_b32 s59, 32768
  buffer_store_dwordx4 v[132:135], v249, s[32:35], s59 offen offset:0 sc1
  v_lshlrev_b32 v96, 16, v184
  v_and_b32 v97, 0xffff0000, v184
  v_lshlrev_b32 v98, 16, v185
  v_and_b32 v99, 0xffff0000, v185
  v_lshlrev_b32 v100, 16, v186
  v_and_b32 v101, 0xffff0000, v186
  v_lshlrev_b32 v102, 16, v187
  v_and_b32 v103, 0xffff0000, v187
  v_lshlrev_b32 v104, 16, v152
  v_and_b32 v105, 0xffff0000, v152
  v_lshlrev_b32 v106, 16, v153
  v_and_b32 v107, 0xffff0000, v153
  v_lshlrev_b32 v108, 16, v154
  v_and_b32 v109, 0xffff0000, v154
  v_lshlrev_b32 v110, 16, v155
  v_and_b32 v111, 0xffff0000, v155
  v_pk_fma_f32 v[96:97], v[96:97], v[32:33], v[104:105]
  v_pk_fma_f32 v[98:99], v[98:99], v[34:35], v[106:107]
  v_pk_fma_f32 v[100:101], v[100:101], v[36:37], v[108:109]
  v_pk_fma_f32 v[102:103], v[102:103], v[38:39], v[110:111]
  v_cvt_pk_bf16_f32 v112, v96, v97
  v_cvt_pk_bf16_f32 v113, v98, v99
  v_cvt_pk_bf16_f32 v114, v100, v101
  v_cvt_pk_bf16_f32 v115, v102, v103
  s_nop 1
  v_permlane16_swap_b32 v112, v114
  v_permlane16_swap_b32 v113, v115
  s_mov_b32 s59, 65536
  buffer_store_dwordx4 v[112:115], v249, s[32:35], s59 offen offset:0 sc1
  v_lshlrev_b32 v116, 16, v188
  v_and_b32 v117, 0xffff0000, v188
  v_lshlrev_b32 v118, 16, v189
  v_and_b32 v119, 0xffff0000, v189
  v_lshlrev_b32 v120, 16, v190
  v_and_b32 v121, 0xffff0000, v190
  v_lshlrev_b32 v122, 16, v191
  v_and_b32 v123, 0xffff0000, v191
  v_lshlrev_b32 v124, 16, v156
  v_and_b32 v125, 0xffff0000, v156
  v_lshlrev_b32 v126, 16, v157
  v_and_b32 v127, 0xffff0000, v157
  v_lshlrev_b32 v128, 16, v158
  v_and_b32 v129, 0xffff0000, v158
  v_lshlrev_b32 v130, 16, v159
  v_and_b32 v131, 0xffff0000, v159
  v_pk_fma_f32 v[116:117], v[116:117], v[40:41], v[124:125]
  v_pk_fma_f32 v[118:119], v[118:119], v[42:43], v[126:127]
  v_pk_fma_f32 v[120:121], v[120:121], v[44:45], v[128:129]
  v_pk_fma_f32 v[122:123], v[122:123], v[46:47], v[130:131]
  v_cvt_pk_bf16_f32 v132, v116, v117
  v_cvt_pk_bf16_f32 v133, v118, v119
  v_cvt_pk_bf16_f32 v134, v120, v121
  v_cvt_pk_bf16_f32 v135, v122, v123
  s_nop 1
  v_permlane16_swap_b32 v132, v134
  v_permlane16_swap_b32 v133, v135
  s_mov_b32 s59, 98304
  buffer_store_dwordx4 v[132:135], v249, s[32:35], s59 offen offset:0 sc1
  v_lshlrev_b32 v96, 16, v192
  v_and_b32 v97, 0xffff0000, v192
  v_lshlrev_b32 v98, 16, v193
  v_and_b32 v99, 0xffff0000, v193
  v_lshlrev_b32 v100, 16, v194
  v_and_b32 v101, 0xffff0000, v194
  v_lshlrev_b32 v102, 16, v195
  v_and_b32 v103, 0xffff0000, v195
  v_lshlrev_b32 v104, 16, v160
  v_and_b32 v105, 0xffff0000, v160
  v_lshlrev_b32 v106, 16, v161
  v_and_b32 v107, 0xffff0000, v161
  v_lshlrev_b32 v108, 16, v162
  v_and_b32 v109, 0xffff0000, v162
  v_lshlrev_b32 v110, 16, v163
  v_and_b32 v111, 0xffff0000, v163
  v_pk_fma_f32 v[96:97], v[96:97], v[48:49], v[104:105]
  v_pk_fma_f32 v[98:99], v[98:99], v[50:51], v[106:107]
  v_pk_fma_f32 v[100:101], v[100:101], v[52:53], v[108:109]
  v_pk_fma_f32 v[102:103], v[102:103], v[54:55], v[110:111]
  v_cvt_pk_bf16_f32 v112, v96, v97
  v_cvt_pk_bf16_f32 v113, v98, v99
  v_cvt_pk_bf16_f32 v114, v100, v101
  v_cvt_pk_bf16_f32 v115, v102, v103
  s_nop 1
  v_permlane16_swap_b32 v112, v114
  v_permlane16_swap_b32 v113, v115
  s_mov_b32 s59, 0
  buffer_store_dwordx4 v[112:115], v249, s[32:35], s59 offen offset:64 sc1
  v_lshlrev_b32 v116, 16, v196
  v_and_b32 v117, 0xffff0000, v196
  v_lshlrev_b32 v118, 16, v197
  v_and_b32 v119, 0xffff0000, v197
  v_lshlrev_b32 v120, 16, v198
  v_and_b32 v121, 0xffff0000, v198
  v_lshlrev_b32 v122, 16, v199
  v_and_b32 v123, 0xffff0000, v199
  v_lshlrev_b32 v124, 16, v164
  v_and_b32 v125, 0xffff0000, v164
  v_lshlrev_b32 v126, 16, v165
  v_and_b32 v127, 0xffff0000, v165
  v_lshlrev_b32 v128, 16, v166
  v_and_b32 v129, 0xffff0000, v166
  v_lshlrev_b32 v130, 16, v167
  v_and_b32 v131, 0xffff0000, v167
  v_pk_fma_f32 v[116:117], v[116:117], v[56:57], v[124:125]
  v_pk_fma_f32 v[118:119], v[118:119], v[58:59], v[126:127]
  v_pk_fma_f32 v[120:121], v[120:121], v[60:61], v[128:129]
  v_pk_fma_f32 v[122:123], v[122:123], v[62:63], v[130:131]
  v_cvt_pk_bf16_f32 v132, v116, v117
  v_cvt_pk_bf16_f32 v133, v118, v119
  v_cvt_pk_bf16_f32 v134, v120, v121
  v_cvt_pk_bf16_f32 v135, v122, v123
  s_nop 1
  v_permlane16_swap_b32 v132, v134
  v_permlane16_swap_b32 v133, v135
  s_mov_b32 s59, 32768
  buffer_store_dwordx4 v[132:135], v249, s[32:35], s59 offen offset:64 sc1
  v_lshlrev_b32 v96, 16, v200
  v_and_b32 v97, 0xffff0000, v200
  v_lshlrev_b32 v98, 16, v201
  v_and_b32 v99, 0xffff0000, v201
  v_lshlrev_b32 v100, 16, v202
  v_and_b32 v101, 0xffff0000, v202
  v_lshlrev_b32 v102, 16, v203
  v_and_b32 v103, 0xffff0000, v203
  v_lshlrev_b32 v104, 16, v168
  v_and_b32 v105, 0xffff0000, v168
  v_lshlrev_b32 v106, 16, v169
  v_and_b32 v107, 0xffff0000, v169
  v_lshlrev_b32 v108, 16, v170
  v_and_b32 v109, 0xffff0000, v170
  v_lshlrev_b32 v110, 16, v171
  v_and_b32 v111, 0xffff0000, v171
  v_pk_fma_f32 v[96:97], v[96:97], v[64:65], v[104:105]
  v_pk_fma_f32 v[98:99], v[98:99], v[66:67], v[106:107]
  v_pk_fma_f32 v[100:101], v[100:101], v[68:69], v[108:109]
  v_pk_fma_f32 v[102:103], v[102:103], v[70:71], v[110:111]
  v_cvt_pk_bf16_f32 v112, v96, v97
  v_cvt_pk_bf16_f32 v113, v98, v99
  v_cvt_pk_bf16_f32 v114, v100, v101
  v_cvt_pk_bf16_f32 v115, v102, v103
  s_nop 1
  v_permlane16_swap_b32 v112, v114
  v_permlane16_swap_b32 v113, v115
  s_mov_b32 s59, 65536
  buffer_store_dwordx4 v[112:115], v249, s[32:35], s59 offen offset:64 sc1
  v_lshlrev_b32 v116, 16, v204
  v_and_b32 v117, 0xffff0000, v204
  v_lshlrev_b32 v118, 16, v205
  v_and_b32 v119, 0xffff0000, v205
  v_lshlrev_b32 v120, 16, v206
  v_and_b32 v121, 0xffff0000, v206
  v_lshlrev_b32 v122, 16, v207
  v_and_b32 v123, 0xffff0000, v207
  v_lshlrev_b32 v124, 16, v172
  v_and_b32 v125, 0xffff0000, v172
  v_lshlrev_b32 v126, 16, v173
  v_and_b32 v127, 0xffff0000, v173
  v_lshlrev_b32 v128, 16, v174
  v_and_b32 v129, 0xffff0000, v174
  v_lshlrev_b32 v130, 16, v175
  v_and_b32 v131, 0xffff0000, v175
  v_pk_fma_f32 v[116:117], v[116:117], v[72:73], v[124:125]
  v_pk_fma_f32 v[118:119], v[118:119], v[74:75], v[126:127]
  v_pk_fma_f32 v[120:121], v[120:121], v[76:77], v[128:129]
  v_pk_fma_f32 v[122:123], v[122:123], v[78:79], v[130:131]
  v_cvt_pk_bf16_f32 v132, v116, v117
  v_cvt_pk_bf16_f32 v133, v118, v119
  v_cvt_pk_bf16_f32 v134, v120, v121
  v_cvt_pk_bf16_f32 v135, v122, v123
  s_nop 1
  v_permlane16_swap_b32 v132, v134
  v_permlane16_swap_b32 v133, v135
  s_mov_b32 s59, 98304
  buffer_store_dwordx4 v[132:135], v249, s[32:35], s59 offen offset:64 sc1
  s_endpgm
fz_end:
.section .rodata,"a"
.p2align 6
.amdhsa_kernel recurrent_scan__sliding_block__glu_gated_bilinear__prompt_kernel
  .amdhsa_next_free_vgpr 512
  .amdhsa_next_free_sgpr 102
  .amdhsa_accum_offset 256
  .amdhsa_group_segment_fixed_size 0
  .amdhsa_kernarg_size 80
  .amdhsa_user_sgpr_count 2
  .amdhsa_user_sgpr_kernarg_segment_ptr 1
  .amdhsa_system_sgpr_workgroup_id_x 1
.end_amdhsa_kernel
```
